```python
import torch

def _softmax(x, axis=-1):
    return torch.softmax(x, dim=axis)

def _gelu(x):
    return torch.nn.functional.gelu(x, approximate='tanh')

def _silu(x):
    return torch.nn.functional.silu(x)

def _sigmoid(x):
    return torch.sigmoid(x)

def _layernorm(x, axis=-1, eps=1e-05):
    m = x.mean(dim=axis, keepdim=True)
    v = x.var(dim=axis, keepdim=True, unbiased=False)
    return (x - m) / torch.sqrt(v + eps)

def _scatter_add(tgt, idx, src, axis=0):
    return tgt.clone().index_add_(axis, idx, src)

def _segment_sum(src, seg, n):
    out = torch.zeros((n,) + src.shape[1:], dtype=src.dtype)
    return out.index_add_(0, seg, src)

def _pad(x, pw):
    flat = tuple((v for pair in reversed(pw) for v in pair))
    return torch.nn.functional.pad(x, flat)
kernel_name = 'standalone__tensor_product_equiv_mace__graph'

def setup_inputs():

    _w = lambda a: (lambda t: t.to(torch.bfloat16) if t.is_floating_point() else t)(torch.as_tensor(a))
    N, deg = (10000, 16)
    Lmax, C, De = (1, 256, 16)
    M = (Lmax + 1) ** 2
    E = N * deg
    src = (lambda lo, hi, *s: torch.randint(lo, hi, s))(0, N, E).to(torch.int64)
    dst = (lambda lo, hi, *s: torch.randint(lo, hi, s))(0, N, E).to(torch.int64)
    r = (lambda *s: torch.randn(*s, dtype=torch.bfloat16) * 0.05)(E, 3).to(float)
    r = r / (torch.linalg.norm(r, dim=-1, keepdim=True).to(float) + 1e-06)
    rx, ry, rz = (r[:, 0].clone(), r[:, 1].clone(), r[:, 2].clone())
    x2, y2, z2 = (rx * rx, ry * ry, rz * rz)
    sh_list = [torch.ones_like(rx), rx, ry, rz, rx * ry, ry * rz, 2.0 * z2 - x2 - y2, rx * rz, x2 - y2, ry * (3.0 * x2 - y2), rx * ry * rz, ry * (4.0 * z2 - x2 - y2), rz * (2.0 * z2 - 3.0 * x2 - 3.0 * y2), rx * (4.0 * z2 - x2 - y2), rz * (x2 - y2), rx * (x2 - 3.0 * y2)]
    sh16 = torch.stack(sh_list, dim=-1).to(float)
    pad = max(0, M - 16)
    sh_full = torch.cat([sh16, torch.zeros((E, pad), dtype=float)], dim=-1)[:, :M]
    cg = ((lambda *s: torch.randn(*s, dtype=torch.bfloat16) * 0.05)(M, M, M) * (1.0 / float(M))).to(float)
    return {'x': _w(((lambda *s: torch.randn(*s, dtype=torch.bfloat16) * 0.05)(N, M, C) * 0.3).to(float)), 'src': _w(src), 'dst': _w(dst), 'sh': _w(sh_full.to(float)), 'edge_attr': _w(((lambda *s: torch.randn(*s, dtype=torch.bfloat16) * 0.05)(E, De) * 0.3).to(float)), 'cg': _w(cg), 'w_r': _w(((lambda *s: torch.randn(*s, dtype=torch.bfloat16) * 0.05)(De, C) * (1.0 / float(De) ** 0.5)).to(float)), 'w_out': _w(((lambda *s: torch.randn(*s, dtype=torch.bfloat16) * 0.05)(C, C) * (1.0 / float(C) ** 0.5)).to(float))}

def reference(x, src, dst, sh, edge_attr, cg, w_r, w_out):
    N = x.shape[0]
    M = x.shape[1]
    C = x.shape[2]
    h = x[src]
    tp = torch.einsum('uvw,euc,ev->ewc', cg, h, sh)
    rw = edge_attr @ w_r
    msg = tp * rw[:, None, :]
    msg2 = msg.reshape(-1, M * C)
    agg = _segment_sum(msg2, dst, N).reshape(N, M, C)
    out = torch.einsum('nmc,cd->nmd', agg, w_out)
    return out
```

```asm
; @launch kernel=ka_kernel grid=(256,1,1) block=(640,1,1) lds=90112
; @launch kernel=main_kernel grid=(256,1,1) block=(768,1,1) lds=163840
.amdgcn_target "amdgcn-amd-amdhsa--gfx950"
.text
.globl ka_kernel
.p2align 8
.type ka_kernel,@function
ka_kernel:
    s_cmp_ge_u32 s2, 256
    s_cbranch_scc1 ka_end
    s_load_dwordx8 s[4:11], s[0:1], 8
    s_load_dwordx2 s[16:17], s[0:1], 0
    s_load_dwordx2 s[14:15], s[0:1], 80
    s_load_dwordx2 s[32:33], s[0:1], 56
    v_lshrrev_b32 v9, 6, v0
    v_and_b32 v1, 63, v0
    v_readfirstlane_b32 s18, v9
    s_cmp_ge_u32 s2, 128
    s_cbranch_scc1 ka_pf
    v_lshlrev_b32 v2, 2, v0
    v_and_b32 v2, 0x3fc, v2
    v_mov_b32 v3, 0
    ds_write_b32 v2, v3
    s_mul_i32 s3, s2, 1280
    v_add_u32 v4, s3, v0
    v_lshlrev_b32 v5, 2, v4
    v_lshlrev_b32 v6, 3, v4
    v_add_u32 v8, 5120, v6
    v_and_b32 v7, 0xffffffc0, v4
    v_lshlrev_b32 v7, 5, v7
    v_lshl_add_u32 v7, v1, 4, v7
    v_add_u32 v9, 20480, v7
    s_mov_b32 s22, 12582912
    s_mov_b32 s23, 0x20000
    s_and_b32 s28, s2, 7
    s_lshl_b32 s28, s28, 6
    s_lshr_b32 s29, s2, 3
    s_lshl2_add_u32 s28, s29, s28
    s_add_u32 s28, s28, 10485760
    s_cmp_ge_u32 s2, 125
    s_waitcnt lgkmcnt(0)
    s_mov_b32 s20, s14
    s_cbranch_scc1 ka_extra
    global_load_dword v10, v5, s[6:7]
    global_load_dword v60, v5, s[6:7] offset:2560
    global_load_dword v11, v5, s[4:5]
    global_load_dword v61, v5, s[4:5] offset:2560
    s_and_b32 s21, s15, 0xffff
    v_mov_b32 v3, 1
    v_lshrrev_b32 v24, 1, v1
    v_lshlrev_b32 v24, 2, v24
    v_and_b32 v25, 1, v0
    v_lshlrev_b32 v25, 4, v25
    v_lshlrev_b32 v26, 4, v1
    s_lshl_b32 s19, s18, 10
    v_add_u32 v27, s19, v26
    s_movk_i32 s29, 625
    s_movk_i32 s39, 1250
    s_barrier
    global_load_dwordx2 v[12:13], v6, s[8:9]
    global_load_dwordx4 v[16:19], v7, s[10:11]
    global_load_dwordx4 v[20:23], v7, s[10:11] offset:1024
    global_load_dwordx2 v[72:73], v8, s[8:9]
    global_load_dwordx4 v[64:67], v9, s[10:11]
    global_load_dwordx4 v[68:71], v9, s[10:11] offset:1024
    s_waitcnt vmcnt(9)
    v_mul_u32_u24 v32, 214749, v10
    v_lshrrev_b32 v32, 23, v32
    v_min_u32 v32, 255, v32
    v_lshlrev_b32 v35, 2, v32
    ds_add_rtn_u32 v36, v35, v3
    s_waitcnt vmcnt(8)
    v_mul_u32_u24 v62, 214749, v60
    v_lshrrev_b32 v62, 23, v62
    v_min_u32 v62, 255, v62
    v_lshlrev_b32 v76, 2, v62
    ds_add_rtn_u32 v77, v76, v3
    s_waitcnt vmcnt(6)
    v_mad_u32_u24 v33, v32, s29, 15
    v_lshrrev_b32 v33, 4, v33
    v_sub_u32 v33, v10, v33
    v_mul_u32_u24 v39, 6711, v11
    v_lshrrev_b32 v39, 21, v39
    v_lshlrev_b32 v32, 2, v32
    v_sub_u32 v39, v39, v32
    v_and_b32 v39, 31, v39
    v_and_b32 v15, 1, v33
    v_lshl_or_b32 v39, v15, 5, v39
    v_and_b32 v14, 0x3fff, v11
    v_lshl_or_b32 v14, v39, 18, v14
    v_and_b32 v15, 62, v33
    v_lshlrev_b32 v15, 1, v15
    v_add_u32 v35, s19, v35
    v_mad_u32_u24 v63, v62, s29, 15
    v_lshrrev_b32 v63, 4, v63
    v_sub_u32 v63, v60, v63
    v_mul_u32_u24 v78, 6711, v61
    v_lshrrev_b32 v78, 21, v78
    v_lshlrev_b32 v62, 2, v62
    v_sub_u32 v78, v78, v62
    v_and_b32 v78, 31, v78
    v_and_b32 v75, 1, v63
    v_lshl_or_b32 v78, v75, 5, v78
    v_and_b32 v74, 0x3fff, v61
    v_lshl_or_b32 v74, v78, 18, v74
    v_and_b32 v75, 62, v63
    v_lshlrev_b32 v75, 1, v75
    v_add_u32 v76, s19, v76
    s_waitcnt lgkmcnt(0)
    s_barrier
    ds_read_b128 v[44:47], v26
    ds_read_b32 v37, v2
    s_add_u32 s34, s2, 0
    s_and_b32 s34, s34, 7
    s_mul_i32 s34, s34, 2560000
    s_add_u32 s24, s16, s34
    s_addc_u32 s25, s17, 0
    s_and_b32 s25, s25, 0xffff
    s_mov_b32 s26, 1638400
    s_mov_b32 s27, 0x20000
    s_bfe_u32 s30, s2, 0x40003
    v_lshlrev_b32 v40, 7, v0
    s_mul_i32 s30, s30, 24576
    s_add_u32 s30, s30, 1310720
    s_cmp_lt_u32 s18, 2
    s_cselect_b32 s31, s30, 0x8000000
    buffer_load_dword v42, v40, s[24:27], s31 offen
    v_add_u32 v28, s19, v2
    v_lshlrev_b32 v29, 9, v0
    s_mul_i32 s19, s2, 61440
    s_waitcnt lgkmcnt(1)
    v_add_u32 v53, v44, v45
    v_add_u32 v54, v53, v46
    v_add_u32 v38, v54, v47
    v_mov_b32 v55, v38
    s_nop 0
    v_add_u32_dpp v38, v38, v38 row_shr:1 row_mask:0xf bank_mask:0xf
    s_nop 1
    v_add_u32_dpp v38, v38, v38 row_shr:2 row_mask:0xf bank_mask:0xf
    s_nop 1
    v_add_u32_dpp v38, v38, v38 row_shr:4 row_mask:0xf bank_mask:0xf
    s_nop 1
    v_add_u32_dpp v38, v38, v38 row_shr:8 row_mask:0xf bank_mask:0xf
    s_nop 1
    v_add_u32_dpp v38, v38, v38 row_bcast:15 row_mask:0xa bank_mask:0xf
    s_nop 1
    v_add_u32_dpp v38, v38, v38 row_bcast:31 row_mask:0xc bank_mask:0xf
    v_sub_u32 v56, v38, v55
    v_add_u32 v57, v56, v44
    v_add_u32 v58, v56, v53
    v_add_u32 v59, v56, v54
    ds_write_b128 v27, v[56:59] offset:1024
    ds_read_b32 v43, v35 offset:1024
    ds_read_b32 v79, v76 offset:1024
    ds_read_b32 v30, v28 offset:1024
    s_waitcnt lgkmcnt(1)
    v_add_u32 v43, v43, v36
    v_mul_u32_u24 v43, 48, v43
    ds_bpermute_b32 v48, v24, v43
    ds_bpermute_b32 v49, v24, v43 offset:128
    v_add_u32 v79, v79, v77
    v_mul_u32_u24 v79, 48, v79
    ds_bpermute_b32 v80, v24, v79
    ds_bpermute_b32 v81, v24, v79 offset:128
    s_cmp_ge_u32 s18, 4
    s_waitcnt lgkmcnt(0)
    v_lshl_or_b32 v30, v37, 16, v30
    v_add_u32 v48, v48, v25
    v_add_u32 v49, v49, v25
    v_add_u32 v80, v80, v25
    v_add_u32 v81, v81, v25
    s_waitcnt vmcnt(6)
    ds_write_b128 v43, v[12:15] offset:11296
    s_waitcnt vmcnt(5)
    ds_write_b128 v48, v[16:19] offset:11264
    s_waitcnt vmcnt(4)
    ds_write_b128 v49, v[20:23] offset:11264
    s_waitcnt vmcnt(3)
    ds_write_b128 v79, v[72:75] offset:11296
    s_waitcnt vmcnt(2)
    ds_write_b128 v80, v[64:67] offset:11264
    s_waitcnt vmcnt(1)
    ds_write_b128 v81, v[68:71] offset:11264
    s_cbranch_scc1 ka_nohdr
    buffer_store_dword v30, v29, s[20:23], s28 offen
ka_nohdr:
    v_lshlrev_b32 v5, 4, v0
    s_waitcnt lgkmcnt(0)
    s_barrier
    ds_read_b128 v[12:15], v5 offset:11264
    ds_read_b128 v[16:19], v5 offset:21504
    ds_read_b128 v[20:23], v5 offset:31744
    ds_read_b128 v[24:27], v5 offset:41984
    ds_read_b128 v[28:31], v5 offset:52224
    ds_read_b128 v[32:35], v5 offset:62464
    s_waitcnt lgkmcnt(5)
    buffer_store_dwordx4 v[12:15], v5, s[20:23], s19 offen
    s_addk_i32 s19, 10240
    s_waitcnt lgkmcnt(4)
    buffer_store_dwordx4 v[16:19], v5, s[20:23], s19 offen
    s_addk_i32 s19, 10240
    s_waitcnt lgkmcnt(3)
    buffer_store_dwordx4 v[20:23], v5, s[20:23], s19 offen
    s_addk_i32 s19, 10240
    s_waitcnt lgkmcnt(2)
    buffer_store_dwordx4 v[24:27], v5, s[20:23], s19 offen
    s_addk_i32 s19, 10240
    s_waitcnt lgkmcnt(1)
    buffer_store_dwordx4 v[28:31], v5, s[20:23], s19 offen
    s_addk_i32 s19, 10240
    s_waitcnt lgkmcnt(0)
    buffer_store_dwordx4 v[32:35], v5, s[20:23], s19 offen
ka_late:
    s_cmp_lt_u32 s18, 2
    s_cbranch_scc1 ka_end
    s_cmp_ge_u32 s18, 3
    s_cbranch_scc1 ka_end
    buffer_load_dword v42, v40, s[24:27], s30 offen
    s_endpgm
ka_pf:
    s_waitcnt lgkmcnt(0)
    s_add_u32 s34, s2, 0
    s_and_b32 s34, s34, 7
    s_mul_i32 s34, s34, 2560000
    s_add_u32 s24, s16, s34
    s_addc_u32 s25, s17, 0
    s_and_b32 s25, s25, 0xffff
    s_mov_b32 s26, 1638400
    s_mov_b32 s27, 0x20000
    s_bfe_u32 s30, s2, 0x40003
    v_lshlrev_b32 v40, 7, v0
    s_mul_i32 s30, s30, 81920
    s_cmp_lg_u32 s18, 9
    s_cbranch_scc1 ka_pf1
    s_bitcmp1_b32 s2, 3
    s_cbranch_scc1 ka_pf0
    s_and_b32 s35, s2, 7
    s_bfe_u32 s36, s2, 0x30004
    s_lshl_b32 s37, s35, 14
    s_lshr_b32 s38, s36, 1
    s_lshl_b32 s38, s38, 7
    s_add_u32 s37, s37, s38
    s_and_b32 s38, s36, 1
    s_lshl2_add_u32 s37, s38, s37
    v_lshrrev_b32 v44, 4, v1
    v_lshlrev_b32 v44, 11, v44
    v_and_b32 v45, 7, v1
    v_lshl_add_u32 v44, v45, 4, v44
    v_and_b32 v45, 8, v1
    v_add3_u32 v44, v44, v45, s37
    v_add_u32 v45, 0x2000, v44
    global_load_dword v48, v44, s[32:33] offset:0
    global_load_dword v49, v44, s[32:33] offset:512
    global_load_dword v50, v44, s[32:33] offset:1024
    global_load_dword v51, v44, s[32:33] offset:1536
    global_load_dword v52, v45, s[32:33] offset:0
    global_load_dword v53, v45, s[32:33] offset:512
    global_load_dword v54, v45, s[32:33] offset:1024
    global_load_dword v55, v45, s[32:33] offset:1536
    s_lshr_b32 s36, s36, 1
    s_lshl3_add_u32 s36, s36, s35
    s_lshl1_add_u32 s36, s36, s38
    s_lshl_b32 s36, s36, 11
    s_add_u32 s36, s36, 11534336
    v_lshl_add_u32 v46, v1, 4, s36
    s_mov_b32 s38, 0x05040100
    s_mov_b32 s39, 0x07060302
    s_waitcnt vmcnt(0)
    v_perm_b32 v56, v49, v48, s38
    v_perm_b32 v60, v49, v48, s39
    v_perm_b32 v57, v51, v50, s38
    v_perm_b32 v61, v51, v50, s39
    v_perm_b32 v58, v53, v52, s38
    v_perm_b32 v62, v53, v52, s39
    v_perm_b32 v59, v55, v54, s38
    v_perm_b32 v63, v55, v54, s39
    global_store_dwordx4 v46, v[56:59], s[14:15]
    global_store_dwordx4 v46, v[60:63], s[14:15] offset:1024
    s_branch ka_pf1
ka_pf0:
    s_load_dwordx4 s[36:39], s[0:1], 40
    v_lshlrev_b32 v44, 7, v1
    v_mov_b32 v45, 0
    s_waitcnt lgkmcnt(0)
    global_load_dword v46, v44, s[38:39]
    global_load_dword v47, v45, s[36:37]
ka_pf1:
    s_cmp_ge_u32 s18, 10
    s_cbranch_scc1 ka_pf2
    buffer_load_dword v42, v40, s[24:27], s30 offen
    s_cmp_ge_u32 s18, 0
    s_cbranch_scc1 ka_pf2
    s_add_u32 s30, s30, 81920
    buffer_load_dword v43, v40, s[24:27], s30 offen
ka_pf2:
    s_waitcnt vmcnt(0)
    s_endpgm
ka_extra:
    s_add_u32 s34, s2, 0
    s_and_b32 s34, s34, 7
    s_mul_i32 s34, s34, 2560000
    s_add_u32 s24, s16, s34
    s_addc_u32 s25, s17, 0
    s_and_b32 s25, s25, 0xffff
    s_mov_b32 s26, 1638400
    s_mov_b32 s27, 0x20000
    s_bfe_u32 s30, s2, 0x40003
    v_lshlrev_b32 v40, 7, v0
    s_mul_i32 s30, s30, 24576
    s_add_u32 s30, s30, 1310720
    s_cmp_lt_u32 s18, 2
    s_cselect_b32 s31, s30, 0x8000000
    buffer_load_dword v42, v40, s[24:27], s31 offen
    s_branch ka_late
ka_end:
    s_endpgm
.globl main_kernel
.p2align 8
.type main_kernel,@function
main_kernel:
    s_cmp_ge_u32 s2, 256
    s_cbranch_scc1 mn_end
    s_load_dwordx2 s[54:55], s[0:1], 80
    s_load_dwordx2 s[50:51], s[0:1], 0
    s_load_dwordx4 s[60:63], s[0:1], 40
    s_load_dwordx2 s[56:57], s[0:1], 64
    v_lshrrev_b32 v41, 6, v0
    v_lshlrev_b32 v42, 2, v0
    v_readfirstlane_b32 s16, v41
    v_and_b32 v42, 0x1fc, v42
    v_mov_b32 v43, 0
    ds_write_b32 v42, v43
    v_mul_u32_u24 v38, 10923, v0
    v_lshrrev_b32 v38, 16, v38
    v_lshlrev_b32 v41, 2, v38
    s_lshl_b32 s49, s2, 9
    s_add_u32 s49, s49, 10485760
    s_mov_b32 s10, 12582912
    s_mov_b32 s11, 0x20000
    v_lshlrev_b32 v42, 4, v0
    s_lshl_b32 s52, s16, 10
    s_add_u32 s52, s52, 1024
    s_mov_b32 m0, s52
    s_cmp_ge_u32 s16, 8
    s_waitcnt lgkmcnt(0)
    s_mov_b32 s8, s54
    s_and_b32 s9, s55, 0xffff
    s_cmp_ge_u32 s16, 8
    buffer_load_dword v84, v41, s[8:11], s49 offen
    s_cbranch_scc1 mn_cg
    global_load_lds_dwordx4 v42, s[62:63]
mn_cg_back:
    s_and_b32 s17, s16, 3
    s_bfe_u32 s18, s16, 0x10002
    s_lshl_b32 s53, s17, 7
    s_add_u32 s4, s50, s53
    s_addc_u32 s5, s51, 0
    s_and_b32 s5, s5, 0xffff
    s_or_b32 s5, s5, 0x08000000
    s_movk_i32 s6, 10000
    s_mov_b32 s7, 0x20000
    s_mul_i32 s22, s2, 625
    s_add_u32 s52, s22, 640
    s_add_u32 s22, s22, 15
    s_lshr_b32 s22, s22, 4
    s_lshr_b32 s52, s52, 4
    s_mov_b32 s12, s56
    s_and_b32 s13, s57, 0xffff
    s_lshl_b32 s14, s52, 11
    s_mov_b32 s15, 0x20000
    s_and_b32 s52, s16, 7
    s_mul_i32 s40, s52, 11520
    s_add_u32 s40, s40, 71680
    s_add_u32 s41, s40, 1024
    s_add_u32 s42, s40, 2048
    s_add_u32 s43, s40, 3072
    s_add_u32 s44, s40, 4096
    s_add_u32 s45, s40, 5120
    s_mov_b32 s24, 0x0f0f0f0f
    s_mov_b32 s25, 0x0f0f0f0f
    s_not_b64 s[26:27], s[24:25]
    s_movk_i32 s20, 24
    v_and_b32 v41, 15, v38
    v_lshrrev_b32 v42, 4, v38
    v_lshl_or_b32 v41, v41, 3, v42
    v_cmp_gt_u32 vcc, 125, v41
    v_mul_u32_u24 v85, 61440, v41
    v_mul_u32_u24 v38, 6, v38
    v_sub_u32 v38, v0, v38
    v_mad_u32_u24 v85, v38, 48, v85
    v_and_b32 v41, 3, v0
    v_bfe_u32 v42, v0, 2, 2
    v_bfe_u32 v43, v0, 4, 1
    v_bfe_u32 v39, v0, 5, 1
    v_lshlrev_b32 v1, 3, v41
    v_lshl_add_u32 v1, v43, 5, v1
    v_lshl_add_u32 v1, v42, 6, v1
    v_lshl_add_u32 v1, v39, 8, v1
    v_add_u32 v1, s40, v1
    v_lshlrev_b32 v5, 4, v41
    v_lshl_add_u32 v5, v43, 6, v5
    v_lshl_add_u32 v5, v42, 9, v5
    v_mov_b32 v7, v5
    v_mov_b32 v60, 0
    v_mov_b32 v61, 0
    v_mov_b32 v62, 0
    v_mov_b32 v63, 0
    v_mov_b32 v64, 0
    v_mov_b32 v65, 0
    v_mov_b32 v66, 0
    v_mov_b32 v67, 0
    s_barrier
    s_waitcnt vmcnt(1)
    v_and_b32 v41, 0xffff, v84
    v_lshrrev_b32 v84, 16, v84
    v_mad_u32_u24 v85, v41, 48, v85
    v_cndmask_b32 v84, 0, v84, vcc
    v_sub_u32 v84, v84, v38
    v_cmpx_lt_i32 vcc, 0, v84
    s_cbranch_execz mn_ld_done
    buffer_load_dwordx4 v[44:47], v85, s[8:11], 0 offen offset:32
    s_cmp_le_u32 s20, 6
    s_cbranch_scc1 mn_ld_done
    v_cmpx_lt_i32 vcc, 6, v84
    s_cbranch_execz mn_ld_done
    buffer_load_dwordx4 v[48:51], v85, s[8:11], 0 offen offset:320
    v_cmpx_lt_i32 vcc, 12, v84
    s_cbranch_execz mn_ld_done
    buffer_load_dwordx4 v[52:55], v85, s[8:11], 0 offen offset:608
    v_cmpx_lt_i32 vcc, 18, v84
    s_cbranch_execz mn_ld_done
    buffer_load_dwordx4 v[56:59], v85, s[8:11], 0 offen offset:896
mn_ld_done:
    s_mov_b64 exec, -1
    v_mov_b64 v[88:89], 0
    v_mov_b64 v[90:91], 0
    v_mov_b64 v[92:93], 0
    v_mov_b64 v[94:95], 0
    v_mov_b64 v[96:97], 0
    v_mov_b64 v[98:99], 0
    v_mov_b64 v[100:101], 0
    v_mov_b64 v[102:103], 0
    v_mov_b64 v[104:105], 0
    v_mov_b64 v[106:107], 0
    v_mov_b64 v[108:109], 0
    v_mov_b64 v[110:111], 0
    v_mov_b64 v[112:113], 0
    v_mov_b64 v[114:115], 0
    v_mov_b64 v[116:117], 0
    v_mov_b64 v[118:119], 0
    v_mov_b64 v[120:121], 0
    v_mov_b64 v[122:123], 0
    v_mov_b64 v[124:125], 0
    v_mov_b64 v[126:127], 0
    v_mov_b64 v[128:129], 0
    v_mov_b64 v[130:131], 0
    v_mov_b64 v[132:133], 0
    v_mov_b64 v[134:135], 0
    v_mov_b64 v[136:137], 0
    v_mov_b64 v[138:139], 0
    v_mov_b64 v[140:141], 0
    v_mov_b64 v[142:143], 0
    v_mov_b64 v[144:145], 0
    v_mov_b64 v[146:147], 0
    v_mov_b64 v[148:149], 0
    v_mov_b64 v[150:151], 0
    v_mov_b64 v[152:153], 0
    v_mov_b64 v[154:155], 0
    v_mov_b64 v[156:157], 0
    v_mov_b64 v[158:159], 0
    v_mov_b64 v[160:161], 0
    v_mov_b64 v[162:163], 0
    v_mov_b64 v[164:165], 0
    v_mov_b64 v[166:167], 0
mn_pass:
    v_and_b32 v28, 63, v0
    v_mov_b32 v30, 1
    v_lshlrev_b32 v29, 2, v28
    v_bfe_u32 v2, v0, 5, 1
    v_bfe_u32 v3, v0, 3, 2
    v_and_b32 v18, 3, v0
    v_lshl_add_u32 v3, v3, 2, v18
    v_mul_u32_u24 v31, 20, v2
    v_lshlrev_b32 v2, 4, v2
    v_lshl_add_u32 v3, v3, 5, v2
    v_lshrrev_b32 v41, 2, v28
    v_lshl_add_u32 v18, v18, 4, v41
    v_lshlrev_b32 v18, 4, v18
    v_mov_b32 v32, 0
    v_mov_b32 v33, 0
    v_mov_b32 v34, 0xffff
    v_mov_b32 v35, 0x7fffff00
    v_lshrrev_b32 v36, 1, v0
    v_lshlrev_b32 v36, 4, v36
    v_and_b32 v37, 1, v0
    v_lshlrev_b32 v37, 4, v37
    s_waitcnt vmcnt(0)
mn_count:
    v_cmp_lt_i32 vcc, s20, v84
    s_cbranch_vccnz mn_setmore
mn_setmore_back:
    v_cmpx_lt_i32 vcc, 0, v84
    s_cbranch_execz mn_cn_done
    v_lshrrev_b32 v20, 16, v46
    ds_add_rtn_u32 v24, v20, v30
    s_cmp_le_u32 s20, 6
    s_cbranch_scc1 mn_cn_done
    v_cmpx_lt_i32 vcc, 6, v84
    s_cbranch_execz mn_cn_done
    v_lshrrev_b32 v21, 16, v50
    ds_add_rtn_u32 v25, v21, v30
    v_cmpx_lt_i32 vcc, 12, v84
    s_cbranch_execz mn_cn_done
    v_lshrrev_b32 v22, 16, v54
    ds_add_rtn_u32 v26, v22, v30
    v_cmpx_lt_i32 vcc, 18, v84
    s_cbranch_execz mn_cn_done
    v_lshrrev_b32 v23, 16, v58
    ds_add_rtn_u32 v27, v23, v30
mn_cn_done:
    s_mov_b64 exec, -1
    s_cmp_ge_u32 s16, 4
    s_cbranch_scc1 mn_nopf
    s_lshr_b32 s52, s2, 3
    s_mul_i32 s52, s52, 225
    s_and_b32 s53, s2, 7
    s_mul_i32 s53, s53, 20000
    s_add_u32 s52, s52, s53
    s_add_u32 s52, s52, 12800
    s_lshl_b32 s52, s52, 7
    s_mov_b32 s36, s50
    s_and_b32 s37, s51, 0xffff
    s_mov_b32 s38, 20480000
    s_mov_b32 s39, 0x20000
    v_lshlrev_b32 v8, 7, v0
    buffer_load_dword v86, v8, s[36:39], s52 offen
mn_nopf:
    v_lshlrev_b32 v41, 4, v85
    s_lshl_b32 s52, s18, 5
    s_add_u32 s53, s52, 31
    s_waitcnt lgkmcnt(0)
    s_barrier
    ds_read_b32 v39, v29 offset:0
    ds_read_b32 v38, v32 offset:272
    s_waitcnt lgkmcnt(1)
    v_mov_b32 v40, v39
    v_sub_u32 v39, v31, v39
    v_or_b32 v47, v47, v41
    v_add_u32_dpp v40, v40, v40 row_shr:1 row_mask:0xf bank_mask:0xf
    v_add_u32 v41, 4608, v41
    v_or_b32 v51, v51, v41
    v_add_u32_dpp v40, v40, v40 row_shr:2 row_mask:0xf bank_mask:0xf
    v_add_u32 v41, 4608, v41
    v_or_b32 v55, v55, v41
    v_add_u32_dpp v40, v40, v40 row_shr:4 row_mask:0xf bank_mask:0xf
    v_add_u32 v41, 4608, v41
    v_or_b32 v59, v59, v41
    v_add_u32_dpp v40, v40, v40 row_shr:8 row_mask:0xf bank_mask:0xf
    s_nop 1
    v_add_u32_dpp v40, v40, v40 row_bcast:15 row_mask:0xa bank_mask:0xf
    s_nop 1
    v_add_u32_dpp v40, v40, v40 row_bcast:31 row_mask:0xc bank_mask:0xf
    v_add_u32 v39, v39, v40
    v_add_u32 v40, v40, v31
    ds_bpermute_b32 v20, v20, v39
    ds_bpermute_b32 v21, v21, v39
    ds_bpermute_b32 v22, v22, v39
    ds_bpermute_b32 v23, v23, v39
    v_readlane_b32 s32, v39, s52
    v_readlane_b32 s33, v40, s53
    v_readlane_b32 s23, v40, 63
    s_waitcnt lgkmcnt(4)
    v_readfirstlane_b32 s21, v38
    s_cmp_gt_u32 s23, 1260
    s_cbranch_scc1 mn_ovf
    v_add_lshl_u32 v41, s33, v28, 4
    s_lshl_b32 s52, s32, 4
    s_lshl_b32 s53, s32, 5
    s_add_u32 s53, s53, 29696
    s_mov_b32 exec_lo, 1048575
    s_mov_b32 exec_hi, 0
    ds_write_b128 v41, v[32:35] offset:9216
    s_mov_b64 exec, -1
    v_add_u32 v2, s52, v2
    v_add_u32 v3, s53, v3
    v_add_u32 v18, s52, v18
    s_sub_u32 s19, s33, s32
    s_add_u32 s19, s19, 3
    s_lshr_b32 s19, s19, 2
    s_add_u32 s23, s23, 3
    s_waitcnt lgkmcnt(1)
    v_cmpx_lt_i32 vcc, 0, v84
    s_cbranch_execz mn_w2_done
    v_add_lshl_u32 v20, v20, v24, 4
    ds_write_b128 v20, v[44:47] offset:9216
    s_cmp_le_u32 s20, 6
    s_cbranch_scc1 mn_w2_done
    v_cmpx_lt_i32 vcc, 6, v84
    s_cbranch_execz mn_w2_done
    v_add_lshl_u32 v21, v21, v25, 4
    ds_write_b128 v21, v[48:51] offset:9216
    v_cmpx_lt_i32 vcc, 12, v84
    s_cbranch_execz mn_w2_done
    v_add_lshl_u32 v22, v22, v26, 4
    ds_write_b128 v22, v[52:55] offset:9216
    v_cmpx_lt_i32 vcc, 18, v84
    s_cbranch_execz mn_w2_done
    v_add_lshl_u32 v23, v23, v27, 4
    ds_write_b128 v23, v[56:59] offset:9216
mn_w2_done:
    s_mov_b64 exec, -1
    s_lshl_b32 s52, s16, 5
    s_lshl_b32 s53, s16, 10
    s_add_u32 s53, s53, 29696
    s_mov_b32 m0, s53
    s_waitcnt lgkmcnt(0)
    s_barrier
    ds_read_b32 v41, v36 offset:9228
    ds_read_b32 v42, v36 offset:15372
    ds_read_u16 v44, v2 offset:9224
    ds_read_u16 v45, v2 offset:9256
    ds_read_u16 v46, v2 offset:9288
    ds_read_u16 v47, v2 offset:9320
    ds_read_u16 v48, v2 offset:9352
    ds_read_u16 v49, v2 offset:9384
    ds_read_u16 v50, v2 offset:9416
    ds_read_u16 v51, v2 offset:9448
    ds_read_b128 v[8:11], v18 offset:9216
    s_add_u32 s52, s52, 384
    s_cmp_lt_u32 s52, s23
    s_waitcnt lgkmcnt(9)
    v_lshrrev_b32 v41, 8, v41
    v_lshl_add_u32 v41, v41, 4, v37
    buffer_load_dwordx4 v41, s[8:11], 0 offen lds
    s_cbranch_scc0 mn_ea_done
mn_ea2:
    v_lshrrev_b32 v42, 8, v42
    s_add_u32 m0, m0, 12288
    v_lshl_add_u32 v42, v42, 4, v37
    buffer_load_dwordx4 v42, s[8:11], 0 offen lds
    s_add_u32 s52, s52, 384
    s_cmp_lt_u32 s52, s23
    s_cbranch_scc1 mn_ea3
mn_ea_done:
    s_cmp_ge_u32 s16, 8
    s_cbranch_scc1 gm_start
    s_waitcnt lgkmcnt(1)
    s_mov_b32 m0, s40
    v_mov_b32 v4, v44
    buffer_load_dwordx4 v[4:5], s[4:7], 0 idxen offen lds
    s_mov_b32 m0, s41
    v_mov_b32 v4, v45
    buffer_load_dwordx4 v[4:5], s[4:7], 0 idxen offen lds
    s_mov_b32 m0, s42
    v_mov_b32 v4, v46
    buffer_load_dwordx4 v[4:5], s[4:7], 0 idxen offen lds
    s_mov_b32 m0, s43
    v_mov_b32 v4, v47
    buffer_load_dwordx4 v[4:5], s[4:7], 0 idxen offen lds
    s_mov_b32 m0, s44
    v_mov_b32 v4, v48
    buffer_load_dwordx4 v[4:5], s[4:7], 0 idxen offen lds
    s_mov_b32 m0, s45
    v_mov_b32 v4, v49
    buffer_load_dwordx4 v[4:5], s[4:7], 0 idxen offen lds
    v_mov_b32 v4, v50
    v_mov_b32 v6, v51
    v_bfe_u32 v20, v0, 2, 2
    v_bfe_u32 v21, v0, 5, 1
    v_lshlrev_b32 v22, 3, v20
    v_lshl_add_u32 v20, v21, 3, v20
    v_lshlrev_b32 v20, 9, v20
    v_bfe_u32 v21, v0, 4, 1
    v_lshl_add_u32 v20, v21, 5, v20
    v_and_b32 v21, 3, v0
    v_lshl_add_u32 v20, v21, 3, v20
    v_lshl_add_u32 v20, s17, 7, v20
    ds_read_b64_tr_b16 v[76:77], v22 offset:512
    ds_read_b64_tr_b16 v[78:79], v22 offset:544
    ds_read_b64_tr_b16 v[80:81], v22 offset:576
    ds_read_b64_tr_b16 v[82:83], v22 offset:608
    ds_read_b64_tr_b16 v[68:69], v20 offset:1024
    ds_read_b64_tr_b16 v[70:71], v20 offset:3072
    ds_read_b64_tr_b16 v[72:73], v20 offset:1088
    ds_read_b64_tr_b16 v[74:75], v20 offset:3136
    s_waitcnt lgkmcnt(4)
    v_mov_b32 v19, v11
    v_mfma_f32_4x4x4_16b_bf16 v[28:31], v[8:9], v[76:77], 0
    v_mfma_f32_4x4x4_16b_bf16 v[32:35], v[8:9], v[78:79], 0
    v_mfma_f32_4x4x4_16b_bf16 v[36:39], v[8:9], v[80:81], 0
    v_mfma_f32_4x4x4_16b_bf16 v[40:43], v[8:9], v[82:83], 0
    s_setprio 3
    s_nop 3
    v_cvt_pk_bf16_f32 v12, v28, v32
    v_cvt_pk_bf16_f32 v14, v29, v33
    v_cvt_pk_bf16_f32 v16, v30, v34
    v_cvt_pk_bf16_f32 v13, v36, v40
    v_cvt_pk_bf16_f32 v15, v37, v41
    v_cvt_pk_bf16_f32 v17, v38, v42
    s_waitcnt vmcnt(6)
    s_barrier
    s_mov_b64 exec, s[24:25]
    ds_read_b128 v[60:63], v3 offset:0
    s_mov_b64 exec, s[26:27]
    ds_read_b128 v[64:67], v3 offset:0
    s_mov_b64 exec, -1
    s_sub_u32 s19, s19, 1
    s_cbranch_scc1 mn_exit
    s_waitcnt vmcnt(4)
    ds_read_b64_tr_b16 v[20:21], v1 offset:0
    ds_read_b64_tr_b16 v[22:23], v1 offset:512
    ds_read_b64_tr_b16 v[24:25], v1 offset:1024
    ds_read_b64_tr_b16 v[26:27], v1 offset:1536
    s_waitcnt lgkmcnt(4)
    v_mfma_f32_32x32x16_bf16 v[44:59], v[60:63], v[68:71], 0
    v_mfma_f32_32x32x16_bf16 v[44:59], v[64:67], v[72:75], v[44:59]
    s_mov_b32 m0, s40
    s_waitcnt lgkmcnt(0)
    buffer_load_dwordx4 v[4:5], s[4:7], 0 idxen offen lds
    s_mov_b32 m0, s41
    s_nop 0
    buffer_load_dwordx4 v[6:7], s[4:7], 0 idxen offen lds
mn_loop:
    v_mfma_f32_4x4x4_16b_bf16 v[28:31], v[12:13], v[20:21], 0 cbsz:4 abid:0
    v_mfma_f32_4x4x4_16b_bf16 v[32:35], v[12:13], v[22:23], 0 cbsz:4 abid:1
    v_mfma_f32_4x4x4_16b_bf16 v[36:39], v[12:13], v[24:25], 0 cbsz:4 abid:2
    v_mfma_f32_4x4x4_16b_bf16 v[40:43], v[12:13], v[26:27], 0 cbsz:4 abid:3
    ds_read_u16 v4, v2 offset:9480
    ds_read_u16 v6, v2 offset:9512
    v_readlane_b32 s28, v19, 0
    v_readlane_b32 s29, v19, 4
    v_readlane_b32 s30, v19, 8
    v_readlane_b32 s31, v19, 12
    s_waitcnt vmcnt(5)
    ds_read_b64_tr_b16 v[20:21], v1 offset:2048
    ds_read_b64_tr_b16 v[22:23], v1 offset:2560
    s_waitcnt vmcnt(4)
    ds_read_b64_tr_b16 v[24:25], v1 offset:3072
    ds_read_b64_tr_b16 v[26:27], v1 offset:3584
    s_set_gpr_idx_on s28, gpr_idx(DST)
    v_fmac_f32 v88, v28, v44
    v_fmac_f32 v89, v29, v44
    v_fmac_f32 v90, v30, v44
    v_fmac_f32 v91, v31, v44
    s_set_gpr_idx_idx s29
    v_fmac_f32 v88, v32, v45
    v_fmac_f32 v89, v33, v45
    v_fmac_f32 v90, v34, v45
    v_fmac_f32 v91, v35, v45
    s_set_gpr_idx_idx s30
    v_fmac_f32 v88, v36, v46
    v_fmac_f32 v89, v37, v46
    v_fmac_f32 v90, v38, v46
    v_fmac_f32 v91, v39, v46
    s_set_gpr_idx_idx s31
    v_fmac_f32 v88, v40, v47
    v_fmac_f32 v89, v41, v47
    v_fmac_f32 v90, v42, v47
    v_fmac_f32 v91, v43, v47
    s_set_gpr_idx_off
    s_sub_u32 s19, s19, 1
    s_cbranch_scc1 mn_exit
    s_mov_b32 m0, s42
    s_waitcnt lgkmcnt(2)
    buffer_load_dwordx4 v[4:5], s[4:7], 0 idxen offen lds
    s_mov_b32 m0, s43
    s_waitcnt lgkmcnt(0)
    buffer_load_dwordx4 v[6:7], s[4:7], 0 idxen offen lds
    v_mfma_f32_4x4x4_16b_bf16 v[28:31], v[12:13], v[20:21], 0 cbsz:4 abid:4
    v_mfma_f32_4x4x4_16b_bf16 v[32:35], v[12:13], v[22:23], 0 cbsz:4 abid:5
    v_mfma_f32_4x4x4_16b_bf16 v[36:39], v[12:13], v[24:25], 0 cbsz:4 abid:6
    v_mfma_f32_4x4x4_16b_bf16 v[40:43], v[12:13], v[26:27], 0 cbsz:4 abid:7
    ds_read_u16 v4, v2 offset:9544
    ds_read_u16 v6, v2 offset:9576
    v_readlane_b32 s28, v19, 16
    v_readlane_b32 s29, v19, 20
    v_readlane_b32 s30, v19, 24
    v_readlane_b32 s31, v19, 28
    s_waitcnt vmcnt(5)
    ds_read_b64_tr_b16 v[20:21], v1 offset:4096
    ds_read_b64_tr_b16 v[22:23], v1 offset:4608
    s_waitcnt vmcnt(4)
    ds_read_b64_tr_b16 v[24:25], v1 offset:5120
    ds_read_b64_tr_b16 v[26:27], v1 offset:5632
    s_set_gpr_idx_on s28, gpr_idx(DST)
    v_fmac_f32 v88, v28, v48
    v_fmac_f32 v89, v29, v48
    v_fmac_f32 v90, v30, v48
    v_fmac_f32 v91, v31, v48
    s_set_gpr_idx_idx s29
    v_fmac_f32 v88, v32, v49
    v_fmac_f32 v89, v33, v49
    v_fmac_f32 v90, v34, v49
    v_fmac_f32 v91, v35, v49
    s_set_gpr_idx_idx s30
    v_fmac_f32 v88, v36, v50
    v_fmac_f32 v89, v37, v50
    v_fmac_f32 v90, v38, v50
    v_fmac_f32 v91, v39, v50
    s_set_gpr_idx_idx s31
    v_fmac_f32 v88, v40, v51
    v_fmac_f32 v89, v41, v51
    v_fmac_f32 v90, v42, v51
    v_fmac_f32 v91, v43, v51
    s_set_gpr_idx_off
    s_sub_u32 s19, s19, 1
    s_cbranch_scc1 mn_exit
    s_mov_b32 m0, s44
    s_waitcnt lgkmcnt(2)
    buffer_load_dwordx4 v[4:5], s[4:7], 0 idxen offen lds
    s_mov_b32 m0, s45
    s_waitcnt lgkmcnt(0)
    buffer_load_dwordx4 v[6:7], s[4:7], 0 idxen offen lds
    v_mfma_f32_4x4x4_16b_bf16 v[28:31], v[12:13], v[20:21], 0 cbsz:4 abid:8
    v_mfma_f32_4x4x4_16b_bf16 v[32:35], v[12:13], v[22:23], 0 cbsz:4 abid:9
    v_mfma_f32_4x4x4_16b_bf16 v[36:39], v[12:13], v[24:25], 0 cbsz:4 abid:10
    v_mfma_f32_4x4x4_16b_bf16 v[40:43], v[12:13], v[26:27], 0 cbsz:4 abid:11
    ds_read_u16 v4, v2 offset:9608
    ds_read_u16 v6, v2 offset:9640
    v_readlane_b32 s28, v19, 32
    v_readlane_b32 s29, v19, 36
    v_readlane_b32 s30, v19, 40
    v_readlane_b32 s31, v19, 44
    s_mov_b64 exec, s[24:25]
    ds_read_b128 v[60:63], v3 offset:512
    s_mov_b64 exec, s[26:27]
    ds_read_b128 v[64:67], v3 offset:512
    s_mov_b64 exec, -1
    s_waitcnt vmcnt(5)
    ds_read_b64_tr_b16 v[20:21], v1 offset:0
    ds_read_b64_tr_b16 v[22:23], v1 offset:512
    s_waitcnt vmcnt(4)
    ds_read_b64_tr_b16 v[24:25], v1 offset:1024
    ds_read_b64_tr_b16 v[26:27], v1 offset:1536
    s_set_gpr_idx_on s28, gpr_idx(DST)
    v_fmac_f32 v88, v28, v52
    v_fmac_f32 v89, v29, v52
    v_fmac_f32 v90, v30, v52
    v_fmac_f32 v91, v31, v52
    s_set_gpr_idx_idx s29
    v_fmac_f32 v88, v32, v53
    v_fmac_f32 v89, v33, v53
    v_fmac_f32 v90, v34, v53
    v_fmac_f32 v91, v35, v53
    s_set_gpr_idx_idx s30
    v_fmac_f32 v88, v36, v54
    v_fmac_f32 v89, v37, v54
    v_fmac_f32 v90, v38, v54
    v_fmac_f32 v91, v39, v54
    s_set_gpr_idx_idx s31
    v_fmac_f32 v88, v40, v55
    v_fmac_f32 v89, v41, v55
    v_fmac_f32 v90, v42, v55
    v_fmac_f32 v91, v43, v55
    s_set_gpr_idx_off
    s_sub_u32 s19, s19, 1
    s_cbranch_scc1 mn_exit
    s_mov_b32 m0, s40
    s_waitcnt lgkmcnt(2)
    buffer_load_dwordx4 v[4:5], s[4:7], 0 idxen offen lds
    s_mov_b32 m0, s41
    s_waitcnt lgkmcnt(0)
    buffer_load_dwordx4 v[6:7], s[4:7], 0 idxen offen lds
    v_mfma_f32_4x4x4_16b_bf16 v[28:31], v[12:13], v[20:21], 0 cbsz:4 abid:12
    v_mfma_f32_4x4x4_16b_bf16 v[32:35], v[12:13], v[22:23], 0 cbsz:4 abid:13
    v_mfma_f32_4x4x4_16b_bf16 v[36:39], v[12:13], v[24:25], 0 cbsz:4 abid:14
    v_mfma_f32_4x4x4_16b_bf16 v[40:43], v[12:13], v[26:27], 0 cbsz:4 abid:15
    ds_read_u16 v4, v2 offset:9672
    ds_read_u16 v6, v2 offset:9704
    v_readlane_b32 s28, v19, 48
    v_readlane_b32 s29, v19, 52
    v_readlane_b32 s30, v19, 56
    v_readlane_b32 s31, v19, 60
    s_waitcnt vmcnt(5)
    ds_read_b64_tr_b16 v[20:21], v1 offset:2048
    ds_read_b64_tr_b16 v[22:23], v1 offset:2560
    s_waitcnt vmcnt(4)
    ds_read_b64_tr_b16 v[24:25], v1 offset:3072
    ds_read_b64_tr_b16 v[26:27], v1 offset:3584
    s_set_gpr_idx_on s28, gpr_idx(DST)
    v_fmac_f32 v88, v28, v56
    v_fmac_f32 v89, v29, v56
    v_fmac_f32 v90, v30, v56
    v_fmac_f32 v91, v31, v56
    s_set_gpr_idx_idx s29
    v_fmac_f32 v88, v32, v57
    v_fmac_f32 v89, v33, v57
    v_fmac_f32 v90, v34, v57
    v_fmac_f32 v91, v35, v57
    s_set_gpr_idx_idx s30
    v_fmac_f32 v88, v36, v58
    v_fmac_f32 v89, v37, v58
    v_fmac_f32 v90, v38, v58
    v_fmac_f32 v91, v39, v58
    s_set_gpr_idx_idx s31
    v_fmac_f32 v88, v40, v59
    v_fmac_f32 v89, v41, v59
    v_fmac_f32 v90, v42, v59
    v_fmac_f32 v91, v43, v59
    s_set_gpr_idx_off
    v_mfma_f32_32x32x16_bf16 v[44:59], v[60:63], v[68:71], 0
    v_mfma_f32_32x32x16_bf16 v[44:59], v[64:67], v[72:75], v[44:59]
    s_sub_u32 s19, s19, 1
    s_cbranch_scc1 mn_exit
    s_mov_b32 m0, s42
    s_waitcnt lgkmcnt(2)
    buffer_load_dwordx4 v[4:5], s[4:7], 0 idxen offen lds
    s_mov_b32 m0, s43
    s_waitcnt lgkmcnt(0)
    buffer_load_dwordx4 v[6:7], s[4:7], 0 idxen offen lds
    v_mfma_f32_4x4x4_16b_bf16 v[28:31], v[14:15], v[20:21], 0 cbsz:4 abid:0
    v_mfma_f32_4x4x4_16b_bf16 v[32:35], v[14:15], v[22:23], 0 cbsz:4 abid:1
    v_mfma_f32_4x4x4_16b_bf16 v[36:39], v[14:15], v[24:25], 0 cbsz:4 abid:2
    v_mfma_f32_4x4x4_16b_bf16 v[40:43], v[14:15], v[26:27], 0 cbsz:4 abid:3
    ds_read_u16 v4, v2 offset:9736
    ds_read_u16 v6, v2 offset:9768
    v_readlane_b32 s28, v19, 1
    v_readlane_b32 s29, v19, 5
    v_readlane_b32 s30, v19, 9
    v_readlane_b32 s31, v19, 13
    s_waitcnt vmcnt(5)
    ds_read_b64_tr_b16 v[20:21], v1 offset:4096
    ds_read_b64_tr_b16 v[22:23], v1 offset:4608
    s_waitcnt vmcnt(4)
    ds_read_b64_tr_b16 v[24:25], v1 offset:5120
    ds_read_b64_tr_b16 v[26:27], v1 offset:5632
    s_set_gpr_idx_on s28, gpr_idx(DST)
    v_fmac_f32 v88, v28, v44
    v_fmac_f32 v89, v29, v44
    v_fmac_f32 v90, v30, v44
    v_fmac_f32 v91, v31, v44
    s_set_gpr_idx_idx s29
    v_fmac_f32 v88, v32, v45
    v_fmac_f32 v89, v33, v45
    v_fmac_f32 v90, v34, v45
    v_fmac_f32 v91, v35, v45
    s_set_gpr_idx_idx s30
    v_fmac_f32 v88, v36, v46
    v_fmac_f32 v89, v37, v46
    v_fmac_f32 v90, v38, v46
    v_fmac_f32 v91, v39, v46
    s_set_gpr_idx_idx s31
    v_fmac_f32 v88, v40, v47
    v_fmac_f32 v89, v41, v47
    v_fmac_f32 v90, v42, v47
    v_fmac_f32 v91, v43, v47
    s_set_gpr_idx_off
    s_sub_u32 s19, s19, 1
    s_cbranch_scc1 mn_exit
    s_mov_b32 m0, s44
    s_waitcnt lgkmcnt(2)
    buffer_load_dwordx4 v[4:5], s[4:7], 0 idxen offen lds
    s_mov_b32 m0, s45
    s_waitcnt lgkmcnt(0)
    buffer_load_dwordx4 v[6:7], s[4:7], 0 idxen offen lds
    v_mfma_f32_4x4x4_16b_bf16 v[28:31], v[14:15], v[20:21], 0 cbsz:4 abid:4
    v_mfma_f32_4x4x4_16b_bf16 v[32:35], v[14:15], v[22:23], 0 cbsz:4 abid:5
    v_mfma_f32_4x4x4_16b_bf16 v[36:39], v[14:15], v[24:25], 0 cbsz:4 abid:6
    v_mfma_f32_4x4x4_16b_bf16 v[40:43], v[14:15], v[26:27], 0 cbsz:4 abid:7
    ds_read_u16 v4, v2 offset:9800
    ds_read_u16 v6, v2 offset:9832
    v_readlane_b32 s28, v19, 17
    v_readlane_b32 s29, v19, 21
    v_readlane_b32 s30, v19, 25
    v_readlane_b32 s31, v19, 29
    s_waitcnt vmcnt(5)
    ds_read_b64_tr_b16 v[20:21], v1 offset:0
    ds_read_b64_tr_b16 v[22:23], v1 offset:512
    s_waitcnt vmcnt(4)
    ds_read_b64_tr_b16 v[24:25], v1 offset:1024
    ds_read_b64_tr_b16 v[26:27], v1 offset:1536
    s_set_gpr_idx_on s28, gpr_idx(DST)
    v_fmac_f32 v88, v28, v48
    v_fmac_f32 v89, v29, v48
    v_fmac_f32 v90, v30, v48
    v_fmac_f32 v91, v31, v48
    s_set_gpr_idx_idx s29
    v_fmac_f32 v88, v32, v49
    v_fmac_f32 v89, v33, v49
    v_fmac_f32 v90, v34, v49
    v_fmac_f32 v91, v35, v49
    s_set_gpr_idx_idx s30
    v_fmac_f32 v88, v36, v50
    v_fmac_f32 v89, v37, v50
    v_fmac_f32 v90, v38, v50
    v_fmac_f32 v91, v39, v50
    s_set_gpr_idx_idx s31
    v_fmac_f32 v88, v40, v51
    v_fmac_f32 v89, v41, v51
    v_fmac_f32 v90, v42, v51
    v_fmac_f32 v91, v43, v51
    s_set_gpr_idx_off
    s_sub_u32 s19, s19, 1
    s_cbranch_scc1 mn_exit
    s_mov_b32 m0, s40
    s_waitcnt lgkmcnt(2)
    buffer_load_dwordx4 v[4:5], s[4:7], 0 idxen offen lds
    s_mov_b32 m0, s41
    s_waitcnt lgkmcnt(0)
    buffer_load_dwordx4 v[6:7], s[4:7], 0 idxen offen lds
    v_mfma_f32_4x4x4_16b_bf16 v[28:31], v[14:15], v[20:21], 0 cbsz:4 abid:8
    v_mfma_f32_4x4x4_16b_bf16 v[32:35], v[14:15], v[22:23], 0 cbsz:4 abid:9
    v_mfma_f32_4x4x4_16b_bf16 v[36:39], v[14:15], v[24:25], 0 cbsz:4 abid:10
    v_mfma_f32_4x4x4_16b_bf16 v[40:43], v[14:15], v[26:27], 0 cbsz:4 abid:11
    ds_read_u16 v4, v2 offset:9864
    ds_read_u16 v6, v2 offset:9896
    v_readlane_b32 s28, v19, 33
    v_readlane_b32 s29, v19, 37
    v_readlane_b32 s30, v19, 41
    v_readlane_b32 s31, v19, 45
    s_mov_b64 exec, s[24:25]
    ds_read_b128 v[60:63], v3 offset:1024
    s_mov_b64 exec, s[26:27]
    ds_read_b128 v[64:67], v3 offset:1024
    s_mov_b64 exec, -1
    s_waitcnt vmcnt(5)
    ds_read_b64_tr_b16 v[20:21], v1 offset:2048
    ds_read_b64_tr_b16 v[22:23], v1 offset:2560
    s_waitcnt vmcnt(4)
    ds_read_b64_tr_b16 v[24:25], v1 offset:3072
    ds_read_b64_tr_b16 v[26:27], v1 offset:3584
    s_set_gpr_idx_on s28, gpr_idx(DST)
    v_fmac_f32 v88, v28, v52
    v_fmac_f32 v89, v29, v52
    v_fmac_f32 v90, v30, v52
    v_fmac_f32 v91, v31, v52
    s_set_gpr_idx_idx s29
    v_fmac_f32 v88, v32, v53
    v_fmac_f32 v89, v33, v53
    v_fmac_f32 v90, v34, v53
    v_fmac_f32 v91, v35, v53
    s_set_gpr_idx_idx s30
    v_fmac_f32 v88, v36, v54
    v_fmac_f32 v89, v37, v54
    v_fmac_f32 v90, v38, v54
    v_fmac_f32 v91, v39, v54
    s_set_gpr_idx_idx s31
    v_fmac_f32 v88, v40, v55
    v_fmac_f32 v89, v41, v55
    v_fmac_f32 v90, v42, v55
    v_fmac_f32 v91, v43, v55
    s_set_gpr_idx_off
    s_sub_u32 s19, s19, 1
    s_cbranch_scc1 mn_exit
    s_mov_b32 m0, s42
    s_waitcnt lgkmcnt(2)
    buffer_load_dwordx4 v[4:5], s[4:7], 0 idxen offen lds
    s_mov_b32 m0, s43
    s_waitcnt lgkmcnt(0)
    buffer_load_dwordx4 v[6:7], s[4:7], 0 idxen offen lds
    v_mfma_f32_4x4x4_16b_bf16 v[28:31], v[14:15], v[20:21], 0 cbsz:4 abid:12
    v_mfma_f32_4x4x4_16b_bf16 v[32:35], v[14:15], v[22:23], 0 cbsz:4 abid:13
    v_mfma_f32_4x4x4_16b_bf16 v[36:39], v[14:15], v[24:25], 0 cbsz:4 abid:14
    v_mfma_f32_4x4x4_16b_bf16 v[40:43], v[14:15], v[26:27], 0 cbsz:4 abid:15
    ds_read_u16 v4, v2 offset:9928
    ds_read_u16 v6, v2 offset:9960
    v_readlane_b32 s28, v19, 49
    v_readlane_b32 s29, v19, 53
    v_readlane_b32 s30, v19, 57
    v_readlane_b32 s31, v19, 61
    s_waitcnt vmcnt(5)
    ds_read_b64_tr_b16 v[20:21], v1 offset:4096
    ds_read_b64_tr_b16 v[22:23], v1 offset:4608
    s_waitcnt vmcnt(4)
    ds_read_b64_tr_b16 v[24:25], v1 offset:5120
    ds_read_b64_tr_b16 v[26:27], v1 offset:5632
    s_set_gpr_idx_on s28, gpr_idx(DST)
    v_fmac_f32 v88, v28, v56
    v_fmac_f32 v89, v29, v56
    v_fmac_f32 v90, v30, v56
    v_fmac_f32 v91, v31, v56
    s_set_gpr_idx_idx s29
    v_fmac_f32 v88, v32, v57
    v_fmac_f32 v89, v33, v57
    v_fmac_f32 v90, v34, v57
    v_fmac_f32 v91, v35, v57
    s_set_gpr_idx_idx s30
    v_fmac_f32 v88, v36, v58
    v_fmac_f32 v89, v37, v58
    v_fmac_f32 v90, v38, v58
    v_fmac_f32 v91, v39, v58
    s_set_gpr_idx_idx s31
    v_fmac_f32 v88, v40, v59
    v_fmac_f32 v89, v41, v59
    v_fmac_f32 v90, v42, v59
    v_fmac_f32 v91, v43, v59
    s_set_gpr_idx_off
    v_mfma_f32_32x32x16_bf16 v[44:59], v[60:63], v[68:71], 0
    v_mfma_f32_32x32x16_bf16 v[44:59], v[64:67], v[72:75], v[44:59]
    s_sub_u32 s19, s19, 1
    s_cbranch_scc1 mn_exit
    s_mov_b32 m0, s44
    s_waitcnt lgkmcnt(2)
    buffer_load_dwordx4 v[4:5], s[4:7], 0 idxen offen lds
    s_mov_b32 m0, s45
    s_waitcnt lgkmcnt(0)
    buffer_load_dwordx4 v[6:7], s[4:7], 0 idxen offen lds
    v_mfma_f32_4x4x4_16b_bf16 v[28:31], v[16:17], v[20:21], 0 cbsz:4 abid:0
    v_mfma_f32_4x4x4_16b_bf16 v[32:35], v[16:17], v[22:23], 0 cbsz:4 abid:1
    v_mfma_f32_4x4x4_16b_bf16 v[36:39], v[16:17], v[24:25], 0 cbsz:4 abid:2
    v_mfma_f32_4x4x4_16b_bf16 v[40:43], v[16:17], v[26:27], 0 cbsz:4 abid:3
    ds_read_u16 v4, v2 offset:9992
    ds_read_u16 v6, v2 offset:10024
    v_readlane_b32 s28, v19, 2
    v_readlane_b32 s29, v19, 6
    v_readlane_b32 s30, v19, 10
    v_readlane_b32 s31, v19, 14
    s_waitcnt vmcnt(5)
    ds_read_b64_tr_b16 v[20:21], v1 offset:0
    ds_read_b64_tr_b16 v[22:23], v1 offset:512
    s_waitcnt vmcnt(4)
    ds_read_b64_tr_b16 v[24:25], v1 offset:1024
    ds_read_b64_tr_b16 v[26:27], v1 offset:1536
    s_set_gpr_idx_on s28, gpr_idx(DST)
    v_fmac_f32 v88, v28, v44
    v_fmac_f32 v89, v29, v44
    v_fmac_f32 v90, v30, v44
    v_fmac_f32 v91, v31, v44
    s_set_gpr_idx_idx s29
    v_fmac_f32 v88, v32, v45
    v_fmac_f32 v89, v33, v45
    v_fmac_f32 v90, v34, v45
    v_fmac_f32 v91, v35, v45
    s_set_gpr_idx_idx s30
    v_fmac_f32 v88, v36, v46
    v_fmac_f32 v89, v37, v46
    v_fmac_f32 v90, v38, v46
    v_fmac_f32 v91, v39, v46
    s_set_gpr_idx_idx s31
    v_fmac_f32 v88, v40, v47
    v_fmac_f32 v89, v41, v47
    v_fmac_f32 v90, v42, v47
    v_fmac_f32 v91, v43, v47
    s_set_gpr_idx_off
    s_sub_u32 s19, s19, 1
    s_cbranch_scc1 mn_exit
    s_mov_b32 m0, s40
    s_waitcnt lgkmcnt(2)
    buffer_load_dwordx4 v[4:5], s[4:7], 0 idxen offen lds
    s_mov_b32 m0, s41
    s_waitcnt lgkmcnt(0)
    buffer_load_dwordx4 v[6:7], s[4:7], 0 idxen offen lds
    v_mfma_f32_4x4x4_16b_bf16 v[28:31], v[16:17], v[20:21], 0 cbsz:4 abid:4
    v_mfma_f32_4x4x4_16b_bf16 v[32:35], v[16:17], v[22:23], 0 cbsz:4 abid:5
    v_mfma_f32_4x4x4_16b_bf16 v[36:39], v[16:17], v[24:25], 0 cbsz:4 abid:6
    v_mfma_f32_4x4x4_16b_bf16 v[40:43], v[16:17], v[26:27], 0 cbsz:4 abid:7
    ds_read_u16 v4, v2 offset:10056
    ds_read_u16 v6, v2 offset:10088
    v_readlane_b32 s28, v19, 18
    v_readlane_b32 s29, v19, 22
    v_readlane_b32 s30, v19, 26
    v_readlane_b32 s31, v19, 30
    ds_read_b128 v[8:11], v18 offset:9984
    s_waitcnt vmcnt(5)
    ds_read_b64_tr_b16 v[20:21], v1 offset:2048
    ds_read_b64_tr_b16 v[22:23], v1 offset:2560
    s_waitcnt vmcnt(4)
    ds_read_b64_tr_b16 v[24:25], v1 offset:3072
    ds_read_b64_tr_b16 v[26:27], v1 offset:3584
    s_set_gpr_idx_on s28, gpr_idx(DST)
    v_fmac_f32 v88, v28, v48
    v_fmac_f32 v89, v29, v48
    v_fmac_f32 v90, v30, v48
    v_fmac_f32 v91, v31, v48
    s_set_gpr_idx_idx s29
    v_fmac_f32 v88, v32, v49
    v_fmac_f32 v89, v33, v49
    v_fmac_f32 v90, v34, v49
    v_fmac_f32 v91, v35, v49
    s_set_gpr_idx_idx s30
    v_fmac_f32 v88, v36, v50
    v_fmac_f32 v89, v37, v50
    v_fmac_f32 v90, v38, v50
    v_fmac_f32 v91, v39, v50
    s_set_gpr_idx_idx s31
    v_fmac_f32 v88, v40, v51
    v_fmac_f32 v89, v41, v51
    v_fmac_f32 v90, v42, v51
    v_fmac_f32 v91, v43, v51
    s_set_gpr_idx_off
    s_sub_u32 s19, s19, 1
    s_cbranch_scc1 mn_exit
    s_mov_b32 m0, s42
    s_waitcnt lgkmcnt(2)
    buffer_load_dwordx4 v[4:5], s[4:7], 0 idxen offen lds
    s_mov_b32 m0, s43
    s_waitcnt lgkmcnt(0)
    buffer_load_dwordx4 v[6:7], s[4:7], 0 idxen offen lds
    v_mfma_f32_4x4x4_16b_bf16 v[28:31], v[16:17], v[20:21], 0 cbsz:4 abid:8
    v_mfma_f32_4x4x4_16b_bf16 v[32:35], v[16:17], v[22:23], 0 cbsz:4 abid:9
    v_mfma_f32_4x4x4_16b_bf16 v[36:39], v[16:17], v[24:25], 0 cbsz:4 abid:10
    v_mfma_f32_4x4x4_16b_bf16 v[40:43], v[16:17], v[26:27], 0 cbsz:4 abid:11
    ds_read_u16 v4, v2 offset:10120
    ds_read_u16 v6, v2 offset:10152
    v_readlane_b32 s28, v19, 34
    v_readlane_b32 s29, v19, 38
    v_readlane_b32 s30, v19, 42
    v_readlane_b32 s31, v19, 46
    s_mov_b64 exec, s[24:25]
    ds_read_b128 v[60:63], v3 offset:1536
    s_mov_b64 exec, s[26:27]
    ds_read_b128 v[64:67], v3 offset:1536
    s_mov_b64 exec, -1
    s_waitcnt vmcnt(5)
    ds_read_b64_tr_b16 v[20:21], v1 offset:4096
    ds_read_b64_tr_b16 v[22:23], v1 offset:4608
    s_waitcnt vmcnt(4)
    ds_read_b64_tr_b16 v[24:25], v1 offset:5120
    ds_read_b64_tr_b16 v[26:27], v1 offset:5632
    s_set_gpr_idx_on s28, gpr_idx(DST)
    v_fmac_f32 v88, v28, v52
    v_fmac_f32 v89, v29, v52
    v_fmac_f32 v90, v30, v52
    v_fmac_f32 v91, v31, v52
    s_set_gpr_idx_idx s29
    v_fmac_f32 v88, v32, v53
    v_fmac_f32 v89, v33, v53
    v_fmac_f32 v90, v34, v53
    v_fmac_f32 v91, v35, v53
    s_set_gpr_idx_idx s30
    v_fmac_f32 v88, v36, v54
    v_fmac_f32 v89, v37, v54
    v_fmac_f32 v90, v38, v54
    v_fmac_f32 v91, v39, v54
    s_set_gpr_idx_idx s31
    v_fmac_f32 v88, v40, v55
    v_fmac_f32 v89, v41, v55
    v_fmac_f32 v90, v42, v55
    v_fmac_f32 v91, v43, v55
    s_set_gpr_idx_off
    s_sub_u32 s19, s19, 1
    s_cbranch_scc1 mn_exit
    s_mov_b32 m0, s44
    s_waitcnt lgkmcnt(2)
    buffer_load_dwordx4 v[4:5], s[4:7], 0 idxen offen lds
    s_mov_b32 m0, s45
    s_waitcnt lgkmcnt(0)
    buffer_load_dwordx4 v[6:7], s[4:7], 0 idxen offen lds
    v_mfma_f32_4x4x4_16b_bf16 v[28:31], v[16:17], v[20:21], 0 cbsz:4 abid:12
    v_mfma_f32_4x4x4_16b_bf16 v[32:35], v[16:17], v[22:23], 0 cbsz:4 abid:13
    v_mfma_f32_4x4x4_16b_bf16 v[36:39], v[16:17], v[24:25], 0 cbsz:4 abid:14
    v_mfma_f32_4x4x4_16b_bf16 v[40:43], v[16:17], v[26:27], 0 cbsz:4 abid:15
    ds_read_u16 v4, v2 offset:10184
    ds_read_u16 v6, v2 offset:10216
    v_readlane_b32 s28, v19, 50
    v_readlane_b32 s29, v19, 54
    v_readlane_b32 s30, v19, 58
    v_readlane_b32 s31, v19, 62
    s_waitcnt vmcnt(5)
    ds_read_b64_tr_b16 v[20:21], v1 offset:0
    ds_read_b64_tr_b16 v[22:23], v1 offset:512
    s_waitcnt vmcnt(4)
    ds_read_b64_tr_b16 v[24:25], v1 offset:1024
    ds_read_b64_tr_b16 v[26:27], v1 offset:1536
    s_set_gpr_idx_on s28, gpr_idx(DST)
    v_fmac_f32 v88, v28, v56
    v_fmac_f32 v89, v29, v56
    v_fmac_f32 v90, v30, v56
    v_fmac_f32 v91, v31, v56
    s_set_gpr_idx_idx s29
    v_fmac_f32 v88, v32, v57
    v_fmac_f32 v89, v33, v57
    v_fmac_f32 v90, v34, v57
    v_fmac_f32 v91, v35, v57
    s_set_gpr_idx_idx s30
    v_fmac_f32 v88, v36, v58
    v_fmac_f32 v89, v37, v58
    v_fmac_f32 v90, v38, v58
    v_fmac_f32 v91, v39, v58
    s_set_gpr_idx_idx s31
    v_fmac_f32 v88, v40, v59
    v_fmac_f32 v89, v41, v59
    v_fmac_f32 v90, v42, v59
    v_fmac_f32 v91, v43, v59
    s_set_gpr_idx_off
    v_mfma_f32_4x4x4_16b_bf16 v[28:31], v[8:9], v[76:77], 0
    v_mfma_f32_4x4x4_16b_bf16 v[32:35], v[8:9], v[78:79], 0
    v_mfma_f32_4x4x4_16b_bf16 v[36:39], v[8:9], v[80:81], 0
    v_mfma_f32_4x4x4_16b_bf16 v[40:43], v[8:9], v[82:83], 0
    v_mfma_f32_32x32x16_bf16 v[44:59], v[60:63], v[68:71], 0
    v_mfma_f32_32x32x16_bf16 v[44:59], v[64:67], v[72:75], v[44:59]
    v_mov_b32 v19, v11
    v_add_u32 v2, 768, v2
    v_add_u32 v3, 1536, v3
    v_add_u32 v18, 768, v18
    s_sub_u32 s19, s19, 1
    s_cbranch_scc1 mn_exit
    s_mov_b32 m0, s40
    s_waitcnt lgkmcnt(2)
    buffer_load_dwordx4 v[4:5], s[4:7], 0 idxen offen lds
    v_cvt_pk_bf16_f32 v12, v28, v32
    v_cvt_pk_bf16_f32 v14, v29, v33
    v_cvt_pk_bf16_f32 v16, v30, v34
    v_cvt_pk_bf16_f32 v13, v36, v40
    v_cvt_pk_bf16_f32 v15, v37, v41
    v_cvt_pk_bf16_f32 v17, v38, v42
    s_mov_b32 m0, s41
    s_waitcnt lgkmcnt(0)
    buffer_load_dwordx4 v[6:7], s[4:7], 0 idxen offen lds
    s_branch mn_loop
mn_exit:
    s_cmp_lg_u32 s21, 0
    s_cbranch_scc1 mn_next
    v_mbcnt_lo_u32_b32 v2, -1, 0
    v_mbcnt_hi_u32_b32 v2, -1, v2
    v_lshl_add_u32 v1, v2, 3, s40
    v_cvt_pk_bf16_f32 v88, v88, v89
    v_cvt_pk_bf16_f32 v89, v90, v91
    v_cvt_pk_bf16_f32 v92, v92, v93
    v_cvt_pk_bf16_f32 v93, v94, v95
    v_cvt_pk_bf16_f32 v96, v96, v97
    v_cvt_pk_bf16_f32 v97, v98, v99
    v_cvt_pk_bf16_f32 v100, v100, v101
    v_cvt_pk_bf16_f32 v101, v102, v103
    s_waitcnt vmcnt(0)
    ds_write_b64 v1, v[88:89] offset:0
    v_cvt_pk_bf16_f32 v104, v104, v105
    v_cvt_pk_bf16_f32 v105, v106, v107
    ds_write_b64 v1, v[92:93] offset:576
    v_cvt_pk_bf16_f32 v108, v108, v109
    v_cvt_pk_bf16_f32 v109, v110, v111
    ds_write_b64 v1, v[96:97] offset:1152
    v_cvt_pk_bf16_f32 v112, v112, v113
    v_cvt_pk_bf16_f32 v113, v114, v115
    ds_write_b64 v1, v[100:101] offset:1728
    v_cvt_pk_bf16_f32 v116, v116, v117
    v_cvt_pk_bf16_f32 v117, v118, v119
    ds_write_b64 v1, v[104:105] offset:2304
    v_cvt_pk_bf16_f32 v120, v120, v121
    v_cvt_pk_bf16_f32 v121, v122, v123
    ds_write_b64 v1, v[108:109] offset:2880
    v_cvt_pk_bf16_f32 v124, v124, v125
    v_cvt_pk_bf16_f32 v125, v126, v127
    ds_write_b64 v1, v[112:113] offset:3456
    v_cvt_pk_bf16_f32 v128, v128, v129
    v_cvt_pk_bf16_f32 v129, v130, v131
    ds_write_b64 v1, v[116:117] offset:4032
    v_cvt_pk_bf16_f32 v132, v132, v133
    v_cvt_pk_bf16_f32 v133, v134, v135
    ds_write_b64 v1, v[120:121] offset:4608
    v_cvt_pk_bf16_f32 v136, v136, v137
    v_cvt_pk_bf16_f32 v137, v138, v139
    ds_write_b64 v1, v[124:125] offset:5184
    v_cvt_pk_bf16_f32 v140, v140, v141
    v_cvt_pk_bf16_f32 v141, v142, v143
    ds_write_b64 v1, v[128:129] offset:5760
    v_cvt_pk_bf16_f32 v144, v144, v145
    v_cvt_pk_bf16_f32 v145, v146, v147
    ds_write_b64 v1, v[132:133] offset:6336
    v_cvt_pk_bf16_f32 v148, v148, v149
    v_cvt_pk_bf16_f32 v149, v150, v151
    ds_write_b64 v1, v[136:137] offset:6912
    v_cvt_pk_bf16_f32 v152, v152, v153
    v_cvt_pk_bf16_f32 v153, v154, v155
    ds_write_b64 v1, v[140:141] offset:7488
    v_cvt_pk_bf16_f32 v156, v156, v157
    v_cvt_pk_bf16_f32 v157, v158, v159
    ds_write_b64 v1, v[144:145] offset:8064
    v_cvt_pk_bf16_f32 v160, v160, v161
    v_cvt_pk_bf16_f32 v161, v162, v163
    ds_write_b64 v1, v[148:149] offset:8640
    v_cvt_pk_bf16_f32 v164, v164, v165
    v_cvt_pk_bf16_f32 v165, v166, v167
    ds_write_b64 v1, v[152:153] offset:9216
    ds_write_b64 v1, v[156:157] offset:9792
    ds_write_b64 v1, v[160:161] offset:10368
    ds_write_b64 v1, v[164:165] offset:10944
    s_lshl_b32 s52, s18, 3
    s_lshl_b32 s52, 1, s52
    v_mov_b32 v2, s52
    v_mov_b32 v3, 0
    s_mov_b64 exec, 1
    ds_add_u32 v3, v2 offset:276
    s_waitcnt lgkmcnt(0)
mn_end:
    s_endpgm
gm_start:
    s_waitcnt vmcnt(0) lgkmcnt(0)
    s_barrier
    s_cmp_lg_u32 s21, 0
    s_cbranch_scc1 mn_next
    v_and_b32 v3, 63, v0
    v_lshlrev_b32 v2, 4, v3
    s_lshl_b32 s52, s17, 15
    s_add_u32 s52, s52, 11534336
    buffer_load_dwordx4 v[40:43], v2, s[8:11], s52 offen offset:0
    s_waitcnt vmcnt(0)
    buffer_load_dwordx4 v[44:47], v2, s[8:11], s52 offen offset:1024
    s_waitcnt vmcnt(0)
    buffer_load_dwordx4 v[48:51], v2, s[8:11], s52 offen offset:2048
    s_waitcnt vmcnt(0)
    buffer_load_dwordx4 v[52:55], v2, s[8:11], s52 offen offset:3072
    s_waitcnt vmcnt(0)
    s_addk_i32 s52, 4096
    buffer_load_dwordx4 v[56:59], v2, s[8:11], s52 offen offset:0
    s_waitcnt vmcnt(0)
    buffer_load_dwordx4 v[60:63], v2, s[8:11], s52 offen offset:1024
    s_waitcnt vmcnt(0)
    buffer_load_dwordx4 v[64:67], v2, s[8:11], s52 offen offset:2048
    s_waitcnt vmcnt(0)
    buffer_load_dwordx4 v[68:71], v2, s[8:11], s52 offen offset:3072
    s_waitcnt vmcnt(0)
    s_addk_i32 s52, 4096
    buffer_load_dwordx4 v[72:75], v2, s[8:11], s52 offen offset:0
    s_waitcnt vmcnt(0)
    buffer_load_dwordx4 v[76:79], v2, s[8:11], s52 offen offset:1024
    s_waitcnt vmcnt(0)
    buffer_load_dwordx4 v[80:83], v2, s[8:11], s52 offen offset:2048
    s_waitcnt vmcnt(0)
    buffer_load_dwordx4 v[84:87], v2, s[8:11], s52 offen offset:3072
    s_waitcnt vmcnt(0)
    s_addk_i32 s52, 4096
    buffer_load_dwordx4 v[88:91], v2, s[8:11], s52 offen offset:0
    s_waitcnt vmcnt(0)
    buffer_load_dwordx4 v[92:95], v2, s[8:11], s52 offen offset:1024
    s_waitcnt vmcnt(0)
    buffer_load_dwordx4 v[96:99], v2, s[8:11], s52 offen offset:2048
    s_waitcnt vmcnt(0)
    buffer_load_dwordx4 v[100:103], v2, s[8:11], s52 offen offset:3072
    s_waitcnt vmcnt(0)
    s_addk_i32 s52, 4096
    buffer_load_dwordx4 v[104:107], v2, s[8:11], s52 offen offset:0
    s_waitcnt vmcnt(0)
    buffer_load_dwordx4 v[108:111], v2, s[8:11], s52 offen offset:1024
    s_waitcnt vmcnt(0)
    buffer_load_dwordx4 v[112:115], v2, s[8:11], s52 offen offset:2048
    s_waitcnt vmcnt(0)
    buffer_load_dwordx4 v[116:119], v2, s[8:11], s52 offen offset:3072
    s_waitcnt vmcnt(0)
    s_addk_i32 s52, 4096
    buffer_load_dwordx4 v[120:123], v2, s[8:11], s52 offen offset:0
    s_waitcnt vmcnt(0)
    buffer_load_dwordx4 v[124:127], v2, s[8:11], s52 offen offset:1024
    s_waitcnt vmcnt(0)
    buffer_load_dwordx4 v[128:131], v2, s[8:11], s52 offen offset:2048
    s_waitcnt vmcnt(0)
    buffer_load_dwordx4 v[132:135], v2, s[8:11], s52 offen offset:3072
    s_waitcnt vmcnt(0)
    s_addk_i32 s52, 4096
    buffer_load_dwordx4 v[136:139], v2, s[8:11], s52 offen offset:0
    s_waitcnt vmcnt(0)
    buffer_load_dwordx4 v[140:143], v2, s[8:11], s52 offen offset:1024
    s_waitcnt vmcnt(0)
    buffer_load_dwordx4 v[144:147], v2, s[8:11], s52 offen offset:2048
    s_waitcnt vmcnt(0)
    buffer_load_dwordx4 v[148:151], v2, s[8:11], s52 offen offset:3072
    s_waitcnt vmcnt(0)
    s_addk_i32 s52, 4096
    buffer_load_dwordx4 v[152:155], v2, s[8:11], s52 offen offset:0
    s_waitcnt vmcnt(0)
    buffer_load_dwordx4 v[156:159], v2, s[8:11], s52 offen offset:1024
    s_waitcnt vmcnt(0)
    buffer_load_dwordx4 v[160:163], v2, s[8:11], s52 offen offset:2048
    s_waitcnt vmcnt(0)
    buffer_load_dwordx4 v[164:167], v2, s[8:11], s52 offen offset:3072
    s_waitcnt vmcnt(0)
    v_lshrrev_b32 v1, 4, v3
    v_lshlrev_b32 v1, 12, v1
    v_and_b32 v4, 7, v3
    v_lshl_add_u32 v1, v4, 4, v1
    v_bfe_u32 v4, v3, 3, 1
    v_lshl_add_u32 v1, v4, 9, v1
    v_and_b32 v4, 3, v3
    v_lshrrev_b32 v5, 2, v3
    v_mul_u32_u24 v0, 576, v4
    v_lshl_add_u32 v0, v5, 3, v0
    v_add_u32 v0, 71680, v0
    s_lshl_b32 s38, s22, 11
    s_lshl_b32 s53, s17, 7
    s_add_u32 s38, s38, s53
    s_movk_i32 s36, 0x0404
    s_mov_b32 s39, 0
    s_waitcnt vmcnt(0)
gm_poll:
    v_mov_b32 v2, 0
    ds_read_b32 v2, v2 offset:276
    s_waitcnt lgkmcnt(0)
    v_readfirstlane_b32 s52, v2
    s_and_b32 s52, s52, s36
    s_cbranch_scc1 gm_go
    s_sleep 2
    s_branch gm_poll
gm_go:
    s_ff1_i32_b32 s52, s52
    s_bitset0_b32 s36, s52
    s_lshr_b32 s52, s52, 3
    s_lshl_b32 s37, s52, 11
    s_add_u32 s37, s37, s38
    s_mul_i32 s52, s52, 46080
    s_sub_u32 s53, s52, s39
    s_mov_b32 s39, s52
    v_add_u32 v0, s53, v0
gm_job:
    ds_read_b64_tr_b16 v[12:13], v0 offset:0
    ds_read_b64_tr_b16 v[14:15], v0 offset:128
    ds_read_b64_tr_b16 v[16:17], v0 offset:256
    ds_read_b64_tr_b16 v[18:19], v0 offset:384
    s_waitcnt lgkmcnt(2)
    v_mfma_f32_16x16x32_bf16 v[24:27], v[12:15], v[40:43], 0
    ds_read_b64_tr_b16 v[20:21], v0 offset:11520
    v_mfma_f32_16x16x32_bf16 v[28:31], v[12:15], v[44:47], 0
    ds_read_b64_tr_b16 v[22:23], v0 offset:11648
    v_mfma_f32_16x16x32_bf16 v[32:35], v[12:15], v[48:51], 0
    v_mfma_f32_16x16x32_bf16 v[36:39], v[12:15], v[52:55], 0
    s_waitcnt lgkmcnt(2)
    v_mfma_f32_16x16x32_bf16 v[24:27], v[16:19], v[56:59], v[24:27]
    ds_read_b64_tr_b16 v[12:13], v0 offset:11776
    v_mfma_f32_16x16x32_bf16 v[28:31], v[16:19], v[60:63], v[28:31]
    ds_read_b64_tr_b16 v[14:15], v0 offset:11904
    v_mfma_f32_16x16x32_bf16 v[32:35], v[16:19], v[64:67], v[32:35]
    v_mfma_f32_16x16x32_bf16 v[36:39], v[16:19], v[68:71], v[36:39]
    s_waitcnt lgkmcnt(2)
    v_mfma_f32_16x16x32_bf16 v[24:27], v[20:23], v[72:75], v[24:27]
    ds_read_b64_tr_b16 v[16:17], v0 offset:23040
    v_mfma_f32_16x16x32_bf16 v[28:31], v[20:23], v[76:79], v[28:31]
    ds_read_b64_tr_b16 v[18:19], v0 offset:23168
    v_mfma_f32_16x16x32_bf16 v[32:35], v[20:23], v[80:83], v[32:35]
    v_mfma_f32_16x16x32_bf16 v[36:39], v[20:23], v[84:87], v[36:39]
    s_waitcnt lgkmcnt(2)
    v_mfma_f32_16x16x32_bf16 v[24:27], v[12:15], v[88:91], v[24:27]
    ds_read_b64_tr_b16 v[20:21], v0 offset:23296
    v_mfma_f32_16x16x32_bf16 v[28:31], v[12:15], v[92:95], v[28:31]
    ds_read_b64_tr_b16 v[22:23], v0 offset:23424
    v_mfma_f32_16x16x32_bf16 v[32:35], v[12:15], v[96:99], v[32:35]
    v_mfma_f32_16x16x32_bf16 v[36:39], v[12:15], v[100:103], v[36:39]
    s_waitcnt lgkmcnt(2)
    v_mfma_f32_16x16x32_bf16 v[24:27], v[16:19], v[104:107], v[24:27]
    ds_read_b64_tr_b16 v[12:13], v0 offset:34560
    v_mfma_f32_16x16x32_bf16 v[28:31], v[16:19], v[108:111], v[28:31]
    ds_read_b64_tr_b16 v[14:15], v0 offset:34688
    v_mfma_f32_16x16x32_bf16 v[32:35], v[16:19], v[112:115], v[32:35]
    v_mfma_f32_16x16x32_bf16 v[36:39], v[16:19], v[116:119], v[36:39]
    s_waitcnt lgkmcnt(2)
    v_mfma_f32_16x16x32_bf16 v[24:27], v[20:23], v[120:123], v[24:27]
    ds_read_b64_tr_b16 v[16:17], v0 offset:34816
    v_mfma_f32_16x16x32_bf16 v[28:31], v[20:23], v[124:127], v[28:31]
    ds_read_b64_tr_b16 v[18:19], v0 offset:34944
    v_mfma_f32_16x16x32_bf16 v[32:35], v[20:23], v[128:131], v[32:35]
    v_mfma_f32_16x16x32_bf16 v[36:39], v[20:23], v[132:135], v[36:39]
    s_waitcnt lgkmcnt(2)
    v_mfma_f32_16x16x32_bf16 v[24:27], v[12:15], v[136:139], v[24:27]
    ds_read_b64_tr_b16 v[20:21], v0 offset:2304
    v_mfma_f32_16x16x32_bf16 v[28:31], v[12:15], v[140:143], v[28:31]
    ds_read_b64_tr_b16 v[22:23], v0 offset:2432
    v_mfma_f32_16x16x32_bf16 v[32:35], v[12:15], v[144:147], v[32:35]
    v_mfma_f32_16x16x32_bf16 v[36:39], v[12:15], v[148:151], v[36:39]
    s_waitcnt lgkmcnt(2)
    v_mfma_f32_16x16x32_bf16 v[24:27], v[16:19], v[152:155], v[24:27]
    v_mfma_f32_16x16x32_bf16 v[28:31], v[16:19], v[156:159], v[28:31]
    v_mfma_f32_16x16x32_bf16 v[32:35], v[16:19], v[160:163], v[32:35]
    ds_read_b64_tr_b16 v[12:13], v0 offset:2560
    v_mfma_f32_16x16x32_bf16 v[36:39], v[16:19], v[164:167], v[36:39]
    ds_read_b64_tr_b16 v[14:15], v0 offset:2688
    s_nop 3
    v_cvt_pk_bf16_f32 v4, v24, v28
    v_cvt_pk_bf16_f32 v6, v25, v29
    v_cvt_pk_bf16_f32 v8, v26, v30
    v_cvt_pk_bf16_f32 v10, v27, v31
    s_waitcnt lgkmcnt(2)
    v_mfma_f32_16x16x32_bf16 v[24:27], v[20:23], v[40:43], 0
    v_cvt_pk_bf16_f32 v7, v33, v37
    v_cvt_pk_bf16_f32 v5, v32, v36
    v_mfma_f32_16x16x32_bf16 v[28:31], v[20:23], v[44:47], 0
    v_cvt_pk_bf16_f32 v11, v35, v39
    v_cvt_pk_bf16_f32 v9, v34, v38
    v_mfma_f32_16x16x32_bf16 v[32:35], v[20:23], v[48:51], 0
    ds_read_b64_tr_b16 v[16:17], v0 offset:13824
    v_mfma_f32_16x16x32_bf16 v[36:39], v[20:23], v[52:55], 0
    ds_read_b64_tr_b16 v[18:19], v0 offset:13952
    s_waitcnt lgkmcnt(2)
    v_mfma_f32_16x16x32_bf16 v[24:27], v[12:15], v[56:59], v[24:27]
    ds_read_b64_tr_b16 v[20:21], v0 offset:14080
    v_mfma_f32_16x16x32_bf16 v[28:31], v[12:15], v[60:63], v[28:31]
    ds_read_b64_tr_b16 v[22:23], v0 offset:14208
    v_mov_b32_dpp v2, v6 row_ror:8 row_mask:0xf bank_mask:0xf
    v_mfma_f32_16x16x32_bf16 v[32:35], v[12:15], v[64:67], v[32:35]
    v_mov_b32_dpp v3, v7 row_ror:8 row_mask:0xf bank_mask:0xf
    v_mfma_f32_16x16x32_bf16 v[36:39], v[12:15], v[68:71], v[36:39]
    v_mov_b32_dpp v6, v4 row_ror:8 row_mask:0xf bank_mask:0x3
    s_waitcnt lgkmcnt(2)
    v_mfma_f32_16x16x32_bf16 v[24:27], v[16:19], v[72:75], v[24:27]
    ds_read_b64_tr_b16 v[12:13], v0 offset:25344
    v_mfma_f32_16x16x32_bf16 v[28:31], v[16:19], v[76:79], v[28:31]
    ds_read_b64_tr_b16 v[14:15], v0 offset:25472
    v_mov_b32_dpp v7, v5 row_ror:8 row_mask:0xf bank_mask:0x3
    v_mfma_f32_16x16x32_bf16 v[32:35], v[16:19], v[80:83], v[32:35]
    v_mov_b32_dpp v4, v2 quad_perm:[0,1,2,3] row_mask:0xf bank_mask:0xc
    v_mfma_f32_16x16x32_bf16 v[36:39], v[16:19], v[84:87], v[36:39]
    v_mov_b32_dpp v5, v3 quad_perm:[0,1,2,3] row_mask:0xf bank_mask:0xc
    s_waitcnt lgkmcnt(2)
    v_mfma_f32_16x16x32_bf16 v[24:27], v[20:23], v[88:91], v[24:27]
    ds_read_b64_tr_b16 v[16:17], v0 offset:25600
    v_mfma_f32_16x16x32_bf16 v[28:31], v[20:23], v[92:95], v[28:31]
    ds_read_b64_tr_b16 v[18:19], v0 offset:25728
    buffer_store_dwordx4 v[4:7], v1, s[12:15], s37 offen offset:0 sc0 sc1
    v_mfma_f32_16x16x32_bf16 v[32:35], v[20:23], v[96:99], v[32:35]
    v_mov_b32_dpp v2, v10 row_ror:8 row_mask:0xf bank_mask:0xf
    v_mfma_f32_16x16x32_bf16 v[36:39], v[20:23], v[100:103], v[36:39]
    v_mov_b32_dpp v3, v11 row_ror:8 row_mask:0xf bank_mask:0xf
    s_waitcnt lgkmcnt(2)
    v_mfma_f32_16x16x32_bf16 v[24:27], v[12:15], v[104:107], v[24:27]
    ds_read_b64_tr_b16 v[20:21], v0 offset:36864
    v_mfma_f32_16x16x32_bf16 v[28:31], v[12:15], v[108:111], v[28:31]
    ds_read_b64_tr_b16 v[22:23], v0 offset:36992
    v_mov_b32_dpp v10, v8 row_ror:8 row_mask:0xf bank_mask:0x3
    v_mfma_f32_16x16x32_bf16 v[32:35], v[12:15], v[112:115], v[32:35]
    v_mov_b32_dpp v11, v9 row_ror:8 row_mask:0xf bank_mask:0x3
    v_mfma_f32_16x16x32_bf16 v[36:39], v[12:15], v[116:119], v[36:39]
    v_mov_b32_dpp v8, v2 quad_perm:[0,1,2,3] row_mask:0xf bank_mask:0xc
    s_waitcnt lgkmcnt(2)
    v_mfma_f32_16x16x32_bf16 v[24:27], v[16:19], v[120:123], v[24:27]
    ds_read_b64_tr_b16 v[12:13], v0 offset:37120
    v_mfma_f32_16x16x32_bf16 v[28:31], v[16:19], v[124:127], v[28:31]
    ds_read_b64_tr_b16 v[14:15], v0 offset:37248
    v_mov_b32_dpp v9, v3 quad_perm:[0,1,2,3] row_mask:0xf bank_mask:0xc
    v_mfma_f32_16x16x32_bf16 v[32:35], v[16:19], v[128:131], v[32:35]
    buffer_store_dwordx4 v[8:11], v1, s[12:15], s37 offen offset:1024 sc0 sc1
    v_mfma_f32_16x16x32_bf16 v[36:39], v[16:19], v[132:135], v[36:39]
    s_add_u32 s37, s37, 16384
    s_waitcnt lgkmcnt(2)
    v_mfma_f32_16x16x32_bf16 v[24:27], v[20:23], v[136:139], v[24:27]
    ds_read_b64_tr_b16 v[16:17], v0 offset:4608
    v_mfma_f32_16x16x32_bf16 v[28:31], v[20:23], v[140:143], v[28:31]
    ds_read_b64_tr_b16 v[18:19], v0 offset:4736
    v_mfma_f32_16x16x32_bf16 v[32:35], v[20:23], v[144:147], v[32:35]
    v_mfma_f32_16x16x32_bf16 v[36:39], v[20:23], v[148:151], v[36:39]
    s_waitcnt lgkmcnt(2)
    v_mfma_f32_16x16x32_bf16 v[24:27], v[12:15], v[152:155], v[24:27]
    v_mfma_f32_16x16x32_bf16 v[28:31], v[12:15], v[156:159], v[28:31]
    v_mfma_f32_16x16x32_bf16 v[32:35], v[12:15], v[160:163], v[32:35]
    ds_read_b64_tr_b16 v[20:21], v0 offset:4864
    v_mfma_f32_16x16x32_bf16 v[36:39], v[12:15], v[164:167], v[36:39]
    ds_read_b64_tr_b16 v[22:23], v0 offset:4992
    s_nop 3
    v_cvt_pk_bf16_f32 v4, v24, v28
    v_cvt_pk_bf16_f32 v6, v25, v29
    v_cvt_pk_bf16_f32 v8, v26, v30
    v_cvt_pk_bf16_f32 v10, v27, v31
    s_waitcnt lgkmcnt(2)
    v_mfma_f32_16x16x32_bf16 v[24:27], v[16:19], v[40:43], 0
    v_cvt_pk_bf16_f32 v7, v33, v37
    v_cvt_pk_bf16_f32 v5, v32, v36
    v_mfma_f32_16x16x32_bf16 v[28:31], v[16:19], v[44:47], 0
    v_cvt_pk_bf16_f32 v11, v35, v39
    v_cvt_pk_bf16_f32 v9, v34, v38
    v_mfma_f32_16x16x32_bf16 v[32:35], v[16:19], v[48:51], 0
    ds_read_b64_tr_b16 v[12:13], v0 offset:16128
    v_mfma_f32_16x16x32_bf16 v[36:39], v[16:19], v[52:55], 0
    ds_read_b64_tr_b16 v[14:15], v0 offset:16256
    s_waitcnt lgkmcnt(2)
    v_mfma_f32_16x16x32_bf16 v[24:27], v[20:23], v[56:59], v[24:27]
    ds_read_b64_tr_b16 v[16:17], v0 offset:16384
    v_mfma_f32_16x16x32_bf16 v[28:31], v[20:23], v[60:63], v[28:31]
    ds_read_b64_tr_b16 v[18:19], v0 offset:16512
    v_mov_b32_dpp v2, v6 row_ror:8 row_mask:0xf bank_mask:0xf
    v_mfma_f32_16x16x32_bf16 v[32:35], v[20:23], v[64:67], v[32:35]
    v_mov_b32_dpp v3, v7 row_ror:8 row_mask:0xf bank_mask:0xf
    v_mfma_f32_16x16x32_bf16 v[36:39], v[20:23], v[68:71], v[36:39]
    v_mov_b32_dpp v6, v4 row_ror:8 row_mask:0xf bank_mask:0x3
    s_waitcnt lgkmcnt(2)
    v_mfma_f32_16x16x32_bf16 v[24:27], v[12:15], v[72:75], v[24:27]
    ds_read_b64_tr_b16 v[20:21], v0 offset:27648
    v_mfma_f32_16x16x32_bf16 v[28:31], v[12:15], v[76:79], v[28:31]
    ds_read_b64_tr_b16 v[22:23], v0 offset:27776
    v_mov_b32_dpp v7, v5 row_ror:8 row_mask:0xf bank_mask:0x3
    v_mfma_f32_16x16x32_bf16 v[32:35], v[12:15], v[80:83], v[32:35]
    v_mov_b32_dpp v4, v2 quad_perm:[0,1,2,3] row_mask:0xf bank_mask:0xc
    v_mfma_f32_16x16x32_bf16 v[36:39], v[12:15], v[84:87], v[36:39]
    v_mov_b32_dpp v5, v3 quad_perm:[0,1,2,3] row_mask:0xf bank_mask:0xc
    s_waitcnt lgkmcnt(2)
    v_mfma_f32_16x16x32_bf16 v[24:27], v[16:19], v[88:91], v[24:27]
    ds_read_b64_tr_b16 v[12:13], v0 offset:27904
    v_mfma_f32_16x16x32_bf16 v[28:31], v[16:19], v[92:95], v[28:31]
    ds_read_b64_tr_b16 v[14:15], v0 offset:28032
    buffer_store_dwordx4 v[4:7], v1, s[12:15], s37 offen offset:0 sc0 sc1
    v_mfma_f32_16x16x32_bf16 v[32:35], v[16:19], v[96:99], v[32:35]
    v_mov_b32_dpp v2, v10 row_ror:8 row_mask:0xf bank_mask:0xf
    v_mfma_f32_16x16x32_bf16 v[36:39], v[16:19], v[100:103], v[36:39]
    v_mov_b32_dpp v3, v11 row_ror:8 row_mask:0xf bank_mask:0xf
    s_waitcnt lgkmcnt(2)
    v_mfma_f32_16x16x32_bf16 v[24:27], v[20:23], v[104:107], v[24:27]
    ds_read_b64_tr_b16 v[16:17], v0 offset:39168
    v_mfma_f32_16x16x32_bf16 v[28:31], v[20:23], v[108:111], v[28:31]
    ds_read_b64_tr_b16 v[18:19], v0 offset:39296
    v_mov_b32_dpp v10, v8 row_ror:8 row_mask:0xf bank_mask:0x3
    v_mfma_f32_16x16x32_bf16 v[32:35], v[20:23], v[112:115], v[32:35]
    v_mov_b32_dpp v11, v9 row_ror:8 row_mask:0xf bank_mask:0x3
    v_mfma_f32_16x16x32_bf16 v[36:39], v[20:23], v[116:119], v[36:39]
    v_mov_b32_dpp v8, v2 quad_perm:[0,1,2,3] row_mask:0xf bank_mask:0xc
    s_waitcnt lgkmcnt(2)
    v_mfma_f32_16x16x32_bf16 v[24:27], v[12:15], v[120:123], v[24:27]
    ds_read_b64_tr_b16 v[20:21], v0 offset:39424
    v_mfma_f32_16x16x32_bf16 v[28:31], v[12:15], v[124:127], v[28:31]
    ds_read_b64_tr_b16 v[22:23], v0 offset:39552
    v_mov_b32_dpp v9, v3 quad_perm:[0,1,2,3] row_mask:0xf bank_mask:0xc
    v_mfma_f32_16x16x32_bf16 v[32:35], v[12:15], v[128:131], v[32:35]
    buffer_store_dwordx4 v[8:11], v1, s[12:15], s37 offen offset:1024 sc0 sc1
    v_mfma_f32_16x16x32_bf16 v[36:39], v[12:15], v[132:135], v[36:39]
    s_add_u32 s37, s37, 16384
    s_waitcnt lgkmcnt(2)
    v_mfma_f32_16x16x32_bf16 v[24:27], v[16:19], v[136:139], v[24:27]
    ds_read_b64_tr_b16 v[12:13], v0 offset:6912
    v_mfma_f32_16x16x32_bf16 v[28:31], v[16:19], v[140:143], v[28:31]
    ds_read_b64_tr_b16 v[14:15], v0 offset:7040
    v_mfma_f32_16x16x32_bf16 v[32:35], v[16:19], v[144:147], v[32:35]
    v_mfma_f32_16x16x32_bf16 v[36:39], v[16:19], v[148:151], v[36:39]
    s_waitcnt lgkmcnt(2)
    v_mfma_f32_16x16x32_bf16 v[24:27], v[20:23], v[152:155], v[24:27]
    v_mfma_f32_16x16x32_bf16 v[28:31], v[20:23], v[156:159], v[28:31]
    v_mfma_f32_16x16x32_bf16 v[32:35], v[20:23], v[160:163], v[32:35]
    ds_read_b64_tr_b16 v[16:17], v0 offset:7168
    v_mfma_f32_16x16x32_bf16 v[36:39], v[20:23], v[164:167], v[36:39]
    ds_read_b64_tr_b16 v[18:19], v0 offset:7296
    s_nop 3
    v_cvt_pk_bf16_f32 v4, v24, v28
    v_cvt_pk_bf16_f32 v6, v25, v29
    v_cvt_pk_bf16_f32 v8, v26, v30
    v_cvt_pk_bf16_f32 v10, v27, v31
    s_waitcnt lgkmcnt(2)
    v_mfma_f32_16x16x32_bf16 v[24:27], v[12:15], v[40:43], 0
    v_cvt_pk_bf16_f32 v7, v33, v37
    v_cvt_pk_bf16_f32 v5, v32, v36
    v_mfma_f32_16x16x32_bf16 v[28:31], v[12:15], v[44:47], 0
    v_cvt_pk_bf16_f32 v11, v35, v39
    v_cvt_pk_bf16_f32 v9, v34, v38
    v_mfma_f32_16x16x32_bf16 v[32:35], v[12:15], v[48:51], 0
    ds_read_b64_tr_b16 v[20:21], v0 offset:18432
    v_mfma_f32_16x16x32_bf16 v[36:39], v[12:15], v[52:55], 0
    ds_read_b64_tr_b16 v[22:23], v0 offset:18560
    s_waitcnt lgkmcnt(2)
    v_mfma_f32_16x16x32_bf16 v[24:27], v[16:19], v[56:59], v[24:27]
    ds_read_b64_tr_b16 v[12:13], v0 offset:18688
    v_mfma_f32_16x16x32_bf16 v[28:31], v[16:19], v[60:63], v[28:31]
    ds_read_b64_tr_b16 v[14:15], v0 offset:18816
    v_mov_b32_dpp v2, v6 row_ror:8 row_mask:0xf bank_mask:0xf
    v_mfma_f32_16x16x32_bf16 v[32:35], v[16:19], v[64:67], v[32:35]
    v_mov_b32_dpp v3, v7 row_ror:8 row_mask:0xf bank_mask:0xf
    v_mfma_f32_16x16x32_bf16 v[36:39], v[16:19], v[68:71], v[36:39]
    v_mov_b32_dpp v6, v4 row_ror:8 row_mask:0xf bank_mask:0x3
    s_waitcnt lgkmcnt(2)
    v_mfma_f32_16x16x32_bf16 v[24:27], v[20:23], v[72:75], v[24:27]
    ds_read_b64_tr_b16 v[16:17], v0 offset:29952
    v_mfma_f32_16x16x32_bf16 v[28:31], v[20:23], v[76:79], v[28:31]
    ds_read_b64_tr_b16 v[18:19], v0 offset:30080
    v_mov_b32_dpp v7, v5 row_ror:8 row_mask:0xf bank_mask:0x3
    v_mfma_f32_16x16x32_bf16 v[32:35], v[20:23], v[80:83], v[32:35]
    v_mov_b32_dpp v4, v2 quad_perm:[0,1,2,3] row_mask:0xf bank_mask:0xc
    v_mfma_f32_16x16x32_bf16 v[36:39], v[20:23], v[84:87], v[36:39]
    v_mov_b32_dpp v5, v3 quad_perm:[0,1,2,3] row_mask:0xf bank_mask:0xc
    s_waitcnt lgkmcnt(2)
    v_mfma_f32_16x16x32_bf16 v[24:27], v[12:15], v[88:91], v[24:27]
    ds_read_b64_tr_b16 v[20:21], v0 offset:30208
    v_mfma_f32_16x16x32_bf16 v[28:31], v[12:15], v[92:95], v[28:31]
    ds_read_b64_tr_b16 v[22:23], v0 offset:30336
    buffer_store_dwordx4 v[4:7], v1, s[12:15], s37 offen offset:0 sc0 sc1
    v_mfma_f32_16x16x32_bf16 v[32:35], v[12:15], v[96:99], v[32:35]
    v_mov_b32_dpp v2, v10 row_ror:8 row_mask:0xf bank_mask:0xf
    v_mfma_f32_16x16x32_bf16 v[36:39], v[12:15], v[100:103], v[36:39]
    v_mov_b32_dpp v3, v11 row_ror:8 row_mask:0xf bank_mask:0xf
    s_waitcnt lgkmcnt(2)
    v_mfma_f32_16x16x32_bf16 v[24:27], v[16:19], v[104:107], v[24:27]
    ds_read_b64_tr_b16 v[12:13], v0 offset:41472
    v_mfma_f32_16x16x32_bf16 v[28:31], v[16:19], v[108:111], v[28:31]
    ds_read_b64_tr_b16 v[14:15], v0 offset:41600
    v_mov_b32_dpp v10, v8 row_ror:8 row_mask:0xf bank_mask:0x3
    v_mfma_f32_16x16x32_bf16 v[32:35], v[16:19], v[112:115], v[32:35]
    v_mov_b32_dpp v11, v9 row_ror:8 row_mask:0xf bank_mask:0x3
    v_mfma_f32_16x16x32_bf16 v[36:39], v[16:19], v[116:119], v[36:39]
    v_mov_b32_dpp v8, v2 quad_perm:[0,1,2,3] row_mask:0xf bank_mask:0xc
    s_waitcnt lgkmcnt(2)
    v_mfma_f32_16x16x32_bf16 v[24:27], v[20:23], v[120:123], v[24:27]
    ds_read_b64_tr_b16 v[16:17], v0 offset:41728
    v_mfma_f32_16x16x32_bf16 v[28:31], v[20:23], v[124:127], v[28:31]
    ds_read_b64_tr_b16 v[18:19], v0 offset:41856
    v_mov_b32_dpp v9, v3 quad_perm:[0,1,2,3] row_mask:0xf bank_mask:0xc
    v_mfma_f32_16x16x32_bf16 v[32:35], v[20:23], v[128:131], v[32:35]
    buffer_store_dwordx4 v[8:11], v1, s[12:15], s37 offen offset:1024 sc0 sc1
    v_mfma_f32_16x16x32_bf16 v[36:39], v[20:23], v[132:135], v[36:39]
    s_add_u32 s37, s37, 16384
    s_waitcnt lgkmcnt(2)
    v_mfma_f32_16x16x32_bf16 v[24:27], v[12:15], v[136:139], v[24:27]
    ds_read_b64_tr_b16 v[20:21], v0 offset:9216
    v_mfma_f32_16x16x32_bf16 v[28:31], v[12:15], v[140:143], v[28:31]
    ds_read_b64_tr_b16 v[22:23], v0 offset:9344
    v_mfma_f32_16x16x32_bf16 v[32:35], v[12:15], v[144:147], v[32:35]
    v_mfma_f32_16x16x32_bf16 v[36:39], v[12:15], v[148:151], v[36:39]
    s_waitcnt lgkmcnt(2)
    v_mfma_f32_16x16x32_bf16 v[24:27], v[16:19], v[152:155], v[24:27]
    v_mfma_f32_16x16x32_bf16 v[28:31], v[16:19], v[156:159], v[28:31]
    v_mfma_f32_16x16x32_bf16 v[32:35], v[16:19], v[160:163], v[32:35]
    ds_read_b64_tr_b16 v[12:13], v0 offset:9472
    v_mfma_f32_16x16x32_bf16 v[36:39], v[16:19], v[164:167], v[36:39]
    ds_read_b64_tr_b16 v[14:15], v0 offset:9600
    s_nop 3
    v_cvt_pk_bf16_f32 v4, v24, v28
    v_cvt_pk_bf16_f32 v6, v25, v29
    v_cvt_pk_bf16_f32 v8, v26, v30
    v_cvt_pk_bf16_f32 v10, v27, v31
    s_waitcnt lgkmcnt(2)
    v_mfma_f32_16x16x32_bf16 v[24:27], v[20:23], v[40:43], 0
    v_cvt_pk_bf16_f32 v7, v33, v37
    v_cvt_pk_bf16_f32 v5, v32, v36
    v_mfma_f32_16x16x32_bf16 v[28:31], v[20:23], v[44:47], 0
    v_cvt_pk_bf16_f32 v11, v35, v39
    v_cvt_pk_bf16_f32 v9, v34, v38
    v_mfma_f32_16x16x32_bf16 v[32:35], v[20:23], v[48:51], 0
    ds_read_b64_tr_b16 v[16:17], v0 offset:20736
    v_mfma_f32_16x16x32_bf16 v[36:39], v[20:23], v[52:55], 0
    ds_read_b64_tr_b16 v[18:19], v0 offset:20864
    s_waitcnt lgkmcnt(2)
    v_mfma_f32_16x16x32_bf16 v[24:27], v[12:15], v[56:59], v[24:27]
    ds_read_b64_tr_b16 v[20:21], v0 offset:20992
    v_mfma_f32_16x16x32_bf16 v[28:31], v[12:15], v[60:63], v[28:31]
    ds_read_b64_tr_b16 v[22:23], v0 offset:21120
    v_mov_b32_dpp v2, v6 row_ror:8 row_mask:0xf bank_mask:0xf
    v_mfma_f32_16x16x32_bf16 v[32:35], v[12:15], v[64:67], v[32:35]
    v_mov_b32_dpp v3, v7 row_ror:8 row_mask:0xf bank_mask:0xf
    v_mfma_f32_16x16x32_bf16 v[36:39], v[12:15], v[68:71], v[36:39]
    v_mov_b32_dpp v6, v4 row_ror:8 row_mask:0xf bank_mask:0x3
    s_waitcnt lgkmcnt(2)
    v_mfma_f32_16x16x32_bf16 v[24:27], v[16:19], v[72:75], v[24:27]
    ds_read_b64_tr_b16 v[12:13], v0 offset:32256
    v_mfma_f32_16x16x32_bf16 v[28:31], v[16:19], v[76:79], v[28:31]
    ds_read_b64_tr_b16 v[14:15], v0 offset:32384
    v_mov_b32_dpp v7, v5 row_ror:8 row_mask:0xf bank_mask:0x3
    v_mfma_f32_16x16x32_bf16 v[32:35], v[16:19], v[80:83], v[32:35]
    v_mov_b32_dpp v4, v2 quad_perm:[0,1,2,3] row_mask:0xf bank_mask:0xc
    v_mfma_f32_16x16x32_bf16 v[36:39], v[16:19], v[84:87], v[36:39]
    v_mov_b32_dpp v5, v3 quad_perm:[0,1,2,3] row_mask:0xf bank_mask:0xc
    s_waitcnt lgkmcnt(2)
    v_mfma_f32_16x16x32_bf16 v[24:27], v[20:23], v[88:91], v[24:27]
    ds_read_b64_tr_b16 v[16:17], v0 offset:32512
    v_mfma_f32_16x16x32_bf16 v[28:31], v[20:23], v[92:95], v[28:31]
    ds_read_b64_tr_b16 v[18:19], v0 offset:32640
    buffer_store_dwordx4 v[4:7], v1, s[12:15], s37 offen offset:0 sc0 sc1
    v_mfma_f32_16x16x32_bf16 v[32:35], v[20:23], v[96:99], v[32:35]
    v_mov_b32_dpp v2, v10 row_ror:8 row_mask:0xf bank_mask:0xf
    v_mfma_f32_16x16x32_bf16 v[36:39], v[20:23], v[100:103], v[36:39]
    v_mov_b32_dpp v3, v11 row_ror:8 row_mask:0xf bank_mask:0xf
    s_waitcnt lgkmcnt(2)
    v_mfma_f32_16x16x32_bf16 v[24:27], v[12:15], v[104:107], v[24:27]
    ds_read_b64_tr_b16 v[20:21], v0 offset:43776
    v_mfma_f32_16x16x32_bf16 v[28:31], v[12:15], v[108:111], v[28:31]
    ds_read_b64_tr_b16 v[22:23], v0 offset:43904
    v_mov_b32_dpp v10, v8 row_ror:8 row_mask:0xf bank_mask:0x3
    v_mfma_f32_16x16x32_bf16 v[32:35], v[12:15], v[112:115], v[32:35]
    v_mov_b32_dpp v11, v9 row_ror:8 row_mask:0xf bank_mask:0x3
    v_mfma_f32_16x16x32_bf16 v[36:39], v[12:15], v[116:119], v[36:39]
    v_mov_b32_dpp v8, v2 quad_perm:[0,1,2,3] row_mask:0xf bank_mask:0xc
    s_waitcnt lgkmcnt(2)
    v_mfma_f32_16x16x32_bf16 v[24:27], v[16:19], v[120:123], v[24:27]
    ds_read_b64_tr_b16 v[12:13], v0 offset:44032
    v_mfma_f32_16x16x32_bf16 v[28:31], v[16:19], v[124:127], v[28:31]
    ds_read_b64_tr_b16 v[14:15], v0 offset:44160
    v_mov_b32_dpp v9, v3 quad_perm:[0,1,2,3] row_mask:0xf bank_mask:0xc
    v_mfma_f32_16x16x32_bf16 v[32:35], v[16:19], v[128:131], v[32:35]
    buffer_store_dwordx4 v[8:11], v1, s[12:15], s37 offen offset:1024 sc0 sc1
    v_mfma_f32_16x16x32_bf16 v[36:39], v[16:19], v[132:135], v[36:39]
    s_add_u32 s37, s37, 16384
    s_waitcnt lgkmcnt(2)
    v_mfma_f32_16x16x32_bf16 v[24:27], v[20:23], v[136:139], v[24:27]
    v_mfma_f32_16x16x32_bf16 v[28:31], v[20:23], v[140:143], v[28:31]
    v_mfma_f32_16x16x32_bf16 v[32:35], v[20:23], v[144:147], v[32:35]
    v_mfma_f32_16x16x32_bf16 v[36:39], v[20:23], v[148:151], v[36:39]
    s_waitcnt lgkmcnt(0)
    v_mfma_f32_16x16x32_bf16 v[24:27], v[12:15], v[152:155], v[24:27]
    v_mfma_f32_16x16x32_bf16 v[28:31], v[12:15], v[156:159], v[28:31]
    v_mfma_f32_16x16x32_bf16 v[32:35], v[12:15], v[160:163], v[32:35]
    v_mfma_f32_16x16x32_bf16 v[36:39], v[12:15], v[164:167], v[36:39]
    s_nop 5
    v_cvt_pk_bf16_f32 v4, v24, v28
    v_cvt_pk_bf16_f32 v6, v25, v29
    v_cvt_pk_bf16_f32 v8, v26, v30
    v_cvt_pk_bf16_f32 v10, v27, v31
    v_cvt_pk_bf16_f32 v7, v33, v37
    v_cvt_pk_bf16_f32 v5, v32, v36
    v_cvt_pk_bf16_f32 v11, v35, v39
    v_cvt_pk_bf16_f32 v9, v34, v38
    v_mov_b32_dpp v2, v6 row_ror:8 row_mask:0xf bank_mask:0xf
    v_mov_b32_dpp v3, v7 row_ror:8 row_mask:0xf bank_mask:0xf
    v_mov_b32_dpp v6, v4 row_ror:8 row_mask:0xf bank_mask:0x3
    v_mov_b32_dpp v7, v5 row_ror:8 row_mask:0xf bank_mask:0x3
    v_mov_b32_dpp v4, v2 quad_perm:[0,1,2,3] row_mask:0xf bank_mask:0xc
    v_mov_b32_dpp v5, v3 quad_perm:[0,1,2,3] row_mask:0xf bank_mask:0xc
    buffer_store_dwordx4 v[4:7], v1, s[12:15], s37 offen offset:0 sc0 sc1
    v_mov_b32_dpp v2, v10 row_ror:8 row_mask:0xf bank_mask:0xf
    v_mov_b32_dpp v3, v11 row_ror:8 row_mask:0xf bank_mask:0xf
    v_mov_b32_dpp v10, v8 row_ror:8 row_mask:0xf bank_mask:0x3
    v_mov_b32_dpp v11, v9 row_ror:8 row_mask:0xf bank_mask:0x3
    v_mov_b32_dpp v8, v2 quad_perm:[0,1,2,3] row_mask:0xf bank_mask:0xc
    v_mov_b32_dpp v9, v3 quad_perm:[0,1,2,3] row_mask:0xf bank_mask:0xc
    buffer_store_dwordx4 v[8:11], v1, s[12:15], s37 offen offset:1024 sc0 sc1
    s_add_u32 s37, s37, 16384
    s_cmp_lg_u32 s36, 0
    s_cbranch_scc1 gm_poll
    s_endpgm
mn_cg:
    v_and_b32 v42, 0x70, v42
    s_movk_i32 m0, 512
    s_mov_b64 exec, 0xff
    global_load_lds_dwordx4 v42, s[60:61]
    s_mov_b64 exec, -1
    s_branch mn_cg_back
mn_ea3:
    v_add_u32 v36, 6144, v36
    ds_read_b32 v42, v36 offset:15372
    s_waitcnt lgkmcnt(0)
    s_branch mn_ea2
mn_setmore:
    v_mov_b32 v41, 272
    ds_write_b32 v41, v30
    s_branch mn_setmore_back
mn_ovf:
    s_movk_i32 s20, 6
    s_waitcnt lgkmcnt(0)
    s_barrier
    ds_write_b32 v29, v32 offset:0
    ds_write_b32 v32, v32 offset:272
    s_waitcnt lgkmcnt(0)
    s_barrier
    s_branch mn_count
mn_next:
    s_waitcnt vmcnt(0) lgkmcnt(0)
    s_nop 7
    v_and_b32 v29, 63, v0
    v_lshlrev_b32 v29, 2, v29
    v_mov_b32 v41, 0
    ds_write_b32 v29, v41 offset:0
    ds_write_b32 v41, v41 offset:272
    v_subrev_u32 v84, s20, v84
    s_mul_i32 s52, s20, 48
    v_add_u32 v85, s52, v85
    s_waitcnt lgkmcnt(0)
    s_barrier
    v_cmpx_lt_i32 vcc, 0, v84
    s_cbranch_execz mn_ld2_done
    buffer_load_dwordx4 v[44:47], v85, s[8:11], 0 offen offset:32
    s_cmp_le_u32 s20, 6
    s_cbranch_scc1 mn_ld2_done
    v_cmpx_lt_i32 vcc, 6, v84
    s_cbranch_execz mn_ld2_done
    buffer_load_dwordx4 v[48:51], v85, s[8:11], 0 offen offset:320
    v_cmpx_lt_i32 vcc, 12, v84
    s_cbranch_execz mn_ld2_done
    buffer_load_dwordx4 v[52:55], v85, s[8:11], 0 offen offset:608
    v_cmpx_lt_i32 vcc, 18, v84
    s_cbranch_execz mn_ld2_done
    buffer_load_dwordx4 v[56:59], v85, s[8:11], 0 offen offset:896
mn_ld2_done:
    s_mov_b64 exec, -1
    s_branch mn_pass
.section .rodata,"a"
.p2align 6
.amdhsa_kernel ka_kernel
  .amdhsa_next_free_vgpr 88
  .amdhsa_next_free_sgpr 40
  .amdhsa_accum_offset 88
  .amdhsa_group_segment_fixed_size 0
  .amdhsa_kernarg_size 88
  .amdhsa_user_sgpr_count 2
  .amdhsa_user_sgpr_kernarg_segment_ptr 1
  .amdhsa_system_sgpr_workgroup_id_x 1
.end_amdhsa_kernel
.p2align 6
.amdhsa_kernel main_kernel
  .amdhsa_next_free_vgpr 168
  .amdhsa_next_free_sgpr 64
  .amdhsa_accum_offset 168
  .amdhsa_group_segment_fixed_size 0
  .amdhsa_kernarg_size 88
  .amdhsa_user_sgpr_count 2
  .amdhsa_user_sgpr_kernarg_segment_ptr 1
  .amdhsa_system_sgpr_workgroup_id_x 1
.end_amdhsa_kernel
```

```asm
; @launch kernel=ka_kernel grid=(256,1,1) block=(640,1,1) lds=89088
; @launch kernel=main_kernel grid=(256,1,1) block=(768,1,1) lds=163840
.amdgcn_target "amdgcn-amd-amdhsa--gfx950"
.text
.globl ka_kernel
.p2align 8
.type ka_kernel,@function
ka_kernel:
    s_cmp_ge_u32 s2, 256
    s_cbranch_scc1 ka_end
    s_load_dwordx8 s[4:11], s[0:1], 8
    s_load_dwordx2 s[16:17], s[0:1], 0
    s_load_dwordx2 s[14:15], s[0:1], 80
    s_load_dwordx2 s[32:33], s[0:1], 56
    v_lshrrev_b32 v9, 6, v0
    v_and_b32 v1, 63, v0
    v_readfirstlane_b32 s18, v9
    s_cmp_ge_u32 s2, 128
    s_cbranch_scc1 ka_pf
    s_cmp_ge_u32 s2, 125
    s_cbranch_scc1 ka_extra
    s_mul_i32 s3, s2, 1280
    v_add_u32 v4, s3, v0
    v_lshlrev_b32 v5, 2, v4
    v_lshlrev_b32 v2, 2, v0
    v_and_b32 v2, 0x3fc, v2
    v_mov_b32 v3, 0
    v_lshlrev_b32 v6, 3, v4
    v_add_u32 v8, 5120, v6
    v_and_b32 v7, 0xffffffc0, v4
    v_lshlrev_b32 v7, 5, v7
    v_lshl_add_u32 v7, v1, 4, v7
    v_add_u32 v9, 20480, v7
    s_waitcnt lgkmcnt(0)
    global_load_dword v10, v5, s[6:7]
    global_load_dword v60, v5, s[6:7] offset:2560
    global_load_dword v11, v5, s[4:5]
    global_load_dword v61, v5, s[4:5] offset:2560
    ds_write_b32 v2, v3
    v_lshlrev_b32 v5, 4, v0
    v_mov_b32 v44, 0
    v_mov_b32 v45, 0
    v_mov_b32 v46, 0
    v_mov_b32 v47, 0
    ds_write_b128 v5, v[44:47] offset:11264
    ds_write_b128 v5, v[44:47] offset:17408
    s_mov_b32 s20, s14
    s_and_b32 s21, s15, 0xffff
    s_mov_b32 s22, 12582912
    s_mov_b32 s23, 0x20000
    s_and_b32 s28, s2, 7
    s_lshl_b32 s28, s28, 4
    s_lshr_b32 s29, s2, 3
    s_add_u32 s28, s28, s29
    s_lshl_b32 s30, s28, 6
    s_add_u32 s30, s30, 8388608
    s_lshl_b32 s28, s28, 2
    s_add_u32 s28, s28, 10485760
    v_mov_b32 v3, 1
    v_lshrrev_b32 v24, 1, v1
    v_lshlrev_b32 v24, 2, v24
    v_and_b32 v25, 1, v0
    v_lshlrev_b32 v25, 4, v25
    v_lshlrev_b32 v26, 4, v1
    s_lshl_b32 s19, s18, 10
    v_add_u32 v27, s19, v26
    s_movk_i32 s29, 625
    s_movk_i32 s38, 640
    s_movk_i32 s39, 1250
    s_waitcnt lgkmcnt(0)
    s_barrier
    global_load_dwordx2 v[12:13], v6, s[8:9]
    global_load_dwordx4 v[16:19], v7, s[10:11]
    global_load_dwordx4 v[20:23], v7, s[10:11] offset:1024
    global_load_dwordx2 v[72:73], v8, s[8:9]
    global_load_dwordx4 v[64:67], v9, s[10:11]
    global_load_dwordx4 v[68:71], v9, s[10:11] offset:1024
    s_waitcnt vmcnt(9)
    v_mul_u32_u24 v32, 214749, v10
    v_lshrrev_b32 v32, 23, v32
    v_min_u32 v32, 255, v32
    v_and_b32 v35, 7, v32
    v_lshrrev_b32 v33, 3, v32
    v_lshl_add_u32 v35, v35, 5, v33
    v_lshlrev_b32 v35, 2, v35
    ds_add_rtn_u32 v36, v35, v3
    s_waitcnt vmcnt(8)
    v_mul_u32_u24 v62, 214749, v60
    v_lshrrev_b32 v62, 23, v62
    v_min_u32 v62, 255, v62
    v_and_b32 v76, 7, v62
    v_lshrrev_b32 v63, 3, v62
    v_lshl_add_u32 v76, v76, 5, v63
    v_lshlrev_b32 v76, 2, v76
    ds_add_rtn_u32 v77, v76, v3
    s_waitcnt vmcnt(6)
    v_mad_u32_u24 v33, v32, s29, 15
    v_lshrrev_b32 v33, 4, v33
    v_sub_u32 v33, v10, v33
    v_and_b32 v32, 7, v32
    v_mul_u32_u24 v32, 1250, v32
    v_sub_u32 v39, v11, v32
    v_add_u32 v32, 10000, v39
    v_min_u32 v39, v39, v32
    v_mul_u32_u24 v39, 3330, v39
    v_lshrrev_b32 v39, 20, v39
    v_subrev_u32 v32, 20, v33
    v_min_u32 v15, v32, v33
    v_min_u32 v15, 19, v15
    v_lshrrev_b32 v32, 2, v15
    v_add_u32 v32, 27, v32
    v_cmp_gt_u32 vcc, 27, v39
    v_lshlrev_b32 v15, 2, v15
    v_and_b32 v14, 0x3fff, v11
    v_cndmask_b32 v39, v32, v39, vcc
    v_cmp_le_u32 vcc, 20, v33
    v_add_u32 v32, 32, v39
    v_lshlrev_b32 v40, 4, v35
    v_cndmask_b32 v39, v39, v32, vcc
    v_add_u32 v35, s19, v35
    v_or_b32 v39, 64, v39
    v_lshl_or_b32 v14, v39, 25, v14
    v_mad_u32_u24 v63, v62, s29, 15
    v_lshrrev_b32 v63, 4, v63
    v_sub_u32 v63, v60, v63
    v_and_b32 v62, 7, v62
    v_mul_u32_u24 v62, 1250, v62
    v_sub_u32 v78, v61, v62
    v_add_u32 v62, 10000, v78
    v_min_u32 v78, v78, v62
    v_mul_u32_u24 v78, 3330, v78
    v_lshrrev_b32 v78, 20, v78
    v_subrev_u32 v62, 20, v63
    v_min_u32 v75, v62, v63
    v_min_u32 v75, 19, v75
    v_lshrrev_b32 v62, 2, v75
    v_add_u32 v62, 27, v62
    v_cmp_gt_u32 vcc, 27, v78
    v_lshlrev_b32 v75, 2, v75
    v_and_b32 v74, 0x3fff, v61
    v_cndmask_b32 v78, v62, v78, vcc
    v_cmp_le_u32 vcc, 20, v63
    v_add_u32 v62, 32, v78
    v_lshlrev_b32 v82, 4, v76
    v_cndmask_b32 v78, v78, v62, vcc
    v_add_u32 v76, s19, v76
    v_or_b32 v78, 64, v78
    v_lshl_or_b32 v74, v78, 25, v74
    s_waitcnt lgkmcnt(0)
    s_barrier
    ds_read_b128 v[44:47], v26
    ds_read_b32 v37, v2
    v_add_u32 v28, s19, v2
    v_lshlrev_b32 v29, 9, v0
    s_mul_i32 s19, s2, 61440
    v_and_b32 v32, 3, v36
    v_lshl_add_u32 v40, v32, 4, v40
    v_and_b32 v32, 12, v36
    v_add_u32 v40, v32, v40
    v_cmp_lt_u32 vcc, 15, v36
    v_mov_b32 v32, 0x40000
    v_lshl_add_u32 v15, s19, 4, v15
    v_cndmask_b32 v40, v40, v32, vcc
    v_and_b32 v62, 3, v77
    v_lshl_add_u32 v82, v62, 4, v82
    v_and_b32 v62, 12, v77
    v_add_u32 v82, v62, v82
    v_cmp_lt_u32 vcc, 15, v77
    v_mov_b32 v62, 0x40000
    v_lshl_add_u32 v75, s19, 4, v75
    v_cndmask_b32 v82, v82, v62, vcc
    s_waitcnt lgkmcnt(1)
    v_add_u32 v53, v44, v45
    v_add_u32 v54, v53, v46
    v_add_u32 v38, v54, v47
    v_mov_b32 v55, v38
    s_nop 0
    v_add_u32_dpp v38, v38, v38 row_shr:1 row_mask:0xf bank_mask:0xf
    s_nop 1
    v_add_u32_dpp v38, v38, v38 row_shr:2 row_mask:0xf bank_mask:0xf
    s_nop 1
    v_add_u32_dpp v38, v38, v38 row_shr:4 row_mask:0xf bank_mask:0xf
    s_nop 1
    v_add_u32_dpp v38, v38, v38 row_shr:8 row_mask:0xf bank_mask:0xf
    s_nop 1
    v_add_u32_dpp v38, v38, v38 row_bcast:15 row_mask:0xa bank_mask:0xf
    s_nop 1
    v_add_u32_dpp v38, v38, v38 row_bcast:31 row_mask:0xc bank_mask:0xf
    v_sub_u32 v56, v38, v55
    v_add_u32 v57, v56, v44
    v_add_u32 v58, v56, v53
    v_add_u32 v59, v56, v54
    ds_write_b128 v27, v[56:59] offset:1024
    ds_read_b32 v43, v35 offset:1024
    ds_read_b32 v79, v76 offset:1024
    ds_read_b32 v30, v28 offset:1024
    s_waitcnt lgkmcnt(1)
    v_add_u32 v43, v43, v36
    v_lshl_or_b32 v41, v43, 14, v14
    v_mul_u32_u24 v43, 48, v43
    ds_bpermute_b32 v48, v24, v43
    ds_bpermute_b32 v49, v24, v43 offset:128
    ds_write_b32 v40, v41 offset:11264
    v_lshl_add_u32 v15, v43, 4, v15
    v_add_u32 v79, v79, v77
    v_lshl_or_b32 v83, v79, 14, v74
    v_mul_u32_u24 v79, 48, v79
    ds_bpermute_b32 v80, v24, v79
    ds_bpermute_b32 v81, v24, v79 offset:128
    ds_write_b32 v82, v83 offset:11264
    v_lshl_add_u32 v75, v79, 4, v75
    s_cmp_ge_u32 s18, 4
    s_waitcnt lgkmcnt(1)
    v_lshl_or_b32 v30, v37, 16, v30
    v_add_u32 v48, v48, v25
    v_add_u32 v49, v49, v25
    v_add_u32 v80, v80, v25
    v_add_u32 v81, v81, v25
    s_waitcnt vmcnt(5)
    ds_write_b128 v43, v[12:15] offset:27680
    s_waitcnt vmcnt(4)
    ds_write_b128 v48, v[16:19] offset:27648
    s_waitcnt vmcnt(3)
    ds_write_b128 v49, v[20:23] offset:27648
    s_waitcnt vmcnt(2)
    ds_write_b128 v79, v[72:75] offset:27680
    s_waitcnt vmcnt(1)
    ds_write_b128 v80, v[64:67] offset:27648
    s_waitcnt vmcnt(0)
    ds_write_b128 v81, v[68:71] offset:27648
    s_cbranch_scc1 ka_nohdr
    buffer_store_dword v30, v29, s[20:23], s28 offen
ka_nohdr:
    v_lshrrev_b32 v6, 2, v0
    v_lshlrev_b32 v6, 13, v6
    v_and_b32 v7, 0x30, v5
    v_or_b32 v6, v6, v7
    v_add_u32 v7, 27648, v5
    s_add_u32 s31, s30, 1310720
    s_cmp_ge_u32 s18, 6
    s_waitcnt lgkmcnt(0)
    s_barrier
    ds_read_b128 v[36:39], v5 offset:11264
    ds_read_b128 v[40:43], v5 offset:21504
    ds_read_b128 v[12:15], v7 offset:0
    ds_read_b128 v[16:19], v7 offset:10240
    ds_read_b128 v[20:23], v7 offset:20480
    ds_read_b128 v[24:27], v7 offset:30720
    ds_read_b128 v[28:31], v7 offset:40960
    ds_read_b128 v[32:35], v7 offset:51200
    s_waitcnt lgkmcnt(6)
    buffer_store_dwordx4 v[36:39], v6, s[20:23], s30 offen
    s_cbranch_scc1 ka_noc2
    buffer_store_dwordx4 v[40:43], v6, s[20:23], s31 offen
ka_noc2:
    s_waitcnt lgkmcnt(5)
    buffer_store_dwordx4 v[12:15], v5, s[20:23], s19 offen sc1
    s_addk_i32 s19, 10240
    s_waitcnt lgkmcnt(4)
    buffer_store_dwordx4 v[16:19], v5, s[20:23], s19 offen sc1
    s_addk_i32 s19, 10240
    s_waitcnt lgkmcnt(3)
    buffer_store_dwordx4 v[20:23], v5, s[20:23], s19 offen sc1
    s_addk_i32 s19, 10240
    s_waitcnt lgkmcnt(2)
    buffer_store_dwordx4 v[24:27], v5, s[20:23], s19 offen sc1
    s_addk_i32 s19, 10240
    s_waitcnt lgkmcnt(1)
    buffer_store_dwordx4 v[28:31], v5, s[20:23], s19 offen sc1
    s_addk_i32 s19, 10240
    s_waitcnt lgkmcnt(0)
    buffer_store_dwordx4 v[32:35], v5, s[20:23], s19 offen sc1
    s_endpgm
ka_pf:
    s_waitcnt lgkmcnt(0)
    s_and_b32 s34, s2, 7
    s_mul_i32 s34, s34, 2560000
    s_add_u32 s24, s16, s34
    s_addc_u32 s25, s17, 0
    s_and_b32 s25, s25, 0xffff
    s_mov_b32 s26, 1310720
    s_mov_b32 s27, 0x20000
    s_bfe_u32 s30, s2, 0x40003
    v_lshlrev_b32 v40, 7, v0
    s_mul_i32 s30, s30, 81920
    s_cmp_lg_u32 s18, 0
    s_cbranch_scc1 ka_nocpf
    s_cmp_ge_u32 s2, 144
    s_cbranch_scc1 ka_nocpf
    s_getpc_b64 s[36:37]
ka_pc:
    s_add_u32 s36, s36, main_kernel-ka_pc
    s_addc_u32 s37, s37, 0
    s_bfe_u32 s38, s2, 0x10003
    s_lshl_b32 s38, s38, 13
    v_lshl_add_u32 v41, v1, 7, s38
    v_min_u32 v41, mn_last-main_kernel, v41
    global_load_dword v41, v41, s[36:37]
ka_nocpf:
    s_cmp_lg_u32 s18, 9
    s_cbranch_scc1 ka_pf1
    s_bitcmp1_b32 s2, 3
    s_cbranch_scc1 ka_pf1
    s_and_b32 s35, s2, 7
    s_bfe_u32 s36, s2, 0x30004
    s_lshl_b32 s37, s35, 14
    s_lshr_b32 s38, s36, 1
    s_lshl_b32 s38, s38, 7
    s_add_u32 s37, s37, s38
    s_and_b32 s38, s36, 1
    s_lshl2_add_u32 s37, s38, s37
    v_lshrrev_b32 v44, 4, v1
    v_lshlrev_b32 v44, 11, v44
    v_and_b32 v45, 7, v1
    v_lshl_add_u32 v44, v45, 4, v44
    v_and_b32 v45, 8, v1
    v_add3_u32 v44, v44, v45, s37
    v_add_u32 v45, 0x2000, v44
    global_load_dword v48, v44, s[32:33] offset:0
    global_load_dword v49, v44, s[32:33] offset:512
    global_load_dword v50, v44, s[32:33] offset:1024
    global_load_dword v51, v44, s[32:33] offset:1536
    global_load_dword v52, v45, s[32:33] offset:0
    global_load_dword v53, v45, s[32:33] offset:512
    global_load_dword v54, v45, s[32:33] offset:1024
    global_load_dword v55, v45, s[32:33] offset:1536
    s_lshr_b32 s36, s36, 1
    s_lshl3_add_u32 s36, s36, s35
    s_lshl1_add_u32 s36, s36, s38
    s_lshl_b32 s36, s36, 11
    s_add_u32 s36, s36, 11534336
    v_lshl_add_u32 v46, v1, 4, s36
    s_mov_b32 s38, 0x05040100
    s_mov_b32 s39, 0x07060302
    s_waitcnt vmcnt(0)
    v_perm_b32 v56, v49, v48, s38
    v_perm_b32 v60, v49, v48, s39
    v_perm_b32 v57, v51, v50, s38
    v_perm_b32 v61, v51, v50, s39
    v_perm_b32 v58, v53, v52, s38
    v_perm_b32 v62, v53, v52, s39
    v_perm_b32 v59, v55, v54, s38
    v_perm_b32 v63, v55, v54, s39
    global_store_dwordx4 v46, v[56:59], s[14:15]
    global_store_dwordx4 v46, v[60:63], s[14:15] offset:1024
ka_pf1:
    s_cmp_ge_u32 s18, 10
    s_cbranch_scc1 ka_end
    buffer_load_dword v42, v40, s[24:27], s30 offen
    s_cmp_ge_u32 s18, 0
    s_cbranch_scc1 ka_end
    s_add_u32 s30, s30, 81920
    buffer_load_dword v43, v40, s[24:27], s30 offen
    s_endpgm
ka_extra:
    s_cmp_lg_u32 s2, 125
    s_cbranch_scc1 ka_end
    s_cmp_ge_u32 s18, 6
    s_cbranch_scc1 ka_end
    s_load_dwordx4 s[36:39], s[0:1], 40
    s_lshl_b32 s34, s18, 11
    s_add_u32 s34, s34, 11665408
    v_lshl_add_u32 v46, v1, 4, s34
    s_cmp_eq_u32 s18, 5
    s_cbranch_scc1 ka_dum
    s_cmp_eq_u32 s18, 4
    s_cbranch_scc1 ka_cg
    v_lshrrev_b32 v44, 5, v1
    v_lshlrev_b32 v44, 12, v44
    v_and_b32 v45, 31, v1
    v_lshl_add_u32 v44, v45, 1, v44
    v_lshl_add_u32 v44, s18, 7, v44
    s_waitcnt lgkmcnt(0)
    global_load_ushort v48, v44, s[38:39] offset:0
    global_load_ushort v49, v44, s[38:39] offset:512
    global_load_ushort v50, v44, s[38:39] offset:1024
    global_load_ushort v51, v44, s[38:39] offset:1536
    global_load_ushort v52, v44, s[38:39] offset:2048
    global_load_ushort v53, v44, s[38:39] offset:2560
    global_load_ushort v54, v44, s[38:39] offset:3072
    global_load_ushort v55, v44, s[38:39] offset:3584
    global_load_ushort v56, v44, s[38:39] offset:64
    global_load_ushort v57, v44, s[38:39] offset:576
    global_load_ushort v58, v44, s[38:39] offset:1088
    global_load_ushort v59, v44, s[38:39] offset:1600
    global_load_ushort v60, v44, s[38:39] offset:2112
    global_load_ushort v61, v44, s[38:39] offset:2624
    global_load_ushort v62, v44, s[38:39] offset:3136
    global_load_ushort v63, v44, s[38:39] offset:3648
    s_branch ka_pk
ka_cg:
    v_and_b32 v44, 3, v1
    v_lshlrev_b32 v44, 1, v44
    s_waitcnt lgkmcnt(0)
    global_load_ushort v48, v44, s[36:37] offset:0
    global_load_ushort v49, v44, s[36:37] offset:8
    global_load_ushort v50, v44, s[36:37] offset:16
    global_load_ushort v51, v44, s[36:37] offset:24
    global_load_ushort v52, v44, s[36:37] offset:32
    global_load_ushort v53, v44, s[36:37] offset:40
    global_load_ushort v54, v44, s[36:37] offset:48
    global_load_ushort v55, v44, s[36:37] offset:56
    global_load_ushort v56, v44, s[36:37] offset:64
    global_load_ushort v57, v44, s[36:37] offset:72
    global_load_ushort v58, v44, s[36:37] offset:80
    global_load_ushort v59, v44, s[36:37] offset:88
    global_load_ushort v60, v44, s[36:37] offset:96
    global_load_ushort v61, v44, s[36:37] offset:104
    global_load_ushort v62, v44, s[36:37] offset:112
    global_load_ushort v63, v44, s[36:37] offset:120
ka_pk:
    s_waitcnt vmcnt(0)
    v_lshl_or_b32 v64, v49, 16, v48
    v_lshl_or_b32 v65, v51, 16, v50
    v_lshl_or_b32 v66, v53, 16, v52
    v_lshl_or_b32 v67, v55, 16, v54
    v_lshl_or_b32 v68, v57, 16, v56
    v_lshl_or_b32 v69, v59, 16, v58
    v_lshl_or_b32 v70, v61, 16, v60
    v_lshl_or_b32 v71, v63, 16, v62
    global_store_dwordx4 v46, v[64:67], s[14:15]
    global_store_dwordx4 v46, v[68:71], s[14:15] offset:1024
    s_endpgm
ka_dum:
    v_mov_b32 v46, 11677696
    v_mov_b32 v48, 0
    v_mov_b32 v49, 0
    v_mov_b32 v50, 0
    v_mov_b32 v51, 0
    v_mov_b32 v52, 0x3fff
    v_mov_b32 v53, 186843136
    s_mov_b64 exec, 1
    s_waitcnt lgkmcnt(0)
    global_store_dwordx4 v46, v[48:51], s[14:15]
    global_store_dwordx4 v46, v[48:51], s[14:15] offset:16
    global_store_dwordx4 v46, v[50:53], s[14:15] offset:32
ka_end:
    s_endpgm
.globl main_kernel
.p2align 8
.type main_kernel,@function
main_kernel:
    s_cmp_ge_u32 s2, 256
    s_cbranch_scc1 mn_end
    s_load_dwordx2 s[54:55], s[0:1], 80
    s_load_dwordx2 s[50:51], s[0:1], 0
    s_load_dwordx2 s[56:57], s[0:1], 64
    v_lshrrev_b32 v56, 6, v0
    v_lshlrev_b32 v55, 1, v0
    v_readfirstlane_b32 s16, v56
    v_and_b32 v55, 0x78, v55
    v_or_b32 v55, v55, v56
    v_mul_u32_u24 v58, 61440, v55
    v_and_b32 v56, 0x200, v0
    v_or_b32 v55, v55, v56
    v_cmp_gt_u32 vcc, 125, v55
    v_bfrev_b32 v56, 2
    v_lshlrev_b32 v55, 4, v0
    v_and_b32 v57, 0x1fc, v0
    v_cndmask_b32 v55, v56, v55, vcc
    v_cndmask_b32 v57, v56, v57, vcc
    s_and_b32 s48, s2, 7
    s_lshr_b32 s47, s2, 3
    s_lshl_b32 s25, s48, 5
    s_add_u32 s25, s25, s47
    s_lshl_b32 s49, s25, 13
    s_add_u32 s49, s49, 8388608
    s_lshl_b32 s25, s25, 9
    s_add_u32 s25, s25, 10485760
    s_mov_b32 s10, 12582912
    s_mov_b32 s11, 0x20000
    s_and_b32 s17, s16, 3
    v_and_b32 v46, 63, v0
    s_waitcnt lgkmcnt(0)
    s_mov_b32 s8, s54
    s_and_b32 s9, s55, 0xffff
    buffer_load_dwordx4 v[20:23], v55, s[8:11], s49 offen
    buffer_load_dword v59, v57, s[8:11], s25 offen
    s_cmp_ge_u32 s16, 8
    s_cbranch_scc1 gm_touch
gm_touch_back:
    v_lshlrev_b32 v56, 2, v0
    v_and_b32 v56, 0x1fc, v56
    v_mov_b32 v24, 0
    ds_write_b32 v56, v24
    s_bfe_u32 s18, s16, 0x10002
    s_lshl_b32 s53, s17, 7
    s_add_u32 s4, s50, s53
    s_addc_u32 s5, s51, 0
    s_and_b32 s5, s5, 0xffff
    s_or_b32 s5, s5, 0x08000000
    s_movk_i32 s6, 10000
    s_mov_b32 s7, 0x20000
    s_mul_i32 s22, s2, 625
    s_add_u32 s52, s22, 640
    s_add_u32 s22, s22, 15
    s_lshr_b32 s22, s22, 4
    s_lshr_b32 s52, s52, 4
    s_mov_b32 s12, s56
    s_and_b32 s13, s57, 0xffff
    s_lshl_b32 s14, s52, 11
    s_mov_b32 s15, 0x20000
    s_and_b32 s52, s16, 7
    s_mul_i32 s40, s52, 15360
    s_add_u32 s40, s40, 40960
    v_lshl_add_u32 v87, v46, 3, s40
    s_add_u32 s40, s40, 9216
    s_waitcnt lgkmcnt(0)
    s_barrier
    s_add_u32 s41, s40, 1024
    s_add_u32 s42, s40, 2048
    s_add_u32 s43, s40, 3072
    s_add_u32 s44, s40, 4096
    s_add_u32 s45, s40, 5120
    s_movk_i32 s20, 20
    s_mov_b32 s24, 0
    v_and_b32 v55, 3, v0
    v_bfe_u32 v56, v0, 2, 2
    v_bfe_u32 v57, v0, 4, 1
    v_bfe_u32 v53, v0, 5, 1
    v_lshlrev_b32 v1, 3, v55
    v_lshl_add_u32 v1, v57, 5, v1
    v_lshl_add_u32 v1, v56, 6, v1
    v_lshl_add_u32 v1, v53, 8, v1
    v_add_u32 v1, s40, v1
    v_lshlrev_b32 v5, 4, v55
    v_lshl_add_u32 v5, v57, 6, v5
    v_lshl_add_u32 v5, v56, 9, v5
    v_mov_b32 v7, v5
    v_and_b32 v46, 63, v0
    v_mov_b32 v48, 1
    v_lshlrev_b32 v47, 2, v46
    v_bfe_u32 v2, v0, 5, 1
    v_bfe_u32 v3, v0, 3, 2
    v_and_b32 v18, 3, v0
    v_lshl_add_u32 v3, v3, 2, v18
    v_mul_u32_u24 v49, 20, v2
    v_bfe_u32 v55, v0, 2, 1
    v_lshlrev_b32 v86, 4, v2
    v_lshl_or_b32 v86, v55, 18, v86
    v_lshrrev_b32 v55, 2, v46
    v_lshl_add_u32 v18, v18, 4, v55
    v_mov_b32 v50, 1327103
    v_and_b32 v35, 3, v0
    v_min_u32 v44, 1, v46
    v_lshlrev_b32 v44, 18, v44
    v_mov_b64 v[88:89], 0
    v_mov_b64 v[90:91], 0
    v_mov_b64 v[92:93], 0
    v_mov_b64 v[94:95], 0
    v_mov_b64 v[96:97], 0
    v_mov_b64 v[98:99], 0
    v_mov_b64 v[100:101], 0
    v_mov_b64 v[102:103], 0
    v_mov_b64 v[104:105], 0
    v_mov_b64 v[106:107], 0
    v_mov_b64 v[108:109], 0
    v_mov_b64 v[110:111], 0
    v_mov_b64 v[112:113], 0
    v_mov_b64 v[114:115], 0
    v_mov_b64 v[116:117], 0
    v_mov_b64 v[118:119], 0
    v_mov_b64 v[120:121], 0
    v_mov_b64 v[122:123], 0
    v_mov_b64 v[124:125], 0
    v_mov_b64 v[126:127], 0
    s_mov_b32 s52, 0x110000
    s_cmp_ge_u32 s16, 8
    s_cbranch_scc1 gm_pre
    s_waitcnt vmcnt(0)
    v_cmp_le_u32 vcc, s52, v59
    s_cbranch_vccnz mn_w5
mn_count:
    v_lshrrev_b32 v42, 16, v59
    v_subrev_u32 v42, s24, v42
    v_med3_i32 v42, v42, 0, s20
    v_mov_b32 v43, v42
    v_lshrrev_b32 v25, 23, v20
    v_and_b32 v25, 0xfc, v25
    v_add_u32_dpp v43, v43, v43 row_shr:4 row_mask:0xf bank_mask:0xf
    v_lshrrev_b32 v26, 23, v21
    v_and_b32 v26, 0xfc, v26
    v_add_u32_dpp v43, v43, v43 row_shr:8 row_mask:0xf bank_mask:0xf
    v_lshrrev_b32 v27, 23, v22
    v_and_b32 v27, 0xfc, v27
    v_add_u32_dpp v43, v43, v43 row_bcast:15 row_mask:0xa bank_mask:0xf
    v_lshrrev_b32 v28, 23, v23
    v_and_b32 v28, 0xfc, v28
    v_add_u32_dpp v43, v43, v43 row_bcast:31 row_mask:0xc bank_mask:0xf
    v_lshrrev_b32 v29, 23, v24
    v_and_b32 v29, 0xfc, v29
    v_readlane_b32 s52, v43, 63
    v_sub_u32 v41, v43, v42
    v_add_u32 v41, v41, v35
    v_mov_b32 v55, s52
    ds_add_rtn_u32 v55, v44, v55 offset:280
    v_cmpx_gt_i32 vcc, 0, v20
    s_cbranch_execz mn_cn_done
    ds_add_rtn_u32 v30, v25, v48
    v_bfe_u32 v36, v20, 14, 11
    v_mad_u32_u24 v36, v36, 48, v58
    v_cmpx_gt_i32 vcc, 0, v21
    s_cbranch_execz mn_cn_done
    ds_add_rtn_u32 v31, v26, v48
    v_bfe_u32 v37, v21, 14, 11
    v_mad_u32_u24 v37, v37, 48, v58
    v_cmpx_gt_i32 vcc, 0, v22
    s_cbranch_execz mn_cn_done
    ds_add_rtn_u32 v32, v27, v48
    v_bfe_u32 v38, v22, 14, 11
    v_mad_u32_u24 v38, v38, 48, v58
    v_cmpx_gt_i32 vcc, 0, v23
    s_cbranch_execz mn_cn_done
    ds_add_rtn_u32 v33, v28, v48
    v_bfe_u32 v39, v23, 14, 11
    v_mad_u32_u24 v39, v39, 48, v58
    v_cmpx_gt_i32 vcc, 0, v24
    s_cbranch_execz mn_cn_done
    ds_add_rtn_u32 v34, v29, v48
    v_bfe_u32 v40, v24, 14, 11
    v_mad_u32_u24 v40, v40, 48, v58
mn_cn_done:
    s_mov_b64 exec, -1
    s_waitcnt lgkmcnt(0)
    s_nop 2
    v_readfirstlane_b32 s52, v55
    s_min_u32 s52, s52, 774
    v_add_u32 v41, s52, v41
    v_lshlrev_b32 v55, 2, v41
    v_cmpx_gt_i32 vcc, 0, v20
    s_cbranch_execz mn_tb_done
    ds_write_b32 v55, v36 offset:41984
    v_cmpx_gt_i32 vcc, 0, v21
    s_cbranch_execz mn_tb_done
    ds_write_b32 v55, v37 offset:42000
    v_cmpx_gt_i32 vcc, 0, v22
    s_cbranch_execz mn_tb_done
    ds_write_b32 v55, v38 offset:42016
    v_cmpx_gt_i32 vcc, 0, v23
    s_cbranch_execz mn_tb_done
    ds_write_b32 v55, v39 offset:42032
    v_cmpx_gt_i32 vcc, 0, v24
    s_cbranch_execz mn_tb_done
    ds_write_b32 v55, v40 offset:42048
mn_tb_done:
    s_mov_b64 exec, -1
    s_lshl_b32 s52, s17, 11
    s_add_u32 s52, s52, 11665408
    s_mov_b32 s53, 11673600
    v_lshlrev_b32 v52, 4, v46
    buffer_load_dwordx4 v[68:71], v52, s[8:11], s52 offen
    buffer_load_dwordx4 v[72:75], v52, s[8:11], s52 offen offset:1024
    buffer_load_dwordx4 v[76:79], v52, s[8:11], s53 offen
    buffer_load_dwordx4 v[80:83], v52, s[8:11], s53 offen offset:1024
mn_cbar:
    s_lshl_b32 s52, s18, 5
    s_add_u32 s53, s52, 31
    v_mov_b32 v52, 0
    s_movk_i32 s48, 0x3fff
    s_movk_i32 s49, 236
    s_cmp_ge_u32 s16, 8
    s_waitcnt lgkmcnt(0)
    s_barrier
    ds_read_b32 v53, v47 offset:0
    ds_read_b32 v52, v52 offset:272
    s_cbranch_scc1 gm_raw
gm_raw_back:
    v_mad_u32_u24 v41, v41, 3, s49
    v_lshlrev_b32 v41, 16, v41
    s_waitcnt lgkmcnt(1)
    v_mov_b32 v54, v53
    v_sub_u32 v53, v49, v53
    s_nop 0
    v_add_u32_dpp v54, v54, v54 row_shr:1 row_mask:0xf bank_mask:0xf
    v_and_or_b32 v36, v20, s48, v41
    v_add_u32 v41, 786432, v41
    v_add_u32_dpp v54, v54, v54 row_shr:2 row_mask:0xf bank_mask:0xf
    v_and_or_b32 v37, v21, s48, v41
    v_add_u32 v41, 786432, v41
    v_add_u32_dpp v54, v54, v54 row_shr:4 row_mask:0xf bank_mask:0xf
    v_and_or_b32 v38, v22, s48, v41
    v_add_u32 v41, 786432, v41
    v_add_u32_dpp v54, v54, v54 row_shr:8 row_mask:0xf bank_mask:0xf
    v_and_or_b32 v39, v23, s48, v41
    v_add_u32 v41, 786432, v41
    v_add_u32_dpp v54, v54, v54 row_bcast:15 row_mask:0xa bank_mask:0xf
    v_and_or_b32 v40, v24, s48, v41
    v_add_u32 v41, 786432, v41
    v_add_u32_dpp v54, v54, v54 row_bcast:31 row_mask:0xc bank_mask:0xf
    v_add_u32 v53, v53, v54
    v_add_u32 v54, v54, v49
    ds_bpermute_b32 v25, v25, v53
    ds_bpermute_b32 v26, v26, v53
    ds_bpermute_b32 v27, v27, v53
    ds_bpermute_b32 v28, v28, v53
    ds_bpermute_b32 v29, v29, v53
    v_readlane_b32 s23, v54, 63
    v_readlane_b32 s33, v54, s53
    v_readlane_b32 s32, v53, s52
    s_cmp_gt_u32 s23, 794
    s_cbranch_scc1 mn_ovf
    v_add_lshl_u32 v55, s33, v46, 2
    s_mov_b32 exec_lo, 1048575
    s_mov_b32 exec_hi, 0
    ds_write_b32 v55, v50 offset:512
    s_mov_b64 exec, -1
    s_waitcnt lgkmcnt(1)
    v_cmpx_gt_i32 vcc, 0, v20
    s_cbranch_execz mn_w2_done
    v_add_lshl_u32 v25, v25, v30, 2
    ds_write_b32 v25, v36 offset:512
    v_cmpx_gt_i32 vcc, 0, v21
    s_cbranch_execz mn_w2_done
    v_add_lshl_u32 v26, v26, v31, 2
    ds_write_b32 v26, v37 offset:512
    v_cmpx_gt_i32 vcc, 0, v22
    s_cbranch_execz mn_w2_done
    v_add_lshl_u32 v27, v27, v32, 2
    ds_write_b32 v27, v38 offset:512
    v_cmpx_gt_i32 vcc, 0, v23
    s_cbranch_execz mn_w2_done
    v_add_lshl_u32 v28, v28, v33, 2
    ds_write_b32 v28, v39 offset:512
    v_cmpx_gt_i32 vcc, 0, v24
    s_cbranch_execz mn_w2_done
    v_add_lshl_u32 v29, v29, v34, 2
    ds_write_b32 v29, v40 offset:512
mn_w2_done:
    s_mov_b64 exec, -1
    v_add_lshl_u32 v2, s32, v2, 2
    v_add_lshl_u32 v3, s32, v3, 2
    v_add_lshl_u32 v18, s32, v18, 2
    s_cmp_ge_u32 s16, 8
    v_readfirstlane_b32 s21, v52
    s_waitcnt lgkmcnt(0)
    s_barrier
    s_cbranch_scc1 gm_start
    ds_read_u16 v44, v2 offset:512
    ds_read_u16 v45, v2 offset:520
    ds_read_u16 v46, v2 offset:528
    ds_read_u16 v47, v2 offset:536
    ds_read_u16 v48, v2 offset:544
    ds_read_u16 v49, v2 offset:552
    ds_read_u16 v50, v2 offset:560
    ds_read_u16 v51, v2 offset:568
    ds_read_u16 v84, v3 offset:514
    ds_read_u16 v8, v18 offset:514
    s_sub_u32 s53, s53, 4
    v_readlane_b32 s84, v54, s53
    s_add_u32 s53, s53, 1
    v_readlane_b32 s85, v54, s53
    s_add_u32 s53, s53, 1
    v_readlane_b32 s86, v54, s53
    s_add_u32 s53, s53, 1
    v_readlane_b32 s87, v54, s53
    s_waitcnt lgkmcnt(2)
    s_mov_b32 m0, s40
    v_mov_b32 v4, v44
    buffer_load_dwordx4 v[4:5], s[4:7], 0 idxen offen lds
    s_mov_b32 m0, s41
    v_mov_b32 v4, v45
    buffer_load_dwordx4 v[4:5], s[4:7], 0 idxen offen lds
    s_mov_b32 m0, s42
    v_mov_b32 v4, v46
    buffer_load_dwordx4 v[4:5], s[4:7], 0 idxen offen lds
    s_mov_b32 m0, s43
    v_mov_b32 v4, v47
    buffer_load_dwordx4 v[4:5], s[4:7], 0 idxen offen lds
    s_mov_b32 m0, s44
    v_mov_b32 v4, v48
    buffer_load_dwordx4 v[4:5], s[4:7], 0 idxen offen lds
    s_mov_b32 m0, s45
    v_mov_b32 v4, v49
    buffer_load_dwordx4 v[4:5], s[4:7], 0 idxen offen lds
    v_mov_b32 v4, v50
    v_mov_b32 v6, v51
    s_sub_u32 s32, s32, 3
    s_sub_u32 s59, s33, s32
    s_lshr_b32 s59, s59, 2
    s_sub_u32 s84, s84, s32
    s_sub_u32 s85, s85, s32
    s_sub_u32 s86, s86, s32
    s_sub_u32 s87, s87, s32
    s_lshr_b32 s84, s84, 2
    s_lshr_b32 s85, s85, 2
    s_lshr_b32 s86, s86, 2
    s_lshr_b32 s87, s87, 2
    s_sub_u32 s88, s59, s87
    s_sub_u32 s87, s87, s86
    s_sub_u32 s86, s86, s85
    s_sub_u32 s85, s85, s84
    s_cmp_lg_u32 s21, 0
    s_cselect_b32 s19, s59, s84
    s_mov_b32 s58, 0
    s_mov_b32 s35, 0
    s_sub_i32 s34, s59, 4
    s_max_i32 s34, s34, 0
    s_cmp_lg_u32 s24, 0
    s_cbranch_scc1 mn_noz
    v_mov_b64 v[128:129], 0
    v_mov_b64 v[130:131], 0
    v_mov_b64 v[132:133], 0
    v_mov_b64 v[134:135], 0
    v_mov_b64 v[136:137], 0
    v_mov_b64 v[138:139], 0
    v_mov_b64 v[140:141], 0
    v_mov_b64 v[142:143], 0
    v_mov_b64 v[144:145], 0
    v_mov_b64 v[146:147], 0
    v_mov_b64 v[148:149], 0
    v_mov_b64 v[150:151], 0
    v_mov_b64 v[152:153], 0
    v_mov_b64 v[154:155], 0
    v_mov_b64 v[156:157], 0
    v_mov_b64 v[158:159], 0
    v_mov_b64 v[160:161], 0
    v_mov_b64 v[162:163], 0
    v_mov_b64 v[164:165], 0
    v_mov_b64 v[166:167], 0
mn_noz:
    s_setprio 3
    s_waitcnt vmcnt(6) lgkmcnt(0)
    s_barrier
    v_lshlrev_b32 v8, 4, v8
    ds_read_b128 v[8:11], v8 offset:32
    v_lshl_add_u32 v84, v84, 4, v86
    v_xor_b32 v85, 0x40000, v84
    ds_read_b128 v[60:63], v84
    ds_read_b128 v[64:67], v85
    s_waitcnt lgkmcnt(2)
    v_mfma_f32_4x4x4_16b_bf16 v[28:31], v[8:9], v[76:77], 0
    v_mfma_f32_4x4x4_16b_bf16 v[32:35], v[8:9], v[78:79], 0
    v_mfma_f32_4x4x4_16b_bf16 v[36:39], v[8:9], v[80:81], 0
    v_mfma_f32_4x4x4_16b_bf16 v[40:43], v[8:9], v[82:83], 0
    v_and_b32 v11, 0xff, v11
    v_or_b32 v11, 0xc000, v11
    v_lshlrev_b32 v10, 16, v11
    s_waitcnt lgkmcnt(0)
    v_mfma_f32_32x32x16_bf16 v[44:59], v[60:63], v[68:71], 0
    v_mfma_f32_32x32x16_bf16 v[44:59], v[64:67], v[72:75], v[44:59]
    v_or_b32_dpp v19, v10, v11 row_shl:4 row_mask:0xf bank_mask:0xf bound_ctrl:0
    v_cvt_pk_bf16_f32 v12, v28, v32
    v_cvt_pk_bf16_f32 v14, v29, v33
    v_cvt_pk_bf16_f32 v16, v30, v34
    v_cvt_pk_bf16_f32 v13, v36, v40
    v_cvt_pk_bf16_f32 v15, v37, v41
    v_cvt_pk_bf16_f32 v17, v38, v42
    s_sub_u32 s19, s19, 1
    s_cbranch_scc1 mn_st12
mn_st12_back:
    s_waitcnt vmcnt(4)
    ds_read_b64_tr_b16 v[20:21], v1 offset:0
    ds_read_b64_tr_b16 v[22:23], v1 offset:512
    ds_read_b64_tr_b16 v[24:25], v1 offset:1024
    ds_read_b64_tr_b16 v[26:27], v1 offset:1536
    s_set_gpr_idx_on s40, gpr_idx(SRC2,DST)
    s_mov_b32 m0, s40
    s_waitcnt lgkmcnt(0)
    buffer_load_dwordx4 v[4:5], s[4:7], 0 idxen offen lds
    s_mov_b32 m0, s41
    s_nop 0
    buffer_load_dwordx4 v[6:7], s[4:7], 0 idxen offen lds
mn_loop:
    v_mfma_f32_4x4x4_16b_bf16 v[28:31], v[12:13], v[20:21], 0 cbsz:4 abid:0
    v_mfma_f32_4x4x4_16b_bf16 v[32:35], v[12:13], v[22:23], 0 cbsz:4 abid:1
    v_mfma_f32_4x4x4_16b_bf16 v[36:39], v[12:13], v[24:25], 0 cbsz:4 abid:2
    v_mfma_f32_4x4x4_16b_bf16 v[40:43], v[12:13], v[26:27], 0 cbsz:4 abid:3
    ds_read_u16 v4, v2 offset:576
    ds_read_u16 v6, v2 offset:584
    v_readlane_b32 s28, v19, 0
    v_readlane_b32 s29, v19, 8
    s_waitcnt vmcnt(5)
    ds_read_b64_tr_b16 v[20:21], v1 offset:2048
    ds_read_b64_tr_b16 v[22:23], v1 offset:2560
    s_waitcnt vmcnt(4)
    ds_read_b64_tr_b16 v[24:25], v1 offset:3072
    ds_read_b64_tr_b16 v[26:27], v1 offset:3584
    s_sub_u32 s34, s34, 1
    s_cmov_b32 s35, 0x30000
    s_mov_b32 m0, s28
    v_fmac_f32 v88, v28, v44
    v_fmac_f32 v89, v29, v44
    v_fmac_f32 v90, v30, v44
    v_fmac_f32 v91, v31, v44
    s_lshr_b32 m0, s28, 16
    v_fmac_f32 v88, v32, v45
    v_fmac_f32 v89, v33, v45
    v_fmac_f32 v90, v34, v45
    v_fmac_f32 v91, v35, v45
    s_mov_b32 m0, s29
    v_fmac_f32 v88, v36, v46
    v_fmac_f32 v89, v37, v46
    v_fmac_f32 v90, v38, v46
    v_fmac_f32 v91, v39, v46
    s_lshr_b32 m0, s29, 16
    v_fmac_f32 v88, v40, v47
    v_fmac_f32 v89, v41, v47
    v_fmac_f32 v90, v42, v47
    v_fmac_f32 v91, v43, v47
    s_or_b32 m0, s42, s35
    s_waitcnt lgkmcnt(2)
    buffer_load_dwordx4 v[4:5], s[4:7], 0 idxen offen lds
    s_or_b32 m0, s43, s35
    s_waitcnt lgkmcnt(0)
    buffer_load_dwordx4 v[6:7], s[4:7], 0 idxen offen lds
    s_sub_u32 s19, s19, 1
    s_cbranch_scc1 mn_st0
mn_st0_back:
    v_mfma_f32_4x4x4_16b_bf16 v[28:31], v[12:13], v[20:21], 0 cbsz:4 abid:4
    v_mfma_f32_4x4x4_16b_bf16 v[32:35], v[12:13], v[22:23], 0 cbsz:4 abid:5
    v_mfma_f32_4x4x4_16b_bf16 v[36:39], v[12:13], v[24:25], 0 cbsz:4 abid:6
    v_mfma_f32_4x4x4_16b_bf16 v[40:43], v[12:13], v[26:27], 0 cbsz:4 abid:7
    ds_read_u16 v4, v2 offset:592
    ds_read_u16 v6, v2 offset:600
    v_readlane_b32 s28, v19, 16
    v_readlane_b32 s29, v19, 24
    ds_read_u16 v84, v3 offset:578
    s_waitcnt vmcnt(5)
    ds_read_b64_tr_b16 v[20:21], v1 offset:4096
    ds_read_b64_tr_b16 v[22:23], v1 offset:4608
    s_waitcnt vmcnt(4)
    ds_read_b64_tr_b16 v[24:25], v1 offset:5120
    ds_read_b64_tr_b16 v[26:27], v1 offset:5632
    s_sub_u32 s34, s34, 1
    s_cmov_b32 s35, 0x30000
    s_mov_b32 m0, s28
    v_fmac_f32 v88, v28, v48
    v_fmac_f32 v89, v29, v48
    v_fmac_f32 v90, v30, v48
    v_fmac_f32 v91, v31, v48
    s_lshr_b32 m0, s28, 16
    v_fmac_f32 v88, v32, v49
    v_fmac_f32 v89, v33, v49
    v_fmac_f32 v90, v34, v49
    v_fmac_f32 v91, v35, v49
    s_mov_b32 m0, s29
    v_fmac_f32 v88, v36, v50
    v_fmac_f32 v89, v37, v50
    v_fmac_f32 v90, v38, v50
    v_fmac_f32 v91, v39, v50
    s_lshr_b32 m0, s29, 16
    v_fmac_f32 v88, v40, v51
    v_fmac_f32 v89, v41, v51
    v_fmac_f32 v90, v42, v51
    v_fmac_f32 v91, v43, v51
    s_or_b32 m0, s44, s35
    s_waitcnt lgkmcnt(2)
    buffer_load_dwordx4 v[4:5], s[4:7], 0 idxen offen lds
    s_or_b32 m0, s45, s35
    s_waitcnt lgkmcnt(0)
    buffer_load_dwordx4 v[6:7], s[4:7], 0 idxen offen lds
    s_sub_u32 s19, s19, 1
    s_cbranch_scc1 mn_st1
mn_st1_back:
    v_mfma_f32_4x4x4_16b_bf16 v[28:31], v[12:13], v[20:21], 0 cbsz:4 abid:8
    v_mfma_f32_4x4x4_16b_bf16 v[32:35], v[12:13], v[22:23], 0 cbsz:4 abid:9
    v_mfma_f32_4x4x4_16b_bf16 v[36:39], v[12:13], v[24:25], 0 cbsz:4 abid:10
    v_mfma_f32_4x4x4_16b_bf16 v[40:43], v[12:13], v[26:27], 0 cbsz:4 abid:11
    ds_read_u16 v4, v2 offset:608
    ds_read_u16 v6, v2 offset:616
    v_readlane_b32 s28, v19, 32
    v_readlane_b32 s29, v19, 40
    v_lshl_add_u32 v84, v84, 4, v86
    v_xor_b32 v85, 0x40000, v84
    ds_read_b128 v[60:63], v84
    ds_read_b128 v[64:67], v85
    s_waitcnt vmcnt(5)
    ds_read_b64_tr_b16 v[20:21], v1 offset:0
    ds_read_b64_tr_b16 v[22:23], v1 offset:512
    s_waitcnt vmcnt(4)
    ds_read_b64_tr_b16 v[24:25], v1 offset:1024
    ds_read_b64_tr_b16 v[26:27], v1 offset:1536
    s_sub_u32 s34, s34, 1
    s_cmov_b32 s35, 0x30000
    s_mov_b32 m0, s28
    v_fmac_f32 v88, v28, v52
    v_fmac_f32 v89, v29, v52
    v_fmac_f32 v90, v30, v52
    v_fmac_f32 v91, v31, v52
    s_lshr_b32 m0, s28, 16
    v_fmac_f32 v88, v32, v53
    v_fmac_f32 v89, v33, v53
    v_fmac_f32 v90, v34, v53
    v_fmac_f32 v91, v35, v53
    s_mov_b32 m0, s29
    v_fmac_f32 v88, v36, v54
    v_fmac_f32 v89, v37, v54
    v_fmac_f32 v90, v38, v54
    v_fmac_f32 v91, v39, v54
    s_lshr_b32 m0, s29, 16
    v_fmac_f32 v88, v40, v55
    v_fmac_f32 v89, v41, v55
    v_fmac_f32 v90, v42, v55
    v_fmac_f32 v91, v43, v55
    s_or_b32 m0, s40, s35
    s_waitcnt lgkmcnt(2)
    buffer_load_dwordx4 v[4:5], s[4:7], 0 idxen offen lds
    s_or_b32 m0, s41, s35
    s_waitcnt lgkmcnt(0)
    buffer_load_dwordx4 v[6:7], s[4:7], 0 idxen offen lds
    s_sub_u32 s19, s19, 1
    s_cbranch_scc1 mn_st2
mn_st2_back:
    v_mfma_f32_4x4x4_16b_bf16 v[28:31], v[12:13], v[20:21], 0 cbsz:4 abid:12
    v_mfma_f32_4x4x4_16b_bf16 v[32:35], v[12:13], v[22:23], 0 cbsz:4 abid:13
    v_mfma_f32_4x4x4_16b_bf16 v[36:39], v[12:13], v[24:25], 0 cbsz:4 abid:14
    v_mfma_f32_4x4x4_16b_bf16 v[40:43], v[12:13], v[26:27], 0 cbsz:4 abid:15
    ds_read_u16 v4, v2 offset:624
    ds_read_u16 v6, v2 offset:632
    v_readlane_b32 s28, v19, 48
    v_readlane_b32 s29, v19, 56
    s_waitcnt vmcnt(5)
    ds_read_b64_tr_b16 v[20:21], v1 offset:2048
    ds_read_b64_tr_b16 v[22:23], v1 offset:2560
    s_waitcnt vmcnt(4)
    ds_read_b64_tr_b16 v[24:25], v1 offset:3072
    ds_read_b64_tr_b16 v[26:27], v1 offset:3584
    s_sub_u32 s34, s34, 1
    s_cmov_b32 s35, 0x30000
    s_mov_b32 m0, s28
    v_fmac_f32 v88, v28, v56
    v_fmac_f32 v89, v29, v56
    v_fmac_f32 v90, v30, v56
    v_fmac_f32 v91, v31, v56
    s_lshr_b32 m0, s28, 16
    v_fmac_f32 v88, v32, v57
    v_fmac_f32 v89, v33, v57
    v_fmac_f32 v90, v34, v57
    v_fmac_f32 v91, v35, v57
    s_mov_b32 m0, s29
    v_fmac_f32 v88, v36, v58
    v_fmac_f32 v89, v37, v58
    v_fmac_f32 v90, v38, v58
    v_fmac_f32 v91, v39, v58
    s_lshr_b32 m0, s29, 16
    v_fmac_f32 v88, v40, v59
    v_fmac_f32 v89, v41, v59
    v_fmac_f32 v90, v42, v59
    v_fmac_f32 v91, v43, v59
    s_or_b32 m0, s42, s35
    v_mfma_f32_32x32x16_bf16 v[44:59], v[60:63], v[68:71], 0
    v_mfma_f32_32x32x16_bf16 v[44:59], v[64:67], v[72:75], v[44:59]
    s_waitcnt lgkmcnt(2)
    buffer_load_dwordx4 v[4:5], s[4:7], 0 idxen offen lds
    s_or_b32 m0, s43, s35
    s_waitcnt lgkmcnt(0)
    buffer_load_dwordx4 v[6:7], s[4:7], 0 idxen offen lds
    s_sub_u32 s19, s19, 1
    s_cbranch_scc1 mn_st3
mn_st3_back:
    v_mfma_f32_4x4x4_16b_bf16 v[28:31], v[14:15], v[20:21], 0 cbsz:4 abid:0
    v_mfma_f32_4x4x4_16b_bf16 v[32:35], v[14:15], v[22:23], 0 cbsz:4 abid:1
    v_mfma_f32_4x4x4_16b_bf16 v[36:39], v[14:15], v[24:25], 0 cbsz:4 abid:2
    v_mfma_f32_4x4x4_16b_bf16 v[40:43], v[14:15], v[26:27], 0 cbsz:4 abid:3
    ds_read_u16 v4, v2 offset:640
    ds_read_u16 v6, v2 offset:648
    v_readlane_b32 s28, v19, 1
    v_readlane_b32 s29, v19, 9
    s_waitcnt vmcnt(5)
    ds_read_b64_tr_b16 v[20:21], v1 offset:4096
    ds_read_b64_tr_b16 v[22:23], v1 offset:4608
    s_waitcnt vmcnt(4)
    ds_read_b64_tr_b16 v[24:25], v1 offset:5120
    ds_read_b64_tr_b16 v[26:27], v1 offset:5632
    s_sub_u32 s34, s34, 1
    s_cmov_b32 s35, 0x30000
    s_mov_b32 m0, s28
    v_fmac_f32 v88, v28, v44
    v_fmac_f32 v89, v29, v44
    v_fmac_f32 v90, v30, v44
    v_fmac_f32 v91, v31, v44
    s_lshr_b32 m0, s28, 16
    v_fmac_f32 v88, v32, v45
    v_fmac_f32 v89, v33, v45
    v_fmac_f32 v90, v34, v45
    v_fmac_f32 v91, v35, v45
    s_mov_b32 m0, s29
    v_fmac_f32 v88, v36, v46
    v_fmac_f32 v89, v37, v46
    v_fmac_f32 v90, v38, v46
    v_fmac_f32 v91, v39, v46
    s_lshr_b32 m0, s29, 16
    v_fmac_f32 v88, v40, v47
    v_fmac_f32 v89, v41, v47
    v_fmac_f32 v90, v42, v47
    v_fmac_f32 v91, v43, v47
    s_or_b32 m0, s44, s35
    s_waitcnt lgkmcnt(2)
    buffer_load_dwordx4 v[4:5], s[4:7], 0 idxen offen lds
    s_or_b32 m0, s45, s35
    s_waitcnt lgkmcnt(0)
    buffer_load_dwordx4 v[6:7], s[4:7], 0 idxen offen lds
    s_sub_u32 s19, s19, 1
    s_cbranch_scc1 mn_st4
mn_st4_back:
    v_mfma_f32_4x4x4_16b_bf16 v[28:31], v[14:15], v[20:21], 0 cbsz:4 abid:4
    v_mfma_f32_4x4x4_16b_bf16 v[32:35], v[14:15], v[22:23], 0 cbsz:4 abid:5
    v_mfma_f32_4x4x4_16b_bf16 v[36:39], v[14:15], v[24:25], 0 cbsz:4 abid:6
    v_mfma_f32_4x4x4_16b_bf16 v[40:43], v[14:15], v[26:27], 0 cbsz:4 abid:7
    ds_read_u16 v4, v2 offset:656
    ds_read_u16 v6, v2 offset:664
    v_readlane_b32 s28, v19, 17
    v_readlane_b32 s29, v19, 25
    ds_read_u16 v84, v3 offset:642
    s_waitcnt vmcnt(5)
    ds_read_b64_tr_b16 v[20:21], v1 offset:0
    ds_read_b64_tr_b16 v[22:23], v1 offset:512
    s_waitcnt vmcnt(4)
    ds_read_b64_tr_b16 v[24:25], v1 offset:1024
    ds_read_b64_tr_b16 v[26:27], v1 offset:1536
    s_sub_u32 s34, s34, 1
    s_cmov_b32 s35, 0x30000
    s_mov_b32 m0, s28
    v_fmac_f32 v88, v28, v48
    v_fmac_f32 v89, v29, v48
    v_fmac_f32 v90, v30, v48
    v_fmac_f32 v91, v31, v48
    s_lshr_b32 m0, s28, 16
    v_fmac_f32 v88, v32, v49
    v_fmac_f32 v89, v33, v49
    v_fmac_f32 v90, v34, v49
    v_fmac_f32 v91, v35, v49
    s_mov_b32 m0, s29
    v_fmac_f32 v88, v36, v50
    v_fmac_f32 v89, v37, v50
    v_fmac_f32 v90, v38, v50
    v_fmac_f32 v91, v39, v50
    s_lshr_b32 m0, s29, 16
    v_fmac_f32 v88, v40, v51
    v_fmac_f32 v89, v41, v51
    v_fmac_f32 v90, v42, v51
    v_fmac_f32 v91, v43, v51
    s_or_b32 m0, s40, s35
    s_waitcnt lgkmcnt(2)
    buffer_load_dwordx4 v[4:5], s[4:7], 0 idxen offen lds
    s_or_b32 m0, s41, s35
    s_waitcnt lgkmcnt(0)
    buffer_load_dwordx4 v[6:7], s[4:7], 0 idxen offen lds
    s_sub_u32 s19, s19, 1
    s_cbranch_scc1 mn_st5
mn_st5_back:
    v_mfma_f32_4x4x4_16b_bf16 v[28:31], v[14:15], v[20:21], 0 cbsz:4 abid:8
    v_mfma_f32_4x4x4_16b_bf16 v[32:35], v[14:15], v[22:23], 0 cbsz:4 abid:9
    v_mfma_f32_4x4x4_16b_bf16 v[36:39], v[14:15], v[24:25], 0 cbsz:4 abid:10
    v_mfma_f32_4x4x4_16b_bf16 v[40:43], v[14:15], v[26:27], 0 cbsz:4 abid:11
    ds_read_u16 v4, v2 offset:672
    ds_read_u16 v6, v2 offset:680
    v_readlane_b32 s28, v19, 33
    v_readlane_b32 s29, v19, 41
    v_lshl_add_u32 v84, v84, 4, v86
    v_xor_b32 v85, 0x40000, v84
    ds_read_b128 v[60:63], v84
    ds_read_b128 v[64:67], v85
    s_waitcnt vmcnt(5)
    ds_read_b64_tr_b16 v[20:21], v1 offset:2048
    ds_read_b64_tr_b16 v[22:23], v1 offset:2560
    s_waitcnt vmcnt(4)
    ds_read_b64_tr_b16 v[24:25], v1 offset:3072
    ds_read_b64_tr_b16 v[26:27], v1 offset:3584
    s_sub_u32 s34, s34, 1
    s_cmov_b32 s35, 0x30000
    s_mov_b32 m0, s28
    v_fmac_f32 v88, v28, v52
    v_fmac_f32 v89, v29, v52
    v_fmac_f32 v90, v30, v52
    v_fmac_f32 v91, v31, v52
    s_lshr_b32 m0, s28, 16
    v_fmac_f32 v88, v32, v53
    v_fmac_f32 v89, v33, v53
    v_fmac_f32 v90, v34, v53
    v_fmac_f32 v91, v35, v53
    s_mov_b32 m0, s29
    v_fmac_f32 v88, v36, v54
    v_fmac_f32 v89, v37, v54
    v_fmac_f32 v90, v38, v54
    v_fmac_f32 v91, v39, v54
    s_lshr_b32 m0, s29, 16
    v_fmac_f32 v88, v40, v55
    v_fmac_f32 v89, v41, v55
    v_fmac_f32 v90, v42, v55
    v_fmac_f32 v91, v43, v55
    s_or_b32 m0, s42, s35
    s_waitcnt lgkmcnt(2)
    buffer_load_dwordx4 v[4:5], s[4:7], 0 idxen offen lds
    s_or_b32 m0, s43, s35
    s_waitcnt lgkmcnt(0)
    buffer_load_dwordx4 v[6:7], s[4:7], 0 idxen offen lds
    s_sub_u32 s19, s19, 1
    s_cbranch_scc1 mn_st6
mn_st6_back:
    v_mfma_f32_4x4x4_16b_bf16 v[28:31], v[14:15], v[20:21], 0 cbsz:4 abid:12
    v_mfma_f32_4x4x4_16b_bf16 v[32:35], v[14:15], v[22:23], 0 cbsz:4 abid:13
    v_mfma_f32_4x4x4_16b_bf16 v[36:39], v[14:15], v[24:25], 0 cbsz:4 abid:14
    v_mfma_f32_4x4x4_16b_bf16 v[40:43], v[14:15], v[26:27], 0 cbsz:4 abid:15
    ds_read_u16 v4, v2 offset:688
    ds_read_u16 v6, v2 offset:696
    v_readlane_b32 s28, v19, 49
    v_readlane_b32 s29, v19, 57
    s_waitcnt vmcnt(5)
    ds_read_b64_tr_b16 v[20:21], v1 offset:4096
    ds_read_b64_tr_b16 v[22:23], v1 offset:4608
    s_waitcnt vmcnt(4)
    ds_read_b64_tr_b16 v[24:25], v1 offset:5120
    ds_read_b64_tr_b16 v[26:27], v1 offset:5632
    s_sub_u32 s34, s34, 1
    s_cmov_b32 s35, 0x30000
    s_mov_b32 m0, s28
    v_fmac_f32 v88, v28, v56
    v_fmac_f32 v89, v29, v56
    v_fmac_f32 v90, v30, v56
    v_fmac_f32 v91, v31, v56
    s_lshr_b32 m0, s28, 16
    v_fmac_f32 v88, v32, v57
    v_fmac_f32 v89, v33, v57
    v_fmac_f32 v90, v34, v57
    v_fmac_f32 v91, v35, v57
    s_mov_b32 m0, s29
    v_fmac_f32 v88, v36, v58
    v_fmac_f32 v89, v37, v58
    v_fmac_f32 v90, v38, v58
    v_fmac_f32 v91, v39, v58
    s_lshr_b32 m0, s29, 16
    v_fmac_f32 v88, v40, v59
    v_fmac_f32 v89, v41, v59
    v_fmac_f32 v90, v42, v59
    v_fmac_f32 v91, v43, v59
    s_or_b32 m0, s44, s35
    v_mfma_f32_32x32x16_bf16 v[44:59], v[60:63], v[68:71], 0
    v_mfma_f32_32x32x16_bf16 v[44:59], v[64:67], v[72:75], v[44:59]
    s_waitcnt lgkmcnt(2)
    buffer_load_dwordx4 v[4:5], s[4:7], 0 idxen offen lds
    s_or_b32 m0, s45, s35
    s_waitcnt lgkmcnt(0)
    buffer_load_dwordx4 v[6:7], s[4:7], 0 idxen offen lds
    s_sub_u32 s19, s19, 1
    s_cbranch_scc1 mn_st7
mn_st7_back:
    v_mfma_f32_4x4x4_16b_bf16 v[28:31], v[16:17], v[20:21], 0 cbsz:4 abid:0
    v_mfma_f32_4x4x4_16b_bf16 v[32:35], v[16:17], v[22:23], 0 cbsz:4 abid:1
    v_mfma_f32_4x4x4_16b_bf16 v[36:39], v[16:17], v[24:25], 0 cbsz:4 abid:2
    v_mfma_f32_4x4x4_16b_bf16 v[40:43], v[16:17], v[26:27], 0 cbsz:4 abid:3
    ds_read_u16 v4, v2 offset:704
    ds_read_u16 v6, v2 offset:712
    v_readlane_b32 s28, v19, 2
    v_readlane_b32 s29, v19, 10
    ds_read_u16 v8, v18 offset:706
    s_waitcnt vmcnt(5)
    ds_read_b64_tr_b16 v[20:21], v1 offset:0
    ds_read_b64_tr_b16 v[22:23], v1 offset:512
    s_waitcnt vmcnt(4)
    ds_read_b64_tr_b16 v[24:25], v1 offset:1024
    ds_read_b64_tr_b16 v[26:27], v1 offset:1536
    s_sub_u32 s34, s34, 1
    s_cmov_b32 s35, 0x30000
    s_mov_b32 m0, s28
    v_fmac_f32 v88, v28, v44
    v_fmac_f32 v89, v29, v44
    v_fmac_f32 v90, v30, v44
    v_fmac_f32 v91, v31, v44
    s_lshr_b32 m0, s28, 16
    v_fmac_f32 v88, v32, v45
    v_fmac_f32 v89, v33, v45
    v_fmac_f32 v90, v34, v45
    v_fmac_f32 v91, v35, v45
    s_mov_b32 m0, s29
    v_fmac_f32 v88, v36, v46
    v_fmac_f32 v89, v37, v46
    v_fmac_f32 v90, v38, v46
    v_fmac_f32 v91, v39, v46
    s_lshr_b32 m0, s29, 16
    v_fmac_f32 v88, v40, v47
    v_fmac_f32 v89, v41, v47
    v_fmac_f32 v90, v42, v47
    v_fmac_f32 v91, v43, v47
    s_or_b32 m0, s40, s35
    s_waitcnt lgkmcnt(2)
    buffer_load_dwordx4 v[4:5], s[4:7], 0 idxen offen lds
    s_or_b32 m0, s41, s35
    s_waitcnt lgkmcnt(0)
    buffer_load_dwordx4 v[6:7], s[4:7], 0 idxen offen lds
    s_sub_u32 s19, s19, 1
    s_cbranch_scc1 mn_st8
mn_st8_back:
    v_mfma_f32_4x4x4_16b_bf16 v[28:31], v[16:17], v[20:21], 0 cbsz:4 abid:4
    v_mfma_f32_4x4x4_16b_bf16 v[32:35], v[16:17], v[22:23], 0 cbsz:4 abid:5
    v_mfma_f32_4x4x4_16b_bf16 v[36:39], v[16:17], v[24:25], 0 cbsz:4 abid:6
    v_mfma_f32_4x4x4_16b_bf16 v[40:43], v[16:17], v[26:27], 0 cbsz:4 abid:7
    ds_read_u16 v4, v2 offset:720
    ds_read_u16 v6, v2 offset:728
    v_readlane_b32 s28, v19, 18
    v_readlane_b32 s29, v19, 26
    ds_read_u16 v84, v3 offset:706
    v_lshlrev_b32 v8, 4, v8
    ds_read_b128 v[8:11], v8 offset:32
    s_waitcnt vmcnt(5)
    ds_read_b64_tr_b16 v[20:21], v1 offset:2048
    ds_read_b64_tr_b16 v[22:23], v1 offset:2560
    s_waitcnt vmcnt(4)
    ds_read_b64_tr_b16 v[24:25], v1 offset:3072
    ds_read_b64_tr_b16 v[26:27], v1 offset:3584
    s_sub_u32 s34, s34, 1
    s_cmov_b32 s35, 0x30000
    s_mov_b32 m0, s28
    v_fmac_f32 v88, v28, v48
    v_fmac_f32 v89, v29, v48
    v_fmac_f32 v90, v30, v48
    v_fmac_f32 v91, v31, v48
    s_lshr_b32 m0, s28, 16
    v_fmac_f32 v88, v32, v49
    v_fmac_f32 v89, v33, v49
    v_fmac_f32 v90, v34, v49
    v_fmac_f32 v91, v35, v49
    s_mov_b32 m0, s29
    v_fmac_f32 v88, v36, v50
    v_fmac_f32 v89, v37, v50
    v_fmac_f32 v90, v38, v50
    v_fmac_f32 v91, v39, v50
    s_lshr_b32 m0, s29, 16
    v_fmac_f32 v88, v40, v51
    v_fmac_f32 v89, v41, v51
    v_fmac_f32 v90, v42, v51
    v_fmac_f32 v91, v43, v51
    s_or_b32 m0, s42, s35
    s_waitcnt lgkmcnt(2)
    buffer_load_dwordx4 v[4:5], s[4:7], 0 idxen offen lds
    s_or_b32 m0, s43, s35
    s_waitcnt lgkmcnt(0)
    buffer_load_dwordx4 v[6:7], s[4:7], 0 idxen offen lds
    s_sub_u32 s19, s19, 1
    s_cbranch_scc1 mn_st9
mn_st9_back:
    v_mfma_f32_4x4x4_16b_bf16 v[28:31], v[16:17], v[20:21], 0 cbsz:4 abid:8
    v_mfma_f32_4x4x4_16b_bf16 v[32:35], v[16:17], v[22:23], 0 cbsz:4 abid:9
    v_mfma_f32_4x4x4_16b_bf16 v[36:39], v[16:17], v[24:25], 0 cbsz:4 abid:10
    v_mfma_f32_4x4x4_16b_bf16 v[40:43], v[16:17], v[26:27], 0 cbsz:4 abid:11
    ds_read_u16 v4, v2 offset:736
    ds_read_u16 v6, v2 offset:744
    v_readlane_b32 s28, v19, 34
    v_readlane_b32 s29, v19, 42
    v_lshl_add_u32 v84, v84, 4, v86
    v_xor_b32 v85, 0x40000, v84
    ds_read_b128 v[60:63], v84
    ds_read_b128 v[64:67], v85
    s_waitcnt vmcnt(5)
    ds_read_b64_tr_b16 v[20:21], v1 offset:4096
    ds_read_b64_tr_b16 v[22:23], v1 offset:4608
    s_waitcnt vmcnt(4)
    ds_read_b64_tr_b16 v[24:25], v1 offset:5120
    ds_read_b64_tr_b16 v[26:27], v1 offset:5632
    s_sub_u32 s34, s34, 1
    s_cmov_b32 s35, 0x30000
    s_mov_b32 m0, s28
    v_fmac_f32 v88, v28, v52
    v_fmac_f32 v89, v29, v52
    v_fmac_f32 v90, v30, v52
    v_fmac_f32 v91, v31, v52
    s_lshr_b32 m0, s28, 16
    v_fmac_f32 v88, v32, v53
    v_fmac_f32 v89, v33, v53
    v_fmac_f32 v90, v34, v53
    v_fmac_f32 v91, v35, v53
    s_mov_b32 m0, s29
    v_fmac_f32 v88, v36, v54
    v_fmac_f32 v89, v37, v54
    v_fmac_f32 v90, v38, v54
    v_fmac_f32 v91, v39, v54
    s_lshr_b32 m0, s29, 16
    v_fmac_f32 v88, v40, v55
    v_fmac_f32 v89, v41, v55
    v_fmac_f32 v90, v42, v55
    v_fmac_f32 v91, v43, v55
    s_or_b32 m0, s44, s35
    s_waitcnt lgkmcnt(2)
    buffer_load_dwordx4 v[4:5], s[4:7], 0 idxen offen lds
    s_or_b32 m0, s45, s35
    s_waitcnt lgkmcnt(0)
    buffer_load_dwordx4 v[6:7], s[4:7], 0 idxen offen lds
    v_and_b32 v11, 0xff, v11
    v_or_b32 v11, 0xc000, v11
    v_lshlrev_b32 v10, 16, v11
    s_sub_u32 s19, s19, 1
    s_cbranch_scc1 mn_st10
mn_st10_back:
    v_mfma_f32_4x4x4_16b_bf16 v[28:31], v[16:17], v[20:21], 0 cbsz:4 abid:12
    v_mfma_f32_4x4x4_16b_bf16 v[32:35], v[16:17], v[22:23], 0 cbsz:4 abid:13
    v_mfma_f32_4x4x4_16b_bf16 v[36:39], v[16:17], v[24:25], 0 cbsz:4 abid:14
    v_mfma_f32_4x4x4_16b_bf16 v[40:43], v[16:17], v[26:27], 0 cbsz:4 abid:15
    ds_read_u16 v4, v2 offset:752
    ds_read_u16 v6, v2 offset:760
    v_readlane_b32 s28, v19, 50
    v_readlane_b32 s29, v19, 58
    s_waitcnt vmcnt(5)
    ds_read_b64_tr_b16 v[20:21], v1 offset:0
    ds_read_b64_tr_b16 v[22:23], v1 offset:512
    s_waitcnt vmcnt(4)
    ds_read_b64_tr_b16 v[24:25], v1 offset:1024
    ds_read_b64_tr_b16 v[26:27], v1 offset:1536
    s_sub_u32 s34, s34, 1
    s_cmov_b32 s35, 0x30000
    s_mov_b32 m0, s28
    v_fmac_f32 v88, v28, v56
    v_fmac_f32 v89, v29, v56
    v_fmac_f32 v90, v30, v56
    v_fmac_f32 v91, v31, v56
    s_lshr_b32 m0, s28, 16
    v_fmac_f32 v88, v32, v57
    v_fmac_f32 v89, v33, v57
    v_fmac_f32 v90, v34, v57
    v_fmac_f32 v91, v35, v57
    s_mov_b32 m0, s29
    v_fmac_f32 v88, v36, v58
    v_fmac_f32 v89, v37, v58
    v_fmac_f32 v90, v38, v58
    v_fmac_f32 v91, v39, v58
    s_lshr_b32 m0, s29, 16
    v_fmac_f32 v88, v40, v59
    v_fmac_f32 v89, v41, v59
    v_fmac_f32 v90, v42, v59
    v_fmac_f32 v91, v43, v59
    s_or_b32 m0, s40, s35
    v_mfma_f32_4x4x4_16b_bf16 v[28:31], v[8:9], v[76:77], 0
    v_mfma_f32_4x4x4_16b_bf16 v[32:35], v[8:9], v[78:79], 0
    v_mfma_f32_4x4x4_16b_bf16 v[36:39], v[8:9], v[80:81], 0
    v_mfma_f32_4x4x4_16b_bf16 v[40:43], v[8:9], v[82:83], 0
    v_mfma_f32_32x32x16_bf16 v[44:59], v[60:63], v[68:71], 0
    v_mfma_f32_32x32x16_bf16 v[44:59], v[64:67], v[72:75], v[44:59]
    s_waitcnt lgkmcnt(2)
    buffer_load_dwordx4 v[4:5], s[4:7], 0 idxen offen lds
    s_or_b32 m0, s41, s35
    s_waitcnt lgkmcnt(0)
    buffer_load_dwordx4 v[6:7], s[4:7], 0 idxen offen lds
    v_cvt_pk_bf16_f32 v12, v28, v32
    v_cvt_pk_bf16_f32 v14, v29, v33
    v_cvt_pk_bf16_f32 v16, v30, v34
    v_cvt_pk_bf16_f32 v13, v36, v40
    v_cvt_pk_bf16_f32 v15, v37, v41
    v_cvt_pk_bf16_f32 v17, v38, v42
    v_or_b32_dpp v19, v10, v11 row_shl:4 row_mask:0xf bank_mask:0xf bound_ctrl:0
    v_add_u32 v2, 192, v2
    v_add_u32 v3, 192, v3
    v_add_u32 v18, 192, v18
    s_sub_u32 s19, s19, 1
    s_cbranch_scc1 mn_st11
mn_st11_back:
    s_branch mn_loop
mn_st0:
    s_cmp_lg_u32 s21, 0
    s_cbranch_scc1 mn_next
    s_call_b64 s[48:49], mn_flush
    s_branch mn_st0_back
mn_st1:
    s_cmp_lg_u32 s21, 0
    s_cbranch_scc1 mn_next
    s_call_b64 s[48:49], mn_flush
    s_branch mn_st1_back
mn_st2:
    s_cmp_lg_u32 s21, 0
    s_cbranch_scc1 mn_next
    s_call_b64 s[48:49], mn_flush
    s_branch mn_st2_back
mn_st3:
    s_cmp_lg_u32 s21, 0
    s_cbranch_scc1 mn_next
    s_call_b64 s[48:49], mn_flush
    s_branch mn_st3_back
mn_st4:
    s_cmp_lg_u32 s21, 0
    s_cbranch_scc1 mn_next
    s_call_b64 s[48:49], mn_flush
    s_branch mn_st4_back
mn_st5:
    s_cmp_lg_u32 s21, 0
    s_cbranch_scc1 mn_next
    s_call_b64 s[48:49], mn_flush
    s_branch mn_st5_back
mn_st6:
    s_cmp_lg_u32 s21, 0
    s_cbranch_scc1 mn_next
    s_call_b64 s[48:49], mn_flush
    s_branch mn_st6_back
mn_st7:
    s_cmp_lg_u32 s21, 0
    s_cbranch_scc1 mn_next
    s_call_b64 s[48:49], mn_flush
    s_branch mn_st7_back
mn_st8:
    s_cmp_lg_u32 s21, 0
    s_cbranch_scc1 mn_next
    s_call_b64 s[48:49], mn_flush
    s_branch mn_st8_back
mn_st9:
    s_cmp_lg_u32 s21, 0
    s_cbranch_scc1 mn_next
    s_call_b64 s[48:49], mn_flush
    s_branch mn_st9_back
mn_st10:
    s_cmp_lg_u32 s21, 0
    s_cbranch_scc1 mn_next
    s_call_b64 s[48:49], mn_flush
    s_branch mn_st10_back
mn_st11:
    s_cmp_lg_u32 s21, 0
    s_cbranch_scc1 mn_next
    s_call_b64 s[48:49], mn_flush
    s_branch mn_st11_back
mn_st12:
    s_cmp_lg_u32 s21, 0
    s_cbranch_scc1 mn_next
    s_call_b64 s[48:49], mn_flush
    s_branch mn_st12_back
mn_flush:
    s_cmp_eq_u32 s58, 4
    s_cbranch_scc1 mn_fl4
    s_cmp_eq_u32 s58, 3
    s_cbranch_scc1 mn_fl3
    s_cmp_eq_u32 s58, 2
    s_cbranch_scc1 mn_fl2
    s_cmp_eq_u32 s58, 1
    s_cbranch_scc1 mn_fl1
mn_fl0:
    v_cvt_pk_bf16_f32 v88, v88, v89
    v_cvt_pk_bf16_f32 v89, v90, v91
    ds_write_b64 v87, v[88:89] offset:0
    v_cvt_pk_bf16_f32 v92, v92, v93
    v_cvt_pk_bf16_f32 v93, v94, v95
    ds_write_b64 v87, v[92:93] offset:576
    v_cvt_pk_bf16_f32 v96, v96, v97
    v_cvt_pk_bf16_f32 v97, v98, v99
    ds_write_b64 v87, v[96:97] offset:1152
    v_cvt_pk_bf16_f32 v100, v100, v101
    v_cvt_pk_bf16_f32 v101, v102, v103
    ds_write_b64 v87, v[100:101] offset:1728
    s_mul_i32 s52, s18, 3
    s_lshl_b32 s52, 1, s52
    v_mov_b32 v90, s52
    v_mov_b32 v91, 0
    s_mov_b64 exec, 1
    ds_add_u32 v91, v90 offset:276
    s_mov_b64 exec, -1
    s_add_u32 s58, s58, 1
    s_sub_u32 s19, s85, 1
    s_cbranch_scc1 mn_fl1
    s_setpc_b64 s[48:49]
mn_fl1:
    v_cvt_pk_bf16_f32 v104, v104, v105
    v_cvt_pk_bf16_f32 v105, v106, v107
    ds_write_b64 v87, v[104:105] offset:2304
    v_cvt_pk_bf16_f32 v108, v108, v109
    v_cvt_pk_bf16_f32 v109, v110, v111
    ds_write_b64 v87, v[108:109] offset:2880
    v_cvt_pk_bf16_f32 v112, v112, v113
    v_cvt_pk_bf16_f32 v113, v114, v115
    ds_write_b64 v87, v[112:113] offset:3456
    v_cvt_pk_bf16_f32 v116, v116, v117
    v_cvt_pk_bf16_f32 v117, v118, v119
    ds_write_b64 v87, v[116:117] offset:4032
    s_mul_i32 s52, s18, 3
    s_lshl_b32 s52, 64, s52
    v_mov_b32 v106, s52
    v_mov_b32 v107, 0
    s_mov_b64 exec, 1
    ds_add_u32 v107, v106 offset:276
    s_mov_b64 exec, -1
    s_add_u32 s58, s58, 1
    s_sub_u32 s19, s86, 1
    s_cbranch_scc1 mn_fl2
    s_setpc_b64 s[48:49]
mn_fl2:
    v_cvt_pk_bf16_f32 v120, v120, v121
    v_cvt_pk_bf16_f32 v121, v122, v123
    ds_write_b64 v87, v[120:121] offset:4608
    v_cvt_pk_bf16_f32 v124, v124, v125
    v_cvt_pk_bf16_f32 v125, v126, v127
    ds_write_b64 v87, v[124:125] offset:5184
    v_cvt_pk_bf16_f32 v128, v128, v129
    v_cvt_pk_bf16_f32 v129, v130, v131
    ds_write_b64 v87, v[128:129] offset:5760
    v_cvt_pk_bf16_f32 v132, v132, v133
    v_cvt_pk_bf16_f32 v133, v134, v135
    ds_write_b64 v87, v[132:133] offset:6336
    s_mul_i32 s52, s18, 3
    s_lshl_b32 s52, 4096, s52
    v_mov_b32 v122, s52
    v_mov_b32 v123, 0
    s_mov_b64 exec, 1
    ds_add_u32 v123, v122 offset:276
    s_mov_b64 exec, -1
    s_add_u32 s58, s58, 1
    s_sub_u32 s19, s87, 1
    s_cbranch_scc1 mn_fl3
    s_setpc_b64 s[48:49]
mn_fl3:
    v_cvt_pk_bf16_f32 v136, v136, v137
    v_cvt_pk_bf16_f32 v137, v138, v139
    ds_write_b64 v87, v[136:137] offset:6912
    v_cvt_pk_bf16_f32 v140, v140, v141
    v_cvt_pk_bf16_f32 v141, v142, v143
    ds_write_b64 v87, v[140:141] offset:7488
    v_cvt_pk_bf16_f32 v144, v144, v145
    v_cvt_pk_bf16_f32 v145, v146, v147
    ds_write_b64 v87, v[144:145] offset:8064
    v_cvt_pk_bf16_f32 v148, v148, v149
    v_cvt_pk_bf16_f32 v149, v150, v151
    ds_write_b64 v87, v[148:149] offset:8640
    s_mul_i32 s52, s18, 3
    s_lshl_b32 s52, 262144, s52
    v_mov_b32 v138, s52
    v_mov_b32 v139, 0
    s_mov_b64 exec, 1
    ds_add_u32 v139, v138 offset:276
    s_mov_b64 exec, -1
    s_add_u32 s58, s58, 1
    s_sub_u32 s19, s88, 1
    s_cbranch_scc1 mn_fl4
    s_setpc_b64 s[48:49]
mn_fl4:
    s_cmp_ge_u32 s59, 4
    s_cbranch_scc1 mn_fl4b
    s_waitcnt vmcnt(0)
mn_fl4b:
    v_cvt_pk_bf16_f32 v152, v152, v153
    v_cvt_pk_bf16_f32 v153, v154, v155
    ds_write_b64 v87, v[152:153] offset:9216
    v_cvt_pk_bf16_f32 v156, v156, v157
    v_cvt_pk_bf16_f32 v157, v158, v159
    ds_write_b64 v87, v[156:157] offset:9792
    v_cvt_pk_bf16_f32 v160, v160, v161
    v_cvt_pk_bf16_f32 v161, v162, v163
    ds_write_b64 v87, v[160:161] offset:10368
    v_cvt_pk_bf16_f32 v164, v164, v165
    v_cvt_pk_bf16_f32 v165, v166, v167
    ds_write_b64 v87, v[164:165] offset:10944
    s_mul_i32 s52, s18, 3
    s_lshl_b32 s52, 16777216, s52
    v_mov_b32 v154, s52
    v_mov_b32 v155, 0
    s_mov_b64 exec, 1
    ds_add_u32 v155, v154 offset:276
    s_mov_b64 exec, -1
    s_waitcnt vmcnt(0) lgkmcnt(0)
mn_end:
    s_endpgm
gm_touch:
    s_lshl2_add_u32 s47, s47, s17
    s_mul_i32 s47, s47, 61440
    s_mul_i32 s48, s48, 7680
    s_add_u32 s47, s47, s48
    s_sub_i32 s47, s47, 256
    s_max_i32 s47, s47, 0
    v_lshlrev_b32 v56, 7, v46
    buffer_load_dword v84, v56, s[8:11], s47 offen
    s_branch gm_touch_back
gm_pre:
    v_and_b32 v2, 0xff, v0
    v_add_u32 v3, 0, v2
    v_mul_u32_u24 v88, 21846, v3
    v_lshrrev_b32 v88, 16, v88
    v_lshlrev_b32 v120, 2, v88
    v_mad_i32_i24 v88, v88, -3, v3
    v_lshlrev_b32 v88, 4, v88
    v_add_u32 v3, 256, v2
    v_mul_u32_u24 v89, 21846, v3
    v_lshrrev_b32 v89, 16, v89
    v_lshlrev_b32 v121, 2, v89
    v_mad_i32_i24 v89, v89, -3, v3
    v_lshlrev_b32 v89, 4, v89
    v_add_u32 v3, 512, v2
    v_mul_u32_u24 v90, 21846, v3
    v_lshrrev_b32 v90, 16, v90
    v_lshlrev_b32 v122, 2, v90
    v_mad_i32_i24 v90, v90, -3, v3
    v_lshlrev_b32 v90, 4, v90
    v_add_u32 v3, 768, v2
    v_mul_u32_u24 v91, 21846, v3
    v_lshrrev_b32 v91, 16, v91
    v_lshlrev_b32 v123, 2, v91
    v_mad_i32_i24 v91, v91, -3, v3
    v_lshlrev_b32 v91, 4, v91
    v_add_u32 v3, 1024, v2
    v_mul_u32_u24 v92, 21846, v3
    v_lshrrev_b32 v92, 16, v92
    v_lshlrev_b32 v124, 2, v92
    v_mad_i32_i24 v92, v92, -3, v3
    v_lshlrev_b32 v92, 4, v92
    v_add_u32 v3, 1280, v2
    v_mul_u32_u24 v93, 21846, v3
    v_lshrrev_b32 v93, 16, v93
    v_lshlrev_b32 v125, 2, v93
    v_mad_i32_i24 v93, v93, -3, v3
    v_lshlrev_b32 v93, 4, v93
    v_add_u32 v3, 1536, v2
    v_mul_u32_u24 v94, 21846, v3
    v_lshrrev_b32 v94, 16, v94
    v_lshlrev_b32 v126, 2, v94
    v_mad_i32_i24 v94, v94, -3, v3
    v_lshlrev_b32 v94, 4, v94
    v_add_u32 v3, 1792, v2
    v_mul_u32_u24 v95, 21846, v3
    v_lshrrev_b32 v95, 16, v95
    v_lshlrev_b32 v127, 2, v95
    v_mad_i32_i24 v95, v95, -3, v3
    v_lshlrev_b32 v95, 4, v95
    v_add_u32 v3, 2048, v2
    v_mul_u32_u24 v96, 21846, v3
    v_lshrrev_b32 v96, 16, v96
    v_lshlrev_b32 v128, 2, v96
    v_mad_i32_i24 v96, v96, -3, v3
    v_lshlrev_b32 v96, 4, v96
    v_add_u32 v3, 2304, v2
    v_mul_u32_u24 v97, 21846, v3
    v_lshrrev_b32 v97, 16, v97
    v_lshlrev_b32 v129, 2, v97
    v_mad_i32_i24 v97, v97, -3, v3
    v_lshlrev_b32 v97, 4, v97
    s_waitcnt vmcnt(1)
    s_branch mn_cbar
gm_raw:
    v_mov_b32 v1, 0
    ds_read_b32 v1, v1 offset:280
    ds_read_b32 v104, v120 offset:41984
    ds_read_b32 v105, v121 offset:41984
    ds_read_b32 v106, v122 offset:41984
    ds_read_b32 v107, v123 offset:41984
    ds_read_b32 v108, v124 offset:41984
    ds_read_b32 v109, v125 offset:41984
    ds_read_b32 v110, v126 offset:41984
    ds_read_b32 v111, v127 offset:41984
    ds_read_b32 v112, v128 offset:41984
    ds_read_b32 v113, v129 offset:41984
    s_lshl_b32 s36, s17, 6
    s_lshl_b32 s37, s17, 10
    s_add_u32 m0, s37, 3776
    s_waitcnt lgkmcnt(10)
    v_readfirstlane_b32 s37, v1
    s_min_u32 s37, s37, 774
    s_mul_i32 s37, s37, 3
    s_cmp_ge_u32 s36, s37
    s_cbranch_scc1 gm_raw_back
    s_waitcnt lgkmcnt(9)
    v_add_u32 v104, v88, v104
    buffer_load_dwordx4 v104, s[8:11], 0 offen lds
    s_add_u32 m0, m0, 4096
    s_addk_i32 s36, 256
    s_cmp_ge_u32 s36, s37
    s_cbranch_scc1 gm_raw_back
    s_waitcnt lgkmcnt(8)
    v_add_u32 v105, v89, v105
    buffer_load_dwordx4 v105, s[8:11], 0 offen lds
    s_add_u32 m0, m0, 4096
    s_addk_i32 s36, 256
    s_cmp_ge_u32 s36, s37
    s_cbranch_scc1 gm_raw_back
    s_waitcnt lgkmcnt(7)
    v_add_u32 v106, v90, v106
    buffer_load_dwordx4 v106, s[8:11], 0 offen lds
    s_add_u32 m0, m0, 4096
    s_addk_i32 s36, 256
    s_cmp_ge_u32 s36, s37
    s_cbranch_scc1 gm_raw_back
    s_waitcnt lgkmcnt(6)
    v_add_u32 v107, v91, v107
    buffer_load_dwordx4 v107, s[8:11], 0 offen lds
    s_add_u32 m0, m0, 4096
    s_addk_i32 s36, 256
    s_cmp_ge_u32 s36, s37
    s_cbranch_scc1 gm_raw_back
    s_waitcnt lgkmcnt(5)
    v_add_u32 v108, v92, v108
    buffer_load_dwordx4 v108, s[8:11], 0 offen lds
    s_add_u32 m0, m0, 4096
    s_addk_i32 s36, 256
    s_cmp_ge_u32 s36, s37
    s_cbranch_scc1 gm_raw_back
    s_waitcnt lgkmcnt(4)
    v_add_u32 v109, v93, v109
    buffer_load_dwordx4 v109, s[8:11], 0 offen lds
    s_add_u32 m0, m0, 4096
    s_addk_i32 s36, 256
    s_cmp_ge_u32 s36, s37
    s_cbranch_scc1 gm_raw_back
    s_waitcnt lgkmcnt(3)
    v_add_u32 v110, v94, v110
    buffer_load_dwordx4 v110, s[8:11], 0 offen lds
    s_add_u32 m0, m0, 4096
    s_addk_i32 s36, 256
    s_cmp_ge_u32 s36, s37
    s_cbranch_scc1 gm_raw_back
    s_waitcnt lgkmcnt(2)
    v_add_u32 v111, v95, v111
    buffer_load_dwordx4 v111, s[8:11], 0 offen lds
    s_add_u32 m0, m0, 4096
    s_addk_i32 s36, 256
    s_cmp_ge_u32 s36, s37
    s_cbranch_scc1 gm_raw_back
    s_waitcnt lgkmcnt(1)
    v_add_u32 v112, v96, v112
    buffer_load_dwordx4 v112, s[8:11], 0 offen lds
    s_add_u32 m0, m0, 4096
    s_addk_i32 s36, 256
    s_cmp_ge_u32 s36, s37
    s_cbranch_scc1 gm_raw_back
    s_waitcnt lgkmcnt(0)
    v_add_u32 v113, v97, v113
    buffer_load_dwordx4 v113, s[8:11], 0 offen lds
    s_add_u32 m0, m0, 4096
    s_addk_i32 s36, 256
    s_branch gm_raw_back
gm_start:
    s_waitcnt vmcnt(0)
    s_barrier
    s_cmp_lg_u32 s21, 0
    s_cbranch_scc1 mn_next
    s_lshr_b32 s52, s2, 3
    s_lshl2_add_u32 s52, s52, s17
    s_lshl_b32 s52, s52, 3
    s_and_b32 s53, s2, 7
    s_mul_i32 s53, s53, 20000
    s_add_u32 s52, s52, s53
    s_add_u32 s52, s52, 10240
    s_movk_i32 s53, 10
gm_pf:
    s_min_u32 s36, s52, 159992
    s_lshl_b32 s36, s36, 7
    s_load_dword s37, s[50:51], s36 offset:0
    s_load_dword s37, s[50:51], s36 offset:64
    s_load_dword s37, s[50:51], s36 offset:128
    s_load_dword s37, s[50:51], s36 offset:192
    s_load_dword s37, s[50:51], s36 offset:256
    s_load_dword s37, s[50:51], s36 offset:320
    s_load_dword s37, s[50:51], s36 offset:384
    s_load_dword s37, s[50:51], s36 offset:448
    s_load_dword s37, s[50:51], s36 offset:512
    s_load_dword s37, s[50:51], s36 offset:576
    s_load_dword s37, s[50:51], s36 offset:640
    s_load_dword s37, s[50:51], s36 offset:704
    s_load_dword s37, s[50:51], s36 offset:768
    s_load_dword s37, s[50:51], s36 offset:832
    s_load_dword s37, s[50:51], s36 offset:896
    s_load_dword s37, s[50:51], s36 offset:960
    s_addk_i32 s52, 1024
    s_sub_u32 s53, s53, 1
    s_cmp_lg_u32 s53, 0
    s_cbranch_scc1 gm_pf
gm_warm_back:
    v_and_b32 v3, 63, v0
    v_lshlrev_b32 v2, 4, v3
    s_lshl_b32 s52, s17, 15
    s_add_u32 s52, s52, 11534336
    buffer_load_dwordx4 v[40:43], v2, s[8:11], s52 offen offset:0
    buffer_load_dwordx4 v[44:47], v2, s[8:11], s52 offen offset:1024
    s_waitcnt vmcnt(1)
    buffer_load_dwordx4 v[48:51], v2, s[8:11], s52 offen offset:2048
    s_waitcnt vmcnt(1)
    buffer_load_dwordx4 v[52:55], v2, s[8:11], s52 offen offset:3072
    s_waitcnt vmcnt(1)
    s_addk_i32 s52, 4096
    buffer_load_dwordx4 v[56:59], v2, s[8:11], s52 offen offset:0
    s_waitcnt vmcnt(1)
    buffer_load_dwordx4 v[60:63], v2, s[8:11], s52 offen offset:1024
    s_waitcnt vmcnt(1)
    buffer_load_dwordx4 v[64:67], v2, s[8:11], s52 offen offset:2048
    s_waitcnt vmcnt(1)
    buffer_load_dwordx4 v[68:71], v2, s[8:11], s52 offen offset:3072
    s_waitcnt vmcnt(1)
    s_addk_i32 s52, 4096
    buffer_load_dwordx4 v[72:75], v2, s[8:11], s52 offen offset:0
    s_waitcnt vmcnt(1)
    buffer_load_dwordx4 v[76:79], v2, s[8:11], s52 offen offset:1024
    s_waitcnt vmcnt(1)
    buffer_load_dwordx4 v[80:83], v2, s[8:11], s52 offen offset:2048
    s_waitcnt vmcnt(1)
    buffer_load_dwordx4 v[84:87], v2, s[8:11], s52 offen offset:3072
    s_waitcnt vmcnt(1)
    s_addk_i32 s52, 4096
    buffer_load_dwordx4 v[88:91], v2, s[8:11], s52 offen offset:0
    s_waitcnt vmcnt(1)
    buffer_load_dwordx4 v[92:95], v2, s[8:11], s52 offen offset:1024
    s_waitcnt vmcnt(1)
    buffer_load_dwordx4 v[96:99], v2, s[8:11], s52 offen offset:2048
    s_waitcnt vmcnt(1)
    buffer_load_dwordx4 v[100:103], v2, s[8:11], s52 offen offset:3072
    s_waitcnt vmcnt(1)
    s_addk_i32 s52, 4096
    buffer_load_dwordx4 v[104:107], v2, s[8:11], s52 offen offset:0
    s_waitcnt vmcnt(1)
    buffer_load_dwordx4 v[108:111], v2, s[8:11], s52 offen offset:1024
    s_waitcnt vmcnt(1)
    buffer_load_dwordx4 v[112:115], v2, s[8:11], s52 offen offset:2048
    s_waitcnt vmcnt(1)
    buffer_load_dwordx4 v[116:119], v2, s[8:11], s52 offen offset:3072
    s_waitcnt vmcnt(1)
    s_addk_i32 s52, 4096
    buffer_load_dwordx4 v[120:123], v2, s[8:11], s52 offen offset:0
    s_waitcnt vmcnt(1)
    buffer_load_dwordx4 v[124:127], v2, s[8:11], s52 offen offset:1024
    s_waitcnt vmcnt(1)
    buffer_load_dwordx4 v[128:131], v2, s[8:11], s52 offen offset:2048
    s_waitcnt vmcnt(1)
    buffer_load_dwordx4 v[132:135], v2, s[8:11], s52 offen offset:3072
    s_waitcnt vmcnt(1)
    s_addk_i32 s52, 4096
    buffer_load_dwordx4 v[136:139], v2, s[8:11], s52 offen offset:0
    s_waitcnt vmcnt(1)
    buffer_load_dwordx4 v[140:143], v2, s[8:11], s52 offen offset:1024
    s_waitcnt vmcnt(1)
    buffer_load_dwordx4 v[144:147], v2, s[8:11], s52 offen offset:2048
    s_waitcnt vmcnt(1)
    buffer_load_dwordx4 v[148:151], v2, s[8:11], s52 offen offset:3072
    s_waitcnt vmcnt(1)
    s_addk_i32 s52, 4096
    buffer_load_dwordx4 v[152:155], v2, s[8:11], s52 offen offset:0
    s_waitcnt vmcnt(1)
    buffer_load_dwordx4 v[156:159], v2, s[8:11], s52 offen offset:1024
    s_waitcnt vmcnt(1)
    buffer_load_dwordx4 v[160:163], v2, s[8:11], s52 offen offset:2048
    s_waitcnt vmcnt(1)
    buffer_load_dwordx4 v[164:167], v2, s[8:11], s52 offen offset:3072
    s_waitcnt vmcnt(1)
    v_lshrrev_b32 v1, 4, v3
    v_lshlrev_b32 v1, 11, v1
    v_and_b32 v4, 7, v3
    v_lshl_add_u32 v1, v4, 4, v1
    v_bfe_u32 v4, v3, 3, 1
    v_lshl_add_u32 v1, v4, 9, v1
    v_and_b32 v4, 3, v3
    v_lshrrev_b32 v5, 2, v3
    v_mul_u32_u24 v0, 576, v4
    v_lshl_add_u32 v0, v5, 3, v0
    v_add_u32 v0, 40960, v0
    s_lshl_b32 s38, s22, 11
    s_lshl_b32 s53, s17, 7
    s_add_u32 s38, s38, s53
    s_mov_b32 s36, 0x24924924
    s_mov_b32 s39, 0
    s_waitcnt vmcnt(0)
gm_poll:
    v_mov_b32 v2, 0
    ds_read_b32 v2, v2 offset:276
    s_waitcnt lgkmcnt(0)
    v_readfirstlane_b32 s52, v2
    s_and_b32 s52, s52, s36
    s_cbranch_scc1 gm_go
    s_sleep 2
    s_branch gm_poll
gm_go:
    s_ff1_i32_b32 s52, s52
    s_bitset0_b32 s36, s52
    s_mul_i32 s52, s52, 11
    s_bfe_u32 s53, s52, 0x10005
    s_bfe_u32 s52, s52, 0x30006
    s_mul_i32 s33, s53, 5
    s_add_u32 s33, s33, s52
    s_lshl_b32 s33, s33, 13
    s_add_u32 s33, s33, s38
    s_mul_i32 s53, s53, 61440
    s_mul_i32 s52, s52, 2304
    s_add_u32 s52, s52, s53
    s_sub_u32 s53, s52, s39
    s_mov_b32 s39, s52
    v_add_u32 v0, s53, v0
    ds_read_b64_tr_b16 v[12:13], v0 offset:0
    ds_read_b64_tr_b16 v[14:15], v0 offset:128
    ds_read_b64_tr_b16 v[16:17], v0 offset:256
    ds_read_b64_tr_b16 v[18:19], v0 offset:384
    s_mov_b32 s37, s33
    s_mov_b32 s32, 0x7ffffff0
gm_loop:
    s_waitcnt lgkmcnt(2)
    v_mfma_f32_16x16x32_bf16 v[24:27], v[12:15], v[40:43], 0
    v_cvt_pk_bf16_f32 v7, v33, v37
    v_cvt_pk_bf16_f32 v5, v32, v36
    ds_read_b64_tr_b16 v[20:21], v0 offset:15360
    v_mfma_f32_16x16x32_bf16 v[28:31], v[12:15], v[44:47], 0
    v_cvt_pk_bf16_f32 v11, v35, v39
    v_cvt_pk_bf16_f32 v9, v34, v38
    ds_read_b64_tr_b16 v[22:23], v0 offset:15488
    v_mfma_f32_16x16x32_bf16 v[32:35], v[12:15], v[48:51], 0
    v_mov_b32_dpp v2, v6 row_ror:8 row_mask:0xf bank_mask:0xf
    v_mov_b32_dpp v3, v7 row_ror:8 row_mask:0xf bank_mask:0xf
    v_mfma_f32_16x16x32_bf16 v[36:39], v[12:15], v[52:55], 0
    v_mov_b32_dpp v6, v4 row_ror:8 row_mask:0xf bank_mask:0x3
    v_mov_b32_dpp v7, v5 row_ror:8 row_mask:0xf bank_mask:0x3
    s_waitcnt lgkmcnt(2)
    v_mfma_f32_16x16x32_bf16 v[24:27], v[16:19], v[56:59], v[24:27]
    ds_read_b64_tr_b16 v[12:13], v0 offset:15616
    v_mov_b32_dpp v4, v2 quad_perm:[0,1,2,3] row_mask:0xf bank_mask:0xc
    v_mfma_f32_16x16x32_bf16 v[28:31], v[16:19], v[60:63], v[28:31]
    ds_read_b64_tr_b16 v[14:15], v0 offset:15744
    v_mov_b32_dpp v5, v3 quad_perm:[0,1,2,3] row_mask:0xf bank_mask:0xc
    v_mfma_f32_16x16x32_bf16 v[32:35], v[16:19], v[64:67], v[32:35]
    buffer_store_dwordx4 v[4:7], v1, s[12:15], s32 offen offset:0 sc0 sc1
    v_mov_b32_dpp v2, v10 row_ror:8 row_mask:0xf bank_mask:0xf
    v_mfma_f32_16x16x32_bf16 v[36:39], v[16:19], v[68:71], v[36:39]
    v_mov_b32_dpp v3, v11 row_ror:8 row_mask:0xf bank_mask:0xf
    v_mov_b32_dpp v10, v8 row_ror:8 row_mask:0xf bank_mask:0x3
    s_waitcnt lgkmcnt(2)
    v_mfma_f32_16x16x32_bf16 v[24:27], v[20:23], v[72:75], v[24:27]
    ds_read_b64_tr_b16 v[16:17], v0 offset:30720
    v_mov_b32_dpp v11, v9 row_ror:8 row_mask:0xf bank_mask:0x3
    v_mfma_f32_16x16x32_bf16 v[28:31], v[20:23], v[76:79], v[28:31]
    ds_read_b64_tr_b16 v[18:19], v0 offset:30848
    v_mov_b32_dpp v8, v2 quad_perm:[0,1,2,3] row_mask:0xf bank_mask:0xc
    v_mfma_f32_16x16x32_bf16 v[32:35], v[20:23], v[80:83], v[32:35]
    v_mov_b32_dpp v9, v3 quad_perm:[0,1,2,3] row_mask:0xf bank_mask:0xc
    buffer_store_dwordx4 v[8:11], v1, s[12:15], s32 offen offset:1024 sc0 sc1
    v_mfma_f32_16x16x32_bf16 v[36:39], v[20:23], v[84:87], v[36:39]
    s_waitcnt lgkmcnt(2)
    v_mfma_f32_16x16x32_bf16 v[24:27], v[12:15], v[88:91], v[24:27]
    ds_read_b64_tr_b16 v[20:21], v0 offset:30976
    v_mfma_f32_16x16x32_bf16 v[28:31], v[12:15], v[92:95], v[28:31]
    ds_read_b64_tr_b16 v[22:23], v0 offset:31104
    v_mfma_f32_16x16x32_bf16 v[32:35], v[12:15], v[96:99], v[32:35]
    v_mov_b32 v2, 0
    v_mfma_f32_16x16x32_bf16 v[36:39], v[12:15], v[100:103], v[36:39]
    ds_read_b32 v2, v2 offset:276
    s_waitcnt lgkmcnt(3)
    v_mfma_f32_16x16x32_bf16 v[24:27], v[16:19], v[104:107], v[24:27]
    ds_read_b64_tr_b16 v[12:13], v0 offset:46080
    v_mfma_f32_16x16x32_bf16 v[28:31], v[16:19], v[108:111], v[28:31]
    ds_read_b64_tr_b16 v[14:15], v0 offset:46208
    v_mfma_f32_16x16x32_bf16 v[32:35], v[16:19], v[112:115], v[32:35]
    s_waitcnt lgkmcnt(2)
    v_readfirstlane_b32 s52, v2
    s_and_b32 s52, s52, s36
    v_mfma_f32_16x16x32_bf16 v[36:39], v[16:19], v[116:119], v[36:39]
    s_cselect_b32 s34, 1, 0
    s_ff1_i32_b32 s52, s52
    s_waitcnt lgkmcnt(2)
    v_mfma_f32_16x16x32_bf16 v[24:27], v[20:23], v[120:123], v[24:27]
    ds_read_b64_tr_b16 v[16:17], v0 offset:46336
    s_bitset0_b32 s36, s52
    s_mul_i32 s52, s52, 11
    v_mfma_f32_16x16x32_bf16 v[28:31], v[20:23], v[124:127], v[28:31]
    ds_read_b64_tr_b16 v[18:19], v0 offset:46464
    s_bfe_u32 s53, s52, 0x10005
    s_bfe_u32 s52, s52, 0x30006
    v_mfma_f32_16x16x32_bf16 v[32:35], v[20:23], v[128:131], v[32:35]
    s_mul_i32 s35, s53, 61440
    s_mul_i32 s31, s52, 2304
    s_add_u32 s31, s31, s35
    v_mfma_f32_16x16x32_bf16 v[36:39], v[20:23], v[132:135], v[36:39]
    s_sub_u32 s35, s31, s39
    v_add_u32 v0, s35, v0
    s_waitcnt lgkmcnt(2)
    v_mfma_f32_16x16x32_bf16 v[24:27], v[12:15], v[136:139], v[24:27]
    ds_read_b64_tr_b16 v[20:21], v0 offset:0
    v_mfma_f32_16x16x32_bf16 v[28:31], v[12:15], v[140:143], v[28:31]
    ds_read_b64_tr_b16 v[22:23], v0 offset:128
    v_mfma_f32_16x16x32_bf16 v[32:35], v[12:15], v[144:147], v[32:35]
    s_mov_b32 s39, s31
    s_mul_i32 s33, s53, 5
    s_add_u32 s33, s33, s52
    v_mfma_f32_16x16x32_bf16 v[36:39], v[12:15], v[148:151], v[36:39]
    s_lshl_b32 s33, s33, 13
    s_add_u32 s33, s33, s38
    s_waitcnt lgkmcnt(2)
    v_mfma_f32_16x16x32_bf16 v[24:27], v[16:19], v[152:155], v[24:27]
    ds_read_b64_tr_b16 v[12:13], v0 offset:256
    v_mfma_f32_16x16x32_bf16 v[28:31], v[16:19], v[156:159], v[28:31]
    ds_read_b64_tr_b16 v[14:15], v0 offset:384
    s_mov_b32 s32, s37
    s_mov_b32 s37, s33
    v_mfma_f32_16x16x32_bf16 v[32:35], v[16:19], v[160:163], v[32:35]
    s_cmp_eq_u32 s34, 0
    s_nop 1
    v_mfma_f32_16x16x32_bf16 v[36:39], v[16:19], v[164:167], v[36:39]
    v_cvt_pk_bf16_f32 v4, v24, v28
    v_cvt_pk_bf16_f32 v6, v25, v29
    v_cvt_pk_bf16_f32 v8, v26, v30
    v_cvt_pk_bf16_f32 v10, v27, v31
    s_nop 0
    s_cbranch_scc1 gm_drain
    s_waitcnt lgkmcnt(2)
    v_mfma_f32_16x16x32_bf16 v[24:27], v[20:23], v[40:43], 0
    v_cvt_pk_bf16_f32 v7, v33, v37
    v_cvt_pk_bf16_f32 v5, v32, v36
    ds_read_b64_tr_b16 v[16:17], v0 offset:15360
    v_mfma_f32_16x16x32_bf16 v[28:31], v[20:23], v[44:47], 0
    v_cvt_pk_bf16_f32 v11, v35, v39
    v_cvt_pk_bf16_f32 v9, v34, v38
    ds_read_b64_tr_b16 v[18:19], v0 offset:15488
    v_mfma_f32_16x16x32_bf16 v[32:35], v[20:23], v[48:51], 0
    v_mov_b32_dpp v2, v6 row_ror:8 row_mask:0xf bank_mask:0xf
    v_mov_b32_dpp v3, v7 row_ror:8 row_mask:0xf bank_mask:0xf
    v_mfma_f32_16x16x32_bf16 v[36:39], v[20:23], v[52:55], 0
    v_mov_b32_dpp v6, v4 row_ror:8 row_mask:0xf bank_mask:0x3
    v_mov_b32_dpp v7, v5 row_ror:8 row_mask:0xf bank_mask:0x3
    s_waitcnt lgkmcnt(2)
    v_mfma_f32_16x16x32_bf16 v[24:27], v[12:15], v[56:59], v[24:27]
    ds_read_b64_tr_b16 v[20:21], v0 offset:15616
    v_mov_b32_dpp v4, v2 quad_perm:[0,1,2,3] row_mask:0xf bank_mask:0xc
    v_mfma_f32_16x16x32_bf16 v[28:31], v[12:15], v[60:63], v[28:31]
    ds_read_b64_tr_b16 v[22:23], v0 offset:15744
    v_mov_b32_dpp v5, v3 quad_perm:[0,1,2,3] row_mask:0xf bank_mask:0xc
    v_mfma_f32_16x16x32_bf16 v[32:35], v[12:15], v[64:67], v[32:35]
    buffer_store_dwordx4 v[4:7], v1, s[12:15], s32 offen offset:0 sc0 sc1
    v_mov_b32_dpp v2, v10 row_ror:8 row_mask:0xf bank_mask:0xf
    v_mfma_f32_16x16x32_bf16 v[36:39], v[12:15], v[68:71], v[36:39]
    v_mov_b32_dpp v3, v11 row_ror:8 row_mask:0xf bank_mask:0xf
    v_mov_b32_dpp v10, v8 row_ror:8 row_mask:0xf bank_mask:0x3
    s_waitcnt lgkmcnt(2)
    v_mfma_f32_16x16x32_bf16 v[24:27], v[16:19], v[72:75], v[24:27]
    ds_read_b64_tr_b16 v[12:13], v0 offset:30720
    v_mov_b32_dpp v11, v9 row_ror:8 row_mask:0xf bank_mask:0x3
    v_mfma_f32_16x16x32_bf16 v[28:31], v[16:19], v[76:79], v[28:31]
    ds_read_b64_tr_b16 v[14:15], v0 offset:30848
    v_mov_b32_dpp v8, v2 quad_perm:[0,1,2,3] row_mask:0xf bank_mask:0xc
    v_mfma_f32_16x16x32_bf16 v[32:35], v[16:19], v[80:83], v[32:35]
    v_mov_b32_dpp v9, v3 quad_perm:[0,1,2,3] row_mask:0xf bank_mask:0xc
    buffer_store_dwordx4 v[8:11], v1, s[12:15], s32 offen offset:1024 sc0 sc1
    v_mfma_f32_16x16x32_bf16 v[36:39], v[16:19], v[84:87], v[36:39]
    s_waitcnt lgkmcnt(2)
    v_mfma_f32_16x16x32_bf16 v[24:27], v[20:23], v[88:91], v[24:27]
    ds_read_b64_tr_b16 v[16:17], v0 offset:30976
    v_mfma_f32_16x16x32_bf16 v[28:31], v[20:23], v[92:95], v[28:31]
    ds_read_b64_tr_b16 v[18:19], v0 offset:31104
    v_mfma_f32_16x16x32_bf16 v[32:35], v[20:23], v[96:99], v[32:35]
    v_mov_b32 v2, 0
    v_mfma_f32_16x16x32_bf16 v[36:39], v[20:23], v[100:103], v[36:39]
    ds_read_b32 v2, v2 offset:276
    s_waitcnt lgkmcnt(3)
    v_mfma_f32_16x16x32_bf16 v[24:27], v[12:15], v[104:107], v[24:27]
    ds_read_b64_tr_b16 v[20:21], v0 offset:46080
    v_mfma_f32_16x16x32_bf16 v[28:31], v[12:15], v[108:111], v[28:31]
    ds_read_b64_tr_b16 v[22:23], v0 offset:46208
    v_mfma_f32_16x16x32_bf16 v[32:35], v[12:15], v[112:115], v[32:35]
    s_waitcnt lgkmcnt(2)
    v_readfirstlane_b32 s52, v2
    s_and_b32 s52, s52, s36
    v_mfma_f32_16x16x32_bf16 v[36:39], v[12:15], v[116:119], v[36:39]
    s_cselect_b32 s34, 1, 0
    s_ff1_i32_b32 s52, s52
    s_waitcnt lgkmcnt(2)
    v_mfma_f32_16x16x32_bf16 v[24:27], v[16:19], v[120:123], v[24:27]
    ds_read_b64_tr_b16 v[12:13], v0 offset:46336
    s_bitset0_b32 s36, s52
    s_mul_i32 s52, s52, 11
    v_mfma_f32_16x16x32_bf16 v[28:31], v[16:19], v[124:127], v[28:31]
    ds_read_b64_tr_b16 v[14:15], v0 offset:46464
    s_bfe_u32 s53, s52, 0x10005
    s_bfe_u32 s52, s52, 0x30006
    v_mfma_f32_16x16x32_bf16 v[32:35], v[16:19], v[128:131], v[32:35]
    s_mul_i32 s35, s53, 61440
    s_mul_i32 s31, s52, 2304
    s_add_u32 s31, s31, s35
    v_mfma_f32_16x16x32_bf16 v[36:39], v[16:19], v[132:135], v[36:39]
    s_sub_u32 s35, s31, s39
    v_add_u32 v0, s35, v0
    s_waitcnt lgkmcnt(2)
    v_mfma_f32_16x16x32_bf16 v[24:27], v[20:23], v[136:139], v[24:27]
    ds_read_b64_tr_b16 v[16:17], v0 offset:0
    v_mfma_f32_16x16x32_bf16 v[28:31], v[20:23], v[140:143], v[28:31]
    ds_read_b64_tr_b16 v[18:19], v0 offset:128
    v_mfma_f32_16x16x32_bf16 v[32:35], v[20:23], v[144:147], v[32:35]
    s_mov_b32 s39, s31
    s_mul_i32 s33, s53, 5
    s_add_u32 s33, s33, s52
    v_mfma_f32_16x16x32_bf16 v[36:39], v[20:23], v[148:151], v[36:39]
    s_lshl_b32 s33, s33, 13
    s_add_u32 s33, s33, s38
    s_waitcnt lgkmcnt(2)
    v_mfma_f32_16x16x32_bf16 v[24:27], v[12:15], v[152:155], v[24:27]
    ds_read_b64_tr_b16 v[20:21], v0 offset:256
    v_mfma_f32_16x16x32_bf16 v[28:31], v[12:15], v[156:159], v[28:31]
    ds_read_b64_tr_b16 v[22:23], v0 offset:384
    s_mov_b32 s32, s37
    s_mov_b32 s37, s33
    v_mfma_f32_16x16x32_bf16 v[32:35], v[12:15], v[160:163], v[32:35]
    s_cmp_eq_u32 s34, 0
    s_nop 1
    v_mfma_f32_16x16x32_bf16 v[36:39], v[12:15], v[164:167], v[36:39]
    v_cvt_pk_bf16_f32 v4, v24, v28
    v_cvt_pk_bf16_f32 v6, v25, v29
    v_cvt_pk_bf16_f32 v8, v26, v30
    v_cvt_pk_bf16_f32 v10, v27, v31
    s_nop 0
    s_cbranch_scc1 gm_drain
    s_waitcnt lgkmcnt(2)
    v_mfma_f32_16x16x32_bf16 v[24:27], v[16:19], v[40:43], 0
    v_cvt_pk_bf16_f32 v7, v33, v37
    v_cvt_pk_bf16_f32 v5, v32, v36
    ds_read_b64_tr_b16 v[12:13], v0 offset:15360
    v_mfma_f32_16x16x32_bf16 v[28:31], v[16:19], v[44:47], 0
    v_cvt_pk_bf16_f32 v11, v35, v39
    v_cvt_pk_bf16_f32 v9, v34, v38
    ds_read_b64_tr_b16 v[14:15], v0 offset:15488
    v_mfma_f32_16x16x32_bf16 v[32:35], v[16:19], v[48:51], 0
    v_mov_b32_dpp v2, v6 row_ror:8 row_mask:0xf bank_mask:0xf
    v_mov_b32_dpp v3, v7 row_ror:8 row_mask:0xf bank_mask:0xf
    v_mfma_f32_16x16x32_bf16 v[36:39], v[16:19], v[52:55], 0
    v_mov_b32_dpp v6, v4 row_ror:8 row_mask:0xf bank_mask:0x3
    v_mov_b32_dpp v7, v5 row_ror:8 row_mask:0xf bank_mask:0x3
    s_waitcnt lgkmcnt(2)
    v_mfma_f32_16x16x32_bf16 v[24:27], v[20:23], v[56:59], v[24:27]
    ds_read_b64_tr_b16 v[16:17], v0 offset:15616
    v_mov_b32_dpp v4, v2 quad_perm:[0,1,2,3] row_mask:0xf bank_mask:0xc
    v_mfma_f32_16x16x32_bf16 v[28:31], v[20:23], v[60:63], v[28:31]
    ds_read_b64_tr_b16 v[18:19], v0 offset:15744
    v_mov_b32_dpp v5, v3 quad_perm:[0,1,2,3] row_mask:0xf bank_mask:0xc
    v_mfma_f32_16x16x32_bf16 v[32:35], v[20:23], v[64:67], v[32:35]
    buffer_store_dwordx4 v[4:7], v1, s[12:15], s32 offen offset:0 sc0 sc1
    v_mov_b32_dpp v2, v10 row_ror:8 row_mask:0xf bank_mask:0xf
    v_mfma_f32_16x16x32_bf16 v[36:39], v[20:23], v[68:71], v[36:39]
    v_mov_b32_dpp v3, v11 row_ror:8 row_mask:0xf bank_mask:0xf
    v_mov_b32_dpp v10, v8 row_ror:8 row_mask:0xf bank_mask:0x3
    s_waitcnt lgkmcnt(2)
    v_mfma_f32_16x16x32_bf16 v[24:27], v[12:15], v[72:75], v[24:27]
    ds_read_b64_tr_b16 v[20:21], v0 offset:30720
    v_mov_b32_dpp v11, v9 row_ror:8 row_mask:0xf bank_mask:0x3
    v_mfma_f32_16x16x32_bf16 v[28:31], v[12:15], v[76:79], v[28:31]
    ds_read_b64_tr_b16 v[22:23], v0 offset:30848
    v_mov_b32_dpp v8, v2 quad_perm:[0,1,2,3] row_mask:0xf bank_mask:0xc
    v_mfma_f32_16x16x32_bf16 v[32:35], v[12:15], v[80:83], v[32:35]
    v_mov_b32_dpp v9, v3 quad_perm:[0,1,2,3] row_mask:0xf bank_mask:0xc
    buffer_store_dwordx4 v[8:11], v1, s[12:15], s32 offen offset:1024 sc0 sc1
    v_mfma_f32_16x16x32_bf16 v[36:39], v[12:15], v[84:87], v[36:39]
    s_waitcnt lgkmcnt(2)
    v_mfma_f32_16x16x32_bf16 v[24:27], v[16:19], v[88:91], v[24:27]
    ds_read_b64_tr_b16 v[12:13], v0 offset:30976
    v_mfma_f32_16x16x32_bf16 v[28:31], v[16:19], v[92:95], v[28:31]
    ds_read_b64_tr_b16 v[14:15], v0 offset:31104
    v_mfma_f32_16x16x32_bf16 v[32:35], v[16:19], v[96:99], v[32:35]
    v_mov_b32 v2, 0
    v_mfma_f32_16x16x32_bf16 v[36:39], v[16:19], v[100:103], v[36:39]
    ds_read_b32 v2, v2 offset:276
    s_waitcnt lgkmcnt(3)
    v_mfma_f32_16x16x32_bf16 v[24:27], v[20:23], v[104:107], v[24:27]
    ds_read_b64_tr_b16 v[16:17], v0 offset:46080
    v_mfma_f32_16x16x32_bf16 v[28:31], v[20:23], v[108:111], v[28:31]
    ds_read_b64_tr_b16 v[18:19], v0 offset:46208
    v_mfma_f32_16x16x32_bf16 v[32:35], v[20:23], v[112:115], v[32:35]
    s_waitcnt lgkmcnt(2)
    v_readfirstlane_b32 s52, v2
    s_and_b32 s52, s52, s36
    v_mfma_f32_16x16x32_bf16 v[36:39], v[20:23], v[116:119], v[36:39]
    s_cselect_b32 s34, 1, 0
    s_ff1_i32_b32 s52, s52
    s_waitcnt lgkmcnt(2)
    v_mfma_f32_16x16x32_bf16 v[24:27], v[12:15], v[120:123], v[24:27]
    ds_read_b64_tr_b16 v[20:21], v0 offset:46336
    s_bitset0_b32 s36, s52
    s_mul_i32 s52, s52, 11
    v_mfma_f32_16x16x32_bf16 v[28:31], v[12:15], v[124:127], v[28:31]
    ds_read_b64_tr_b16 v[22:23], v0 offset:46464
    s_bfe_u32 s53, s52, 0x10005
    s_bfe_u32 s52, s52, 0x30006
    v_mfma_f32_16x16x32_bf16 v[32:35], v[12:15], v[128:131], v[32:35]
    s_mul_i32 s35, s53, 61440
    s_mul_i32 s31, s52, 2304
    s_add_u32 s31, s31, s35
    v_mfma_f32_16x16x32_bf16 v[36:39], v[12:15], v[132:135], v[36:39]
    s_sub_u32 s35, s31, s39
    v_add_u32 v0, s35, v0
    s_waitcnt lgkmcnt(2)
    v_mfma_f32_16x16x32_bf16 v[24:27], v[16:19], v[136:139], v[24:27]
    ds_read_b64_tr_b16 v[12:13], v0 offset:0
    v_mfma_f32_16x16x32_bf16 v[28:31], v[16:19], v[140:143], v[28:31]
    ds_read_b64_tr_b16 v[14:15], v0 offset:128
    v_mfma_f32_16x16x32_bf16 v[32:35], v[16:19], v[144:147], v[32:35]
    s_mov_b32 s39, s31
    s_mul_i32 s33, s53, 5
    s_add_u32 s33, s33, s52
    v_mfma_f32_16x16x32_bf16 v[36:39], v[16:19], v[148:151], v[36:39]
    s_lshl_b32 s33, s33, 13
    s_add_u32 s33, s33, s38
    s_waitcnt lgkmcnt(2)
    v_mfma_f32_16x16x32_bf16 v[24:27], v[20:23], v[152:155], v[24:27]
    ds_read_b64_tr_b16 v[16:17], v0 offset:256
    v_mfma_f32_16x16x32_bf16 v[28:31], v[20:23], v[156:159], v[28:31]
    ds_read_b64_tr_b16 v[18:19], v0 offset:384
    s_mov_b32 s32, s37
    s_mov_b32 s37, s33
    v_mfma_f32_16x16x32_bf16 v[32:35], v[20:23], v[160:163], v[32:35]
    s_cmp_eq_u32 s34, 0
    s_nop 1
    v_mfma_f32_16x16x32_bf16 v[36:39], v[20:23], v[164:167], v[36:39]
    v_cvt_pk_bf16_f32 v4, v24, v28
    v_cvt_pk_bf16_f32 v6, v25, v29
    v_cvt_pk_bf16_f32 v8, v26, v30
    v_cvt_pk_bf16_f32 v10, v27, v31
    s_nop 0
    s_cbranch_scc0 gm_loop
gm_drain:
    s_nop 2
    v_cvt_pk_bf16_f32 v7, v33, v37
    v_cvt_pk_bf16_f32 v5, v32, v36
    v_cvt_pk_bf16_f32 v11, v35, v39
    v_cvt_pk_bf16_f32 v9, v34, v38
    v_mov_b32_dpp v2, v6 row_ror:8 row_mask:0xf bank_mask:0xf
    v_mov_b32_dpp v3, v7 row_ror:8 row_mask:0xf bank_mask:0xf
    v_mov_b32_dpp v6, v4 row_ror:8 row_mask:0xf bank_mask:0x3
    v_mov_b32_dpp v7, v5 row_ror:8 row_mask:0xf bank_mask:0x3
    v_mov_b32_dpp v4, v2 quad_perm:[0,1,2,3] row_mask:0xf bank_mask:0xc
    v_mov_b32_dpp v5, v3 quad_perm:[0,1,2,3] row_mask:0xf bank_mask:0xc
    buffer_store_dwordx4 v[4:7], v1, s[12:15], s32 offen offset:0 sc0 sc1
    v_mov_b32_dpp v2, v10 row_ror:8 row_mask:0xf bank_mask:0xf
    v_mov_b32_dpp v3, v11 row_ror:8 row_mask:0xf bank_mask:0xf
    v_mov_b32_dpp v10, v8 row_ror:8 row_mask:0xf bank_mask:0x3
    v_mov_b32_dpp v11, v9 row_ror:8 row_mask:0xf bank_mask:0x3
    v_mov_b32_dpp v8, v2 quad_perm:[0,1,2,3] row_mask:0xf bank_mask:0xc
    v_mov_b32_dpp v9, v3 quad_perm:[0,1,2,3] row_mask:0xf bank_mask:0xc
    buffer_store_dwordx4 v[8:11], v1, s[12:15], s32 offen offset:1024 sc0 sc1
    s_cmp_lg_u32 s36, 0
    s_cbranch_scc1 gm_poll
    s_endpgm
mn_w5:
    v_add_u32 v55, 16, v35
    v_add_u32 v55, s24, v55
    v_lshrrev_b32 v56, 16, v59
    v_mov_b32 v24, 0
    v_cmpx_lt_u32 vcc, v55, v56
    s_cbranch_execz mn_g0
    v_and_b32 v56, 0xffff, v59
    v_add_u32 v55, v55, v56
    v_mad_u32_u24 v56, v55, 48, v58
    buffer_load_dword v24, v56, s[8:11], 0 offen offset:40
    s_waitcnt vmcnt(0)
    v_lshl_or_b32 v24, v55, 14, v24
mn_g0:
    s_mov_b64 exec, -1
mn_more:
    s_add_u32 s52, s24, s20
    v_lshrrev_b32 v56, 16, v59
    v_cmp_lt_u32 vcc, s52, v56
    s_cbranch_vccz mn_count
    v_mov_b32 v55, 272
    ds_write_b32 v55, v48
    s_branch mn_count
mn_ovf:
    s_movk_i32 s20, 4
    s_waitcnt vmcnt(0) lgkmcnt(0)
    s_barrier
    s_branch mn_again
mn_next:
    s_set_gpr_idx_off
mn_next2:
    s_waitcnt vmcnt(0) lgkmcnt(0)
    s_nop 7
    s_add_u32 s24, s24, s20
    v_and_b32 v46, 63, v0
    v_mov_b32 v48, 1
    v_lshlrev_b32 v47, 2, v46
    v_bfe_u32 v2, v0, 5, 1
    v_bfe_u32 v3, v0, 3, 2
    v_and_b32 v18, 3, v0
    v_lshl_add_u32 v3, v3, 2, v18
    v_mul_u32_u24 v49, 20, v2
    v_bfe_u32 v55, v0, 2, 1
    v_lshlrev_b32 v86, 4, v2
    v_lshl_or_b32 v86, v55, 18, v86
    v_lshrrev_b32 v55, 2, v46
    v_lshl_add_u32 v18, v18, 4, v55
    v_mov_b32 v50, 1327103
    v_and_b32 v35, 3, v0
    v_min_u32 v44, 1, v46
    v_lshlrev_b32 v44, 18, v44
    v_lshrrev_b32 v56, 6, v0
    v_lshlrev_b32 v55, 1, v0
    v_and_b32 v55, 0x78, v55
    v_or_b32 v55, v55, v56
    v_mul_u32_u24 v58, 61440, v55
    v_and_b32 v56, 0x200, v0
    v_or_b32 v55, v55, v56
    v_cmp_gt_u32 vcc, 125, v55
    v_bfrev_b32 v56, 2
    v_and_b32 v57, 0x1fc, v0
    s_nop 0
    v_cndmask_b32 v57, v56, v57, vcc
    buffer_load_dword v59, v57, s[8:11], s25 offen
mn_again:
    v_mov_b32 v55, 0
    ds_write_b32 v47, v55 offset:0
    ds_write_b32 v47, v55 offset:256
    s_waitcnt vmcnt(0) lgkmcnt(0)
    s_barrier
    v_add_u32 v55, 0, v35
    v_add_u32 v55, s24, v55
    v_lshrrev_b32 v56, 16, v59
    v_mov_b32 v20, 0
    v_cmpx_lt_u32 vcc, v55, v56
    s_cbranch_execz mn_g1
    v_and_b32 v56, 0xffff, v59
    v_add_u32 v55, v55, v56
    v_mad_u32_u24 v56, v55, 48, v58
    buffer_load_dword v20, v56, s[8:11], 0 offen offset:40
    s_waitcnt vmcnt(0)
    v_lshl_or_b32 v20, v55, 14, v20
mn_g1:
    s_mov_b64 exec, -1
    v_mov_b32 v21, 0
    v_mov_b32 v22, 0
    v_mov_b32 v23, 0
    v_mov_b32 v24, 0
    s_cmp_le_u32 s20, 4
    s_cbranch_scc1 mn_more
    v_add_u32 v55, 4, v35
    v_add_u32 v55, s24, v55
    v_lshrrev_b32 v56, 16, v59
    v_mov_b32 v21, 0
    v_cmpx_lt_u32 vcc, v55, v56
    s_cbranch_execz mn_g2
    v_and_b32 v56, 0xffff, v59
    v_add_u32 v55, v55, v56
    v_mad_u32_u24 v56, v55, 48, v58
    buffer_load_dword v21, v56, s[8:11], 0 offen offset:40
    s_waitcnt vmcnt(0)
    v_lshl_or_b32 v21, v55, 14, v21
mn_g2:
    s_mov_b64 exec, -1
    v_add_u32 v55, 8, v35
    v_add_u32 v55, s24, v55
    v_lshrrev_b32 v56, 16, v59
    v_mov_b32 v22, 0
    v_cmpx_lt_u32 vcc, v55, v56
    s_cbranch_execz mn_g3
    v_and_b32 v56, 0xffff, v59
    v_add_u32 v55, v55, v56
    v_mad_u32_u24 v56, v55, 48, v58
    buffer_load_dword v22, v56, s[8:11], 0 offen offset:40
    s_waitcnt vmcnt(0)
    v_lshl_or_b32 v22, v55, 14, v22
mn_g3:
    s_mov_b64 exec, -1
    v_add_u32 v55, 12, v35
    v_add_u32 v55, s24, v55
    v_lshrrev_b32 v56, 16, v59
    v_mov_b32 v23, 0
    v_cmpx_lt_u32 vcc, v55, v56
    s_cbranch_execz mn_g4
    v_and_b32 v56, 0xffff, v59
    v_add_u32 v55, v55, v56
    v_mad_u32_u24 v56, v55, 48, v58
    buffer_load_dword v23, v56, s[8:11], 0 offen offset:40
    s_waitcnt vmcnt(0)
    v_lshl_or_b32 v23, v55, 14, v23
mn_g4:
    s_mov_b64 exec, -1
    v_add_u32 v55, 16, v35
    v_add_u32 v55, s24, v55
    v_lshrrev_b32 v56, 16, v59
    v_mov_b32 v24, 0
    v_cmpx_lt_u32 vcc, v55, v56
    s_cbranch_execz mn_g5
    v_and_b32 v56, 0xffff, v59
    v_add_u32 v55, v55, v56
    v_mad_u32_u24 v56, v55, 48, v58
    buffer_load_dword v24, v56, s[8:11], 0 offen offset:40
    s_waitcnt vmcnt(0)
    v_lshl_or_b32 v24, v55, 14, v24
mn_g5:
    s_mov_b64 exec, -1
    s_branch mn_more
mn_last:
    s_endpgm
.section .rodata,"a"
.p2align 6
.amdhsa_kernel ka_kernel
  .amdhsa_next_free_vgpr 88
  .amdhsa_next_free_sgpr 40
  .amdhsa_accum_offset 88
  .amdhsa_group_segment_fixed_size 0
  .amdhsa_kernarg_size 88
  .amdhsa_user_sgpr_count 2
  .amdhsa_user_sgpr_kernarg_segment_ptr 1
  .amdhsa_system_sgpr_workgroup_id_x 1
.end_amdhsa_kernel
.p2align 6
.amdhsa_kernel main_kernel
  .amdhsa_next_free_vgpr 168
  .amdhsa_next_free_sgpr 96
  .amdhsa_accum_offset 168
  .amdhsa_group_segment_fixed_size 0
  .amdhsa_kernarg_size 88
  .amdhsa_user_sgpr_count 2
  .amdhsa_user_sgpr_kernarg_segment_ptr 1
  .amdhsa_system_sgpr_workgroup_id_x 1
.end_amdhsa_kernel
```

```asm
; @launch kernel=ka_kernel grid=(256,1,1) block=(640,1,1) lds=89088
; @launch kernel=main_kernel grid=(256,1,1) block=(768,1,1) lds=163840
.amdgcn_target "amdgcn-amd-amdhsa--gfx950"
.text
.globl ka_kernel
.p2align 8
.type ka_kernel,@function
ka_kernel:
    s_cmp_ge_u32 s2, 256
    s_cbranch_scc1 ka_end
    s_load_dwordx8 s[4:11], s[0:1], 8
    s_load_dwordx2 s[16:17], s[0:1], 0
    s_load_dwordx2 s[14:15], s[0:1], 80
    s_load_dwordx2 s[32:33], s[0:1], 56
    v_lshrrev_b32 v9, 6, v0
    v_and_b32 v1, 63, v0
    v_readfirstlane_b32 s18, v9
    s_cmp_ge_u32 s2, 128
    s_cbranch_scc1 ka_pf
    s_cmp_ge_u32 s2, 125
    s_cbranch_scc1 ka_extra
    s_mul_i32 s3, s2, 1280
    v_add_u32 v4, s3, v0
    v_lshlrev_b32 v5, 2, v4
    v_lshlrev_b32 v2, 2, v0
    v_and_b32 v2, 0x3fc, v2
    v_mov_b32 v3, 0
    v_lshlrev_b32 v6, 3, v4
    v_add_u32 v8, 5120, v6
    v_and_b32 v7, 0xffffffc0, v4
    v_lshlrev_b32 v7, 5, v7
    v_lshl_add_u32 v7, v1, 4, v7
    v_add_u32 v9, 20480, v7
    s_waitcnt lgkmcnt(0)
    global_load_dword v10, v5, s[6:7]
    global_load_dword v60, v5, s[6:7] offset:2560
    global_load_dword v11, v5, s[4:5]
    global_load_dword v61, v5, s[4:5] offset:2560
    ds_write_b32 v2, v3
    v_lshlrev_b32 v5, 4, v0
    v_mov_b32 v44, 0
    v_mov_b32 v45, 0
    v_mov_b32 v46, 0
    v_mov_b32 v47, 0
    ds_write_b128 v5, v[44:47] offset:11264
    ds_write_b128 v5, v[44:47] offset:17408
    s_mov_b32 s20, s14
    s_and_b32 s21, s15, 0xffff
    s_mov_b32 s22, 12582912
    s_mov_b32 s23, 0x20000
    s_and_b32 s28, s2, 7
    s_lshl_b32 s28, s28, 4
    s_lshr_b32 s29, s2, 3
    s_add_u32 s28, s28, s29
    s_lshl_b32 s30, s28, 6
    s_add_u32 s30, s30, 8388608
    s_lshl_b32 s28, s28, 2
    s_add_u32 s28, s28, 10485760
    v_mov_b32 v3, 1
    v_lshrrev_b32 v24, 1, v1
    v_lshlrev_b32 v24, 2, v24
    v_and_b32 v25, 1, v0
    v_lshlrev_b32 v25, 4, v25
    v_lshlrev_b32 v26, 4, v1
    s_lshl_b32 s19, s18, 10
    v_add_u32 v27, s19, v26
    s_movk_i32 s29, 625
    s_movk_i32 s38, 320
    s_movk_i32 s39, 1250
    s_waitcnt lgkmcnt(0)
    s_barrier
    global_load_dwordx2 v[12:13], v6, s[8:9]
    global_load_dwordx4 v[16:19], v7, s[10:11]
    global_load_dwordx4 v[20:23], v7, s[10:11] offset:1024
    global_load_dwordx2 v[72:73], v8, s[8:9]
    global_load_dwordx4 v[64:67], v9, s[10:11]
    global_load_dwordx4 v[68:71], v9, s[10:11] offset:1024
    s_waitcnt vmcnt(9)
    v_mul_u32_u24 v32, 214749, v10
    v_lshrrev_b32 v32, 23, v32
    v_min_u32 v32, 255, v32
    v_and_b32 v35, 7, v32
    v_lshrrev_b32 v33, 3, v32
    v_lshl_add_u32 v35, v35, 5, v33
    v_lshlrev_b32 v35, 2, v35
    ds_add_rtn_u32 v36, v35, v3
    s_waitcnt vmcnt(8)
    v_mul_u32_u24 v62, 214749, v60
    v_lshrrev_b32 v62, 23, v62
    v_min_u32 v62, 255, v62
    v_and_b32 v76, 7, v62
    v_lshrrev_b32 v63, 3, v62
    v_lshl_add_u32 v76, v76, 5, v63
    v_lshlrev_b32 v76, 2, v76
    ds_add_rtn_u32 v77, v76, v3
    s_waitcnt vmcnt(6)
    v_mad_u32_u24 v33, v32, s29, 15
    v_lshrrev_b32 v33, 4, v33
    v_sub_u32 v33, v10, v33
    v_and_b32 v32, 7, v32
    v_mul_u32_u24 v32, 0, v32
    v_sub_u32 v39, v11, v32
    v_add_u32 v32, 10000, v39
    v_min_u32 v39, v39, v32
    v_mul_u32_u24 v39, 3330, v39
    v_lshrrev_b32 v39, 20, v39
    v_subrev_u32 v32, 20, v33
    v_min_u32 v15, v32, v33
    v_min_u32 v15, 19, v15
    v_lshrrev_b32 v32, 2, v15
    v_add_u32 v32, 27, v32
    v_cmp_gt_u32 vcc, 27, v39
    v_lshlrev_b32 v15, 2, v15
    v_and_b32 v14, 0x3fff, v11
    v_cndmask_b32 v39, v32, v39, vcc
    v_cmp_le_u32 vcc, 20, v33
    v_add_u32 v32, 32, v39
    v_lshlrev_b32 v40, 4, v35
    v_cndmask_b32 v39, v39, v32, vcc
    v_add_u32 v35, s19, v35
    v_or_b32 v39, 64, v39
    v_lshl_or_b32 v14, v39, 25, v14
    v_mad_u32_u24 v63, v62, s29, 15
    v_lshrrev_b32 v63, 4, v63
    v_sub_u32 v63, v60, v63
    v_and_b32 v62, 7, v62
    v_mul_u32_u24 v62, 0, v62
    v_sub_u32 v78, v61, v62
    v_add_u32 v62, 10000, v78
    v_min_u32 v78, v78, v62
    v_mul_u32_u24 v78, 3330, v78
    v_lshrrev_b32 v78, 20, v78
    v_subrev_u32 v62, 20, v63
    v_min_u32 v75, v62, v63
    v_min_u32 v75, 19, v75
    v_lshrrev_b32 v62, 2, v75
    v_add_u32 v62, 27, v62
    v_cmp_gt_u32 vcc, 27, v78
    v_lshlrev_b32 v75, 2, v75
    v_and_b32 v74, 0x3fff, v61
    v_cndmask_b32 v78, v62, v78, vcc
    v_cmp_le_u32 vcc, 20, v63
    v_add_u32 v62, 32, v78
    v_lshlrev_b32 v82, 4, v76
    v_cndmask_b32 v78, v78, v62, vcc
    v_add_u32 v76, s19, v76
    v_or_b32 v78, 64, v78
    v_lshl_or_b32 v74, v78, 25, v74
    s_waitcnt lgkmcnt(0)
    s_barrier
    ds_read_b128 v[44:47], v26
    ds_read_b32 v37, v2
    v_add_u32 v28, s19, v2
    v_lshlrev_b32 v29, 9, v0
    s_mul_i32 s19, s2, 61440
    v_and_b32 v32, 3, v36
    v_lshl_add_u32 v40, v32, 4, v40
    v_and_b32 v32, 12, v36
    v_add_u32 v40, v32, v40
    v_cmp_lt_u32 vcc, 15, v36
    v_mov_b32 v32, 0x40000
    v_lshl_add_u32 v15, s19, 4, v15
    v_cndmask_b32 v40, v40, v32, vcc
    v_and_b32 v62, 3, v77
    v_lshl_add_u32 v82, v62, 4, v82
    v_and_b32 v62, 12, v77
    v_add_u32 v82, v62, v82
    v_cmp_lt_u32 vcc, 15, v77
    v_mov_b32 v62, 0x40000
    v_lshl_add_u32 v75, s19, 4, v75
    v_cndmask_b32 v82, v82, v62, vcc
    s_waitcnt lgkmcnt(1)
    v_add_u32 v53, v44, v45
    v_add_u32 v54, v53, v46
    v_add_u32 v38, v54, v47
    v_mov_b32 v55, v38
    s_nop 0
    v_add_u32_dpp v38, v38, v38 row_shr:1 row_mask:0xf bank_mask:0xf
    s_nop 1
    v_add_u32_dpp v38, v38, v38 row_shr:2 row_mask:0xf bank_mask:0xf
    s_nop 1
    v_add_u32_dpp v38, v38, v38 row_shr:4 row_mask:0xf bank_mask:0xf
    s_nop 1
    v_add_u32_dpp v38, v38, v38 row_shr:8 row_mask:0xf bank_mask:0xf
    s_nop 1
    v_add_u32_dpp v38, v38, v38 row_bcast:15 row_mask:0xa bank_mask:0xf
    s_nop 1
    v_add_u32_dpp v38, v38, v38 row_bcast:31 row_mask:0xc bank_mask:0xf
    v_sub_u32 v56, v38, v55
    v_add_u32 v57, v56, v44
    v_add_u32 v58, v56, v53
    v_add_u32 v59, v56, v54
    ds_write_b128 v27, v[56:59] offset:1024
    ds_read_b32 v43, v35 offset:1024
    ds_read_b32 v79, v76 offset:1024
    ds_read_b32 v30, v28 offset:1024
    s_waitcnt lgkmcnt(1)
    v_add_u32 v43, v43, v36
    v_lshl_or_b32 v41, v43, 14, v14
    v_mul_u32_u24 v43, 48, v43
    ds_bpermute_b32 v48, v24, v43
    ds_bpermute_b32 v49, v24, v43 offset:128
    ds_write_b32 v40, v41 offset:11264
    v_lshl_add_u32 v15, v43, 4, v15
    v_add_u32 v79, v79, v77
    v_lshl_or_b32 v83, v79, 14, v74
    v_mul_u32_u24 v79, 48, v79
    ds_bpermute_b32 v80, v24, v79
    ds_bpermute_b32 v81, v24, v79 offset:128
    ds_write_b32 v82, v83 offset:11264
    v_lshl_add_u32 v75, v79, 4, v75
    s_cmp_ge_u32 s18, 4
    s_waitcnt lgkmcnt(1)
    v_lshl_or_b32 v30, v37, 16, v30
    v_add_u32 v48, v48, v25
    v_add_u32 v49, v49, v25
    v_add_u32 v80, v80, v25
    v_add_u32 v81, v81, v25
    s_waitcnt vmcnt(5)
    ds_write_b128 v43, v[12:15] offset:27680
    s_waitcnt vmcnt(4)
    ds_write_b128 v48, v[16:19] offset:27648
    s_waitcnt vmcnt(3)
    ds_write_b128 v49, v[20:23] offset:27648
    s_waitcnt vmcnt(2)
    ds_write_b128 v79, v[72:75] offset:27680
    s_waitcnt vmcnt(1)
    ds_write_b128 v80, v[64:67] offset:27648
    s_waitcnt vmcnt(0)
    ds_write_b128 v81, v[68:71] offset:27648
    s_cbranch_scc1 ka_nohdr
    buffer_store_dword v30, v29, s[20:23], s28 offen
ka_nohdr:
    v_lshrrev_b32 v6, 2, v0
    v_lshlrev_b32 v6, 13, v6
    v_and_b32 v7, 0x30, v5
    v_or_b32 v6, v6, v7
    v_add_u32 v7, 27648, v5
    s_add_u32 s31, s30, 1310720
    s_cmp_ge_u32 s18, 6
    s_waitcnt lgkmcnt(0)
    s_barrier
    ds_read_b128 v[36:39], v5 offset:11264
    ds_read_b128 v[40:43], v5 offset:21504
    ds_read_b128 v[12:15], v7 offset:0
    ds_read_b128 v[16:19], v7 offset:10240
    ds_read_b128 v[20:23], v7 offset:20480
    ds_read_b128 v[24:27], v7 offset:30720
    ds_read_b128 v[28:31], v7 offset:40960
    ds_read_b128 v[32:35], v7 offset:51200
    s_waitcnt lgkmcnt(6)
    buffer_store_dwordx4 v[36:39], v6, s[20:23], s30 offen
    s_cbranch_scc1 ka_noc2
    buffer_store_dwordx4 v[40:43], v6, s[20:23], s31 offen
ka_noc2:
    s_waitcnt lgkmcnt(5)
    buffer_store_dwordx4 v[12:15], v5, s[20:23], s19 offen sc1
    s_addk_i32 s19, 10240
    s_waitcnt lgkmcnt(4)
    buffer_store_dwordx4 v[16:19], v5, s[20:23], s19 offen sc1
    s_addk_i32 s19, 10240
    s_waitcnt lgkmcnt(3)
    buffer_store_dwordx4 v[20:23], v5, s[20:23], s19 offen sc1
    s_addk_i32 s19, 10240
    s_waitcnt lgkmcnt(2)
    buffer_store_dwordx4 v[24:27], v5, s[20:23], s19 offen sc1
    s_addk_i32 s19, 10240
    s_waitcnt lgkmcnt(1)
    buffer_store_dwordx4 v[28:31], v5, s[20:23], s19 offen sc1
    s_addk_i32 s19, 10240
    s_waitcnt lgkmcnt(0)
    buffer_store_dwordx4 v[32:35], v5, s[20:23], s19 offen sc1
    s_endpgm
ka_pf:
    s_waitcnt lgkmcnt(0)
    s_and_b32 s34, s2, 7
    s_mul_i32 s34, s34, 655360
    s_add_u32 s24, s16, s34
    s_addc_u32 s25, s17, 0
    s_and_b32 s25, s25, 0xffff
    s_mov_b32 s26, 655360
    s_mov_b32 s27, 0x20000
    s_bfe_u32 s30, s2, 0x40003
    v_lshlrev_b32 v40, 7, v0
    s_mul_i32 s30, s30, 40960
    s_cmp_lg_u32 s18, 0
    s_cbranch_scc1 ka_nocpf
    s_cmp_ge_u32 s2, 144
    s_cbranch_scc1 ka_nocpf
    s_getpc_b64 s[36:37]
ka_pc:
    s_add_u32 s36, s36, main_kernel-ka_pc
    s_addc_u32 s37, s37, 0
    s_bfe_u32 s38, s2, 0x10003
    s_lshl_b32 s38, s38, 13
    v_lshl_add_u32 v41, v1, 7, s38
    v_min_u32 v41, mn_last-main_kernel, v41
    global_load_dword v41, v41, s[36:37]
ka_nocpf:
    s_cmp_lg_u32 s18, 9
    s_cbranch_scc1 ka_pf1
    s_bitcmp1_b32 s2, 3
    s_cbranch_scc1 ka_pf1
    s_and_b32 s35, s2, 7
    s_bfe_u32 s36, s2, 0x30004
    s_lshl_b32 s37, s35, 14
    s_lshr_b32 s38, s36, 1
    s_lshl_b32 s38, s38, 7
    s_add_u32 s37, s37, s38
    s_and_b32 s38, s36, 1
    s_lshl2_add_u32 s37, s38, s37
    v_lshrrev_b32 v44, 4, v1
    v_lshlrev_b32 v44, 11, v44
    v_and_b32 v45, 7, v1
    v_lshl_add_u32 v44, v45, 4, v44
    v_and_b32 v45, 8, v1
    v_add3_u32 v44, v44, v45, s37
    v_add_u32 v45, 0x2000, v44
    global_load_dword v48, v44, s[32:33] offset:0
    global_load_dword v49, v44, s[32:33] offset:512
    global_load_dword v50, v44, s[32:33] offset:1024
    global_load_dword v51, v44, s[32:33] offset:1536
    global_load_dword v52, v45, s[32:33] offset:0
    global_load_dword v53, v45, s[32:33] offset:512
    global_load_dword v54, v45, s[32:33] offset:1024
    global_load_dword v55, v45, s[32:33] offset:1536
    s_lshr_b32 s36, s36, 1
    s_lshl3_add_u32 s36, s36, s35
    s_lshl1_add_u32 s36, s36, s38
    s_lshl_b32 s36, s36, 11
    s_add_u32 s36, s36, 11534336
    v_lshl_add_u32 v46, v1, 4, s36
    s_mov_b32 s38, 0x05040100
    s_mov_b32 s39, 0x07060302
    s_waitcnt vmcnt(0)
    v_perm_b32 v56, v49, v48, s38
    v_perm_b32 v60, v49, v48, s39
    v_perm_b32 v57, v51, v50, s38
    v_perm_b32 v61, v51, v50, s39
    v_perm_b32 v58, v53, v52, s38
    v_perm_b32 v62, v53, v52, s39
    v_perm_b32 v59, v55, v54, s38
    v_perm_b32 v63, v55, v54, s39
    global_store_dwordx4 v46, v[56:59], s[14:15]
    global_store_dwordx4 v46, v[60:63], s[14:15] offset:1024
ka_pf1:
    s_cmp_ge_u32 s18, 5
    s_cbranch_scc1 ka_end
    buffer_load_dword v42, v40, s[24:27], s30 offen
    s_cmp_ge_u32 s18, 0
    s_cbranch_scc1 ka_end
    s_add_u32 s30, s30, 81920
    buffer_load_dword v43, v40, s[24:27], s30 offen
    s_endpgm
ka_extra:
    s_cmp_lg_u32 s2, 125
    s_cbranch_scc1 ka_end
    s_cmp_ge_u32 s18, 6
    s_cbranch_scc1 ka_end
    s_load_dwordx4 s[36:39], s[0:1], 40
    s_lshl_b32 s34, s18, 11
    s_add_u32 s34, s34, 11665408
    v_lshl_add_u32 v46, v1, 4, s34
    s_cmp_eq_u32 s18, 5
    s_cbranch_scc1 ka_dum
    s_cmp_eq_u32 s18, 4
    s_cbranch_scc1 ka_cg
    v_lshrrev_b32 v44, 5, v1
    v_lshlrev_b32 v44, 12, v44
    v_and_b32 v45, 31, v1
    v_lshl_add_u32 v44, v45, 1, v44
    v_lshl_add_u32 v44, s18, 7, v44
    s_waitcnt lgkmcnt(0)
    global_load_ushort v48, v44, s[38:39] offset:0
    global_load_ushort v49, v44, s[38:39] offset:512
    global_load_ushort v50, v44, s[38:39] offset:1024
    global_load_ushort v51, v44, s[38:39] offset:1536
    global_load_ushort v52, v44, s[38:39] offset:2048
    global_load_ushort v53, v44, s[38:39] offset:2560
    global_load_ushort v54, v44, s[38:39] offset:3072
    global_load_ushort v55, v44, s[38:39] offset:3584
    global_load_ushort v56, v44, s[38:39] offset:64
    global_load_ushort v57, v44, s[38:39] offset:576
    global_load_ushort v58, v44, s[38:39] offset:1088
    global_load_ushort v59, v44, s[38:39] offset:1600
    global_load_ushort v60, v44, s[38:39] offset:2112
    global_load_ushort v61, v44, s[38:39] offset:2624
    global_load_ushort v62, v44, s[38:39] offset:3136
    global_load_ushort v63, v44, s[38:39] offset:3648
    s_branch ka_pk
ka_cg:
    v_and_b32 v44, 3, v1
    v_lshlrev_b32 v44, 1, v44
    s_waitcnt lgkmcnt(0)
    global_load_ushort v48, v44, s[36:37] offset:0
    global_load_ushort v49, v44, s[36:37] offset:8
    global_load_ushort v50, v44, s[36:37] offset:16
    global_load_ushort v51, v44, s[36:37] offset:24
    global_load_ushort v52, v44, s[36:37] offset:32
    global_load_ushort v53, v44, s[36:37] offset:40
    global_load_ushort v54, v44, s[36:37] offset:48
    global_load_ushort v55, v44, s[36:37] offset:56
    global_load_ushort v56, v44, s[36:37] offset:64
    global_load_ushort v57, v44, s[36:37] offset:72
    global_load_ushort v58, v44, s[36:37] offset:80
    global_load_ushort v59, v44, s[36:37] offset:88
    global_load_ushort v60, v44, s[36:37] offset:96
    global_load_ushort v61, v44, s[36:37] offset:104
    global_load_ushort v62, v44, s[36:37] offset:112
    global_load_ushort v63, v44, s[36:37] offset:120
ka_pk:
    s_waitcnt vmcnt(0)
    v_lshl_or_b32 v64, v49, 16, v48
    v_lshl_or_b32 v65, v51, 16, v50
    v_lshl_or_b32 v66, v53, 16, v52
    v_lshl_or_b32 v67, v55, 16, v54
    v_lshl_or_b32 v68, v57, 16, v56
    v_lshl_or_b32 v69, v59, 16, v58
    v_lshl_or_b32 v70, v61, 16, v60
    v_lshl_or_b32 v71, v63, 16, v62
    global_store_dwordx4 v46, v[64:67], s[14:15]
    global_store_dwordx4 v46, v[68:71], s[14:15] offset:1024
    s_endpgm
ka_dum:
    v_mov_b32 v46, 11677696
    v_mov_b32 v48, 0
    v_mov_b32 v49, 0
    v_mov_b32 v50, 0
    v_mov_b32 v51, 0
    v_mov_b32 v52, 0x3fff
    v_mov_b32 v53, 186843136
    s_mov_b64 exec, 1
    s_waitcnt lgkmcnt(0)
    global_store_dwordx4 v46, v[48:51], s[14:15]
    global_store_dwordx4 v46, v[48:51], s[14:15] offset:16
    global_store_dwordx4 v46, v[50:53], s[14:15] offset:32
ka_end:
    s_endpgm
.globl main_kernel
.p2align 8
.type main_kernel,@function
main_kernel:
    s_cmp_ge_u32 s2, 256
    s_cbranch_scc1 mn_end
    s_load_dwordx2 s[54:55], s[0:1], 80
    s_load_dwordx2 s[50:51], s[0:1], 0
    v_lshrrev_b32 v56, 6, v0
    s_and_b32 s48, s2, 7
    v_readfirstlane_b32 s16, v56
    s_lshr_b32 s47, s2, 3
    s_lshl_b32 s25, s48, 5
    s_add_u32 s25, s25, s47
    s_lshl_b32 s49, s25, 13
    s_add_u32 s49, s49, 8388608
    s_lshl_b32 s25, s25, 9
    s_add_u32 s25, s25, 10485760
    s_mov_b32 s10, 12582912
    s_mov_b32 s11, 0x20000
    s_and_b32 s17, s16, 3
    s_movk_i32 s20, 20
    s_mov_b32 s24, 0
    s_cmp_ge_u32 s16, 8
    s_cbranch_scc1 gm_main
    v_lshrrev_b32 v56, 6, v0
    v_lshlrev_b32 v55, 1, v0
    v_and_b32 v55, 0x78, v55
    v_or_b32 v55, v55, v56
    v_cmp_gt_u32 vcc, 125, v55
    v_mul_u32_u24 v46, 61440, v55
    v_bfrev_b32 v56, 2
    v_lshlrev_b32 v55, 4, v0
    v_and_b32 v57, 0x1fc, v0
    v_cndmask_b32 v55, v56, v55, vcc
    v_cndmask_b32 v57, v56, v57, vcc
    v_and_b32 v51, 63, v0
    v_lshlrev_b32 v56, 3, v51
    s_lshl_b32 s52, s17, 11
    s_add_u32 s52, s52, 11665408
    s_mov_b32 s53, 11673600
    v_lshlrev_b32 v52, 4, v51
    s_waitcnt lgkmcnt(0)
    s_mov_b32 s8, s54
    s_and_b32 s9, s55, 0xffff
    buffer_load_dwordx4 v[20:23], v55, s[8:11], s49 offen
    buffer_load_dword v58, v57, s[8:11], s25 offen
    buffer_load_dwordx2 v[44:45], v56, s[8:11], s25 offen
    s_barrier
    buffer_load_dwordx4 v[68:71], v52, s[8:11], s52 offen
    buffer_load_dwordx4 v[72:75], v52, s[8:11], s52 offen offset:1024
    buffer_load_dwordx4 v[76:79], v52, s[8:11], s53 offen
    buffer_load_dwordx4 v[80:83], v52, s[8:11], s53 offen offset:1024
    v_mov_b32 v24, 0
    s_lshr_b32 s18, s16, 2
    s_lshl_b32 s53, s17, 7
    s_add_u32 s4, s50, s53
    s_addc_u32 s5, s51, 0
    s_and_b32 s5, s5, 0xffff
    s_or_b32 s5, s5, 0x08000000
    s_movk_i32 s6, 10000
    s_mov_b32 s7, 0x20000
    s_mul_i32 s40, s16, 15360
    s_add_u32 s40, s40, 40960
    v_lshl_add_u32 v87, v51, 3, s40
    s_add_u32 s40, s40, 9216
    s_add_u32 s41, s40, 1024
    s_add_u32 s42, s40, 2048
    s_add_u32 s43, s40, 3072
    s_add_u32 s44, s40, 4096
    s_add_u32 s45, s40, 5120
    v_and_b32 v55, 3, v0
    v_bfe_u32 v56, v0, 2, 2
    v_bfe_u32 v57, v0, 4, 1
    v_bfe_u32 v53, v0, 5, 1
    v_lshlrev_b32 v1, 3, v55
    v_lshl_add_u32 v1, v57, 5, v1
    v_lshl_add_u32 v1, v56, 6, v1
    v_lshl_add_u32 v1, v53, 8, v1
    v_add_u32 v1, s40, v1
    v_lshlrev_b32 v5, 4, v55
    v_lshl_add_u32 v5, v57, 6, v5
    v_lshl_add_u32 v5, v56, 9, v5
    v_mov_b32 v7, v5
    v_bfe_u32 v55, v0, 2, 1
    v_lshlrev_b32 v86, 4, v53
    v_lshl_or_b32 v86, v55, 18, v86
    v_mov_b32 v48, 1
    v_lshlrev_b32 v47, 2, v51
    v_bfe_u32 v2, v0, 5, 1
    v_bfe_u32 v3, v0, 3, 2
    v_and_b32 v35, 3, v0
    v_lshl_add_u32 v3, v3, 2, v35
    v_mul_u32_u24 v49, 20, v2
    v_lshrrev_b32 v18, 2, v51
    v_lshl_add_u32 v18, v35, 4, v18
    v_mov_b32 v50, 1327103
    s_lshl_b32 s52, s16, 3
    s_bfm_b64 s[36:37], s52, 0
    s_andn2_b32 s39, s37, 2155905024
    s_mov_b32 s38, s36
    v_mov_b64 v[88:89], 0
    v_mov_b64 v[90:91], 0
    v_mov_b64 v[92:93], 0
    v_mov_b64 v[94:95], 0
    v_mov_b64 v[96:97], 0
    v_mov_b64 v[98:99], 0
    v_mov_b64 v[100:101], 0
    v_mov_b64 v[102:103], 0
    v_mov_b64 v[104:105], 0
    v_mov_b64 v[106:107], 0
    v_mov_b64 v[108:109], 0
    v_mov_b64 v[110:111], 0
    v_mov_b64 v[112:113], 0
    v_mov_b64 v[114:115], 0
    v_mov_b64 v[116:117], 0
    v_mov_b64 v[118:119], 0
    v_mov_b64 v[120:121], 0
    v_mov_b64 v[122:123], 0
    v_mov_b64 v[124:125], 0
    v_mov_b64 v[126:127], 0
    v_mov_b64 v[128:129], 0
    v_mov_b64 v[130:131], 0
    v_mov_b64 v[132:133], 0
    v_mov_b64 v[134:135], 0
    v_mov_b64 v[136:137], 0
    v_mov_b64 v[138:139], 0
    v_mov_b64 v[140:141], 0
    v_mov_b64 v[142:143], 0
    v_mov_b64 v[144:145], 0
    v_mov_b64 v[146:147], 0
    v_mov_b64 v[148:149], 0
    v_mov_b64 v[150:151], 0
    v_mov_b64 v[152:153], 0
    v_mov_b64 v[154:155], 0
    v_mov_b64 v[156:157], 0
    v_mov_b64 v[158:159], 0
    v_mov_b64 v[160:161], 0
    v_mov_b64 v[162:163], 0
    v_mov_b64 v[164:165], 0
    v_mov_b64 v[166:167], 0
    s_mov_b32 s52, 0x110000
    s_waitcnt vmcnt(4)
    v_cmp_le_u32 vcc, s52, v58
    s_cbranch_vccnz mn_w5
mn_count:
    v_cmpx_gt_i32 vcc, 0, v20
    s_cbranch_execz mn_cn_done
    v_lshrrev_b32 v25, 23, v20
    v_and_b32 v25, 0xfc, v25
    ds_add_rtn_u32 v30, v25, v48
    v_cmpx_gt_i32 vcc, 0, v21
    s_cbranch_execz mn_cn_done
    v_lshrrev_b32 v26, 23, v21
    v_and_b32 v26, 0xfc, v26
    ds_add_rtn_u32 v31, v26, v48
    v_cmpx_gt_i32 vcc, 0, v22
    s_cbranch_execz mn_cn_done
    v_lshrrev_b32 v27, 23, v22
    v_and_b32 v27, 0xfc, v27
    ds_add_rtn_u32 v32, v27, v48
    v_cmpx_gt_i32 vcc, 0, v23
    s_cbranch_execz mn_cn_done
    v_lshrrev_b32 v28, 23, v23
    v_and_b32 v28, 0xfc, v28
    ds_add_rtn_u32 v33, v28, v48
    v_cmpx_gt_i32 vcc, 0, v24
    s_cbranch_execz mn_cn_done
    v_lshrrev_b32 v29, 23, v24
    v_and_b32 v29, 0xfc, v29
    ds_add_rtn_u32 v34, v29, v48
mn_cn_done:
    s_mov_b64 exec, -1
    v_lshrrev_b32 v42, 16, v58
    v_subrev_u32 v42, s24, v42
    v_med3_i32 v42, v42, 0, s20
    v_lshrrev_b32 v55, 16, v44
    v_subrev_u32 v55, s24, v55
    v_med3_i32 v55, v55, 0, s20
    v_lshrrev_b32 v56, 16, v45
    v_subrev_u32 v56, s24, v56
    v_med3_i32 v56, v56, 0, s20
    v_mov_b32 v43, v42
    v_cndmask_b32 v55, 0, v55, s[36:37]
    v_cndmask_b32 v56, 0, v56, s[38:39]
    v_add_u32 v59, v55, v56
    v_mov_b32 v52, 0
    s_lshl_b32 s52, s18, 5
    s_add_u32 s53, s52, 31
    s_waitcnt lgkmcnt(0)
    s_barrier
    ds_read_b32 v53, v47 offset:0
    ds_read_b32 v52, v52 offset:272
    v_add_u32_dpp v59, v59, v59 row_shr:1 row_mask:0xf bank_mask:0xf
    s_nop 1
    v_add_u32_dpp v59, v59, v59 row_shr:2 row_mask:0xf bank_mask:0xf
    s_nop 1
    v_add_u32_dpp v59, v59, v59 row_shr:4 row_mask:0xf bank_mask:0xf
    v_add_u32_dpp v43, v43, v43 row_shr:4 row_mask:0xf bank_mask:0xf
    s_nop 0
    v_add_u32_dpp v59, v59, v59 row_shr:8 row_mask:0xf bank_mask:0xf
    v_add_u32_dpp v43, v43, v43 row_shr:8 row_mask:0xf bank_mask:0xf
    s_nop 0
    v_add_u32_dpp v59, v59, v59 row_bcast:15 row_mask:0xa bank_mask:0xf
    v_add_u32_dpp v43, v43, v43 row_bcast:15 row_mask:0xa bank_mask:0xf
    s_nop 0
    v_add_u32_dpp v59, v59, v59 row_bcast:31 row_mask:0xc bank_mask:0xf
    v_add_u32_dpp v43, v43, v43 row_bcast:31 row_mask:0xc bank_mask:0xf
    s_nop 0
    v_readlane_b32 s49, v59, 63
    v_sub_u32 v41, v43, v42
    s_movk_i32 s48, 0x3fff
    s_waitcnt lgkmcnt(1)
    v_mov_b32 v54, v53
    v_sub_u32 v53, v49, v53
    v_add3_u32 v41, v41, v35, s49
    v_add_u32_dpp v54, v54, v54 row_shr:1 row_mask:0xf bank_mask:0xf
    v_mul_u32_u24 v41, 196608, v41
    v_add_u32 v41, 15466496, v41
    v_add_u32_dpp v54, v54, v54 row_shr:2 row_mask:0xf bank_mask:0xf
    v_and_or_b32 v36, v20, s48, v41
    v_add_u32 v41, 786432, v41
    v_add_u32_dpp v54, v54, v54 row_shr:4 row_mask:0xf bank_mask:0xf
    v_and_or_b32 v37, v21, s48, v41
    v_add_u32 v41, 786432, v41
    v_add_u32_dpp v54, v54, v54 row_shr:8 row_mask:0xf bank_mask:0xf
    v_and_or_b32 v38, v22, s48, v41
    v_add_u32 v41, 786432, v41
    v_add_u32_dpp v54, v54, v54 row_bcast:15 row_mask:0xa bank_mask:0xf
    v_and_or_b32 v39, v23, s48, v41
    v_add_u32 v41, 786432, v41
    v_add_u32_dpp v54, v54, v54 row_bcast:31 row_mask:0xc bank_mask:0xf
    v_add_u32 v53, v53, v54
    v_add_u32 v54, v54, v49
    ds_bpermute_b32 v25, v25, v53
    ds_bpermute_b32 v26, v26, v53
    ds_bpermute_b32 v27, v27, v53
    ds_bpermute_b32 v28, v28, v53
    ds_bpermute_b32 v29, v29, v53
    v_and_or_b32 v40, v24, s48, v41
    v_readlane_b32 s23, v54, 63
    v_readlane_b32 s33, v54, s53
    v_readlane_b32 s32, v53, s52
    s_cmp_gt_u32 s23, 794
    s_cbranch_scc1 mn_ovf
    v_add_lshl_u32 v55, s33, v51, 2
    s_mov_b32 exec_lo, 1048575
    s_mov_b32 exec_hi, 0
    ds_write_b32 v55, v50 offset:512
    s_mov_b64 exec, -1
    v_add_lshl_u32 v2, s32, v2, 2
    v_add_lshl_u32 v3, s32, v3, 2
    v_add_lshl_u32 v18, s32, v18, 2
    s_waitcnt lgkmcnt(1)
    v_readfirstlane_b32 s21, v52
    v_cmpx_gt_i32 vcc, 0, v20
    s_cbranch_execz mn_w2_done
    v_add_lshl_u32 v25, v25, v30, 2
    ds_write_b32 v25, v36 offset:512
    v_cmpx_gt_i32 vcc, 0, v21
    s_cbranch_execz mn_w2_done
    v_add_lshl_u32 v26, v26, v31, 2
    ds_write_b32 v26, v37 offset:512
    v_cmpx_gt_i32 vcc, 0, v22
    s_cbranch_execz mn_w2_done
    v_add_lshl_u32 v27, v27, v32, 2
    ds_write_b32 v27, v38 offset:512
    v_cmpx_gt_i32 vcc, 0, v23
    s_cbranch_execz mn_w2_done
    v_add_lshl_u32 v28, v28, v33, 2
    ds_write_b32 v28, v39 offset:512
    v_cmpx_gt_i32 vcc, 0, v24
    s_cbranch_execz mn_w2_done
    v_add_lshl_u32 v29, v29, v34, 2
    ds_write_b32 v29, v40 offset:512
mn_w2_done:
    s_mov_b64 exec, -1
    s_mov_b32 m0, s40
    s_sub_u32 s32, s32, 3
    s_sub_u32 s59, s33, s32
    s_lshr_b32 s59, s59, 2
    s_waitcnt lgkmcnt(0)
    s_barrier
    ds_read_u16 v4, v2 offset:512
    ds_read_u16 v6, v2 offset:520
    ds_read_u16 v8, v18 offset:514
    ds_read_u16 v84, v3 offset:514
    ds_read_u16 v22, v2 offset:528
    ds_read_u16 v23, v2 offset:536
    ds_read_u16 v24, v2 offset:544
    ds_read_u16 v25, v2 offset:552
    ds_read_u16 v26, v2 offset:560
    ds_read_u16 v27, v2 offset:568
    s_sub_u32 s53, s53, 4
    v_readlane_b32 s84, v54, s53
    s_add_u32 s53, s53, 1
    v_readlane_b32 s85, v54, s53
    s_add_u32 s53, s53, 1
    v_readlane_b32 s86, v54, s53
    s_add_u32 s53, s53, 1
    v_readlane_b32 s87, v54, s53
    s_waitcnt lgkmcnt(8)
    buffer_load_dwordx4 v[4:5], s[4:7], 0 idxen offen lds
    s_mov_b32 m0, s41
    s_waitcnt lgkmcnt(6)
    buffer_load_dwordx4 v[6:7], s[4:7], 0 idxen offen lds
    v_lshlrev_b32 v8, 4, v8
    v_lshl_add_u32 v84, v84, 4, v86
    v_xor_b32 v85, 0x40000, v84
    s_waitcnt lgkmcnt(0)
    s_mov_b32 m0, s42
    v_mov_b32 v4, v22
    buffer_load_dwordx4 v[4:5], s[4:7], 0 idxen offen lds
    s_mov_b32 m0, s43
    v_mov_b32 v4, v23
    buffer_load_dwordx4 v[4:5], s[4:7], 0 idxen offen lds
    s_setprio 3
    s_waitcnt vmcnt(4) lgkmcnt(0)
    s_barrier
    ds_read_b128 v[8:11], v8 offset:32
    ds_read_b128 v[60:63], v84
    ds_read_b128 v[64:67], v85
    s_mov_b32 m0, s44
    v_mov_b32 v4, v24
    buffer_load_dwordx4 v[4:5], s[4:7], 0 idxen offen lds
    s_mov_b32 m0, s45
    v_mov_b32 v4, v25
    buffer_load_dwordx4 v[4:5], s[4:7], 0 idxen offen lds
    v_mov_b32 v4, v26
    v_mov_b32 v6, v27
    s_waitcnt vmcnt(4)
    ds_read_b64_tr_b16 v[20:21], v1 offset:0
    ds_read_b64_tr_b16 v[22:23], v1 offset:512
    ds_read_b64_tr_b16 v[24:25], v1 offset:1024
    ds_read_b64_tr_b16 v[26:27], v1 offset:1536
    s_waitcnt lgkmcnt(6)
    v_mfma_f32_4x4x4_16b_bf16 v[28:31], v[8:9], v[76:77], 0
    v_mfma_f32_4x4x4_16b_bf16 v[32:35], v[8:9], v[78:79], 0
    v_mfma_f32_4x4x4_16b_bf16 v[36:39], v[8:9], v[80:81], 0
    v_mfma_f32_4x4x4_16b_bf16 v[40:43], v[8:9], v[82:83], 0
    v_min_u32 v0, 1, v51
    v_lshlrev_b32 v0, 18, v0
    v_lshl_add_u32 v0, s17, 2, v0
    s_lshl_b32 s52, s18, 1
    s_sub_i32 s52, 1, s52
    s_mul_i32 s53, s52, s59
    s_add_i32 s53, s53, 2
    v_mov_b32 v19, s53
    v_and_b32 v11, 0xff, v11
    v_or_b32 v11, 0xc000, v11
    v_lshlrev_b32 v10, 16, v11
    s_waitcnt lgkmcnt(4)
    v_mfma_f32_32x32x16_bf16 v[44:59], v[60:63], v[68:71], 0
    v_mfma_f32_32x32x16_bf16 v[44:59], v[64:67], v[72:75], v[44:59]
    s_mov_b32 m0, s40
    s_waitcnt lgkmcnt(0)
    buffer_load_dwordx4 v[4:5], s[4:7], 0 idxen offen lds
    s_mov_b32 m0, s41
    ds_add_u32 v0, v19 offset:288
    buffer_load_dwordx4 v[6:7], s[4:7], 0 idxen offen lds
    v_or_b32_dpp v19, v10, v11 row_shl:4 row_mask:0xf bank_mask:0xf bound_ctrl:0
    v_cvt_pk_bf16_f32 v12, v28, v32
    v_cvt_pk_bf16_f32 v14, v29, v33
    v_cvt_pk_bf16_f32 v16, v30, v34
    v_cvt_pk_bf16_f32 v13, v36, v40
    v_cvt_pk_bf16_f32 v15, v37, v41
    v_cvt_pk_bf16_f32 v17, v38, v42
    s_sub_u32 s84, s84, s32
    s_lshr_b32 s84, s84, 2
    s_sub_u32 s85, s85, s32
    s_lshr_b32 s85, s85, 2
    s_sub_u32 s86, s86, s32
    s_lshr_b32 s86, s86, 2
    s_sub_u32 s87, s87, s32
    s_lshr_b32 s87, s87, 2
    s_sub_u32 s88, s59, s87
    s_sub_u32 s87, s87, s86
    s_sub_u32 s86, s86, s85
    s_sub_u32 s85, s85, s84
    s_cmp_lg_u32 s21, 0
    s_cselect_b32 s19, s59, s84
    s_mov_b32 s58, 0
    s_mov_b32 s35, 0
    s_sub_i32 s34, s59, 4
    s_max_i32 s34, s34, 0
    s_mul_i32 s30, s52, -4
    s_lshl_b32 s26, s18, 31
    s_set_gpr_idx_on s40, gpr_idx(SRC2,DST)
    s_sub_u32 s19, s19, 1
    s_cbranch_scc1 mn_st12
mn_st12_back:
mn_loop:
    v_mfma_f32_4x4x4_16b_bf16 v[28:31], v[12:13], v[20:21], 0 cbsz:4 abid:0
    v_mfma_f32_4x4x4_16b_bf16 v[32:35], v[12:13], v[22:23], 0 cbsz:4 abid:1
    v_mfma_f32_4x4x4_16b_bf16 v[36:39], v[12:13], v[24:25], 0 cbsz:4 abid:2
    v_mfma_f32_4x4x4_16b_bf16 v[40:43], v[12:13], v[26:27], 0 cbsz:4 abid:3
    ds_read_u16 v4, v2 offset:576
    ds_read_u16 v6, v2 offset:584
    v_readlane_b32 s28, v19, 0
    v_readlane_b32 s29, v19, 8
    s_waitcnt vmcnt(5)
    ds_read_b64_tr_b16 v[20:21], v1 offset:2048
    ds_read_b64_tr_b16 v[22:23], v1 offset:2560
    s_waitcnt vmcnt(4)
    ds_read_b64_tr_b16 v[24:25], v1 offset:3072
    ds_read_b64_tr_b16 v[26:27], v1 offset:3584
    s_sub_u32 s34, s34, 1
    s_cmov_b32 s35, 0x30000
    s_mov_b32 m0, s28
    v_fmac_f32 v88, v28, v44
    v_fmac_f32 v89, v29, v44
    v_fmac_f32 v90, v30, v44
    v_fmac_f32 v91, v31, v44
    s_lshr_b32 m0, s28, 16
    v_fmac_f32 v88, v32, v45
    v_fmac_f32 v89, v33, v45
    v_fmac_f32 v90, v34, v45
    v_fmac_f32 v91, v35, v45
    s_mov_b32 m0, s29
    v_fmac_f32 v88, v36, v46
    v_fmac_f32 v89, v37, v46
    v_fmac_f32 v90, v38, v46
    v_fmac_f32 v91, v39, v46
    s_lshr_b32 m0, s29, 16
    v_fmac_f32 v88, v40, v47
    v_fmac_f32 v89, v41, v47
    v_fmac_f32 v90, v42, v47
    v_fmac_f32 v91, v43, v47
    s_or_b32 m0, s42, s35
    s_waitcnt lgkmcnt(2)
    buffer_load_dwordx4 v[4:5], s[4:7], 0 idxen offen lds
    s_or_b32 m0, s43, s35
    s_waitcnt lgkmcnt(0)
    buffer_load_dwordx4 v[6:7], s[4:7], 0 idxen offen lds
    s_sub_u32 s19, s19, 1
    s_cbranch_scc1 mn_st0
mn_st0_back:
    v_mfma_f32_4x4x4_16b_bf16 v[28:31], v[12:13], v[20:21], 0 cbsz:4 abid:4
    v_mfma_f32_4x4x4_16b_bf16 v[32:35], v[12:13], v[22:23], 0 cbsz:4 abid:5
    v_mfma_f32_4x4x4_16b_bf16 v[36:39], v[12:13], v[24:25], 0 cbsz:4 abid:6
    v_mfma_f32_4x4x4_16b_bf16 v[40:43], v[12:13], v[26:27], 0 cbsz:4 abid:7
    ds_read_u16 v4, v2 offset:592
    ds_read_u16 v6, v2 offset:600
    v_readlane_b32 s28, v19, 16
    v_readlane_b32 s29, v19, 24
    ds_read_u16 v84, v3 offset:578
    s_waitcnt vmcnt(5)
    ds_read_b64_tr_b16 v[20:21], v1 offset:4096
    ds_read_b64_tr_b16 v[22:23], v1 offset:4608
    s_waitcnt vmcnt(4)
    ds_read_b64_tr_b16 v[24:25], v1 offset:5120
    ds_read_b64_tr_b16 v[26:27], v1 offset:5632
    s_sub_u32 s34, s34, 1
    s_cmov_b32 s35, 0x30000
    s_mov_b32 m0, s28
    v_fmac_f32 v88, v28, v48
    v_fmac_f32 v89, v29, v48
    v_fmac_f32 v90, v30, v48
    v_fmac_f32 v91, v31, v48
    s_lshr_b32 m0, s28, 16
    v_fmac_f32 v88, v32, v49
    v_fmac_f32 v89, v33, v49
    v_fmac_f32 v90, v34, v49
    v_fmac_f32 v91, v35, v49
    s_mov_b32 m0, s29
    v_fmac_f32 v88, v36, v50
    v_fmac_f32 v89, v37, v50
    v_fmac_f32 v90, v38, v50
    v_fmac_f32 v91, v39, v50
    s_lshr_b32 m0, s29, 16
    v_fmac_f32 v88, v40, v51
    v_fmac_f32 v89, v41, v51
    v_fmac_f32 v90, v42, v51
    v_fmac_f32 v91, v43, v51
    s_or_b32 m0, s44, s35
    s_waitcnt lgkmcnt(2)
    buffer_load_dwordx4 v[4:5], s[4:7], 0 idxen offen lds
    s_or_b32 m0, s45, s35
    s_waitcnt lgkmcnt(0)
    buffer_load_dwordx4 v[6:7], s[4:7], 0 idxen offen lds
    s_sub_u32 s19, s19, 1
    s_cbranch_scc1 mn_st1
mn_st1_back:
    v_mfma_f32_4x4x4_16b_bf16 v[28:31], v[12:13], v[20:21], 0 cbsz:4 abid:8
    v_mfma_f32_4x4x4_16b_bf16 v[32:35], v[12:13], v[22:23], 0 cbsz:4 abid:9
    v_mfma_f32_4x4x4_16b_bf16 v[36:39], v[12:13], v[24:25], 0 cbsz:4 abid:10
    v_mfma_f32_4x4x4_16b_bf16 v[40:43], v[12:13], v[26:27], 0 cbsz:4 abid:11
    ds_read_u16 v4, v2 offset:608
    ds_read_u16 v6, v2 offset:616
    v_readlane_b32 s28, v19, 32
    v_readlane_b32 s29, v19, 40
    v_lshl_add_u32 v84, v84, 4, v86
    v_xor_b32 v85, 0x40000, v84
    ds_read_b128 v[60:63], v84
    ds_read_b128 v[64:67], v85
    s_waitcnt vmcnt(5)
    ds_read_b64_tr_b16 v[20:21], v1 offset:0
    ds_read_b64_tr_b16 v[22:23], v1 offset:512
    s_waitcnt vmcnt(4)
    ds_read_b64_tr_b16 v[24:25], v1 offset:1024
    ds_read_b64_tr_b16 v[26:27], v1 offset:1536
    s_sub_u32 s34, s34, 1
    s_cmov_b32 s35, 0x30000
    s_mov_b32 m0, s28
    v_fmac_f32 v88, v28, v52
    v_fmac_f32 v89, v29, v52
    v_fmac_f32 v90, v30, v52
    v_fmac_f32 v91, v31, v52
    s_lshr_b32 m0, s28, 16
    v_fmac_f32 v88, v32, v53
    v_fmac_f32 v89, v33, v53
    v_fmac_f32 v90, v34, v53
    v_fmac_f32 v91, v35, v53
    s_mov_b32 m0, s29
    v_fmac_f32 v88, v36, v54
    v_fmac_f32 v89, v37, v54
    v_fmac_f32 v90, v38, v54
    v_fmac_f32 v91, v39, v54
    s_lshr_b32 m0, s29, 16
    v_fmac_f32 v88, v40, v55
    v_fmac_f32 v89, v41, v55
    v_fmac_f32 v90, v42, v55
    v_fmac_f32 v91, v43, v55
    s_or_b32 m0, s40, s35
    s_waitcnt lgkmcnt(2)
    buffer_load_dwordx4 v[4:5], s[4:7], 0 idxen offen lds
    s_or_b32 m0, s41, s35
    s_waitcnt lgkmcnt(0)
    buffer_load_dwordx4 v[6:7], s[4:7], 0 idxen offen lds
    s_sub_u32 s19, s19, 1
    s_cbranch_scc1 mn_st2
mn_st2_back:
    v_mfma_f32_4x4x4_16b_bf16 v[28:31], v[12:13], v[20:21], 0 cbsz:4 abid:12
    v_mfma_f32_4x4x4_16b_bf16 v[32:35], v[12:13], v[22:23], 0 cbsz:4 abid:13
    v_mfma_f32_4x4x4_16b_bf16 v[36:39], v[12:13], v[24:25], 0 cbsz:4 abid:14
    v_mfma_f32_4x4x4_16b_bf16 v[40:43], v[12:13], v[26:27], 0 cbsz:4 abid:15
    ds_read_u16 v4, v2 offset:624
    ds_read_u16 v6, v2 offset:632
    v_readlane_b32 s28, v19, 48
    v_readlane_b32 s29, v19, 56
    v_mov_b32 v85, s30
    ds_add_rtn_u32 v85, v0, v85 offset:288
    s_waitcnt vmcnt(5)
    ds_read_b64_tr_b16 v[20:21], v1 offset:2048
    ds_read_b64_tr_b16 v[22:23], v1 offset:2560
    s_waitcnt vmcnt(4)
    ds_read_b64_tr_b16 v[24:25], v1 offset:3072
    ds_read_b64_tr_b16 v[26:27], v1 offset:3584
    s_sub_u32 s34, s34, 1
    s_cmov_b32 s35, 0x30000
    s_mov_b32 m0, s28
    v_fmac_f32 v88, v28, v56
    v_fmac_f32 v89, v29, v56
    v_fmac_f32 v90, v30, v56
    v_fmac_f32 v91, v31, v56
    s_lshr_b32 m0, s28, 16
    v_fmac_f32 v88, v32, v57
    v_fmac_f32 v89, v33, v57
    v_fmac_f32 v90, v34, v57
    v_fmac_f32 v91, v35, v57
    s_mov_b32 m0, s29
    v_fmac_f32 v88, v36, v58
    v_fmac_f32 v89, v37, v58
    v_fmac_f32 v90, v38, v58
    v_fmac_f32 v91, v39, v58
    s_lshr_b32 m0, s29, 16
    v_fmac_f32 v88, v40, v59
    v_fmac_f32 v89, v41, v59
    v_fmac_f32 v90, v42, v59
    v_fmac_f32 v91, v43, v59
    s_or_b32 m0, s42, s35
    v_mfma_f32_32x32x16_bf16 v[44:59], v[60:63], v[68:71], 0
    v_mfma_f32_32x32x16_bf16 v[44:59], v[64:67], v[72:75], v[44:59]
    s_waitcnt lgkmcnt(2)
    buffer_load_dwordx4 v[4:5], s[4:7], 0 idxen offen lds
    s_or_b32 m0, s43, s35
    s_waitcnt lgkmcnt(0)
    buffer_load_dwordx4 v[6:7], s[4:7], 0 idxen offen lds
    v_readfirstlane_b32 s27, v85
    s_setprio 3
    s_xor_b32 s27, s27, s26
    s_cmp_ge_i32 s27, 0
    s_cbranch_scc1 mn_pr3
    s_setprio 2
mn_pr3:
    s_sub_u32 s19, s19, 1
    s_cbranch_scc1 mn_st3
mn_st3_back:
    v_mfma_f32_4x4x4_16b_bf16 v[28:31], v[14:15], v[20:21], 0 cbsz:4 abid:0
    v_mfma_f32_4x4x4_16b_bf16 v[32:35], v[14:15], v[22:23], 0 cbsz:4 abid:1
    v_mfma_f32_4x4x4_16b_bf16 v[36:39], v[14:15], v[24:25], 0 cbsz:4 abid:2
    v_mfma_f32_4x4x4_16b_bf16 v[40:43], v[14:15], v[26:27], 0 cbsz:4 abid:3
    ds_read_u16 v4, v2 offset:640
    ds_read_u16 v6, v2 offset:648
    v_readlane_b32 s28, v19, 1
    v_readlane_b32 s29, v19, 9
    s_waitcnt vmcnt(5)
    ds_read_b64_tr_b16 v[20:21], v1 offset:4096
    ds_read_b64_tr_b16 v[22:23], v1 offset:4608
    s_waitcnt vmcnt(4)
    ds_read_b64_tr_b16 v[24:25], v1 offset:5120
    ds_read_b64_tr_b16 v[26:27], v1 offset:5632
    s_sub_u32 s34, s34, 1
    s_cmov_b32 s35, 0x30000
    s_mov_b32 m0, s28
    v_fmac_f32 v88, v28, v44
    v_fmac_f32 v89, v29, v44
    v_fmac_f32 v90, v30, v44
    v_fmac_f32 v91, v31, v44
    s_lshr_b32 m0, s28, 16
    v_fmac_f32 v88, v32, v45
    v_fmac_f32 v89, v33, v45
    v_fmac_f32 v90, v34, v45
    v_fmac_f32 v91, v35, v45
    s_mov_b32 m0, s29
    v_fmac_f32 v88, v36, v46
    v_fmac_f32 v89, v37, v46
    v_fmac_f32 v90, v38, v46
    v_fmac_f32 v91, v39, v46
    s_lshr_b32 m0, s29, 16
    v_fmac_f32 v88, v40, v47
    v_fmac_f32 v89, v41, v47
    v_fmac_f32 v90, v42, v47
    v_fmac_f32 v91, v43, v47
    s_or_b32 m0, s44, s35
    s_waitcnt lgkmcnt(2)
    buffer_load_dwordx4 v[4:5], s[4:7], 0 idxen offen lds
    s_or_b32 m0, s45, s35
    s_waitcnt lgkmcnt(0)
    buffer_load_dwordx4 v[6:7], s[4:7], 0 idxen offen lds
    s_sub_u32 s19, s19, 1
    s_cbranch_scc1 mn_st4
mn_st4_back:
    v_mfma_f32_4x4x4_16b_bf16 v[28:31], v[14:15], v[20:21], 0 cbsz:4 abid:4
    v_mfma_f32_4x4x4_16b_bf16 v[32:35], v[14:15], v[22:23], 0 cbsz:4 abid:5
    v_mfma_f32_4x4x4_16b_bf16 v[36:39], v[14:15], v[24:25], 0 cbsz:4 abid:6
    v_mfma_f32_4x4x4_16b_bf16 v[40:43], v[14:15], v[26:27], 0 cbsz:4 abid:7
    ds_read_u16 v4, v2 offset:656
    ds_read_u16 v6, v2 offset:664
    v_readlane_b32 s28, v19, 17
    v_readlane_b32 s29, v19, 25
    ds_read_u16 v84, v3 offset:642
    s_waitcnt vmcnt(5)
    ds_read_b64_tr_b16 v[20:21], v1 offset:0
    ds_read_b64_tr_b16 v[22:23], v1 offset:512
    s_waitcnt vmcnt(4)
    ds_read_b64_tr_b16 v[24:25], v1 offset:1024
    ds_read_b64_tr_b16 v[26:27], v1 offset:1536
    s_sub_u32 s34, s34, 1
    s_cmov_b32 s35, 0x30000
    s_mov_b32 m0, s28
    v_fmac_f32 v88, v28, v48
    v_fmac_f32 v89, v29, v48
    v_fmac_f32 v90, v30, v48
    v_fmac_f32 v91, v31, v48
    s_lshr_b32 m0, s28, 16
    v_fmac_f32 v88, v32, v49
    v_fmac_f32 v89, v33, v49
    v_fmac_f32 v90, v34, v49
    v_fmac_f32 v91, v35, v49
    s_mov_b32 m0, s29
    v_fmac_f32 v88, v36, v50
    v_fmac_f32 v89, v37, v50
    v_fmac_f32 v90, v38, v50
    v_fmac_f32 v91, v39, v50
    s_lshr_b32 m0, s29, 16
    v_fmac_f32 v88, v40, v51
    v_fmac_f32 v89, v41, v51
    v_fmac_f32 v90, v42, v51
    v_fmac_f32 v91, v43, v51
    s_or_b32 m0, s40, s35
    s_waitcnt lgkmcnt(2)
    buffer_load_dwordx4 v[4:5], s[4:7], 0 idxen offen lds
    s_or_b32 m0, s41, s35
    s_waitcnt lgkmcnt(0)
    buffer_load_dwordx4 v[6:7], s[4:7], 0 idxen offen lds
    s_sub_u32 s19, s19, 1
    s_cbranch_scc1 mn_st5
mn_st5_back:
    v_mfma_f32_4x4x4_16b_bf16 v[28:31], v[14:15], v[20:21], 0 cbsz:4 abid:8
    v_mfma_f32_4x4x4_16b_bf16 v[32:35], v[14:15], v[22:23], 0 cbsz:4 abid:9
    v_mfma_f32_4x4x4_16b_bf16 v[36:39], v[14:15], v[24:25], 0 cbsz:4 abid:10
    v_mfma_f32_4x4x4_16b_bf16 v[40:43], v[14:15], v[26:27], 0 cbsz:4 abid:11
    ds_read_u16 v4, v2 offset:672
    ds_read_u16 v6, v2 offset:680
    v_readlane_b32 s28, v19, 33
    v_readlane_b32 s29, v19, 41
    v_lshl_add_u32 v84, v84, 4, v86
    v_xor_b32 v85, 0x40000, v84
    ds_read_b128 v[60:63], v84
    ds_read_b128 v[64:67], v85
    s_waitcnt vmcnt(5)
    ds_read_b64_tr_b16 v[20:21], v1 offset:2048
    ds_read_b64_tr_b16 v[22:23], v1 offset:2560
    s_waitcnt vmcnt(4)
    ds_read_b64_tr_b16 v[24:25], v1 offset:3072
    ds_read_b64_tr_b16 v[26:27], v1 offset:3584
    s_sub_u32 s34, s34, 1
    s_cmov_b32 s35, 0x30000
    s_mov_b32 m0, s28
    v_fmac_f32 v88, v28, v52
    v_fmac_f32 v89, v29, v52
    v_fmac_f32 v90, v30, v52
    v_fmac_f32 v91, v31, v52
    s_lshr_b32 m0, s28, 16
    v_fmac_f32 v88, v32, v53
    v_fmac_f32 v89, v33, v53
    v_fmac_f32 v90, v34, v53
    v_fmac_f32 v91, v35, v53
    s_mov_b32 m0, s29
    v_fmac_f32 v88, v36, v54
    v_fmac_f32 v89, v37, v54
    v_fmac_f32 v90, v38, v54
    v_fmac_f32 v91, v39, v54
    s_lshr_b32 m0, s29, 16
    v_fmac_f32 v88, v40, v55
    v_fmac_f32 v89, v41, v55
    v_fmac_f32 v90, v42, v55
    v_fmac_f32 v91, v43, v55
    s_or_b32 m0, s42, s35
    s_waitcnt lgkmcnt(2)
    buffer_load_dwordx4 v[4:5], s[4:7], 0 idxen offen lds
    s_or_b32 m0, s43, s35
    s_waitcnt lgkmcnt(0)
    buffer_load_dwordx4 v[6:7], s[4:7], 0 idxen offen lds
    s_sub_u32 s19, s19, 1
    s_cbranch_scc1 mn_st6
mn_st6_back:
    v_mfma_f32_4x4x4_16b_bf16 v[28:31], v[14:15], v[20:21], 0 cbsz:4 abid:12
    v_mfma_f32_4x4x4_16b_bf16 v[32:35], v[14:15], v[22:23], 0 cbsz:4 abid:13
    v_mfma_f32_4x4x4_16b_bf16 v[36:39], v[14:15], v[24:25], 0 cbsz:4 abid:14
    v_mfma_f32_4x4x4_16b_bf16 v[40:43], v[14:15], v[26:27], 0 cbsz:4 abid:15
    ds_read_u16 v4, v2 offset:688
    ds_read_u16 v6, v2 offset:696
    v_readlane_b32 s28, v19, 49
    v_readlane_b32 s29, v19, 57
    v_mov_b32 v85, s30
    ds_add_rtn_u32 v85, v0, v85 offset:288
    s_waitcnt vmcnt(5)
    ds_read_b64_tr_b16 v[20:21], v1 offset:4096
    ds_read_b64_tr_b16 v[22:23], v1 offset:4608
    s_waitcnt vmcnt(4)
    ds_read_b64_tr_b16 v[24:25], v1 offset:5120
    ds_read_b64_tr_b16 v[26:27], v1 offset:5632
    s_sub_u32 s34, s34, 1
    s_cmov_b32 s35, 0x30000
    s_mov_b32 m0, s28
    v_fmac_f32 v88, v28, v56
    v_fmac_f32 v89, v29, v56
    v_fmac_f32 v90, v30, v56
    v_fmac_f32 v91, v31, v56
    s_lshr_b32 m0, s28, 16
    v_fmac_f32 v88, v32, v57
    v_fmac_f32 v89, v33, v57
    v_fmac_f32 v90, v34, v57
    v_fmac_f32 v91, v35, v57
    s_mov_b32 m0, s29
    v_fmac_f32 v88, v36, v58
    v_fmac_f32 v89, v37, v58
    v_fmac_f32 v90, v38, v58
    v_fmac_f32 v91, v39, v58
    s_lshr_b32 m0, s29, 16
    v_fmac_f32 v88, v40, v59
    v_fmac_f32 v89, v41, v59
    v_fmac_f32 v90, v42, v59
    v_fmac_f32 v91, v43, v59
    s_or_b32 m0, s44, s35
    v_mfma_f32_32x32x16_bf16 v[44:59], v[60:63], v[68:71], 0
    v_mfma_f32_32x32x16_bf16 v[44:59], v[64:67], v[72:75], v[44:59]
    s_waitcnt lgkmcnt(2)
    buffer_load_dwordx4 v[4:5], s[4:7], 0 idxen offen lds
    s_or_b32 m0, s45, s35
    s_waitcnt lgkmcnt(0)
    buffer_load_dwordx4 v[6:7], s[4:7], 0 idxen offen lds
    v_readfirstlane_b32 s27, v85
    s_setprio 3
    s_xor_b32 s27, s27, s26
    s_cmp_ge_i32 s27, 0
    s_cbranch_scc1 mn_pr7
    s_setprio 2
mn_pr7:
    s_sub_u32 s19, s19, 1
    s_cbranch_scc1 mn_st7
mn_st7_back:
    v_mfma_f32_4x4x4_16b_bf16 v[28:31], v[16:17], v[20:21], 0 cbsz:4 abid:0
    v_mfma_f32_4x4x4_16b_bf16 v[32:35], v[16:17], v[22:23], 0 cbsz:4 abid:1
    v_mfma_f32_4x4x4_16b_bf16 v[36:39], v[16:17], v[24:25], 0 cbsz:4 abid:2
    v_mfma_f32_4x4x4_16b_bf16 v[40:43], v[16:17], v[26:27], 0 cbsz:4 abid:3
    ds_read_u16 v4, v2 offset:704
    ds_read_u16 v6, v2 offset:712
    v_readlane_b32 s28, v19, 2
    v_readlane_b32 s29, v19, 10
    ds_read_u16 v8, v18 offset:706
    s_waitcnt vmcnt(5)
    ds_read_b64_tr_b16 v[20:21], v1 offset:0
    ds_read_b64_tr_b16 v[22:23], v1 offset:512
    s_waitcnt vmcnt(4)
    ds_read_b64_tr_b16 v[24:25], v1 offset:1024
    ds_read_b64_tr_b16 v[26:27], v1 offset:1536
    s_sub_u32 s34, s34, 1
    s_cmov_b32 s35, 0x30000
    s_mov_b32 m0, s28
    v_fmac_f32 v88, v28, v44
    v_fmac_f32 v89, v29, v44
    v_fmac_f32 v90, v30, v44
    v_fmac_f32 v91, v31, v44
    s_lshr_b32 m0, s28, 16
    v_fmac_f32 v88, v32, v45
    v_fmac_f32 v89, v33, v45
    v_fmac_f32 v90, v34, v45
    v_fmac_f32 v91, v35, v45
    s_mov_b32 m0, s29
    v_fmac_f32 v88, v36, v46
    v_fmac_f32 v89, v37, v46
    v_fmac_f32 v90, v38, v46
    v_fmac_f32 v91, v39, v46
    s_lshr_b32 m0, s29, 16
    v_fmac_f32 v88, v40, v47
    v_fmac_f32 v89, v41, v47
    v_fmac_f32 v90, v42, v47
    v_fmac_f32 v91, v43, v47
    s_or_b32 m0, s40, s35
    s_waitcnt lgkmcnt(2)
    buffer_load_dwordx4 v[4:5], s[4:7], 0 idxen offen lds
    s_or_b32 m0, s41, s35
    s_waitcnt lgkmcnt(0)
    buffer_load_dwordx4 v[6:7], s[4:7], 0 idxen offen lds
    s_sub_u32 s19, s19, 1
    s_cbranch_scc1 mn_st8
mn_st8_back:
    v_mfma_f32_4x4x4_16b_bf16 v[28:31], v[16:17], v[20:21], 0 cbsz:4 abid:4
    v_mfma_f32_4x4x4_16b_bf16 v[32:35], v[16:17], v[22:23], 0 cbsz:4 abid:5
    v_mfma_f32_4x4x4_16b_bf16 v[36:39], v[16:17], v[24:25], 0 cbsz:4 abid:6
    v_mfma_f32_4x4x4_16b_bf16 v[40:43], v[16:17], v[26:27], 0 cbsz:4 abid:7
    ds_read_u16 v4, v2 offset:720
    ds_read_u16 v6, v2 offset:728
    v_readlane_b32 s28, v19, 18
    v_readlane_b32 s29, v19, 26
    ds_read_u16 v84, v3 offset:706
    v_lshlrev_b32 v8, 4, v8
    ds_read_b128 v[8:11], v8 offset:32
    s_waitcnt vmcnt(5)
    ds_read_b64_tr_b16 v[20:21], v1 offset:2048
    ds_read_b64_tr_b16 v[22:23], v1 offset:2560
    s_waitcnt vmcnt(4)
    ds_read_b64_tr_b16 v[24:25], v1 offset:3072
    ds_read_b64_tr_b16 v[26:27], v1 offset:3584
    s_sub_u32 s34, s34, 1
    s_cmov_b32 s35, 0x30000
    s_mov_b32 m0, s28
    v_fmac_f32 v88, v28, v48
    v_fmac_f32 v89, v29, v48
    v_fmac_f32 v90, v30, v48
    v_fmac_f32 v91, v31, v48
    s_lshr_b32 m0, s28, 16
    v_fmac_f32 v88, v32, v49
    v_fmac_f32 v89, v33, v49
    v_fmac_f32 v90, v34, v49
    v_fmac_f32 v91, v35, v49
    s_mov_b32 m0, s29
    v_fmac_f32 v88, v36, v50
    v_fmac_f32 v89, v37, v50
    v_fmac_f32 v90, v38, v50
    v_fmac_f32 v91, v39, v50
    s_lshr_b32 m0, s29, 16
    v_fmac_f32 v88, v40, v51
    v_fmac_f32 v89, v41, v51
    v_fmac_f32 v90, v42, v51
    v_fmac_f32 v91, v43, v51
    s_or_b32 m0, s42, s35
    s_waitcnt lgkmcnt(2)
    buffer_load_dwordx4 v[4:5], s[4:7], 0 idxen offen lds
    s_or_b32 m0, s43, s35
    s_waitcnt lgkmcnt(0)
    buffer_load_dwordx4 v[6:7], s[4:7], 0 idxen offen lds
    s_sub_u32 s19, s19, 1
    s_cbranch_scc1 mn_st9
mn_st9_back:
    v_mfma_f32_4x4x4_16b_bf16 v[28:31], v[16:17], v[20:21], 0 cbsz:4 abid:8
    v_mfma_f32_4x4x4_16b_bf16 v[32:35], v[16:17], v[22:23], 0 cbsz:4 abid:9
    v_mfma_f32_4x4x4_16b_bf16 v[36:39], v[16:17], v[24:25], 0 cbsz:4 abid:10
    v_mfma_f32_4x4x4_16b_bf16 v[40:43], v[16:17], v[26:27], 0 cbsz:4 abid:11
    ds_read_u16 v4, v2 offset:736
    ds_read_u16 v6, v2 offset:744
    v_readlane_b32 s28, v19, 34
    v_readlane_b32 s29, v19, 42
    v_lshl_add_u32 v84, v84, 4, v86
    v_xor_b32 v85, 0x40000, v84
    ds_read_b128 v[60:63], v84
    ds_read_b128 v[64:67], v85
    s_waitcnt vmcnt(5)
    ds_read_b64_tr_b16 v[20:21], v1 offset:4096
    ds_read_b64_tr_b16 v[22:23], v1 offset:4608
    s_waitcnt vmcnt(4)
    ds_read_b64_tr_b16 v[24:25], v1 offset:5120
    ds_read_b64_tr_b16 v[26:27], v1 offset:5632
    s_sub_u32 s34, s34, 1
    s_cmov_b32 s35, 0x30000
    s_mov_b32 m0, s28
    v_fmac_f32 v88, v28, v52
    v_fmac_f32 v89, v29, v52
    v_fmac_f32 v90, v30, v52
    v_fmac_f32 v91, v31, v52
    s_lshr_b32 m0, s28, 16
    v_fmac_f32 v88, v32, v53
    v_fmac_f32 v89, v33, v53
    v_fmac_f32 v90, v34, v53
    v_fmac_f32 v91, v35, v53
    s_mov_b32 m0, s29
    v_fmac_f32 v88, v36, v54
    v_fmac_f32 v89, v37, v54
    v_fmac_f32 v90, v38, v54
    v_fmac_f32 v91, v39, v54
    s_lshr_b32 m0, s29, 16
    v_fmac_f32 v88, v40, v55
    v_fmac_f32 v89, v41, v55
    v_fmac_f32 v90, v42, v55
    v_fmac_f32 v91, v43, v55
    s_or_b32 m0, s44, s35
    s_waitcnt lgkmcnt(2)
    buffer_load_dwordx4 v[4:5], s[4:7], 0 idxen offen lds
    s_or_b32 m0, s45, s35
    s_waitcnt lgkmcnt(0)
    buffer_load_dwordx4 v[6:7], s[4:7], 0 idxen offen lds
    v_and_b32 v11, 0xff, v11
    v_or_b32 v11, 0xc000, v11
    v_lshlrev_b32 v10, 16, v11
    s_sub_u32 s19, s19, 1
    s_cbranch_scc1 mn_st10
mn_st10_back:
    v_mfma_f32_4x4x4_16b_bf16 v[28:31], v[16:17], v[20:21], 0 cbsz:4 abid:12
    v_mfma_f32_4x4x4_16b_bf16 v[32:35], v[16:17], v[22:23], 0 cbsz:4 abid:13
    v_mfma_f32_4x4x4_16b_bf16 v[36:39], v[16:17], v[24:25], 0 cbsz:4 abid:14
    v_mfma_f32_4x4x4_16b_bf16 v[40:43], v[16:17], v[26:27], 0 cbsz:4 abid:15
    ds_read_u16 v4, v2 offset:752
    ds_read_u16 v6, v2 offset:760
    v_readlane_b32 s28, v19, 50
    v_readlane_b32 s29, v19, 58
    v_mov_b32 v85, s30
    ds_add_rtn_u32 v85, v0, v85 offset:288
    s_waitcnt vmcnt(5)
    ds_read_b64_tr_b16 v[20:21], v1 offset:0
    ds_read_b64_tr_b16 v[22:23], v1 offset:512
    s_waitcnt vmcnt(4)
    ds_read_b64_tr_b16 v[24:25], v1 offset:1024
    ds_read_b64_tr_b16 v[26:27], v1 offset:1536
    s_sub_u32 s34, s34, 1
    s_cmov_b32 s35, 0x30000
    s_mov_b32 m0, s28
    v_fmac_f32 v88, v28, v56
    v_fmac_f32 v89, v29, v56
    v_fmac_f32 v90, v30, v56
    v_fmac_f32 v91, v31, v56
    s_lshr_b32 m0, s28, 16
    v_fmac_f32 v88, v32, v57
    v_fmac_f32 v89, v33, v57
    v_fmac_f32 v90, v34, v57
    v_fmac_f32 v91, v35, v57
    s_mov_b32 m0, s29
    v_fmac_f32 v88, v36, v58
    v_fmac_f32 v89, v37, v58
    v_fmac_f32 v90, v38, v58
    v_fmac_f32 v91, v39, v58
    s_lshr_b32 m0, s29, 16
    v_fmac_f32 v88, v40, v59
    v_fmac_f32 v89, v41, v59
    v_fmac_f32 v90, v42, v59
    v_fmac_f32 v91, v43, v59
    s_or_b32 m0, s40, s35
    v_mfma_f32_4x4x4_16b_bf16 v[28:31], v[8:9], v[76:77], 0
    v_mfma_f32_4x4x4_16b_bf16 v[32:35], v[8:9], v[78:79], 0
    v_mfma_f32_4x4x4_16b_bf16 v[36:39], v[8:9], v[80:81], 0
    v_mfma_f32_4x4x4_16b_bf16 v[40:43], v[8:9], v[82:83], 0
    v_mfma_f32_32x32x16_bf16 v[44:59], v[60:63], v[68:71], 0
    v_mfma_f32_32x32x16_bf16 v[44:59], v[64:67], v[72:75], v[44:59]
    s_waitcnt lgkmcnt(2)
    buffer_load_dwordx4 v[4:5], s[4:7], 0 idxen offen lds
    s_or_b32 m0, s41, s35
    s_waitcnt lgkmcnt(0)
    buffer_load_dwordx4 v[6:7], s[4:7], 0 idxen offen lds
    v_cvt_pk_bf16_f32 v12, v28, v32
    v_cvt_pk_bf16_f32 v14, v29, v33
    v_cvt_pk_bf16_f32 v16, v30, v34
    v_cvt_pk_bf16_f32 v13, v36, v40
    v_cvt_pk_bf16_f32 v15, v37, v41
    v_cvt_pk_bf16_f32 v17, v38, v42
    v_or_b32_dpp v19, v10, v11 row_shl:4 row_mask:0xf bank_mask:0xf bound_ctrl:0
    v_add_u32 v2, 192, v2
    v_add_u32 v3, 192, v3
    v_add_u32 v18, 192, v18
    v_readfirstlane_b32 s27, v85
    s_setprio 3
    s_xor_b32 s27, s27, s26
    s_cmp_ge_i32 s27, 0
    s_cbranch_scc1 mn_pr11
    s_setprio 2
mn_pr11:
    s_sub_u32 s19, s19, 1
    s_cbranch_scc1 mn_st11
mn_st11_back:
    s_branch mn_loop
mn_st0:
    s_cmp_lg_u32 s21, 0
    s_cbranch_scc1 mn_next
    s_call_b64 s[48:49], mn_flush
    s_branch mn_st0_back
mn_st1:
    s_cmp_lg_u32 s21, 0
    s_cbranch_scc1 mn_next
    s_call_b64 s[48:49], mn_flush
    s_branch mn_st1_back
mn_st2:
    s_cmp_lg_u32 s21, 0
    s_cbranch_scc1 mn_next
    s_call_b64 s[48:49], mn_flush
    s_branch mn_st2_back
mn_st3:
    s_cmp_lg_u32 s21, 0
    s_cbranch_scc1 mn_next
    s_call_b64 s[48:49], mn_flush
    s_branch mn_st3_back
mn_st4:
    s_cmp_lg_u32 s21, 0
    s_cbranch_scc1 mn_next
    s_call_b64 s[48:49], mn_flush
    s_branch mn_st4_back
mn_st5:
    s_cmp_lg_u32 s21, 0
    s_cbranch_scc1 mn_next
    s_call_b64 s[48:49], mn_flush
    s_branch mn_st5_back
mn_st6:
    s_cmp_lg_u32 s21, 0
    s_cbranch_scc1 mn_next
    s_call_b64 s[48:49], mn_flush
    s_branch mn_st6_back
mn_st7:
    s_cmp_lg_u32 s21, 0
    s_cbranch_scc1 mn_next
    s_call_b64 s[48:49], mn_flush
    s_branch mn_st7_back
mn_st8:
    s_cmp_lg_u32 s21, 0
    s_cbranch_scc1 mn_next
    s_call_b64 s[48:49], mn_flush
    s_branch mn_st8_back
mn_st9:
    s_cmp_lg_u32 s21, 0
    s_cbranch_scc1 mn_next
    s_call_b64 s[48:49], mn_flush
    s_branch mn_st9_back
mn_st10:
    s_cmp_lg_u32 s21, 0
    s_cbranch_scc1 mn_next
    s_call_b64 s[48:49], mn_flush
    s_branch mn_st10_back
mn_st11:
    s_cmp_lg_u32 s21, 0
    s_cbranch_scc1 mn_next
    s_call_b64 s[48:49], mn_flush
    s_branch mn_st11_back
mn_st12:
    s_cmp_lg_u32 s21, 0
    s_cbranch_scc1 mn_next
    s_call_b64 s[48:49], mn_flush
    s_branch mn_st12_back
mn_flush:
    s_cmp_eq_u32 s58, 4
    s_cbranch_scc1 mn_fl4
    s_cmp_eq_u32 s58, 3
    s_cbranch_scc1 mn_fl3
    s_cmp_eq_u32 s58, 2
    s_cbranch_scc1 mn_fl2
    s_cmp_eq_u32 s58, 1
    s_cbranch_scc1 mn_fl1
mn_fl0:
    v_cvt_pk_bf16_f32 v88, v88, v89
    v_cvt_pk_bf16_f32 v89, v90, v91
    ds_write_b64 v87, v[88:89] offset:0
    v_cvt_pk_bf16_f32 v92, v92, v93
    v_cvt_pk_bf16_f32 v93, v94, v95
    ds_write_b64 v87, v[92:93] offset:576
    v_cvt_pk_bf16_f32 v96, v96, v97
    v_cvt_pk_bf16_f32 v97, v98, v99
    ds_write_b64 v87, v[96:97] offset:1152
    v_cvt_pk_bf16_f32 v100, v100, v101
    v_cvt_pk_bf16_f32 v101, v102, v103
    ds_write_b64 v87, v[100:101] offset:1728
    s_mul_i32 s52, s18, 3
    s_lshl_b32 s52, 1, s52
    v_mov_b32 v90, s52
    v_mov_b32 v91, 0
    s_mov_b64 exec, 1
    ds_add_u32 v91, v90 offset:276
    s_mov_b64 exec, -1
    s_add_u32 s58, s58, 1
    s_sub_u32 s19, s85, 1
    s_cbranch_scc1 mn_fl1
    s_setpc_b64 s[48:49]
mn_fl1:
    v_cvt_pk_bf16_f32 v104, v104, v105
    v_cvt_pk_bf16_f32 v105, v106, v107
    ds_write_b64 v87, v[104:105] offset:2304
    v_cvt_pk_bf16_f32 v108, v108, v109
    v_cvt_pk_bf16_f32 v109, v110, v111
    ds_write_b64 v87, v[108:109] offset:2880
    v_cvt_pk_bf16_f32 v112, v112, v113
    v_cvt_pk_bf16_f32 v113, v114, v115
    ds_write_b64 v87, v[112:113] offset:3456
    v_cvt_pk_bf16_f32 v116, v116, v117
    v_cvt_pk_bf16_f32 v117, v118, v119
    ds_write_b64 v87, v[116:117] offset:4032
    s_mul_i32 s52, s18, 3
    s_lshl_b32 s52, 64, s52
    v_mov_b32 v106, s52
    v_mov_b32 v107, 0
    s_mov_b64 exec, 1
    ds_add_u32 v107, v106 offset:276
    s_mov_b64 exec, -1
    s_add_u32 s58, s58, 1
    s_sub_u32 s19, s86, 1
    s_cbranch_scc1 mn_fl2
    s_setpc_b64 s[48:49]
mn_fl2:
    v_cvt_pk_bf16_f32 v120, v120, v121
    v_cvt_pk_bf16_f32 v121, v122, v123
    ds_write_b64 v87, v[120:121] offset:4608
    v_cvt_pk_bf16_f32 v124, v124, v125
    v_cvt_pk_bf16_f32 v125, v126, v127
    ds_write_b64 v87, v[124:125] offset:5184
    v_cvt_pk_bf16_f32 v128, v128, v129
    v_cvt_pk_bf16_f32 v129, v130, v131
    ds_write_b64 v87, v[128:129] offset:5760
    v_cvt_pk_bf16_f32 v132, v132, v133
    v_cvt_pk_bf16_f32 v133, v134, v135
    ds_write_b64 v87, v[132:133] offset:6336
    s_mul_i32 s52, s18, 3
    s_lshl_b32 s52, 4096, s52
    v_mov_b32 v122, s52
    v_mov_b32 v123, 0
    s_mov_b64 exec, 1
    ds_add_u32 v123, v122 offset:276
    s_mov_b64 exec, -1
    s_add_u32 s58, s58, 1
    s_sub_u32 s19, s87, 1
    s_cbranch_scc1 mn_fl3
    s_setpc_b64 s[48:49]
mn_fl3:
    v_cvt_pk_bf16_f32 v136, v136, v137
    v_cvt_pk_bf16_f32 v137, v138, v139
    ds_write_b64 v87, v[136:137] offset:6912
    v_cvt_pk_bf16_f32 v140, v140, v141
    v_cvt_pk_bf16_f32 v141, v142, v143
    ds_write_b64 v87, v[140:141] offset:7488
    v_cvt_pk_bf16_f32 v144, v144, v145
    v_cvt_pk_bf16_f32 v145, v146, v147
    ds_write_b64 v87, v[144:145] offset:8064
    v_cvt_pk_bf16_f32 v148, v148, v149
    v_cvt_pk_bf16_f32 v149, v150, v151
    ds_write_b64 v87, v[148:149] offset:8640
    s_mul_i32 s52, s18, 3
    s_lshl_b32 s52, 262144, s52
    v_mov_b32 v138, s52
    v_mov_b32 v139, 0
    s_mov_b64 exec, 1
    ds_add_u32 v139, v138 offset:276
    s_mov_b64 exec, -1
    s_add_u32 s58, s58, 1
    s_sub_u32 s19, s88, 1
    s_cbranch_scc1 mn_fl4
    s_setpc_b64 s[48:49]
mn_fl4:
    s_cmp_ge_u32 s59, 4
    s_cbranch_scc1 mn_fl4b
    s_waitcnt vmcnt(0)
mn_fl4b:
    v_cvt_pk_bf16_f32 v152, v152, v153
    v_cvt_pk_bf16_f32 v153, v154, v155
    ds_write_b64 v87, v[152:153] offset:9216
    v_cvt_pk_bf16_f32 v156, v156, v157
    v_cvt_pk_bf16_f32 v157, v158, v159
    ds_write_b64 v87, v[156:157] offset:9792
    v_cvt_pk_bf16_f32 v160, v160, v161
    v_cvt_pk_bf16_f32 v161, v162, v163
    ds_write_b64 v87, v[160:161] offset:10368
    v_cvt_pk_bf16_f32 v164, v164, v165
    v_cvt_pk_bf16_f32 v165, v166, v167
    ds_write_b64 v87, v[164:165] offset:10944
    s_mul_i32 s52, s18, 3
    s_lshl_b32 s52, 16777216, s52
    v_mov_b32 v154, s52
    v_mov_b32 v155, 0
    s_mov_b64 exec, 1
    ds_add_u32 v155, v154 offset:276
    s_mov_b64 exec, -1
    s_waitcnt vmcnt(0) lgkmcnt(0)
mn_end:
    s_endpgm
gm_main:
    s_load_dwordx2 s[56:57], s[0:1], 64
    v_and_b32 v3, 63, v0
    v_and_b32 v11, 0x7f, v0
    v_lshlrev_b32 v11, 2, v11
    v_mov_b32 v10, 0
    ds_write_b32 v11, v10
    v_bfe_u32 v12, v0, 1, 7
    v_and_b32 v11, 15, v12
    v_lshrrev_b32 v10, 4, v12
    v_lshl_or_b32 v11, v11, 3, v10
    v_cmp_gt_u32 vcc, 125, v11
    v_mul_u32_u24 v13, 61440, v11
    v_bfrev_b32 v10, 2
    v_lshlrev_b32 v12, 2, v12
    v_cndmask_b32 v12, v10, v12, vcc
    v_lshlrev_b32 v11, 3, v3
    v_lshlrev_b32 v2, 4, v3
    s_lshl_b32 s40, s17, 15
    s_add_u32 s40, s40, 11534336
    s_waitcnt lgkmcnt(0)
    s_mov_b32 s8, s54
    s_and_b32 s9, s55, 0xffff
    buffer_load_dword v4, v12, s[8:11], s25 offen
    buffer_load_dwordx2 v[6:7], v11, s[8:11], s25 offen
    s_barrier
    s_lshl2_add_u32 s47, s47, s17
    s_mul_i32 s47, s47, 61440
    s_mul_i32 s48, s48, 7680
    s_add_u32 s47, s47, s48
    s_sub_i32 s47, s47, 256
    s_max_i32 s47, s47, 0
    v_lshlrev_b32 v11, 7, v3
    buffer_load_dword v39, v11, s[8:11], s47 offen
    s_mul_i32 s41, s2, 625
    s_add_u32 s52, s41, 640
    s_add_u32 s41, s41, 15
    s_lshr_b32 s41, s41, 4
    s_lshr_b32 s52, s52, 4
    s_mov_b32 s12, s56
    s_and_b32 s13, s57, 0xffff
    s_lshl_b32 s14, s52, 11
    s_mov_b32 s15, 0x20000
    s_mul_i32 s42, s17, 15360
    s_add_u32 s42, s42, 40960
    s_lshl_b32 s43, s17, 4
    s_sub_u32 s43, s43, 1
    s_mov_b32 s44, -1
    s_mov_b32 s45, 2139062271
    v_add_u32 v11, 0, v3
    v_mul_u32_u24 v10, 21846, v11
    v_lshrrev_b32 v10, 16, v10
    v_lshl_add_u32 v34, v10, 2, s42
    v_mad_i32_i24 v10, v10, -3, v11
    v_lshlrev_b32 v30, 4, v10
    v_add_u32 v11, 64, v3
    v_mul_u32_u24 v10, 21846, v11
    v_lshrrev_b32 v10, 16, v10
    v_lshl_add_u32 v35, v10, 2, s42
    v_mad_i32_i24 v10, v10, -3, v11
    v_lshlrev_b32 v31, 4, v10
    v_add_u32 v11, 128, v3
    v_mul_u32_u24 v10, 21846, v11
    v_lshrrev_b32 v10, 16, v10
    v_lshl_add_u32 v36, v10, 2, s42
    v_mad_i32_i24 v10, v10, -3, v11
    v_lshlrev_b32 v32, 4, v10
    s_waitcnt vmcnt(1)
gm_pass:
    v_lshrrev_b32 v8, 16, v4
    v_subrev_u32 v8, s24, v8
    v_med3_i32 v8, v8, 0, s20
    v_lshrrev_b32 v11, 16, v6
    v_subrev_u32 v11, s24, v11
    v_med3_i32 v11, v11, 0, s20
    v_lshrrev_b32 v10, 16, v7
    v_subrev_u32 v10, s24, v10
    v_med3_i32 v10, v10, 0, s20
    v_mov_b32 v9, v8
    v_cndmask_b32 v10, 0, v10, s[44:45]
    v_add_u32 v10, v11, v10
    v_and_b32 v12, 1, v0
    v_and_b32 v14, 0xffff, v4
    v_add_u32_dpp v10, v10, v10 row_shr:1 row_mask:0xf bank_mask:0xf
    s_nop 0
    v_add3_u32 v14, v14, v12, s24
    v_add_u32_dpp v10, v10, v10 row_shr:2 row_mask:0xf bank_mask:0xf
    v_add_u32_dpp v9, v9, v9 row_shr:2 row_mask:0xf bank_mask:0xf
    v_mad_u32_u24 v14, v14, 48, v13
    v_add_u32_dpp v10, v10, v10 row_shr:4 row_mask:0xf bank_mask:0xf
    v_add_u32_dpp v9, v9, v9 row_shr:4 row_mask:0xf bank_mask:0xf
    v_sub_u32 v15, v8, v12
    v_add_u32_dpp v10, v10, v10 row_shr:8 row_mask:0xf bank_mask:0xf
    v_add_u32_dpp v9, v9, v9 row_shr:8 row_mask:0xf bank_mask:0xf
    s_nop 0
    v_add_u32_dpp v10, v10, v10 row_bcast:15 row_mask:0xa bank_mask:0xf
    v_add_u32_dpp v9, v9, v9 row_bcast:15 row_mask:0xa bank_mask:0xf
    s_nop 0
    v_add_u32_dpp v10, v10, v10 row_bcast:31 row_mask:0xc bank_mask:0xf
    v_add_u32_dpp v9, v9, v9 row_bcast:31 row_mask:0xc bank_mask:0xf
    s_nop 0
    v_readlane_b32 s23, v10, 63
    v_readlane_b32 s46, v10, s43
    v_readlane_b32 s47, v9, 63
    v_sub_u32 v16, v9, v15
    v_lshl_add_u32 v16, v16, 2, s42
    s_cmp_gt_u32 s23, 774
    s_cbranch_scc1 gm_ovf
    s_cmp_eq_u32 s17, 0
    s_cmov_b32 s46, 0
    v_cmpx_lt_i32 vcc, 0, v15
    s_cbranch_execz gm_tb_done
    ds_write_b32 v16, v14 offset:0
    v_add_u32 v14, 96, v14
    v_cmpx_lt_i32 vcc, 2, v15
    s_cbranch_execz gm_tb_done
    ds_write_b32 v16, v14 offset:8
    v_add_u32 v14, 96, v14
    v_cmpx_lt_i32 vcc, 4, v15
    s_cbranch_execz gm_tb_done
    ds_write_b32 v16, v14 offset:16
    v_add_u32 v14, 96, v14
    v_cmpx_lt_i32 vcc, 6, v15
    s_cbranch_execz gm_tb_done
    ds_write_b32 v16, v14 offset:24
    v_add_u32 v14, 96, v14
    v_cmpx_lt_i32 vcc, 8, v15
    s_cbranch_execz gm_tb_done
    ds_write_b32 v16, v14 offset:32
    v_add_u32 v14, 96, v14
    v_cmpx_lt_i32 vcc, 10, v15
    s_cbranch_execz gm_tb_done
    ds_write_b32 v16, v14 offset:40
    v_add_u32 v14, 96, v14
    v_cmpx_lt_i32 vcc, 12, v15
    s_cbranch_execz gm_tb_done
    ds_write_b32 v16, v14 offset:48
    v_add_u32 v14, 96, v14
    v_cmpx_lt_i32 vcc, 14, v15
    s_cbranch_execz gm_tb_done
    ds_write_b32 v16, v14 offset:56
    v_add_u32 v14, 96, v14
    v_cmpx_lt_i32 vcc, 16, v15
    s_cbranch_execz gm_tb_done
    ds_write_b32 v16, v14 offset:64
    v_add_u32 v14, 96, v14
    v_cmpx_lt_i32 vcc, 18, v15
    s_cbranch_execz gm_tb_done
    ds_write_b32 v16, v14 offset:72
gm_tb_done:
    s_mov_b64 exec, -1
    s_mul_i32 s46, s46, 48
    s_add_u32 m0, s46, 3776
    s_mul_i32 s47, s47, 3
    v_mov_b32 v11, v34
    v_mov_b32 v10, v35
    v_mov_b32 v14, v36
    s_barrier
gm_raw:
    ds_read_b32 v18, v11 offset:0
    ds_read_b32 v19, v10 offset:0
    ds_read_b32 v20, v14 offset:0
    ds_read_b32 v21, v11 offset:256
    ds_read_b32 v22, v10 offset:256
    ds_read_b32 v23, v14 offset:256
    ds_read_b32 v24, v11 offset:512
    ds_read_b32 v25, v10 offset:512
    ds_read_b32 v26, v14 offset:512
    v_cmpx_gt_i32 vcc, s47, v3
    s_cbranch_execz gm_raw_done
    s_waitcnt lgkmcnt(8)
    v_add_u32 v18, v18, v30
    buffer_load_dwordx4 v18, s[8:11], 0 offen lds
    s_add_u32 m0, m0, 1024
    s_sub_i32 s47, s47, 64
    v_cmpx_gt_i32 vcc, s47, v3
    s_cbranch_execz gm_raw_done
    s_waitcnt lgkmcnt(7)
    v_add_u32 v19, v19, v31
    buffer_load_dwordx4 v19, s[8:11], 0 offen lds
    s_add_u32 m0, m0, 1024
    s_sub_i32 s47, s47, 64
    v_cmpx_gt_i32 vcc, s47, v3
    s_cbranch_execz gm_raw_done
    s_waitcnt lgkmcnt(6)
    v_add_u32 v20, v20, v32
    buffer_load_dwordx4 v20, s[8:11], 0 offen lds
    s_add_u32 m0, m0, 1024
    s_sub_i32 s47, s47, 64
    v_cmpx_gt_i32 vcc, s47, v3
    s_cbranch_execz gm_raw_done
    s_waitcnt lgkmcnt(5)
    v_add_u32 v21, v21, v30
    buffer_load_dwordx4 v21, s[8:11], 0 offen lds
    s_add_u32 m0, m0, 1024
    s_sub_i32 s47, s47, 64
    v_cmpx_gt_i32 vcc, s47, v3
    s_cbranch_execz gm_raw_done
    s_waitcnt lgkmcnt(4)
    v_add_u32 v22, v22, v31
    buffer_load_dwordx4 v22, s[8:11], 0 offen lds
    s_add_u32 m0, m0, 1024
    s_sub_i32 s47, s47, 64
    v_cmpx_gt_i32 vcc, s47, v3
    s_cbranch_execz gm_raw_done
    s_waitcnt lgkmcnt(3)
    v_add_u32 v23, v23, v32
    buffer_load_dwordx4 v23, s[8:11], 0 offen lds
    s_add_u32 m0, m0, 1024
    s_sub_i32 s47, s47, 64
    v_cmpx_gt_i32 vcc, s47, v3
    s_cbranch_execz gm_raw_done
    s_waitcnt lgkmcnt(2)
    v_add_u32 v24, v24, v30
    buffer_load_dwordx4 v24, s[8:11], 0 offen lds
    s_add_u32 m0, m0, 1024
    s_sub_i32 s47, s47, 64
    v_cmpx_gt_i32 vcc, s47, v3
    s_cbranch_execz gm_raw_done
    s_waitcnt lgkmcnt(1)
    v_add_u32 v25, v25, v31
    buffer_load_dwordx4 v25, s[8:11], 0 offen lds
    s_add_u32 m0, m0, 1024
    s_sub_i32 s47, s47, 64
    v_cmpx_gt_i32 vcc, s47, v3
    s_cbranch_execz gm_raw_done
    s_waitcnt lgkmcnt(0)
    v_add_u32 v26, v26, v32
    buffer_load_dwordx4 v26, s[8:11], 0 offen lds
    s_add_u32 m0, m0, 1024
    s_sub_i32 s47, s47, 64
    v_add_u32 v11, 768, v11
    v_add_u32 v10, 768, v10
    v_add_u32 v14, 768, v14
    s_branch gm_raw
gm_raw_done:
    s_mov_b64 exec, -1
    v_mov_b32 v11, 0
    ds_read_b32 v11, v11 offset:272
    s_barrier
    s_waitcnt vmcnt(0) lgkmcnt(0)
    v_readfirstlane_b32 s21, v11
    s_barrier
    s_cmp_lg_u32 s21, 0
    s_cbranch_scc1 gm_next
    s_add_u32 s52, s40, 0
    buffer_load_dwordx4 v[40:43], v2, s[8:11], s52 offen offset:0
    buffer_load_dwordx4 v[44:47], v2, s[8:11], s52 offen offset:1024
    s_waitcnt vmcnt(1)
    buffer_load_dwordx4 v[48:51], v2, s[8:11], s52 offen offset:2048
    s_waitcnt vmcnt(1)
    buffer_load_dwordx4 v[52:55], v2, s[8:11], s52 offen offset:3072
    s_waitcnt vmcnt(1)
    s_add_u32 s52, s40, 4096
    buffer_load_dwordx4 v[56:59], v2, s[8:11], s52 offen offset:0
    s_waitcnt vmcnt(1)
    buffer_load_dwordx4 v[60:63], v2, s[8:11], s52 offen offset:1024
    s_waitcnt vmcnt(1)
    buffer_load_dwordx4 v[64:67], v2, s[8:11], s52 offen offset:2048
    s_waitcnt vmcnt(1)
    buffer_load_dwordx4 v[68:71], v2, s[8:11], s52 offen offset:3072
    s_waitcnt vmcnt(1)
    s_add_u32 s52, s40, 8192
    buffer_load_dwordx4 v[72:75], v2, s[8:11], s52 offen offset:0
    s_waitcnt vmcnt(1)
    buffer_load_dwordx4 v[76:79], v2, s[8:11], s52 offen offset:1024
    s_waitcnt vmcnt(1)
    buffer_load_dwordx4 v[80:83], v2, s[8:11], s52 offen offset:2048
    s_waitcnt vmcnt(1)
    buffer_load_dwordx4 v[84:87], v2, s[8:11], s52 offen offset:3072
    s_waitcnt vmcnt(1)
    s_add_u32 s52, s40, 12288
    buffer_load_dwordx4 v[88:91], v2, s[8:11], s52 offen offset:0
    s_waitcnt vmcnt(1)
    buffer_load_dwordx4 v[92:95], v2, s[8:11], s52 offen offset:1024
    s_waitcnt vmcnt(1)
    buffer_load_dwordx4 v[96:99], v2, s[8:11], s52 offen offset:2048
    s_waitcnt vmcnt(1)
    buffer_load_dwordx4 v[100:103], v2, s[8:11], s52 offen offset:3072
    s_waitcnt vmcnt(1)
    s_add_u32 s52, s40, 16384
    buffer_load_dwordx4 v[104:107], v2, s[8:11], s52 offen offset:0
    s_waitcnt vmcnt(1)
    buffer_load_dwordx4 v[108:111], v2, s[8:11], s52 offen offset:1024
    s_waitcnt vmcnt(1)
    buffer_load_dwordx4 v[112:115], v2, s[8:11], s52 offen offset:2048
    s_waitcnt vmcnt(1)
    buffer_load_dwordx4 v[116:119], v2, s[8:11], s52 offen offset:3072
    s_waitcnt vmcnt(1)
    s_add_u32 s52, s40, 20480
    buffer_load_dwordx4 v[120:123], v2, s[8:11], s52 offen offset:0
    s_waitcnt vmcnt(1)
    buffer_load_dwordx4 v[124:127], v2, s[8:11], s52 offen offset:1024
    s_waitcnt vmcnt(1)
    buffer_load_dwordx4 v[128:131], v2, s[8:11], s52 offen offset:2048
    s_waitcnt vmcnt(1)
    buffer_load_dwordx4 v[132:135], v2, s[8:11], s52 offen offset:3072
    s_waitcnt vmcnt(1)
    s_add_u32 s52, s40, 24576
    buffer_load_dwordx4 v[136:139], v2, s[8:11], s52 offen offset:0
    s_waitcnt vmcnt(1)
    buffer_load_dwordx4 v[140:143], v2, s[8:11], s52 offen offset:1024
    s_waitcnt vmcnt(1)
    buffer_load_dwordx4 v[144:147], v2, s[8:11], s52 offen offset:2048
    s_waitcnt vmcnt(1)
    buffer_load_dwordx4 v[148:151], v2, s[8:11], s52 offen offset:3072
    s_waitcnt vmcnt(1)
    s_add_u32 s52, s40, 28672
    buffer_load_dwordx4 v[152:155], v2, s[8:11], s52 offen offset:0
    s_waitcnt vmcnt(1)
    buffer_load_dwordx4 v[156:159], v2, s[8:11], s52 offen offset:1024
    s_waitcnt vmcnt(1)
    buffer_load_dwordx4 v[160:163], v2, s[8:11], s52 offen offset:2048
    s_waitcnt vmcnt(1)
    buffer_load_dwordx4 v[164:167], v2, s[8:11], s52 offen offset:3072
    s_waitcnt vmcnt(1)
    v_lshrrev_b32 v1, 4, v3
    v_lshlrev_b32 v1, 11, v1
    v_and_b32 v4, 7, v3
    v_lshl_add_u32 v1, v4, 4, v1
    v_bfe_u32 v4, v3, 3, 1
    v_lshl_add_u32 v1, v4, 9, v1
    v_and_b32 v4, 3, v3
    v_lshrrev_b32 v5, 2, v3
    v_mul_u32_u24 v0, 576, v4
    v_lshl_add_u32 v0, v5, 3, v0
    v_add_u32 v0, 40960, v0
    s_lshl_b32 s38, s41, 11
    s_lshl_b32 s53, s17, 7
    s_add_u32 s38, s38, s53
    s_mov_b32 s36, 0x24924924
    s_mov_b32 s39, 0
    s_waitcnt vmcnt(0)
gm_poll:
    v_mov_b32 v2, 0
    ds_read_b32 v2, v2 offset:276
    s_waitcnt lgkmcnt(0)
    v_readfirstlane_b32 s52, v2
    s_and_b32 s52, s52, s36
    s_cbranch_scc1 gm_go
    s_sleep 2
    s_branch gm_poll
gm_go:
    s_ff1_i32_b32 s52, s52
    s_bitset0_b32 s36, s52
    s_mul_i32 s52, s52, 11
    s_bfe_u32 s53, s52, 0x10005
    s_bfe_u32 s52, s52, 0x30006
    s_mul_i32 s35, s53, 61440
    s_mul_i32 s31, s52, 2304
    s_add_u32 s31, s31, s35
    s_sub_u32 s35, s31, s39
    v_add_u32 v0, s35, v0
    ds_read_b64_tr_b16 v[12:13], v0 offset:0
    ds_read_b64_tr_b16 v[14:15], v0 offset:128
    ds_read_b64_tr_b16 v[16:17], v0 offset:256
    ds_read_b64_tr_b16 v[18:19], v0 offset:384
    s_mov_b32 s39, s31
    s_mul_i32 s33, s53, 5
    s_add_u32 s33, s33, s52
    s_lshl_b32 s33, s33, 13
    s_add_u32 s33, s33, s38
    s_mov_b32 s37, s33
    s_mov_b32 s32, 0x7ffffff0
gm_loop:
    s_waitcnt lgkmcnt(2)
    v_mfma_f32_16x16x32_bf16 v[24:27], v[12:15], v[40:43], 0
    v_cvt_pk_bf16_f32 v7, v33, v37
    v_cvt_pk_bf16_f32 v5, v32, v36
    ds_read_b64_tr_b16 v[20:21], v0 offset:15360
    v_mfma_f32_16x16x32_bf16 v[28:31], v[12:15], v[44:47], 0
    v_cvt_pk_bf16_f32 v11, v35, v39
    v_cvt_pk_bf16_f32 v9, v34, v38
    ds_read_b64_tr_b16 v[22:23], v0 offset:15488
    v_mfma_f32_16x16x32_bf16 v[32:35], v[12:15], v[48:51], 0
    v_mov_b32_dpp v2, v6 row_ror:8 row_mask:0xf bank_mask:0xf
    v_mov_b32_dpp v3, v7 row_ror:8 row_mask:0xf bank_mask:0xf
    v_mfma_f32_16x16x32_bf16 v[36:39], v[12:15], v[52:55], 0
    v_mov_b32_dpp v6, v4 row_ror:8 row_mask:0xf bank_mask:0x3
    v_mov_b32_dpp v7, v5 row_ror:8 row_mask:0xf bank_mask:0x3
    s_waitcnt lgkmcnt(2)
    v_mfma_f32_16x16x32_bf16 v[24:27], v[16:19], v[56:59], v[24:27]
    ds_read_b64_tr_b16 v[12:13], v0 offset:15616
    v_mov_b32_dpp v4, v2 quad_perm:[0,1,2,3] row_mask:0xf bank_mask:0xc
    v_mfma_f32_16x16x32_bf16 v[28:31], v[16:19], v[60:63], v[28:31]
    ds_read_b64_tr_b16 v[14:15], v0 offset:15744
    v_mov_b32_dpp v5, v3 quad_perm:[0,1,2,3] row_mask:0xf bank_mask:0xc
    v_mfma_f32_16x16x32_bf16 v[32:35], v[16:19], v[64:67], v[32:35]
    buffer_store_dwordx4 v[4:7], v1, s[12:15], s32 offen offset:0 sc0 sc1
    v_mov_b32_dpp v2, v10 row_ror:8 row_mask:0xf bank_mask:0xf
    v_mfma_f32_16x16x32_bf16 v[36:39], v[16:19], v[68:71], v[36:39]
    v_mov_b32_dpp v3, v11 row_ror:8 row_mask:0xf bank_mask:0xf
    v_mov_b32_dpp v10, v8 row_ror:8 row_mask:0xf bank_mask:0x3
    s_waitcnt lgkmcnt(2)
    v_mfma_f32_16x16x32_bf16 v[24:27], v[20:23], v[72:75], v[24:27]
    ds_read_b64_tr_b16 v[16:17], v0 offset:30720
    v_mov_b32_dpp v11, v9 row_ror:8 row_mask:0xf bank_mask:0x3
    v_mfma_f32_16x16x32_bf16 v[28:31], v[20:23], v[76:79], v[28:31]
    ds_read_b64_tr_b16 v[18:19], v0 offset:30848
    v_mov_b32_dpp v8, v2 quad_perm:[0,1,2,3] row_mask:0xf bank_mask:0xc
    v_mfma_f32_16x16x32_bf16 v[32:35], v[20:23], v[80:83], v[32:35]
    v_mov_b32_dpp v9, v3 quad_perm:[0,1,2,3] row_mask:0xf bank_mask:0xc
    buffer_store_dwordx4 v[8:11], v1, s[12:15], s32 offen offset:1024 sc0 sc1
    v_mfma_f32_16x16x32_bf16 v[36:39], v[20:23], v[84:87], v[36:39]
    s_waitcnt lgkmcnt(2)
    v_mfma_f32_16x16x32_bf16 v[24:27], v[12:15], v[88:91], v[24:27]
    ds_read_b64_tr_b16 v[20:21], v0 offset:30976
    v_mfma_f32_16x16x32_bf16 v[28:31], v[12:15], v[92:95], v[28:31]
    ds_read_b64_tr_b16 v[22:23], v0 offset:31104
    v_mfma_f32_16x16x32_bf16 v[32:35], v[12:15], v[96:99], v[32:35]
    v_mov_b32 v2, 0
    v_mfma_f32_16x16x32_bf16 v[36:39], v[12:15], v[100:103], v[36:39]
    ds_read_b32 v2, v2 offset:276
    s_waitcnt lgkmcnt(3)
    v_mfma_f32_16x16x32_bf16 v[24:27], v[16:19], v[104:107], v[24:27]
    ds_read_b64_tr_b16 v[12:13], v0 offset:46080
    v_mfma_f32_16x16x32_bf16 v[28:31], v[16:19], v[108:111], v[28:31]
    ds_read_b64_tr_b16 v[14:15], v0 offset:46208
    v_mfma_f32_16x16x32_bf16 v[32:35], v[16:19], v[112:115], v[32:35]
    s_waitcnt lgkmcnt(2)
    v_readfirstlane_b32 s52, v2
    s_and_b32 s52, s52, s36
    v_mfma_f32_16x16x32_bf16 v[36:39], v[16:19], v[116:119], v[36:39]
    s_cselect_b32 s34, 1, 0
    s_ff1_i32_b32 s52, s52
    s_waitcnt lgkmcnt(2)
    v_mfma_f32_16x16x32_bf16 v[24:27], v[20:23], v[120:123], v[24:27]
    ds_read_b64_tr_b16 v[16:17], v0 offset:46336
    s_bitset0_b32 s36, s52
    s_mul_i32 s52, s52, 11
    v_mfma_f32_16x16x32_bf16 v[28:31], v[20:23], v[124:127], v[28:31]
    ds_read_b64_tr_b16 v[18:19], v0 offset:46464
    s_bfe_u32 s53, s52, 0x10005
    s_bfe_u32 s52, s52, 0x30006
    v_mfma_f32_16x16x32_bf16 v[32:35], v[20:23], v[128:131], v[32:35]
    s_mul_i32 s35, s53, 61440
    s_mul_i32 s31, s52, 2304
    s_add_u32 s31, s31, s35
    v_mfma_f32_16x16x32_bf16 v[36:39], v[20:23], v[132:135], v[36:39]
    s_sub_u32 s35, s31, s39
    v_add_u32 v0, s35, v0
    s_waitcnt lgkmcnt(2)
    v_mfma_f32_16x16x32_bf16 v[24:27], v[12:15], v[136:139], v[24:27]
    ds_read_b64_tr_b16 v[20:21], v0 offset:0
    v_mfma_f32_16x16x32_bf16 v[28:31], v[12:15], v[140:143], v[28:31]
    ds_read_b64_tr_b16 v[22:23], v0 offset:128
    v_mfma_f32_16x16x32_bf16 v[32:35], v[12:15], v[144:147], v[32:35]
    s_mov_b32 s39, s31
    s_mul_i32 s33, s53, 5
    s_add_u32 s33, s33, s52
    v_mfma_f32_16x16x32_bf16 v[36:39], v[12:15], v[148:151], v[36:39]
    s_lshl_b32 s33, s33, 13
    s_add_u32 s33, s33, s38
    s_waitcnt lgkmcnt(2)
    v_mfma_f32_16x16x32_bf16 v[24:27], v[16:19], v[152:155], v[24:27]
    ds_read_b64_tr_b16 v[12:13], v0 offset:256
    v_mfma_f32_16x16x32_bf16 v[28:31], v[16:19], v[156:159], v[28:31]
    ds_read_b64_tr_b16 v[14:15], v0 offset:384
    s_mov_b32 s32, s37
    s_mov_b32 s37, s33
    v_mfma_f32_16x16x32_bf16 v[32:35], v[16:19], v[160:163], v[32:35]
    s_cmp_eq_u32 s34, 0
    s_nop 1
    v_mfma_f32_16x16x32_bf16 v[36:39], v[16:19], v[164:167], v[36:39]
    v_cvt_pk_bf16_f32 v4, v24, v28
    v_cvt_pk_bf16_f32 v6, v25, v29
    v_cvt_pk_bf16_f32 v8, v26, v30
    v_cvt_pk_bf16_f32 v10, v27, v31
    s_nop 0
    s_cbranch_scc1 gm_drain
    s_waitcnt lgkmcnt(2)
    v_mfma_f32_16x16x32_bf16 v[24:27], v[20:23], v[40:43], 0
    v_cvt_pk_bf16_f32 v7, v33, v37
    v_cvt_pk_bf16_f32 v5, v32, v36
    ds_read_b64_tr_b16 v[16:17], v0 offset:15360
    v_mfma_f32_16x16x32_bf16 v[28:31], v[20:23], v[44:47], 0
    v_cvt_pk_bf16_f32 v11, v35, v39
    v_cvt_pk_bf16_f32 v9, v34, v38
    ds_read_b64_tr_b16 v[18:19], v0 offset:15488
    v_mfma_f32_16x16x32_bf16 v[32:35], v[20:23], v[48:51], 0
    v_mov_b32_dpp v2, v6 row_ror:8 row_mask:0xf bank_mask:0xf
    v_mov_b32_dpp v3, v7 row_ror:8 row_mask:0xf bank_mask:0xf
    v_mfma_f32_16x16x32_bf16 v[36:39], v[20:23], v[52:55], 0
    v_mov_b32_dpp v6, v4 row_ror:8 row_mask:0xf bank_mask:0x3
    v_mov_b32_dpp v7, v5 row_ror:8 row_mask:0xf bank_mask:0x3
    s_waitcnt lgkmcnt(2)
    v_mfma_f32_16x16x32_bf16 v[24:27], v[12:15], v[56:59], v[24:27]
    ds_read_b64_tr_b16 v[20:21], v0 offset:15616
    v_mov_b32_dpp v4, v2 quad_perm:[0,1,2,3] row_mask:0xf bank_mask:0xc
    v_mfma_f32_16x16x32_bf16 v[28:31], v[12:15], v[60:63], v[28:31]
    ds_read_b64_tr_b16 v[22:23], v0 offset:15744
    v_mov_b32_dpp v5, v3 quad_perm:[0,1,2,3] row_mask:0xf bank_mask:0xc
    v_mfma_f32_16x16x32_bf16 v[32:35], v[12:15], v[64:67], v[32:35]
    buffer_store_dwordx4 v[4:7], v1, s[12:15], s32 offen offset:0 sc0 sc1
    v_mov_b32_dpp v2, v10 row_ror:8 row_mask:0xf bank_mask:0xf
    v_mfma_f32_16x16x32_bf16 v[36:39], v[12:15], v[68:71], v[36:39]
    v_mov_b32_dpp v3, v11 row_ror:8 row_mask:0xf bank_mask:0xf
    v_mov_b32_dpp v10, v8 row_ror:8 row_mask:0xf bank_mask:0x3
    s_waitcnt lgkmcnt(2)
    v_mfma_f32_16x16x32_bf16 v[24:27], v[16:19], v[72:75], v[24:27]
    ds_read_b64_tr_b16 v[12:13], v0 offset:30720
    v_mov_b32_dpp v11, v9 row_ror:8 row_mask:0xf bank_mask:0x3
    v_mfma_f32_16x16x32_bf16 v[28:31], v[16:19], v[76:79], v[28:31]
    ds_read_b64_tr_b16 v[14:15], v0 offset:30848
    v_mov_b32_dpp v8, v2 quad_perm:[0,1,2,3] row_mask:0xf bank_mask:0xc
    v_mfma_f32_16x16x32_bf16 v[32:35], v[16:19], v[80:83], v[32:35]
    v_mov_b32_dpp v9, v3 quad_perm:[0,1,2,3] row_mask:0xf bank_mask:0xc
    buffer_store_dwordx4 v[8:11], v1, s[12:15], s32 offen offset:1024 sc0 sc1
    v_mfma_f32_16x16x32_bf16 v[36:39], v[16:19], v[84:87], v[36:39]
    s_waitcnt lgkmcnt(2)
    v_mfma_f32_16x16x32_bf16 v[24:27], v[20:23], v[88:91], v[24:27]
    ds_read_b64_tr_b16 v[16:17], v0 offset:30976
    v_mfma_f32_16x16x32_bf16 v[28:31], v[20:23], v[92:95], v[28:31]
    ds_read_b64_tr_b16 v[18:19], v0 offset:31104
    v_mfma_f32_16x16x32_bf16 v[32:35], v[20:23], v[96:99], v[32:35]
    v_mov_b32 v2, 0
    v_mfma_f32_16x16x32_bf16 v[36:39], v[20:23], v[100:103], v[36:39]
    ds_read_b32 v2, v2 offset:276
    s_waitcnt lgkmcnt(3)
    v_mfma_f32_16x16x32_bf16 v[24:27], v[12:15], v[104:107], v[24:27]
    ds_read_b64_tr_b16 v[20:21], v0 offset:46080
    v_mfma_f32_16x16x32_bf16 v[28:31], v[12:15], v[108:111], v[28:31]
    ds_read_b64_tr_b16 v[22:23], v0 offset:46208
    v_mfma_f32_16x16x32_bf16 v[32:35], v[12:15], v[112:115], v[32:35]
    s_waitcnt lgkmcnt(2)
    v_readfirstlane_b32 s52, v2
    s_and_b32 s52, s52, s36
    v_mfma_f32_16x16x32_bf16 v[36:39], v[12:15], v[116:119], v[36:39]
    s_cselect_b32 s34, 1, 0
    s_ff1_i32_b32 s52, s52
    s_waitcnt lgkmcnt(2)
    v_mfma_f32_16x16x32_bf16 v[24:27], v[16:19], v[120:123], v[24:27]
    ds_read_b64_tr_b16 v[12:13], v0 offset:46336
    s_bitset0_b32 s36, s52
    s_mul_i32 s52, s52, 11
    v_mfma_f32_16x16x32_bf16 v[28:31], v[16:19], v[124:127], v[28:31]
    ds_read_b64_tr_b16 v[14:15], v0 offset:46464
    s_bfe_u32 s53, s52, 0x10005
    s_bfe_u32 s52, s52, 0x30006
    v_mfma_f32_16x16x32_bf16 v[32:35], v[16:19], v[128:131], v[32:35]
    s_mul_i32 s35, s53, 61440
    s_mul_i32 s31, s52, 2304
    s_add_u32 s31, s31, s35
    v_mfma_f32_16x16x32_bf16 v[36:39], v[16:19], v[132:135], v[36:39]
    s_sub_u32 s35, s31, s39
    v_add_u32 v0, s35, v0
    s_waitcnt lgkmcnt(2)
    v_mfma_f32_16x16x32_bf16 v[24:27], v[20:23], v[136:139], v[24:27]
    ds_read_b64_tr_b16 v[16:17], v0 offset:0
    v_mfma_f32_16x16x32_bf16 v[28:31], v[20:23], v[140:143], v[28:31]
    ds_read_b64_tr_b16 v[18:19], v0 offset:128
    v_mfma_f32_16x16x32_bf16 v[32:35], v[20:23], v[144:147], v[32:35]
    s_mov_b32 s39, s31
    s_mul_i32 s33, s53, 5
    s_add_u32 s33, s33, s52
    v_mfma_f32_16x16x32_bf16 v[36:39], v[20:23], v[148:151], v[36:39]
    s_lshl_b32 s33, s33, 13
    s_add_u32 s33, s33, s38
    s_waitcnt lgkmcnt(2)
    v_mfma_f32_16x16x32_bf16 v[24:27], v[12:15], v[152:155], v[24:27]
    ds_read_b64_tr_b16 v[20:21], v0 offset:256
    v_mfma_f32_16x16x32_bf16 v[28:31], v[12:15], v[156:159], v[28:31]
    ds_read_b64_tr_b16 v[22:23], v0 offset:384
    s_mov_b32 s32, s37
    s_mov_b32 s37, s33
    v_mfma_f32_16x16x32_bf16 v[32:35], v[12:15], v[160:163], v[32:35]
    s_cmp_eq_u32 s34, 0
    s_nop 1
    v_mfma_f32_16x16x32_bf16 v[36:39], v[12:15], v[164:167], v[36:39]
    v_cvt_pk_bf16_f32 v4, v24, v28
    v_cvt_pk_bf16_f32 v6, v25, v29
    v_cvt_pk_bf16_f32 v8, v26, v30
    v_cvt_pk_bf16_f32 v10, v27, v31
    s_nop 0
    s_cbranch_scc1 gm_drain
    s_waitcnt lgkmcnt(2)
    v_mfma_f32_16x16x32_bf16 v[24:27], v[16:19], v[40:43], 0
    v_cvt_pk_bf16_f32 v7, v33, v37
    v_cvt_pk_bf16_f32 v5, v32, v36
    ds_read_b64_tr_b16 v[12:13], v0 offset:15360
    v_mfma_f32_16x16x32_bf16 v[28:31], v[16:19], v[44:47], 0
    v_cvt_pk_bf16_f32 v11, v35, v39
    v_cvt_pk_bf16_f32 v9, v34, v38
    ds_read_b64_tr_b16 v[14:15], v0 offset:15488
    v_mfma_f32_16x16x32_bf16 v[32:35], v[16:19], v[48:51], 0
    v_mov_b32_dpp v2, v6 row_ror:8 row_mask:0xf bank_mask:0xf
    v_mov_b32_dpp v3, v7 row_ror:8 row_mask:0xf bank_mask:0xf
    v_mfma_f32_16x16x32_bf16 v[36:39], v[16:19], v[52:55], 0
    v_mov_b32_dpp v6, v4 row_ror:8 row_mask:0xf bank_mask:0x3
    v_mov_b32_dpp v7, v5 row_ror:8 row_mask:0xf bank_mask:0x3
    s_waitcnt lgkmcnt(2)
    v_mfma_f32_16x16x32_bf16 v[24:27], v[20:23], v[56:59], v[24:27]
    ds_read_b64_tr_b16 v[16:17], v0 offset:15616
    v_mov_b32_dpp v4, v2 quad_perm:[0,1,2,3] row_mask:0xf bank_mask:0xc
    v_mfma_f32_16x16x32_bf16 v[28:31], v[20:23], v[60:63], v[28:31]
    ds_read_b64_tr_b16 v[18:19], v0 offset:15744
    v_mov_b32_dpp v5, v3 quad_perm:[0,1,2,3] row_mask:0xf bank_mask:0xc
    v_mfma_f32_16x16x32_bf16 v[32:35], v[20:23], v[64:67], v[32:35]
    buffer_store_dwordx4 v[4:7], v1, s[12:15], s32 offen offset:0 sc0 sc1
    v_mov_b32_dpp v2, v10 row_ror:8 row_mask:0xf bank_mask:0xf
    v_mfma_f32_16x16x32_bf16 v[36:39], v[20:23], v[68:71], v[36:39]
    v_mov_b32_dpp v3, v11 row_ror:8 row_mask:0xf bank_mask:0xf
    v_mov_b32_dpp v10, v8 row_ror:8 row_mask:0xf bank_mask:0x3
    s_waitcnt lgkmcnt(2)
    v_mfma_f32_16x16x32_bf16 v[24:27], v[12:15], v[72:75], v[24:27]
    ds_read_b64_tr_b16 v[20:21], v0 offset:30720
    v_mov_b32_dpp v11, v9 row_ror:8 row_mask:0xf bank_mask:0x3
    v_mfma_f32_16x16x32_bf16 v[28:31], v[12:15], v[76:79], v[28:31]
    ds_read_b64_tr_b16 v[22:23], v0 offset:30848
    v_mov_b32_dpp v8, v2 quad_perm:[0,1,2,3] row_mask:0xf bank_mask:0xc
    v_mfma_f32_16x16x32_bf16 v[32:35], v[12:15], v[80:83], v[32:35]
    v_mov_b32_dpp v9, v3 quad_perm:[0,1,2,3] row_mask:0xf bank_mask:0xc
    buffer_store_dwordx4 v[8:11], v1, s[12:15], s32 offen offset:1024 sc0 sc1
    v_mfma_f32_16x16x32_bf16 v[36:39], v[12:15], v[84:87], v[36:39]
    s_waitcnt lgkmcnt(2)
    v_mfma_f32_16x16x32_bf16 v[24:27], v[16:19], v[88:91], v[24:27]
    ds_read_b64_tr_b16 v[12:13], v0 offset:30976
    v_mfma_f32_16x16x32_bf16 v[28:31], v[16:19], v[92:95], v[28:31]
    ds_read_b64_tr_b16 v[14:15], v0 offset:31104
    v_mfma_f32_16x16x32_bf16 v[32:35], v[16:19], v[96:99], v[32:35]
    v_mov_b32 v2, 0
    v_mfma_f32_16x16x32_bf16 v[36:39], v[16:19], v[100:103], v[36:39]
    ds_read_b32 v2, v2 offset:276
    s_waitcnt lgkmcnt(3)
    v_mfma_f32_16x16x32_bf16 v[24:27], v[20:23], v[104:107], v[24:27]
    ds_read_b64_tr_b16 v[16:17], v0 offset:46080
    v_mfma_f32_16x16x32_bf16 v[28:31], v[20:23], v[108:111], v[28:31]
    ds_read_b64_tr_b16 v[18:19], v0 offset:46208
    v_mfma_f32_16x16x32_bf16 v[32:35], v[20:23], v[112:115], v[32:35]
    s_waitcnt lgkmcnt(2)
    v_readfirstlane_b32 s52, v2
    s_and_b32 s52, s52, s36
    v_mfma_f32_16x16x32_bf16 v[36:39], v[20:23], v[116:119], v[36:39]
    s_cselect_b32 s34, 1, 0
    s_ff1_i32_b32 s52, s52
    s_waitcnt lgkmcnt(2)
    v_mfma_f32_16x16x32_bf16 v[24:27], v[12:15], v[120:123], v[24:27]
    ds_read_b64_tr_b16 v[20:21], v0 offset:46336
    s_bitset0_b32 s36, s52
    s_mul_i32 s52, s52, 11
    v_mfma_f32_16x16x32_bf16 v[28:31], v[12:15], v[124:127], v[28:31]
    ds_read_b64_tr_b16 v[22:23], v0 offset:46464
    s_bfe_u32 s53, s52, 0x10005
    s_bfe_u32 s52, s52, 0x30006
    v_mfma_f32_16x16x32_bf16 v[32:35], v[12:15], v[128:131], v[32:35]
    s_mul_i32 s35, s53, 61440
    s_mul_i32 s31, s52, 2304
    s_add_u32 s31, s31, s35
    v_mfma_f32_16x16x32_bf16 v[36:39], v[12:15], v[132:135], v[36:39]
    s_sub_u32 s35, s31, s39
    v_add_u32 v0, s35, v0
    s_waitcnt lgkmcnt(2)
    v_mfma_f32_16x16x32_bf16 v[24:27], v[16:19], v[136:139], v[24:27]
    ds_read_b64_tr_b16 v[12:13], v0 offset:0
    v_mfma_f32_16x16x32_bf16 v[28:31], v[16:19], v[140:143], v[28:31]
    ds_read_b64_tr_b16 v[14:15], v0 offset:128
    v_mfma_f32_16x16x32_bf16 v[32:35], v[16:19], v[144:147], v[32:35]
    s_mov_b32 s39, s31
    s_mul_i32 s33, s53, 5
    s_add_u32 s33, s33, s52
    v_mfma_f32_16x16x32_bf16 v[36:39], v[16:19], v[148:151], v[36:39]
    s_lshl_b32 s33, s33, 13
    s_add_u32 s33, s33, s38
    s_waitcnt lgkmcnt(2)
    v_mfma_f32_16x16x32_bf16 v[24:27], v[20:23], v[152:155], v[24:27]
    ds_read_b64_tr_b16 v[16:17], v0 offset:256
    v_mfma_f32_16x16x32_bf16 v[28:31], v[20:23], v[156:159], v[28:31]
    ds_read_b64_tr_b16 v[18:19], v0 offset:384
    s_mov_b32 s32, s37
    s_mov_b32 s37, s33
    v_mfma_f32_16x16x32_bf16 v[32:35], v[20:23], v[160:163], v[32:35]
    s_cmp_eq_u32 s34, 0
    s_nop 1
    v_mfma_f32_16x16x32_bf16 v[36:39], v[20:23], v[164:167], v[36:39]
    v_cvt_pk_bf16_f32 v4, v24, v28
    v_cvt_pk_bf16_f32 v6, v25, v29
    v_cvt_pk_bf16_f32 v8, v26, v30
    v_cvt_pk_bf16_f32 v10, v27, v31
    s_nop 0
    s_cbranch_scc0 gm_loop
gm_drain:
    s_nop 2
    v_cvt_pk_bf16_f32 v7, v33, v37
    v_cvt_pk_bf16_f32 v5, v32, v36
    v_cvt_pk_bf16_f32 v11, v35, v39
    v_cvt_pk_bf16_f32 v9, v34, v38
    v_mov_b32_dpp v2, v6 row_ror:8 row_mask:0xf bank_mask:0xf
    v_mov_b32_dpp v3, v7 row_ror:8 row_mask:0xf bank_mask:0xf
    v_mov_b32_dpp v6, v4 row_ror:8 row_mask:0xf bank_mask:0x3
    v_mov_b32_dpp v7, v5 row_ror:8 row_mask:0xf bank_mask:0x3
    v_mov_b32_dpp v4, v2 quad_perm:[0,1,2,3] row_mask:0xf bank_mask:0xc
    v_mov_b32_dpp v5, v3 quad_perm:[0,1,2,3] row_mask:0xf bank_mask:0xc
    buffer_store_dwordx4 v[4:7], v1, s[12:15], s32 offen offset:0 sc0 sc1
    v_mov_b32_dpp v2, v10 row_ror:8 row_mask:0xf bank_mask:0xf
    v_mov_b32_dpp v3, v11 row_ror:8 row_mask:0xf bank_mask:0xf
    v_mov_b32_dpp v10, v8 row_ror:8 row_mask:0xf bank_mask:0x3
    v_mov_b32_dpp v11, v9 row_ror:8 row_mask:0xf bank_mask:0x3
    v_mov_b32_dpp v8, v2 quad_perm:[0,1,2,3] row_mask:0xf bank_mask:0xc
    v_mov_b32_dpp v9, v3 quad_perm:[0,1,2,3] row_mask:0xf bank_mask:0xc
    buffer_store_dwordx4 v[8:11], v1, s[12:15], s32 offen offset:1024 sc0 sc1
    s_cmp_lg_u32 s36, 0
    s_cbranch_scc1 gm_poll
    s_endpgm
gm_ovf:
    s_movk_i32 s20, 4
    s_barrier
    s_barrier
    s_barrier
    s_branch gm_pass
gm_next:
    s_add_u32 s24, s24, s20
    s_barrier
    s_branch gm_pass
mn_w5:
    v_add_u32 v55, 16, v35
    v_add_u32 v55, s24, v55
    v_lshrrev_b32 v56, 16, v58
    v_mov_b32 v24, 0
    v_cmpx_lt_u32 vcc, v55, v56
    s_cbranch_execz mn_g0
    v_and_b32 v56, 0xffff, v58
    v_add_u32 v55, v55, v56
    v_mad_u32_u24 v56, v55, 48, v46
    buffer_load_dword v24, v56, s[8:11], 0 offen offset:40
    s_waitcnt vmcnt(0)
mn_g0:
    s_mov_b64 exec, -1
mn_more:
    s_add_u32 s52, s24, s20
    v_lshrrev_b32 v56, 16, v58
    v_cmp_lt_u32 vcc, s52, v56
    s_cbranch_vccz mn_count
    v_mov_b32 v55, 272
    ds_write_b32 v55, v48
    s_branch mn_count
mn_ovf:
    s_movk_i32 s20, 4
    s_waitcnt vmcnt(0) lgkmcnt(0)
    s_barrier
    s_branch mn_again
mn_next:
    s_set_gpr_idx_off
    s_waitcnt vmcnt(0) lgkmcnt(0)
    s_nop 7
    s_add_u32 s24, s24, s20
    v_mbcnt_lo_u32_b32 v0, -1, 0
    v_mbcnt_hi_u32_b32 v0, -1, v0
    v_lshl_add_u32 v0, s16, 6, v0
    v_lshrrev_b32 v56, 6, v0
    v_lshlrev_b32 v55, 1, v0
    v_and_b32 v55, 0x78, v55
    v_or_b32 v55, v55, v56
    v_cmp_gt_u32 vcc, 125, v55
    v_mul_u32_u24 v46, 61440, v55
    v_bfrev_b32 v56, 2
    v_lshlrev_b32 v55, 4, v0
    v_and_b32 v57, 0x1fc, v0
    v_cndmask_b32 v55, v56, v55, vcc
    v_cndmask_b32 v57, v56, v57, vcc
    v_and_b32 v51, 63, v0
    v_lshlrev_b32 v56, 3, v51
    buffer_load_dword v58, v57, s[8:11], s25 offen
    buffer_load_dwordx2 v[44:45], v56, s[8:11], s25 offen
    v_mov_b32 v48, 1
    v_lshlrev_b32 v47, 2, v51
    v_bfe_u32 v2, v0, 5, 1
    v_bfe_u32 v3, v0, 3, 2
    v_and_b32 v35, 3, v0
    v_lshl_add_u32 v3, v3, 2, v35
    v_mul_u32_u24 v49, 20, v2
    v_lshrrev_b32 v18, 2, v51
    v_lshl_add_u32 v18, v35, 4, v18
    v_mov_b32 v50, 1327103
    s_lshl_b32 s52, s16, 3
    s_bfm_b64 s[36:37], s52, 0
    s_andn2_b32 s39, s37, 2155905024
    s_mov_b32 s38, s36
mn_again:
    v_mov_b32 v55, 0
    ds_write_b32 v47, v55 offset:0
    ds_write_b32 v47, v55 offset:256
    s_waitcnt vmcnt(0) lgkmcnt(0)
    s_barrier
    v_add_u32 v55, 0, v35
    v_add_u32 v55, s24, v55
    v_lshrrev_b32 v56, 16, v58
    v_mov_b32 v20, 0
    v_cmpx_lt_u32 vcc, v55, v56
    s_cbranch_execz mn_g1
    v_and_b32 v56, 0xffff, v58
    v_add_u32 v55, v55, v56
    v_mad_u32_u24 v56, v55, 48, v46
    buffer_load_dword v20, v56, s[8:11], 0 offen offset:40
    s_waitcnt vmcnt(0)
mn_g1:
    s_mov_b64 exec, -1
    v_mov_b32 v21, 0
    v_mov_b32 v22, 0
    v_mov_b32 v23, 0
    v_mov_b32 v24, 0
    s_cmp_le_u32 s20, 4
    s_cbranch_scc1 mn_more
    v_add_u32 v55, 4, v35
    v_add_u32 v55, s24, v55
    v_lshrrev_b32 v56, 16, v58
    v_mov_b32 v21, 0
    v_cmpx_lt_u32 vcc, v55, v56
    s_cbranch_execz mn_g2
    v_and_b32 v56, 0xffff, v58
    v_add_u32 v55, v55, v56
    v_mad_u32_u24 v56, v55, 48, v46
    buffer_load_dword v21, v56, s[8:11], 0 offen offset:40
    s_waitcnt vmcnt(0)
mn_g2:
    s_mov_b64 exec, -1
    v_add_u32 v55, 8, v35
    v_add_u32 v55, s24, v55
    v_lshrrev_b32 v56, 16, v58
    v_mov_b32 v22, 0
    v_cmpx_lt_u32 vcc, v55, v56
    s_cbranch_execz mn_g3
    v_and_b32 v56, 0xffff, v58
    v_add_u32 v55, v55, v56
    v_mad_u32_u24 v56, v55, 48, v46
    buffer_load_dword v22, v56, s[8:11], 0 offen offset:40
    s_waitcnt vmcnt(0)
mn_g3:
    s_mov_b64 exec, -1
    v_add_u32 v55, 12, v35
    v_add_u32 v55, s24, v55
    v_lshrrev_b32 v56, 16, v58
    v_mov_b32 v23, 0
    v_cmpx_lt_u32 vcc, v55, v56
    s_cbranch_execz mn_g4
    v_and_b32 v56, 0xffff, v58
    v_add_u32 v55, v55, v56
    v_mad_u32_u24 v56, v55, 48, v46
    buffer_load_dword v23, v56, s[8:11], 0 offen offset:40
    s_waitcnt vmcnt(0)
mn_g4:
    s_mov_b64 exec, -1
    v_add_u32 v55, 16, v35
    v_add_u32 v55, s24, v55
    v_lshrrev_b32 v56, 16, v58
    v_mov_b32 v24, 0
    v_cmpx_lt_u32 vcc, v55, v56
    s_cbranch_execz mn_g5
    v_and_b32 v56, 0xffff, v58
    v_add_u32 v55, v55, v56
    v_mad_u32_u24 v56, v55, 48, v46
    buffer_load_dword v24, v56, s[8:11], 0 offen offset:40
    s_waitcnt vmcnt(0)
mn_g5:
    s_mov_b64 exec, -1
    s_branch mn_more
mn_last:
    s_endpgm
.section .rodata,"a"
.p2align 6
.amdhsa_kernel ka_kernel
  .amdhsa_next_free_vgpr 88
  .amdhsa_next_free_sgpr 40
  .amdhsa_accum_offset 88
  .amdhsa_group_segment_fixed_size 0
  .amdhsa_kernarg_size 88
  .amdhsa_user_sgpr_count 2
  .amdhsa_user_sgpr_kernarg_segment_ptr 1
  .amdhsa_system_sgpr_workgroup_id_x 1
.end_amdhsa_kernel
.p2align 6
.amdhsa_kernel main_kernel
  .amdhsa_next_free_vgpr 168
  .amdhsa_next_free_sgpr 96
  .amdhsa_accum_offset 168
  .amdhsa_group_segment_fixed_size 0
  .amdhsa_kernarg_size 88
  .amdhsa_user_sgpr_count 2
  .amdhsa_user_sgpr_kernarg_segment_ptr 1
  .amdhsa_system_sgpr_workgroup_id_x 1
.end_amdhsa_kernel
```

```asm
; @launch kernel=ka_kernel grid=(256,1,1) block=(640,1,1) lds=89088
; @launch kernel=main_kernel grid=(256,1,1) block=(768,1,1) lds=163840
.amdgcn_target "amdgcn-amd-amdhsa--gfx950"
.text
.globl ka_kernel
.p2align 8
.type ka_kernel,@function
ka_kernel:
    s_cmp_ge_u32 s2, 256
    s_cbranch_scc1 ka_end
    s_cmp_lt_u32 s2, 128
    s_cbranch_scc1 ka_nospf
    s_getpc_b64 s[36:37]
ka_pc0:
    v_lshlrev_b32 v41, 7, v0
    v_min_u32 v41, mn_last-ka_pc0, v41
    global_load_dword v41, v41, s[36:37]
ka_nospf:
    s_load_dwordx8 s[4:11], s[0:1], 8
    s_load_dwordx2 s[16:17], s[0:1], 0
    s_load_dwordx2 s[14:15], s[0:1], 80
    s_load_dwordx2 s[32:33], s[0:1], 56
    v_lshrrev_b32 v9, 6, v0
    v_and_b32 v1, 63, v0
    v_readfirstlane_b32 s18, v9
    s_cmp_ge_u32 s2, 128
    s_cbranch_scc1 ka_pf
    s_cmp_ge_u32 s2, 125
    s_cbranch_scc1 ka_extra
    s_mul_i32 s3, s2, 1280
    v_add_u32 v4, s3, v0
    v_lshlrev_b32 v5, 2, v4
    v_lshlrev_b32 v2, 2, v0
    v_and_b32 v2, 0x3fc, v2
    v_mov_b32 v3, 0
    v_lshlrev_b32 v6, 3, v4
    v_add_u32 v8, 5120, v6
    v_and_b32 v7, 0xffffffc0, v4
    v_lshlrev_b32 v7, 5, v7
    v_lshl_add_u32 v7, v1, 4, v7
    v_add_u32 v9, 20480, v7
    s_waitcnt lgkmcnt(0)
    global_load_dword v10, v5, s[6:7]
    global_load_dword v60, v5, s[6:7] offset:2560
    global_load_dword v11, v5, s[4:5]
    global_load_dword v61, v5, s[4:5] offset:2560
    ds_write_b32 v2, v3
    v_lshlrev_b32 v5, 4, v0
    v_mov_b32 v44, 0
    v_mov_b32 v45, 0
    v_mov_b32 v46, 0
    v_mov_b32 v47, 0
    ds_write_b128 v5, v[44:47] offset:11264
    ds_write_b128 v5, v[44:47] offset:17408
    s_mov_b32 s20, s14
    s_and_b32 s21, s15, 0xffff
    s_mov_b32 s22, 12582912
    s_mov_b32 s23, 0x20000
    s_and_b32 s28, s2, 7
    s_lshl_b32 s28, s28, 4
    s_lshr_b32 s29, s2, 3
    s_add_u32 s28, s28, s29
    s_lshl_b32 s30, s28, 6
    s_add_u32 s30, s30, 8388608
    s_lshl_b32 s28, s28, 2
    s_add_u32 s28, s28, 10485760
    v_mov_b32 v3, 1
    v_lshrrev_b32 v24, 1, v1
    v_lshlrev_b32 v24, 2, v24
    v_and_b32 v25, 1, v0
    v_lshlrev_b32 v25, 4, v25
    v_lshlrev_b32 v26, 4, v1
    s_lshl_b32 s19, s18, 10
    v_add_u32 v27, s19, v26
    s_movk_i32 s29, 625
    s_movk_i32 s38, 320
    s_movk_i32 s39, 1250
    s_waitcnt lgkmcnt(0)
    s_barrier
    global_load_dwordx2 v[12:13], v6, s[8:9]
    global_load_dwordx4 v[16:19], v7, s[10:11]
    global_load_dwordx4 v[20:23], v7, s[10:11] offset:1024
    s_waitcnt vmcnt(6)
    v_mul_u32_u24 v32, 214749, v10
    v_lshrrev_b32 v32, 23, v32
    v_min_u32 v32, 255, v32
    v_and_b32 v35, 7, v32
    v_lshrrev_b32 v33, 3, v32
    v_lshl_add_u32 v35, v35, 5, v33
    v_lshlrev_b32 v35, 2, v35
    ds_add_rtn_u32 v36, v35, v3
    s_waitcnt vmcnt(5)
    v_mul_u32_u24 v62, 214749, v60
    v_lshrrev_b32 v62, 23, v62
    v_min_u32 v62, 255, v62
    v_and_b32 v76, 7, v62
    v_lshrrev_b32 v63, 3, v62
    v_lshl_add_u32 v76, v76, 5, v63
    v_lshlrev_b32 v76, 2, v76
    ds_add_rtn_u32 v77, v76, v3
    s_waitcnt vmcnt(3)
    v_mad_u32_u24 v33, v32, s29, 15
    v_lshrrev_b32 v33, 4, v33
    v_sub_u32 v33, v10, v33
    v_and_b32 v32, 7, v32
    v_mul_u32_u24 v32, 0, v32
    v_sub_u32 v39, v11, v32
    v_add_u32 v32, 10000, v39
    v_min_u32 v39, v39, v32
    v_mul_u32_u24 v39, 3330, v39
    v_lshrrev_b32 v39, 20, v39
    v_subrev_u32 v32, 20, v33
    v_min_u32 v15, v32, v33
    v_min_u32 v15, 19, v15
    v_lshrrev_b32 v32, 2, v15
    v_add_u32 v32, 27, v32
    v_cmp_gt_u32 vcc, 27, v39
    v_lshlrev_b32 v15, 2, v15
    v_and_b32 v14, 0x3fff, v11
    v_cndmask_b32 v39, v32, v39, vcc
    v_cmp_le_u32 vcc, 20, v33
    v_add_u32 v32, 32, v39
    v_lshlrev_b32 v40, 4, v35
    v_cndmask_b32 v39, v39, v32, vcc
    v_add_u32 v35, s19, v35
    v_or_b32 v39, 64, v39
    v_lshl_or_b32 v14, v39, 25, v14
    v_mad_u32_u24 v63, v62, s29, 15
    v_lshrrev_b32 v63, 4, v63
    v_sub_u32 v63, v60, v63
    v_and_b32 v62, 7, v62
    v_mul_u32_u24 v62, 0, v62
    v_sub_u32 v78, v61, v62
    v_add_u32 v62, 10000, v78
    v_min_u32 v78, v78, v62
    v_mul_u32_u24 v78, 3330, v78
    v_lshrrev_b32 v78, 20, v78
    v_subrev_u32 v62, 20, v63
    v_min_u32 v75, v62, v63
    v_min_u32 v75, 19, v75
    v_lshrrev_b32 v62, 2, v75
    v_add_u32 v62, 27, v62
    v_cmp_gt_u32 vcc, 27, v78
    v_lshlrev_b32 v75, 2, v75
    v_and_b32 v74, 0x3fff, v61
    v_cndmask_b32 v78, v62, v78, vcc
    v_cmp_le_u32 vcc, 20, v63
    v_add_u32 v62, 32, v78
    v_lshlrev_b32 v82, 4, v76
    v_cndmask_b32 v78, v78, v62, vcc
    v_add_u32 v76, s19, v76
    v_or_b32 v78, 64, v78
    v_lshl_or_b32 v74, v78, 25, v74
    s_waitcnt lgkmcnt(0)
    s_barrier
    ds_read_b128 v[44:47], v26
    ds_read_b32 v37, v2
    global_load_dwordx2 v[72:73], v8, s[8:9]
    global_load_dwordx4 v[64:67], v9, s[10:11]
    global_load_dwordx4 v[68:71], v9, s[10:11] offset:1024
    v_add_u32 v28, s19, v2
    v_lshlrev_b32 v29, 9, v0
    s_mul_i32 s19, s2, 61440
    v_and_b32 v32, 3, v36
    v_lshl_add_u32 v40, v32, 4, v40
    v_and_b32 v32, 12, v36
    v_add_u32 v40, v32, v40
    v_cmp_lt_u32 vcc, 15, v36
    v_mov_b32 v32, 0x40000
    v_lshl_add_u32 v15, s19, 4, v15
    v_cndmask_b32 v40, v40, v32, vcc
    v_and_b32 v62, 3, v77
    v_lshl_add_u32 v82, v62, 4, v82
    v_and_b32 v62, 12, v77
    v_add_u32 v82, v62, v82
    v_cmp_lt_u32 vcc, 15, v77
    v_mov_b32 v62, 0x40000
    v_lshl_add_u32 v75, s19, 4, v75
    v_cndmask_b32 v82, v82, v62, vcc
    s_waitcnt lgkmcnt(1)
    v_add_u32 v53, v44, v45
    v_add_u32 v54, v53, v46
    v_add_u32 v38, v54, v47
    v_mov_b32 v55, v38
    s_nop 0
    v_add_u32_dpp v38, v38, v38 row_shr:1 row_mask:0xf bank_mask:0xf
    s_nop 1
    v_add_u32_dpp v38, v38, v38 row_shr:2 row_mask:0xf bank_mask:0xf
    s_nop 1
    v_add_u32_dpp v38, v38, v38 row_shr:4 row_mask:0xf bank_mask:0xf
    s_nop 1
    v_add_u32_dpp v38, v38, v38 row_shr:8 row_mask:0xf bank_mask:0xf
    s_nop 1
    v_add_u32_dpp v38, v38, v38 row_bcast:15 row_mask:0xa bank_mask:0xf
    s_nop 1
    v_add_u32_dpp v38, v38, v38 row_bcast:31 row_mask:0xc bank_mask:0xf
    v_sub_u32 v56, v38, v55
    v_add_u32 v57, v56, v44
    v_add_u32 v58, v56, v53
    v_add_u32 v59, v56, v54
    ds_write_b128 v27, v[56:59] offset:1024
    ds_read_b32 v43, v35 offset:1024
    ds_read_b32 v79, v76 offset:1024
    ds_read_b32 v30, v28 offset:1024
    s_waitcnt lgkmcnt(1)
    v_add_u32 v43, v43, v36
    v_lshl_or_b32 v41, v43, 14, v14
    v_mul_u32_u24 v43, 48, v43
    ds_bpermute_b32 v48, v24, v43
    ds_bpermute_b32 v49, v24, v43 offset:128
    ds_write_b32 v40, v41 offset:11264
    v_lshl_add_u32 v15, v43, 4, v15
    v_add_u32 v79, v79, v77
    v_lshl_or_b32 v83, v79, 14, v74
    v_mul_u32_u24 v79, 48, v79
    ds_bpermute_b32 v80, v24, v79
    ds_bpermute_b32 v81, v24, v79 offset:128
    ds_write_b32 v82, v83 offset:11264
    v_lshl_add_u32 v75, v79, 4, v75
    s_cmp_ge_u32 s18, 4
    s_waitcnt lgkmcnt(1)
    v_lshl_or_b32 v30, v37, 16, v30
    v_add_u32 v48, v48, v25
    v_add_u32 v49, v49, v25
    v_add_u32 v80, v80, v25
    v_add_u32 v81, v81, v25
    s_waitcnt vmcnt(5)
    ds_write_b128 v43, v[12:15] offset:27680
    s_waitcnt vmcnt(4)
    ds_write_b128 v48, v[16:19] offset:27648
    s_waitcnt vmcnt(3)
    ds_write_b128 v49, v[20:23] offset:27648
    s_waitcnt vmcnt(2)
    ds_write_b128 v79, v[72:75] offset:27680
    s_waitcnt vmcnt(1)
    ds_write_b128 v80, v[64:67] offset:27648
    s_waitcnt vmcnt(0)
    ds_write_b128 v81, v[68:71] offset:27648
    s_cbranch_scc1 ka_nohdr
    buffer_store_dword v30, v29, s[20:23], s28 offen
ka_nohdr:
    v_lshrrev_b32 v6, 2, v0
    v_lshlrev_b32 v6, 13, v6
    v_and_b32 v7, 0x30, v5
    v_or_b32 v6, v6, v7
    v_add_u32 v7, 27648, v5
    s_add_u32 s31, s30, 1310720
    s_cmp_ge_u32 s18, 6
    s_waitcnt lgkmcnt(0)
    s_barrier
    ds_read_b128 v[36:39], v5 offset:11264
    ds_read_b128 v[40:43], v5 offset:21504
    ds_read_b128 v[12:15], v7 offset:0
    ds_read_b128 v[16:19], v7 offset:10240
    ds_read_b128 v[20:23], v7 offset:20480
    ds_read_b128 v[24:27], v7 offset:30720
    ds_read_b128 v[28:31], v7 offset:40960
    ds_read_b128 v[32:35], v7 offset:51200
    s_waitcnt lgkmcnt(6)
    buffer_store_dwordx4 v[36:39], v6, s[20:23], s30 offen
    s_cbranch_scc1 ka_noc2
    buffer_store_dwordx4 v[40:43], v6, s[20:23], s31 offen
ka_noc2:
    s_waitcnt lgkmcnt(5)
    buffer_store_dwordx4 v[12:15], v5, s[20:23], s19 offen sc1
    s_addk_i32 s19, 10240
    s_waitcnt lgkmcnt(4)
    buffer_store_dwordx4 v[16:19], v5, s[20:23], s19 offen sc1
    s_addk_i32 s19, 10240
    s_waitcnt lgkmcnt(3)
    buffer_store_dwordx4 v[20:23], v5, s[20:23], s19 offen sc1
    s_addk_i32 s19, 10240
    s_waitcnt lgkmcnt(2)
    buffer_store_dwordx4 v[24:27], v5, s[20:23], s19 offen sc1
    s_addk_i32 s19, 10240
    s_waitcnt lgkmcnt(1)
    buffer_store_dwordx4 v[28:31], v5, s[20:23], s19 offen sc1
    s_addk_i32 s19, 10240
    s_waitcnt lgkmcnt(0)
    buffer_store_dwordx4 v[32:35], v5, s[20:23], s19 offen sc1
    s_endpgm
ka_pf:
    s_sub_u32 s34, s2, 127
    s_mul_i32 s34, s34, 40960
    s_sub_u32 s34, s34, 24576
    v_lshl_add_u32 v44, v0, 7, s34
    v_min_u32 v44, 5119996, v44
    s_waitcnt lgkmcnt(0)
    s_cmp_ge_u32 s18, 3
    s_cbranch_scc1 ka_nohlp
    global_load_dword v45, v44, s[10:11]
ka_nohlp:
    s_and_b32 s34, s2, 7
    s_mul_i32 s34, s34, 655360
    s_add_u32 s24, s16, s34
    s_addc_u32 s25, s17, 0
    s_and_b32 s25, s25, 0xffff
    s_mov_b32 s26, 655360
    s_mov_b32 s27, 0x20000
    s_bfe_u32 s30, s2, 0x40003
    v_lshlrev_b32 v40, 7, v0
    s_mul_i32 s30, s30, 40960
    s_cmp_lg_u32 s18, 9
    s_cbranch_scc1 ka_pf1
    s_bitcmp1_b32 s2, 3
    s_cbranch_scc1 ka_pf1
    s_and_b32 s35, s2, 7
    s_bfe_u32 s36, s2, 0x30004
    s_lshl_b32 s37, s35, 14
    s_lshr_b32 s38, s36, 1
    s_lshl_b32 s38, s38, 7
    s_add_u32 s37, s37, s38
    s_and_b32 s38, s36, 1
    s_lshl2_add_u32 s37, s38, s37
    v_lshrrev_b32 v44, 4, v1
    v_lshlrev_b32 v44, 11, v44
    v_and_b32 v45, 7, v1
    v_lshl_add_u32 v44, v45, 4, v44
    v_and_b32 v45, 8, v1
    v_add3_u32 v44, v44, v45, s37
    v_add_u32 v45, 0x2000, v44
    global_load_dword v48, v44, s[32:33] offset:0
    global_load_dword v49, v44, s[32:33] offset:512
    global_load_dword v50, v44, s[32:33] offset:1024
    global_load_dword v51, v44, s[32:33] offset:1536
    global_load_dword v52, v45, s[32:33] offset:0
    global_load_dword v53, v45, s[32:33] offset:512
    global_load_dword v54, v45, s[32:33] offset:1024
    global_load_dword v55, v45, s[32:33] offset:1536
    s_lshr_b32 s36, s36, 1
    s_lshl3_add_u32 s36, s36, s35
    s_lshl1_add_u32 s36, s36, s38
    s_lshl_b32 s36, s36, 11
    s_add_u32 s36, s36, 11534336
    v_lshl_add_u32 v46, v1, 4, s36
    s_mov_b32 s38, 0x05040100
    s_mov_b32 s39, 0x07060302
    s_waitcnt vmcnt(0)
    v_perm_b32 v56, v49, v48, s38
    v_perm_b32 v60, v49, v48, s39
    v_perm_b32 v57, v51, v50, s38
    v_perm_b32 v61, v51, v50, s39
    v_perm_b32 v58, v53, v52, s38
    v_perm_b32 v62, v53, v52, s39
    v_perm_b32 v59, v55, v54, s38
    v_perm_b32 v63, v55, v54, s39
    global_store_dwordx4 v46, v[56:59], s[14:15]
    global_store_dwordx4 v46, v[60:63], s[14:15] offset:1024
ka_pf1:
    s_cmp_ge_u32 s18, 5
    s_cbranch_scc1 ka_end
    buffer_load_dword v42, v40, s[24:27], s30 offen
    s_cmp_ge_u32 s18, 0
    s_cbranch_scc1 ka_end
    s_add_u32 s30, s30, 81920
    buffer_load_dword v43, v40, s[24:27], s30 offen
    s_endpgm
ka_extra:
    s_cmp_lg_u32 s2, 125
    s_cbranch_scc1 ka_end
    s_cmp_ge_u32 s18, 6
    s_cbranch_scc1 ka_end
    s_load_dwordx4 s[36:39], s[0:1], 40
    s_lshl_b32 s34, s18, 11
    s_add_u32 s34, s34, 11665408
    v_lshl_add_u32 v46, v1, 4, s34
    s_cmp_eq_u32 s18, 5
    s_cbranch_scc1 ka_dum
    s_cmp_eq_u32 s18, 4
    s_cbranch_scc1 ka_cg
    v_lshrrev_b32 v44, 5, v1
    v_lshlrev_b32 v44, 12, v44
    v_and_b32 v45, 31, v1
    v_lshl_add_u32 v44, v45, 1, v44
    v_lshl_add_u32 v44, s18, 7, v44
    s_waitcnt lgkmcnt(0)
    global_load_ushort v48, v44, s[38:39] offset:0
    global_load_ushort v49, v44, s[38:39] offset:512
    global_load_ushort v50, v44, s[38:39] offset:1024
    global_load_ushort v51, v44, s[38:39] offset:1536
    global_load_ushort v52, v44, s[38:39] offset:2048
    global_load_ushort v53, v44, s[38:39] offset:2560
    global_load_ushort v54, v44, s[38:39] offset:3072
    global_load_ushort v55, v44, s[38:39] offset:3584
    global_load_ushort v56, v44, s[38:39] offset:64
    global_load_ushort v57, v44, s[38:39] offset:576
    global_load_ushort v58, v44, s[38:39] offset:1088
    global_load_ushort v59, v44, s[38:39] offset:1600
    global_load_ushort v60, v44, s[38:39] offset:2112
    global_load_ushort v61, v44, s[38:39] offset:2624
    global_load_ushort v62, v44, s[38:39] offset:3136
    global_load_ushort v63, v44, s[38:39] offset:3648
    s_branch ka_pk
ka_cg:
    v_and_b32 v44, 3, v1
    v_lshlrev_b32 v44, 1, v44
    s_waitcnt lgkmcnt(0)
    global_load_ushort v48, v44, s[36:37] offset:0
    global_load_ushort v49, v44, s[36:37] offset:8
    global_load_ushort v50, v44, s[36:37] offset:16
    global_load_ushort v51, v44, s[36:37] offset:24
    global_load_ushort v52, v44, s[36:37] offset:32
    global_load_ushort v53, v44, s[36:37] offset:40
    global_load_ushort v54, v44, s[36:37] offset:48
    global_load_ushort v55, v44, s[36:37] offset:56
    global_load_ushort v56, v44, s[36:37] offset:64
    global_load_ushort v57, v44, s[36:37] offset:72
    global_load_ushort v58, v44, s[36:37] offset:80
    global_load_ushort v59, v44, s[36:37] offset:88
    global_load_ushort v60, v44, s[36:37] offset:96
    global_load_ushort v61, v44, s[36:37] offset:104
    global_load_ushort v62, v44, s[36:37] offset:112
    global_load_ushort v63, v44, s[36:37] offset:120
ka_pk:
    s_waitcnt vmcnt(0)
    v_lshl_or_b32 v64, v49, 16, v48
    v_lshl_or_b32 v65, v51, 16, v50
    v_lshl_or_b32 v66, v53, 16, v52
    v_lshl_or_b32 v67, v55, 16, v54
    v_lshl_or_b32 v68, v57, 16, v56
    v_lshl_or_b32 v69, v59, 16, v58
    v_lshl_or_b32 v70, v61, 16, v60
    v_lshl_or_b32 v71, v63, 16, v62
    global_store_dwordx4 v46, v[64:67], s[14:15]
    global_store_dwordx4 v46, v[68:71], s[14:15] offset:1024
    s_endpgm
ka_dum:
    v_mov_b32 v46, 11677696
    v_mov_b32 v48, 0
    v_mov_b32 v49, 0
    v_mov_b32 v50, 0
    v_mov_b32 v51, 0
    v_mov_b32 v52, 0x3fff
    v_mov_b32 v53, 186843136
    s_mov_b64 exec, 1
    s_waitcnt lgkmcnt(0)
    global_store_dwordx4 v46, v[48:51], s[14:15]
    global_store_dwordx4 v46, v[48:51], s[14:15] offset:16
    global_store_dwordx4 v46, v[50:53], s[14:15] offset:32
ka_end:
    s_endpgm
.globl main_kernel
.p2align 8
.type main_kernel,@function
main_kernel:
    s_cmp_ge_u32 s2, 256
    s_cbranch_scc1 mn_end
    s_load_dwordx2 s[54:55], s[0:1], 80
    s_load_dwordx2 s[50:51], s[0:1], 0
    v_lshrrev_b32 v56, 6, v0
    s_and_b32 s48, s2, 7
    v_readfirstlane_b32 s16, v56
    s_lshr_b32 s47, s2, 3
    s_lshl_b32 s25, s48, 5
    s_add_u32 s25, s25, s47
    s_lshl_b32 s49, s25, 13
    s_add_u32 s49, s49, 8388608
    s_lshl_b32 s25, s25, 9
    s_add_u32 s25, s25, 10485760
    s_mov_b32 s10, 12582912
    s_mov_b32 s11, 0x20000
    s_and_b32 s17, s16, 3
    s_movk_i32 s20, 20
    s_mov_b32 s24, 0
    s_cmp_ge_u32 s16, 8
    s_cbranch_scc1 gm_main
    v_lshrrev_b32 v56, 6, v0
    v_lshlrev_b32 v55, 1, v0
    v_and_b32 v55, 0x78, v55
    v_or_b32 v55, v55, v56
    v_cmp_gt_u32 vcc, 125, v55
    v_mul_u32_u24 v46, 61440, v55
    v_bfrev_b32 v56, 2
    v_lshlrev_b32 v55, 4, v0
    v_and_b32 v57, 0x1fc, v0
    v_cndmask_b32 v55, v56, v55, vcc
    v_cndmask_b32 v57, v56, v57, vcc
    v_and_b32 v51, 63, v0
    v_lshlrev_b32 v56, 3, v51
    s_lshl_b32 s52, s17, 11
    s_add_u32 s52, s52, 11665408
    s_mov_b32 s53, 11673600
    v_lshlrev_b32 v52, 4, v51
    s_waitcnt lgkmcnt(0)
    s_mov_b32 s8, s54
    s_and_b32 s9, s55, 0xffff
    buffer_load_dwordx4 v[20:23], v55, s[8:11], s49 offen
    buffer_load_dword v58, v57, s[8:11], s25 offen
    buffer_load_dwordx2 v[44:45], v56, s[8:11], s25 offen
    s_barrier
    buffer_load_dwordx4 v[68:71], v52, s[8:11], s52 offen
    buffer_load_dwordx4 v[72:75], v52, s[8:11], s52 offen offset:1024
    buffer_load_dwordx4 v[76:79], v52, s[8:11], s53 offen
    buffer_load_dwordx4 v[80:83], v52, s[8:11], s53 offen offset:1024
    v_mov_b32 v24, 0
    s_lshr_b32 s18, s16, 2
    s_lshl_b32 s53, s17, 7
    s_add_u32 s4, s50, s53
    s_addc_u32 s5, s51, 0
    s_and_b32 s5, s5, 0xffff
    s_or_b32 s5, s5, 0x08000000
    s_movk_i32 s6, 10000
    s_mov_b32 s7, 0x20000
    s_mul_i32 s40, s16, 15360
    s_add_u32 s40, s40, 40960
    v_lshl_add_u32 v87, v51, 3, s40
    s_add_u32 s40, s40, 9216
    s_add_u32 s41, s40, 1024
    s_add_u32 s42, s40, 2048
    s_add_u32 s43, s40, 3072
    s_add_u32 s44, s40, 4096
    s_add_u32 s45, s40, 5120
    v_and_b32 v55, 3, v0
    v_bfe_u32 v56, v0, 2, 2
    v_bfe_u32 v57, v0, 4, 1
    v_bfe_u32 v53, v0, 5, 1
    v_lshlrev_b32 v1, 3, v55
    v_lshl_add_u32 v1, v57, 5, v1
    v_lshl_add_u32 v1, v56, 6, v1
    v_lshl_add_u32 v1, v53, 8, v1
    v_add_u32 v1, s40, v1
    v_lshlrev_b32 v5, 4, v55
    v_lshl_add_u32 v5, v57, 6, v5
    v_lshl_add_u32 v5, v56, 9, v5
    v_mov_b32 v7, v5
    v_bfe_u32 v55, v0, 2, 1
    v_lshlrev_b32 v86, 4, v53
    v_lshl_or_b32 v86, v55, 18, v86
    v_mov_b32 v48, 1
    v_lshlrev_b32 v47, 2, v51
    v_bfe_u32 v2, v0, 5, 1
    v_bfe_u32 v3, v0, 3, 2
    v_and_b32 v35, 3, v0
    v_lshl_add_u32 v3, v3, 2, v35
    v_mul_u32_u24 v49, 20, v2
    v_lshrrev_b32 v18, 2, v51
    v_lshl_add_u32 v18, v35, 4, v18
    v_mov_b32 v50, 1327103
    s_lshl_b32 s52, s16, 3
    s_bfm_b64 s[36:37], s52, 0
    s_andn2_b32 s39, s37, 2155905024
    s_mov_b32 s38, s36
    v_mov_b64 v[88:89], 0
    v_mov_b64 v[90:91], 0
    v_mov_b64 v[92:93], 0
    v_mov_b64 v[94:95], 0
    v_mov_b64 v[96:97], 0
    v_mov_b64 v[98:99], 0
    v_mov_b64 v[100:101], 0
    v_mov_b64 v[102:103], 0
    v_mov_b64 v[104:105], 0
    v_mov_b64 v[106:107], 0
    v_mov_b64 v[108:109], 0
    v_mov_b64 v[110:111], 0
    v_mov_b64 v[112:113], 0
    v_mov_b64 v[114:115], 0
    v_mov_b64 v[116:117], 0
    v_mov_b64 v[118:119], 0
    v_mov_b64 v[120:121], 0
    v_mov_b64 v[122:123], 0
    v_mov_b64 v[124:125], 0
    v_mov_b64 v[126:127], 0
    v_mov_b64 v[128:129], 0
    v_mov_b64 v[130:131], 0
    v_mov_b64 v[132:133], 0
    v_mov_b64 v[134:135], 0
    v_mov_b64 v[136:137], 0
    v_mov_b64 v[138:139], 0
    v_mov_b64 v[140:141], 0
    v_mov_b64 v[142:143], 0
    v_mov_b64 v[144:145], 0
    v_mov_b64 v[146:147], 0
    v_mov_b64 v[148:149], 0
    v_mov_b64 v[150:151], 0
    v_mov_b64 v[152:153], 0
    v_mov_b64 v[154:155], 0
    v_mov_b64 v[156:157], 0
    v_mov_b64 v[158:159], 0
    v_mov_b64 v[160:161], 0
    v_mov_b64 v[162:163], 0
    v_mov_b64 v[164:165], 0
    v_mov_b64 v[166:167], 0
    s_mov_b32 s52, 0x110000
    s_waitcnt vmcnt(4)
    v_cmp_le_u32 vcc, s52, v58
    s_cbranch_vccnz mn_w5
mn_count:
    v_cmpx_gt_i32 vcc, 0, v20
    s_cbranch_execz mn_cn_done
    v_lshrrev_b32 v25, 23, v20
    v_and_b32 v25, 0xfc, v25
    ds_add_rtn_u32 v30, v25, v48
    v_cmpx_gt_i32 vcc, 0, v21
    s_cbranch_execz mn_cn_done
    v_lshrrev_b32 v26, 23, v21
    v_and_b32 v26, 0xfc, v26
    ds_add_rtn_u32 v31, v26, v48
    v_cmpx_gt_i32 vcc, 0, v22
    s_cbranch_execz mn_cn_done
    v_lshrrev_b32 v27, 23, v22
    v_and_b32 v27, 0xfc, v27
    ds_add_rtn_u32 v32, v27, v48
    v_cmpx_gt_i32 vcc, 0, v23
    s_cbranch_execz mn_cn_done
    v_lshrrev_b32 v28, 23, v23
    v_and_b32 v28, 0xfc, v28
    ds_add_rtn_u32 v33, v28, v48
    v_cmpx_gt_i32 vcc, 0, v24
    s_cbranch_execz mn_cn_done
    v_lshrrev_b32 v29, 23, v24
    v_and_b32 v29, 0xfc, v29
    ds_add_rtn_u32 v34, v29, v48
mn_cn_done:
    s_mov_b64 exec, -1
    v_lshrrev_b32 v42, 16, v58
    v_subrev_u32 v42, s24, v42
    v_med3_i32 v42, v42, 0, s20
    v_lshrrev_b32 v55, 16, v44
    v_subrev_u32 v55, s24, v55
    v_med3_i32 v55, v55, 0, s20
    v_lshrrev_b32 v56, 16, v45
    v_subrev_u32 v56, s24, v56
    v_med3_i32 v56, v56, 0, s20
    v_mov_b32 v43, v42
    v_cndmask_b32 v55, 0, v55, s[36:37]
    v_cndmask_b32 v56, 0, v56, s[38:39]
    v_add_u32 v59, v55, v56
    v_mov_b32 v52, 0
    s_lshl_b32 s52, s18, 5
    s_add_u32 s53, s52, 31
    s_waitcnt lgkmcnt(0)
    s_barrier
    ds_read_b32 v53, v47 offset:0
    ds_read_b32 v52, v52 offset:272
    v_add_u32_dpp v59, v59, v59 row_shr:1 row_mask:0xf bank_mask:0xf
    s_nop 1
    v_add_u32_dpp v59, v59, v59 row_shr:2 row_mask:0xf bank_mask:0xf
    s_nop 1
    v_add_u32_dpp v59, v59, v59 row_shr:4 row_mask:0xf bank_mask:0xf
    v_add_u32_dpp v43, v43, v43 row_shr:4 row_mask:0xf bank_mask:0xf
    s_nop 0
    v_add_u32_dpp v59, v59, v59 row_shr:8 row_mask:0xf bank_mask:0xf
    v_add_u32_dpp v43, v43, v43 row_shr:8 row_mask:0xf bank_mask:0xf
    s_nop 0
    v_add_u32_dpp v59, v59, v59 row_bcast:15 row_mask:0xa bank_mask:0xf
    v_add_u32_dpp v43, v43, v43 row_bcast:15 row_mask:0xa bank_mask:0xf
    s_nop 0
    v_add_u32_dpp v59, v59, v59 row_bcast:31 row_mask:0xc bank_mask:0xf
    v_add_u32_dpp v43, v43, v43 row_bcast:31 row_mask:0xc bank_mask:0xf
    s_nop 0
    v_readlane_b32 s49, v59, 63
    v_sub_u32 v41, v43, v42
    s_movk_i32 s48, 0x3fff
    s_waitcnt lgkmcnt(1)
    v_mov_b32 v54, v53
    v_sub_u32 v53, v49, v53
    v_add3_u32 v41, v41, v35, s49
    v_add_u32_dpp v54, v54, v54 row_shr:1 row_mask:0xf bank_mask:0xf
    v_mul_u32_u24 v41, 196608, v41
    v_add_u32 v41, 15466496, v41
    v_add_u32_dpp v54, v54, v54 row_shr:2 row_mask:0xf bank_mask:0xf
    v_and_or_b32 v36, v20, s48, v41
    v_add_u32 v41, 786432, v41
    v_add_u32_dpp v54, v54, v54 row_shr:4 row_mask:0xf bank_mask:0xf
    v_and_or_b32 v37, v21, s48, v41
    v_add_u32 v41, 786432, v41
    v_add_u32_dpp v54, v54, v54 row_shr:8 row_mask:0xf bank_mask:0xf
    v_and_or_b32 v38, v22, s48, v41
    v_add_u32 v41, 786432, v41
    v_add_u32_dpp v54, v54, v54 row_bcast:15 row_mask:0xa bank_mask:0xf
    v_and_or_b32 v39, v23, s48, v41
    v_add_u32 v41, 786432, v41
    v_add_u32_dpp v54, v54, v54 row_bcast:31 row_mask:0xc bank_mask:0xf
    v_add_u32 v53, v53, v54
    v_add_u32 v54, v54, v49
    ds_bpermute_b32 v25, v25, v53
    ds_bpermute_b32 v26, v26, v53
    ds_bpermute_b32 v27, v27, v53
    ds_bpermute_b32 v28, v28, v53
    ds_bpermute_b32 v29, v29, v53
    v_and_or_b32 v40, v24, s48, v41
    v_readlane_b32 s23, v54, 63
    v_readlane_b32 s33, v54, s53
    v_readlane_b32 s32, v53, s52
    s_cmp_gt_u32 s23, 794
    s_cbranch_scc1 mn_ovf
    v_add_lshl_u32 v55, s33, v51, 2
    s_mov_b32 exec_lo, 1048575
    s_mov_b32 exec_hi, 0
    ds_write_b32 v55, v50 offset:512
    s_mov_b64 exec, -1
    v_add_lshl_u32 v2, s32, v2, 2
    v_add_lshl_u32 v3, s32, v3, 2
    v_add_lshl_u32 v18, s32, v18, 2
    s_waitcnt lgkmcnt(1)
    v_readfirstlane_b32 s21, v52
    v_cmpx_gt_i32 vcc, 0, v20
    s_cbranch_execz mn_w2_done
    v_add_lshl_u32 v25, v25, v30, 2
    ds_write_b32 v25, v36 offset:512
    v_cmpx_gt_i32 vcc, 0, v21
    s_cbranch_execz mn_w2_done
    v_add_lshl_u32 v26, v26, v31, 2
    ds_write_b32 v26, v37 offset:512
    v_cmpx_gt_i32 vcc, 0, v22
    s_cbranch_execz mn_w2_done
    v_add_lshl_u32 v27, v27, v32, 2
    ds_write_b32 v27, v38 offset:512
    v_cmpx_gt_i32 vcc, 0, v23
    s_cbranch_execz mn_w2_done
    v_add_lshl_u32 v28, v28, v33, 2
    ds_write_b32 v28, v39 offset:512
    v_cmpx_gt_i32 vcc, 0, v24
    s_cbranch_execz mn_w2_done
    v_add_lshl_u32 v29, v29, v34, 2
    ds_write_b32 v29, v40 offset:512
mn_w2_done:
    s_mov_b64 exec, -1
    s_mov_b32 m0, s40
    s_sub_u32 s32, s32, 3
    s_sub_u32 s59, s33, s32
    s_lshr_b32 s59, s59, 2
    s_waitcnt lgkmcnt(0)
    s_barrier
    ds_read_u16 v4, v2 offset:512
    ds_read_u16 v6, v2 offset:520
    ds_read_u16 v8, v18 offset:514
    ds_read_u16 v84, v3 offset:514
    ds_read_u16 v22, v2 offset:528
    ds_read_u16 v23, v2 offset:536
    ds_read_u16 v24, v2 offset:544
    ds_read_u16 v25, v2 offset:552
    ds_read_u16 v26, v2 offset:560
    ds_read_u16 v27, v2 offset:568
    s_sub_u32 s53, s53, 4
    v_readlane_b32 s84, v54, s53
    s_add_u32 s53, s53, 1
    v_readlane_b32 s85, v54, s53
    s_add_u32 s53, s53, 1
    v_readlane_b32 s86, v54, s53
    s_add_u32 s53, s53, 1
    v_readlane_b32 s87, v54, s53
    s_waitcnt lgkmcnt(8)
    buffer_load_dwordx4 v[4:5], s[4:7], 0 idxen offen lds
    s_mov_b32 m0, s41
    s_waitcnt lgkmcnt(6)
    buffer_load_dwordx4 v[6:7], s[4:7], 0 idxen offen lds
    v_lshlrev_b32 v8, 4, v8
    v_lshl_add_u32 v84, v84, 4, v86
    v_xor_b32 v85, 0x40000, v84
    s_waitcnt lgkmcnt(0)
    s_mov_b32 m0, s42
    v_mov_b32 v4, v22
    buffer_load_dwordx4 v[4:5], s[4:7], 0 idxen offen lds
    s_mov_b32 m0, s43
    v_mov_b32 v4, v23
    buffer_load_dwordx4 v[4:5], s[4:7], 0 idxen offen lds
    s_setprio 3
    s_waitcnt vmcnt(4) lgkmcnt(0)
    s_barrier
    ds_read_b128 v[8:11], v8 offset:32
    ds_read_b128 v[60:63], v84
    ds_read_b128 v[64:67], v85
    s_mov_b32 m0, s44
    v_mov_b32 v4, v24
    buffer_load_dwordx4 v[4:5], s[4:7], 0 idxen offen lds
    s_mov_b32 m0, s45
    v_mov_b32 v4, v25
    buffer_load_dwordx4 v[4:5], s[4:7], 0 idxen offen lds
    v_mov_b32 v4, v26
    v_mov_b32 v6, v27
    s_waitcnt vmcnt(4)
    ds_read_b64_tr_b16 v[20:21], v1 offset:0
    ds_read_b64_tr_b16 v[22:23], v1 offset:512
    ds_read_b64_tr_b16 v[24:25], v1 offset:1024
    ds_read_b64_tr_b16 v[26:27], v1 offset:1536
    s_waitcnt lgkmcnt(6)
    v_mfma_f32_4x4x4_16b_bf16 v[28:31], v[8:9], v[76:77], 0
    v_mfma_f32_4x4x4_16b_bf16 v[32:35], v[8:9], v[78:79], 0
    v_mfma_f32_4x4x4_16b_bf16 v[36:39], v[8:9], v[80:81], 0
    v_mfma_f32_4x4x4_16b_bf16 v[40:43], v[8:9], v[82:83], 0
    v_min_u32 v0, 1, v51
    v_lshlrev_b32 v0, 18, v0
    v_lshl_add_u32 v0, s17, 2, v0
    s_lshl_b32 s52, s18, 1
    s_sub_i32 s52, 1, s52
    s_mul_i32 s53, s52, s59
    s_add_i32 s53, s53, 2
    v_mov_b32 v19, s53
    v_and_b32 v11, 0xff, v11
    v_or_b32 v11, 0xc000, v11
    v_lshlrev_b32 v10, 16, v11
    s_waitcnt lgkmcnt(4)
    v_mfma_f32_32x32x16_bf16 v[44:59], v[60:63], v[68:71], 0
    v_mfma_f32_32x32x16_bf16 v[44:59], v[64:67], v[72:75], v[44:59]
    s_mov_b32 m0, s40
    s_waitcnt lgkmcnt(0)
    buffer_load_dwordx4 v[4:5], s[4:7], 0 idxen offen lds
    s_mov_b32 m0, s41
    ds_add_u32 v0, v19 offset:288
    buffer_load_dwordx4 v[6:7], s[4:7], 0 idxen offen lds
    v_or_b32_dpp v19, v10, v11 row_shl:4 row_mask:0xf bank_mask:0xf bound_ctrl:0
    v_cvt_pk_bf16_f32 v12, v28, v32
    v_cvt_pk_bf16_f32 v14, v29, v33
    v_cvt_pk_bf16_f32 v16, v30, v34
    v_cvt_pk_bf16_f32 v13, v36, v40
    v_cvt_pk_bf16_f32 v15, v37, v41
    v_cvt_pk_bf16_f32 v17, v38, v42
    s_sub_u32 s84, s84, s32
    s_lshr_b32 s84, s84, 2
    s_sub_u32 s85, s85, s32
    s_lshr_b32 s85, s85, 2
    s_sub_u32 s86, s86, s32
    s_lshr_b32 s86, s86, 2
    s_sub_u32 s87, s87, s32
    s_lshr_b32 s87, s87, 2
    s_sub_u32 s88, s59, s87
    s_sub_u32 s87, s87, s86
    s_sub_u32 s86, s86, s85
    s_sub_u32 s85, s85, s84
    s_cmp_lg_u32 s21, 0
    s_cselect_b32 s19, s59, s84
    s_mov_b32 s58, 0
    s_mov_b32 s35, 0
    s_sub_i32 s34, s59, 4
    s_max_i32 s34, s34, 0
    s_mul_i32 s30, s52, -4
    s_lshl_b32 s26, s18, 31
    s_set_gpr_idx_on s40, gpr_idx(SRC2,DST)
    s_sub_u32 s19, s19, 1
    s_cbranch_scc1 mn_st12
mn_st12_back:
mn_loop:
    v_mfma_f32_4x4x4_16b_bf16 v[28:31], v[12:13], v[20:21], 0 cbsz:4 abid:0
    v_mfma_f32_4x4x4_16b_bf16 v[32:35], v[12:13], v[22:23], 0 cbsz:4 abid:1
    v_mfma_f32_4x4x4_16b_bf16 v[36:39], v[12:13], v[24:25], 0 cbsz:4 abid:2
    v_mfma_f32_4x4x4_16b_bf16 v[40:43], v[12:13], v[26:27], 0 cbsz:4 abid:3
    ds_read_u16 v4, v2 offset:576
    ds_read_u16 v6, v2 offset:584
    v_readlane_b32 s28, v19, 0
    v_readlane_b32 s29, v19, 8
    s_waitcnt vmcnt(5)
    ds_read_b64_tr_b16 v[20:21], v1 offset:2048
    ds_read_b64_tr_b16 v[22:23], v1 offset:2560
    s_waitcnt vmcnt(4)
    ds_read_b64_tr_b16 v[24:25], v1 offset:3072
    ds_read_b64_tr_b16 v[26:27], v1 offset:3584
    s_sub_u32 s34, s34, 1
    s_cmov_b32 s35, 0x30000
    s_mov_b32 m0, s28
    v_fmac_f32 v88, v28, v44
    v_fmac_f32 v89, v29, v44
    v_fmac_f32 v90, v30, v44
    v_fmac_f32 v91, v31, v44
    s_lshr_b32 m0, s28, 16
    v_fmac_f32 v88, v32, v45
    v_fmac_f32 v89, v33, v45
    v_fmac_f32 v90, v34, v45
    v_fmac_f32 v91, v35, v45
    s_mov_b32 m0, s29
    v_fmac_f32 v88, v36, v46
    v_fmac_f32 v89, v37, v46
    v_fmac_f32 v90, v38, v46
    v_fmac_f32 v91, v39, v46
    s_lshr_b32 m0, s29, 16
    v_fmac_f32 v88, v40, v47
    v_fmac_f32 v89, v41, v47
    v_fmac_f32 v90, v42, v47
    v_fmac_f32 v91, v43, v47
    s_or_b32 m0, s42, s35
    s_waitcnt lgkmcnt(2)
    buffer_load_dwordx4 v[4:5], s[4:7], 0 idxen offen lds
    s_or_b32 m0, s43, s35
    s_waitcnt lgkmcnt(0)
    buffer_load_dwordx4 v[6:7], s[4:7], 0 idxen offen lds
    s_sub_u32 s19, s19, 1
    s_cbranch_scc1 mn_st0
mn_st0_back:
    v_mfma_f32_4x4x4_16b_bf16 v[28:31], v[12:13], v[20:21], 0 cbsz:4 abid:4
    v_mfma_f32_4x4x4_16b_bf16 v[32:35], v[12:13], v[22:23], 0 cbsz:4 abid:5
    v_mfma_f32_4x4x4_16b_bf16 v[36:39], v[12:13], v[24:25], 0 cbsz:4 abid:6
    v_mfma_f32_4x4x4_16b_bf16 v[40:43], v[12:13], v[26:27], 0 cbsz:4 abid:7
    ds_read_u16 v4, v2 offset:592
    ds_read_u16 v6, v2 offset:600
    v_readlane_b32 s28, v19, 16
    v_readlane_b32 s29, v19, 24
    ds_read_u16 v84, v3 offset:578
    s_waitcnt vmcnt(5)
    ds_read_b64_tr_b16 v[20:21], v1 offset:4096
    ds_read_b64_tr_b16 v[22:23], v1 offset:4608
    s_waitcnt vmcnt(4)
    ds_read_b64_tr_b16 v[24:25], v1 offset:5120
    ds_read_b64_tr_b16 v[26:27], v1 offset:5632
    s_sub_u32 s34, s34, 1
    s_cmov_b32 s35, 0x30000
    s_mov_b32 m0, s28
    v_fmac_f32 v88, v28, v48
    v_fmac_f32 v89, v29, v48
    v_fmac_f32 v90, v30, v48
    v_fmac_f32 v91, v31, v48
    s_lshr_b32 m0, s28, 16
    v_fmac_f32 v88, v32, v49
    v_fmac_f32 v89, v33, v49
    v_fmac_f32 v90, v34, v49
    v_fmac_f32 v91, v35, v49
    s_mov_b32 m0, s29
    v_fmac_f32 v88, v36, v50
    v_fmac_f32 v89, v37, v50
    v_fmac_f32 v90, v38, v50
    v_fmac_f32 v91, v39, v50
    s_lshr_b32 m0, s29, 16
    v_fmac_f32 v88, v40, v51
    v_fmac_f32 v89, v41, v51
    v_fmac_f32 v90, v42, v51
    v_fmac_f32 v91, v43, v51
    s_or_b32 m0, s44, s35
    s_waitcnt lgkmcnt(2)
    buffer_load_dwordx4 v[4:5], s[4:7], 0 idxen offen lds
    s_or_b32 m0, s45, s35
    s_waitcnt lgkmcnt(0)
    buffer_load_dwordx4 v[6:7], s[4:7], 0 idxen offen lds
    s_sub_u32 s19, s19, 1
    s_cbranch_scc1 mn_st1
mn_st1_back:
    v_mfma_f32_4x4x4_16b_bf16 v[28:31], v[12:13], v[20:21], 0 cbsz:4 abid:8
    v_mfma_f32_4x4x4_16b_bf16 v[32:35], v[12:13], v[22:23], 0 cbsz:4 abid:9
    v_mfma_f32_4x4x4_16b_bf16 v[36:39], v[12:13], v[24:25], 0 cbsz:4 abid:10
    v_mfma_f32_4x4x4_16b_bf16 v[40:43], v[12:13], v[26:27], 0 cbsz:4 abid:11
    ds_read_u16 v4, v2 offset:608
    ds_read_u16 v6, v2 offset:616
    v_readlane_b32 s28, v19, 32
    v_readlane_b32 s29, v19, 40
    v_lshl_add_u32 v84, v84, 4, v86
    v_xor_b32 v85, 0x40000, v84
    ds_read_b128 v[60:63], v84
    ds_read_b128 v[64:67], v85
    s_waitcnt vmcnt(5)
    ds_read_b64_tr_b16 v[20:21], v1 offset:0
    ds_read_b64_tr_b16 v[22:23], v1 offset:512
    s_waitcnt vmcnt(4)
    ds_read_b64_tr_b16 v[24:25], v1 offset:1024
    ds_read_b64_tr_b16 v[26:27], v1 offset:1536
    s_sub_u32 s34, s34, 1
    s_cmov_b32 s35, 0x30000
    s_mov_b32 m0, s28
    v_fmac_f32 v88, v28, v52
    v_fmac_f32 v89, v29, v52
    v_fmac_f32 v90, v30, v52
    v_fmac_f32 v91, v31, v52
    s_lshr_b32 m0, s28, 16
    v_fmac_f32 v88, v32, v53
    v_fmac_f32 v89, v33, v53
    v_fmac_f32 v90, v34, v53
    v_fmac_f32 v91, v35, v53
    s_mov_b32 m0, s29
    v_fmac_f32 v88, v36, v54
    v_fmac_f32 v89, v37, v54
    v_fmac_f32 v90, v38, v54
    v_fmac_f32 v91, v39, v54
    s_lshr_b32 m0, s29, 16
    v_fmac_f32 v88, v40, v55
    v_fmac_f32 v89, v41, v55
    v_fmac_f32 v90, v42, v55
    v_fmac_f32 v91, v43, v55
    s_or_b32 m0, s40, s35
    s_waitcnt lgkmcnt(2)
    buffer_load_dwordx4 v[4:5], s[4:7], 0 idxen offen lds
    s_or_b32 m0, s41, s35
    s_waitcnt lgkmcnt(0)
    buffer_load_dwordx4 v[6:7], s[4:7], 0 idxen offen lds
    s_sub_u32 s19, s19, 1
    s_cbranch_scc1 mn_st2
mn_st2_back:
    v_mfma_f32_4x4x4_16b_bf16 v[28:31], v[12:13], v[20:21], 0 cbsz:4 abid:12
    v_mfma_f32_4x4x4_16b_bf16 v[32:35], v[12:13], v[22:23], 0 cbsz:4 abid:13
    v_mfma_f32_4x4x4_16b_bf16 v[36:39], v[12:13], v[24:25], 0 cbsz:4 abid:14
    v_mfma_f32_4x4x4_16b_bf16 v[40:43], v[12:13], v[26:27], 0 cbsz:4 abid:15
    ds_read_u16 v4, v2 offset:624
    ds_read_u16 v6, v2 offset:632
    v_readlane_b32 s28, v19, 48
    v_readlane_b32 s29, v19, 56
    v_mov_b32 v85, s30
    ds_add_rtn_u32 v85, v0, v85 offset:288
    s_waitcnt vmcnt(5)
    ds_read_b64_tr_b16 v[20:21], v1 offset:2048
    ds_read_b64_tr_b16 v[22:23], v1 offset:2560
    s_waitcnt vmcnt(4)
    ds_read_b64_tr_b16 v[24:25], v1 offset:3072
    ds_read_b64_tr_b16 v[26:27], v1 offset:3584
    s_sub_u32 s34, s34, 1
    s_cmov_b32 s35, 0x30000
    s_mov_b32 m0, s28
    v_fmac_f32 v88, v28, v56
    v_fmac_f32 v89, v29, v56
    v_fmac_f32 v90, v30, v56
    v_fmac_f32 v91, v31, v56
    s_lshr_b32 m0, s28, 16
    v_fmac_f32 v88, v32, v57
    v_fmac_f32 v89, v33, v57
    v_fmac_f32 v90, v34, v57
    v_fmac_f32 v91, v35, v57
    s_mov_b32 m0, s29
    v_fmac_f32 v88, v36, v58
    v_fmac_f32 v89, v37, v58
    v_fmac_f32 v90, v38, v58
    v_fmac_f32 v91, v39, v58
    s_lshr_b32 m0, s29, 16
    v_fmac_f32 v88, v40, v59
    v_fmac_f32 v89, v41, v59
    v_fmac_f32 v90, v42, v59
    v_fmac_f32 v91, v43, v59
    s_or_b32 m0, s42, s35
    v_mfma_f32_32x32x16_bf16 v[44:59], v[60:63], v[68:71], 0
    v_mfma_f32_32x32x16_bf16 v[44:59], v[64:67], v[72:75], v[44:59]
    s_waitcnt lgkmcnt(2)
    buffer_load_dwordx4 v[4:5], s[4:7], 0 idxen offen lds
    s_or_b32 m0, s43, s35
    s_waitcnt lgkmcnt(0)
    buffer_load_dwordx4 v[6:7], s[4:7], 0 idxen offen lds
    v_readfirstlane_b32 s27, v85
    s_setprio 3
    s_xor_b32 s27, s27, s26
    s_cmp_ge_i32 s27, 0
    s_cbranch_scc1 mn_pr3
    s_setprio 2
mn_pr3:
    s_sub_u32 s19, s19, 1
    s_cbranch_scc1 mn_st3
mn_st3_back:
    v_mfma_f32_4x4x4_16b_bf16 v[28:31], v[14:15], v[20:21], 0 cbsz:4 abid:0
    v_mfma_f32_4x4x4_16b_bf16 v[32:35], v[14:15], v[22:23], 0 cbsz:4 abid:1
    v_mfma_f32_4x4x4_16b_bf16 v[36:39], v[14:15], v[24:25], 0 cbsz:4 abid:2
    v_mfma_f32_4x4x4_16b_bf16 v[40:43], v[14:15], v[26:27], 0 cbsz:4 abid:3
    ds_read_u16 v4, v2 offset:640
    ds_read_u16 v6, v2 offset:648
    v_readlane_b32 s28, v19, 1
    v_readlane_b32 s29, v19, 9
    s_waitcnt vmcnt(5)
    ds_read_b64_tr_b16 v[20:21], v1 offset:4096
    ds_read_b64_tr_b16 v[22:23], v1 offset:4608
    s_waitcnt vmcnt(4)
    ds_read_b64_tr_b16 v[24:25], v1 offset:5120
    ds_read_b64_tr_b16 v[26:27], v1 offset:5632
    s_sub_u32 s34, s34, 1
    s_cmov_b32 s35, 0x30000
    s_mov_b32 m0, s28
    v_fmac_f32 v88, v28, v44
    v_fmac_f32 v89, v29, v44
    v_fmac_f32 v90, v30, v44
    v_fmac_f32 v91, v31, v44
    s_lshr_b32 m0, s28, 16
    v_fmac_f32 v88, v32, v45
    v_fmac_f32 v89, v33, v45
    v_fmac_f32 v90, v34, v45
    v_fmac_f32 v91, v35, v45
    s_mov_b32 m0, s29
    v_fmac_f32 v88, v36, v46
    v_fmac_f32 v89, v37, v46
    v_fmac_f32 v90, v38, v46
    v_fmac_f32 v91, v39, v46
    s_lshr_b32 m0, s29, 16
    v_fmac_f32 v88, v40, v47
    v_fmac_f32 v89, v41, v47
    v_fmac_f32 v90, v42, v47
    v_fmac_f32 v91, v43, v47
    s_or_b32 m0, s44, s35
    s_waitcnt lgkmcnt(2)
    buffer_load_dwordx4 v[4:5], s[4:7], 0 idxen offen lds
    s_or_b32 m0, s45, s35
    s_waitcnt lgkmcnt(0)
    buffer_load_dwordx4 v[6:7], s[4:7], 0 idxen offen lds
    s_sub_u32 s19, s19, 1
    s_cbranch_scc1 mn_st4
mn_st4_back:
    v_mfma_f32_4x4x4_16b_bf16 v[28:31], v[14:15], v[20:21], 0 cbsz:4 abid:4
    v_mfma_f32_4x4x4_16b_bf16 v[32:35], v[14:15], v[22:23], 0 cbsz:4 abid:5
    v_mfma_f32_4x4x4_16b_bf16 v[36:39], v[14:15], v[24:25], 0 cbsz:4 abid:6
    v_mfma_f32_4x4x4_16b_bf16 v[40:43], v[14:15], v[26:27], 0 cbsz:4 abid:7
    ds_read_u16 v4, v2 offset:656
    ds_read_u16 v6, v2 offset:664
    v_readlane_b32 s28, v19, 17
    v_readlane_b32 s29, v19, 25
    ds_read_u16 v84, v3 offset:642
    s_waitcnt vmcnt(5)
    ds_read_b64_tr_b16 v[20:21], v1 offset:0
    ds_read_b64_tr_b16 v[22:23], v1 offset:512
    s_waitcnt vmcnt(4)
    ds_read_b64_tr_b16 v[24:25], v1 offset:1024
    ds_read_b64_tr_b16 v[26:27], v1 offset:1536
    s_sub_u32 s34, s34, 1
    s_cmov_b32 s35, 0x30000
    s_mov_b32 m0, s28
    v_fmac_f32 v88, v28, v48
    v_fmac_f32 v89, v29, v48
    v_fmac_f32 v90, v30, v48
    v_fmac_f32 v91, v31, v48
    s_lshr_b32 m0, s28, 16
    v_fmac_f32 v88, v32, v49
    v_fmac_f32 v89, v33, v49
    v_fmac_f32 v90, v34, v49
    v_fmac_f32 v91, v35, v49
    s_mov_b32 m0, s29
    v_fmac_f32 v88, v36, v50
    v_fmac_f32 v89, v37, v50
    v_fmac_f32 v90, v38, v50
    v_fmac_f32 v91, v39, v50
    s_lshr_b32 m0, s29, 16
    v_fmac_f32 v88, v40, v51
    v_fmac_f32 v89, v41, v51
    v_fmac_f32 v90, v42, v51
    v_fmac_f32 v91, v43, v51
    s_or_b32 m0, s40, s35
    s_waitcnt lgkmcnt(2)
    buffer_load_dwordx4 v[4:5], s[4:7], 0 idxen offen lds
    s_or_b32 m0, s41, s35
    s_waitcnt lgkmcnt(0)
    buffer_load_dwordx4 v[6:7], s[4:7], 0 idxen offen lds
    s_sub_u32 s19, s19, 1
    s_cbranch_scc1 mn_st5
mn_st5_back:
    v_mfma_f32_4x4x4_16b_bf16 v[28:31], v[14:15], v[20:21], 0 cbsz:4 abid:8
    v_mfma_f32_4x4x4_16b_bf16 v[32:35], v[14:15], v[22:23], 0 cbsz:4 abid:9
    v_mfma_f32_4x4x4_16b_bf16 v[36:39], v[14:15], v[24:25], 0 cbsz:4 abid:10
    v_mfma_f32_4x4x4_16b_bf16 v[40:43], v[14:15], v[26:27], 0 cbsz:4 abid:11
    ds_read_u16 v4, v2 offset:672
    ds_read_u16 v6, v2 offset:680
    v_readlane_b32 s28, v19, 33
    v_readlane_b32 s29, v19, 41
    v_lshl_add_u32 v84, v84, 4, v86
    v_xor_b32 v85, 0x40000, v84
    ds_read_b128 v[60:63], v84
    ds_read_b128 v[64:67], v85
    s_waitcnt vmcnt(5)
    ds_read_b64_tr_b16 v[20:21], v1 offset:2048
    ds_read_b64_tr_b16 v[22:23], v1 offset:2560
    s_waitcnt vmcnt(4)
    ds_read_b64_tr_b16 v[24:25], v1 offset:3072
    ds_read_b64_tr_b16 v[26:27], v1 offset:3584
    s_sub_u32 s34, s34, 1
    s_cmov_b32 s35, 0x30000
    s_mov_b32 m0, s28
    v_fmac_f32 v88, v28, v52
    v_fmac_f32 v89, v29, v52
    v_fmac_f32 v90, v30, v52
    v_fmac_f32 v91, v31, v52
    s_lshr_b32 m0, s28, 16
    v_fmac_f32 v88, v32, v53
    v_fmac_f32 v89, v33, v53
    v_fmac_f32 v90, v34, v53
    v_fmac_f32 v91, v35, v53
    s_mov_b32 m0, s29
    v_fmac_f32 v88, v36, v54
    v_fmac_f32 v89, v37, v54
    v_fmac_f32 v90, v38, v54
    v_fmac_f32 v91, v39, v54
    s_lshr_b32 m0, s29, 16
    v_fmac_f32 v88, v40, v55
    v_fmac_f32 v89, v41, v55
    v_fmac_f32 v90, v42, v55
    v_fmac_f32 v91, v43, v55
    s_or_b32 m0, s42, s35
    s_waitcnt lgkmcnt(2)
    buffer_load_dwordx4 v[4:5], s[4:7], 0 idxen offen lds
    s_or_b32 m0, s43, s35
    s_waitcnt lgkmcnt(0)
    buffer_load_dwordx4 v[6:7], s[4:7], 0 idxen offen lds
    s_sub_u32 s19, s19, 1
    s_cbranch_scc1 mn_st6
mn_st6_back:
    v_mfma_f32_4x4x4_16b_bf16 v[28:31], v[14:15], v[20:21], 0 cbsz:4 abid:12
    v_mfma_f32_4x4x4_16b_bf16 v[32:35], v[14:15], v[22:23], 0 cbsz:4 abid:13
    v_mfma_f32_4x4x4_16b_bf16 v[36:39], v[14:15], v[24:25], 0 cbsz:4 abid:14
    v_mfma_f32_4x4x4_16b_bf16 v[40:43], v[14:15], v[26:27], 0 cbsz:4 abid:15
    ds_read_u16 v4, v2 offset:688
    ds_read_u16 v6, v2 offset:696
    v_readlane_b32 s28, v19, 49
    v_readlane_b32 s29, v19, 57
    v_mov_b32 v85, s30
    ds_add_rtn_u32 v85, v0, v85 offset:288
    s_waitcnt vmcnt(5)
    ds_read_b64_tr_b16 v[20:21], v1 offset:4096
    ds_read_b64_tr_b16 v[22:23], v1 offset:4608
    s_waitcnt vmcnt(4)
    ds_read_b64_tr_b16 v[24:25], v1 offset:5120
    ds_read_b64_tr_b16 v[26:27], v1 offset:5632
    s_sub_u32 s34, s34, 1
    s_cmov_b32 s35, 0x30000
    s_mov_b32 m0, s28
    v_fmac_f32 v88, v28, v56
    v_fmac_f32 v89, v29, v56
    v_fmac_f32 v90, v30, v56
    v_fmac_f32 v91, v31, v56
    s_lshr_b32 m0, s28, 16
    v_fmac_f32 v88, v32, v57
    v_fmac_f32 v89, v33, v57
    v_fmac_f32 v90, v34, v57
    v_fmac_f32 v91, v35, v57
    s_mov_b32 m0, s29
    v_fmac_f32 v88, v36, v58
    v_fmac_f32 v89, v37, v58
    v_fmac_f32 v90, v38, v58
    v_fmac_f32 v91, v39, v58
    s_lshr_b32 m0, s29, 16
    v_fmac_f32 v88, v40, v59
    v_fmac_f32 v89, v41, v59
    v_fmac_f32 v90, v42, v59
    v_fmac_f32 v91, v43, v59
    s_or_b32 m0, s44, s35
    v_mfma_f32_32x32x16_bf16 v[44:59], v[60:63], v[68:71], 0
    v_mfma_f32_32x32x16_bf16 v[44:59], v[64:67], v[72:75], v[44:59]
    s_waitcnt lgkmcnt(2)
    buffer_load_dwordx4 v[4:5], s[4:7], 0 idxen offen lds
    s_or_b32 m0, s45, s35
    s_waitcnt lgkmcnt(0)
    buffer_load_dwordx4 v[6:7], s[4:7], 0 idxen offen lds
    v_readfirstlane_b32 s27, v85
    s_setprio 3
    s_xor_b32 s27, s27, s26
    s_cmp_ge_i32 s27, 0
    s_cbranch_scc1 mn_pr7
    s_setprio 2
mn_pr7:
    s_sub_u32 s19, s19, 1
    s_cbranch_scc1 mn_st7
mn_st7_back:
    v_mfma_f32_4x4x4_16b_bf16 v[28:31], v[16:17], v[20:21], 0 cbsz:4 abid:0
    v_mfma_f32_4x4x4_16b_bf16 v[32:35], v[16:17], v[22:23], 0 cbsz:4 abid:1
    v_mfma_f32_4x4x4_16b_bf16 v[36:39], v[16:17], v[24:25], 0 cbsz:4 abid:2
    v_mfma_f32_4x4x4_16b_bf16 v[40:43], v[16:17], v[26:27], 0 cbsz:4 abid:3
    ds_read_u16 v4, v2 offset:704
    ds_read_u16 v6, v2 offset:712
    v_readlane_b32 s28, v19, 2
    v_readlane_b32 s29, v19, 10
    ds_read_u16 v8, v18 offset:706
    s_waitcnt vmcnt(5)
    ds_read_b64_tr_b16 v[20:21], v1 offset:0
    ds_read_b64_tr_b16 v[22:23], v1 offset:512
    s_waitcnt vmcnt(4)
    ds_read_b64_tr_b16 v[24:25], v1 offset:1024
    ds_read_b64_tr_b16 v[26:27], v1 offset:1536
    s_sub_u32 s34, s34, 1
    s_cmov_b32 s35, 0x30000
    s_mov_b32 m0, s28
    v_fmac_f32 v88, v28, v44
    v_fmac_f32 v89, v29, v44
    v_fmac_f32 v90, v30, v44
    v_fmac_f32 v91, v31, v44
    s_lshr_b32 m0, s28, 16
    v_fmac_f32 v88, v32, v45
    v_fmac_f32 v89, v33, v45
    v_fmac_f32 v90, v34, v45
    v_fmac_f32 v91, v35, v45
    s_mov_b32 m0, s29
    v_fmac_f32 v88, v36, v46
    v_fmac_f32 v89, v37, v46
    v_fmac_f32 v90, v38, v46
    v_fmac_f32 v91, v39, v46
    s_lshr_b32 m0, s29, 16
    v_fmac_f32 v88, v40, v47
    v_fmac_f32 v89, v41, v47
    v_fmac_f32 v90, v42, v47
    v_fmac_f32 v91, v43, v47
    s_or_b32 m0, s40, s35
    s_waitcnt lgkmcnt(2)
    buffer_load_dwordx4 v[4:5], s[4:7], 0 idxen offen lds
    s_or_b32 m0, s41, s35
    s_waitcnt lgkmcnt(0)
    buffer_load_dwordx4 v[6:7], s[4:7], 0 idxen offen lds
    s_sub_u32 s19, s19, 1
    s_cbranch_scc1 mn_st8
mn_st8_back:
    v_mfma_f32_4x4x4_16b_bf16 v[28:31], v[16:17], v[20:21], 0 cbsz:4 abid:4
    v_mfma_f32_4x4x4_16b_bf16 v[32:35], v[16:17], v[22:23], 0 cbsz:4 abid:5
    v_mfma_f32_4x4x4_16b_bf16 v[36:39], v[16:17], v[24:25], 0 cbsz:4 abid:6
    v_mfma_f32_4x4x4_16b_bf16 v[40:43], v[16:17], v[26:27], 0 cbsz:4 abid:7
    ds_read_u16 v4, v2 offset:720
    ds_read_u16 v6, v2 offset:728
    v_readlane_b32 s28, v19, 18
    v_readlane_b32 s29, v19, 26
    ds_read_u16 v84, v3 offset:706
    v_lshlrev_b32 v8, 4, v8
    ds_read_b128 v[8:11], v8 offset:32
    s_waitcnt vmcnt(5)
    ds_read_b64_tr_b16 v[20:21], v1 offset:2048
    ds_read_b64_tr_b16 v[22:23], v1 offset:2560
    s_waitcnt vmcnt(4)
    ds_read_b64_tr_b16 v[24:25], v1 offset:3072
    ds_read_b64_tr_b16 v[26:27], v1 offset:3584
    s_sub_u32 s34, s34, 1
    s_cmov_b32 s35, 0x30000
    s_mov_b32 m0, s28
    v_fmac_f32 v88, v28, v48
    v_fmac_f32 v89, v29, v48
    v_fmac_f32 v90, v30, v48
    v_fmac_f32 v91, v31, v48
    s_lshr_b32 m0, s28, 16
    v_fmac_f32 v88, v32, v49
    v_fmac_f32 v89, v33, v49
    v_fmac_f32 v90, v34, v49
    v_fmac_f32 v91, v35, v49
    s_mov_b32 m0, s29
    v_fmac_f32 v88, v36, v50
    v_fmac_f32 v89, v37, v50
    v_fmac_f32 v90, v38, v50
    v_fmac_f32 v91, v39, v50
    s_lshr_b32 m0, s29, 16
    v_fmac_f32 v88, v40, v51
    v_fmac_f32 v89, v41, v51
    v_fmac_f32 v90, v42, v51
    v_fmac_f32 v91, v43, v51
    s_or_b32 m0, s42, s35
    s_waitcnt lgkmcnt(2)
    buffer_load_dwordx4 v[4:5], s[4:7], 0 idxen offen lds
    s_or_b32 m0, s43, s35
    s_waitcnt lgkmcnt(0)
    buffer_load_dwordx4 v[6:7], s[4:7], 0 idxen offen lds
    s_sub_u32 s19, s19, 1
    s_cbranch_scc1 mn_st9
mn_st9_back:
    v_mfma_f32_4x4x4_16b_bf16 v[28:31], v[16:17], v[20:21], 0 cbsz:4 abid:8
    v_mfma_f32_4x4x4_16b_bf16 v[32:35], v[16:17], v[22:23], 0 cbsz:4 abid:9
    v_mfma_f32_4x4x4_16b_bf16 v[36:39], v[16:17], v[24:25], 0 cbsz:4 abid:10
    v_mfma_f32_4x4x4_16b_bf16 v[40:43], v[16:17], v[26:27], 0 cbsz:4 abid:11
    ds_read_u16 v4, v2 offset:736
    ds_read_u16 v6, v2 offset:744
    v_readlane_b32 s28, v19, 34
    v_readlane_b32 s29, v19, 42
    v_lshl_add_u32 v84, v84, 4, v86
    v_xor_b32 v85, 0x40000, v84
    ds_read_b128 v[60:63], v84
    ds_read_b128 v[64:67], v85
    s_waitcnt vmcnt(5)
    ds_read_b64_tr_b16 v[20:21], v1 offset:4096
    ds_read_b64_tr_b16 v[22:23], v1 offset:4608
    s_waitcnt vmcnt(4)
    ds_read_b64_tr_b16 v[24:25], v1 offset:5120
    ds_read_b64_tr_b16 v[26:27], v1 offset:5632
    s_sub_u32 s34, s34, 1
    s_cmov_b32 s35, 0x30000
    s_mov_b32 m0, s28
    v_fmac_f32 v88, v28, v52
    v_fmac_f32 v89, v29, v52
    v_fmac_f32 v90, v30, v52
    v_fmac_f32 v91, v31, v52
    s_lshr_b32 m0, s28, 16
    v_fmac_f32 v88, v32, v53
    v_fmac_f32 v89, v33, v53
    v_fmac_f32 v90, v34, v53
    v_fmac_f32 v91, v35, v53
    s_mov_b32 m0, s29
    v_fmac_f32 v88, v36, v54
    v_fmac_f32 v89, v37, v54
    v_fmac_f32 v90, v38, v54
    v_fmac_f32 v91, v39, v54
    s_lshr_b32 m0, s29, 16
    v_fmac_f32 v88, v40, v55
    v_fmac_f32 v89, v41, v55
    v_fmac_f32 v90, v42, v55
    v_fmac_f32 v91, v43, v55
    s_or_b32 m0, s44, s35
    s_waitcnt lgkmcnt(2)
    buffer_load_dwordx4 v[4:5], s[4:7], 0 idxen offen lds
    s_or_b32 m0, s45, s35
    s_waitcnt lgkmcnt(0)
    buffer_load_dwordx4 v[6:7], s[4:7], 0 idxen offen lds
    v_and_b32 v11, 0xff, v11
    v_or_b32 v11, 0xc000, v11
    v_lshlrev_b32 v10, 16, v11
    s_sub_u32 s19, s19, 1
    s_cbranch_scc1 mn_st10
mn_st10_back:
    v_mfma_f32_4x4x4_16b_bf16 v[28:31], v[16:17], v[20:21], 0 cbsz:4 abid:12
    v_mfma_f32_4x4x4_16b_bf16 v[32:35], v[16:17], v[22:23], 0 cbsz:4 abid:13
    v_mfma_f32_4x4x4_16b_bf16 v[36:39], v[16:17], v[24:25], 0 cbsz:4 abid:14
    v_mfma_f32_4x4x4_16b_bf16 v[40:43], v[16:17], v[26:27], 0 cbsz:4 abid:15
    ds_read_u16 v4, v2 offset:752
    ds_read_u16 v6, v2 offset:760
    v_readlane_b32 s28, v19, 50
    v_readlane_b32 s29, v19, 58
    v_mov_b32 v85, s30
    ds_add_rtn_u32 v85, v0, v85 offset:288
    s_waitcnt vmcnt(5)
    ds_read_b64_tr_b16 v[20:21], v1 offset:0
    ds_read_b64_tr_b16 v[22:23], v1 offset:512
    s_waitcnt vmcnt(4)
    ds_read_b64_tr_b16 v[24:25], v1 offset:1024
    ds_read_b64_tr_b16 v[26:27], v1 offset:1536
    s_sub_u32 s34, s34, 1
    s_cmov_b32 s35, 0x30000
    s_mov_b32 m0, s28
    v_fmac_f32 v88, v28, v56
    v_fmac_f32 v89, v29, v56
    v_fmac_f32 v90, v30, v56
    v_fmac_f32 v91, v31, v56
    s_lshr_b32 m0, s28, 16
    v_fmac_f32 v88, v32, v57
    v_fmac_f32 v89, v33, v57
    v_fmac_f32 v90, v34, v57
    v_fmac_f32 v91, v35, v57
    s_mov_b32 m0, s29
    v_fmac_f32 v88, v36, v58
    v_fmac_f32 v89, v37, v58
    v_fmac_f32 v90, v38, v58
    v_fmac_f32 v91, v39, v58
    s_lshr_b32 m0, s29, 16
    v_fmac_f32 v88, v40, v59
    v_fmac_f32 v89, v41, v59
    v_fmac_f32 v90, v42, v59
    v_fmac_f32 v91, v43, v59
    s_or_b32 m0, s40, s35
    v_mfma_f32_4x4x4_16b_bf16 v[28:31], v[8:9], v[76:77], 0
    v_mfma_f32_4x4x4_16b_bf16 v[32:35], v[8:9], v[78:79], 0
    v_mfma_f32_4x4x4_16b_bf16 v[36:39], v[8:9], v[80:81], 0
    v_mfma_f32_4x4x4_16b_bf16 v[40:43], v[8:9], v[82:83], 0
    v_mfma_f32_32x32x16_bf16 v[44:59], v[60:63], v[68:71], 0
    v_mfma_f32_32x32x16_bf16 v[44:59], v[64:67], v[72:75], v[44:59]
    s_waitcnt lgkmcnt(2)
    buffer_load_dwordx4 v[4:5], s[4:7], 0 idxen offen lds
    s_or_b32 m0, s41, s35
    s_waitcnt lgkmcnt(0)
    buffer_load_dwordx4 v[6:7], s[4:7], 0 idxen offen lds
    v_cvt_pk_bf16_f32 v12, v28, v32
    v_cvt_pk_bf16_f32 v14, v29, v33
    v_cvt_pk_bf16_f32 v16, v30, v34
    v_cvt_pk_bf16_f32 v13, v36, v40
    v_cvt_pk_bf16_f32 v15, v37, v41
    v_cvt_pk_bf16_f32 v17, v38, v42
    v_or_b32_dpp v19, v10, v11 row_shl:4 row_mask:0xf bank_mask:0xf bound_ctrl:0
    v_add_u32 v2, 192, v2
    v_add_u32 v3, 192, v3
    v_add_u32 v18, 192, v18
    v_readfirstlane_b32 s27, v85
    s_setprio 3
    s_xor_b32 s27, s27, s26
    s_cmp_ge_i32 s27, 0
    s_cbranch_scc1 mn_pr11
    s_setprio 2
mn_pr11:
    s_sub_u32 s19, s19, 1
    s_cbranch_scc1 mn_st11
mn_st11_back:
    s_branch mn_loop
mn_st0:
    s_cmp_lg_u32 s21, 0
    s_cbranch_scc1 mn_next
    s_call_b64 s[48:49], mn_flush
    s_branch mn_st0_back
mn_st1:
    s_cmp_lg_u32 s21, 0
    s_cbranch_scc1 mn_next
    s_call_b64 s[48:49], mn_flush
    s_branch mn_st1_back
mn_st2:
    s_cmp_lg_u32 s21, 0
    s_cbranch_scc1 mn_next
    s_call_b64 s[48:49], mn_flush
    s_branch mn_st2_back
mn_st3:
    s_cmp_lg_u32 s21, 0
    s_cbranch_scc1 mn_next
    s_call_b64 s[48:49], mn_flush
    s_branch mn_st3_back
mn_st4:
    s_cmp_lg_u32 s21, 0
    s_cbranch_scc1 mn_next
    s_call_b64 s[48:49], mn_flush
    s_branch mn_st4_back
mn_st5:
    s_cmp_lg_u32 s21, 0
    s_cbranch_scc1 mn_next
    s_call_b64 s[48:49], mn_flush
    s_branch mn_st5_back
mn_st6:
    s_cmp_lg_u32 s21, 0
    s_cbranch_scc1 mn_next
    s_call_b64 s[48:49], mn_flush
    s_branch mn_st6_back
mn_st7:
    s_cmp_lg_u32 s21, 0
    s_cbranch_scc1 mn_next
    s_call_b64 s[48:49], mn_flush
    s_branch mn_st7_back
mn_st8:
    s_cmp_lg_u32 s21, 0
    s_cbranch_scc1 mn_next
    s_call_b64 s[48:49], mn_flush
    s_branch mn_st8_back
mn_st9:
    s_cmp_lg_u32 s21, 0
    s_cbranch_scc1 mn_next
    s_call_b64 s[48:49], mn_flush
    s_branch mn_st9_back
mn_st10:
    s_cmp_lg_u32 s21, 0
    s_cbranch_scc1 mn_next
    s_call_b64 s[48:49], mn_flush
    s_branch mn_st10_back
mn_st11:
    s_cmp_lg_u32 s21, 0
    s_cbranch_scc1 mn_next
    s_call_b64 s[48:49], mn_flush
    s_branch mn_st11_back
mn_st12:
    s_cmp_lg_u32 s21, 0
    s_cbranch_scc1 mn_next
    s_call_b64 s[48:49], mn_flush
    s_branch mn_st12_back
mn_flush:
    s_cmp_eq_u32 s58, 4
    s_cbranch_scc1 mn_fl4
    s_cmp_eq_u32 s58, 3
    s_cbranch_scc1 mn_fl3
    s_cmp_eq_u32 s58, 2
    s_cbranch_scc1 mn_fl2
    s_cmp_eq_u32 s58, 1
    s_cbranch_scc1 mn_fl1
mn_fl0:
    v_cvt_pk_bf16_f32 v88, v88, v89
    v_cvt_pk_bf16_f32 v89, v90, v91
    ds_write_b64 v87, v[88:89] offset:0
    v_cvt_pk_bf16_f32 v92, v92, v93
    v_cvt_pk_bf16_f32 v93, v94, v95
    ds_write_b64 v87, v[92:93] offset:576
    v_cvt_pk_bf16_f32 v96, v96, v97
    v_cvt_pk_bf16_f32 v97, v98, v99
    ds_write_b64 v87, v[96:97] offset:1152
    v_cvt_pk_bf16_f32 v100, v100, v101
    v_cvt_pk_bf16_f32 v101, v102, v103
    ds_write_b64 v87, v[100:101] offset:1728
    s_mul_i32 s52, s18, 3
    s_lshl_b32 s52, 1, s52
    v_mov_b32 v90, s52
    v_mov_b32 v91, 0
    s_mov_b64 exec, 1
    ds_add_u32 v91, v90 offset:276
    s_mov_b64 exec, -1
    s_add_u32 s58, s58, 1
    s_sub_u32 s19, s85, 1
    s_cbranch_scc1 mn_fl1
    s_setpc_b64 s[48:49]
mn_fl1:
    v_cvt_pk_bf16_f32 v104, v104, v105
    v_cvt_pk_bf16_f32 v105, v106, v107
    ds_write_b64 v87, v[104:105] offset:2304
    v_cvt_pk_bf16_f32 v108, v108, v109
    v_cvt_pk_bf16_f32 v109, v110, v111
    ds_write_b64 v87, v[108:109] offset:2880
    v_cvt_pk_bf16_f32 v112, v112, v113
    v_cvt_pk_bf16_f32 v113, v114, v115
    ds_write_b64 v87, v[112:113] offset:3456
    v_cvt_pk_bf16_f32 v116, v116, v117
    v_cvt_pk_bf16_f32 v117, v118, v119
    ds_write_b64 v87, v[116:117] offset:4032
    s_mul_i32 s52, s18, 3
    s_lshl_b32 s52, 64, s52
    v_mov_b32 v106, s52
    v_mov_b32 v107, 0
    s_mov_b64 exec, 1
    ds_add_u32 v107, v106 offset:276
    s_mov_b64 exec, -1
    s_add_u32 s58, s58, 1
    s_sub_u32 s19, s86, 1
    s_cbranch_scc1 mn_fl2
    s_setpc_b64 s[48:49]
mn_fl2:
    v_cvt_pk_bf16_f32 v120, v120, v121
    v_cvt_pk_bf16_f32 v121, v122, v123
    ds_write_b64 v87, v[120:121] offset:4608
    v_cvt_pk_bf16_f32 v124, v124, v125
    v_cvt_pk_bf16_f32 v125, v126, v127
    ds_write_b64 v87, v[124:125] offset:5184
    v_cvt_pk_bf16_f32 v128, v128, v129
    v_cvt_pk_bf16_f32 v129, v130, v131
    ds_write_b64 v87, v[128:129] offset:5760
    v_cvt_pk_bf16_f32 v132, v132, v133
    v_cvt_pk_bf16_f32 v133, v134, v135
    ds_write_b64 v87, v[132:133] offset:6336
    s_mul_i32 s52, s18, 3
    s_lshl_b32 s52, 4096, s52
    v_mov_b32 v122, s52
    v_mov_b32 v123, 0
    s_mov_b64 exec, 1
    ds_add_u32 v123, v122 offset:276
    s_mov_b64 exec, -1
    s_add_u32 s58, s58, 1
    s_sub_u32 s19, s87, 1
    s_cbranch_scc1 mn_fl3
    s_setpc_b64 s[48:49]
mn_fl3:
    v_cvt_pk_bf16_f32 v136, v136, v137
    v_cvt_pk_bf16_f32 v137, v138, v139
    ds_write_b64 v87, v[136:137] offset:6912
    v_cvt_pk_bf16_f32 v140, v140, v141
    v_cvt_pk_bf16_f32 v141, v142, v143
    ds_write_b64 v87, v[140:141] offset:7488
    v_cvt_pk_bf16_f32 v144, v144, v145
    v_cvt_pk_bf16_f32 v145, v146, v147
    ds_write_b64 v87, v[144:145] offset:8064
    v_cvt_pk_bf16_f32 v148, v148, v149
    v_cvt_pk_bf16_f32 v149, v150, v151
    ds_write_b64 v87, v[148:149] offset:8640
    s_mul_i32 s52, s18, 3
    s_lshl_b32 s52, 262144, s52
    v_mov_b32 v138, s52
    v_mov_b32 v139, 0
    s_mov_b64 exec, 1
    ds_add_u32 v139, v138 offset:276
    s_mov_b64 exec, -1
    s_add_u32 s58, s58, 1
    s_sub_u32 s19, s88, 1
    s_cbranch_scc1 mn_fl4
    s_setpc_b64 s[48:49]
mn_fl4:
    s_cmp_ge_u32 s59, 4
    s_cbranch_scc1 mn_fl4b
    s_waitcnt vmcnt(0)
mn_fl4b:
    v_cvt_pk_bf16_f32 v152, v152, v153
    v_cvt_pk_bf16_f32 v153, v154, v155
    ds_write_b64 v87, v[152:153] offset:9216
    v_cvt_pk_bf16_f32 v156, v156, v157
    v_cvt_pk_bf16_f32 v157, v158, v159
    ds_write_b64 v87, v[156:157] offset:9792
    v_cvt_pk_bf16_f32 v160, v160, v161
    v_cvt_pk_bf16_f32 v161, v162, v163
    ds_write_b64 v87, v[160:161] offset:10368
    v_cvt_pk_bf16_f32 v164, v164, v165
    v_cvt_pk_bf16_f32 v165, v166, v167
    ds_write_b64 v87, v[164:165] offset:10944
    s_mul_i32 s52, s18, 3
    s_lshl_b32 s52, 16777216, s52
    v_mov_b32 v154, s52
    v_mov_b32 v155, 0
    s_mov_b64 exec, 1
    ds_add_u32 v155, v154 offset:276
    s_mov_b64 exec, -1
    s_waitcnt vmcnt(0) lgkmcnt(0)
mn_end:
    s_endpgm
gm_main:
    s_load_dwordx2 s[56:57], s[0:1], 64
    v_and_b32 v3, 63, v0
    v_and_b32 v11, 0x7f, v0
    v_lshlrev_b32 v11, 2, v11
    v_mov_b32 v10, 0
    ds_write_b32 v11, v10
    v_bfe_u32 v12, v0, 1, 7
    v_and_b32 v11, 15, v12
    v_lshrrev_b32 v10, 4, v12
    v_lshl_or_b32 v11, v11, 3, v10
    v_cmp_gt_u32 vcc, 125, v11
    v_mul_u32_u24 v13, 61440, v11
    v_bfrev_b32 v10, 2
    v_lshlrev_b32 v12, 2, v12
    v_cndmask_b32 v12, v10, v12, vcc
    v_lshlrev_b32 v11, 3, v3
    v_lshlrev_b32 v2, 4, v3
    s_lshl_b32 s40, s17, 15
    s_add_u32 s40, s40, 11534336
    s_waitcnt lgkmcnt(0)
    s_mov_b32 s8, s54
    s_and_b32 s9, s55, 0xffff
    buffer_load_dword v4, v12, s[8:11], s25 offen
    buffer_load_dwordx2 v[6:7], v11, s[8:11], s25 offen
    s_barrier
    s_lshl2_add_u32 s47, s47, s17
    s_mul_i32 s47, s47, 61440
    s_mul_i32 s48, s48, 7680
    s_add_u32 s47, s47, s48
    s_sub_i32 s47, s47, 256
    s_max_i32 s47, s47, 0
    v_lshlrev_b32 v11, 7, v3
    buffer_load_dword v39, v11, s[8:11], s47 offen
    s_mul_i32 s41, s2, 625
    s_add_u32 s52, s41, 640
    s_add_u32 s41, s41, 15
    s_lshr_b32 s41, s41, 4
    s_lshr_b32 s52, s52, 4
    s_mov_b32 s12, s56
    s_and_b32 s13, s57, 0xffff
    s_lshl_b32 s14, s52, 11
    s_mov_b32 s15, 0x20000
    s_mul_i32 s42, s17, 15360
    s_add_u32 s42, s42, 40960
    s_lshl_b32 s43, s17, 4
    s_sub_u32 s43, s43, 1
    s_mov_b32 s44, -1
    s_mov_b32 s45, 2139062271
    v_add_u32 v11, 0, v3
    v_mul_u32_u24 v10, 21846, v11
    v_lshrrev_b32 v10, 16, v10
    v_lshl_add_u32 v34, v10, 2, s42
    v_mad_i32_i24 v10, v10, -3, v11
    v_lshlrev_b32 v30, 4, v10
    v_add_u32 v11, 64, v3
    v_mul_u32_u24 v10, 21846, v11
    v_lshrrev_b32 v10, 16, v10
    v_lshl_add_u32 v35, v10, 2, s42
    v_mad_i32_i24 v10, v10, -3, v11
    v_lshlrev_b32 v31, 4, v10
    v_add_u32 v11, 128, v3
    v_mul_u32_u24 v10, 21846, v11
    v_lshrrev_b32 v10, 16, v10
    v_lshl_add_u32 v36, v10, 2, s42
    v_mad_i32_i24 v10, v10, -3, v11
    v_lshlrev_b32 v32, 4, v10
    s_waitcnt vmcnt(1)
gm_pass:
    v_lshrrev_b32 v8, 16, v4
    v_subrev_u32 v8, s24, v8
    v_med3_i32 v8, v8, 0, s20
    v_lshrrev_b32 v11, 16, v6
    v_subrev_u32 v11, s24, v11
    v_med3_i32 v11, v11, 0, s20
    v_lshrrev_b32 v10, 16, v7
    v_subrev_u32 v10, s24, v10
    v_med3_i32 v10, v10, 0, s20
    v_mov_b32 v9, v8
    v_cndmask_b32 v10, 0, v10, s[44:45]
    v_add_u32 v10, v11, v10
    v_and_b32 v12, 1, v0
    v_and_b32 v14, 0xffff, v4
    v_add_u32_dpp v10, v10, v10 row_shr:1 row_mask:0xf bank_mask:0xf
    s_nop 0
    v_add3_u32 v14, v14, v12, s24
    v_add_u32_dpp v10, v10, v10 row_shr:2 row_mask:0xf bank_mask:0xf
    v_add_u32_dpp v9, v9, v9 row_shr:2 row_mask:0xf bank_mask:0xf
    v_mad_u32_u24 v14, v14, 48, v13
    v_add_u32_dpp v10, v10, v10 row_shr:4 row_mask:0xf bank_mask:0xf
    v_add_u32_dpp v9, v9, v9 row_shr:4 row_mask:0xf bank_mask:0xf
    v_sub_u32 v15, v8, v12
    v_add_u32_dpp v10, v10, v10 row_shr:8 row_mask:0xf bank_mask:0xf
    v_add_u32_dpp v9, v9, v9 row_shr:8 row_mask:0xf bank_mask:0xf
    s_nop 0
    v_add_u32_dpp v10, v10, v10 row_bcast:15 row_mask:0xa bank_mask:0xf
    v_add_u32_dpp v9, v9, v9 row_bcast:15 row_mask:0xa bank_mask:0xf
    s_nop 0
    v_add_u32_dpp v10, v10, v10 row_bcast:31 row_mask:0xc bank_mask:0xf
    v_add_u32_dpp v9, v9, v9 row_bcast:31 row_mask:0xc bank_mask:0xf
    s_nop 0
    v_readlane_b32 s23, v10, 63
    v_readlane_b32 s46, v10, s43
    v_readlane_b32 s47, v9, 63
    v_sub_u32 v16, v9, v15
    v_lshl_add_u32 v16, v16, 2, s42
    s_cmp_gt_u32 s23, 774
    s_cbranch_scc1 gm_ovf
    s_cmp_eq_u32 s17, 0
    s_cmov_b32 s46, 0
    v_cmpx_lt_i32 vcc, 0, v15
    s_cbranch_execz gm_tb_done
    ds_write_b32 v16, v14 offset:0
    v_add_u32 v14, 96, v14
    v_cmpx_lt_i32 vcc, 2, v15
    s_cbranch_execz gm_tb_done
    ds_write_b32 v16, v14 offset:8
    v_add_u32 v14, 96, v14
    v_cmpx_lt_i32 vcc, 4, v15
    s_cbranch_execz gm_tb_done
    ds_write_b32 v16, v14 offset:16
    v_add_u32 v14, 96, v14
    v_cmpx_lt_i32 vcc, 6, v15
    s_cbranch_execz gm_tb_done
    ds_write_b32 v16, v14 offset:24
    v_add_u32 v14, 96, v14
    v_cmpx_lt_i32 vcc, 8, v15
    s_cbranch_execz gm_tb_done
    ds_write_b32 v16, v14 offset:32
    v_add_u32 v14, 96, v14
    v_cmpx_lt_i32 vcc, 10, v15
    s_cbranch_execz gm_tb_done
    ds_write_b32 v16, v14 offset:40
    v_add_u32 v14, 96, v14
    v_cmpx_lt_i32 vcc, 12, v15
    s_cbranch_execz gm_tb_done
    ds_write_b32 v16, v14 offset:48
    v_add_u32 v14, 96, v14
    v_cmpx_lt_i32 vcc, 14, v15
    s_cbranch_execz gm_tb_done
    ds_write_b32 v16, v14 offset:56
    v_add_u32 v14, 96, v14
    v_cmpx_lt_i32 vcc, 16, v15
    s_cbranch_execz gm_tb_done
    ds_write_b32 v16, v14 offset:64
    v_add_u32 v14, 96, v14
    v_cmpx_lt_i32 vcc, 18, v15
    s_cbranch_execz gm_tb_done
    ds_write_b32 v16, v14 offset:72
gm_tb_done:
    s_mov_b64 exec, -1
    s_mul_i32 s46, s46, 48
    s_add_u32 m0, s46, 3776
    s_mul_i32 s47, s47, 3
    v_mov_b32 v11, v34
    v_mov_b32 v10, v35
    v_mov_b32 v14, v36
    s_barrier
gm_raw:
    ds_read_b32 v18, v11 offset:0
    ds_read_b32 v19, v10 offset:0
    ds_read_b32 v20, v14 offset:0
    ds_read_b32 v21, v11 offset:256
    ds_read_b32 v22, v10 offset:256
    ds_read_b32 v23, v14 offset:256
    ds_read_b32 v24, v11 offset:512
    ds_read_b32 v25, v10 offset:512
    ds_read_b32 v26, v14 offset:512
    v_cmpx_gt_i32 vcc, s47, v3
    s_cbranch_execz gm_raw_done
    s_waitcnt lgkmcnt(8)
    v_add_u32 v18, v18, v30
    buffer_load_dwordx4 v18, s[8:11], 0 offen lds
    s_add_u32 m0, m0, 1024
    s_sub_i32 s47, s47, 64
    v_cmpx_gt_i32 vcc, s47, v3
    s_cbranch_execz gm_raw_done
    s_waitcnt lgkmcnt(7)
    v_add_u32 v19, v19, v31
    buffer_load_dwordx4 v19, s[8:11], 0 offen lds
    s_add_u32 m0, m0, 1024
    s_sub_i32 s47, s47, 64
    v_cmpx_gt_i32 vcc, s47, v3
    s_cbranch_execz gm_raw_done
    s_waitcnt lgkmcnt(6)
    v_add_u32 v20, v20, v32
    buffer_load_dwordx4 v20, s[8:11], 0 offen lds
    s_add_u32 m0, m0, 1024
    s_sub_i32 s47, s47, 64
    v_cmpx_gt_i32 vcc, s47, v3
    s_cbranch_execz gm_raw_done
    s_waitcnt lgkmcnt(5)
    v_add_u32 v21, v21, v30
    buffer_load_dwordx4 v21, s[8:11], 0 offen lds
    s_add_u32 m0, m0, 1024
    s_sub_i32 s47, s47, 64
    v_cmpx_gt_i32 vcc, s47, v3
    s_cbranch_execz gm_raw_done
    s_waitcnt lgkmcnt(4)
    v_add_u32 v22, v22, v31
    buffer_load_dwordx4 v22, s[8:11], 0 offen lds
    s_add_u32 m0, m0, 1024
    s_sub_i32 s47, s47, 64
    v_cmpx_gt_i32 vcc, s47, v3
    s_cbranch_execz gm_raw_done
    s_waitcnt lgkmcnt(3)
    v_add_u32 v23, v23, v32
    buffer_load_dwordx4 v23, s[8:11], 0 offen lds
    s_add_u32 m0, m0, 1024
    s_sub_i32 s47, s47, 64
    v_cmpx_gt_i32 vcc, s47, v3
    s_cbranch_execz gm_raw_done
    s_waitcnt lgkmcnt(2)
    v_add_u32 v24, v24, v30
    buffer_load_dwordx4 v24, s[8:11], 0 offen lds
    s_add_u32 m0, m0, 1024
    s_sub_i32 s47, s47, 64
    v_cmpx_gt_i32 vcc, s47, v3
    s_cbranch_execz gm_raw_done
    s_waitcnt lgkmcnt(1)
    v_add_u32 v25, v25, v31
    buffer_load_dwordx4 v25, s[8:11], 0 offen lds
    s_add_u32 m0, m0, 1024
    s_sub_i32 s47, s47, 64
    v_cmpx_gt_i32 vcc, s47, v3
    s_cbranch_execz gm_raw_done
    s_waitcnt lgkmcnt(0)
    v_add_u32 v26, v26, v32
    buffer_load_dwordx4 v26, s[8:11], 0 offen lds
    s_add_u32 m0, m0, 1024
    s_sub_i32 s47, s47, 64
    v_add_u32 v11, 768, v11
    v_add_u32 v10, 768, v10
    v_add_u32 v14, 768, v14
    s_branch gm_raw
gm_raw_done:
    s_mov_b64 exec, -1
    v_mov_b32 v11, 0
    ds_read_b32 v11, v11 offset:272
    s_barrier
    s_waitcnt vmcnt(0) lgkmcnt(0)
    v_readfirstlane_b32 s21, v11
    s_barrier
    s_cmp_lg_u32 s21, 0
    s_cbranch_scc1 gm_next
    s_add_u32 s52, s40, 0
    buffer_load_dwordx4 v[40:43], v2, s[8:11], s52 offen offset:0
    buffer_load_dwordx4 v[44:47], v2, s[8:11], s52 offen offset:1024
    s_waitcnt vmcnt(1)
    buffer_load_dwordx4 v[48:51], v2, s[8:11], s52 offen offset:2048
    s_waitcnt vmcnt(1)
    buffer_load_dwordx4 v[52:55], v2, s[8:11], s52 offen offset:3072
    s_waitcnt vmcnt(1)
    s_add_u32 s52, s40, 4096
    buffer_load_dwordx4 v[56:59], v2, s[8:11], s52 offen offset:0
    s_waitcnt vmcnt(1)
    buffer_load_dwordx4 v[60:63], v2, s[8:11], s52 offen offset:1024
    s_waitcnt vmcnt(1)
    buffer_load_dwordx4 v[64:67], v2, s[8:11], s52 offen offset:2048
    s_waitcnt vmcnt(1)
    buffer_load_dwordx4 v[68:71], v2, s[8:11], s52 offen offset:3072
    s_waitcnt vmcnt(1)
    s_add_u32 s52, s40, 8192
    buffer_load_dwordx4 v[72:75], v2, s[8:11], s52 offen offset:0
    s_waitcnt vmcnt(1)
    buffer_load_dwordx4 v[76:79], v2, s[8:11], s52 offen offset:1024
    s_waitcnt vmcnt(1)
    buffer_load_dwordx4 v[80:83], v2, s[8:11], s52 offen offset:2048
    s_waitcnt vmcnt(1)
    buffer_load_dwordx4 v[84:87], v2, s[8:11], s52 offen offset:3072
    s_waitcnt vmcnt(1)
    s_add_u32 s52, s40, 12288
    buffer_load_dwordx4 v[88:91], v2, s[8:11], s52 offen offset:0
    s_waitcnt vmcnt(1)
    buffer_load_dwordx4 v[92:95], v2, s[8:11], s52 offen offset:1024
    s_waitcnt vmcnt(1)
    buffer_load_dwordx4 v[96:99], v2, s[8:11], s52 offen offset:2048
    s_waitcnt vmcnt(1)
    buffer_load_dwordx4 v[100:103], v2, s[8:11], s52 offen offset:3072
    s_waitcnt vmcnt(1)
    s_add_u32 s52, s40, 16384
    buffer_load_dwordx4 v[104:107], v2, s[8:11], s52 offen offset:0
    s_waitcnt vmcnt(1)
    buffer_load_dwordx4 v[108:111], v2, s[8:11], s52 offen offset:1024
    s_waitcnt vmcnt(1)
    buffer_load_dwordx4 v[112:115], v2, s[8:11], s52 offen offset:2048
    s_waitcnt vmcnt(1)
    buffer_load_dwordx4 v[116:119], v2, s[8:11], s52 offen offset:3072
    s_waitcnt vmcnt(1)
    s_add_u32 s52, s40, 20480
    buffer_load_dwordx4 v[120:123], v2, s[8:11], s52 offen offset:0
    s_waitcnt vmcnt(1)
    buffer_load_dwordx4 v[124:127], v2, s[8:11], s52 offen offset:1024
    s_waitcnt vmcnt(1)
    buffer_load_dwordx4 v[128:131], v2, s[8:11], s52 offen offset:2048
    s_waitcnt vmcnt(1)
    buffer_load_dwordx4 v[132:135], v2, s[8:11], s52 offen offset:3072
    s_waitcnt vmcnt(1)
    s_add_u32 s52, s40, 24576
    buffer_load_dwordx4 v[136:139], v2, s[8:11], s52 offen offset:0
    s_waitcnt vmcnt(1)
    buffer_load_dwordx4 v[140:143], v2, s[8:11], s52 offen offset:1024
    s_waitcnt vmcnt(1)
    buffer_load_dwordx4 v[144:147], v2, s[8:11], s52 offen offset:2048
    s_waitcnt vmcnt(1)
    buffer_load_dwordx4 v[148:151], v2, s[8:11], s52 offen offset:3072
    s_waitcnt vmcnt(1)
    s_add_u32 s52, s40, 28672
    buffer_load_dwordx4 v[152:155], v2, s[8:11], s52 offen offset:0
    s_waitcnt vmcnt(1)
    buffer_load_dwordx4 v[156:159], v2, s[8:11], s52 offen offset:1024
    s_waitcnt vmcnt(1)
    buffer_load_dwordx4 v[160:163], v2, s[8:11], s52 offen offset:2048
    s_waitcnt vmcnt(1)
    buffer_load_dwordx4 v[164:167], v2, s[8:11], s52 offen offset:3072
    s_waitcnt vmcnt(1)
    v_lshrrev_b32 v1, 4, v3
    v_lshlrev_b32 v1, 11, v1
    v_and_b32 v4, 7, v3
    v_lshl_add_u32 v1, v4, 4, v1
    v_bfe_u32 v4, v3, 3, 1
    v_lshl_add_u32 v1, v4, 9, v1
    v_and_b32 v4, 3, v3
    v_lshrrev_b32 v5, 2, v3
    v_mul_u32_u24 v0, 576, v4
    v_lshl_add_u32 v0, v5, 3, v0
    v_add_u32 v0, 40960, v0
    s_lshl_b32 s38, s41, 11
    s_lshl_b32 s53, s17, 7
    s_add_u32 s38, s38, s53
    s_mov_b32 s36, 0x24924924
    s_mov_b32 s39, 0
    s_waitcnt vmcnt(0)
gm_poll:
    v_mov_b32 v2, 0
    ds_read_b32 v2, v2 offset:276
    s_waitcnt lgkmcnt(0)
    v_readfirstlane_b32 s52, v2
    s_and_b32 s52, s52, s36
    s_cbranch_scc1 gm_go
    s_sleep 2
    s_branch gm_poll
gm_go:
    s_ff1_i32_b32 s52, s52
    s_bitset0_b32 s36, s52
    s_mul_i32 s52, s52, 11
    s_bfe_u32 s53, s52, 0x10005
    s_bfe_u32 s52, s52, 0x30006
    s_mul_i32 s35, s53, 61440
    s_mul_i32 s31, s52, 2304
    s_add_u32 s31, s31, s35
    s_sub_u32 s35, s31, s39
    v_add_u32 v0, s35, v0
    ds_read_b64_tr_b16 v[12:13], v0 offset:0
    ds_read_b64_tr_b16 v[14:15], v0 offset:128
    ds_read_b64_tr_b16 v[16:17], v0 offset:256
    ds_read_b64_tr_b16 v[18:19], v0 offset:384
    s_mov_b32 s39, s31
    s_mul_i32 s33, s53, 5
    s_add_u32 s33, s33, s52
    s_lshl_b32 s33, s33, 13
    s_add_u32 s33, s33, s38
    s_mov_b32 s37, s33
    s_mov_b32 s32, 0x7ffffff0
gm_loop:
    s_waitcnt lgkmcnt(2)
    v_mfma_f32_16x16x32_bf16 v[24:27], v[12:15], v[40:43], 0
    v_cvt_pk_bf16_f32 v7, v33, v37
    v_cvt_pk_bf16_f32 v5, v32, v36
    ds_read_b64_tr_b16 v[20:21], v0 offset:15360
    v_mfma_f32_16x16x32_bf16 v[28:31], v[12:15], v[44:47], 0
    v_cvt_pk_bf16_f32 v11, v35, v39
    v_cvt_pk_bf16_f32 v9, v34, v38
    ds_read_b64_tr_b16 v[22:23], v0 offset:15488
    v_mfma_f32_16x16x32_bf16 v[32:35], v[12:15], v[48:51], 0
    v_mov_b32_dpp v2, v6 row_ror:8 row_mask:0xf bank_mask:0xf
    v_mov_b32_dpp v3, v7 row_ror:8 row_mask:0xf bank_mask:0xf
    v_mfma_f32_16x16x32_bf16 v[36:39], v[12:15], v[52:55], 0
    v_mov_b32_dpp v6, v4 row_ror:8 row_mask:0xf bank_mask:0x3
    v_mov_b32_dpp v7, v5 row_ror:8 row_mask:0xf bank_mask:0x3
    s_waitcnt lgkmcnt(2)
    v_mfma_f32_16x16x32_bf16 v[24:27], v[16:19], v[56:59], v[24:27]
    ds_read_b64_tr_b16 v[12:13], v0 offset:15616
    v_mov_b32_dpp v4, v2 quad_perm:[0,1,2,3] row_mask:0xf bank_mask:0xc
    v_mfma_f32_16x16x32_bf16 v[28:31], v[16:19], v[60:63], v[28:31]
    ds_read_b64_tr_b16 v[14:15], v0 offset:15744
    v_mov_b32_dpp v5, v3 quad_perm:[0,1,2,3] row_mask:0xf bank_mask:0xc
    v_mfma_f32_16x16x32_bf16 v[32:35], v[16:19], v[64:67], v[32:35]
    buffer_store_dwordx4 v[4:7], v1, s[12:15], s32 offen offset:0 sc0 sc1
    v_mov_b32_dpp v2, v10 row_ror:8 row_mask:0xf bank_mask:0xf
    v_mfma_f32_16x16x32_bf16 v[36:39], v[16:19], v[68:71], v[36:39]
    v_mov_b32_dpp v3, v11 row_ror:8 row_mask:0xf bank_mask:0xf
    v_mov_b32_dpp v10, v8 row_ror:8 row_mask:0xf bank_mask:0x3
    s_waitcnt lgkmcnt(2)
    v_mfma_f32_16x16x32_bf16 v[24:27], v[20:23], v[72:75], v[24:27]
    ds_read_b64_tr_b16 v[16:17], v0 offset:30720
    v_mov_b32_dpp v11, v9 row_ror:8 row_mask:0xf bank_mask:0x3
    v_mfma_f32_16x16x32_bf16 v[28:31], v[20:23], v[76:79], v[28:31]
    ds_read_b64_tr_b16 v[18:19], v0 offset:30848
    v_mov_b32_dpp v8, v2 quad_perm:[0,1,2,3] row_mask:0xf bank_mask:0xc
    v_mfma_f32_16x16x32_bf16 v[32:35], v[20:23], v[80:83], v[32:35]
    v_mov_b32_dpp v9, v3 quad_perm:[0,1,2,3] row_mask:0xf bank_mask:0xc
    buffer_store_dwordx4 v[8:11], v1, s[12:15], s32 offen offset:1024 sc0 sc1
    v_mfma_f32_16x16x32_bf16 v[36:39], v[20:23], v[84:87], v[36:39]
    s_waitcnt lgkmcnt(2)
    v_mfma_f32_16x16x32_bf16 v[24:27], v[12:15], v[88:91], v[24:27]
    ds_read_b64_tr_b16 v[20:21], v0 offset:30976
    v_mfma_f32_16x16x32_bf16 v[28:31], v[12:15], v[92:95], v[28:31]
    ds_read_b64_tr_b16 v[22:23], v0 offset:31104
    v_mfma_f32_16x16x32_bf16 v[32:35], v[12:15], v[96:99], v[32:35]
    v_mov_b32 v2, 0
    v_mfma_f32_16x16x32_bf16 v[36:39], v[12:15], v[100:103], v[36:39]
    ds_read_b32 v2, v2 offset:276
    s_waitcnt lgkmcnt(3)
    v_mfma_f32_16x16x32_bf16 v[24:27], v[16:19], v[104:107], v[24:27]
    ds_read_b64_tr_b16 v[12:13], v0 offset:46080
    v_mfma_f32_16x16x32_bf16 v[28:31], v[16:19], v[108:111], v[28:31]
    ds_read_b64_tr_b16 v[14:15], v0 offset:46208
    v_mfma_f32_16x16x32_bf16 v[32:35], v[16:19], v[112:115], v[32:35]
    s_waitcnt lgkmcnt(2)
    v_readfirstlane_b32 s52, v2
    s_and_b32 s52, s52, s36
    v_mfma_f32_16x16x32_bf16 v[36:39], v[16:19], v[116:119], v[36:39]
    s_cselect_b32 s34, 1, 0
    s_ff1_i32_b32 s52, s52
    s_waitcnt lgkmcnt(2)
    v_mfma_f32_16x16x32_bf16 v[24:27], v[20:23], v[120:123], v[24:27]
    ds_read_b64_tr_b16 v[16:17], v0 offset:46336
    s_bitset0_b32 s36, s52
    s_mul_i32 s52, s52, 11
    v_mfma_f32_16x16x32_bf16 v[28:31], v[20:23], v[124:127], v[28:31]
    ds_read_b64_tr_b16 v[18:19], v0 offset:46464
    s_bfe_u32 s53, s52, 0x10005
    s_bfe_u32 s52, s52, 0x30006
    v_mfma_f32_16x16x32_bf16 v[32:35], v[20:23], v[128:131], v[32:35]
    s_mul_i32 s35, s53, 61440
    s_mul_i32 s31, s52, 2304
    s_add_u32 s31, s31, s35
    v_mfma_f32_16x16x32_bf16 v[36:39], v[20:23], v[132:135], v[36:39]
    s_sub_u32 s35, s31, s39
    v_add_u32 v0, s35, v0
    s_waitcnt lgkmcnt(2)
    v_mfma_f32_16x16x32_bf16 v[24:27], v[12:15], v[136:139], v[24:27]
    ds_read_b64_tr_b16 v[20:21], v0 offset:0
    v_mfma_f32_16x16x32_bf16 v[28:31], v[12:15], v[140:143], v[28:31]
    ds_read_b64_tr_b16 v[22:23], v0 offset:128
    v_mfma_f32_16x16x32_bf16 v[32:35], v[12:15], v[144:147], v[32:35]
    s_mov_b32 s39, s31
    s_mul_i32 s33, s53, 5
    s_add_u32 s33, s33, s52
    v_mfma_f32_16x16x32_bf16 v[36:39], v[12:15], v[148:151], v[36:39]
    s_lshl_b32 s33, s33, 13
    s_add_u32 s33, s33, s38
    s_waitcnt lgkmcnt(2)
    v_mfma_f32_16x16x32_bf16 v[24:27], v[16:19], v[152:155], v[24:27]
    ds_read_b64_tr_b16 v[12:13], v0 offset:256
    v_mfma_f32_16x16x32_bf16 v[28:31], v[16:19], v[156:159], v[28:31]
    ds_read_b64_tr_b16 v[14:15], v0 offset:384
    s_mov_b32 s32, s37
    s_mov_b32 s37, s33
    v_mfma_f32_16x16x32_bf16 v[32:35], v[16:19], v[160:163], v[32:35]
    s_cmp_eq_u32 s34, 0
    s_nop 1
    v_mfma_f32_16x16x32_bf16 v[36:39], v[16:19], v[164:167], v[36:39]
    v_cvt_pk_bf16_f32 v4, v24, v28
    v_cvt_pk_bf16_f32 v6, v25, v29
    v_cvt_pk_bf16_f32 v8, v26, v30
    v_cvt_pk_bf16_f32 v10, v27, v31
    s_nop 0
    s_cbranch_scc1 gm_drain
    s_waitcnt lgkmcnt(2)
    v_mfma_f32_16x16x32_bf16 v[24:27], v[20:23], v[40:43], 0
    v_cvt_pk_bf16_f32 v7, v33, v37
    v_cvt_pk_bf16_f32 v5, v32, v36
    ds_read_b64_tr_b16 v[16:17], v0 offset:15360
    v_mfma_f32_16x16x32_bf16 v[28:31], v[20:23], v[44:47], 0
    v_cvt_pk_bf16_f32 v11, v35, v39
    v_cvt_pk_bf16_f32 v9, v34, v38
    ds_read_b64_tr_b16 v[18:19], v0 offset:15488
    v_mfma_f32_16x16x32_bf16 v[32:35], v[20:23], v[48:51], 0
    v_mov_b32_dpp v2, v6 row_ror:8 row_mask:0xf bank_mask:0xf
    v_mov_b32_dpp v3, v7 row_ror:8 row_mask:0xf bank_mask:0xf
    v_mfma_f32_16x16x32_bf16 v[36:39], v[20:23], v[52:55], 0
    v_mov_b32_dpp v6, v4 row_ror:8 row_mask:0xf bank_mask:0x3
    v_mov_b32_dpp v7, v5 row_ror:8 row_mask:0xf bank_mask:0x3
    s_waitcnt lgkmcnt(2)
    v_mfma_f32_16x16x32_bf16 v[24:27], v[12:15], v[56:59], v[24:27]
    ds_read_b64_tr_b16 v[20:21], v0 offset:15616
    v_mov_b32_dpp v4, v2 quad_perm:[0,1,2,3] row_mask:0xf bank_mask:0xc
    v_mfma_f32_16x16x32_bf16 v[28:31], v[12:15], v[60:63], v[28:31]
    ds_read_b64_tr_b16 v[22:23], v0 offset:15744
    v_mov_b32_dpp v5, v3 quad_perm:[0,1,2,3] row_mask:0xf bank_mask:0xc
    v_mfma_f32_16x16x32_bf16 v[32:35], v[12:15], v[64:67], v[32:35]
    buffer_store_dwordx4 v[4:7], v1, s[12:15], s32 offen offset:0 sc0 sc1
    v_mov_b32_dpp v2, v10 row_ror:8 row_mask:0xf bank_mask:0xf
    v_mfma_f32_16x16x32_bf16 v[36:39], v[12:15], v[68:71], v[36:39]
    v_mov_b32_dpp v3, v11 row_ror:8 row_mask:0xf bank_mask:0xf
    v_mov_b32_dpp v10, v8 row_ror:8 row_mask:0xf bank_mask:0x3
    s_waitcnt lgkmcnt(2)
    v_mfma_f32_16x16x32_bf16 v[24:27], v[16:19], v[72:75], v[24:27]
    ds_read_b64_tr_b16 v[12:13], v0 offset:30720
    v_mov_b32_dpp v11, v9 row_ror:8 row_mask:0xf bank_mask:0x3
    v_mfma_f32_16x16x32_bf16 v[28:31], v[16:19], v[76:79], v[28:31]
    ds_read_b64_tr_b16 v[14:15], v0 offset:30848
    v_mov_b32_dpp v8, v2 quad_perm:[0,1,2,3] row_mask:0xf bank_mask:0xc
    v_mfma_f32_16x16x32_bf16 v[32:35], v[16:19], v[80:83], v[32:35]
    v_mov_b32_dpp v9, v3 quad_perm:[0,1,2,3] row_mask:0xf bank_mask:0xc
    buffer_store_dwordx4 v[8:11], v1, s[12:15], s32 offen offset:1024 sc0 sc1
    v_mfma_f32_16x16x32_bf16 v[36:39], v[16:19], v[84:87], v[36:39]
    s_waitcnt lgkmcnt(2)
    v_mfma_f32_16x16x32_bf16 v[24:27], v[20:23], v[88:91], v[24:27]
    ds_read_b64_tr_b16 v[16:17], v0 offset:30976
    v_mfma_f32_16x16x32_bf16 v[28:31], v[20:23], v[92:95], v[28:31]
    ds_read_b64_tr_b16 v[18:19], v0 offset:31104
    v_mfma_f32_16x16x32_bf16 v[32:35], v[20:23], v[96:99], v[32:35]
    v_mov_b32 v2, 0
    v_mfma_f32_16x16x32_bf16 v[36:39], v[20:23], v[100:103], v[36:39]
    ds_read_b32 v2, v2 offset:276
    s_waitcnt lgkmcnt(3)
    v_mfma_f32_16x16x32_bf16 v[24:27], v[12:15], v[104:107], v[24:27]
    ds_read_b64_tr_b16 v[20:21], v0 offset:46080
    v_mfma_f32_16x16x32_bf16 v[28:31], v[12:15], v[108:111], v[28:31]
    ds_read_b64_tr_b16 v[22:23], v0 offset:46208
    v_mfma_f32_16x16x32_bf16 v[32:35], v[12:15], v[112:115], v[32:35]
    s_waitcnt lgkmcnt(2)
    v_readfirstlane_b32 s52, v2
    s_and_b32 s52, s52, s36
    v_mfma_f32_16x16x32_bf16 v[36:39], v[12:15], v[116:119], v[36:39]
    s_cselect_b32 s34, 1, 0
    s_ff1_i32_b32 s52, s52
    s_waitcnt lgkmcnt(2)
    v_mfma_f32_16x16x32_bf16 v[24:27], v[16:19], v[120:123], v[24:27]
    ds_read_b64_tr_b16 v[12:13], v0 offset:46336
    s_bitset0_b32 s36, s52
    s_mul_i32 s52, s52, 11
    v_mfma_f32_16x16x32_bf16 v[28:31], v[16:19], v[124:127], v[28:31]
    ds_read_b64_tr_b16 v[14:15], v0 offset:46464
    s_bfe_u32 s53, s52, 0x10005
    s_bfe_u32 s52, s52, 0x30006
    v_mfma_f32_16x16x32_bf16 v[32:35], v[16:19], v[128:131], v[32:35]
    s_mul_i32 s35, s53, 61440
    s_mul_i32 s31, s52, 2304
    s_add_u32 s31, s31, s35
    v_mfma_f32_16x16x32_bf16 v[36:39], v[16:19], v[132:135], v[36:39]
    s_sub_u32 s35, s31, s39
    v_add_u32 v0, s35, v0
    s_waitcnt lgkmcnt(2)
    v_mfma_f32_16x16x32_bf16 v[24:27], v[20:23], v[136:139], v[24:27]
    ds_read_b64_tr_b16 v[16:17], v0 offset:0
    v_mfma_f32_16x16x32_bf16 v[28:31], v[20:23], v[140:143], v[28:31]
    ds_read_b64_tr_b16 v[18:19], v0 offset:128
    v_mfma_f32_16x16x32_bf16 v[32:35], v[20:23], v[144:147], v[32:35]
    s_mov_b32 s39, s31
    s_mul_i32 s33, s53, 5
    s_add_u32 s33, s33, s52
    v_mfma_f32_16x16x32_bf16 v[36:39], v[20:23], v[148:151], v[36:39]
    s_lshl_b32 s33, s33, 13
    s_add_u32 s33, s33, s38
    s_waitcnt lgkmcnt(2)
    v_mfma_f32_16x16x32_bf16 v[24:27], v[12:15], v[152:155], v[24:27]
    ds_read_b64_tr_b16 v[20:21], v0 offset:256
    v_mfma_f32_16x16x32_bf16 v[28:31], v[12:15], v[156:159], v[28:31]
    ds_read_b64_tr_b16 v[22:23], v0 offset:384
    s_mov_b32 s32, s37
    s_mov_b32 s37, s33
    v_mfma_f32_16x16x32_bf16 v[32:35], v[12:15], v[160:163], v[32:35]
    s_cmp_eq_u32 s34, 0
    s_nop 1
    v_mfma_f32_16x16x32_bf16 v[36:39], v[12:15], v[164:167], v[36:39]
    v_cvt_pk_bf16_f32 v4, v24, v28
    v_cvt_pk_bf16_f32 v6, v25, v29
    v_cvt_pk_bf16_f32 v8, v26, v30
    v_cvt_pk_bf16_f32 v10, v27, v31
    s_nop 0
    s_cbranch_scc1 gm_drain
    s_waitcnt lgkmcnt(2)
    v_mfma_f32_16x16x32_bf16 v[24:27], v[16:19], v[40:43], 0
    v_cvt_pk_bf16_f32 v7, v33, v37
    v_cvt_pk_bf16_f32 v5, v32, v36
    ds_read_b64_tr_b16 v[12:13], v0 offset:15360
    v_mfma_f32_16x16x32_bf16 v[28:31], v[16:19], v[44:47], 0
    v_cvt_pk_bf16_f32 v11, v35, v39
    v_cvt_pk_bf16_f32 v9, v34, v38
    ds_read_b64_tr_b16 v[14:15], v0 offset:15488
    v_mfma_f32_16x16x32_bf16 v[32:35], v[16:19], v[48:51], 0
    v_mov_b32_dpp v2, v6 row_ror:8 row_mask:0xf bank_mask:0xf
    v_mov_b32_dpp v3, v7 row_ror:8 row_mask:0xf bank_mask:0xf
    v_mfma_f32_16x16x32_bf16 v[36:39], v[16:19], v[52:55], 0
    v_mov_b32_dpp v6, v4 row_ror:8 row_mask:0xf bank_mask:0x3
    v_mov_b32_dpp v7, v5 row_ror:8 row_mask:0xf bank_mask:0x3
    s_waitcnt lgkmcnt(2)
    v_mfma_f32_16x16x32_bf16 v[24:27], v[20:23], v[56:59], v[24:27]
    ds_read_b64_tr_b16 v[16:17], v0 offset:15616
    v_mov_b32_dpp v4, v2 quad_perm:[0,1,2,3] row_mask:0xf bank_mask:0xc
    v_mfma_f32_16x16x32_bf16 v[28:31], v[20:23], v[60:63], v[28:31]
    ds_read_b64_tr_b16 v[18:19], v0 offset:15744
    v_mov_b32_dpp v5, v3 quad_perm:[0,1,2,3] row_mask:0xf bank_mask:0xc
    v_mfma_f32_16x16x32_bf16 v[32:35], v[20:23], v[64:67], v[32:35]
    buffer_store_dwordx4 v[4:7], v1, s[12:15], s32 offen offset:0 sc0 sc1
    v_mov_b32_dpp v2, v10 row_ror:8 row_mask:0xf bank_mask:0xf
    v_mfma_f32_16x16x32_bf16 v[36:39], v[20:23], v[68:71], v[36:39]
    v_mov_b32_dpp v3, v11 row_ror:8 row_mask:0xf bank_mask:0xf
    v_mov_b32_dpp v10, v8 row_ror:8 row_mask:0xf bank_mask:0x3
    s_waitcnt lgkmcnt(2)
    v_mfma_f32_16x16x32_bf16 v[24:27], v[12:15], v[72:75], v[24:27]
    ds_read_b64_tr_b16 v[20:21], v0 offset:30720
    v_mov_b32_dpp v11, v9 row_ror:8 row_mask:0xf bank_mask:0x3
    v_mfma_f32_16x16x32_bf16 v[28:31], v[12:15], v[76:79], v[28:31]
    ds_read_b64_tr_b16 v[22:23], v0 offset:30848
    v_mov_b32_dpp v8, v2 quad_perm:[0,1,2,3] row_mask:0xf bank_mask:0xc
    v_mfma_f32_16x16x32_bf16 v[32:35], v[12:15], v[80:83], v[32:35]
    v_mov_b32_dpp v9, v3 quad_perm:[0,1,2,3] row_mask:0xf bank_mask:0xc
    buffer_store_dwordx4 v[8:11], v1, s[12:15], s32 offen offset:1024 sc0 sc1
    v_mfma_f32_16x16x32_bf16 v[36:39], v[12:15], v[84:87], v[36:39]
    s_waitcnt lgkmcnt(2)
    v_mfma_f32_16x16x32_bf16 v[24:27], v[16:19], v[88:91], v[24:27]
    ds_read_b64_tr_b16 v[12:13], v0 offset:30976
    v_mfma_f32_16x16x32_bf16 v[28:31], v[16:19], v[92:95], v[28:31]
    ds_read_b64_tr_b16 v[14:15], v0 offset:31104
    v_mfma_f32_16x16x32_bf16 v[32:35], v[16:19], v[96:99], v[32:35]
    v_mov_b32 v2, 0
    v_mfma_f32_16x16x32_bf16 v[36:39], v[16:19], v[100:103], v[36:39]
    ds_read_b32 v2, v2 offset:276
    s_waitcnt lgkmcnt(3)
    v_mfma_f32_16x16x32_bf16 v[24:27], v[20:23], v[104:107], v[24:27]
    ds_read_b64_tr_b16 v[16:17], v0 offset:46080
    v_mfma_f32_16x16x32_bf16 v[28:31], v[20:23], v[108:111], v[28:31]
    ds_read_b64_tr_b16 v[18:19], v0 offset:46208
    v_mfma_f32_16x16x32_bf16 v[32:35], v[20:23], v[112:115], v[32:35]
    s_waitcnt lgkmcnt(2)
    v_readfirstlane_b32 s52, v2
    s_and_b32 s52, s52, s36
    v_mfma_f32_16x16x32_bf16 v[36:39], v[20:23], v[116:119], v[36:39]
    s_cselect_b32 s34, 1, 0
    s_ff1_i32_b32 s52, s52
    s_waitcnt lgkmcnt(2)
    v_mfma_f32_16x16x32_bf16 v[24:27], v[12:15], v[120:123], v[24:27]
    ds_read_b64_tr_b16 v[20:21], v0 offset:46336
    s_bitset0_b32 s36, s52
    s_mul_i32 s52, s52, 11
    v_mfma_f32_16x16x32_bf16 v[28:31], v[12:15], v[124:127], v[28:31]
    ds_read_b64_tr_b16 v[22:23], v0 offset:46464
    s_bfe_u32 s53, s52, 0x10005
    s_bfe_u32 s52, s52, 0x30006
    v_mfma_f32_16x16x32_bf16 v[32:35], v[12:15], v[128:131], v[32:35]
    s_mul_i32 s35, s53, 61440
    s_mul_i32 s31, s52, 2304
    s_add_u32 s31, s31, s35
    v_mfma_f32_16x16x32_bf16 v[36:39], v[12:15], v[132:135], v[36:39]
    s_sub_u32 s35, s31, s39
    v_add_u32 v0, s35, v0
    s_waitcnt lgkmcnt(2)
    v_mfma_f32_16x16x32_bf16 v[24:27], v[16:19], v[136:139], v[24:27]
    ds_read_b64_tr_b16 v[12:13], v0 offset:0
    v_mfma_f32_16x16x32_bf16 v[28:31], v[16:19], v[140:143], v[28:31]
    ds_read_b64_tr_b16 v[14:15], v0 offset:128
    v_mfma_f32_16x16x32_bf16 v[32:35], v[16:19], v[144:147], v[32:35]
    s_mov_b32 s39, s31
    s_mul_i32 s33, s53, 5
    s_add_u32 s33, s33, s52
    v_mfma_f32_16x16x32_bf16 v[36:39], v[16:19], v[148:151], v[36:39]
    s_lshl_b32 s33, s33, 13
    s_add_u32 s33, s33, s38
    s_waitcnt lgkmcnt(2)
    v_mfma_f32_16x16x32_bf16 v[24:27], v[20:23], v[152:155], v[24:27]
    ds_read_b64_tr_b16 v[16:17], v0 offset:256
    v_mfma_f32_16x16x32_bf16 v[28:31], v[20:23], v[156:159], v[28:31]
    ds_read_b64_tr_b16 v[18:19], v0 offset:384
    s_mov_b32 s32, s37
    s_mov_b32 s37, s33
    v_mfma_f32_16x16x32_bf16 v[32:35], v[20:23], v[160:163], v[32:35]
    s_cmp_eq_u32 s34, 0
    s_nop 1
    v_mfma_f32_16x16x32_bf16 v[36:39], v[20:23], v[164:167], v[36:39]
    v_cvt_pk_bf16_f32 v4, v24, v28
    v_cvt_pk_bf16_f32 v6, v25, v29
    v_cvt_pk_bf16_f32 v8, v26, v30
    v_cvt_pk_bf16_f32 v10, v27, v31
    s_nop 0
    s_cbranch_scc0 gm_loop
gm_drain:
    s_nop 2
    v_cvt_pk_bf16_f32 v7, v33, v37
    v_cvt_pk_bf16_f32 v5, v32, v36
    v_cvt_pk_bf16_f32 v11, v35, v39
    v_cvt_pk_bf16_f32 v9, v34, v38
    v_mov_b32_dpp v2, v6 row_ror:8 row_mask:0xf bank_mask:0xf
    v_mov_b32_dpp v3, v7 row_ror:8 row_mask:0xf bank_mask:0xf
    v_mov_b32_dpp v6, v4 row_ror:8 row_mask:0xf bank_mask:0x3
    v_mov_b32_dpp v7, v5 row_ror:8 row_mask:0xf bank_mask:0x3
    v_mov_b32_dpp v4, v2 quad_perm:[0,1,2,3] row_mask:0xf bank_mask:0xc
    v_mov_b32_dpp v5, v3 quad_perm:[0,1,2,3] row_mask:0xf bank_mask:0xc
    buffer_store_dwordx4 v[4:7], v1, s[12:15], s32 offen offset:0 sc0 sc1
    v_mov_b32_dpp v2, v10 row_ror:8 row_mask:0xf bank_mask:0xf
    v_mov_b32_dpp v3, v11 row_ror:8 row_mask:0xf bank_mask:0xf
    v_mov_b32_dpp v10, v8 row_ror:8 row_mask:0xf bank_mask:0x3
    v_mov_b32_dpp v11, v9 row_ror:8 row_mask:0xf bank_mask:0x3
    v_mov_b32_dpp v8, v2 quad_perm:[0,1,2,3] row_mask:0xf bank_mask:0xc
    v_mov_b32_dpp v9, v3 quad_perm:[0,1,2,3] row_mask:0xf bank_mask:0xc
    buffer_store_dwordx4 v[8:11], v1, s[12:15], s32 offen offset:1024 sc0 sc1
    s_cmp_lg_u32 s36, 0
    s_cbranch_scc1 gm_poll
    s_endpgm
gm_ovf:
    s_movk_i32 s20, 4
    s_barrier
    s_barrier
    s_barrier
    s_branch gm_pass
gm_next:
    s_add_u32 s24, s24, s20
    s_barrier
    s_branch gm_pass
mn_w5:
    v_add_u32 v55, 16, v35
    v_add_u32 v55, s24, v55
    v_lshrrev_b32 v56, 16, v58
    v_mov_b32 v24, 0
    v_cmpx_lt_u32 vcc, v55, v56
    s_cbranch_execz mn_g0
    v_and_b32 v56, 0xffff, v58
    v_add_u32 v55, v55, v56
    v_mad_u32_u24 v56, v55, 48, v46
    buffer_load_dword v24, v56, s[8:11], 0 offen offset:40
    s_waitcnt vmcnt(0)
mn_g0:
    s_mov_b64 exec, -1
mn_more:
    s_add_u32 s52, s24, s20
    v_lshrrev_b32 v56, 16, v58
    v_cmp_lt_u32 vcc, s52, v56
    s_cbranch_vccz mn_count
    v_mov_b32 v55, 272
    ds_write_b32 v55, v48
    s_branch mn_count
mn_ovf:
    s_movk_i32 s20, 4
    s_waitcnt vmcnt(0) lgkmcnt(0)
    s_barrier
    s_branch mn_again
mn_next:
    s_set_gpr_idx_off
    s_waitcnt vmcnt(0) lgkmcnt(0)
    s_nop 7
    s_add_u32 s24, s24, s20
    v_mbcnt_lo_u32_b32 v0, -1, 0
    v_mbcnt_hi_u32_b32 v0, -1, v0
    v_lshl_add_u32 v0, s16, 6, v0
    v_lshrrev_b32 v56, 6, v0
    v_lshlrev_b32 v55, 1, v0
    v_and_b32 v55, 0x78, v55
    v_or_b32 v55, v55, v56
    v_cmp_gt_u32 vcc, 125, v55
    v_mul_u32_u24 v46, 61440, v55
    v_bfrev_b32 v56, 2
    v_lshlrev_b32 v55, 4, v0
    v_and_b32 v57, 0x1fc, v0
    v_cndmask_b32 v55, v56, v55, vcc
    v_cndmask_b32 v57, v56, v57, vcc
    v_and_b32 v51, 63, v0
    v_lshlrev_b32 v56, 3, v51
    buffer_load_dword v58, v57, s[8:11], s25 offen
    buffer_load_dwordx2 v[44:45], v56, s[8:11], s25 offen
    v_mov_b32 v48, 1
    v_lshlrev_b32 v47, 2, v51
    v_bfe_u32 v2, v0, 5, 1
    v_bfe_u32 v3, v0, 3, 2
    v_and_b32 v35, 3, v0
    v_lshl_add_u32 v3, v3, 2, v35
    v_mul_u32_u24 v49, 20, v2
    v_lshrrev_b32 v18, 2, v51
    v_lshl_add_u32 v18, v35, 4, v18
    v_mov_b32 v50, 1327103
    s_lshl_b32 s52, s16, 3
    s_bfm_b64 s[36:37], s52, 0
    s_andn2_b32 s39, s37, 2155905024
    s_mov_b32 s38, s36
mn_again:
    v_mov_b32 v55, 0
    ds_write_b32 v47, v55 offset:0
    ds_write_b32 v47, v55 offset:256
    s_waitcnt vmcnt(0) lgkmcnt(0)
    s_barrier
    v_add_u32 v55, 0, v35
    v_add_u32 v55, s24, v55
    v_lshrrev_b32 v56, 16, v58
    v_mov_b32 v20, 0
    v_cmpx_lt_u32 vcc, v55, v56
    s_cbranch_execz mn_g1
    v_and_b32 v56, 0xffff, v58
    v_add_u32 v55, v55, v56
    v_mad_u32_u24 v56, v55, 48, v46
    buffer_load_dword v20, v56, s[8:11], 0 offen offset:40
    s_waitcnt vmcnt(0)
mn_g1:
    s_mov_b64 exec, -1
    v_mov_b32 v21, 0
    v_mov_b32 v22, 0
    v_mov_b32 v23, 0
    v_mov_b32 v24, 0
    s_cmp_le_u32 s20, 4
    s_cbranch_scc1 mn_more
    v_add_u32 v55, 4, v35
    v_add_u32 v55, s24, v55
    v_lshrrev_b32 v56, 16, v58
    v_mov_b32 v21, 0
    v_cmpx_lt_u32 vcc, v55, v56
    s_cbranch_execz mn_g2
    v_and_b32 v56, 0xffff, v58
    v_add_u32 v55, v55, v56
    v_mad_u32_u24 v56, v55, 48, v46
    buffer_load_dword v21, v56, s[8:11], 0 offen offset:40
    s_waitcnt vmcnt(0)
mn_g2:
    s_mov_b64 exec, -1
    v_add_u32 v55, 8, v35
    v_add_u32 v55, s24, v55
    v_lshrrev_b32 v56, 16, v58
    v_mov_b32 v22, 0
    v_cmpx_lt_u32 vcc, v55, v56
    s_cbranch_execz mn_g3
    v_and_b32 v56, 0xffff, v58
    v_add_u32 v55, v55, v56
    v_mad_u32_u24 v56, v55, 48, v46
    buffer_load_dword v22, v56, s[8:11], 0 offen offset:40
    s_waitcnt vmcnt(0)
mn_g3:
    s_mov_b64 exec, -1
    v_add_u32 v55, 12, v35
    v_add_u32 v55, s24, v55
    v_lshrrev_b32 v56, 16, v58
    v_mov_b32 v23, 0
    v_cmpx_lt_u32 vcc, v55, v56
    s_cbranch_execz mn_g4
    v_and_b32 v56, 0xffff, v58
    v_add_u32 v55, v55, v56
    v_mad_u32_u24 v56, v55, 48, v46
    buffer_load_dword v23, v56, s[8:11], 0 offen offset:40
    s_waitcnt vmcnt(0)
mn_g4:
    s_mov_b64 exec, -1
    v_add_u32 v55, 16, v35
    v_add_u32 v55, s24, v55
    v_lshrrev_b32 v56, 16, v58
    v_mov_b32 v24, 0
    v_cmpx_lt_u32 vcc, v55, v56
    s_cbranch_execz mn_g5
    v_and_b32 v56, 0xffff, v58
    v_add_u32 v55, v55, v56
    v_mad_u32_u24 v56, v55, 48, v46
    buffer_load_dword v24, v56, s[8:11], 0 offen offset:40
    s_waitcnt vmcnt(0)
mn_g5:
    s_mov_b64 exec, -1
    s_branch mn_more
mn_last:
    s_endpgm
.section .rodata,"a"
.p2align 6
.amdhsa_kernel ka_kernel
  .amdhsa_next_free_vgpr 88
  .amdhsa_next_free_sgpr 40
  .amdhsa_accum_offset 88
  .amdhsa_group_segment_fixed_size 0
  .amdhsa_kernarg_size 88
  .amdhsa_user_sgpr_count 2
  .amdhsa_user_sgpr_kernarg_segment_ptr 1
  .amdhsa_system_sgpr_workgroup_id_x 1
.end_amdhsa_kernel
.p2align 6
.amdhsa_kernel main_kernel
  .amdhsa_next_free_vgpr 168
  .amdhsa_next_free_sgpr 96
  .amdhsa_accum_offset 168
  .amdhsa_group_segment_fixed_size 0
  .amdhsa_kernarg_size 88
  .amdhsa_user_sgpr_count 2
  .amdhsa_user_sgpr_kernarg_segment_ptr 1
  .amdhsa_system_sgpr_workgroup_id_x 1
.end_amdhsa_kernel
```

```asm
; @launch kernel=ka_kernel grid=(256,1,1) block=(768,1,1) lds=94208
; @launch kernel=main_kernel grid=(256,1,1) block=(768,1,1) lds=163840
.amdgcn_target "amdgcn-amd-amdhsa--gfx950"
.text
.globl ka_kernel
.p2align 8
.type ka_kernel,@function
ka_kernel:
    s_cmp_ge_u32 s2, 256
    s_cbranch_scc1 ka_end
    s_cmp_lt_u32 s2, 128
    s_cbranch_scc1 ka_nospf
    s_getpc_b64 s[36:37]
ka_pc0:
    v_lshlrev_b32 v41, 7, v0
    v_min_u32 v41, mn_last-ka_pc0, v41
    global_load_dword v41, v41, s[36:37]
ka_nospf:
    s_load_dwordx8 s[4:11], s[0:1], 8
    s_load_dwordx2 s[16:17], s[0:1], 0
    s_load_dwordx2 s[14:15], s[0:1], 80
    s_load_dwordx2 s[32:33], s[0:1], 56
    v_lshrrev_b32 v9, 6, v0
    v_and_b32 v1, 63, v0
    v_readfirstlane_b32 s18, v9
    s_cmp_ge_u32 s2, 128
    s_cbranch_scc1 ka_pf
    s_cmp_ge_u32 s2, 125
    s_cbranch_scc1 ka_extra
    s_mul_i32 s3, s2, 1280
    v_add_u32 v4, s3, v0
    v_lshlrev_b32 v5, 2, v4
    v_lshlrev_b32 v6, 3, v4
    v_add_u32 v8, 5120, v6
    s_mov_b32 s22, 12582912
    s_mov_b32 s23, 0x20000
    s_and_b32 s28, s2, 7
    s_lshl_b32 s28, s28, 4
    s_lshr_b32 s29, s2, 3
    s_add_u32 s28, s28, s29
    s_cmp_ge_u32 s18, 10
    s_waitcnt lgkmcnt(0)
    s_mov_b32 s20, s14
    s_cbranch_scc1 ka_dma
    global_load_dword v10, v5, s[6:7]
    global_load_dword v60, v5, s[6:7] offset:2560
    global_load_dword v11, v5, s[4:5]
    global_load_dword v61, v5, s[4:5] offset:2560
    v_lshlrev_b32 v2, 2, v0
    v_and_b32 v2, 0x3fc, v2
    v_lshlrev_b32 v5, 4, v0
    v_mov_b32 v44, 0
    v_mov_b32 v45, 0
    v_mov_b32 v46, 0
    v_mov_b32 v47, 0
    ds_write_b32 v2, v44
    ds_write_b128 v5, v[44:47] offset:11264
    ds_write_b128 v5, v[44:47] offset:17408
    s_and_b32 s21, s15, 0xffff
    s_lshl_b32 s28, s28, 2
    s_add_u32 s28, s28, 10485760
    v_mov_b32 v3, 1
    v_lshlrev_b32 v26, 4, v1
    s_lshl_b32 s19, s18, 10
    v_add_u32 v27, s19, v26
    v_mov_b32 v4, 0x40000
    s_movk_i32 s29, 625
    s_waitcnt lgkmcnt(0)
    s_barrier
    global_load_dwordx2 v[12:13], v6, s[8:9]
    global_load_dwordx2 v[72:73], v8, s[8:9]
    v_mul_u32_u24 v16, 21846, v0
    v_lshrrev_b32 v16, 16, v16
    v_mad_i32_i24 v18, v16, -3, v0
    v_lshlrev_b32 v16, 2, v16
    v_cmp_eq_u32 vcc, 2, v18
    v_lshlrev_b32 v18, 4, v18
    v_add_u32 v18, 53248, v18
    v_mov_b32 v19, 32768
    v_cndmask_b32 v17, 5, 4, vcc
    v_cndmask_b32 v18, v18, v19, vcc
    v_lshlrev_b32 v19, 4, v0
    s_mul_i32 s31, s2, 61440
    s_waitcnt vmcnt(5)
    v_mul_u32_u24 v32, 214749, v10
    v_lshrrev_b32 v32, 23, v32
    v_min_u32 v32, 255, v32
    v_and_b32 v35, 7, v32
    v_lshrrev_b32 v33, 3, v32
    v_lshl_add_u32 v35, v35, 5, v33
    v_lshlrev_b32 v35, 2, v35
    ds_add_rtn_u32 v36, v35, v3
    s_waitcnt vmcnt(4)
    v_mul_u32_u24 v62, 214749, v60
    v_lshrrev_b32 v62, 23, v62
    v_min_u32 v62, 255, v62
    v_and_b32 v66, 7, v62
    v_lshrrev_b32 v63, 3, v62
    v_lshl_add_u32 v66, v66, 5, v63
    v_lshlrev_b32 v66, 2, v66
    ds_add_rtn_u32 v67, v66, v3
    v_mad_u32_u24 v33, v32, s29, 15
    v_lshrrev_b32 v33, 4, v33
    v_sub_u32 v33, v10, v33
    v_subrev_u32 v32, 20, v33
    v_min_u32 v32, v32, v33
    v_min_u32 v32, 19, v32
    v_lshlrev_b32 v40, 4, v35
    v_add_u32 v35, s19, v35
    v_mad_u32_u24 v63, v62, s29, 15
    v_lshrrev_b32 v63, 4, v63
    v_sub_u32 v63, v60, v63
    v_subrev_u32 v62, 20, v63
    v_min_u32 v62, v62, v63
    v_min_u32 v62, 19, v62
    v_lshlrev_b32 v70, 4, v66
    v_add_u32 v66, s19, v66
    s_waitcnt vmcnt(2) lgkmcnt(0)
    v_mul_u32_u24 v39, 3330, v11
    v_lshrrev_b32 v39, 20, v39
    v_lshrrev_b32 v34, 2, v32
    v_cmp_gt_u32 vcc, 27, v39
    v_add_u32 v34, 27, v34
    v_lshlrev_b32 v15, 2, v32
    v_cndmask_b32 v39, v34, v39, vcc
    v_cmp_le_u32 vcc, 20, v33
    v_and_b32 v14, 0x3fff, v11
    v_or_b32 v39, 64, v39
    v_add_u32 v34, 32, v39
    v_cndmask_b32 v39, v39, v34, vcc
    v_lshl_or_b32 v14, v39, 25, v14
    v_cmp_lt_u32 vcc, 15, v36
    v_and_b32 v34, 3, v36
    v_lshl_add_u32 v40, v34, 4, v40
    v_and_or_b32 v40, v36, 12, v40
    v_cndmask_b32 v40, v40, v4, vcc
    ds_write_b32 v40, v14 offset:11264
    v_mul_u32_u24 v68, 3330, v61
    v_lshrrev_b32 v68, 20, v68
    v_lshrrev_b32 v71, 2, v62
    v_cmp_gt_u32 vcc, 27, v68
    v_add_u32 v71, 27, v71
    v_lshlrev_b32 v75, 2, v62
    v_cndmask_b32 v68, v71, v68, vcc
    v_cmp_le_u32 vcc, 20, v63
    v_and_b32 v74, 0x3fff, v61
    v_or_b32 v68, 64, v68
    v_add_u32 v71, 32, v68
    v_cndmask_b32 v68, v68, v71, vcc
    v_lshl_or_b32 v74, v68, 25, v74
    v_cmp_lt_u32 vcc, 15, v67
    v_and_b32 v71, 3, v67
    v_lshl_add_u32 v70, v71, 4, v70
    v_and_or_b32 v70, v67, 12, v70
    v_cndmask_b32 v70, v70, v4, vcc
    ds_write_b32 v70, v74 offset:11264
    s_waitcnt lgkmcnt(0)
    s_barrier
    ds_read_b128 v[44:47], v26
    ds_read_b32 v37, v2
    v_add_u32 v28, s19, v2
    v_lshlrev_b32 v29, 9, v0
    v_add_u32 v9, 640, v0
    s_waitcnt vmcnt(2)
    s_waitcnt lgkmcnt(1)
    v_add_u32 v53, v44, v45
    v_add_u32 v54, v53, v46
    v_add_u32 v38, v54, v47
    v_mov_b32 v55, v38
    s_nop 0
    v_add_u32_dpp v38, v38, v38 row_shr:1 row_mask:0xf bank_mask:0xf
    s_nop 0
    s_nop 0
    v_add_u32_dpp v38, v38, v38 row_shr:2 row_mask:0xf bank_mask:0xf
    s_nop 0
    s_nop 0
    v_add_u32_dpp v38, v38, v38 row_shr:4 row_mask:0xf bank_mask:0xf
    s_nop 0
    s_nop 0
    v_add_u32_dpp v38, v38, v38 row_shr:8 row_mask:0xf bank_mask:0xf
    s_nop 0
    s_nop 0
    v_add_u32_dpp v38, v38, v38 row_bcast:15 row_mask:0xa bank_mask:0xf
    s_nop 0
    s_nop 0
    v_add_u32_dpp v38, v38, v38 row_bcast:31 row_mask:0xc bank_mask:0xf
    v_sub_u32 v56, v38, v55
    v_add_u32 v57, v56, v44
    v_add_u32 v58, v56, v53
    v_add_u32 v59, v56, v54
    ds_write_b128 v27, v[56:59] offset:1024
    ds_read_b32 v43, v35 offset:1024
    ds_read_b32 v69, v66 offset:1024
    ds_read_b32 v30, v28 offset:1024
    s_cmp_ge_u32 s18, 4
    s_waitcnt vmcnt(0)
    ds_write_b128 v5, v[12:15] offset:32768
    ds_write_b128 v5, v[72:75] offset:43008
    s_waitcnt lgkmcnt(2)
    v_add_lshl_u32 v43, v43, v36, 2
    v_add_lshl_u32 v69, v69, v67, 2
    ds_write_b32 v43, v0 offset:27648
    ds_write_b32 v69, v9 offset:27648
    v_lshl_or_b32 v30, v37, 16, v30
    s_cbranch_scc1 ka_nohdr
    buffer_store_dword v30, v29, s[20:23], s28 offen
ka_nohdr:
    s_waitcnt lgkmcnt(0)
ka_copy:
    s_barrier
    ds_read_b32 v20, v16 offset:27648
    ds_read_b32 v21, v16 offset:28672
    ds_read_b32 v22, v16 offset:29696
    ds_read_b32 v23, v16 offset:30720
    ds_read_b32 v24, v16 offset:31744
    s_waitcnt lgkmcnt(4)
    v_lshl_add_u32 v20, v20, v17, v18
    ds_read_b128 v[44:47], v20
    s_waitcnt lgkmcnt(4)
    v_lshl_add_u32 v21, v21, v17, v18
    ds_read_b128 v[48:51], v21
    s_waitcnt lgkmcnt(4)
    v_lshl_add_u32 v22, v22, v17, v18
    ds_read_b128 v[52:55], v22
    s_waitcnt lgkmcnt(4)
    v_lshl_add_u32 v23, v23, v17, v18
    ds_read_b128 v[56:59], v23
    s_waitcnt lgkmcnt(4)
    v_lshl_add_u32 v24, v24, v17, v18
    ds_read_b128 v[60:63], v24
    s_waitcnt lgkmcnt(4)
    buffer_store_dwordx4 v[44:47], v19, s[20:23], s31 offen sc1
    s_addk_i32 s31, 12288
    s_waitcnt lgkmcnt(3)
    buffer_store_dwordx4 v[48:51], v19, s[20:23], s31 offen sc1
    s_addk_i32 s31, 12288
    s_waitcnt lgkmcnt(2)
    buffer_store_dwordx4 v[52:55], v19, s[20:23], s31 offen sc1
    s_addk_i32 s31, 12288
    s_waitcnt lgkmcnt(1)
    buffer_store_dwordx4 v[56:59], v19, s[20:23], s31 offen sc1
    s_addk_i32 s31, 12288
    s_waitcnt lgkmcnt(0)
    buffer_store_dwordx4 v[60:63], v19, s[20:23], s31 offen sc1
    s_endpgm
ka_dma:
    s_and_b32 s21, s15, 0xffff
    s_sub_u32 s33, s18, 10
    s_lshl_b32 s34, s33, 10
    s_mul_i32 s35, s2, 40960
    s_add_u32 s35, s35, s34
    v_lshl_add_u32 v7, v1, 4, s35
    s_add_u32 m0, s34, 53248
    s_lshl_b32 s30, s28, 6
    s_add_u32 s30, s30, 8388608
    s_barrier
    global_load_lds_dwordx4 v7, s[10:11]
    s_add_u32 m0, m0, 2048
    v_add_u32 v7, 2048, v7
    global_load_lds_dwordx4 v7, s[10:11]
    s_add_u32 m0, m0, 2048
    v_add_u32 v7, 2048, v7
    global_load_lds_dwordx4 v7, s[10:11]
    s_add_u32 m0, m0, 2048
    v_add_u32 v7, 2048, v7
    v_mul_u32_u24 v16, 21846, v0
    v_lshrrev_b32 v16, 16, v16
    v_mad_i32_i24 v18, v16, -3, v0
    v_lshlrev_b32 v16, 2, v16
    v_cmp_eq_u32 vcc, 2, v18
    v_lshlrev_b32 v18, 4, v18
    v_add_u32 v18, 53248, v18
    v_mov_b32 v19, 32768
    v_cndmask_b32 v17, 5, 4, vcc
    v_cndmask_b32 v18, v18, v19, vcc
    v_lshlrev_b32 v19, 4, v0
    s_mul_i32 s31, s2, 61440
    s_barrier
    global_load_lds_dwordx4 v7, s[10:11]
    s_add_u32 m0, m0, 2048
    v_add_u32 v7, 2048, v7
    global_load_lds_dwordx4 v7, s[10:11]
    s_add_u32 m0, m0, 2048
    v_add_u32 v7, 2048, v7
    global_load_lds_dwordx4 v7, s[10:11]
    s_add_u32 m0, m0, 2048
    v_add_u32 v7, 2048, v7
    global_load_lds_dwordx4 v7, s[10:11]
    s_add_u32 m0, m0, 2048
    v_add_u32 v7, 2048, v7
    global_load_lds_dwordx4 v7, s[10:11]
    s_add_u32 m0, m0, 2048
    v_add_u32 v7, 2048, v7
    global_load_lds_dwordx4 v7, s[10:11]
    s_add_u32 m0, m0, 2048
    v_add_u32 v7, 2048, v7
    global_load_lds_dwordx4 v7, s[10:11]
    s_add_u32 m0, m0, 2048
    v_add_u32 v7, 2048, v7
    global_load_lds_dwordx4 v7, s[10:11]
    s_add_u32 m0, m0, 2048
    v_add_u32 v7, 2048, v7
    global_load_lds_dwordx4 v7, s[10:11]
    s_add_u32 m0, m0, 2048
    v_add_u32 v7, 2048, v7
    global_load_lds_dwordx4 v7, s[10:11]
    s_add_u32 m0, m0, 2048
    v_add_u32 v7, 2048, v7
    global_load_lds_dwordx4 v7, s[10:11]
    s_add_u32 m0, m0, 2048
    v_add_u32 v7, 2048, v7
    global_load_lds_dwordx4 v7, s[10:11]
    s_add_u32 m0, m0, 2048
    v_add_u32 v7, 2048, v7
    global_load_lds_dwordx4 v7, s[10:11]
    s_add_u32 m0, m0, 2048
    v_add_u32 v7, 2048, v7
    global_load_lds_dwordx4 v7, s[10:11]
    s_add_u32 m0, m0, 2048
    v_add_u32 v7, 2048, v7
    global_load_lds_dwordx4 v7, s[10:11]
    s_add_u32 m0, m0, 2048
    v_add_u32 v7, 2048, v7
    global_load_lds_dwordx4 v7, s[10:11]
    s_add_u32 m0, m0, 2048
    v_add_u32 v7, 2048, v7
    global_load_lds_dwordx4 v7, s[10:11]
    s_add_u32 m0, m0, 2048
    v_add_u32 v7, 2048, v7
    v_and_b32 v2, 0x7f, v0
    v_lshlrev_b32 v5, 4, v2
    v_lshrrev_b32 v6, 2, v2
    v_lshlrev_b32 v6, 13, v6
    v_and_or_b32 v6, v5, 0x30, v6
    ds_read_b128 v[44:47], v5 offset:11264
    ds_read_b128 v[48:51], v5 offset:13312
    ds_read_b128 v[52:55], v5 offset:15360
    ds_read_b128 v[56:59], v5 offset:17408
    ds_read_b128 v[60:63], v5 offset:19456
    ds_read_b128 v[64:67], v5 offset:21504
    ds_read_b128 v[68:71], v5 offset:23552
    ds_read_b128 v[72:75], v5 offset:25600
    s_waitcnt lgkmcnt(7)
    buffer_store_dwordx4 v[44:47], v6, s[20:23], s30 offen
    s_add_u32 s30, s30, 262144
    s_waitcnt lgkmcnt(6)
    buffer_store_dwordx4 v[48:51], v6, s[20:23], s30 offen
    s_add_u32 s30, s30, 262144
    s_waitcnt lgkmcnt(5)
    buffer_store_dwordx4 v[52:55], v6, s[20:23], s30 offen
    s_add_u32 s30, s30, 262144
    s_waitcnt lgkmcnt(4)
    buffer_store_dwordx4 v[56:59], v6, s[20:23], s30 offen
    s_add_u32 s30, s30, 262144
    s_waitcnt lgkmcnt(3)
    buffer_store_dwordx4 v[60:63], v6, s[20:23], s30 offen
    s_add_u32 s30, s30, 262144
    s_waitcnt lgkmcnt(2)
    buffer_store_dwordx4 v[64:67], v6, s[20:23], s30 offen
    s_add_u32 s30, s30, 262144
    s_waitcnt lgkmcnt(1)
    buffer_store_dwordx4 v[68:71], v6, s[20:23], s30 offen
    s_add_u32 s30, s30, 262144
    s_waitcnt lgkmcnt(0)
    buffer_store_dwordx4 v[72:75], v6, s[20:23], s30 offen
    s_waitcnt vmcnt(8)
    s_branch ka_copy
ka_pf:
    s_sub_u32 s34, s2, 127
    s_mul_i32 s34, s34, 40960
    s_sub_u32 s34, s34, 40960
    v_lshl_add_u32 v44, v0, 7, s34
    v_min_u32 v44, 5119996, v44
    s_waitcnt lgkmcnt(0)
    s_cmp_ge_u32 s18, 5
    s_cbranch_scc1 ka_nohlp
    global_load_dword v45, v44, s[10:11]
ka_nohlp:
    s_and_b32 s34, s2, 7
    s_mul_i32 s34, s34, 655360
    s_add_u32 s24, s16, s34
    s_addc_u32 s25, s17, 0
    s_and_b32 s25, s25, 0xffff
    s_mov_b32 s26, 655360
    s_mov_b32 s27, 0x20000
    s_bfe_u32 s30, s2, 0x40003
    v_lshlrev_b32 v40, 7, v0
    s_mul_i32 s30, s30, 40960
    s_cmp_lg_u32 s18, 9
    s_cbranch_scc1 ka_pf1
    s_bitcmp1_b32 s2, 3
    s_cbranch_scc1 ka_pf1
    s_and_b32 s35, s2, 7
    s_bfe_u32 s36, s2, 0x30004
    s_lshl_b32 s37, s35, 14
    s_lshr_b32 s38, s36, 1
    s_lshl_b32 s38, s38, 7
    s_add_u32 s37, s37, s38
    s_and_b32 s38, s36, 1
    s_lshl2_add_u32 s37, s38, s37
    v_lshrrev_b32 v44, 4, v1
    v_lshlrev_b32 v44, 11, v44
    v_and_b32 v45, 7, v1
    v_lshl_add_u32 v44, v45, 4, v44
    v_and_b32 v45, 8, v1
    v_add3_u32 v44, v44, v45, s37
    v_add_u32 v45, 0x2000, v44
    global_load_dword v48, v44, s[32:33] offset:0
    global_load_dword v49, v44, s[32:33] offset:512
    global_load_dword v50, v44, s[32:33] offset:1024
    global_load_dword v51, v44, s[32:33] offset:1536
    global_load_dword v52, v45, s[32:33] offset:0
    global_load_dword v53, v45, s[32:33] offset:512
    global_load_dword v54, v45, s[32:33] offset:1024
    global_load_dword v55, v45, s[32:33] offset:1536
    s_lshr_b32 s36, s36, 1
    s_lshl3_add_u32 s36, s36, s35
    s_lshl1_add_u32 s36, s36, s38
    s_lshl_b32 s36, s36, 11
    s_add_u32 s36, s36, 11534336
    v_lshl_add_u32 v46, v1, 4, s36
    s_mov_b32 s38, 0x05040100
    s_mov_b32 s39, 0x07060302
    s_waitcnt vmcnt(0)
    v_perm_b32 v56, v49, v48, s38
    v_perm_b32 v60, v49, v48, s39
    v_perm_b32 v57, v51, v50, s38
    v_perm_b32 v61, v51, v50, s39
    v_perm_b32 v58, v53, v52, s38
    v_perm_b32 v62, v53, v52, s39
    v_perm_b32 v59, v55, v54, s38
    v_perm_b32 v63, v55, v54, s39
    global_store_dwordx4 v46, v[56:59], s[14:15]
    global_store_dwordx4 v46, v[60:63], s[14:15] offset:1024
ka_pf1:
    s_cmp_ge_u32 s18, 5
    s_cbranch_scc1 ka_end
    s_waitcnt vmcnt(0)
    buffer_load_dword v42, v40, s[24:27], s30 offen
    s_cmp_ge_u32 s18, 0
    s_cbranch_scc1 ka_end
    s_add_u32 s30, s30, 81920
    buffer_load_dword v43, v40, s[24:27], s30 offen
    s_endpgm
ka_extra:
    s_cmp_lg_u32 s2, 125
    s_cbranch_scc1 ka_end
    s_cmp_ge_u32 s18, 5
    s_cbranch_scc1 ka_end
    s_load_dwordx4 s[36:39], s[0:1], 40
    s_lshl_b32 s34, s18, 11
    s_add_u32 s34, s34, 11665408
    v_lshl_add_u32 v46, v1, 4, s34
    s_cmp_eq_u32 s18, 5
    s_cbranch_scc1 ka_dum
    s_cmp_eq_u32 s18, 4
    s_cbranch_scc1 ka_cg
    v_lshrrev_b32 v44, 5, v1
    v_lshlrev_b32 v44, 12, v44
    v_and_b32 v45, 31, v1
    v_lshl_add_u32 v44, v45, 1, v44
    v_lshl_add_u32 v44, s18, 7, v44
    s_waitcnt lgkmcnt(0)
    global_load_ushort v48, v44, s[38:39] offset:0
    global_load_ushort v49, v44, s[38:39] offset:512
    global_load_ushort v50, v44, s[38:39] offset:1024
    global_load_ushort v51, v44, s[38:39] offset:1536
    global_load_ushort v52, v44, s[38:39] offset:2048
    global_load_ushort v53, v44, s[38:39] offset:2560
    global_load_ushort v54, v44, s[38:39] offset:3072
    global_load_ushort v55, v44, s[38:39] offset:3584
    global_load_ushort v56, v44, s[38:39] offset:64
    global_load_ushort v57, v44, s[38:39] offset:576
    global_load_ushort v58, v44, s[38:39] offset:1088
    global_load_ushort v59, v44, s[38:39] offset:1600
    global_load_ushort v60, v44, s[38:39] offset:2112
    global_load_ushort v61, v44, s[38:39] offset:2624
    global_load_ushort v62, v44, s[38:39] offset:3136
    global_load_ushort v63, v44, s[38:39] offset:3648
    s_branch ka_pk
ka_cg:
    v_and_b32 v44, 3, v1
    v_lshlrev_b32 v44, 1, v44
    s_waitcnt lgkmcnt(0)
    global_load_ushort v48, v44, s[36:37] offset:0
    global_load_ushort v49, v44, s[36:37] offset:8
    global_load_ushort v50, v44, s[36:37] offset:16
    global_load_ushort v51, v44, s[36:37] offset:24
    global_load_ushort v52, v44, s[36:37] offset:32
    global_load_ushort v53, v44, s[36:37] offset:40
    global_load_ushort v54, v44, s[36:37] offset:48
    global_load_ushort v55, v44, s[36:37] offset:56
    global_load_ushort v56, v44, s[36:37] offset:64
    global_load_ushort v57, v44, s[36:37] offset:72
    global_load_ushort v58, v44, s[36:37] offset:80
    global_load_ushort v59, v44, s[36:37] offset:88
    global_load_ushort v60, v44, s[36:37] offset:96
    global_load_ushort v61, v44, s[36:37] offset:104
    global_load_ushort v62, v44, s[36:37] offset:112
    global_load_ushort v63, v44, s[36:37] offset:120
ka_pk:
    s_waitcnt vmcnt(0)
    v_lshl_or_b32 v64, v49, 16, v48
    v_lshl_or_b32 v65, v51, 16, v50
    v_lshl_or_b32 v66, v53, 16, v52
    v_lshl_or_b32 v67, v55, 16, v54
    v_lshl_or_b32 v68, v57, 16, v56
    v_lshl_or_b32 v69, v59, 16, v58
    v_lshl_or_b32 v70, v61, 16, v60
    v_lshl_or_b32 v71, v63, 16, v62
    global_store_dwordx4 v46, v[64:67], s[14:15]
    global_store_dwordx4 v46, v[68:71], s[14:15] offset:1024
    s_endpgm
ka_dum:
    v_mov_b32 v46, 11677696
    v_mov_b32 v48, 0
    v_mov_b32 v49, 0
    v_mov_b32 v50, 0
    v_mov_b32 v51, 0
    v_mov_b32 v52, 0x3fff
    v_mov_b32 v53, 186843136
    s_mov_b64 exec, 1
    s_waitcnt lgkmcnt(0)
    global_store_dwordx4 v46, v[48:51], s[14:15]
    global_store_dwordx4 v46, v[48:51], s[14:15] offset:16
    global_store_dwordx4 v46, v[50:53], s[14:15] offset:32
ka_end:
    s_endpgm
.globl main_kernel
.p2align 8
.type main_kernel,@function
main_kernel:
    s_cmp_ge_u32 s2, 256
    s_cbranch_scc1 mn_end
    s_load_dwordx2 s[54:55], s[0:1], 80
    s_load_dwordx2 s[50:51], s[0:1], 0
    v_lshrrev_b32 v56, 6, v0
    s_and_b32 s48, s2, 7
    v_readfirstlane_b32 s16, v56
    s_lshr_b32 s47, s2, 3
    s_lshl_b32 s25, s48, 5
    s_add_u32 s25, s25, s47
    s_lshl_b32 s49, s25, 13
    s_add_u32 s49, s49, 8388608
    s_lshl_b32 s25, s25, 9
    s_add_u32 s25, s25, 10485760
    s_mov_b32 s10, 12582912
    s_mov_b32 s11, 0x20000
    s_and_b32 s17, s16, 3
    s_movk_i32 s20, 20
    s_mov_b32 s24, 0
    s_cmp_ge_u32 s16, 8
    s_cbranch_scc1 gm_main
    v_lshrrev_b32 v56, 6, v0
    v_lshlrev_b32 v55, 1, v0
    v_and_b32 v55, 0x78, v55
    v_or_b32 v55, v55, v56
    v_cmp_gt_u32 vcc, 125, v55
    v_mul_u32_u24 v46, 61440, v55
    v_bfrev_b32 v56, 2
    v_lshlrev_b32 v55, 4, v0
    v_and_b32 v57, 0x1fc, v0
    v_cndmask_b32 v55, v56, v55, vcc
    v_cndmask_b32 v57, v56, v57, vcc
    v_and_b32 v51, 63, v0
    v_lshlrev_b32 v56, 3, v51
    s_lshl_b32 s52, s17, 11
    s_add_u32 s52, s52, 11665408
    s_mov_b32 s53, 11673600
    v_lshlrev_b32 v52, 4, v51
    s_waitcnt lgkmcnt(0)
    s_mov_b32 s8, s54
    s_and_b32 s9, s55, 0xffff
    buffer_load_dwordx4 v[20:23], v55, s[8:11], s49 offen
    buffer_load_dword v58, v57, s[8:11], s25 offen
    buffer_load_dwordx2 v[44:45], v56, s[8:11], s25 offen
    s_barrier
    buffer_load_dwordx4 v[68:71], v52, s[8:11], s52 offen
    buffer_load_dwordx4 v[72:75], v52, s[8:11], s52 offen offset:1024
    buffer_load_dwordx4 v[76:79], v52, s[8:11], s53 offen
    buffer_load_dwordx4 v[80:83], v52, s[8:11], s53 offen offset:1024
    v_mov_b32 v24, 0
    s_lshr_b32 s18, s16, 2
    s_lshl_b32 s53, s17, 7
    s_add_u32 s4, s50, s53
    s_addc_u32 s5, s51, 0
    s_and_b32 s5, s5, 0xffff
    s_or_b32 s5, s5, 0x08000000
    s_movk_i32 s6, 10000
    s_mov_b32 s7, 0x20000
    s_mul_i32 s40, s16, 15360
    s_add_u32 s40, s40, 40960
    v_lshl_add_u32 v87, v51, 3, s40
    s_add_u32 s40, s40, 9216
    s_add_u32 s41, s40, 1024
    s_add_u32 s42, s40, 2048
    s_add_u32 s43, s40, 3072
    s_add_u32 s44, s40, 4096
    s_add_u32 s45, s40, 5120
    v_and_b32 v55, 3, v0
    v_bfe_u32 v56, v0, 2, 2
    v_bfe_u32 v57, v0, 4, 1
    v_bfe_u32 v53, v0, 5, 1
    v_lshlrev_b32 v1, 3, v55
    v_lshl_add_u32 v1, v57, 5, v1
    v_lshl_add_u32 v1, v56, 6, v1
    v_lshl_add_u32 v1, v53, 8, v1
    v_add_u32 v1, s40, v1
    v_lshlrev_b32 v5, 4, v55
    v_lshl_add_u32 v5, v57, 6, v5
    v_lshl_add_u32 v5, v56, 9, v5
    v_mov_b32 v7, v5
    v_bfe_u32 v55, v0, 2, 1
    v_lshlrev_b32 v86, 4, v53
    v_lshl_or_b32 v86, v55, 18, v86
    v_mov_b32 v48, 1
    v_lshlrev_b32 v47, 2, v51
    v_bfe_u32 v2, v0, 5, 1
    v_bfe_u32 v3, v0, 3, 2
    v_and_b32 v35, 3, v0
    v_lshl_add_u32 v3, v3, 2, v35
    v_mul_u32_u24 v49, 20, v2
    v_lshrrev_b32 v18, 2, v51
    v_lshl_add_u32 v18, v35, 4, v18
    v_mov_b32 v50, 1327103
    s_lshl_b32 s52, s16, 3
    s_bfm_b64 s[36:37], s52, 0
    s_andn2_b32 s39, s37, 2155905024
    s_mov_b32 s38, s36
    v_mov_b64 v[88:89], 0
    v_mov_b64 v[90:91], 0
    v_mov_b64 v[92:93], 0
    v_mov_b64 v[94:95], 0
    v_mov_b64 v[96:97], 0
    v_mov_b64 v[98:99], 0
    v_mov_b64 v[100:101], 0
    v_mov_b64 v[102:103], 0
    v_mov_b64 v[104:105], 0
    v_mov_b64 v[106:107], 0
    v_mov_b64 v[108:109], 0
    v_mov_b64 v[110:111], 0
    v_mov_b64 v[112:113], 0
    v_mov_b64 v[114:115], 0
    v_mov_b64 v[116:117], 0
    v_mov_b64 v[118:119], 0
    v_mov_b64 v[120:121], 0
    v_mov_b64 v[122:123], 0
    v_mov_b64 v[124:125], 0
    v_mov_b64 v[126:127], 0
    v_mov_b64 v[128:129], 0
    v_mov_b64 v[130:131], 0
    v_mov_b64 v[132:133], 0
    v_mov_b64 v[134:135], 0
    v_mov_b64 v[136:137], 0
    v_mov_b64 v[138:139], 0
    v_mov_b64 v[140:141], 0
    v_mov_b64 v[142:143], 0
    v_mov_b64 v[144:145], 0
    v_mov_b64 v[146:147], 0
    v_mov_b64 v[148:149], 0
    v_mov_b64 v[150:151], 0
    v_mov_b64 v[152:153], 0
    v_mov_b64 v[154:155], 0
    v_mov_b64 v[156:157], 0
    v_mov_b64 v[158:159], 0
    v_mov_b64 v[160:161], 0
    v_mov_b64 v[162:163], 0
    v_mov_b64 v[164:165], 0
    v_mov_b64 v[166:167], 0
    s_mov_b32 s52, 0x110000
    s_waitcnt vmcnt(4)
    v_cmp_le_u32 vcc, s52, v58
    s_cbranch_vccnz mn_w5
mn_count:
    v_cmpx_gt_i32 vcc, 0, v20
    s_cbranch_execz mn_cn_done
    v_lshrrev_b32 v25, 23, v20
    v_and_b32 v25, 0xfc, v25
    ds_add_rtn_u32 v30, v25, v48
    v_cmpx_gt_i32 vcc, 0, v21
    s_cbranch_execz mn_cn_done
    v_lshrrev_b32 v26, 23, v21
    v_and_b32 v26, 0xfc, v26
    ds_add_rtn_u32 v31, v26, v48
    v_cmpx_gt_i32 vcc, 0, v22
    s_cbranch_execz mn_cn_done
    v_lshrrev_b32 v27, 23, v22
    v_and_b32 v27, 0xfc, v27
    ds_add_rtn_u32 v32, v27, v48
    v_cmpx_gt_i32 vcc, 0, v23
    s_cbranch_execz mn_cn_done
    v_lshrrev_b32 v28, 23, v23
    v_and_b32 v28, 0xfc, v28
    ds_add_rtn_u32 v33, v28, v48
    v_cmpx_gt_i32 vcc, 0, v24
    s_cbranch_execz mn_cn_done
    v_lshrrev_b32 v29, 23, v24
    v_and_b32 v29, 0xfc, v29
    ds_add_rtn_u32 v34, v29, v48
mn_cn_done:
    s_mov_b64 exec, -1
    v_lshrrev_b32 v42, 16, v58
    v_subrev_u32 v42, s24, v42
    v_med3_i32 v42, v42, 0, s20
    v_lshrrev_b32 v55, 16, v44
    v_subrev_u32 v55, s24, v55
    v_med3_i32 v55, v55, 0, s20
    v_lshrrev_b32 v56, 16, v45
    v_subrev_u32 v56, s24, v56
    v_med3_i32 v56, v56, 0, s20
    v_mov_b32 v43, v42
    v_cndmask_b32 v55, 0, v55, s[36:37]
    v_cndmask_b32 v56, 0, v56, s[38:39]
    v_add_u32 v59, v55, v56
    v_mov_b32 v52, 0
    s_lshl_b32 s52, s18, 5
    s_add_u32 s53, s52, 31
    s_waitcnt lgkmcnt(0)
    s_barrier
    ds_read_b32 v53, v47 offset:0
    ds_read_b32 v52, v52 offset:272
    v_add_u32_dpp v59, v59, v59 row_shr:1 row_mask:0xf bank_mask:0xf
    s_nop 1
    v_add_u32_dpp v59, v59, v59 row_shr:2 row_mask:0xf bank_mask:0xf
    s_nop 1
    v_add_u32_dpp v59, v59, v59 row_shr:4 row_mask:0xf bank_mask:0xf
    v_add_u32_dpp v43, v43, v43 row_shr:4 row_mask:0xf bank_mask:0xf
    s_nop 0
    v_add_u32_dpp v59, v59, v59 row_shr:8 row_mask:0xf bank_mask:0xf
    v_add_u32_dpp v43, v43, v43 row_shr:8 row_mask:0xf bank_mask:0xf
    s_nop 0
    v_add_u32_dpp v59, v59, v59 row_bcast:15 row_mask:0xa bank_mask:0xf
    v_add_u32_dpp v43, v43, v43 row_bcast:15 row_mask:0xa bank_mask:0xf
    s_nop 0
    v_add_u32_dpp v59, v59, v59 row_bcast:31 row_mask:0xc bank_mask:0xf
    v_add_u32_dpp v43, v43, v43 row_bcast:31 row_mask:0xc bank_mask:0xf
    s_nop 0
    v_readlane_b32 s49, v59, 63
    v_sub_u32 v41, v43, v42
    s_movk_i32 s48, 0x3fff
    s_waitcnt lgkmcnt(1)
    v_mov_b32 v54, v53
    v_sub_u32 v53, v49, v53
    v_add3_u32 v41, v41, v35, s49
    v_add_u32_dpp v54, v54, v54 row_shr:1 row_mask:0xf bank_mask:0xf
    v_mul_u32_u24 v41, 196608, v41
    v_add_u32 v41, 15466496, v41
    v_add_u32_dpp v54, v54, v54 row_shr:2 row_mask:0xf bank_mask:0xf
    v_and_or_b32 v36, v20, s48, v41
    v_add_u32 v41, 786432, v41
    v_add_u32_dpp v54, v54, v54 row_shr:4 row_mask:0xf bank_mask:0xf
    v_and_or_b32 v37, v21, s48, v41
    v_add_u32 v41, 786432, v41
    v_add_u32_dpp v54, v54, v54 row_shr:8 row_mask:0xf bank_mask:0xf
    v_and_or_b32 v38, v22, s48, v41
    v_add_u32 v41, 786432, v41
    v_add_u32_dpp v54, v54, v54 row_bcast:15 row_mask:0xa bank_mask:0xf
    v_and_or_b32 v39, v23, s48, v41
    v_add_u32 v41, 786432, v41
    v_add_u32_dpp v54, v54, v54 row_bcast:31 row_mask:0xc bank_mask:0xf
    v_add_u32 v53, v53, v54
    v_add_u32 v54, v54, v49
    ds_bpermute_b32 v25, v25, v53
    ds_bpermute_b32 v26, v26, v53
    ds_bpermute_b32 v27, v27, v53
    ds_bpermute_b32 v28, v28, v53
    ds_bpermute_b32 v29, v29, v53
    v_and_or_b32 v40, v24, s48, v41
    v_readlane_b32 s23, v54, 63
    v_readlane_b32 s33, v54, s53
    v_readlane_b32 s32, v53, s52
    s_cmp_gt_u32 s23, 794
    s_cbranch_scc1 mn_ovf
    v_add_lshl_u32 v55, s33, v51, 2
    s_mov_b32 exec_lo, 1048575
    s_mov_b32 exec_hi, 0
    ds_write_b32 v55, v50 offset:512
    s_mov_b64 exec, -1
    v_add_lshl_u32 v2, s32, v2, 2
    v_add_lshl_u32 v3, s32, v3, 2
    v_add_lshl_u32 v18, s32, v18, 2
    s_waitcnt lgkmcnt(1)
    v_readfirstlane_b32 s21, v52
    v_cmpx_gt_i32 vcc, 0, v20
    s_cbranch_execz mn_w2_done
    v_add_lshl_u32 v25, v25, v30, 2
    ds_write_b32 v25, v36 offset:512
    v_cmpx_gt_i32 vcc, 0, v21
    s_cbranch_execz mn_w2_done
    v_add_lshl_u32 v26, v26, v31, 2
    ds_write_b32 v26, v37 offset:512
    v_cmpx_gt_i32 vcc, 0, v22
    s_cbranch_execz mn_w2_done
    v_add_lshl_u32 v27, v27, v32, 2
    ds_write_b32 v27, v38 offset:512
    v_cmpx_gt_i32 vcc, 0, v23
    s_cbranch_execz mn_w2_done
    v_add_lshl_u32 v28, v28, v33, 2
    ds_write_b32 v28, v39 offset:512
    v_cmpx_gt_i32 vcc, 0, v24
    s_cbranch_execz mn_w2_done
    v_add_lshl_u32 v29, v29, v34, 2
    ds_write_b32 v29, v40 offset:512
mn_w2_done:
    s_mov_b64 exec, -1
    s_mov_b32 m0, s40
    s_sub_u32 s32, s32, 3
    s_sub_u32 s59, s33, s32
    s_lshr_b32 s59, s59, 2
    s_waitcnt lgkmcnt(0)
    s_barrier
    ds_read_u16 v4, v2 offset:512
    ds_read_u16 v6, v2 offset:520
    ds_read_u16 v8, v18 offset:514
    ds_read_u16 v84, v3 offset:514
    ds_read_u16 v22, v2 offset:528
    ds_read_u16 v23, v2 offset:536
    ds_read_u16 v24, v2 offset:544
    ds_read_u16 v25, v2 offset:552
    ds_read_u16 v26, v2 offset:560
    ds_read_u16 v27, v2 offset:568
    s_sub_u32 s53, s53, 4
    v_readlane_b32 s84, v54, s53
    s_add_u32 s53, s53, 1
    v_readlane_b32 s85, v54, s53
    s_add_u32 s53, s53, 1
    v_readlane_b32 s86, v54, s53
    s_add_u32 s53, s53, 1
    v_readlane_b32 s87, v54, s53
    s_waitcnt lgkmcnt(8)
    buffer_load_dwordx4 v[4:5], s[4:7], 0 idxen offen lds
    s_mov_b32 m0, s41
    s_waitcnt lgkmcnt(6)
    buffer_load_dwordx4 v[6:7], s[4:7], 0 idxen offen lds
    v_lshlrev_b32 v8, 4, v8
    v_lshl_add_u32 v84, v84, 4, v86
    v_xor_b32 v85, 0x40000, v84
    s_waitcnt lgkmcnt(0)
    s_mov_b32 m0, s42
    v_mov_b32 v4, v22
    buffer_load_dwordx4 v[4:5], s[4:7], 0 idxen offen lds
    s_mov_b32 m0, s43
    v_mov_b32 v4, v23
    buffer_load_dwordx4 v[4:5], s[4:7], 0 idxen offen lds
    s_setprio 3
    s_waitcnt vmcnt(4) lgkmcnt(0)
    s_barrier
    ds_read_b128 v[8:11], v8 offset:32
    ds_read_b128 v[60:63], v84
    ds_read_b128 v[64:67], v85
    s_mov_b32 m0, s44
    v_mov_b32 v4, v24
    buffer_load_dwordx4 v[4:5], s[4:7], 0 idxen offen lds
    s_mov_b32 m0, s45
    v_mov_b32 v4, v25
    buffer_load_dwordx4 v[4:5], s[4:7], 0 idxen offen lds
    v_mov_b32 v4, v26
    v_mov_b32 v6, v27
    s_waitcnt vmcnt(4)
    ds_read_b64_tr_b16 v[20:21], v1 offset:0
    ds_read_b64_tr_b16 v[22:23], v1 offset:512
    ds_read_b64_tr_b16 v[24:25], v1 offset:1024
    ds_read_b64_tr_b16 v[26:27], v1 offset:1536
    s_waitcnt lgkmcnt(6)
    v_mfma_f32_4x4x4_16b_bf16 v[28:31], v[8:9], v[76:77], 0
    v_mfma_f32_4x4x4_16b_bf16 v[32:35], v[8:9], v[78:79], 0
    v_mfma_f32_4x4x4_16b_bf16 v[36:39], v[8:9], v[80:81], 0
    v_mfma_f32_4x4x4_16b_bf16 v[40:43], v[8:9], v[82:83], 0
    v_min_u32 v0, 1, v51
    v_lshlrev_b32 v0, 18, v0
    v_lshl_add_u32 v0, s17, 2, v0
    s_lshl_b32 s52, s18, 1
    s_sub_i32 s52, 1, s52
    s_mul_i32 s53, s52, s59
    s_add_i32 s53, s53, 2
    v_mov_b32 v19, s53
    v_and_b32 v11, 0xff, v11
    v_or_b32 v11, 0xc000, v11
    v_lshlrev_b32 v10, 16, v11
    s_waitcnt lgkmcnt(4)
    v_mfma_f32_32x32x16_bf16 v[44:59], v[60:63], v[68:71], 0
    v_mfma_f32_32x32x16_bf16 v[44:59], v[64:67], v[72:75], v[44:59]
    s_mov_b32 m0, s40
    s_waitcnt lgkmcnt(0)
    buffer_load_dwordx4 v[4:5], s[4:7], 0 idxen offen lds
    s_mov_b32 m0, s41
    ds_add_u32 v0, v19 offset:288
    buffer_load_dwordx4 v[6:7], s[4:7], 0 idxen offen lds
    v_or_b32_dpp v19, v10, v11 row_shl:4 row_mask:0xf bank_mask:0xf bound_ctrl:0
    v_cvt_pk_bf16_f32 v12, v28, v32
    v_cvt_pk_bf16_f32 v14, v29, v33
    v_cvt_pk_bf16_f32 v16, v30, v34
    v_cvt_pk_bf16_f32 v13, v36, v40
    v_cvt_pk_bf16_f32 v15, v37, v41
    v_cvt_pk_bf16_f32 v17, v38, v42
    s_sub_u32 s84, s84, s32
    s_lshr_b32 s84, s84, 2
    s_sub_u32 s85, s85, s32
    s_lshr_b32 s85, s85, 2
    s_sub_u32 s86, s86, s32
    s_lshr_b32 s86, s86, 2
    s_sub_u32 s87, s87, s32
    s_lshr_b32 s87, s87, 2
    s_sub_u32 s88, s59, s87
    s_sub_u32 s87, s87, s86
    s_sub_u32 s86, s86, s85
    s_sub_u32 s85, s85, s84
    s_cmp_lg_u32 s21, 0
    s_cselect_b32 s19, s59, s84
    s_mov_b32 s58, 0
    s_mov_b32 s35, 0
    s_mov_b64 s[46:47], -1
    s_sub_i32 s34, s59, 4
    s_max_i32 s34, s34, 0
    s_mul_i32 s30, s52, -4
    s_lshl_b32 s26, s18, 31
    s_set_gpr_idx_on s40, gpr_idx(SRC2,DST)
    s_sub_u32 s19, s19, 1
    s_cbranch_scc1 mn_st12
mn_st12_back:
mn_loop:
    v_mfma_f32_4x4x4_16b_bf16 v[28:31], v[12:13], v[20:21], 0 cbsz:4 abid:0
    v_mfma_f32_4x4x4_16b_bf16 v[32:35], v[12:13], v[22:23], 0 cbsz:4 abid:1
    v_mfma_f32_4x4x4_16b_bf16 v[36:39], v[12:13], v[24:25], 0 cbsz:4 abid:2
    v_mfma_f32_4x4x4_16b_bf16 v[40:43], v[12:13], v[26:27], 0 cbsz:4 abid:3
    ds_read_u16 v4, v2 offset:576
    ds_read_u16 v6, v2 offset:584
    v_readlane_b32 s28, v19, 0
    v_readlane_b32 s29, v19, 8
    s_waitcnt vmcnt(5)
    ds_read_b64_tr_b16 v[20:21], v1 offset:2048
    ds_read_b64_tr_b16 v[22:23], v1 offset:2560
    s_waitcnt vmcnt(4)
    ds_read_b64_tr_b16 v[24:25], v1 offset:3072
    ds_read_b64_tr_b16 v[26:27], v1 offset:3584
    s_sub_u32 s34, s34, 1
    s_cmov_b32 s35, 0x30000
    s_mov_b32 m0, s28
    v_fmac_f32 v88, v28, v44
    v_fmac_f32 v89, v29, v44
    v_fmac_f32 v90, v30, v44
    v_fmac_f32 v91, v31, v44
    s_lshr_b32 m0, s28, 16
    v_fmac_f32 v88, v32, v45
    v_fmac_f32 v89, v33, v45
    v_fmac_f32 v90, v34, v45
    v_fmac_f32 v91, v35, v45
    s_mov_b32 m0, s29
    v_fmac_f32 v88, v36, v46
    v_fmac_f32 v89, v37, v46
    v_fmac_f32 v90, v38, v46
    v_fmac_f32 v91, v39, v46
    s_lshr_b32 m0, s29, 16
    v_fmac_f32 v88, v40, v47
    v_fmac_f32 v89, v41, v47
    v_fmac_f32 v90, v42, v47
    v_fmac_f32 v91, v43, v47
    s_or_b32 m0, s42, s35
    s_waitcnt lgkmcnt(2)
    buffer_load_dwordx4 v[4:5], s[4:7], 0 idxen offen lds
    s_or_b32 m0, s43, s35
    s_waitcnt lgkmcnt(0)
    buffer_load_dwordx4 v[6:7], s[4:7], 0 idxen offen lds
    s_sub_u32 s19, s19, 1
    s_cbranch_scc1 mn_st0
mn_st0_back:
    v_mfma_f32_4x4x4_16b_bf16 v[28:31], v[12:13], v[20:21], 0 cbsz:4 abid:4
    v_mfma_f32_4x4x4_16b_bf16 v[32:35], v[12:13], v[22:23], 0 cbsz:4 abid:5
    v_mfma_f32_4x4x4_16b_bf16 v[36:39], v[12:13], v[24:25], 0 cbsz:4 abid:6
    v_mfma_f32_4x4x4_16b_bf16 v[40:43], v[12:13], v[26:27], 0 cbsz:4 abid:7
    ds_read_u16 v4, v2 offset:592
    ds_read_u16 v6, v2 offset:600
    v_readlane_b32 s28, v19, 16
    v_readlane_b32 s29, v19, 24
    ds_read_u16 v84, v3 offset:578
    s_waitcnt vmcnt(5)
    ds_read_b64_tr_b16 v[20:21], v1 offset:4096
    ds_read_b64_tr_b16 v[22:23], v1 offset:4608
    s_waitcnt vmcnt(4)
    ds_read_b64_tr_b16 v[24:25], v1 offset:5120
    ds_read_b64_tr_b16 v[26:27], v1 offset:5632
    s_sub_u32 s34, s34, 1
    s_cmov_b32 s35, 0x30000
    s_mov_b32 m0, s28
    v_fmac_f32 v88, v28, v48
    v_fmac_f32 v89, v29, v48
    v_fmac_f32 v90, v30, v48
    v_fmac_f32 v91, v31, v48
    s_lshr_b32 m0, s28, 16
    v_fmac_f32 v88, v32, v49
    v_fmac_f32 v89, v33, v49
    v_fmac_f32 v90, v34, v49
    v_fmac_f32 v91, v35, v49
    s_mov_b32 m0, s29
    v_fmac_f32 v88, v36, v50
    v_fmac_f32 v89, v37, v50
    v_fmac_f32 v90, v38, v50
    v_fmac_f32 v91, v39, v50
    s_lshr_b32 m0, s29, 16
    v_fmac_f32 v88, v40, v51
    v_fmac_f32 v89, v41, v51
    v_fmac_f32 v90, v42, v51
    v_fmac_f32 v91, v43, v51
    s_or_b32 m0, s44, s35
    s_waitcnt lgkmcnt(2)
    buffer_load_dwordx4 v[4:5], s[4:7], 0 idxen offen lds
    s_or_b32 m0, s45, s35
    s_waitcnt lgkmcnt(0)
    buffer_load_dwordx4 v[6:7], s[4:7], 0 idxen offen lds
    s_sub_u32 s19, s19, 1
    s_cbranch_scc1 mn_st1
mn_st1_back:
    v_mfma_f32_4x4x4_16b_bf16 v[28:31], v[12:13], v[20:21], 0 cbsz:4 abid:8
    v_mfma_f32_4x4x4_16b_bf16 v[32:35], v[12:13], v[22:23], 0 cbsz:4 abid:9
    v_mfma_f32_4x4x4_16b_bf16 v[36:39], v[12:13], v[24:25], 0 cbsz:4 abid:10
    v_mfma_f32_4x4x4_16b_bf16 v[40:43], v[12:13], v[26:27], 0 cbsz:4 abid:11
    ds_read_u16 v4, v2 offset:608
    ds_read_u16 v6, v2 offset:616
    v_readlane_b32 s28, v19, 32
    v_readlane_b32 s29, v19, 40
    v_lshl_add_u32 v84, v84, 4, v86
    v_xor_b32 v85, 0x40000, v84
    ds_read_b128 v[60:63], v84
    ds_read_b128 v[64:67], v85
    s_waitcnt vmcnt(5)
    ds_read_b64_tr_b16 v[20:21], v1 offset:0
    ds_read_b64_tr_b16 v[22:23], v1 offset:512
    s_waitcnt vmcnt(4)
    ds_read_b64_tr_b16 v[24:25], v1 offset:1024
    ds_read_b64_tr_b16 v[26:27], v1 offset:1536
    s_sub_u32 s34, s34, 1
    s_cmov_b32 s35, 0x30000
    s_mov_b32 m0, s28
    v_fmac_f32 v88, v28, v52
    v_fmac_f32 v89, v29, v52
    v_fmac_f32 v90, v30, v52
    v_fmac_f32 v91, v31, v52
    s_lshr_b32 m0, s28, 16
    v_fmac_f32 v88, v32, v53
    v_fmac_f32 v89, v33, v53
    v_fmac_f32 v90, v34, v53
    v_fmac_f32 v91, v35, v53
    s_mov_b32 m0, s29
    v_fmac_f32 v88, v36, v54
    v_fmac_f32 v89, v37, v54
    v_fmac_f32 v90, v38, v54
    v_fmac_f32 v91, v39, v54
    s_lshr_b32 m0, s29, 16
    v_fmac_f32 v88, v40, v55
    v_fmac_f32 v89, v41, v55
    v_fmac_f32 v90, v42, v55
    v_fmac_f32 v91, v43, v55
    s_or_b32 m0, s40, s35
    s_waitcnt lgkmcnt(2)
    buffer_load_dwordx4 v[4:5], s[4:7], 0 idxen offen lds
    s_or_b32 m0, s41, s35
    s_waitcnt lgkmcnt(0)
    buffer_load_dwordx4 v[6:7], s[4:7], 0 idxen offen lds
    s_sub_u32 s19, s19, 1
    s_cbranch_scc1 mn_st2
mn_st2_back:
    v_mfma_f32_4x4x4_16b_bf16 v[28:31], v[12:13], v[20:21], 0 cbsz:4 abid:12
    v_mfma_f32_4x4x4_16b_bf16 v[32:35], v[12:13], v[22:23], 0 cbsz:4 abid:13
    v_mfma_f32_4x4x4_16b_bf16 v[36:39], v[12:13], v[24:25], 0 cbsz:4 abid:14
    v_mfma_f32_4x4x4_16b_bf16 v[40:43], v[12:13], v[26:27], 0 cbsz:4 abid:15
    ds_read_u16 v4, v2 offset:624
    ds_read_u16 v6, v2 offset:632
    v_readlane_b32 s28, v19, 48
    v_readlane_b32 s29, v19, 56
    v_mov_b32 v85, s30
    ds_add_rtn_u32 v85, v0, v85 offset:288
    s_waitcnt vmcnt(5)
    ds_read_b64_tr_b16 v[20:21], v1 offset:2048
    ds_read_b64_tr_b16 v[22:23], v1 offset:2560
    s_waitcnt vmcnt(4)
    ds_read_b64_tr_b16 v[24:25], v1 offset:3072
    ds_read_b64_tr_b16 v[26:27], v1 offset:3584
    s_sub_u32 s34, s34, 1
    s_cmov_b32 s35, 0x30000
    s_mov_b32 m0, s28
    v_fmac_f32 v88, v28, v56
    v_fmac_f32 v89, v29, v56
    v_fmac_f32 v90, v30, v56
    v_fmac_f32 v91, v31, v56
    s_lshr_b32 m0, s28, 16
    v_fmac_f32 v88, v32, v57
    v_fmac_f32 v89, v33, v57
    v_fmac_f32 v90, v34, v57
    v_fmac_f32 v91, v35, v57
    s_mov_b32 m0, s29
    v_fmac_f32 v88, v36, v58
    v_fmac_f32 v89, v37, v58
    v_fmac_f32 v90, v38, v58
    v_fmac_f32 v91, v39, v58
    s_lshr_b32 m0, s29, 16
    v_fmac_f32 v88, v40, v59
    v_fmac_f32 v89, v41, v59
    v_fmac_f32 v90, v42, v59
    v_fmac_f32 v91, v43, v59
    s_or_b32 m0, s42, s35
    v_mfma_f32_32x32x16_bf16 v[44:59], v[60:63], v[68:71], 0
    v_mfma_f32_32x32x16_bf16 v[44:59], v[64:67], v[72:75], v[44:59]
    s_waitcnt lgkmcnt(2)
    buffer_load_dwordx4 v[4:5], s[4:7], 0 idxen offen lds
    s_or_b32 m0, s43, s35
    s_waitcnt lgkmcnt(0)
    buffer_load_dwordx4 v[6:7], s[4:7], 0 idxen offen lds
    v_readfirstlane_b32 s27, v85
    s_setprio 3
    s_xor_b32 s27, s27, s26
    s_cmp_ge_i32 s27, 0
    s_cbranch_scc1 mn_pr3
    s_setprio 2
mn_pr3:
    s_sub_u32 s19, s19, 1
    s_cbranch_scc1 mn_st3
mn_st3_back:
    v_mfma_f32_4x4x4_16b_bf16 v[28:31], v[14:15], v[20:21], 0 cbsz:4 abid:0
    v_mfma_f32_4x4x4_16b_bf16 v[32:35], v[14:15], v[22:23], 0 cbsz:4 abid:1
    v_mfma_f32_4x4x4_16b_bf16 v[36:39], v[14:15], v[24:25], 0 cbsz:4 abid:2
    v_mfma_f32_4x4x4_16b_bf16 v[40:43], v[14:15], v[26:27], 0 cbsz:4 abid:3
    ds_read_u16 v4, v2 offset:640
    ds_read_u16 v6, v2 offset:648
    v_readlane_b32 s28, v19, 1
    v_readlane_b32 s29, v19, 9
    s_waitcnt vmcnt(5)
    ds_read_b64_tr_b16 v[20:21], v1 offset:4096
    ds_read_b64_tr_b16 v[22:23], v1 offset:4608
    s_waitcnt vmcnt(4)
    ds_read_b64_tr_b16 v[24:25], v1 offset:5120
    ds_read_b64_tr_b16 v[26:27], v1 offset:5632
    s_sub_u32 s34, s34, 1
    s_cmov_b32 s35, 0x30000
    s_mov_b32 m0, s28
    v_fmac_f32 v88, v28, v44
    v_fmac_f32 v89, v29, v44
    v_fmac_f32 v90, v30, v44
    v_fmac_f32 v91, v31, v44
    s_lshr_b32 m0, s28, 16
    v_fmac_f32 v88, v32, v45
    v_fmac_f32 v89, v33, v45
    v_fmac_f32 v90, v34, v45
    v_fmac_f32 v91, v35, v45
    s_mov_b32 m0, s29
    v_fmac_f32 v88, v36, v46
    v_fmac_f32 v89, v37, v46
    v_fmac_f32 v90, v38, v46
    v_fmac_f32 v91, v39, v46
    s_lshr_b32 m0, s29, 16
    v_fmac_f32 v88, v40, v47
    v_fmac_f32 v89, v41, v47
    v_fmac_f32 v90, v42, v47
    v_fmac_f32 v91, v43, v47
    s_or_b32 m0, s44, s35
    s_waitcnt lgkmcnt(2)
    buffer_load_dwordx4 v[4:5], s[4:7], 0 idxen offen lds
    s_or_b32 m0, s45, s35
    s_waitcnt lgkmcnt(0)
    buffer_load_dwordx4 v[6:7], s[4:7], 0 idxen offen lds
    s_sub_u32 s19, s19, 1
    s_cbranch_scc1 mn_st4
mn_st4_back:
    v_mfma_f32_4x4x4_16b_bf16 v[28:31], v[14:15], v[20:21], 0 cbsz:4 abid:4
    v_mfma_f32_4x4x4_16b_bf16 v[32:35], v[14:15], v[22:23], 0 cbsz:4 abid:5
    v_mfma_f32_4x4x4_16b_bf16 v[36:39], v[14:15], v[24:25], 0 cbsz:4 abid:6
    v_mfma_f32_4x4x4_16b_bf16 v[40:43], v[14:15], v[26:27], 0 cbsz:4 abid:7
    ds_read_u16 v4, v2 offset:656
    ds_read_u16 v6, v2 offset:664
    v_readlane_b32 s28, v19, 17
    v_readlane_b32 s29, v19, 25
    ds_read_u16 v84, v3 offset:642
    s_waitcnt vmcnt(5)
    ds_read_b64_tr_b16 v[20:21], v1 offset:0
    ds_read_b64_tr_b16 v[22:23], v1 offset:512
    s_waitcnt vmcnt(4)
    ds_read_b64_tr_b16 v[24:25], v1 offset:1024
    ds_read_b64_tr_b16 v[26:27], v1 offset:1536
    s_sub_u32 s34, s34, 1
    s_cmov_b32 s35, 0x30000
    s_mov_b32 m0, s28
    v_fmac_f32 v88, v28, v48
    v_fmac_f32 v89, v29, v48
    v_fmac_f32 v90, v30, v48
    v_fmac_f32 v91, v31, v48
    s_lshr_b32 m0, s28, 16
    v_fmac_f32 v88, v32, v49
    v_fmac_f32 v89, v33, v49
    v_fmac_f32 v90, v34, v49
    v_fmac_f32 v91, v35, v49
    s_mov_b32 m0, s29
    v_fmac_f32 v88, v36, v50
    v_fmac_f32 v89, v37, v50
    v_fmac_f32 v90, v38, v50
    v_fmac_f32 v91, v39, v50
    s_lshr_b32 m0, s29, 16
    v_fmac_f32 v88, v40, v51
    v_fmac_f32 v89, v41, v51
    v_fmac_f32 v90, v42, v51
    v_fmac_f32 v91, v43, v51
    s_or_b32 m0, s40, s35
    s_waitcnt lgkmcnt(2)
    buffer_load_dwordx4 v[4:5], s[4:7], 0 idxen offen lds
    s_or_b32 m0, s41, s35
    s_waitcnt lgkmcnt(0)
    buffer_load_dwordx4 v[6:7], s[4:7], 0 idxen offen lds
    s_sub_u32 s19, s19, 1
    s_cbranch_scc1 mn_st5
mn_st5_back:
    v_mfma_f32_4x4x4_16b_bf16 v[28:31], v[14:15], v[20:21], 0 cbsz:4 abid:8
    v_mfma_f32_4x4x4_16b_bf16 v[32:35], v[14:15], v[22:23], 0 cbsz:4 abid:9
    v_mfma_f32_4x4x4_16b_bf16 v[36:39], v[14:15], v[24:25], 0 cbsz:4 abid:10
    v_mfma_f32_4x4x4_16b_bf16 v[40:43], v[14:15], v[26:27], 0 cbsz:4 abid:11
    ds_read_u16 v4, v2 offset:672
    ds_read_u16 v6, v2 offset:680
    v_readlane_b32 s28, v19, 33
    v_readlane_b32 s29, v19, 41
    v_lshl_add_u32 v84, v84, 4, v86
    v_xor_b32 v85, 0x40000, v84
    ds_read_b128 v[60:63], v84
    ds_read_b128 v[64:67], v85
    s_waitcnt vmcnt(5)
    ds_read_b64_tr_b16 v[20:21], v1 offset:2048
    ds_read_b64_tr_b16 v[22:23], v1 offset:2560
    s_waitcnt vmcnt(4)
    ds_read_b64_tr_b16 v[24:25], v1 offset:3072
    ds_read_b64_tr_b16 v[26:27], v1 offset:3584
    s_sub_u32 s34, s34, 1
    s_cmov_b32 s35, 0x30000
    s_mov_b32 m0, s28
    v_fmac_f32 v88, v28, v52
    v_fmac_f32 v89, v29, v52
    v_fmac_f32 v90, v30, v52
    v_fmac_f32 v91, v31, v52
    s_lshr_b32 m0, s28, 16
    v_fmac_f32 v88, v32, v53
    v_fmac_f32 v89, v33, v53
    v_fmac_f32 v90, v34, v53
    v_fmac_f32 v91, v35, v53
    s_mov_b32 m0, s29
    v_fmac_f32 v88, v36, v54
    v_fmac_f32 v89, v37, v54
    v_fmac_f32 v90, v38, v54
    v_fmac_f32 v91, v39, v54
    s_lshr_b32 m0, s29, 16
    v_fmac_f32 v88, v40, v55
    v_fmac_f32 v89, v41, v55
    v_fmac_f32 v90, v42, v55
    v_fmac_f32 v91, v43, v55
    s_or_b32 m0, s42, s35
    s_waitcnt lgkmcnt(2)
    buffer_load_dwordx4 v[4:5], s[4:7], 0 idxen offen lds
    s_or_b32 m0, s43, s35
    s_waitcnt lgkmcnt(0)
    buffer_load_dwordx4 v[6:7], s[4:7], 0 idxen offen lds
    s_sub_u32 s19, s19, 1
    s_cbranch_scc1 mn_st6
mn_st6_back:
    v_mfma_f32_4x4x4_16b_bf16 v[28:31], v[14:15], v[20:21], 0 cbsz:4 abid:12
    v_mfma_f32_4x4x4_16b_bf16 v[32:35], v[14:15], v[22:23], 0 cbsz:4 abid:13
    v_mfma_f32_4x4x4_16b_bf16 v[36:39], v[14:15], v[24:25], 0 cbsz:4 abid:14
    v_mfma_f32_4x4x4_16b_bf16 v[40:43], v[14:15], v[26:27], 0 cbsz:4 abid:15
    ds_read_u16 v4, v2 offset:688
    ds_read_u16 v6, v2 offset:696
    v_readlane_b32 s28, v19, 49
    v_readlane_b32 s29, v19, 57
    v_mov_b32 v85, s30
    ds_add_rtn_u32 v85, v0, v85 offset:288
    s_waitcnt vmcnt(5)
    ds_read_b64_tr_b16 v[20:21], v1 offset:4096
    ds_read_b64_tr_b16 v[22:23], v1 offset:4608
    s_waitcnt vmcnt(4)
    ds_read_b64_tr_b16 v[24:25], v1 offset:5120
    ds_read_b64_tr_b16 v[26:27], v1 offset:5632
    s_sub_u32 s34, s34, 1
    s_cmov_b32 s35, 0x30000
    s_mov_b32 m0, s28
    v_fmac_f32 v88, v28, v56
    v_fmac_f32 v89, v29, v56
    v_fmac_f32 v90, v30, v56
    v_fmac_f32 v91, v31, v56
    s_lshr_b32 m0, s28, 16
    v_fmac_f32 v88, v32, v57
    v_fmac_f32 v89, v33, v57
    v_fmac_f32 v90, v34, v57
    v_fmac_f32 v91, v35, v57
    s_mov_b32 m0, s29
    v_fmac_f32 v88, v36, v58
    v_fmac_f32 v89, v37, v58
    v_fmac_f32 v90, v38, v58
    v_fmac_f32 v91, v39, v58
    s_lshr_b32 m0, s29, 16
    v_fmac_f32 v88, v40, v59
    v_fmac_f32 v89, v41, v59
    v_fmac_f32 v90, v42, v59
    v_fmac_f32 v91, v43, v59
    s_or_b32 m0, s44, s35
    v_mfma_f32_32x32x16_bf16 v[44:59], v[60:63], v[68:71], 0
    v_mfma_f32_32x32x16_bf16 v[44:59], v[64:67], v[72:75], v[44:59]
    s_waitcnt lgkmcnt(2)
    buffer_load_dwordx4 v[4:5], s[4:7], 0 idxen offen lds
    s_or_b32 m0, s45, s35
    s_waitcnt lgkmcnt(0)
    buffer_load_dwordx4 v[6:7], s[4:7], 0 idxen offen lds
    v_readfirstlane_b32 s27, v85
    s_setprio 3
    s_xor_b32 s27, s27, s26
    s_cmp_ge_i32 s27, 0
    s_cbranch_scc1 mn_pr7
    s_setprio 2
mn_pr7:
    s_sub_u32 s19, s19, 1
    s_cbranch_scc1 mn_st7
mn_st7_back:
    v_mfma_f32_4x4x4_16b_bf16 v[28:31], v[16:17], v[20:21], 0 cbsz:4 abid:0
    v_mfma_f32_4x4x4_16b_bf16 v[32:35], v[16:17], v[22:23], 0 cbsz:4 abid:1
    v_mfma_f32_4x4x4_16b_bf16 v[36:39], v[16:17], v[24:25], 0 cbsz:4 abid:2
    v_mfma_f32_4x4x4_16b_bf16 v[40:43], v[16:17], v[26:27], 0 cbsz:4 abid:3
    ds_read_u16 v4, v2 offset:704
    ds_read_u16 v6, v2 offset:712
    v_readlane_b32 s28, v19, 2
    v_readlane_b32 s29, v19, 10
    ds_read_u16 v8, v18 offset:706
    s_waitcnt vmcnt(5)
    ds_read_b64_tr_b16 v[20:21], v1 offset:0
    ds_read_b64_tr_b16 v[22:23], v1 offset:512
    s_waitcnt vmcnt(4)
    ds_read_b64_tr_b16 v[24:25], v1 offset:1024
    ds_read_b64_tr_b16 v[26:27], v1 offset:1536
    s_sub_u32 s34, s34, 1
    s_cmov_b32 s35, 0x30000
    s_mov_b32 m0, s28
    v_fmac_f32 v88, v28, v44
    v_fmac_f32 v89, v29, v44
    v_fmac_f32 v90, v30, v44
    v_fmac_f32 v91, v31, v44
    s_lshr_b32 m0, s28, 16
    v_fmac_f32 v88, v32, v45
    v_fmac_f32 v89, v33, v45
    v_fmac_f32 v90, v34, v45
    v_fmac_f32 v91, v35, v45
    s_mov_b32 m0, s29
    v_fmac_f32 v88, v36, v46
    v_fmac_f32 v89, v37, v46
    v_fmac_f32 v90, v38, v46
    v_fmac_f32 v91, v39, v46
    s_lshr_b32 m0, s29, 16
    v_fmac_f32 v88, v40, v47
    v_fmac_f32 v89, v41, v47
    v_fmac_f32 v90, v42, v47
    v_fmac_f32 v91, v43, v47
    s_or_b32 m0, s40, s35
    s_waitcnt lgkmcnt(2)
    buffer_load_dwordx4 v[4:5], s[4:7], 0 idxen offen lds
    s_or_b32 m0, s41, s35
    s_waitcnt lgkmcnt(0)
    buffer_load_dwordx4 v[6:7], s[4:7], 0 idxen offen lds
    s_sub_u32 s19, s19, 1
    s_cbranch_scc1 mn_st8
mn_st8_back:
    v_mfma_f32_4x4x4_16b_bf16 v[28:31], v[16:17], v[20:21], 0 cbsz:4 abid:4
    v_mfma_f32_4x4x4_16b_bf16 v[32:35], v[16:17], v[22:23], 0 cbsz:4 abid:5
    v_mfma_f32_4x4x4_16b_bf16 v[36:39], v[16:17], v[24:25], 0 cbsz:4 abid:6
    v_mfma_f32_4x4x4_16b_bf16 v[40:43], v[16:17], v[26:27], 0 cbsz:4 abid:7
    ds_read_u16 v4, v2 offset:720
    ds_read_u16 v6, v2 offset:728
    v_readlane_b32 s28, v19, 18
    v_readlane_b32 s29, v19, 26
    ds_read_u16 v84, v3 offset:706
    v_lshlrev_b32 v8, 4, v8
    ds_read_b128 v[8:11], v8 offset:32
    s_waitcnt vmcnt(5)
    ds_read_b64_tr_b16 v[20:21], v1 offset:2048
    ds_read_b64_tr_b16 v[22:23], v1 offset:2560
    s_waitcnt vmcnt(4)
    ds_read_b64_tr_b16 v[24:25], v1 offset:3072
    ds_read_b64_tr_b16 v[26:27], v1 offset:3584
    s_sub_u32 s34, s34, 1
    s_cmov_b32 s35, 0x30000
    s_mov_b32 m0, s28
    v_fmac_f32 v88, v28, v48
    v_fmac_f32 v89, v29, v48
    v_fmac_f32 v90, v30, v48
    v_fmac_f32 v91, v31, v48
    s_lshr_b32 m0, s28, 16
    v_fmac_f32 v88, v32, v49
    v_fmac_f32 v89, v33, v49
    v_fmac_f32 v90, v34, v49
    v_fmac_f32 v91, v35, v49
    s_mov_b32 m0, s29
    v_fmac_f32 v88, v36, v50
    v_fmac_f32 v89, v37, v50
    v_fmac_f32 v90, v38, v50
    v_fmac_f32 v91, v39, v50
    s_lshr_b32 m0, s29, 16
    v_fmac_f32 v88, v40, v51
    v_fmac_f32 v89, v41, v51
    v_fmac_f32 v90, v42, v51
    v_fmac_f32 v91, v43, v51
    s_or_b32 m0, s42, s35
    s_waitcnt lgkmcnt(2)
    buffer_load_dwordx4 v[4:5], s[4:7], 0 idxen offen lds
    s_or_b32 m0, s43, s35
    s_waitcnt lgkmcnt(0)
    buffer_load_dwordx4 v[6:7], s[4:7], 0 idxen offen lds
    s_sub_u32 s19, s19, 1
    s_cbranch_scc1 mn_st9
mn_st9_back:
    v_mfma_f32_4x4x4_16b_bf16 v[28:31], v[16:17], v[20:21], 0 cbsz:4 abid:8
    v_mfma_f32_4x4x4_16b_bf16 v[32:35], v[16:17], v[22:23], 0 cbsz:4 abid:9
    v_mfma_f32_4x4x4_16b_bf16 v[36:39], v[16:17], v[24:25], 0 cbsz:4 abid:10
    v_mfma_f32_4x4x4_16b_bf16 v[40:43], v[16:17], v[26:27], 0 cbsz:4 abid:11
    ds_read_u16 v4, v2 offset:736
    ds_read_u16 v6, v2 offset:744
    v_readlane_b32 s28, v19, 34
    v_readlane_b32 s29, v19, 42
    v_lshl_add_u32 v84, v84, 4, v86
    v_xor_b32 v85, 0x40000, v84
    ds_read_b128 v[60:63], v84
    ds_read_b128 v[64:67], v85
    s_waitcnt vmcnt(5)
    ds_read_b64_tr_b16 v[20:21], v1 offset:4096
    ds_read_b64_tr_b16 v[22:23], v1 offset:4608
    s_waitcnt vmcnt(4)
    ds_read_b64_tr_b16 v[24:25], v1 offset:5120
    ds_read_b64_tr_b16 v[26:27], v1 offset:5632
    s_sub_u32 s34, s34, 1
    s_cmov_b32 s35, 0x30000
    s_mov_b32 m0, s28
    v_fmac_f32 v88, v28, v52
    v_fmac_f32 v89, v29, v52
    v_fmac_f32 v90, v30, v52
    v_fmac_f32 v91, v31, v52
    s_lshr_b32 m0, s28, 16
    v_fmac_f32 v88, v32, v53
    v_fmac_f32 v89, v33, v53
    v_fmac_f32 v90, v34, v53
    v_fmac_f32 v91, v35, v53
    s_mov_b32 m0, s29
    v_fmac_f32 v88, v36, v54
    v_fmac_f32 v89, v37, v54
    v_fmac_f32 v90, v38, v54
    v_fmac_f32 v91, v39, v54
    s_lshr_b32 m0, s29, 16
    v_fmac_f32 v88, v40, v55
    v_fmac_f32 v89, v41, v55
    v_fmac_f32 v90, v42, v55
    v_fmac_f32 v91, v43, v55
    s_or_b32 m0, s44, s35
    s_waitcnt lgkmcnt(2)
    buffer_load_dwordx4 v[4:5], s[4:7], 0 idxen offen lds
    s_or_b32 m0, s45, s35
    s_waitcnt lgkmcnt(0)
    buffer_load_dwordx4 v[6:7], s[4:7], 0 idxen offen lds
    v_and_b32 v11, 0xff, v11
    v_or_b32 v11, 0xc000, v11
    v_lshlrev_b32 v10, 16, v11
    s_sub_u32 s19, s19, 1
    s_cbranch_scc1 mn_st10
mn_st10_back:
    v_mfma_f32_4x4x4_16b_bf16 v[28:31], v[16:17], v[20:21], 0 cbsz:4 abid:12
    v_mfma_f32_4x4x4_16b_bf16 v[32:35], v[16:17], v[22:23], 0 cbsz:4 abid:13
    v_mfma_f32_4x4x4_16b_bf16 v[36:39], v[16:17], v[24:25], 0 cbsz:4 abid:14
    v_mfma_f32_4x4x4_16b_bf16 v[40:43], v[16:17], v[26:27], 0 cbsz:4 abid:15
    ds_read_u16 v4, v2 offset:752
    ds_read_u16 v6, v2 offset:760
    v_readlane_b32 s28, v19, 50
    v_readlane_b32 s29, v19, 58
    v_mov_b32 v85, s30
    ds_add_rtn_u32 v85, v0, v85 offset:288
    s_waitcnt vmcnt(5)
    ds_read_b64_tr_b16 v[20:21], v1 offset:0
    ds_read_b64_tr_b16 v[22:23], v1 offset:512
    s_waitcnt vmcnt(4)
    ds_read_b64_tr_b16 v[24:25], v1 offset:1024
    ds_read_b64_tr_b16 v[26:27], v1 offset:1536
    s_sub_u32 s34, s34, 1
    s_cmov_b32 s35, 0x30000
    s_mov_b32 m0, s28
    v_fmac_f32 v88, v28, v56
    v_fmac_f32 v89, v29, v56
    v_fmac_f32 v90, v30, v56
    v_fmac_f32 v91, v31, v56
    s_lshr_b32 m0, s28, 16
    v_fmac_f32 v88, v32, v57
    v_fmac_f32 v89, v33, v57
    v_fmac_f32 v90, v34, v57
    v_fmac_f32 v91, v35, v57
    s_mov_b32 m0, s29
    v_fmac_f32 v88, v36, v58
    v_fmac_f32 v89, v37, v58
    v_fmac_f32 v90, v38, v58
    v_fmac_f32 v91, v39, v58
    s_lshr_b32 m0, s29, 16
    v_fmac_f32 v88, v40, v59
    v_fmac_f32 v89, v41, v59
    v_fmac_f32 v90, v42, v59
    v_fmac_f32 v91, v43, v59
    s_or_b32 m0, s40, s35
    v_mfma_f32_4x4x4_16b_bf16 v[28:31], v[8:9], v[76:77], 0
    v_mfma_f32_4x4x4_16b_bf16 v[32:35], v[8:9], v[78:79], 0
    v_mfma_f32_4x4x4_16b_bf16 v[36:39], v[8:9], v[80:81], 0
    v_mfma_f32_4x4x4_16b_bf16 v[40:43], v[8:9], v[82:83], 0
    v_mfma_f32_32x32x16_bf16 v[44:59], v[60:63], v[68:71], 0
    v_mfma_f32_32x32x16_bf16 v[44:59], v[64:67], v[72:75], v[44:59]
    s_waitcnt lgkmcnt(2)
    buffer_load_dwordx4 v[4:5], s[4:7], 0 idxen offen lds
    s_or_b32 m0, s41, s35
    s_waitcnt lgkmcnt(0)
    buffer_load_dwordx4 v[6:7], s[4:7], 0 idxen offen lds
    v_cvt_pk_bf16_f32 v12, v28, v32
    v_cvt_pk_bf16_f32 v14, v29, v33
    v_cvt_pk_bf16_f32 v16, v30, v34
    v_cvt_pk_bf16_f32 v13, v36, v40
    v_cvt_pk_bf16_f32 v15, v37, v41
    v_cvt_pk_bf16_f32 v17, v38, v42
    v_or_b32_dpp v19, v10, v11 row_shl:4 row_mask:0xf bank_mask:0xf bound_ctrl:0
    v_add_u32 v2, 192, v2
    v_add_u32 v3, 192, v3
    v_add_u32 v18, 192, v18
    v_readfirstlane_b32 s27, v85
    s_setprio 3
    s_xor_b32 s27, s27, s26
    s_cmp_ge_i32 s27, 0
    s_cbranch_scc1 mn_pr11
    s_setprio 2
mn_pr11:
    s_sub_u32 s19, s19, 1
    s_cbranch_scc1 mn_st11
mn_st11_back:
    s_branch mn_loop
mn_st0:
    s_cmp_lg_u32 s21, 0
    s_cbranch_scc1 mn_next
    s_call_b64 s[48:49], mn_flush
    s_branch mn_st0_back
mn_st1:
    s_cmp_lg_u32 s21, 0
    s_cbranch_scc1 mn_next
    s_call_b64 s[48:49], mn_flush
    s_branch mn_st1_back
mn_st2:
    s_cmp_lg_u32 s21, 0
    s_cbranch_scc1 mn_next
    s_call_b64 s[48:49], mn_flush
    s_branch mn_st2_back
mn_st3:
    s_cmp_lg_u32 s21, 0
    s_cbranch_scc1 mn_next
    s_call_b64 s[48:49], mn_flush
    s_branch mn_st3_back
mn_st4:
    s_cmp_lg_u32 s21, 0
    s_cbranch_scc1 mn_next
    s_call_b64 s[48:49], mn_flush
    s_branch mn_st4_back
mn_st5:
    s_cmp_lg_u32 s21, 0
    s_cbranch_scc1 mn_next
    s_call_b64 s[48:49], mn_flush
    s_branch mn_st5_back
mn_st6:
    s_cmp_lg_u32 s21, 0
    s_cbranch_scc1 mn_next
    s_call_b64 s[48:49], mn_flush
    s_branch mn_st6_back
mn_st7:
    s_cmp_lg_u32 s21, 0
    s_cbranch_scc1 mn_next
    s_call_b64 s[48:49], mn_flush
    s_branch mn_st7_back
mn_st8:
    s_cmp_lg_u32 s21, 0
    s_cbranch_scc1 mn_next
    s_call_b64 s[48:49], mn_flush
    s_branch mn_st8_back
mn_st9:
    s_cmp_lg_u32 s21, 0
    s_cbranch_scc1 mn_next
    s_call_b64 s[48:49], mn_flush
    s_branch mn_st9_back
mn_st10:
    s_cmp_lg_u32 s21, 0
    s_cbranch_scc1 mn_next
    s_call_b64 s[48:49], mn_flush
    s_branch mn_st10_back
mn_st11:
    s_cmp_lg_u32 s21, 0
    s_cbranch_scc1 mn_next
    s_call_b64 s[48:49], mn_flush
    s_branch mn_st11_back
mn_st12:
    s_cmp_lg_u32 s21, 0
    s_cbranch_scc1 mn_next
    s_call_b64 s[48:49], mn_flush
    s_branch mn_st12_back
mn_flush:
    s_cmp_eq_u32 s58, 4
    s_cbranch_scc1 mn_fl4
    s_cmp_eq_u32 s58, 3
    s_cbranch_scc1 mn_fl3
    s_cmp_eq_u32 s58, 2
    s_cbranch_scc1 mn_fl2
    s_cmp_eq_u32 s58, 1
    s_cbranch_scc1 mn_fl1
mn_fl0:
    v_cvt_pk_bf16_f32 v88, v88, v89
    v_cvt_pk_bf16_f32 v89, v90, v91
    ds_write_b64 v87, v[88:89] offset:0
    v_cvt_pk_bf16_f32 v92, v92, v93
    v_cvt_pk_bf16_f32 v93, v94, v95
    ds_write_b64 v87, v[92:93] offset:576
    v_cvt_pk_bf16_f32 v96, v96, v97
    v_cvt_pk_bf16_f32 v97, v98, v99
    ds_write_b64 v87, v[96:97] offset:1152
    v_cvt_pk_bf16_f32 v100, v100, v101
    v_cvt_pk_bf16_f32 v101, v102, v103
    ds_write_b64 v87, v[100:101] offset:1728
    s_mul_i32 s52, s18, 3
    s_lshl_b32 s52, 1, s52
    v_mov_b32 v90, s52
    v_mov_b32 v91, 0
    s_mov_b64 exec, 1
    ds_add_u32 v91, v90 offset:276
    s_mov_b64 exec, -1
    s_add_u32 s58, s58, 1
    s_sub_u32 s19, s85, 1
    s_cbranch_scc1 mn_fl1
    s_setpc_b64 s[48:49]
mn_fl1:
    v_cvt_pk_bf16_f32 v104, v104, v105
    v_cvt_pk_bf16_f32 v105, v106, v107
    ds_write_b64 v87, v[104:105] offset:2304
    v_cvt_pk_bf16_f32 v108, v108, v109
    v_cvt_pk_bf16_f32 v109, v110, v111
    ds_write_b64 v87, v[108:109] offset:2880
    v_cvt_pk_bf16_f32 v112, v112, v113
    v_cvt_pk_bf16_f32 v113, v114, v115
    ds_write_b64 v87, v[112:113] offset:3456
    v_cvt_pk_bf16_f32 v116, v116, v117
    v_cvt_pk_bf16_f32 v117, v118, v119
    ds_write_b64 v87, v[116:117] offset:4032
    s_mul_i32 s52, s18, 3
    s_lshl_b32 s52, 64, s52
    v_mov_b32 v106, s52
    v_mov_b32 v107, 0
    s_mov_b64 exec, 1
    ds_add_u32 v107, v106 offset:276
    s_mov_b64 exec, -1
    s_add_u32 s58, s58, 1
    s_sub_u32 s19, s86, 1
    s_cbranch_scc1 mn_fl2
    s_setpc_b64 s[48:49]
mn_fl2:
    v_cvt_pk_bf16_f32 v120, v120, v121
    v_cvt_pk_bf16_f32 v121, v122, v123
    ds_write_b64 v87, v[120:121] offset:4608
    v_cvt_pk_bf16_f32 v124, v124, v125
    v_cvt_pk_bf16_f32 v125, v126, v127
    ds_write_b64 v87, v[124:125] offset:5184
    v_cvt_pk_bf16_f32 v128, v128, v129
    v_cvt_pk_bf16_f32 v129, v130, v131
    ds_write_b64 v87, v[128:129] offset:5760
    v_cvt_pk_bf16_f32 v132, v132, v133
    v_cvt_pk_bf16_f32 v133, v134, v135
    ds_write_b64 v87, v[132:133] offset:6336
    s_mul_i32 s52, s18, 3
    s_lshl_b32 s52, 4096, s52
    v_mov_b32 v122, s52
    v_mov_b32 v123, 0
    s_mov_b64 exec, 1
    ds_add_u32 v123, v122 offset:276
    s_mov_b64 exec, -1
    s_add_u32 s58, s58, 1
    s_sub_u32 s19, s87, 1
    s_cbranch_scc1 mn_fl3
    s_setpc_b64 s[48:49]
mn_fl3:
    v_cvt_pk_bf16_f32 v136, v136, v137
    v_cvt_pk_bf16_f32 v137, v138, v139
    ds_write_b64 v87, v[136:137] offset:6912
    v_cvt_pk_bf16_f32 v140, v140, v141
    v_cvt_pk_bf16_f32 v141, v142, v143
    ds_write_b64 v87, v[140:141] offset:7488
    v_cvt_pk_bf16_f32 v144, v144, v145
    v_cvt_pk_bf16_f32 v145, v146, v147
    ds_write_b64 v87, v[144:145] offset:8064
    v_cvt_pk_bf16_f32 v148, v148, v149
    v_cvt_pk_bf16_f32 v149, v150, v151
    ds_write_b64 v87, v[148:149] offset:8640
    s_mul_i32 s52, s18, 3
    s_lshl_b32 s52, 262144, s52
    v_mov_b32 v138, s52
    v_mov_b32 v139, 0
    s_mov_b64 exec, 1
    ds_add_u32 v139, v138 offset:276
    s_mov_b64 exec, -1
    s_add_u32 s58, s58, 1
    s_sub_u32 s19, s88, 1
    s_cbranch_scc1 mn_fl4
    s_setpc_b64 s[48:49]
mn_fl4:
    s_cmp_ge_u32 s59, 4
    s_cbranch_scc1 mn_fl4b
    s_waitcnt vmcnt(0)
mn_fl4b:
    v_cvt_pk_bf16_f32 v152, v152, v153
    v_cvt_pk_bf16_f32 v153, v154, v155
    ds_write_b64 v87, v[152:153] offset:9216
    v_cvt_pk_bf16_f32 v156, v156, v157
    v_cvt_pk_bf16_f32 v157, v158, v159
    ds_write_b64 v87, v[156:157] offset:9792
    v_cvt_pk_bf16_f32 v160, v160, v161
    v_cvt_pk_bf16_f32 v161, v162, v163
    ds_write_b64 v87, v[160:161] offset:10368
    v_cvt_pk_bf16_f32 v164, v164, v165
    v_cvt_pk_bf16_f32 v165, v166, v167
    ds_write_b64 v87, v[164:165] offset:10944
    s_mul_i32 s52, s18, 3
    s_lshl_b32 s52, 16777216, s52
    v_mov_b32 v154, s52
    v_mov_b32 v155, 0
    s_mov_b64 exec, 1
    ds_add_u32 v155, v154 offset:276
    s_mov_b64 exec, -1
    s_waitcnt vmcnt(0) lgkmcnt(0)
mn_end:
    s_endpgm
gm_main:
    s_load_dwordx2 s[56:57], s[0:1], 64
    v_and_b32 v3, 63, v0
    v_and_b32 v11, 0x7f, v0
    v_lshlrev_b32 v11, 2, v11
    v_mov_b32 v10, 0
    ds_write_b32 v11, v10
    v_bfe_u32 v12, v0, 1, 7
    v_and_b32 v11, 15, v12
    v_lshrrev_b32 v10, 4, v12
    v_lshl_or_b32 v11, v11, 3, v10
    v_cmp_gt_u32 vcc, 125, v11
    v_mul_u32_u24 v13, 61440, v11
    v_bfrev_b32 v10, 2
    v_lshlrev_b32 v12, 2, v12
    v_cndmask_b32 v12, v10, v12, vcc
    v_lshlrev_b32 v11, 3, v3
    v_lshlrev_b32 v2, 4, v3
    s_lshl_b32 s40, s17, 15
    s_add_u32 s40, s40, 11534336
    s_waitcnt lgkmcnt(0)
    s_mov_b32 s8, s54
    s_and_b32 s9, s55, 0xffff
    buffer_load_dword v4, v12, s[8:11], s25 offen
    buffer_load_dwordx2 v[6:7], v11, s[8:11], s25 offen
    s_barrier
    s_lshl2_add_u32 s47, s47, s17
    s_mul_i32 s47, s47, 61440
    s_mul_i32 s48, s48, 7680
    s_add_u32 s47, s47, s48
    s_sub_i32 s47, s47, 256
    s_max_i32 s47, s47, 0
    v_lshlrev_b32 v11, 7, v3
    buffer_load_dword v39, v11, s[8:11], s47 offen
    s_mul_i32 s41, s2, 625
    s_add_u32 s52, s41, 640
    s_add_u32 s41, s41, 15
    s_lshr_b32 s41, s41, 4
    s_lshr_b32 s52, s52, 4
    s_mov_b32 s12, s56
    s_and_b32 s13, s57, 0xffff
    s_lshl_b32 s14, s52, 11
    s_mov_b32 s15, 0x20000
    s_mul_i32 s42, s17, 15360
    s_add_u32 s42, s42, 40960
    s_lshl_b32 s43, s17, 4
    s_sub_u32 s43, s43, 1
    s_mov_b32 s44, -1
    s_mov_b32 s45, 2139062271
    v_add_u32 v11, 0, v3
    v_mul_u32_u24 v10, 21846, v11
    v_lshrrev_b32 v10, 16, v10
    v_lshl_add_u32 v34, v10, 2, s42
    v_mad_i32_i24 v10, v10, -3, v11
    v_lshlrev_b32 v30, 4, v10
    v_add_u32 v11, 64, v3
    v_mul_u32_u24 v10, 21846, v11
    v_lshrrev_b32 v10, 16, v10
    v_lshl_add_u32 v35, v10, 2, s42
    v_mad_i32_i24 v10, v10, -3, v11
    v_lshlrev_b32 v31, 4, v10
    v_add_u32 v11, 128, v3
    v_mul_u32_u24 v10, 21846, v11
    v_lshrrev_b32 v10, 16, v10
    v_lshl_add_u32 v36, v10, 2, s42
    v_mad_i32_i24 v10, v10, -3, v11
    v_lshlrev_b32 v32, 4, v10
    s_waitcnt vmcnt(1)
gm_pass:
    v_lshrrev_b32 v8, 16, v4
    v_subrev_u32 v8, s24, v8
    v_med3_i32 v8, v8, 0, s20
    v_lshrrev_b32 v11, 16, v6
    v_subrev_u32 v11, s24, v11
    v_med3_i32 v11, v11, 0, s20
    v_lshrrev_b32 v10, 16, v7
    v_subrev_u32 v10, s24, v10
    v_med3_i32 v10, v10, 0, s20
    v_mov_b32 v9, v8
    v_cndmask_b32 v10, 0, v10, s[44:45]
    v_add_u32 v10, v11, v10
    v_and_b32 v12, 1, v0
    v_and_b32 v14, 0xffff, v4
    v_add_u32_dpp v10, v10, v10 row_shr:1 row_mask:0xf bank_mask:0xf
    s_nop 0
    v_add3_u32 v14, v14, v12, s24
    v_add_u32_dpp v10, v10, v10 row_shr:2 row_mask:0xf bank_mask:0xf
    v_add_u32_dpp v9, v9, v9 row_shr:2 row_mask:0xf bank_mask:0xf
    v_mad_u32_u24 v14, v14, 48, v13
    v_add_u32_dpp v10, v10, v10 row_shr:4 row_mask:0xf bank_mask:0xf
    v_add_u32_dpp v9, v9, v9 row_shr:4 row_mask:0xf bank_mask:0xf
    v_sub_u32 v15, v8, v12
    v_add_u32_dpp v10, v10, v10 row_shr:8 row_mask:0xf bank_mask:0xf
    v_add_u32_dpp v9, v9, v9 row_shr:8 row_mask:0xf bank_mask:0xf
    s_nop 0
    v_add_u32_dpp v10, v10, v10 row_bcast:15 row_mask:0xa bank_mask:0xf
    v_add_u32_dpp v9, v9, v9 row_bcast:15 row_mask:0xa bank_mask:0xf
    s_nop 0
    v_add_u32_dpp v10, v10, v10 row_bcast:31 row_mask:0xc bank_mask:0xf
    v_add_u32_dpp v9, v9, v9 row_bcast:31 row_mask:0xc bank_mask:0xf
    s_nop 0
    v_readlane_b32 s23, v10, 63
    v_readlane_b32 s46, v10, s43
    v_readlane_b32 s47, v9, 63
    v_sub_u32 v16, v9, v15
    v_lshl_add_u32 v16, v16, 2, s42
    s_cmp_gt_u32 s23, 774
    s_cbranch_scc1 gm_ovf
    s_cmp_eq_u32 s17, 0
    s_cmov_b32 s46, 0
    v_cmpx_lt_i32 vcc, 0, v15
    s_cbranch_execz gm_tb_done
    ds_write_b32 v16, v14 offset:0
    v_add_u32 v14, 96, v14
    v_cmpx_lt_i32 vcc, 2, v15
    s_cbranch_execz gm_tb_done
    ds_write_b32 v16, v14 offset:8
    v_add_u32 v14, 96, v14
    v_cmpx_lt_i32 vcc, 4, v15
    s_cbranch_execz gm_tb_done
    ds_write_b32 v16, v14 offset:16
    v_add_u32 v14, 96, v14
    v_cmpx_lt_i32 vcc, 6, v15
    s_cbranch_execz gm_tb_done
    ds_write_b32 v16, v14 offset:24
    v_add_u32 v14, 96, v14
    v_cmpx_lt_i32 vcc, 8, v15
    s_cbranch_execz gm_tb_done
    ds_write_b32 v16, v14 offset:32
    v_add_u32 v14, 96, v14
    v_cmpx_lt_i32 vcc, 10, v15
    s_cbranch_execz gm_tb_done
    ds_write_b32 v16, v14 offset:40
    v_add_u32 v14, 96, v14
    v_cmpx_lt_i32 vcc, 12, v15
    s_cbranch_execz gm_tb_done
    ds_write_b32 v16, v14 offset:48
    v_add_u32 v14, 96, v14
    v_cmpx_lt_i32 vcc, 14, v15
    s_cbranch_execz gm_tb_done
    ds_write_b32 v16, v14 offset:56
    v_add_u32 v14, 96, v14
    v_cmpx_lt_i32 vcc, 16, v15
    s_cbranch_execz gm_tb_done
    ds_write_b32 v16, v14 offset:64
    v_add_u32 v14, 96, v14
    v_cmpx_lt_i32 vcc, 18, v15
    s_cbranch_execz gm_tb_done
    ds_write_b32 v16, v14 offset:72
gm_tb_done:
    s_mov_b64 exec, -1
    s_mul_i32 s46, s46, 48
    s_add_u32 m0, s46, 3776
    s_mul_i32 s47, s47, 3
    s_mov_b32 s48, 1
    v_mov_b32 v11, v34
    v_mov_b32 v10, v35
    v_mov_b32 v14, v36
    s_barrier
gm_raw:
    ds_read_b32 v18, v11 offset:0
    ds_read_b32 v19, v10 offset:0
    ds_read_b32 v20, v14 offset:0
    ds_read_b32 v21, v11 offset:256
    ds_read_b32 v22, v10 offset:256
    ds_read_b32 v23, v14 offset:256
    ds_read_b32 v24, v11 offset:512
    ds_read_b32 v25, v10 offset:512
    ds_read_b32 v26, v14 offset:512
    v_cmpx_gt_i32 vcc, s47, v3
    s_cbranch_execz gm_raw_done
    s_waitcnt lgkmcnt(8)
    v_add_u32 v18, v18, v30
    buffer_load_dwordx4 v18, s[8:11], 0 offen lds
    s_add_u32 m0, m0, 1024
    s_sub_i32 s47, s47, 64
    v_cmpx_gt_i32 vcc, s47, v3
    s_cbranch_execz gm_raw_done
    s_waitcnt lgkmcnt(7)
    v_add_u32 v19, v19, v31
    buffer_load_dwordx4 v19, s[8:11], 0 offen lds
    s_add_u32 m0, m0, 1024
    s_sub_i32 s47, s47, 64
    v_cmpx_gt_i32 vcc, s47, v3
    s_cbranch_execz gm_raw_done
    s_waitcnt lgkmcnt(6)
    v_add_u32 v20, v20, v32
    buffer_load_dwordx4 v20, s[8:11], 0 offen lds
    s_add_u32 m0, m0, 1024
    s_sub_i32 s47, s47, 64
    v_cmpx_gt_i32 vcc, s47, v3
    s_cbranch_execz gm_raw_done
    s_waitcnt lgkmcnt(5)
    v_add_u32 v21, v21, v30
    buffer_load_dwordx4 v21, s[8:11], 0 offen lds
    s_add_u32 m0, m0, 1024
    s_sub_i32 s47, s47, 64
    v_cmpx_gt_i32 vcc, s47, v3
    s_cbranch_execz gm_raw_done
    s_waitcnt lgkmcnt(4)
    v_add_u32 v22, v22, v31
    buffer_load_dwordx4 v22, s[8:11], 0 offen lds
    s_add_u32 m0, m0, 1024
    s_sub_i32 s47, s47, 64
    v_cmpx_gt_i32 vcc, s47, v3
    s_cbranch_execz gm_raw_done
    s_waitcnt lgkmcnt(3)
    v_add_u32 v23, v23, v32
    buffer_load_dwordx4 v23, s[8:11], 0 offen lds
    s_add_u32 m0, m0, 1024
    s_sub_i32 s47, s47, 64
    v_cmpx_gt_i32 vcc, s47, v3
    s_cbranch_execz gm_raw_done
    s_waitcnt lgkmcnt(2)
    v_add_u32 v24, v24, v30
    buffer_load_dwordx4 v24, s[8:11], 0 offen lds
    s_add_u32 m0, m0, 1024
    s_sub_i32 s47, s47, 64
    v_cmpx_gt_i32 vcc, s47, v3
    s_cbranch_execz gm_raw_done
    s_waitcnt lgkmcnt(1)
    v_add_u32 v25, v25, v31
    buffer_load_dwordx4 v25, s[8:11], 0 offen lds
    s_add_u32 m0, m0, 1024
    s_sub_i32 s47, s47, 64
    v_cmpx_gt_i32 vcc, s47, v3
    s_cbranch_execz gm_raw_done
    s_waitcnt lgkmcnt(0)
    v_add_u32 v26, v26, v32
    buffer_load_dwordx4 v26, s[8:11], 0 offen lds
    s_add_u32 m0, m0, 1024
    s_sub_i32 s47, s47, 64
    v_add_u32 v11, 768, v11
    v_add_u32 v10, 768, v10
    v_add_u32 v14, 768, v14
    s_branch gm_raw
gm_raw_done:
    s_mov_b64 exec, -1
    v_mov_b32 v11, 0
    ds_read_b32 v11, v11 offset:272
    s_barrier
    s_waitcnt vmcnt(0) lgkmcnt(0)
    v_readfirstlane_b32 s21, v11
    s_barrier
    s_cmp_lg_u32 s21, 0
    s_cbranch_scc1 gm_next
    s_add_u32 s52, s40, 0
    buffer_load_dwordx4 v[40:43], v2, s[8:11], s52 offen offset:0
    buffer_load_dwordx4 v[44:47], v2, s[8:11], s52 offen offset:1024
    s_waitcnt vmcnt(1)
    buffer_load_dwordx4 v[48:51], v2, s[8:11], s52 offen offset:2048
    s_waitcnt vmcnt(1)
    buffer_load_dwordx4 v[52:55], v2, s[8:11], s52 offen offset:3072
    s_waitcnt vmcnt(1)
    s_add_u32 s52, s40, 4096
    buffer_load_dwordx4 v[56:59], v2, s[8:11], s52 offen offset:0
    s_waitcnt vmcnt(1)
    buffer_load_dwordx4 v[60:63], v2, s[8:11], s52 offen offset:1024
    s_waitcnt vmcnt(1)
    buffer_load_dwordx4 v[64:67], v2, s[8:11], s52 offen offset:2048
    s_waitcnt vmcnt(1)
    buffer_load_dwordx4 v[68:71], v2, s[8:11], s52 offen offset:3072
    s_waitcnt vmcnt(1)
    s_add_u32 s52, s40, 8192
    buffer_load_dwordx4 v[72:75], v2, s[8:11], s52 offen offset:0
    s_waitcnt vmcnt(1)
    buffer_load_dwordx4 v[76:79], v2, s[8:11], s52 offen offset:1024
    s_waitcnt vmcnt(1)
    buffer_load_dwordx4 v[80:83], v2, s[8:11], s52 offen offset:2048
    s_waitcnt vmcnt(1)
    buffer_load_dwordx4 v[84:87], v2, s[8:11], s52 offen offset:3072
    s_waitcnt vmcnt(1)
    s_add_u32 s52, s40, 12288
    buffer_load_dwordx4 v[88:91], v2, s[8:11], s52 offen offset:0
    s_waitcnt vmcnt(1)
    buffer_load_dwordx4 v[92:95], v2, s[8:11], s52 offen offset:1024
    s_waitcnt vmcnt(1)
    buffer_load_dwordx4 v[96:99], v2, s[8:11], s52 offen offset:2048
    s_waitcnt vmcnt(1)
    buffer_load_dwordx4 v[100:103], v2, s[8:11], s52 offen offset:3072
    s_waitcnt vmcnt(1)
    s_add_u32 s52, s40, 16384
    buffer_load_dwordx4 v[104:107], v2, s[8:11], s52 offen offset:0
    s_waitcnt vmcnt(1)
    buffer_load_dwordx4 v[108:111], v2, s[8:11], s52 offen offset:1024
    s_waitcnt vmcnt(1)
    buffer_load_dwordx4 v[112:115], v2, s[8:11], s52 offen offset:2048
    s_waitcnt vmcnt(1)
    buffer_load_dwordx4 v[116:119], v2, s[8:11], s52 offen offset:3072
    s_waitcnt vmcnt(1)
    s_add_u32 s52, s40, 20480
    buffer_load_dwordx4 v[120:123], v2, s[8:11], s52 offen offset:0
    s_waitcnt vmcnt(1)
    buffer_load_dwordx4 v[124:127], v2, s[8:11], s52 offen offset:1024
    s_waitcnt vmcnt(1)
    buffer_load_dwordx4 v[128:131], v2, s[8:11], s52 offen offset:2048
    s_waitcnt vmcnt(1)
    buffer_load_dwordx4 v[132:135], v2, s[8:11], s52 offen offset:3072
    s_waitcnt vmcnt(1)
    s_add_u32 s52, s40, 24576
    buffer_load_dwordx4 v[136:139], v2, s[8:11], s52 offen offset:0
    s_waitcnt vmcnt(1)
    buffer_load_dwordx4 v[140:143], v2, s[8:11], s52 offen offset:1024
    s_waitcnt vmcnt(1)
    buffer_load_dwordx4 v[144:147], v2, s[8:11], s52 offen offset:2048
    s_waitcnt vmcnt(1)
    buffer_load_dwordx4 v[148:151], v2, s[8:11], s52 offen offset:3072
    s_waitcnt vmcnt(1)
    s_add_u32 s52, s40, 28672
    buffer_load_dwordx4 v[152:155], v2, s[8:11], s52 offen offset:0
    s_waitcnt vmcnt(1)
    buffer_load_dwordx4 v[156:159], v2, s[8:11], s52 offen offset:1024
    s_waitcnt vmcnt(1)
    buffer_load_dwordx4 v[160:163], v2, s[8:11], s52 offen offset:2048
    s_waitcnt vmcnt(1)
    buffer_load_dwordx4 v[164:167], v2, s[8:11], s52 offen offset:3072
    s_waitcnt vmcnt(1)
    v_lshrrev_b32 v1, 4, v3
    v_lshlrev_b32 v1, 11, v1
    v_and_b32 v4, 7, v3
    v_lshl_add_u32 v1, v4, 4, v1
    v_bfe_u32 v4, v3, 3, 1
    v_lshl_add_u32 v1, v4, 9, v1
    v_and_b32 v4, 3, v3
    v_lshrrev_b32 v5, 2, v3
    v_mul_u32_u24 v0, 576, v4
    v_lshl_add_u32 v0, v5, 3, v0
    v_add_u32 v0, 40960, v0
    s_lshl_b32 s38, s41, 11
    s_lshl_b32 s53, s17, 7
    s_add_u32 s38, s38, s53
    s_mov_b32 s36, 0x24924924
    s_mov_b32 s39, 0
    s_waitcnt vmcnt(0)
gm_poll:
    v_mov_b32 v2, 0
    ds_read_b32 v2, v2 offset:276
    s_waitcnt lgkmcnt(0)
    v_readfirstlane_b32 s52, v2
    s_and_b32 s52, s52, s36
    s_cbranch_scc1 gm_go
    s_sleep 2
    s_branch gm_poll
gm_go:
    s_ff1_i32_b32 s52, s52
    s_bitset0_b32 s36, s52
    s_mul_i32 s52, s52, 11
    s_bfe_u32 s53, s52, 0x10005
    s_bfe_u32 s52, s52, 0x30006
    s_mul_i32 s35, s53, 61440
    s_mul_i32 s31, s52, 2304
    s_add_u32 s31, s31, s35
    s_sub_u32 s35, s31, s39
    v_add_u32 v0, s35, v0
    ds_read_b64_tr_b16 v[12:13], v0 offset:0
    ds_read_b64_tr_b16 v[14:15], v0 offset:128
    ds_read_b64_tr_b16 v[16:17], v0 offset:256
    ds_read_b64_tr_b16 v[18:19], v0 offset:384
    s_mov_b32 s39, s31
    s_mul_i32 s33, s53, 5
    s_add_u32 s33, s33, s52
    s_lshl_b32 s33, s33, 13
    s_add_u32 s33, s33, s38
    s_mov_b32 s37, s33
    s_mov_b32 s32, 0x7ffffff0
gm_loop:
    s_waitcnt lgkmcnt(2)
    v_mfma_f32_16x16x32_bf16 v[24:27], v[12:15], v[40:43], 0
    v_cvt_pk_bf16_f32 v7, v33, v37
    v_cvt_pk_bf16_f32 v5, v32, v36
    ds_read_b64_tr_b16 v[20:21], v0 offset:15360
    v_mfma_f32_16x16x32_bf16 v[28:31], v[12:15], v[44:47], 0
    v_cvt_pk_bf16_f32 v11, v35, v39
    v_cvt_pk_bf16_f32 v9, v34, v38
    ds_read_b64_tr_b16 v[22:23], v0 offset:15488
    v_mfma_f32_16x16x32_bf16 v[32:35], v[12:15], v[48:51], 0
    v_mov_b32_dpp v2, v6 row_ror:8 row_mask:0xf bank_mask:0xf
    v_mov_b32_dpp v3, v7 row_ror:8 row_mask:0xf bank_mask:0xf
    v_mfma_f32_16x16x32_bf16 v[36:39], v[12:15], v[52:55], 0
    v_mov_b32_dpp v6, v4 row_ror:8 row_mask:0xf bank_mask:0x3
    v_mov_b32_dpp v7, v5 row_ror:8 row_mask:0xf bank_mask:0x3
    s_waitcnt lgkmcnt(2)
    v_mfma_f32_16x16x32_bf16 v[24:27], v[16:19], v[56:59], v[24:27]
    ds_read_b64_tr_b16 v[12:13], v0 offset:15616
    v_mov_b32_dpp v4, v2 quad_perm:[0,1,2,3] row_mask:0xf bank_mask:0xc
    v_mfma_f32_16x16x32_bf16 v[28:31], v[16:19], v[60:63], v[28:31]
    ds_read_b64_tr_b16 v[14:15], v0 offset:15744
    v_mov_b32_dpp v5, v3 quad_perm:[0,1,2,3] row_mask:0xf bank_mask:0xc
    v_mfma_f32_16x16x32_bf16 v[32:35], v[16:19], v[64:67], v[32:35]
    buffer_store_dwordx4 v[4:7], v1, s[12:15], s32 offen offset:0 sc0 sc1
    v_mov_b32_dpp v2, v10 row_ror:8 row_mask:0xf bank_mask:0xf
    v_mfma_f32_16x16x32_bf16 v[36:39], v[16:19], v[68:71], v[36:39]
    v_mov_b32_dpp v3, v11 row_ror:8 row_mask:0xf bank_mask:0xf
    v_mov_b32_dpp v10, v8 row_ror:8 row_mask:0xf bank_mask:0x3
    s_waitcnt lgkmcnt(2)
    v_mfma_f32_16x16x32_bf16 v[24:27], v[20:23], v[72:75], v[24:27]
    ds_read_b64_tr_b16 v[16:17], v0 offset:30720
    v_mov_b32_dpp v11, v9 row_ror:8 row_mask:0xf bank_mask:0x3
    v_mfma_f32_16x16x32_bf16 v[28:31], v[20:23], v[76:79], v[28:31]
    ds_read_b64_tr_b16 v[18:19], v0 offset:30848
    v_mov_b32_dpp v8, v2 quad_perm:[0,1,2,3] row_mask:0xf bank_mask:0xc
    v_mfma_f32_16x16x32_bf16 v[32:35], v[20:23], v[80:83], v[32:35]
    v_mov_b32_dpp v9, v3 quad_perm:[0,1,2,3] row_mask:0xf bank_mask:0xc
    buffer_store_dwordx4 v[8:11], v1, s[12:15], s32 offen offset:1024 sc0 sc1
    v_mfma_f32_16x16x32_bf16 v[36:39], v[20:23], v[84:87], v[36:39]
    s_waitcnt lgkmcnt(2)
    v_mfma_f32_16x16x32_bf16 v[24:27], v[12:15], v[88:91], v[24:27]
    ds_read_b64_tr_b16 v[20:21], v0 offset:30976
    v_mfma_f32_16x16x32_bf16 v[28:31], v[12:15], v[92:95], v[28:31]
    ds_read_b64_tr_b16 v[22:23], v0 offset:31104
    v_mfma_f32_16x16x32_bf16 v[32:35], v[12:15], v[96:99], v[32:35]
    v_mov_b32 v2, 0
    v_mfma_f32_16x16x32_bf16 v[36:39], v[12:15], v[100:103], v[36:39]
    ds_read_b32 v2, v2 offset:276
    s_waitcnt lgkmcnt(3)
    v_mfma_f32_16x16x32_bf16 v[24:27], v[16:19], v[104:107], v[24:27]
    ds_read_b64_tr_b16 v[12:13], v0 offset:46080
    v_mfma_f32_16x16x32_bf16 v[28:31], v[16:19], v[108:111], v[28:31]
    ds_read_b64_tr_b16 v[14:15], v0 offset:46208
    v_mfma_f32_16x16x32_bf16 v[32:35], v[16:19], v[112:115], v[32:35]
    s_waitcnt lgkmcnt(2)
    v_readfirstlane_b32 s52, v2
    s_and_b32 s52, s52, s36
    v_mfma_f32_16x16x32_bf16 v[36:39], v[16:19], v[116:119], v[36:39]
    s_cselect_b32 s34, 1, 0
    s_ff1_i32_b32 s52, s52
    s_waitcnt lgkmcnt(2)
    v_mfma_f32_16x16x32_bf16 v[24:27], v[20:23], v[120:123], v[24:27]
    ds_read_b64_tr_b16 v[16:17], v0 offset:46336
    s_bitset0_b32 s36, s52
    s_mul_i32 s52, s52, 11
    v_mfma_f32_16x16x32_bf16 v[28:31], v[20:23], v[124:127], v[28:31]
    ds_read_b64_tr_b16 v[18:19], v0 offset:46464
    s_bfe_u32 s53, s52, 0x10005
    s_bfe_u32 s52, s52, 0x30006
    v_mfma_f32_16x16x32_bf16 v[32:35], v[20:23], v[128:131], v[32:35]
    s_mul_i32 s35, s53, 61440
    s_mul_i32 s31, s52, 2304
    s_add_u32 s31, s31, s35
    v_mfma_f32_16x16x32_bf16 v[36:39], v[20:23], v[132:135], v[36:39]
    s_sub_u32 s35, s31, s39
    v_add_u32 v0, s35, v0
    s_waitcnt lgkmcnt(2)
    v_mfma_f32_16x16x32_bf16 v[24:27], v[12:15], v[136:139], v[24:27]
    ds_read_b64_tr_b16 v[20:21], v0 offset:0
    v_mfma_f32_16x16x32_bf16 v[28:31], v[12:15], v[140:143], v[28:31]
    ds_read_b64_tr_b16 v[22:23], v0 offset:128
    v_mfma_f32_16x16x32_bf16 v[32:35], v[12:15], v[144:147], v[32:35]
    s_mov_b32 s39, s31
    s_mul_i32 s33, s53, 5
    s_add_u32 s33, s33, s52
    v_mfma_f32_16x16x32_bf16 v[36:39], v[12:15], v[148:151], v[36:39]
    s_lshl_b32 s33, s33, 13
    s_add_u32 s33, s33, s38
    s_waitcnt lgkmcnt(2)
    v_mfma_f32_16x16x32_bf16 v[24:27], v[16:19], v[152:155], v[24:27]
    ds_read_b64_tr_b16 v[12:13], v0 offset:256
    v_mfma_f32_16x16x32_bf16 v[28:31], v[16:19], v[156:159], v[28:31]
    ds_read_b64_tr_b16 v[14:15], v0 offset:384
    s_mov_b32 s32, s37
    s_mov_b32 s37, s33
    v_mfma_f32_16x16x32_bf16 v[32:35], v[16:19], v[160:163], v[32:35]
    s_cmp_eq_u32 s34, 0
    s_nop 1
    v_mfma_f32_16x16x32_bf16 v[36:39], v[16:19], v[164:167], v[36:39]
    v_cvt_pk_bf16_f32 v4, v24, v28
    v_cvt_pk_bf16_f32 v6, v25, v29
    v_cvt_pk_bf16_f32 v8, v26, v30
    v_cvt_pk_bf16_f32 v10, v27, v31
    s_nop 0
    s_cbranch_scc1 gm_drain
    s_waitcnt lgkmcnt(2)
    v_mfma_f32_16x16x32_bf16 v[24:27], v[20:23], v[40:43], 0
    v_cvt_pk_bf16_f32 v7, v33, v37
    v_cvt_pk_bf16_f32 v5, v32, v36
    ds_read_b64_tr_b16 v[16:17], v0 offset:15360
    v_mfma_f32_16x16x32_bf16 v[28:31], v[20:23], v[44:47], 0
    v_cvt_pk_bf16_f32 v11, v35, v39
    v_cvt_pk_bf16_f32 v9, v34, v38
    ds_read_b64_tr_b16 v[18:19], v0 offset:15488
    v_mfma_f32_16x16x32_bf16 v[32:35], v[20:23], v[48:51], 0
    v_mov_b32_dpp v2, v6 row_ror:8 row_mask:0xf bank_mask:0xf
    v_mov_b32_dpp v3, v7 row_ror:8 row_mask:0xf bank_mask:0xf
    v_mfma_f32_16x16x32_bf16 v[36:39], v[20:23], v[52:55], 0
    v_mov_b32_dpp v6, v4 row_ror:8 row_mask:0xf bank_mask:0x3
    v_mov_b32_dpp v7, v5 row_ror:8 row_mask:0xf bank_mask:0x3
    s_waitcnt lgkmcnt(2)
    v_mfma_f32_16x16x32_bf16 v[24:27], v[12:15], v[56:59], v[24:27]
    ds_read_b64_tr_b16 v[20:21], v0 offset:15616
    v_mov_b32_dpp v4, v2 quad_perm:[0,1,2,3] row_mask:0xf bank_mask:0xc
    v_mfma_f32_16x16x32_bf16 v[28:31], v[12:15], v[60:63], v[28:31]
    ds_read_b64_tr_b16 v[22:23], v0 offset:15744
    v_mov_b32_dpp v5, v3 quad_perm:[0,1,2,3] row_mask:0xf bank_mask:0xc
    v_mfma_f32_16x16x32_bf16 v[32:35], v[12:15], v[64:67], v[32:35]
    buffer_store_dwordx4 v[4:7], v1, s[12:15], s32 offen offset:0 sc0 sc1
    v_mov_b32_dpp v2, v10 row_ror:8 row_mask:0xf bank_mask:0xf
    v_mfma_f32_16x16x32_bf16 v[36:39], v[12:15], v[68:71], v[36:39]
    v_mov_b32_dpp v3, v11 row_ror:8 row_mask:0xf bank_mask:0xf
    v_mov_b32_dpp v10, v8 row_ror:8 row_mask:0xf bank_mask:0x3
    s_waitcnt lgkmcnt(2)
    v_mfma_f32_16x16x32_bf16 v[24:27], v[16:19], v[72:75], v[24:27]
    ds_read_b64_tr_b16 v[12:13], v0 offset:30720
    v_mov_b32_dpp v11, v9 row_ror:8 row_mask:0xf bank_mask:0x3
    v_mfma_f32_16x16x32_bf16 v[28:31], v[16:19], v[76:79], v[28:31]
    ds_read_b64_tr_b16 v[14:15], v0 offset:30848
    v_mov_b32_dpp v8, v2 quad_perm:[0,1,2,3] row_mask:0xf bank_mask:0xc
    v_mfma_f32_16x16x32_bf16 v[32:35], v[16:19], v[80:83], v[32:35]
    v_mov_b32_dpp v9, v3 quad_perm:[0,1,2,3] row_mask:0xf bank_mask:0xc
    buffer_store_dwordx4 v[8:11], v1, s[12:15], s32 offen offset:1024 sc0 sc1
    v_mfma_f32_16x16x32_bf16 v[36:39], v[16:19], v[84:87], v[36:39]
    s_waitcnt lgkmcnt(2)
    v_mfma_f32_16x16x32_bf16 v[24:27], v[20:23], v[88:91], v[24:27]
    ds_read_b64_tr_b16 v[16:17], v0 offset:30976
    v_mfma_f32_16x16x32_bf16 v[28:31], v[20:23], v[92:95], v[28:31]
    ds_read_b64_tr_b16 v[18:19], v0 offset:31104
    v_mfma_f32_16x16x32_bf16 v[32:35], v[20:23], v[96:99], v[32:35]
    v_mov_b32 v2, 0
    v_mfma_f32_16x16x32_bf16 v[36:39], v[20:23], v[100:103], v[36:39]
    ds_read_b32 v2, v2 offset:276
    s_waitcnt lgkmcnt(3)
    v_mfma_f32_16x16x32_bf16 v[24:27], v[12:15], v[104:107], v[24:27]
    ds_read_b64_tr_b16 v[20:21], v0 offset:46080
    v_mfma_f32_16x16x32_bf16 v[28:31], v[12:15], v[108:111], v[28:31]
    ds_read_b64_tr_b16 v[22:23], v0 offset:46208
    v_mfma_f32_16x16x32_bf16 v[32:35], v[12:15], v[112:115], v[32:35]
    s_waitcnt lgkmcnt(2)
    v_readfirstlane_b32 s52, v2
    s_and_b32 s52, s52, s36
    v_mfma_f32_16x16x32_bf16 v[36:39], v[12:15], v[116:119], v[36:39]
    s_cselect_b32 s34, 1, 0
    s_ff1_i32_b32 s52, s52
    s_waitcnt lgkmcnt(2)
    v_mfma_f32_16x16x32_bf16 v[24:27], v[16:19], v[120:123], v[24:27]
    ds_read_b64_tr_b16 v[12:13], v0 offset:46336
    s_bitset0_b32 s36, s52
    s_mul_i32 s52, s52, 11
    v_mfma_f32_16x16x32_bf16 v[28:31], v[16:19], v[124:127], v[28:31]
    ds_read_b64_tr_b16 v[14:15], v0 offset:46464
    s_bfe_u32 s53, s52, 0x10005
    s_bfe_u32 s52, s52, 0x30006
    v_mfma_f32_16x16x32_bf16 v[32:35], v[16:19], v[128:131], v[32:35]
    s_mul_i32 s35, s53, 61440
    s_mul_i32 s31, s52, 2304
    s_add_u32 s31, s31, s35
    v_mfma_f32_16x16x32_bf16 v[36:39], v[16:19], v[132:135], v[36:39]
    s_sub_u32 s35, s31, s39
    v_add_u32 v0, s35, v0
    s_waitcnt lgkmcnt(2)
    v_mfma_f32_16x16x32_bf16 v[24:27], v[20:23], v[136:139], v[24:27]
    ds_read_b64_tr_b16 v[16:17], v0 offset:0
    v_mfma_f32_16x16x32_bf16 v[28:31], v[20:23], v[140:143], v[28:31]
    ds_read_b64_tr_b16 v[18:19], v0 offset:128
    v_mfma_f32_16x16x32_bf16 v[32:35], v[20:23], v[144:147], v[32:35]
    s_mov_b32 s39, s31
    s_mul_i32 s33, s53, 5
    s_add_u32 s33, s33, s52
    v_mfma_f32_16x16x32_bf16 v[36:39], v[20:23], v[148:151], v[36:39]
    s_lshl_b32 s33, s33, 13
    s_add_u32 s33, s33, s38
    s_waitcnt lgkmcnt(2)
    v_mfma_f32_16x16x32_bf16 v[24:27], v[12:15], v[152:155], v[24:27]
    ds_read_b64_tr_b16 v[20:21], v0 offset:256
    v_mfma_f32_16x16x32_bf16 v[28:31], v[12:15], v[156:159], v[28:31]
    ds_read_b64_tr_b16 v[22:23], v0 offset:384
    s_mov_b32 s32, s37
    s_mov_b32 s37, s33
    v_mfma_f32_16x16x32_bf16 v[32:35], v[12:15], v[160:163], v[32:35]
    s_cmp_eq_u32 s34, 0
    s_nop 1
    v_mfma_f32_16x16x32_bf16 v[36:39], v[12:15], v[164:167], v[36:39]
    v_cvt_pk_bf16_f32 v4, v24, v28
    v_cvt_pk_bf16_f32 v6, v25, v29
    v_cvt_pk_bf16_f32 v8, v26, v30
    v_cvt_pk_bf16_f32 v10, v27, v31
    s_nop 0
    s_cbranch_scc1 gm_drain
    s_waitcnt lgkmcnt(2)
    v_mfma_f32_16x16x32_bf16 v[24:27], v[16:19], v[40:43], 0
    v_cvt_pk_bf16_f32 v7, v33, v37
    v_cvt_pk_bf16_f32 v5, v32, v36
    ds_read_b64_tr_b16 v[12:13], v0 offset:15360
    v_mfma_f32_16x16x32_bf16 v[28:31], v[16:19], v[44:47], 0
    v_cvt_pk_bf16_f32 v11, v35, v39
    v_cvt_pk_bf16_f32 v9, v34, v38
    ds_read_b64_tr_b16 v[14:15], v0 offset:15488
    v_mfma_f32_16x16x32_bf16 v[32:35], v[16:19], v[48:51], 0
    v_mov_b32_dpp v2, v6 row_ror:8 row_mask:0xf bank_mask:0xf
    v_mov_b32_dpp v3, v7 row_ror:8 row_mask:0xf bank_mask:0xf
    v_mfma_f32_16x16x32_bf16 v[36:39], v[16:19], v[52:55], 0
    v_mov_b32_dpp v6, v4 row_ror:8 row_mask:0xf bank_mask:0x3
    v_mov_b32_dpp v7, v5 row_ror:8 row_mask:0xf bank_mask:0x3
    s_waitcnt lgkmcnt(2)
    v_mfma_f32_16x16x32_bf16 v[24:27], v[20:23], v[56:59], v[24:27]
    ds_read_b64_tr_b16 v[16:17], v0 offset:15616
    v_mov_b32_dpp v4, v2 quad_perm:[0,1,2,3] row_mask:0xf bank_mask:0xc
    v_mfma_f32_16x16x32_bf16 v[28:31], v[20:23], v[60:63], v[28:31]
    ds_read_b64_tr_b16 v[18:19], v0 offset:15744
    v_mov_b32_dpp v5, v3 quad_perm:[0,1,2,3] row_mask:0xf bank_mask:0xc
    v_mfma_f32_16x16x32_bf16 v[32:35], v[20:23], v[64:67], v[32:35]
    buffer_store_dwordx4 v[4:7], v1, s[12:15], s32 offen offset:0 sc0 sc1
    v_mov_b32_dpp v2, v10 row_ror:8 row_mask:0xf bank_mask:0xf
    v_mfma_f32_16x16x32_bf16 v[36:39], v[20:23], v[68:71], v[36:39]
    v_mov_b32_dpp v3, v11 row_ror:8 row_mask:0xf bank_mask:0xf
    v_mov_b32_dpp v10, v8 row_ror:8 row_mask:0xf bank_mask:0x3
    s_waitcnt lgkmcnt(2)
    v_mfma_f32_16x16x32_bf16 v[24:27], v[12:15], v[72:75], v[24:27]
    ds_read_b64_tr_b16 v[20:21], v0 offset:30720
    v_mov_b32_dpp v11, v9 row_ror:8 row_mask:0xf bank_mask:0x3
    v_mfma_f32_16x16x32_bf16 v[28:31], v[12:15], v[76:79], v[28:31]
    ds_read_b64_tr_b16 v[22:23], v0 offset:30848
    v_mov_b32_dpp v8, v2 quad_perm:[0,1,2,3] row_mask:0xf bank_mask:0xc
    v_mfma_f32_16x16x32_bf16 v[32:35], v[12:15], v[80:83], v[32:35]
    v_mov_b32_dpp v9, v3 quad_perm:[0,1,2,3] row_mask:0xf bank_mask:0xc
    buffer_store_dwordx4 v[8:11], v1, s[12:15], s32 offen offset:1024 sc0 sc1
    v_mfma_f32_16x16x32_bf16 v[36:39], v[12:15], v[84:87], v[36:39]
    s_waitcnt lgkmcnt(2)
    v_mfma_f32_16x16x32_bf16 v[24:27], v[16:19], v[88:91], v[24:27]
    ds_read_b64_tr_b16 v[12:13], v0 offset:30976
    v_mfma_f32_16x16x32_bf16 v[28:31], v[16:19], v[92:95], v[28:31]
    ds_read_b64_tr_b16 v[14:15], v0 offset:31104
    v_mfma_f32_16x16x32_bf16 v[32:35], v[16:19], v[96:99], v[32:35]
    v_mov_b32 v2, 0
    v_mfma_f32_16x16x32_bf16 v[36:39], v[16:19], v[100:103], v[36:39]
    ds_read_b32 v2, v2 offset:276
    s_waitcnt lgkmcnt(3)
    v_mfma_f32_16x16x32_bf16 v[24:27], v[20:23], v[104:107], v[24:27]
    ds_read_b64_tr_b16 v[16:17], v0 offset:46080
    v_mfma_f32_16x16x32_bf16 v[28:31], v[20:23], v[108:111], v[28:31]
    ds_read_b64_tr_b16 v[18:19], v0 offset:46208
    v_mfma_f32_16x16x32_bf16 v[32:35], v[20:23], v[112:115], v[32:35]
    s_waitcnt lgkmcnt(2)
    v_readfirstlane_b32 s52, v2
    s_and_b32 s52, s52, s36
    v_mfma_f32_16x16x32_bf16 v[36:39], v[20:23], v[116:119], v[36:39]
    s_cselect_b32 s34, 1, 0
    s_ff1_i32_b32 s52, s52
    s_waitcnt lgkmcnt(2)
    v_mfma_f32_16x16x32_bf16 v[24:27], v[12:15], v[120:123], v[24:27]
    ds_read_b64_tr_b16 v[20:21], v0 offset:46336
    s_bitset0_b32 s36, s52
    s_mul_i32 s52, s52, 11
    v_mfma_f32_16x16x32_bf16 v[28:31], v[12:15], v[124:127], v[28:31]
    ds_read_b64_tr_b16 v[22:23], v0 offset:46464
    s_bfe_u32 s53, s52, 0x10005
    s_bfe_u32 s52, s52, 0x30006
    v_mfma_f32_16x16x32_bf16 v[32:35], v[12:15], v[128:131], v[32:35]
    s_mul_i32 s35, s53, 61440
    s_mul_i32 s31, s52, 2304
    s_add_u32 s31, s31, s35
    v_mfma_f32_16x16x32_bf16 v[36:39], v[12:15], v[132:135], v[36:39]
    s_sub_u32 s35, s31, s39
    v_add_u32 v0, s35, v0
    s_waitcnt lgkmcnt(2)
    v_mfma_f32_16x16x32_bf16 v[24:27], v[16:19], v[136:139], v[24:27]
    ds_read_b64_tr_b16 v[12:13], v0 offset:0
    v_mfma_f32_16x16x32_bf16 v[28:31], v[16:19], v[140:143], v[28:31]
    ds_read_b64_tr_b16 v[14:15], v0 offset:128
    v_mfma_f32_16x16x32_bf16 v[32:35], v[16:19], v[144:147], v[32:35]
    s_mov_b32 s39, s31
    s_mul_i32 s33, s53, 5
    s_add_u32 s33, s33, s52
    v_mfma_f32_16x16x32_bf16 v[36:39], v[16:19], v[148:151], v[36:39]
    s_lshl_b32 s33, s33, 13
    s_add_u32 s33, s33, s38
    s_waitcnt lgkmcnt(2)
    v_mfma_f32_16x16x32_bf16 v[24:27], v[20:23], v[152:155], v[24:27]
    ds_read_b64_tr_b16 v[16:17], v0 offset:256
    v_mfma_f32_16x16x32_bf16 v[28:31], v[20:23], v[156:159], v[28:31]
    ds_read_b64_tr_b16 v[18:19], v0 offset:384
    s_mov_b32 s32, s37
    s_mov_b32 s37, s33
    v_mfma_f32_16x16x32_bf16 v[32:35], v[20:23], v[160:163], v[32:35]
    s_cmp_eq_u32 s34, 0
    s_nop 1
    v_mfma_f32_16x16x32_bf16 v[36:39], v[20:23], v[164:167], v[36:39]
    v_cvt_pk_bf16_f32 v4, v24, v28
    v_cvt_pk_bf16_f32 v6, v25, v29
    v_cvt_pk_bf16_f32 v8, v26, v30
    v_cvt_pk_bf16_f32 v10, v27, v31
    s_nop 0
    s_cbranch_scc0 gm_loop
gm_drain:
    s_nop 2
    v_cvt_pk_bf16_f32 v7, v33, v37
    v_cvt_pk_bf16_f32 v5, v32, v36
    v_cvt_pk_bf16_f32 v11, v35, v39
    v_cvt_pk_bf16_f32 v9, v34, v38
    v_mov_b32_dpp v2, v6 row_ror:8 row_mask:0xf bank_mask:0xf
    v_mov_b32_dpp v3, v7 row_ror:8 row_mask:0xf bank_mask:0xf
    v_mov_b32_dpp v6, v4 row_ror:8 row_mask:0xf bank_mask:0x3
    v_mov_b32_dpp v7, v5 row_ror:8 row_mask:0xf bank_mask:0x3
    v_mov_b32_dpp v4, v2 quad_perm:[0,1,2,3] row_mask:0xf bank_mask:0xc
    v_mov_b32_dpp v5, v3 quad_perm:[0,1,2,3] row_mask:0xf bank_mask:0xc
    buffer_store_dwordx4 v[4:7], v1, s[12:15], s32 offen offset:0 sc0 sc1
    v_mov_b32_dpp v2, v10 row_ror:8 row_mask:0xf bank_mask:0xf
    v_mov_b32_dpp v3, v11 row_ror:8 row_mask:0xf bank_mask:0xf
    v_mov_b32_dpp v10, v8 row_ror:8 row_mask:0xf bank_mask:0x3
    v_mov_b32_dpp v11, v9 row_ror:8 row_mask:0xf bank_mask:0x3
    v_mov_b32_dpp v8, v2 quad_perm:[0,1,2,3] row_mask:0xf bank_mask:0xc
    v_mov_b32_dpp v9, v3 quad_perm:[0,1,2,3] row_mask:0xf bank_mask:0xc
    buffer_store_dwordx4 v[8:11], v1, s[12:15], s32 offen offset:1024 sc0 sc1
    s_cmp_lg_u32 s36, 0
    s_cbranch_scc1 gm_poll
    s_endpgm
gm_ovf:
    s_movk_i32 s20, 4
    s_barrier
    s_barrier
    s_barrier
    s_branch gm_pass
gm_next:
    s_add_u32 s24, s24, s20
    s_barrier
    s_branch gm_pass
mn_w5:
    v_add_u32 v55, 16, v35
    v_add_u32 v55, s24, v55
    v_lshrrev_b32 v56, 16, v58
    v_mov_b32 v24, 0
    v_cmpx_lt_u32 vcc, v55, v56
    s_cbranch_execz mn_g0
    v_and_b32 v56, 0xffff, v58
    v_add_u32 v55, v55, v56
    v_mad_u32_u24 v56, v55, 48, v46
    buffer_load_dword v24, v56, s[8:11], 0 offen offset:40
    s_waitcnt vmcnt(0)
mn_g0:
    s_mov_b64 exec, -1
mn_more:
    s_add_u32 s52, s24, s20
    v_lshrrev_b32 v56, 16, v58
    v_cmp_lt_u32 vcc, s52, v56
    s_cbranch_vccz mn_count
    v_mov_b32 v55, 272
    ds_write_b32 v55, v48
    s_branch mn_count
mn_ovf:
    s_movk_i32 s20, 4
    s_waitcnt vmcnt(0) lgkmcnt(0)
    s_barrier
    s_branch mn_again
mn_next:
    s_set_gpr_idx_off
    s_waitcnt vmcnt(0) lgkmcnt(0)
    s_nop 7
    s_add_u32 s24, s24, s20
    v_mbcnt_lo_u32_b32 v0, -1, 0
    v_mbcnt_hi_u32_b32 v0, -1, v0
    v_lshl_add_u32 v0, s16, 6, v0
    v_lshrrev_b32 v56, 6, v0
    v_lshlrev_b32 v55, 1, v0
    v_and_b32 v55, 0x78, v55
    v_or_b32 v55, v55, v56
    v_cmp_gt_u32 vcc, 125, v55
    v_mul_u32_u24 v46, 61440, v55
    v_bfrev_b32 v56, 2
    v_lshlrev_b32 v55, 4, v0
    v_and_b32 v57, 0x1fc, v0
    v_cndmask_b32 v55, v56, v55, vcc
    v_cndmask_b32 v57, v56, v57, vcc
    v_and_b32 v51, 63, v0
    v_lshlrev_b32 v56, 3, v51
    buffer_load_dword v58, v57, s[8:11], s25 offen
    buffer_load_dwordx2 v[44:45], v56, s[8:11], s25 offen
    v_mov_b32 v48, 1
    v_lshlrev_b32 v47, 2, v51
    v_bfe_u32 v2, v0, 5, 1
    v_bfe_u32 v3, v0, 3, 2
    v_and_b32 v35, 3, v0
    v_lshl_add_u32 v3, v3, 2, v35
    v_mul_u32_u24 v49, 20, v2
    v_lshrrev_b32 v18, 2, v51
    v_lshl_add_u32 v18, v35, 4, v18
    v_mov_b32 v50, 1327103
    s_lshl_b32 s52, s16, 3
    s_bfm_b64 s[36:37], s52, 0
    s_andn2_b32 s39, s37, 2155905024
    s_mov_b32 s38, s36
mn_again:
    v_mov_b32 v55, 0
    ds_write_b32 v47, v55 offset:0
    ds_write_b32 v47, v55 offset:256
    s_waitcnt vmcnt(0) lgkmcnt(0)
    s_barrier
    v_add_u32 v55, 0, v35
    v_add_u32 v55, s24, v55
    v_lshrrev_b32 v56, 16, v58
    v_mov_b32 v20, 0
    v_cmpx_lt_u32 vcc, v55, v56
    s_cbranch_execz mn_g1
    v_and_b32 v56, 0xffff, v58
    v_add_u32 v55, v55, v56
    v_mad_u32_u24 v56, v55, 48, v46
    buffer_load_dword v20, v56, s[8:11], 0 offen offset:40
    s_waitcnt vmcnt(0)
mn_g1:
    s_mov_b64 exec, -1
    v_mov_b32 v21, 0
    v_mov_b32 v22, 0
    v_mov_b32 v23, 0
    v_mov_b32 v24, 0
    s_cmp_le_u32 s20, 4
    s_cbranch_scc1 mn_more
    v_add_u32 v55, 4, v35
    v_add_u32 v55, s24, v55
    v_lshrrev_b32 v56, 16, v58
    v_mov_b32 v21, 0
    v_cmpx_lt_u32 vcc, v55, v56
    s_cbranch_execz mn_g2
    v_and_b32 v56, 0xffff, v58
    v_add_u32 v55, v55, v56
    v_mad_u32_u24 v56, v55, 48, v46
    buffer_load_dword v21, v56, s[8:11], 0 offen offset:40
    s_waitcnt vmcnt(0)
mn_g2:
    s_mov_b64 exec, -1
    v_add_u32 v55, 8, v35
    v_add_u32 v55, s24, v55
    v_lshrrev_b32 v56, 16, v58
    v_mov_b32 v22, 0
    v_cmpx_lt_u32 vcc, v55, v56
    s_cbranch_execz mn_g3
    v_and_b32 v56, 0xffff, v58
    v_add_u32 v55, v55, v56
    v_mad_u32_u24 v56, v55, 48, v46
    buffer_load_dword v22, v56, s[8:11], 0 offen offset:40
    s_waitcnt vmcnt(0)
mn_g3:
    s_mov_b64 exec, -1
    v_add_u32 v55, 12, v35
    v_add_u32 v55, s24, v55
    v_lshrrev_b32 v56, 16, v58
    v_mov_b32 v23, 0
    v_cmpx_lt_u32 vcc, v55, v56
    s_cbranch_execz mn_g4
    v_and_b32 v56, 0xffff, v58
    v_add_u32 v55, v55, v56
    v_mad_u32_u24 v56, v55, 48, v46
    buffer_load_dword v23, v56, s[8:11], 0 offen offset:40
    s_waitcnt vmcnt(0)
mn_g4:
    s_mov_b64 exec, -1
    v_add_u32 v55, 16, v35
    v_add_u32 v55, s24, v55
    v_lshrrev_b32 v56, 16, v58
    v_mov_b32 v24, 0
    v_cmpx_lt_u32 vcc, v55, v56
    s_cbranch_execz mn_g5
    v_and_b32 v56, 0xffff, v58
    v_add_u32 v55, v55, v56
    v_mad_u32_u24 v56, v55, 48, v46
    buffer_load_dword v24, v56, s[8:11], 0 offen offset:40
    s_waitcnt vmcnt(0)
mn_g5:
    s_mov_b64 exec, -1
    s_branch mn_more
mn_last:
    s_endpgm
.section .rodata,"a"
.p2align 6
.amdhsa_kernel ka_kernel
  .amdhsa_next_free_vgpr 88
  .amdhsa_next_free_sgpr 40
  .amdhsa_accum_offset 88
  .amdhsa_group_segment_fixed_size 0
  .amdhsa_kernarg_size 88
  .amdhsa_user_sgpr_count 2
  .amdhsa_user_sgpr_kernarg_segment_ptr 1
  .amdhsa_system_sgpr_workgroup_id_x 1
.end_amdhsa_kernel
.p2align 6
.amdhsa_kernel main_kernel
  .amdhsa_next_free_vgpr 168
  .amdhsa_next_free_sgpr 96
  .amdhsa_accum_offset 168
  .amdhsa_group_segment_fixed_size 0
  .amdhsa_kernarg_size 88
  .amdhsa_user_sgpr_count 2
  .amdhsa_user_sgpr_kernarg_segment_ptr 1
  .amdhsa_system_sgpr_workgroup_id_x 1
.end_amdhsa_kernel
```

```asm
; @launch kernel=ka_kernel grid=(256,1,1) block=(768,1,1) lds=83968
; @launch kernel=main_kernel grid=(256,1,1) block=(768,1,1) lds=163840
.amdgcn_target "amdgcn-amd-amdhsa--gfx950"
.text
.globl ka_kernel
.p2align 8
.type ka_kernel,@function
ka_kernel:
    s_cmp_ge_u32 s2, 256
    s_cbranch_scc1 ka_end
    s_cmp_lt_u32 s2, 128
    s_cbranch_scc1 ka_nospf
    s_getpc_b64 s[36:37]
ka_pc0:
    v_lshlrev_b32 v41, 7, v0
    v_min_u32 v41, mn_last-ka_pc0, v41
    global_load_dword v41, v41, s[36:37]
ka_nospf:
    s_load_dwordx8 s[4:11], s[0:1], 8
    s_load_dwordx2 s[16:17], s[0:1], 0
    s_load_dwordx2 s[14:15], s[0:1], 80
    s_load_dwordx2 s[32:33], s[0:1], 56
    v_lshrrev_b32 v9, 6, v0
    v_and_b32 v1, 63, v0
    v_readfirstlane_b32 s18, v9
    s_cmp_ge_u32 s2, 128
    s_cbranch_scc1 ka_pf
    s_cmp_ge_u32 s2, 125
    s_cbranch_scc1 ka_extra
    s_mul_i32 s3, s2, 1280
    v_add_u32 v4, s3, v0
    v_lshlrev_b32 v5, 2, v4
    s_mov_b32 s22, 12582912
    s_mov_b32 s23, 0x20000
    s_and_b32 s28, s2, 7
    s_lshl_b32 s28, s28, 4
    s_lshr_b32 s29, s2, 3
    s_add_u32 s28, s28, s29
    s_cmp_ge_u32 s18, 10
    s_waitcnt lgkmcnt(0)
    s_mov_b32 s20, s14
    s_cbranch_scc1 ka_dma
    global_load_dword v10, v5, s[6:7]
    global_load_dword v60, v5, s[6:7] offset:2560
    global_load_dword v11, v5, s[4:5]
    global_load_dword v61, v5, s[4:5] offset:2560
    v_lshlrev_b32 v2, 2, v0
    v_and_b32 v2, 0x3fc, v2
    v_lshlrev_b32 v5, 4, v0
    v_mov_b32 v44, 0
    v_mov_b32 v45, 0
    v_mov_b32 v46, 0
    v_mov_b32 v47, 0
    ds_write_b32 v2, v44
    ds_write_b128 v5, v[44:47] offset:11264
    ds_write_b128 v5, v[44:47] offset:17408
    s_and_b32 s21, s15, 0xffff
    s_lshl_b32 s28, s28, 2
    s_add_u32 s28, s28, 10485760
    v_mov_b32 v3, 1
    v_lshlrev_b32 v26, 4, v1
    s_lshl_b32 s19, s18, 10
    v_add_u32 v27, s19, v26
    v_mov_b32 v4, 0x40000
    s_movk_i32 s29, 625
    s_movk_i32 s38, 0x3fff
    s_waitcnt lgkmcnt(0)
    s_barrier
    v_mov_b32 v19, 73728
    v_lshl_add_u32 v18, v0, 1, 0
    v_mul_u32_u24 v16, 13108, v18
    v_lshrrev_b32 v16, 16, v16
    v_mad_i32_i24 v18, v16, -5, v18
    v_lshlrev_b32 v16, 2, v16
    v_cmp_eq_u32 vcc, 4, v18
    v_lshlrev_b32 v18, 3, v18
    v_add_u32 v18, 32768, v18
    v_cndmask_b32 v17, 5, 3, vcc
    v_cndmask_b32 v18, v18, v19, vcc
    v_lshl_add_u32 v14, v0, 1, 1
    v_mul_u32_u24 v12, 13108, v14
    v_lshrrev_b32 v12, 16, v12
    v_mad_i32_i24 v14, v12, -5, v14
    v_lshlrev_b32 v12, 2, v12
    v_cmp_eq_u32 vcc, 4, v14
    v_lshlrev_b32 v14, 3, v14
    v_add_u32 v14, 32768, v14
    v_cndmask_b32 v13, 5, 3, vcc
    v_cndmask_b32 v14, v14, v19, vcc
    s_mul_i32 s31, s2, 51200
    s_waitcnt vmcnt(3)
    v_mul_u32_u24 v32, 214749, v10
    v_lshrrev_b32 v32, 23, v32
    v_min_u32 v32, 255, v32
    v_and_b32 v35, 7, v32
    v_lshrrev_b32 v33, 3, v32
    v_lshl_add_u32 v35, v35, 5, v33
    v_lshlrev_b32 v35, 2, v35
    ds_add_rtn_u32 v36, v35, v3
    s_waitcnt vmcnt(2)
    v_mul_u32_u24 v62, 214749, v60
    v_lshrrev_b32 v62, 23, v62
    v_min_u32 v62, 255, v62
    v_and_b32 v66, 7, v62
    v_lshrrev_b32 v63, 3, v62
    v_lshl_add_u32 v66, v66, 5, v63
    v_lshlrev_b32 v66, 2, v66
    ds_add_rtn_u32 v67, v66, v3
    v_mad_u32_u24 v33, v32, s29, 15
    v_lshrrev_b32 v33, 4, v33
    v_sub_u32 v33, v10, v33
    v_subrev_u32 v32, 20, v33
    v_min_u32 v32, v32, v33
    v_min_u32 v32, 19, v32
    v_lshlrev_b32 v40, 4, v35
    v_add_u32 v35, s19, v35
    v_mad_u32_u24 v63, v62, s29, 15
    v_lshrrev_b32 v63, 4, v63
    v_sub_u32 v63, v60, v63
    v_subrev_u32 v62, 20, v63
    v_min_u32 v62, v62, v63
    v_min_u32 v62, 19, v62
    v_lshlrev_b32 v70, 4, v66
    v_add_u32 v66, s19, v66
    s_waitcnt vmcnt(0) lgkmcnt(0)
    v_mul_u32_u24 v39, 3330, v11
    v_lshrrev_b32 v39, 20, v39
    v_lshrrev_b32 v34, 2, v32
    v_cmp_gt_u32 vcc, 27, v39
    v_add_u32 v34, 27, v34
    v_lshlrev_b32 v23, 14, v32
    v_cndmask_b32 v39, v34, v39, vcc
    v_cmp_le_u32 vcc, 20, v33
    v_and_or_b32 v22, v11, s38, v23
    v_or_b32 v39, 64, v39
    v_add_u32 v34, 32, v39
    v_cndmask_b32 v39, v39, v34, vcc
    v_lshl_or_b32 v22, v39, 25, v22
    v_cmp_lt_u32 vcc, 15, v36
    v_and_b32 v34, 3, v36
    v_lshl_add_u32 v40, v34, 4, v40
    v_and_or_b32 v40, v36, 12, v40
    v_cndmask_b32 v40, v40, v4, vcc
    ds_write_b32 v40, v22 offset:11264
    v_mul_u32_u24 v68, 3330, v61
    v_lshrrev_b32 v68, 20, v68
    v_lshrrev_b32 v71, 2, v62
    v_cmp_gt_u32 vcc, 27, v68
    v_add_u32 v71, 27, v71
    v_lshlrev_b32 v75, 14, v62
    v_cndmask_b32 v68, v71, v68, vcc
    v_cmp_le_u32 vcc, 20, v63
    v_and_or_b32 v74, v61, s38, v75
    v_or_b32 v68, 64, v68
    v_add_u32 v71, 32, v68
    v_cndmask_b32 v68, v68, v71, vcc
    v_lshl_or_b32 v74, v68, 25, v74
    v_cmp_lt_u32 vcc, 15, v67
    v_and_b32 v71, 3, v67
    v_lshl_add_u32 v70, v71, 4, v70
    v_and_or_b32 v70, v67, 12, v70
    v_cndmask_b32 v70, v70, v4, vcc
    ds_write_b32 v70, v74 offset:11264
    s_waitcnt lgkmcnt(0)
    s_barrier
    ds_read_b128 v[44:47], v26
    ds_read_b32 v37, v2
    v_add_u32 v28, s19, v2
    v_lshlrev_b32 v29, 9, v0
    v_add_u32 v9, 640, v0
    v_max_u32 v8, v36, v67
    v_cmp_lt_u32 vcc, 15, v8
    s_waitcnt lgkmcnt(1)
    v_add_u32 v53, v44, v45
    v_add_u32 v54, v53, v46
    v_add_u32 v38, v54, v47
    v_mov_b32 v55, v38
    s_nop 0
    v_add_u32_dpp v38, v38, v38 row_shr:1 row_mask:0xf bank_mask:0xf
    s_nop 0
    s_nop 0
    v_add_u32_dpp v38, v38, v38 row_shr:2 row_mask:0xf bank_mask:0xf
    s_nop 0
    s_nop 0
    v_add_u32_dpp v38, v38, v38 row_shr:4 row_mask:0xf bank_mask:0xf
    s_nop 0
    s_nop 0
    v_add_u32_dpp v38, v38, v38 row_shr:8 row_mask:0xf bank_mask:0xf
    s_nop 0
    s_nop 0
    v_add_u32_dpp v38, v38, v38 row_bcast:15 row_mask:0xa bank_mask:0xf
    s_nop 0
    s_nop 0
    v_add_u32_dpp v38, v38, v38 row_bcast:31 row_mask:0xc bank_mask:0xf
    v_sub_u32 v56, v38, v55
    v_add_u32 v57, v56, v44
    v_add_u32 v58, v56, v53
    v_add_u32 v59, v56, v54
    ds_write_b128 v27, v[56:59] offset:1024
    ds_read_b32 v43, v35 offset:1024
    ds_read_b32 v69, v66 offset:1024
    ds_read_b32 v30, v28 offset:1024
    s_cmp_ge_u32 s18, 4
    s_waitcnt lgkmcnt(1)
    v_add_lshl_u32 v43, v43, v36, 2
    v_add_lshl_u32 v69, v69, v67, 2
    ds_write_b32 v43, v0 offset:27648
    ds_write_b32 v69, v9 offset:27648
    s_cbranch_scc1 ka_nohdr
    s_waitcnt lgkmcnt(2)
    v_lshl_or_b32 v30, v37, 16, v30
    buffer_store_dword v30, v29, s[20:23], s28 offen
ka_nohdr:
    s_cbranch_vccnz ka_ov
ka_ov_back:
    s_waitcnt lgkmcnt(0)
ka_copy:
    s_barrier
    ds_read_b32 v20, v16 offset:27648
    ds_read_b32 v21, v12 offset:27648
    ds_read_b32 v22, v16 offset:28672
    ds_read_b32 v23, v12 offset:28672
    ds_read_b32 v24, v16 offset:29696
    ds_read_b32 v25, v12 offset:29696
    ds_read_b32 v26, v16 offset:30720
    ds_read_b32 v27, v12 offset:30720
    ds_read_b32 v28, v16 offset:31744
    ds_read_b32 v29, v12 offset:31744
    s_waitcnt lgkmcnt(8)
    v_lshl_add_u32 v20, v20, v17, v18
    v_lshl_add_u32 v21, v21, v13, v14
    ds_read_b64 v[44:45], v20
    ds_read_b64 v[46:47], v21
    s_waitcnt lgkmcnt(8)
    v_lshl_add_u32 v22, v22, v17, v18
    v_lshl_add_u32 v23, v23, v13, v14
    ds_read_b64 v[48:49], v22
    ds_read_b64 v[50:51], v23
    s_waitcnt lgkmcnt(8)
    v_lshl_add_u32 v24, v24, v17, v18
    v_lshl_add_u32 v25, v25, v13, v14
    ds_read_b64 v[52:53], v24
    ds_read_b64 v[54:55], v25
    s_waitcnt lgkmcnt(8)
    v_lshl_add_u32 v26, v26, v17, v18
    v_lshl_add_u32 v27, v27, v13, v14
    ds_read_b64 v[56:57], v26
    ds_read_b64 v[58:59], v27
    s_waitcnt lgkmcnt(8)
    v_lshl_add_u32 v28, v28, v17, v18
    v_lshl_add_u32 v29, v29, v13, v14
    ds_read_b64 v[60:61], v28
    ds_read_b64 v[62:63], v29
    s_waitcnt lgkmcnt(8)
    buffer_store_dwordx4 v[44:47], v5, s[20:23], s31 offen sc1
    s_addk_i32 s31, 10240
    s_waitcnt lgkmcnt(6)
    buffer_store_dwordx4 v[48:51], v5, s[20:23], s31 offen sc1
    s_addk_i32 s31, 10240
    s_waitcnt lgkmcnt(4)
    buffer_store_dwordx4 v[52:55], v5, s[20:23], s31 offen sc1
    s_addk_i32 s31, 10240
    s_waitcnt lgkmcnt(2)
    buffer_store_dwordx4 v[56:59], v5, s[20:23], s31 offen sc1
    s_addk_i32 s31, 10240
    s_waitcnt lgkmcnt(0)
    buffer_store_dwordx4 v[60:63], v5, s[20:23], s31 offen sc1
    s_endpgm
ka_ov:
    s_mul_i32 s33, s2, 5120
    s_add_u32 s33, s33, 7340032
    buffer_store_dword v22, v43, s[20:23], s33 offen
    buffer_store_dword v74, v69, s[20:23], s33 offen
    s_branch ka_ov_back
ka_dma:
    s_and_b32 s21, s15, 0xffff
    s_sub_u32 s33, s18, 10
    s_lshl_b32 s34, s33, 10
    s_mul_i32 s35, s2, 40960
    s_add_u32 s35, s35, s34
    v_lshl_add_u32 v7, v1, 4, s35
    s_add_u32 m0, s34, 32768
    s_lshl_b32 s30, s28, 6
    s_add_u32 s30, s30, 8388608
    s_barrier
    s_mul_i32 s35, s2, 10240
    s_add_u32 s35, s35, s34
    v_lshl_add_u32 v8, v1, 4, s35
    s_add_u32 m0, s34, 73728
    s_nop 0
    global_load_lds_dwordx4 v8, s[8:9]
    s_add_u32 m0, m0, 2048
    v_add_u32 v8, 2048, v8
    s_nop 0
    global_load_lds_dwordx4 v8, s[8:9]
    s_add_u32 m0, m0, 2048
    v_add_u32 v8, 2048, v8
    s_nop 0
    global_load_lds_dwordx4 v8, s[8:9]
    s_add_u32 m0, m0, 2048
    v_add_u32 v8, 2048, v8
    s_nop 0
    global_load_lds_dwordx4 v8, s[8:9]
    s_add_u32 m0, m0, 2048
    v_add_u32 v8, 2048, v8
    s_nop 0
    global_load_lds_dwordx4 v8, s[8:9]
    s_add_u32 m0, m0, 2048
    v_add_u32 v8, 2048, v8
    s_add_u32 m0, s34, 32768
    s_nop 0
    global_load_lds_dwordx4 v7, s[10:11]
    s_add_u32 m0, m0, 2048
    v_add_u32 v7, 2048, v7
    global_load_lds_dwordx4 v7, s[10:11]
    s_add_u32 m0, m0, 2048
    v_add_u32 v7, 2048, v7
    global_load_lds_dwordx4 v7, s[10:11]
    s_add_u32 m0, m0, 2048
    v_add_u32 v7, 2048, v7
    s_barrier
    global_load_lds_dwordx4 v7, s[10:11]
    s_add_u32 m0, m0, 2048
    v_add_u32 v7, 2048, v7
    global_load_lds_dwordx4 v7, s[10:11]
    s_add_u32 m0, m0, 2048
    v_add_u32 v7, 2048, v7
    global_load_lds_dwordx4 v7, s[10:11]
    s_add_u32 m0, m0, 2048
    v_add_u32 v7, 2048, v7
    global_load_lds_dwordx4 v7, s[10:11]
    s_add_u32 m0, m0, 2048
    v_add_u32 v7, 2048, v7
    global_load_lds_dwordx4 v7, s[10:11]
    s_add_u32 m0, m0, 2048
    v_add_u32 v7, 2048, v7
    global_load_lds_dwordx4 v7, s[10:11]
    s_add_u32 m0, m0, 2048
    v_add_u32 v7, 2048, v7
    global_load_lds_dwordx4 v7, s[10:11]
    s_add_u32 m0, m0, 2048
    v_add_u32 v7, 2048, v7
    global_load_lds_dwordx4 v7, s[10:11]
    s_add_u32 m0, m0, 2048
    v_add_u32 v7, 2048, v7
    global_load_lds_dwordx4 v7, s[10:11]
    s_add_u32 m0, m0, 2048
    v_add_u32 v7, 2048, v7
    global_load_lds_dwordx4 v7, s[10:11]
    s_add_u32 m0, m0, 2048
    v_add_u32 v7, 2048, v7
    global_load_lds_dwordx4 v7, s[10:11]
    s_add_u32 m0, m0, 2048
    v_add_u32 v7, 2048, v7
    global_load_lds_dwordx4 v7, s[10:11]
    s_add_u32 m0, m0, 2048
    v_add_u32 v7, 2048, v7
    global_load_lds_dwordx4 v7, s[10:11]
    s_add_u32 m0, m0, 2048
    v_add_u32 v7, 2048, v7
    global_load_lds_dwordx4 v7, s[10:11]
    s_add_u32 m0, m0, 2048
    v_add_u32 v7, 2048, v7
    global_load_lds_dwordx4 v7, s[10:11]
    s_add_u32 m0, m0, 2048
    v_add_u32 v7, 2048, v7
    global_load_lds_dwordx4 v7, s[10:11]
    s_add_u32 m0, m0, 2048
    v_add_u32 v7, 2048, v7
    global_load_lds_dwordx4 v7, s[10:11]
    s_add_u32 m0, m0, 2048
    v_add_u32 v7, 2048, v7
    v_and_b32 v2, 0x7f, v0
    v_lshlrev_b32 v5, 4, v2
    v_lshrrev_b32 v6, 2, v2
    v_lshlrev_b32 v6, 13, v6
    v_and_or_b32 v6, v5, 0x30, v6
    ds_read_b128 v[44:47], v5 offset:11264
    ds_read_b128 v[48:51], v5 offset:13312
    ds_read_b128 v[52:55], v5 offset:15360
    ds_read_b128 v[56:59], v5 offset:17408
    ds_read_b128 v[60:63], v5 offset:19456
    ds_read_b128 v[64:67], v5 offset:21504
    ds_read_b128 v[68:71], v5 offset:23552
    ds_read_b128 v[72:75], v5 offset:25600
    s_waitcnt lgkmcnt(7)
    buffer_store_dwordx4 v[44:47], v6, s[20:23], s30 offen
    s_add_u32 s30, s30, 262144
    s_waitcnt lgkmcnt(6)
    buffer_store_dwordx4 v[48:51], v6, s[20:23], s30 offen
    s_add_u32 s30, s30, 262144
    s_waitcnt lgkmcnt(5)
    buffer_store_dwordx4 v[52:55], v6, s[20:23], s30 offen
    s_add_u32 s30, s30, 262144
    s_waitcnt lgkmcnt(4)
    buffer_store_dwordx4 v[56:59], v6, s[20:23], s30 offen
    s_add_u32 s30, s30, 262144
    s_waitcnt lgkmcnt(3)
    buffer_store_dwordx4 v[60:63], v6, s[20:23], s30 offen
    s_add_u32 s30, s30, 262144
    s_waitcnt lgkmcnt(2)
    buffer_store_dwordx4 v[64:67], v6, s[20:23], s30 offen
    s_add_u32 s30, s30, 262144
    s_waitcnt lgkmcnt(1)
    buffer_store_dwordx4 v[68:71], v6, s[20:23], s30 offen
    s_add_u32 s30, s30, 262144
    s_waitcnt lgkmcnt(0)
    buffer_store_dwordx4 v[72:75], v6, s[20:23], s30 offen
    s_waitcnt vmcnt(8)
    s_barrier
    s_endpgm
ka_pf:
    s_sub_u32 s34, s2, 127
    s_mul_i32 s34, s34, 40960
    s_sub_u32 s34, s34, 40960
    v_lshl_add_u32 v44, v0, 7, s34
    v_min_u32 v44, 5119996, v44
    s_waitcnt lgkmcnt(0)
    s_cmp_ge_u32 s18, 5
    s_cbranch_scc1 ka_nohlp
    global_load_dword v45, v44, s[10:11]
ka_nohlp:
    s_and_b32 s34, s2, 7
    s_mul_i32 s34, s34, 655360
    s_add_u32 s24, s16, s34
    s_addc_u32 s25, s17, 0
    s_and_b32 s25, s25, 0xffff
    s_mov_b32 s26, 655360
    s_mov_b32 s27, 0x20000
    s_bfe_u32 s30, s2, 0x40003
    v_lshlrev_b32 v40, 7, v0
    s_mul_i32 s30, s30, 40960
    s_cmp_lg_u32 s18, 9
    s_cbranch_scc1 ka_pf1
    s_bitcmp1_b32 s2, 3
    s_cbranch_scc1 ka_pf1
    s_and_b32 s35, s2, 7
    s_bfe_u32 s36, s2, 0x30004
    s_lshl_b32 s37, s35, 14
    s_lshr_b32 s38, s36, 1
    s_lshl_b32 s38, s38, 7
    s_add_u32 s37, s37, s38
    s_and_b32 s38, s36, 1
    s_lshl2_add_u32 s37, s38, s37
    v_lshrrev_b32 v44, 4, v1
    v_lshlrev_b32 v44, 11, v44
    v_and_b32 v45, 7, v1
    v_lshl_add_u32 v44, v45, 4, v44
    v_and_b32 v45, 8, v1
    v_add3_u32 v44, v44, v45, s37
    v_add_u32 v45, 0x2000, v44
    global_load_dword v48, v44, s[32:33] offset:0
    global_load_dword v49, v44, s[32:33] offset:512
    global_load_dword v50, v44, s[32:33] offset:1024
    global_load_dword v51, v44, s[32:33] offset:1536
    global_load_dword v52, v45, s[32:33] offset:0
    global_load_dword v53, v45, s[32:33] offset:512
    global_load_dword v54, v45, s[32:33] offset:1024
    global_load_dword v55, v45, s[32:33] offset:1536
    s_lshr_b32 s36, s36, 1
    s_lshl3_add_u32 s36, s36, s35
    s_lshl1_add_u32 s36, s36, s38
    s_lshl_b32 s36, s36, 11
    s_add_u32 s36, s36, 11534336
    v_lshl_add_u32 v46, v1, 4, s36
    s_mov_b32 s38, 0x05040100
    s_mov_b32 s39, 0x07060302
    s_waitcnt vmcnt(0)
    v_perm_b32 v56, v49, v48, s38
    v_perm_b32 v60, v49, v48, s39
    v_perm_b32 v57, v51, v50, s38
    v_perm_b32 v61, v51, v50, s39
    v_perm_b32 v58, v53, v52, s38
    v_perm_b32 v62, v53, v52, s39
    v_perm_b32 v59, v55, v54, s38
    v_perm_b32 v63, v55, v54, s39
    global_store_dwordx4 v46, v[56:59], s[14:15]
    global_store_dwordx4 v46, v[60:63], s[14:15] offset:1024
ka_pf1:
    s_cmp_ge_u32 s18, 5
    s_cbranch_scc1 ka_end
    s_waitcnt vmcnt(0)
    buffer_load_dword v42, v40, s[24:27], s30 offen
    s_cmp_ge_u32 s18, 0
    s_cbranch_scc1 ka_end
    s_add_u32 s30, s30, 81920
    buffer_load_dword v43, v40, s[24:27], s30 offen
    s_endpgm
ka_extra:
    s_cmp_lg_u32 s2, 125
    s_cbranch_scc1 ka_end
    s_cmp_ge_u32 s18, 5
    s_cbranch_scc1 ka_end
    s_load_dwordx4 s[36:39], s[0:1], 40
    s_lshl_b32 s34, s18, 11
    s_add_u32 s34, s34, 11665408
    v_lshl_add_u32 v46, v1, 4, s34
    s_cmp_eq_u32 s18, 5
    s_cbranch_scc1 ka_dum
    s_cmp_eq_u32 s18, 4
    s_cbranch_scc1 ka_cg
    v_lshrrev_b32 v44, 5, v1
    v_lshlrev_b32 v44, 12, v44
    v_and_b32 v45, 31, v1
    v_lshl_add_u32 v44, v45, 1, v44
    v_lshl_add_u32 v44, s18, 7, v44
    s_waitcnt lgkmcnt(0)
    global_load_ushort v48, v44, s[38:39] offset:0
    global_load_ushort v49, v44, s[38:39] offset:512
    global_load_ushort v50, v44, s[38:39] offset:1024
    global_load_ushort v51, v44, s[38:39] offset:1536
    global_load_ushort v52, v44, s[38:39] offset:2048
    global_load_ushort v53, v44, s[38:39] offset:2560
    global_load_ushort v54, v44, s[38:39] offset:3072
    global_load_ushort v55, v44, s[38:39] offset:3584
    global_load_ushort v56, v44, s[38:39] offset:64
    global_load_ushort v57, v44, s[38:39] offset:576
    global_load_ushort v58, v44, s[38:39] offset:1088
    global_load_ushort v59, v44, s[38:39] offset:1600
    global_load_ushort v60, v44, s[38:39] offset:2112
    global_load_ushort v61, v44, s[38:39] offset:2624
    global_load_ushort v62, v44, s[38:39] offset:3136
    global_load_ushort v63, v44, s[38:39] offset:3648
    s_branch ka_pk
ka_cg:
    v_and_b32 v44, 3, v1
    v_lshlrev_b32 v44, 1, v44
    s_waitcnt lgkmcnt(0)
    global_load_ushort v48, v44, s[36:37] offset:0
    global_load_ushort v49, v44, s[36:37] offset:8
    global_load_ushort v50, v44, s[36:37] offset:16
    global_load_ushort v51, v44, s[36:37] offset:24
    global_load_ushort v52, v44, s[36:37] offset:32
    global_load_ushort v53, v44, s[36:37] offset:40
    global_load_ushort v54, v44, s[36:37] offset:48
    global_load_ushort v55, v44, s[36:37] offset:56
    global_load_ushort v56, v44, s[36:37] offset:64
    global_load_ushort v57, v44, s[36:37] offset:72
    global_load_ushort v58, v44, s[36:37] offset:80
    global_load_ushort v59, v44, s[36:37] offset:88
    global_load_ushort v60, v44, s[36:37] offset:96
    global_load_ushort v61, v44, s[36:37] offset:104
    global_load_ushort v62, v44, s[36:37] offset:112
    global_load_ushort v63, v44, s[36:37] offset:120
ka_pk:
    s_waitcnt vmcnt(0)
    v_lshl_or_b32 v64, v49, 16, v48
    v_lshl_or_b32 v65, v51, 16, v50
    v_lshl_or_b32 v66, v53, 16, v52
    v_lshl_or_b32 v67, v55, 16, v54
    v_lshl_or_b32 v68, v57, 16, v56
    v_lshl_or_b32 v69, v59, 16, v58
    v_lshl_or_b32 v70, v61, 16, v60
    v_lshl_or_b32 v71, v63, 16, v62
    global_store_dwordx4 v46, v[64:67], s[14:15]
    global_store_dwordx4 v46, v[68:71], s[14:15] offset:1024
    s_endpgm
ka_dum:
    v_mov_b32 v46, 11677696
    v_mov_b32 v48, 0
    v_mov_b32 v49, 0
    v_mov_b32 v50, 0
    v_mov_b32 v51, 0
    v_mov_b32 v52, 0x3fff
    v_mov_b32 v53, 186843136
    s_mov_b64 exec, 1
    s_waitcnt lgkmcnt(0)
    global_store_dwordx4 v46, v[48:51], s[14:15]
    global_store_dwordx4 v46, v[48:51], s[14:15] offset:16
    global_store_dwordx4 v46, v[50:53], s[14:15] offset:32
ka_end:
    s_endpgm
.globl main_kernel
.p2align 8
.type main_kernel,@function
main_kernel:
    s_cmp_ge_u32 s2, 256
    s_cbranch_scc1 mn_end
    s_load_dwordx2 s[54:55], s[0:1], 80
    s_load_dwordx2 s[50:51], s[0:1], 0
    v_lshrrev_b32 v56, 6, v0
    s_and_b32 s48, s2, 7
    v_readfirstlane_b32 s16, v56
    s_lshr_b32 s47, s2, 3
    s_lshl_b32 s25, s48, 5
    s_add_u32 s25, s25, s47
    s_lshl_b32 s49, s25, 13
    s_add_u32 s49, s49, 8388608
    s_mov_b32 s22, s49
    s_lshl_b32 s25, s25, 9
    s_add_u32 s25, s25, 10485760
    s_mov_b32 s10, 12582912
    s_mov_b32 s11, 0x20000
    s_and_b32 s17, s16, 3
    s_movk_i32 s20, 20
    s_mov_b32 s24, 0
    s_cmp_ge_u32 s16, 8
    s_cbranch_scc1 gm_main
    v_lshrrev_b32 v56, 6, v0
    v_lshlrev_b32 v55, 1, v0
    v_and_b32 v55, 0x78, v55
    v_or_b32 v55, v55, v56
    v_cmp_gt_u32 vcc, 125, v55
    v_mul_u32_u24 v46, 5120, v55
    v_add_u32 v46, 7340032, v46
    v_bfrev_b32 v56, 2
    v_lshlrev_b32 v55, 4, v0
    v_and_b32 v57, 0x1fc, v0
    v_cndmask_b32 v55, v56, v55, vcc
    v_cndmask_b32 v57, v56, v57, vcc
    v_and_b32 v51, 63, v0
    v_lshlrev_b32 v56, 3, v51
    s_lshl_b32 s52, s17, 11
    s_add_u32 s52, s52, 11665408
    s_mov_b32 s53, 11673600
    v_lshlrev_b32 v52, 4, v51
    s_waitcnt lgkmcnt(0)
    s_mov_b32 s8, s54
    s_and_b32 s9, s55, 0xffff
    buffer_load_dwordx4 v[20:23], v55, s[8:11], s49 offen
    buffer_load_dword v58, v57, s[8:11], s25 offen
    buffer_load_dwordx2 v[44:45], v56, s[8:11], s25 offen
    s_barrier
    buffer_load_dwordx4 v[68:71], v52, s[8:11], s52 offen
    buffer_load_dwordx4 v[72:75], v52, s[8:11], s52 offen offset:1024
    buffer_load_dwordx4 v[76:79], v52, s[8:11], s53 offen
    buffer_load_dwordx4 v[80:83], v52, s[8:11], s53 offen offset:1024
    v_mov_b32 v24, 0
    s_lshr_b32 s18, s16, 2
    s_lshl_b32 s53, s17, 7
    s_add_u32 s4, s50, s53
    s_addc_u32 s5, s51, 0
    s_and_b32 s5, s5, 0xffff
    s_or_b32 s5, s5, 0x08000000
    s_movk_i32 s6, 10000
    s_mov_b32 s7, 0x20000
    s_mul_i32 s40, s16, 15360
    s_add_u32 s40, s40, 40960
    v_lshl_add_u32 v87, v51, 3, s40
    s_add_u32 s40, s40, 9216
    s_add_u32 s41, s40, 1024
    s_add_u32 s42, s40, 2048
    s_add_u32 s43, s40, 3072
    s_add_u32 s44, s40, 4096
    s_add_u32 s45, s40, 5120
    v_and_b32 v55, 3, v0
    v_bfe_u32 v56, v0, 2, 2
    v_bfe_u32 v57, v0, 4, 1
    v_bfe_u32 v53, v0, 5, 1
    v_lshlrev_b32 v1, 3, v55
    v_lshl_add_u32 v1, v57, 5, v1
    v_lshl_add_u32 v1, v56, 6, v1
    v_lshl_add_u32 v1, v53, 8, v1
    v_add_u32 v1, s40, v1
    v_lshlrev_b32 v5, 4, v55
    v_lshl_add_u32 v5, v57, 6, v5
    v_lshl_add_u32 v5, v56, 9, v5
    v_mov_b32 v7, v5
    v_bfe_u32 v55, v0, 2, 1
    v_lshlrev_b32 v86, 4, v53
    v_lshl_or_b32 v86, v55, 18, v86
    v_mov_b32 v48, 1
    v_lshlrev_b32 v47, 2, v51
    v_bfe_u32 v2, v0, 5, 1
    v_bfe_u32 v3, v0, 3, 2
    v_and_b32 v35, 3, v0
    v_lshl_add_u32 v3, v3, 2, v35
    v_mul_u32_u24 v49, 20, v2
    v_lshrrev_b32 v18, 2, v51
    v_lshl_add_u32 v18, v35, 4, v18
    v_mov_b32 v50, 0x3fff
    s_lshl_b32 s52, s16, 3
    s_bfm_b64 s[36:37], s52, 0
    s_andn2_b32 s39, s37, 2155905024
    s_mov_b32 s38, s36
    v_mov_b64 v[88:89], 0
    v_mov_b64 v[90:91], 0
    v_mov_b64 v[92:93], 0
    v_mov_b64 v[94:95], 0
    v_mov_b64 v[96:97], 0
    v_mov_b64 v[98:99], 0
    v_mov_b64 v[100:101], 0
    v_mov_b64 v[102:103], 0
    v_mov_b64 v[104:105], 0
    v_mov_b64 v[106:107], 0
    v_mov_b64 v[108:109], 0
    v_mov_b64 v[110:111], 0
    v_mov_b64 v[112:113], 0
    v_mov_b64 v[114:115], 0
    v_mov_b64 v[116:117], 0
    v_mov_b64 v[118:119], 0
    v_mov_b64 v[120:121], 0
    v_mov_b64 v[122:123], 0
    v_mov_b64 v[124:125], 0
    v_mov_b64 v[126:127], 0
    v_mov_b64 v[128:129], 0
    v_mov_b64 v[130:131], 0
    v_mov_b64 v[132:133], 0
    v_mov_b64 v[134:135], 0
    v_mov_b64 v[136:137], 0
    v_mov_b64 v[138:139], 0
    v_mov_b64 v[140:141], 0
    v_mov_b64 v[142:143], 0
    v_mov_b64 v[144:145], 0
    v_mov_b64 v[146:147], 0
    v_mov_b64 v[148:149], 0
    v_mov_b64 v[150:151], 0
    v_mov_b64 v[152:153], 0
    v_mov_b64 v[154:155], 0
    v_mov_b64 v[156:157], 0
    v_mov_b64 v[158:159], 0
    v_mov_b64 v[160:161], 0
    v_mov_b64 v[162:163], 0
    v_mov_b64 v[164:165], 0
    v_mov_b64 v[166:167], 0
    s_mov_b32 s52, 0x110000
    s_waitcnt vmcnt(4)
    v_cmp_le_u32 vcc, s52, v58
    s_cbranch_vccnz mn_w5
mn_count:
    v_cmpx_gt_i32 vcc, 0, v20
    s_cbranch_execz mn_cn_done
    v_lshrrev_b32 v25, 23, v20
    v_and_b32 v25, 0xfc, v25
    ds_add_rtn_u32 v30, v25, v48
    v_cmpx_gt_i32 vcc, 0, v21
    s_cbranch_execz mn_cn_done
    v_lshrrev_b32 v26, 23, v21
    v_and_b32 v26, 0xfc, v26
    ds_add_rtn_u32 v31, v26, v48
    v_cmpx_gt_i32 vcc, 0, v22
    s_cbranch_execz mn_cn_done
    v_lshrrev_b32 v27, 23, v22
    v_and_b32 v27, 0xfc, v27
    ds_add_rtn_u32 v32, v27, v48
    v_cmpx_gt_i32 vcc, 0, v23
    s_cbranch_execz mn_cn_done
    v_lshrrev_b32 v28, 23, v23
    v_and_b32 v28, 0xfc, v28
    ds_add_rtn_u32 v33, v28, v48
    v_cmpx_gt_i32 vcc, 0, v24
    s_cbranch_execz mn_cn_done
    v_lshrrev_b32 v29, 23, v24
    v_and_b32 v29, 0xfc, v29
    ds_add_rtn_u32 v34, v29, v48
mn_cn_done:
    s_mov_b64 exec, -1
    v_lshrrev_b32 v42, 16, v58
    v_subrev_u32 v42, s24, v42
    v_med3_i32 v42, v42, 0, s20
    v_lshrrev_b32 v55, 16, v44
    v_subrev_u32 v55, s24, v55
    v_med3_i32 v55, v55, 0, s20
    v_lshrrev_b32 v56, 16, v45
    v_subrev_u32 v56, s24, v56
    v_med3_i32 v56, v56, 0, s20
    v_mov_b32 v43, v42
    v_cndmask_b32 v55, 0, v55, s[36:37]
    v_cndmask_b32 v56, 0, v56, s[38:39]
    v_add_u32 v59, v55, v56
    v_mov_b32 v52, 0
    s_lshl_b32 s52, s18, 5
    s_add_u32 s53, s52, 31
    s_waitcnt lgkmcnt(0)
    s_barrier
    ds_read_b32 v53, v47 offset:0
    ds_read_b32 v52, v52 offset:272
    v_add_u32_dpp v59, v59, v59 row_shr:1 row_mask:0xf bank_mask:0xf
    s_nop 1
    v_add_u32_dpp v59, v59, v59 row_shr:2 row_mask:0xf bank_mask:0xf
    s_nop 1
    v_add_u32_dpp v59, v59, v59 row_shr:4 row_mask:0xf bank_mask:0xf
    v_add_u32_dpp v43, v43, v43 row_shr:4 row_mask:0xf bank_mask:0xf
    s_nop 0
    v_add_u32_dpp v59, v59, v59 row_shr:8 row_mask:0xf bank_mask:0xf
    v_add_u32_dpp v43, v43, v43 row_shr:8 row_mask:0xf bank_mask:0xf
    s_nop 0
    v_add_u32_dpp v59, v59, v59 row_bcast:15 row_mask:0xa bank_mask:0xf
    v_add_u32_dpp v43, v43, v43 row_bcast:15 row_mask:0xa bank_mask:0xf
    s_nop 0
    v_add_u32_dpp v59, v59, v59 row_bcast:31 row_mask:0xc bank_mask:0xf
    v_add_u32_dpp v43, v43, v43 row_bcast:31 row_mask:0xc bank_mask:0xf
    s_nop 0
    v_readlane_b32 s49, v59, 63
    v_sub_u32 v41, v43, v42
    s_movk_i32 s48, 0x3fff
    s_waitcnt lgkmcnt(1)
    v_mov_b32 v54, v53
    v_sub_u32 v53, v49, v53
    v_add3_u32 v41, v41, v35, s49
    v_add_u32_dpp v54, v54, v54 row_shr:1 row_mask:0xf bank_mask:0xf
    v_add_u32 v41, 72, v41
    v_lshlrev_b32 v41, 16, v41
    v_add_u32_dpp v54, v54, v54 row_shr:2 row_mask:0xf bank_mask:0xf
    v_and_or_b32 v36, v20, s48, v41
    v_add_u32 v41, 262144, v41
    v_add_u32_dpp v54, v54, v54 row_shr:4 row_mask:0xf bank_mask:0xf
    v_and_or_b32 v37, v21, s48, v41
    v_add_u32 v41, 262144, v41
    v_add_u32_dpp v54, v54, v54 row_shr:8 row_mask:0xf bank_mask:0xf
    v_and_or_b32 v38, v22, s48, v41
    v_add_u32 v41, 262144, v41
    v_add_u32_dpp v54, v54, v54 row_bcast:15 row_mask:0xa bank_mask:0xf
    v_and_or_b32 v39, v23, s48, v41
    v_add_u32 v41, 262144, v41
    v_add_u32_dpp v54, v54, v54 row_bcast:31 row_mask:0xc bank_mask:0xf
    v_add_u32 v53, v53, v54
    v_add_u32 v54, v54, v49
    ds_bpermute_b32 v25, v25, v53
    ds_bpermute_b32 v26, v26, v53
    ds_bpermute_b32 v27, v27, v53
    ds_bpermute_b32 v28, v28, v53
    ds_bpermute_b32 v29, v29, v53
    v_and_or_b32 v40, v24, s48, v41
    v_bfe_u32 v56, v20, 14, 5
    v_lshl_or_b32 v36, v56, 26, v36
    v_bfe_u32 v56, v21, 14, 5
    v_lshl_or_b32 v37, v56, 26, v37
    v_bfe_u32 v56, v22, 14, 5
    v_lshl_or_b32 v38, v56, 26, v38
    v_bfe_u32 v56, v23, 14, 5
    v_lshl_or_b32 v39, v56, 26, v39
    v_bfe_u32 v56, v24, 14, 5
    v_lshl_or_b32 v40, v56, 26, v40
    v_readlane_b32 s23, v54, 63
    v_readlane_b32 s33, v54, s53
    v_readlane_b32 s32, v53, s52
    s_cmp_gt_u32 s23, 793
    s_cbranch_scc1 mn_ovf
    v_add_lshl_u32 v55, s33, v51, 2
    s_mov_b32 exec_lo, 1048575
    s_mov_b32 exec_hi, 0
    ds_write_b32 v55, v50 offset:512
    s_mov_b64 exec, -1
    v_add_lshl_u32 v2, s32, v2, 2
    v_add_lshl_u32 v3, s32, v3, 2
    v_add_lshl_u32 v18, s32, v18, 2
    s_waitcnt lgkmcnt(1)
    v_readfirstlane_b32 s21, v52
    v_cmpx_gt_i32 vcc, 0, v20
    s_cbranch_execz mn_w2_done
    v_add_lshl_u32 v25, v25, v30, 2
    ds_write_b32 v25, v36 offset:512
    v_cmpx_gt_i32 vcc, 0, v21
    s_cbranch_execz mn_w2_done
    v_add_lshl_u32 v26, v26, v31, 2
    ds_write_b32 v26, v37 offset:512
    v_cmpx_gt_i32 vcc, 0, v22
    s_cbranch_execz mn_w2_done
    v_add_lshl_u32 v27, v27, v32, 2
    ds_write_b32 v27, v38 offset:512
    v_cmpx_gt_i32 vcc, 0, v23
    s_cbranch_execz mn_w2_done
    v_add_lshl_u32 v28, v28, v33, 2
    ds_write_b32 v28, v39 offset:512
    v_cmpx_gt_i32 vcc, 0, v24
    s_cbranch_execz mn_w2_done
    v_add_lshl_u32 v29, v29, v34, 2
    ds_write_b32 v29, v40 offset:512
mn_w2_done:
    s_mov_b64 exec, -1
    s_mov_b32 m0, s40
    s_sub_u32 s32, s32, 3
    s_sub_u32 s59, s33, s32
    s_lshr_b32 s59, s59, 2
    s_waitcnt lgkmcnt(0)
    s_barrier
    ds_read_u16 v4, v2 offset:512
    ds_read_u16 v6, v2 offset:520
    ds_read_u16 v8, v18 offset:514
    ds_read_u16 v84, v3 offset:514
    ds_read_u16 v22, v2 offset:528
    ds_read_u16 v23, v2 offset:536
    ds_read_u16 v24, v2 offset:544
    ds_read_u16 v25, v2 offset:552
    ds_read_u16 v26, v2 offset:560
    ds_read_u16 v27, v2 offset:568
    s_sub_u32 s53, s53, 4
    v_readlane_b32 s84, v54, s53
    s_add_u32 s53, s53, 1
    v_readlane_b32 s85, v54, s53
    s_add_u32 s53, s53, 1
    v_readlane_b32 s86, v54, s53
    s_add_u32 s53, s53, 1
    v_readlane_b32 s87, v54, s53
    s_waitcnt lgkmcnt(8)
    buffer_load_dwordx4 v[4:5], s[4:7], 0 idxen offen lds
    s_mov_b32 m0, s41
    s_waitcnt lgkmcnt(6)
    buffer_load_dwordx4 v[6:7], s[4:7], 0 idxen offen lds
    v_lshrrev_b32 v11, 8, v8
    v_and_b32 v8, 0x3ff, v8
    v_mul_u32_u24 v8, 48, v8
    v_and_b32 v84, 0x3ff, v84
    v_mad_u32_u24 v84, v84, 48, v86
    v_xor_b32 v85, 0x40000, v84
    s_waitcnt lgkmcnt(0)
    s_mov_b32 m0, s42
    v_mov_b32 v4, v22
    buffer_load_dwordx4 v[4:5], s[4:7], 0 idxen offen lds
    s_mov_b32 m0, s43
    v_mov_b32 v4, v23
    buffer_load_dwordx4 v[4:5], s[4:7], 0 idxen offen lds
    s_setprio 2
    s_waitcnt vmcnt(4) lgkmcnt(0)
    s_barrier
    ds_read_b64 v[8:9], v8 offset:352
    ds_read_b128 v[60:63], v84 offset:320
    ds_read_b128 v[64:67], v85 offset:320
    s_mov_b32 m0, s44
    v_mov_b32 v4, v24
    buffer_load_dwordx4 v[4:5], s[4:7], 0 idxen offen lds
    s_mov_b32 m0, s45
    v_mov_b32 v4, v25
    buffer_load_dwordx4 v[4:5], s[4:7], 0 idxen offen lds
    v_mov_b32 v4, v26
    v_mov_b32 v6, v27
    s_waitcnt vmcnt(4)
    ds_read_b64_tr_b16 v[20:21], v1 offset:0
    ds_read_b64_tr_b16 v[22:23], v1 offset:512
    ds_read_b64_tr_b16 v[24:25], v1 offset:1024
    ds_read_b64_tr_b16 v[26:27], v1 offset:1536
    s_waitcnt lgkmcnt(6)
    v_mfma_f32_4x4x4_16b_bf16 v[28:31], v[8:9], v[76:77], 0
    v_mfma_f32_4x4x4_16b_bf16 v[32:35], v[8:9], v[78:79], 0
    v_mfma_f32_4x4x4_16b_bf16 v[36:39], v[8:9], v[80:81], 0
    v_mfma_f32_4x4x4_16b_bf16 v[40:43], v[8:9], v[82:83], 0
    v_min_u32 v0, 1, v51
    v_lshlrev_b32 v0, 18, v0
    v_lshl_add_u32 v0, s17, 2, v0
    s_lshl_b32 s52, s18, 1
    s_sub_i32 s52, 1, s52
    s_mul_i32 s53, s52, s59
    s_add_i32 s53, s53, 0
    v_mov_b32 v19, s53
    v_and_b32 v11, 0x7c, v11
    v_or_b32 v11, 0xc000, v11
    v_lshlrev_b32 v10, 16, v11
    s_waitcnt lgkmcnt(4)
    v_mfma_f32_32x32x16_bf16 v[44:59], v[60:63], v[68:71], 0
    v_mfma_f32_32x32x16_bf16 v[44:59], v[64:67], v[72:75], v[44:59]
    s_mov_b32 m0, s40
    s_waitcnt lgkmcnt(0)
    buffer_load_dwordx4 v[4:5], s[4:7], 0 idxen offen lds
    s_mov_b32 m0, s41
    ds_add_u32 v0, v19 offset:288
    buffer_load_dwordx4 v[6:7], s[4:7], 0 idxen offen lds
    v_or_b32_dpp v19, v10, v11 row_shl:4 row_mask:0xf bank_mask:0xf bound_ctrl:0
    v_cvt_pk_bf16_f32 v12, v28, v32
    v_cvt_pk_bf16_f32 v14, v29, v33
    v_cvt_pk_bf16_f32 v16, v30, v34
    v_cvt_pk_bf16_f32 v13, v36, v40
    v_cvt_pk_bf16_f32 v15, v37, v41
    v_cvt_pk_bf16_f32 v17, v38, v42
    s_sub_u32 s84, s84, s32
    s_lshr_b32 s84, s84, 2
    s_sub_u32 s85, s85, s32
    s_lshr_b32 s85, s85, 2
    s_sub_u32 s86, s86, s32
    s_lshr_b32 s86, s86, 2
    s_sub_u32 s87, s87, s32
    s_lshr_b32 s87, s87, 2
    s_sub_u32 s88, s59, s87
    s_sub_u32 s87, s87, s86
    s_sub_u32 s86, s86, s85
    s_sub_u32 s85, s85, s84
    s_cmp_lg_u32 s21, 0
    s_cselect_b32 s19, s59, s84
    s_mov_b32 s58, 0
    s_mov_b32 s35, 0
    s_mov_b64 s[46:47], -1
    s_sub_i32 s34, s59, 4
    s_max_i32 s34, s34, 0
    s_mul_i32 s30, s52, -4
    s_lshl_b32 s26, s18, 31
    s_set_gpr_idx_on s40, gpr_idx(SRC2,DST)
    s_sub_u32 s19, s19, 1
    s_cbranch_scc1 mn_st12
mn_st12_back:
mn_loop:
    v_mfma_f32_4x4x4_16b_bf16 v[28:31], v[12:13], v[20:21], 0 cbsz:4 abid:0
    v_mfma_f32_4x4x4_16b_bf16 v[32:35], v[12:13], v[22:23], 0 cbsz:4 abid:1
    v_mfma_f32_4x4x4_16b_bf16 v[36:39], v[12:13], v[24:25], 0 cbsz:4 abid:2
    v_mfma_f32_4x4x4_16b_bf16 v[40:43], v[12:13], v[26:27], 0 cbsz:4 abid:3
    ds_read_u16 v4, v2 offset:576
    ds_read_u16 v6, v2 offset:584
    v_readlane_b32 s28, v19, 0
    v_readlane_b32 s29, v19, 8
    s_waitcnt vmcnt(5)
    ds_read_b64_tr_b16 v[20:21], v1 offset:2048
    ds_read_b64_tr_b16 v[22:23], v1 offset:2560
    s_waitcnt vmcnt(4)
    ds_read_b64_tr_b16 v[24:25], v1 offset:3072
    ds_read_b64_tr_b16 v[26:27], v1 offset:3584
    s_sub_u32 s34, s34, 1
    s_cmov_b32 s35, 0x30000
    s_mov_b32 m0, s28
    v_fmac_f32 v88, v28, v44
    v_fmac_f32 v89, v29, v44
    v_fmac_f32 v90, v30, v44
    v_fmac_f32 v91, v31, v44
    s_lshr_b32 m0, s28, 16
    v_fmac_f32 v88, v32, v45
    v_fmac_f32 v89, v33, v45
    v_fmac_f32 v90, v34, v45
    v_fmac_f32 v91, v35, v45
    s_mov_b32 m0, s29
    v_fmac_f32 v88, v36, v46
    v_fmac_f32 v89, v37, v46
    v_fmac_f32 v90, v38, v46
    v_fmac_f32 v91, v39, v46
    s_lshr_b32 m0, s29, 16
    v_fmac_f32 v88, v40, v47
    v_fmac_f32 v89, v41, v47
    v_fmac_f32 v90, v42, v47
    v_fmac_f32 v91, v43, v47
    s_or_b32 m0, s42, s35
    s_waitcnt lgkmcnt(2)
    buffer_load_dwordx4 v[4:5], s[4:7], 0 idxen offen lds
    s_or_b32 m0, s43, s35
    s_waitcnt lgkmcnt(0)
    buffer_load_dwordx4 v[6:7], s[4:7], 0 idxen offen lds
    s_sub_u32 s19, s19, 1
    s_cbranch_scc1 mn_st0
mn_st0_back:
    v_mfma_f32_4x4x4_16b_bf16 v[28:31], v[12:13], v[20:21], 0 cbsz:4 abid:4
    v_mfma_f32_4x4x4_16b_bf16 v[32:35], v[12:13], v[22:23], 0 cbsz:4 abid:5
    v_mfma_f32_4x4x4_16b_bf16 v[36:39], v[12:13], v[24:25], 0 cbsz:4 abid:6
    v_mfma_f32_4x4x4_16b_bf16 v[40:43], v[12:13], v[26:27], 0 cbsz:4 abid:7
    ds_read_u16 v4, v2 offset:592
    ds_read_u16 v6, v2 offset:600
    v_readlane_b32 s28, v19, 16
    v_readlane_b32 s29, v19, 24
    ds_read_u16 v84, v3 offset:578
    s_waitcnt vmcnt(5)
    ds_read_b64_tr_b16 v[20:21], v1 offset:4096
    ds_read_b64_tr_b16 v[22:23], v1 offset:4608
    s_waitcnt vmcnt(4)
    ds_read_b64_tr_b16 v[24:25], v1 offset:5120
    ds_read_b64_tr_b16 v[26:27], v1 offset:5632
    s_sub_u32 s34, s34, 1
    s_cmov_b32 s35, 0x30000
    s_mov_b32 m0, s28
    v_fmac_f32 v88, v28, v48
    v_fmac_f32 v89, v29, v48
    v_fmac_f32 v90, v30, v48
    v_fmac_f32 v91, v31, v48
    s_lshr_b32 m0, s28, 16
    v_fmac_f32 v88, v32, v49
    v_fmac_f32 v89, v33, v49
    v_fmac_f32 v90, v34, v49
    v_fmac_f32 v91, v35, v49
    s_mov_b32 m0, s29
    v_fmac_f32 v88, v36, v50
    v_fmac_f32 v89, v37, v50
    v_fmac_f32 v90, v38, v50
    v_fmac_f32 v91, v39, v50
    s_lshr_b32 m0, s29, 16
    v_fmac_f32 v88, v40, v51
    v_fmac_f32 v89, v41, v51
    v_fmac_f32 v90, v42, v51
    v_fmac_f32 v91, v43, v51
    s_or_b32 m0, s44, s35
    s_waitcnt lgkmcnt(2)
    buffer_load_dwordx4 v[4:5], s[4:7], 0 idxen offen lds
    s_or_b32 m0, s45, s35
    s_waitcnt lgkmcnt(0)
    buffer_load_dwordx4 v[6:7], s[4:7], 0 idxen offen lds
    s_sub_u32 s19, s19, 1
    s_cbranch_scc1 mn_st1
mn_st1_back:
    v_mfma_f32_4x4x4_16b_bf16 v[28:31], v[12:13], v[20:21], 0 cbsz:4 abid:8
    v_mfma_f32_4x4x4_16b_bf16 v[32:35], v[12:13], v[22:23], 0 cbsz:4 abid:9
    v_mfma_f32_4x4x4_16b_bf16 v[36:39], v[12:13], v[24:25], 0 cbsz:4 abid:10
    v_mfma_f32_4x4x4_16b_bf16 v[40:43], v[12:13], v[26:27], 0 cbsz:4 abid:11
    ds_read_u16 v4, v2 offset:608
    ds_read_u16 v6, v2 offset:616
    v_readlane_b32 s28, v19, 32
    v_readlane_b32 s29, v19, 40
    v_and_b32 v84, 0x3ff, v84
    v_mad_u32_u24 v84, v84, 48, v86
    v_xor_b32 v85, 0x40000, v84
    ds_read_b128 v[60:63], v84 offset:320
    ds_read_b128 v[64:67], v85 offset:320
    s_waitcnt vmcnt(5)
    ds_read_b64_tr_b16 v[20:21], v1 offset:0
    ds_read_b64_tr_b16 v[22:23], v1 offset:512
    s_waitcnt vmcnt(4)
    ds_read_b64_tr_b16 v[24:25], v1 offset:1024
    ds_read_b64_tr_b16 v[26:27], v1 offset:1536
    s_sub_u32 s34, s34, 1
    s_cmov_b32 s35, 0x30000
    s_mov_b32 m0, s28
    v_fmac_f32 v88, v28, v52
    v_fmac_f32 v89, v29, v52
    v_fmac_f32 v90, v30, v52
    v_fmac_f32 v91, v31, v52
    s_lshr_b32 m0, s28, 16
    v_fmac_f32 v88, v32, v53
    v_fmac_f32 v89, v33, v53
    v_fmac_f32 v90, v34, v53
    v_fmac_f32 v91, v35, v53
    s_mov_b32 m0, s29
    v_fmac_f32 v88, v36, v54
    v_fmac_f32 v89, v37, v54
    v_fmac_f32 v90, v38, v54
    v_fmac_f32 v91, v39, v54
    s_lshr_b32 m0, s29, 16
    v_fmac_f32 v88, v40, v55
    v_fmac_f32 v89, v41, v55
    v_fmac_f32 v90, v42, v55
    v_fmac_f32 v91, v43, v55
    s_or_b32 m0, s40, s35
    s_waitcnt lgkmcnt(2)
    buffer_load_dwordx4 v[4:5], s[4:7], 0 idxen offen lds
    s_or_b32 m0, s41, s35
    s_waitcnt lgkmcnt(0)
    buffer_load_dwordx4 v[6:7], s[4:7], 0 idxen offen lds
    s_sub_u32 s19, s19, 1
    s_cbranch_scc1 mn_st2
mn_st2_back:
    v_mfma_f32_4x4x4_16b_bf16 v[28:31], v[12:13], v[20:21], 0 cbsz:4 abid:12
    v_mfma_f32_4x4x4_16b_bf16 v[32:35], v[12:13], v[22:23], 0 cbsz:4 abid:13
    v_mfma_f32_4x4x4_16b_bf16 v[36:39], v[12:13], v[24:25], 0 cbsz:4 abid:14
    v_mfma_f32_4x4x4_16b_bf16 v[40:43], v[12:13], v[26:27], 0 cbsz:4 abid:15
    ds_read_u16 v4, v2 offset:624
    ds_read_u16 v6, v2 offset:632
    v_readlane_b32 s28, v19, 48
    v_readlane_b32 s29, v19, 56
    v_mov_b32 v85, s30
    ds_add_rtn_u32 v85, v0, v85 offset:288
    s_waitcnt vmcnt(5)
    ds_read_b64_tr_b16 v[20:21], v1 offset:2048
    ds_read_b64_tr_b16 v[22:23], v1 offset:2560
    s_waitcnt vmcnt(4)
    ds_read_b64_tr_b16 v[24:25], v1 offset:3072
    ds_read_b64_tr_b16 v[26:27], v1 offset:3584
    s_sub_u32 s34, s34, 1
    s_cmov_b32 s35, 0x30000
    s_mov_b32 m0, s28
    v_fmac_f32 v88, v28, v56
    v_fmac_f32 v89, v29, v56
    v_fmac_f32 v90, v30, v56
    v_fmac_f32 v91, v31, v56
    s_lshr_b32 m0, s28, 16
    v_fmac_f32 v88, v32, v57
    v_fmac_f32 v89, v33, v57
    v_fmac_f32 v90, v34, v57
    v_fmac_f32 v91, v35, v57
    s_mov_b32 m0, s29
    v_fmac_f32 v88, v36, v58
    v_fmac_f32 v89, v37, v58
    v_fmac_f32 v90, v38, v58
    v_fmac_f32 v91, v39, v58
    s_lshr_b32 m0, s29, 16
    v_fmac_f32 v88, v40, v59
    v_fmac_f32 v89, v41, v59
    v_fmac_f32 v90, v42, v59
    v_fmac_f32 v91, v43, v59
    s_or_b32 m0, s42, s35
    v_mfma_f32_32x32x16_bf16 v[44:59], v[60:63], v[68:71], 0
    v_mfma_f32_32x32x16_bf16 v[44:59], v[64:67], v[72:75], v[44:59]
    s_waitcnt lgkmcnt(2)
    buffer_load_dwordx4 v[4:5], s[4:7], 0 idxen offen lds
    s_or_b32 m0, s43, s35
    s_waitcnt lgkmcnt(0)
    buffer_load_dwordx4 v[6:7], s[4:7], 0 idxen offen lds
    v_readfirstlane_b32 s27, v85
    s_setprio 2
    s_xor_b32 s27, s27, s26
    s_cmp_ge_i32 s27, 0
    s_cbranch_scc1 mn_pr3
    s_setprio 1
mn_pr3:
    s_sub_u32 s19, s19, 1
    s_cbranch_scc1 mn_st3
mn_st3_back:
    v_mfma_f32_4x4x4_16b_bf16 v[28:31], v[14:15], v[20:21], 0 cbsz:4 abid:0
    v_mfma_f32_4x4x4_16b_bf16 v[32:35], v[14:15], v[22:23], 0 cbsz:4 abid:1
    v_mfma_f32_4x4x4_16b_bf16 v[36:39], v[14:15], v[24:25], 0 cbsz:4 abid:2
    v_mfma_f32_4x4x4_16b_bf16 v[40:43], v[14:15], v[26:27], 0 cbsz:4 abid:3
    ds_read_u16 v4, v2 offset:640
    ds_read_u16 v6, v2 offset:648
    v_readlane_b32 s28, v19, 1
    v_readlane_b32 s29, v19, 9
    s_waitcnt vmcnt(5)
    ds_read_b64_tr_b16 v[20:21], v1 offset:4096
    ds_read_b64_tr_b16 v[22:23], v1 offset:4608
    s_waitcnt vmcnt(4)
    ds_read_b64_tr_b16 v[24:25], v1 offset:5120
    ds_read_b64_tr_b16 v[26:27], v1 offset:5632
    s_sub_u32 s34, s34, 1
    s_cmov_b32 s35, 0x30000
    s_mov_b32 m0, s28
    v_fmac_f32 v88, v28, v44
    v_fmac_f32 v89, v29, v44
    v_fmac_f32 v90, v30, v44
    v_fmac_f32 v91, v31, v44
    s_lshr_b32 m0, s28, 16
    v_fmac_f32 v88, v32, v45
    v_fmac_f32 v89, v33, v45
    v_fmac_f32 v90, v34, v45
    v_fmac_f32 v91, v35, v45
    s_mov_b32 m0, s29
    v_fmac_f32 v88, v36, v46
    v_fmac_f32 v89, v37, v46
    v_fmac_f32 v90, v38, v46
    v_fmac_f32 v91, v39, v46
    s_lshr_b32 m0, s29, 16
    v_fmac_f32 v88, v40, v47
    v_fmac_f32 v89, v41, v47
    v_fmac_f32 v90, v42, v47
    v_fmac_f32 v91, v43, v47
    s_or_b32 m0, s44, s35
    s_waitcnt lgkmcnt(2)
    buffer_load_dwordx4 v[4:5], s[4:7], 0 idxen offen lds
    s_or_b32 m0, s45, s35
    s_waitcnt lgkmcnt(0)
    buffer_load_dwordx4 v[6:7], s[4:7], 0 idxen offen lds
    s_sub_u32 s19, s19, 1
    s_cbranch_scc1 mn_st4
mn_st4_back:
    v_mfma_f32_4x4x4_16b_bf16 v[28:31], v[14:15], v[20:21], 0 cbsz:4 abid:4
    v_mfma_f32_4x4x4_16b_bf16 v[32:35], v[14:15], v[22:23], 0 cbsz:4 abid:5
    v_mfma_f32_4x4x4_16b_bf16 v[36:39], v[14:15], v[24:25], 0 cbsz:4 abid:6
    v_mfma_f32_4x4x4_16b_bf16 v[40:43], v[14:15], v[26:27], 0 cbsz:4 abid:7
    ds_read_u16 v4, v2 offset:656
    ds_read_u16 v6, v2 offset:664
    v_readlane_b32 s28, v19, 17
    v_readlane_b32 s29, v19, 25
    ds_read_u16 v84, v3 offset:642
    s_waitcnt vmcnt(5)
    ds_read_b64_tr_b16 v[20:21], v1 offset:0
    ds_read_b64_tr_b16 v[22:23], v1 offset:512
    s_waitcnt vmcnt(4)
    ds_read_b64_tr_b16 v[24:25], v1 offset:1024
    ds_read_b64_tr_b16 v[26:27], v1 offset:1536
    s_sub_u32 s34, s34, 1
    s_cmov_b32 s35, 0x30000
    s_mov_b32 m0, s28
    v_fmac_f32 v88, v28, v48
    v_fmac_f32 v89, v29, v48
    v_fmac_f32 v90, v30, v48
    v_fmac_f32 v91, v31, v48
    s_lshr_b32 m0, s28, 16
    v_fmac_f32 v88, v32, v49
    v_fmac_f32 v89, v33, v49
    v_fmac_f32 v90, v34, v49
    v_fmac_f32 v91, v35, v49
    s_mov_b32 m0, s29
    v_fmac_f32 v88, v36, v50
    v_fmac_f32 v89, v37, v50
    v_fmac_f32 v90, v38, v50
    v_fmac_f32 v91, v39, v50
    s_lshr_b32 m0, s29, 16
    v_fmac_f32 v88, v40, v51
    v_fmac_f32 v89, v41, v51
    v_fmac_f32 v90, v42, v51
    v_fmac_f32 v91, v43, v51
    s_or_b32 m0, s40, s35
    s_waitcnt lgkmcnt(2)
    buffer_load_dwordx4 v[4:5], s[4:7], 0 idxen offen lds
    s_or_b32 m0, s41, s35
    s_waitcnt lgkmcnt(0)
    buffer_load_dwordx4 v[6:7], s[4:7], 0 idxen offen lds
    s_sub_u32 s19, s19, 1
    s_cbranch_scc1 mn_st5
mn_st5_back:
    v_mfma_f32_4x4x4_16b_bf16 v[28:31], v[14:15], v[20:21], 0 cbsz:4 abid:8
    v_mfma_f32_4x4x4_16b_bf16 v[32:35], v[14:15], v[22:23], 0 cbsz:4 abid:9
    v_mfma_f32_4x4x4_16b_bf16 v[36:39], v[14:15], v[24:25], 0 cbsz:4 abid:10
    v_mfma_f32_4x4x4_16b_bf16 v[40:43], v[14:15], v[26:27], 0 cbsz:4 abid:11
    ds_read_u16 v4, v2 offset:672
    ds_read_u16 v6, v2 offset:680
    v_readlane_b32 s28, v19, 33
    v_readlane_b32 s29, v19, 41
    v_and_b32 v84, 0x3ff, v84
    v_mad_u32_u24 v84, v84, 48, v86
    v_xor_b32 v85, 0x40000, v84
    ds_read_b128 v[60:63], v84 offset:320
    ds_read_b128 v[64:67], v85 offset:320
    s_waitcnt vmcnt(5)
    ds_read_b64_tr_b16 v[20:21], v1 offset:2048
    ds_read_b64_tr_b16 v[22:23], v1 offset:2560
    s_waitcnt vmcnt(4)
    ds_read_b64_tr_b16 v[24:25], v1 offset:3072
    ds_read_b64_tr_b16 v[26:27], v1 offset:3584
    s_sub_u32 s34, s34, 1
    s_cmov_b32 s35, 0x30000
    s_mov_b32 m0, s28
    v_fmac_f32 v88, v28, v52
    v_fmac_f32 v89, v29, v52
    v_fmac_f32 v90, v30, v52
    v_fmac_f32 v91, v31, v52
    s_lshr_b32 m0, s28, 16
    v_fmac_f32 v88, v32, v53
    v_fmac_f32 v89, v33, v53
    v_fmac_f32 v90, v34, v53
    v_fmac_f32 v91, v35, v53
    s_mov_b32 m0, s29
    v_fmac_f32 v88, v36, v54
    v_fmac_f32 v89, v37, v54
    v_fmac_f32 v90, v38, v54
    v_fmac_f32 v91, v39, v54
    s_lshr_b32 m0, s29, 16
    v_fmac_f32 v88, v40, v55
    v_fmac_f32 v89, v41, v55
    v_fmac_f32 v90, v42, v55
    v_fmac_f32 v91, v43, v55
    s_or_b32 m0, s42, s35
    s_waitcnt lgkmcnt(2)
    buffer_load_dwordx4 v[4:5], s[4:7], 0 idxen offen lds
    s_or_b32 m0, s43, s35
    s_waitcnt lgkmcnt(0)
    buffer_load_dwordx4 v[6:7], s[4:7], 0 idxen offen lds
    s_sub_u32 s19, s19, 1
    s_cbranch_scc1 mn_st6
mn_st6_back:
    v_mfma_f32_4x4x4_16b_bf16 v[28:31], v[14:15], v[20:21], 0 cbsz:4 abid:12
    v_mfma_f32_4x4x4_16b_bf16 v[32:35], v[14:15], v[22:23], 0 cbsz:4 abid:13
    v_mfma_f32_4x4x4_16b_bf16 v[36:39], v[14:15], v[24:25], 0 cbsz:4 abid:14
    v_mfma_f32_4x4x4_16b_bf16 v[40:43], v[14:15], v[26:27], 0 cbsz:4 abid:15
    ds_read_u16 v4, v2 offset:688
    ds_read_u16 v6, v2 offset:696
    v_readlane_b32 s28, v19, 49
    v_readlane_b32 s29, v19, 57
    v_mov_b32 v85, s30
    ds_add_rtn_u32 v85, v0, v85 offset:288
    s_waitcnt vmcnt(5)
    ds_read_b64_tr_b16 v[20:21], v1 offset:4096
    ds_read_b64_tr_b16 v[22:23], v1 offset:4608
    s_waitcnt vmcnt(4)
    ds_read_b64_tr_b16 v[24:25], v1 offset:5120
    ds_read_b64_tr_b16 v[26:27], v1 offset:5632
    s_sub_u32 s34, s34, 1
    s_cmov_b32 s35, 0x30000
    s_mov_b32 m0, s28
    v_fmac_f32 v88, v28, v56
    v_fmac_f32 v89, v29, v56
    v_fmac_f32 v90, v30, v56
    v_fmac_f32 v91, v31, v56
    s_lshr_b32 m0, s28, 16
    v_fmac_f32 v88, v32, v57
    v_fmac_f32 v89, v33, v57
    v_fmac_f32 v90, v34, v57
    v_fmac_f32 v91, v35, v57
    s_mov_b32 m0, s29
    v_fmac_f32 v88, v36, v58
    v_fmac_f32 v89, v37, v58
    v_fmac_f32 v90, v38, v58
    v_fmac_f32 v91, v39, v58
    s_lshr_b32 m0, s29, 16
    v_fmac_f32 v88, v40, v59
    v_fmac_f32 v89, v41, v59
    v_fmac_f32 v90, v42, v59
    v_fmac_f32 v91, v43, v59
    s_or_b32 m0, s44, s35
    v_mfma_f32_32x32x16_bf16 v[44:59], v[60:63], v[68:71], 0
    v_mfma_f32_32x32x16_bf16 v[44:59], v[64:67], v[72:75], v[44:59]
    s_waitcnt lgkmcnt(2)
    buffer_load_dwordx4 v[4:5], s[4:7], 0 idxen offen lds
    s_or_b32 m0, s45, s35
    s_waitcnt lgkmcnt(0)
    buffer_load_dwordx4 v[6:7], s[4:7], 0 idxen offen lds
    v_readfirstlane_b32 s27, v85
    s_setprio 2
    s_xor_b32 s27, s27, s26
    s_cmp_ge_i32 s27, 0
    s_cbranch_scc1 mn_pr7
    s_setprio 1
mn_pr7:
    s_sub_u32 s19, s19, 1
    s_cbranch_scc1 mn_st7
mn_st7_back:
    v_mfma_f32_4x4x4_16b_bf16 v[28:31], v[16:17], v[20:21], 0 cbsz:4 abid:0
    v_mfma_f32_4x4x4_16b_bf16 v[32:35], v[16:17], v[22:23], 0 cbsz:4 abid:1
    v_mfma_f32_4x4x4_16b_bf16 v[36:39], v[16:17], v[24:25], 0 cbsz:4 abid:2
    v_mfma_f32_4x4x4_16b_bf16 v[40:43], v[16:17], v[26:27], 0 cbsz:4 abid:3
    ds_read_u16 v4, v2 offset:704
    ds_read_u16 v6, v2 offset:712
    v_readlane_b32 s28, v19, 2
    v_readlane_b32 s29, v19, 10
    ds_read_u16 v8, v18 offset:706
    s_waitcnt vmcnt(5)
    ds_read_b64_tr_b16 v[20:21], v1 offset:0
    ds_read_b64_tr_b16 v[22:23], v1 offset:512
    s_waitcnt vmcnt(4)
    ds_read_b64_tr_b16 v[24:25], v1 offset:1024
    ds_read_b64_tr_b16 v[26:27], v1 offset:1536
    s_sub_u32 s34, s34, 1
    s_cmov_b32 s35, 0x30000
    s_mov_b32 m0, s28
    v_fmac_f32 v88, v28, v44
    v_fmac_f32 v89, v29, v44
    v_fmac_f32 v90, v30, v44
    v_fmac_f32 v91, v31, v44
    s_lshr_b32 m0, s28, 16
    v_fmac_f32 v88, v32, v45
    v_fmac_f32 v89, v33, v45
    v_fmac_f32 v90, v34, v45
    v_fmac_f32 v91, v35, v45
    s_mov_b32 m0, s29
    v_fmac_f32 v88, v36, v46
    v_fmac_f32 v89, v37, v46
    v_fmac_f32 v90, v38, v46
    v_fmac_f32 v91, v39, v46
    s_lshr_b32 m0, s29, 16
    v_fmac_f32 v88, v40, v47
    v_fmac_f32 v89, v41, v47
    v_fmac_f32 v90, v42, v47
    v_fmac_f32 v91, v43, v47
    s_or_b32 m0, s40, s35
    s_waitcnt lgkmcnt(2)
    buffer_load_dwordx4 v[4:5], s[4:7], 0 idxen offen lds
    s_or_b32 m0, s41, s35
    s_waitcnt lgkmcnt(0)
    buffer_load_dwordx4 v[6:7], s[4:7], 0 idxen offen lds
    s_sub_u32 s19, s19, 1
    s_cbranch_scc1 mn_st8
mn_st8_back:
    v_mfma_f32_4x4x4_16b_bf16 v[28:31], v[16:17], v[20:21], 0 cbsz:4 abid:4
    v_mfma_f32_4x4x4_16b_bf16 v[32:35], v[16:17], v[22:23], 0 cbsz:4 abid:5
    v_mfma_f32_4x4x4_16b_bf16 v[36:39], v[16:17], v[24:25], 0 cbsz:4 abid:6
    v_mfma_f32_4x4x4_16b_bf16 v[40:43], v[16:17], v[26:27], 0 cbsz:4 abid:7
    ds_read_u16 v4, v2 offset:720
    ds_read_u16 v6, v2 offset:728
    v_readlane_b32 s28, v19, 18
    v_readlane_b32 s29, v19, 26
    ds_read_u16 v84, v3 offset:706
    v_lshrrev_b32 v11, 8, v8
    v_and_b32 v8, 0x3ff, v8
    v_mul_u32_u24 v8, 48, v8
    ds_read_b64 v[8:9], v8 offset:352
    s_waitcnt vmcnt(5)
    ds_read_b64_tr_b16 v[20:21], v1 offset:2048
    ds_read_b64_tr_b16 v[22:23], v1 offset:2560
    s_waitcnt vmcnt(4)
    ds_read_b64_tr_b16 v[24:25], v1 offset:3072
    ds_read_b64_tr_b16 v[26:27], v1 offset:3584
    s_sub_u32 s34, s34, 1
    s_cmov_b32 s35, 0x30000
    s_mov_b32 m0, s28
    v_fmac_f32 v88, v28, v48
    v_fmac_f32 v89, v29, v48
    v_fmac_f32 v90, v30, v48
    v_fmac_f32 v91, v31, v48
    s_lshr_b32 m0, s28, 16
    v_fmac_f32 v88, v32, v49
    v_fmac_f32 v89, v33, v49
    v_fmac_f32 v90, v34, v49
    v_fmac_f32 v91, v35, v49
    s_mov_b32 m0, s29
    v_fmac_f32 v88, v36, v50
    v_fmac_f32 v89, v37, v50
    v_fmac_f32 v90, v38, v50
    v_fmac_f32 v91, v39, v50
    s_lshr_b32 m0, s29, 16
    v_fmac_f32 v88, v40, v51
    v_fmac_f32 v89, v41, v51
    v_fmac_f32 v90, v42, v51
    v_fmac_f32 v91, v43, v51
    s_or_b32 m0, s42, s35
    s_waitcnt lgkmcnt(2)
    buffer_load_dwordx4 v[4:5], s[4:7], 0 idxen offen lds
    s_or_b32 m0, s43, s35
    s_waitcnt lgkmcnt(0)
    buffer_load_dwordx4 v[6:7], s[4:7], 0 idxen offen lds
    s_sub_u32 s19, s19, 1
    s_cbranch_scc1 mn_st9
mn_st9_back:
    v_mfma_f32_4x4x4_16b_bf16 v[28:31], v[16:17], v[20:21], 0 cbsz:4 abid:8
    v_mfma_f32_4x4x4_16b_bf16 v[32:35], v[16:17], v[22:23], 0 cbsz:4 abid:9
    v_mfma_f32_4x4x4_16b_bf16 v[36:39], v[16:17], v[24:25], 0 cbsz:4 abid:10
    v_mfma_f32_4x4x4_16b_bf16 v[40:43], v[16:17], v[26:27], 0 cbsz:4 abid:11
    ds_read_u16 v4, v2 offset:736
    ds_read_u16 v6, v2 offset:744
    v_readlane_b32 s28, v19, 34
    v_readlane_b32 s29, v19, 42
    v_and_b32 v84, 0x3ff, v84
    v_mad_u32_u24 v84, v84, 48, v86
    v_xor_b32 v85, 0x40000, v84
    ds_read_b128 v[60:63], v84 offset:320
    ds_read_b128 v[64:67], v85 offset:320
    s_waitcnt vmcnt(5)
    ds_read_b64_tr_b16 v[20:21], v1 offset:4096
    ds_read_b64_tr_b16 v[22:23], v1 offset:4608
    s_waitcnt vmcnt(4)
    ds_read_b64_tr_b16 v[24:25], v1 offset:5120
    ds_read_b64_tr_b16 v[26:27], v1 offset:5632
    s_sub_u32 s34, s34, 1
    s_cmov_b32 s35, 0x30000
    s_mov_b32 m0, s28
    v_fmac_f32 v88, v28, v52
    v_fmac_f32 v89, v29, v52
    v_fmac_f32 v90, v30, v52
    v_fmac_f32 v91, v31, v52
    s_lshr_b32 m0, s28, 16
    v_fmac_f32 v88, v32, v53
    v_fmac_f32 v89, v33, v53
    v_fmac_f32 v90, v34, v53
    v_fmac_f32 v91, v35, v53
    s_mov_b32 m0, s29
    v_fmac_f32 v88, v36, v54
    v_fmac_f32 v89, v37, v54
    v_fmac_f32 v90, v38, v54
    v_fmac_f32 v91, v39, v54
    s_lshr_b32 m0, s29, 16
    v_fmac_f32 v88, v40, v55
    v_fmac_f32 v89, v41, v55
    v_fmac_f32 v90, v42, v55
    v_fmac_f32 v91, v43, v55
    s_or_b32 m0, s44, s35
    s_waitcnt lgkmcnt(2)
    buffer_load_dwordx4 v[4:5], s[4:7], 0 idxen offen lds
    s_or_b32 m0, s45, s35
    s_waitcnt lgkmcnt(0)
    buffer_load_dwordx4 v[6:7], s[4:7], 0 idxen offen lds
    v_and_b32 v11, 0x7c, v11
    v_or_b32 v11, 0xc000, v11
    v_lshlrev_b32 v10, 16, v11
    s_sub_u32 s19, s19, 1
    s_cbranch_scc1 mn_st10
mn_st10_back:
    v_mfma_f32_4x4x4_16b_bf16 v[28:31], v[16:17], v[20:21], 0 cbsz:4 abid:12
    v_mfma_f32_4x4x4_16b_bf16 v[32:35], v[16:17], v[22:23], 0 cbsz:4 abid:13
    v_mfma_f32_4x4x4_16b_bf16 v[36:39], v[16:17], v[24:25], 0 cbsz:4 abid:14
    v_mfma_f32_4x4x4_16b_bf16 v[40:43], v[16:17], v[26:27], 0 cbsz:4 abid:15
    ds_read_u16 v4, v2 offset:752
    ds_read_u16 v6, v2 offset:760
    v_readlane_b32 s28, v19, 50
    v_readlane_b32 s29, v19, 58
    v_mov_b32 v85, s30
    ds_add_rtn_u32 v85, v0, v85 offset:288
    s_waitcnt vmcnt(5)
    ds_read_b64_tr_b16 v[20:21], v1 offset:0
    ds_read_b64_tr_b16 v[22:23], v1 offset:512
    s_waitcnt vmcnt(4)
    ds_read_b64_tr_b16 v[24:25], v1 offset:1024
    ds_read_b64_tr_b16 v[26:27], v1 offset:1536
    s_sub_u32 s34, s34, 1
    s_cmov_b32 s35, 0x30000
    s_mov_b32 m0, s28
    v_fmac_f32 v88, v28, v56
    v_fmac_f32 v89, v29, v56
    v_fmac_f32 v90, v30, v56
    v_fmac_f32 v91, v31, v56
    s_lshr_b32 m0, s28, 16
    v_fmac_f32 v88, v32, v57
    v_fmac_f32 v89, v33, v57
    v_fmac_f32 v90, v34, v57
    v_fmac_f32 v91, v35, v57
    s_mov_b32 m0, s29
    v_fmac_f32 v88, v36, v58
    v_fmac_f32 v89, v37, v58
    v_fmac_f32 v90, v38, v58
    v_fmac_f32 v91, v39, v58
    s_lshr_b32 m0, s29, 16
    v_fmac_f32 v88, v40, v59
    v_fmac_f32 v89, v41, v59
    v_fmac_f32 v90, v42, v59
    v_fmac_f32 v91, v43, v59
    s_or_b32 m0, s40, s35
    v_mfma_f32_4x4x4_16b_bf16 v[28:31], v[8:9], v[76:77], 0
    v_mfma_f32_4x4x4_16b_bf16 v[32:35], v[8:9], v[78:79], 0
    v_mfma_f32_4x4x4_16b_bf16 v[36:39], v[8:9], v[80:81], 0
    v_mfma_f32_4x4x4_16b_bf16 v[40:43], v[8:9], v[82:83], 0
    v_mfma_f32_32x32x16_bf16 v[44:59], v[60:63], v[68:71], 0
    v_mfma_f32_32x32x16_bf16 v[44:59], v[64:67], v[72:75], v[44:59]
    s_waitcnt lgkmcnt(2)
    buffer_load_dwordx4 v[4:5], s[4:7], 0 idxen offen lds
    s_or_b32 m0, s41, s35
    s_waitcnt lgkmcnt(0)
    buffer_load_dwordx4 v[6:7], s[4:7], 0 idxen offen lds
    v_cvt_pk_bf16_f32 v12, v28, v32
    v_cvt_pk_bf16_f32 v14, v29, v33
    v_cvt_pk_bf16_f32 v16, v30, v34
    v_cvt_pk_bf16_f32 v13, v36, v40
    v_cvt_pk_bf16_f32 v15, v37, v41
    v_cvt_pk_bf16_f32 v17, v38, v42
    v_or_b32_dpp v19, v10, v11 row_shl:4 row_mask:0xf bank_mask:0xf bound_ctrl:0
    v_add_u32 v2, 192, v2
    v_add_u32 v3, 192, v3
    v_add_u32 v18, 192, v18
    v_readfirstlane_b32 s27, v85
    s_setprio 2
    s_xor_b32 s27, s27, s26
    s_cmp_ge_i32 s27, 0
    s_cbranch_scc1 mn_pr11
    s_setprio 1
mn_pr11:
    s_sub_u32 s19, s19, 1
    s_cbranch_scc1 mn_st11
mn_st11_back:
    s_branch mn_loop
mn_st0:
    s_cmp_lg_u32 s21, 0
    s_cbranch_scc1 mn_next
    s_call_b64 s[48:49], mn_flush
    s_branch mn_st0_back
mn_st1:
    s_cmp_lg_u32 s21, 0
    s_cbranch_scc1 mn_next
    s_call_b64 s[48:49], mn_flush
    s_branch mn_st1_back
mn_st2:
    s_cmp_lg_u32 s21, 0
    s_cbranch_scc1 mn_next
    s_call_b64 s[48:49], mn_flush
    s_branch mn_st2_back
mn_st3:
    s_cmp_lg_u32 s21, 0
    s_cbranch_scc1 mn_next
    s_call_b64 s[48:49], mn_flush
    s_branch mn_st3_back
mn_st4:
    s_cmp_lg_u32 s21, 0
    s_cbranch_scc1 mn_next
    s_call_b64 s[48:49], mn_flush
    s_branch mn_st4_back
mn_st5:
    s_cmp_lg_u32 s21, 0
    s_cbranch_scc1 mn_next
    s_call_b64 s[48:49], mn_flush
    s_branch mn_st5_back
mn_st6:
    s_cmp_lg_u32 s21, 0
    s_cbranch_scc1 mn_next
    s_call_b64 s[48:49], mn_flush
    s_branch mn_st6_back
mn_st7:
    s_cmp_lg_u32 s21, 0
    s_cbranch_scc1 mn_next
    s_call_b64 s[48:49], mn_flush
    s_branch mn_st7_back
mn_st8:
    s_cmp_lg_u32 s21, 0
    s_cbranch_scc1 mn_next
    s_call_b64 s[48:49], mn_flush
    s_branch mn_st8_back
mn_st9:
    s_cmp_lg_u32 s21, 0
    s_cbranch_scc1 mn_next
    s_call_b64 s[48:49], mn_flush
    s_branch mn_st9_back
mn_st10:
    s_cmp_lg_u32 s21, 0
    s_cbranch_scc1 mn_next
    s_call_b64 s[48:49], mn_flush
    s_branch mn_st10_back
mn_st11:
    s_cmp_lg_u32 s21, 0
    s_cbranch_scc1 mn_next
    s_call_b64 s[48:49], mn_flush
    s_branch mn_st11_back
mn_st12:
    s_cmp_lg_u32 s21, 0
    s_cbranch_scc1 mn_next
    s_call_b64 s[48:49], mn_flush
    s_branch mn_st12_back
mn_flush:
    s_cmp_eq_u32 s58, 4
    s_cbranch_scc1 mn_fl4
    s_cmp_eq_u32 s58, 3
    s_cbranch_scc1 mn_fl3
    s_cmp_eq_u32 s58, 2
    s_cbranch_scc1 mn_fl2
    s_cmp_eq_u32 s58, 1
    s_cbranch_scc1 mn_fl1
mn_fl0:
    v_cvt_pk_bf16_f32 v88, v88, v89
    v_cvt_pk_bf16_f32 v89, v90, v91
    ds_write_b64 v87, v[88:89] offset:0
    v_cvt_pk_bf16_f32 v92, v92, v93
    v_cvt_pk_bf16_f32 v93, v94, v95
    ds_write_b64 v87, v[92:93] offset:576
    v_cvt_pk_bf16_f32 v96, v96, v97
    v_cvt_pk_bf16_f32 v97, v98, v99
    ds_write_b64 v87, v[96:97] offset:1152
    v_cvt_pk_bf16_f32 v100, v100, v101
    v_cvt_pk_bf16_f32 v101, v102, v103
    ds_write_b64 v87, v[100:101] offset:1728
    s_mul_i32 s52, s18, 3
    s_lshl_b32 s52, 1, s52
    v_mov_b32 v90, s52
    v_mov_b32 v91, 0
    s_mov_b64 exec, 1
    ds_add_u32 v91, v90 offset:276
    s_mov_b64 exec, -1
    s_add_u32 s58, s58, 1
    s_sub_u32 s19, s85, 1
    s_cbranch_scc1 mn_fl1
    s_setpc_b64 s[48:49]
mn_fl1:
    v_cvt_pk_bf16_f32 v104, v104, v105
    v_cvt_pk_bf16_f32 v105, v106, v107
    ds_write_b64 v87, v[104:105] offset:2304
    v_cvt_pk_bf16_f32 v108, v108, v109
    v_cvt_pk_bf16_f32 v109, v110, v111
    ds_write_b64 v87, v[108:109] offset:2880
    v_cvt_pk_bf16_f32 v112, v112, v113
    v_cvt_pk_bf16_f32 v113, v114, v115
    ds_write_b64 v87, v[112:113] offset:3456
    v_cvt_pk_bf16_f32 v116, v116, v117
    v_cvt_pk_bf16_f32 v117, v118, v119
    ds_write_b64 v87, v[116:117] offset:4032
    s_mul_i32 s52, s18, 3
    s_lshl_b32 s52, 64, s52
    v_mov_b32 v106, s52
    v_mov_b32 v107, 0
    s_mov_b64 exec, 1
    ds_add_u32 v107, v106 offset:276
    s_mov_b64 exec, -1
    s_add_u32 s58, s58, 1
    s_sub_u32 s19, s86, 1
    s_cbranch_scc1 mn_fl2
    s_setpc_b64 s[48:49]
mn_fl2:
    v_cvt_pk_bf16_f32 v120, v120, v121
    v_cvt_pk_bf16_f32 v121, v122, v123
    ds_write_b64 v87, v[120:121] offset:4608
    v_cvt_pk_bf16_f32 v124, v124, v125
    v_cvt_pk_bf16_f32 v125, v126, v127
    ds_write_b64 v87, v[124:125] offset:5184
    v_cvt_pk_bf16_f32 v128, v128, v129
    v_cvt_pk_bf16_f32 v129, v130, v131
    ds_write_b64 v87, v[128:129] offset:5760
    v_cvt_pk_bf16_f32 v132, v132, v133
    v_cvt_pk_bf16_f32 v133, v134, v135
    ds_write_b64 v87, v[132:133] offset:6336
    s_mul_i32 s52, s18, 3
    s_lshl_b32 s52, 4096, s52
    v_mov_b32 v122, s52
    v_mov_b32 v123, 0
    s_mov_b64 exec, 1
    ds_add_u32 v123, v122 offset:276
    s_mov_b64 exec, -1
    s_add_u32 s58, s58, 1
    s_sub_u32 s19, s87, 1
    s_cbranch_scc1 mn_fl3
    s_setpc_b64 s[48:49]
mn_fl3:
    v_cvt_pk_bf16_f32 v136, v136, v137
    v_cvt_pk_bf16_f32 v137, v138, v139
    ds_write_b64 v87, v[136:137] offset:6912
    v_cvt_pk_bf16_f32 v140, v140, v141
    v_cvt_pk_bf16_f32 v141, v142, v143
    ds_write_b64 v87, v[140:141] offset:7488
    v_cvt_pk_bf16_f32 v144, v144, v145
    v_cvt_pk_bf16_f32 v145, v146, v147
    ds_write_b64 v87, v[144:145] offset:8064
    v_cvt_pk_bf16_f32 v148, v148, v149
    v_cvt_pk_bf16_f32 v149, v150, v151
    ds_write_b64 v87, v[148:149] offset:8640
    s_mul_i32 s52, s18, 3
    s_lshl_b32 s52, 262144, s52
    v_mov_b32 v138, s52
    v_mov_b32 v139, 0
    s_mov_b64 exec, 1
    ds_add_u32 v139, v138 offset:276
    s_mov_b64 exec, -1
    s_add_u32 s58, s58, 1
    s_sub_u32 s19, s88, 1
    s_cbranch_scc1 mn_fl4
    s_setpc_b64 s[48:49]
mn_fl4:
    s_cmp_ge_u32 s59, 4
    s_cbranch_scc1 mn_fl4b
    s_waitcnt vmcnt(0)
mn_fl4b:
    v_cvt_pk_bf16_f32 v152, v152, v153
    v_cvt_pk_bf16_f32 v153, v154, v155
    ds_write_b64 v87, v[152:153] offset:9216
    v_cvt_pk_bf16_f32 v156, v156, v157
    v_cvt_pk_bf16_f32 v157, v158, v159
    ds_write_b64 v87, v[156:157] offset:9792
    v_cvt_pk_bf16_f32 v160, v160, v161
    v_cvt_pk_bf16_f32 v161, v162, v163
    ds_write_b64 v87, v[160:161] offset:10368
    v_cvt_pk_bf16_f32 v164, v164, v165
    v_cvt_pk_bf16_f32 v165, v166, v167
    ds_write_b64 v87, v[164:165] offset:10944
    s_mul_i32 s52, s18, 3
    s_lshl_b32 s52, 16777216, s52
    v_mov_b32 v154, s52
    v_mov_b32 v155, 0
    s_mov_b64 exec, 1
    ds_add_u32 v155, v154 offset:276
    s_mov_b64 exec, -1
    s_waitcnt vmcnt(0) lgkmcnt(0)
mn_end:
    s_endpgm
gm_main:
    s_load_dwordx2 s[56:57], s[0:1], 64
    v_and_b32 v3, 63, v0
    v_and_b32 v11, 0x7f, v0
    v_lshlrev_b32 v11, 2, v11
    v_mov_b32 v10, 0
    ds_write_b32 v11, v10
    v_bfe_u32 v12, v0, 1, 7
    v_and_b32 v11, 15, v12
    v_lshrrev_b32 v10, 4, v12
    v_lshl_or_b32 v11, v11, 3, v10
    v_cmp_gt_u32 vcc, 125, v11
    v_mul_u32_u24 v13, 51200, v11
    v_bfrev_b32 v10, 2
    v_lshlrev_b32 v12, 2, v12
    v_cndmask_b32 v12, v10, v12, vcc
    v_lshlrev_b32 v11, 3, v3
    v_lshlrev_b32 v2, 4, v3
    s_lshl_b32 s40, s17, 15
    s_add_u32 s40, s40, 11534336
    s_waitcnt lgkmcnt(0)
    s_mov_b32 s8, s54
    s_and_b32 s9, s55, 0xffff
    buffer_load_dword v4, v12, s[8:11], s25 offen
    buffer_load_dwordx2 v[6:7], v11, s[8:11], s25 offen
    s_barrier
    s_lshl2_add_u32 s47, s47, s17
    s_mul_i32 s47, s47, 51200
    s_mul_i32 s48, s48, 6400
    s_add_u32 s47, s47, s48
    s_sub_i32 s47, s47, 896
    s_max_i32 s47, s47, 0
    v_lshlrev_b32 v11, 7, v3
    buffer_load_dword v39, v11, s[8:11], s47 offen
    s_mul_i32 s41, s2, 625
    s_add_u32 s52, s41, 640
    s_add_u32 s41, s41, 15
    s_lshr_b32 s41, s41, 4
    s_lshr_b32 s52, s52, 4
    s_mov_b32 s12, s56
    s_and_b32 s13, s57, 0xffff
    s_lshl_b32 s14, s52, 11
    s_mov_b32 s15, 0x20000
    s_mul_i32 s42, s17, 15360
    s_add_u32 s42, s42, 40960
    s_lshl_b32 s43, s17, 4
    s_sub_u32 s43, s43, 1
    s_mov_b32 s44, -1
    s_mov_b32 s45, 2139062271
    v_add_u32 v11, 0, v3
    v_mul_u32_u24 v10, 21846, v11
    v_lshrrev_b32 v10, 16, v10
    v_lshl_add_u32 v34, v10, 2, s42
    v_mad_i32_i24 v10, v10, -3, v11
    v_lshlrev_b32 v30, 4, v10
    v_add_u32 v11, 64, v3
    v_mul_u32_u24 v10, 21846, v11
    v_lshrrev_b32 v10, 16, v10
    v_lshl_add_u32 v35, v10, 2, s42
    v_mad_i32_i24 v10, v10, -3, v11
    v_lshlrev_b32 v31, 4, v10
    v_add_u32 v11, 128, v3
    v_mul_u32_u24 v10, 21846, v11
    v_lshrrev_b32 v10, 16, v10
    v_lshl_add_u32 v36, v10, 2, s42
    v_mad_i32_i24 v10, v10, -3, v11
    v_lshlrev_b32 v32, 4, v10
    s_waitcnt vmcnt(1)
gm_pass:
    v_lshrrev_b32 v8, 16, v4
    v_subrev_u32 v8, s24, v8
    v_med3_i32 v8, v8, 0, s20
    v_lshrrev_b32 v11, 16, v6
    v_subrev_u32 v11, s24, v11
    v_med3_i32 v11, v11, 0, s20
    v_lshrrev_b32 v10, 16, v7
    v_subrev_u32 v10, s24, v10
    v_med3_i32 v10, v10, 0, s20
    v_mov_b32 v9, v8
    v_cndmask_b32 v10, 0, v10, s[44:45]
    v_add_u32 v10, v11, v10
    v_and_b32 v12, 1, v0
    v_and_b32 v14, 0xffff, v4
    v_add_u32_dpp v10, v10, v10 row_shr:1 row_mask:0xf bank_mask:0xf
    s_nop 0
    v_add3_u32 v14, v14, v12, s24
    v_add_u32_dpp v10, v10, v10 row_shr:2 row_mask:0xf bank_mask:0xf
    v_add_u32_dpp v9, v9, v9 row_shr:2 row_mask:0xf bank_mask:0xf
    v_mad_u32_u24 v14, v14, 40, v13
    v_add_u32_dpp v10, v10, v10 row_shr:4 row_mask:0xf bank_mask:0xf
    v_add_u32_dpp v9, v9, v9 row_shr:4 row_mask:0xf bank_mask:0xf
    v_sub_u32 v15, v8, v12
    v_add_u32_dpp v10, v10, v10 row_shr:8 row_mask:0xf bank_mask:0xf
    v_add_u32_dpp v9, v9, v9 row_shr:8 row_mask:0xf bank_mask:0xf
    s_nop 0
    v_add_u32_dpp v10, v10, v10 row_bcast:15 row_mask:0xa bank_mask:0xf
    v_add_u32_dpp v9, v9, v9 row_bcast:15 row_mask:0xa bank_mask:0xf
    s_nop 0
    v_add_u32_dpp v10, v10, v10 row_bcast:31 row_mask:0xc bank_mask:0xf
    v_add_u32_dpp v9, v9, v9 row_bcast:31 row_mask:0xc bank_mask:0xf
    s_nop 0
    v_readlane_b32 s23, v10, 63
    v_readlane_b32 s46, v10, s43
    v_readlane_b32 s47, v9, 63
    v_sub_u32 v16, v9, v15
    v_lshl_add_u32 v16, v16, 2, s42
    s_cmp_gt_u32 s23, 773
    s_cbranch_scc1 gm_ovf
    s_cmp_eq_u32 s17, 0
    s_cmov_b32 s46, 0
    v_cmpx_lt_i32 vcc, 0, v15
    s_cbranch_execz gm_tb_done
    ds_write_b32 v16, v14 offset:0
    v_add_u32 v14, 80, v14
    v_cmpx_lt_i32 vcc, 2, v15
    s_cbranch_execz gm_tb_done
    ds_write_b32 v16, v14 offset:8
    v_add_u32 v14, 80, v14
    v_cmpx_lt_i32 vcc, 4, v15
    s_cbranch_execz gm_tb_done
    ds_write_b32 v16, v14 offset:16
    v_add_u32 v14, 80, v14
    v_cmpx_lt_i32 vcc, 6, v15
    s_cbranch_execz gm_tb_done
    ds_write_b32 v16, v14 offset:24
    v_add_u32 v14, 80, v14
    v_cmpx_lt_i32 vcc, 8, v15
    s_cbranch_execz gm_tb_done
    ds_write_b32 v16, v14 offset:32
    v_add_u32 v14, 80, v14
    v_cmpx_lt_i32 vcc, 10, v15
    s_cbranch_execz gm_tb_done
    ds_write_b32 v16, v14 offset:40
    v_add_u32 v14, 80, v14
    v_cmpx_lt_i32 vcc, 12, v15
    s_cbranch_execz gm_tb_done
    ds_write_b32 v16, v14 offset:48
    v_add_u32 v14, 80, v14
    v_cmpx_lt_i32 vcc, 14, v15
    s_cbranch_execz gm_tb_done
    ds_write_b32 v16, v14 offset:56
    v_add_u32 v14, 80, v14
    v_cmpx_lt_i32 vcc, 16, v15
    s_cbranch_execz gm_tb_done
    ds_write_b32 v16, v14 offset:64
    v_add_u32 v14, 80, v14
    v_cmpx_lt_i32 vcc, 18, v15
    s_cbranch_execz gm_tb_done
    ds_write_b32 v16, v14 offset:72
gm_tb_done:
    s_mov_b64 exec, -1
    s_mul_i32 s46, s46, 48
    s_add_u32 m0, s46, 3776
    s_mul_i32 s47, s47, 3
    s_mov_b32 s48, 1
    v_mov_b32 v11, v34
    v_mov_b32 v10, v35
    v_mov_b32 v14, v36
    s_barrier
gm_raw:
    ds_read_b32 v18, v11 offset:0
    ds_read_b32 v19, v10 offset:0
    ds_read_b32 v20, v14 offset:0
    ds_read_b32 v21, v11 offset:256
    ds_read_b32 v22, v10 offset:256
    ds_read_b32 v23, v14 offset:256
    ds_read_b32 v24, v11 offset:512
    ds_read_b32 v25, v10 offset:512
    ds_read_b32 v26, v14 offset:512
    v_cmpx_gt_i32 vcc, s47, v3
    s_cbranch_execz gm_raw_done
    s_waitcnt lgkmcnt(8)
    v_add_u32 v18, v18, v30
    buffer_load_dwordx4 v18, s[8:11], 0 offen lds
    s_add_u32 m0, m0, 1024
    s_sub_i32 s47, s47, 64
    v_cmpx_gt_i32 vcc, s47, v3
    s_cbranch_execz gm_raw_done
    s_waitcnt lgkmcnt(7)
    v_add_u32 v19, v19, v31
    buffer_load_dwordx4 v19, s[8:11], 0 offen lds
    s_add_u32 m0, m0, 1024
    s_sub_i32 s47, s47, 64
    v_cmpx_gt_i32 vcc, s47, v3
    s_cbranch_execz gm_raw_done
    s_waitcnt lgkmcnt(6)
    v_add_u32 v20, v20, v32
    buffer_load_dwordx4 v20, s[8:11], 0 offen lds
    s_add_u32 m0, m0, 1024
    s_sub_i32 s47, s47, 64
    v_cmpx_gt_i32 vcc, s47, v3
    s_cbranch_execz gm_raw_done
    s_waitcnt lgkmcnt(5)
    v_add_u32 v21, v21, v30
    buffer_load_dwordx4 v21, s[8:11], 0 offen lds
    s_add_u32 m0, m0, 1024
    s_sub_i32 s47, s47, 64
    v_cmpx_gt_i32 vcc, s47, v3
    s_cbranch_execz gm_raw_done
    s_waitcnt lgkmcnt(4)
    v_add_u32 v22, v22, v31
    buffer_load_dwordx4 v22, s[8:11], 0 offen lds
    s_add_u32 m0, m0, 1024
    s_sub_i32 s47, s47, 64
    v_cmpx_gt_i32 vcc, s47, v3
    s_cbranch_execz gm_raw_done
    s_waitcnt lgkmcnt(3)
    v_add_u32 v23, v23, v32
    buffer_load_dwordx4 v23, s[8:11], 0 offen lds
    s_add_u32 m0, m0, 1024
    s_sub_i32 s47, s47, 64
    v_cmpx_gt_i32 vcc, s47, v3
    s_cbranch_execz gm_raw_done
    s_waitcnt lgkmcnt(2)
    v_add_u32 v24, v24, v30
    buffer_load_dwordx4 v24, s[8:11], 0 offen lds
    s_add_u32 m0, m0, 1024
    s_sub_i32 s47, s47, 64
    v_cmpx_gt_i32 vcc, s47, v3
    s_cbranch_execz gm_raw_done
    s_waitcnt lgkmcnt(1)
    v_add_u32 v25, v25, v31
    buffer_load_dwordx4 v25, s[8:11], 0 offen lds
    s_add_u32 m0, m0, 1024
    s_sub_i32 s47, s47, 64
    v_cmpx_gt_i32 vcc, s47, v3
    s_cbranch_execz gm_raw_done
    s_waitcnt lgkmcnt(0)
    v_add_u32 v26, v26, v32
    buffer_load_dwordx4 v26, s[8:11], 0 offen lds
    s_add_u32 m0, m0, 1024
    s_sub_i32 s47, s47, 64
    v_add_u32 v11, 768, v11
    v_add_u32 v10, 768, v10
    v_add_u32 v14, 768, v14
    s_branch gm_raw
gm_raw_done:
    s_mov_b64 exec, -1
    v_mov_b32 v11, 0
    ds_read_b32 v11, v11 offset:272
    s_barrier
    s_waitcnt vmcnt(0) lgkmcnt(0)
    v_readfirstlane_b32 s21, v11
    s_barrier
    s_cmp_lg_u32 s21, 0
    s_cbranch_scc1 gm_next
    s_add_u32 s52, s40, 0
    buffer_load_dwordx4 v[40:43], v2, s[8:11], s52 offen offset:0
    buffer_load_dwordx4 v[44:47], v2, s[8:11], s52 offen offset:1024
    s_waitcnt vmcnt(1)
    buffer_load_dwordx4 v[48:51], v2, s[8:11], s52 offen offset:2048
    s_waitcnt vmcnt(1)
    buffer_load_dwordx4 v[52:55], v2, s[8:11], s52 offen offset:3072
    s_waitcnt vmcnt(1)
    s_add_u32 s52, s40, 4096
    buffer_load_dwordx4 v[56:59], v2, s[8:11], s52 offen offset:0
    s_waitcnt vmcnt(1)
    buffer_load_dwordx4 v[60:63], v2, s[8:11], s52 offen offset:1024
    s_waitcnt vmcnt(1)
    buffer_load_dwordx4 v[64:67], v2, s[8:11], s52 offen offset:2048
    s_waitcnt vmcnt(1)
    buffer_load_dwordx4 v[68:71], v2, s[8:11], s52 offen offset:3072
    s_waitcnt vmcnt(1)
    s_add_u32 s52, s40, 8192
    buffer_load_dwordx4 v[72:75], v2, s[8:11], s52 offen offset:0
    s_waitcnt vmcnt(1)
    buffer_load_dwordx4 v[76:79], v2, s[8:11], s52 offen offset:1024
    s_waitcnt vmcnt(1)
    buffer_load_dwordx4 v[80:83], v2, s[8:11], s52 offen offset:2048
    s_waitcnt vmcnt(1)
    buffer_load_dwordx4 v[84:87], v2, s[8:11], s52 offen offset:3072
    s_waitcnt vmcnt(1)
    s_add_u32 s52, s40, 12288
    buffer_load_dwordx4 v[88:91], v2, s[8:11], s52 offen offset:0
    s_waitcnt vmcnt(1)
    buffer_load_dwordx4 v[92:95], v2, s[8:11], s52 offen offset:1024
    s_waitcnt vmcnt(1)
    buffer_load_dwordx4 v[96:99], v2, s[8:11], s52 offen offset:2048
    s_waitcnt vmcnt(1)
    buffer_load_dwordx4 v[100:103], v2, s[8:11], s52 offen offset:3072
    s_waitcnt vmcnt(1)
    s_add_u32 s52, s40, 16384
    buffer_load_dwordx4 v[104:107], v2, s[8:11], s52 offen offset:0
    s_waitcnt vmcnt(1)
    buffer_load_dwordx4 v[108:111], v2, s[8:11], s52 offen offset:1024
    s_waitcnt vmcnt(1)
    buffer_load_dwordx4 v[112:115], v2, s[8:11], s52 offen offset:2048
    s_waitcnt vmcnt(1)
    buffer_load_dwordx4 v[116:119], v2, s[8:11], s52 offen offset:3072
    s_waitcnt vmcnt(1)
    s_add_u32 s52, s40, 20480
    buffer_load_dwordx4 v[120:123], v2, s[8:11], s52 offen offset:0
    s_waitcnt vmcnt(1)
    buffer_load_dwordx4 v[124:127], v2, s[8:11], s52 offen offset:1024
    s_waitcnt vmcnt(1)
    buffer_load_dwordx4 v[128:131], v2, s[8:11], s52 offen offset:2048
    s_waitcnt vmcnt(1)
    buffer_load_dwordx4 v[132:135], v2, s[8:11], s52 offen offset:3072
    s_waitcnt vmcnt(1)
    s_add_u32 s52, s40, 24576
    buffer_load_dwordx4 v[136:139], v2, s[8:11], s52 offen offset:0
    s_waitcnt vmcnt(1)
    buffer_load_dwordx4 v[140:143], v2, s[8:11], s52 offen offset:1024
    s_waitcnt vmcnt(1)
    buffer_load_dwordx4 v[144:147], v2, s[8:11], s52 offen offset:2048
    s_waitcnt vmcnt(1)
    buffer_load_dwordx4 v[148:151], v2, s[8:11], s52 offen offset:3072
    s_waitcnt vmcnt(1)
    s_add_u32 s52, s40, 28672
    buffer_load_dwordx4 v[152:155], v2, s[8:11], s52 offen offset:0
    s_waitcnt vmcnt(1)
    buffer_load_dwordx4 v[156:159], v2, s[8:11], s52 offen offset:1024
    s_waitcnt vmcnt(1)
    buffer_load_dwordx4 v[160:163], v2, s[8:11], s52 offen offset:2048
    s_waitcnt vmcnt(1)
    buffer_load_dwordx4 v[164:167], v2, s[8:11], s52 offen offset:3072
    s_waitcnt vmcnt(1)
    v_lshrrev_b32 v1, 4, v3
    v_lshlrev_b32 v1, 11, v1
    v_and_b32 v4, 7, v3
    v_lshl_add_u32 v1, v4, 4, v1
    v_bfe_u32 v4, v3, 3, 1
    v_lshl_add_u32 v1, v4, 9, v1
    v_and_b32 v4, 3, v3
    v_lshrrev_b32 v5, 2, v3
    v_mul_u32_u24 v0, 576, v4
    v_lshl_add_u32 v0, v5, 3, v0
    v_add_u32 v0, 40960, v0
    s_lshl_b32 s38, s41, 11
    s_lshl_b32 s53, s17, 7
    s_add_u32 s38, s38, s53
    s_mov_b32 s36, 0x24924924
    s_mov_b32 s39, 0
    s_waitcnt vmcnt(0)
gm_poll:
    v_mov_b32 v2, 0
    ds_read_b32 v2, v2 offset:276
    s_waitcnt lgkmcnt(0)
    v_readfirstlane_b32 s52, v2
    s_and_b32 s52, s52, s36
    s_cbranch_scc1 gm_go
    s_sleep 2
    s_branch gm_poll
gm_go:
    s_ff1_i32_b32 s52, s52
    s_bitset0_b32 s36, s52
    s_mul_i32 s52, s52, 11
    s_bfe_u32 s53, s52, 0x10005
    s_bfe_u32 s52, s52, 0x30006
    s_mul_i32 s35, s53, 61440
    s_mul_i32 s31, s52, 2304
    s_add_u32 s31, s31, s35
    s_sub_u32 s35, s31, s39
    v_add_u32 v0, s35, v0
    ds_read_b64_tr_b16 v[12:13], v0 offset:0
    ds_read_b64_tr_b16 v[14:15], v0 offset:128
    ds_read_b64_tr_b16 v[16:17], v0 offset:256
    ds_read_b64_tr_b16 v[18:19], v0 offset:384
    s_mov_b32 s39, s31
    s_mul_i32 s33, s53, 5
    s_add_u32 s33, s33, s52
    s_lshl_b32 s33, s33, 13
    s_add_u32 s33, s33, s38
    s_mov_b32 s37, s33
    s_mov_b32 s32, 0x7ffffff0
gm_loop:
    s_waitcnt lgkmcnt(2)
    v_mfma_f32_16x16x32_bf16 v[24:27], v[12:15], v[40:43], 0
    s_setprio 3
    v_cvt_pk_bf16_f32 v7, v33, v37
    v_cvt_pk_bf16_f32 v5, v32, v36
    ds_read_b64_tr_b16 v[20:21], v0 offset:15360
    s_setprio 0
    v_mfma_f32_16x16x32_bf16 v[28:31], v[12:15], v[44:47], 0
    s_setprio 3
    v_cvt_pk_bf16_f32 v11, v35, v39
    v_cvt_pk_bf16_f32 v9, v34, v38
    ds_read_b64_tr_b16 v[22:23], v0 offset:15488
    s_setprio 0
    v_mfma_f32_16x16x32_bf16 v[32:35], v[12:15], v[48:51], 0
    s_setprio 3
    v_mov_b32_dpp v2, v6 row_ror:8 row_mask:0xf bank_mask:0xf
    v_mov_b32_dpp v3, v7 row_ror:8 row_mask:0xf bank_mask:0xf
    s_setprio 0
    v_mfma_f32_16x16x32_bf16 v[36:39], v[12:15], v[52:55], 0
    s_setprio 3
    v_mov_b32_dpp v6, v4 row_ror:8 row_mask:0xf bank_mask:0x3
    v_mov_b32_dpp v7, v5 row_ror:8 row_mask:0xf bank_mask:0x3
    s_setprio 0
    s_waitcnt lgkmcnt(2)
    v_mfma_f32_16x16x32_bf16 v[24:27], v[16:19], v[56:59], v[24:27]
    s_setprio 3
    ds_read_b64_tr_b16 v[12:13], v0 offset:15616
    v_mov_b32_dpp v4, v2 quad_perm:[0,1,2,3] row_mask:0xf bank_mask:0xc
    s_setprio 0
    v_mfma_f32_16x16x32_bf16 v[28:31], v[16:19], v[60:63], v[28:31]
    s_setprio 3
    ds_read_b64_tr_b16 v[14:15], v0 offset:15744
    v_mov_b32_dpp v5, v3 quad_perm:[0,1,2,3] row_mask:0xf bank_mask:0xc
    s_setprio 0
    v_mfma_f32_16x16x32_bf16 v[32:35], v[16:19], v[64:67], v[32:35]
    s_setprio 3
    buffer_store_dwordx4 v[4:7], v1, s[12:15], s32 offen offset:0 sc0 sc1
    v_mov_b32_dpp v2, v10 row_ror:8 row_mask:0xf bank_mask:0xf
    s_setprio 0
    v_mfma_f32_16x16x32_bf16 v[36:39], v[16:19], v[68:71], v[36:39]
    s_setprio 3
    v_mov_b32_dpp v3, v11 row_ror:8 row_mask:0xf bank_mask:0xf
    v_mov_b32_dpp v10, v8 row_ror:8 row_mask:0xf bank_mask:0x3
    s_setprio 0
    s_waitcnt lgkmcnt(2)
    v_mfma_f32_16x16x32_bf16 v[24:27], v[20:23], v[72:75], v[24:27]
    s_setprio 3
    ds_read_b64_tr_b16 v[16:17], v0 offset:30720
    v_mov_b32_dpp v11, v9 row_ror:8 row_mask:0xf bank_mask:0x3
    s_setprio 0
    v_mfma_f32_16x16x32_bf16 v[28:31], v[20:23], v[76:79], v[28:31]
    s_setprio 3
    ds_read_b64_tr_b16 v[18:19], v0 offset:30848
    v_mov_b32_dpp v8, v2 quad_perm:[0,1,2,3] row_mask:0xf bank_mask:0xc
    s_setprio 0
    v_mfma_f32_16x16x32_bf16 v[32:35], v[20:23], v[80:83], v[32:35]
    s_setprio 3
    v_mov_b32_dpp v9, v3 quad_perm:[0,1,2,3] row_mask:0xf bank_mask:0xc
    buffer_store_dwordx4 v[8:11], v1, s[12:15], s32 offen offset:1024 sc0 sc1
    s_setprio 0
    v_mfma_f32_16x16x32_bf16 v[36:39], v[20:23], v[84:87], v[36:39]
    s_waitcnt lgkmcnt(2)
    v_mfma_f32_16x16x32_bf16 v[24:27], v[12:15], v[88:91], v[24:27]
    ds_read_b64_tr_b16 v[20:21], v0 offset:30976
    v_mfma_f32_16x16x32_bf16 v[28:31], v[12:15], v[92:95], v[28:31]
    ds_read_b64_tr_b16 v[22:23], v0 offset:31104
    v_mfma_f32_16x16x32_bf16 v[32:35], v[12:15], v[96:99], v[32:35]
    s_setprio 3
    v_mov_b32 v2, 0
    s_setprio 0
    v_mfma_f32_16x16x32_bf16 v[36:39], v[12:15], v[100:103], v[36:39]
    ds_read_b32 v2, v2 offset:276
    s_waitcnt lgkmcnt(3)
    v_mfma_f32_16x16x32_bf16 v[24:27], v[16:19], v[104:107], v[24:27]
    ds_read_b64_tr_b16 v[12:13], v0 offset:46080
    v_mfma_f32_16x16x32_bf16 v[28:31], v[16:19], v[108:111], v[28:31]
    ds_read_b64_tr_b16 v[14:15], v0 offset:46208
    v_mfma_f32_16x16x32_bf16 v[32:35], v[16:19], v[112:115], v[32:35]
    s_setprio 3
    s_waitcnt lgkmcnt(2)
    v_readfirstlane_b32 s52, v2
    s_and_b32 s52, s52, s36
    s_setprio 0
    v_mfma_f32_16x16x32_bf16 v[36:39], v[16:19], v[116:119], v[36:39]
    s_cselect_b32 s34, 1, 0
    s_ff1_i32_b32 s52, s52
    s_waitcnt lgkmcnt(2)
    v_mfma_f32_16x16x32_bf16 v[24:27], v[20:23], v[120:123], v[24:27]
    ds_read_b64_tr_b16 v[16:17], v0 offset:46336
    s_bitset0_b32 s36, s52
    s_mul_i32 s52, s52, 11
    v_mfma_f32_16x16x32_bf16 v[28:31], v[20:23], v[124:127], v[28:31]
    ds_read_b64_tr_b16 v[18:19], v0 offset:46464
    s_bfe_u32 s53, s52, 0x10005
    s_bfe_u32 s52, s52, 0x30006
    v_mfma_f32_16x16x32_bf16 v[32:35], v[20:23], v[128:131], v[32:35]
    s_mul_i32 s35, s53, 61440
    s_mul_i32 s31, s52, 2304
    s_add_u32 s31, s31, s35
    v_mfma_f32_16x16x32_bf16 v[36:39], v[20:23], v[132:135], v[36:39]
    s_setprio 3
    s_sub_u32 s35, s31, s39
    v_add_u32 v0, s35, v0
    s_setprio 0
    s_waitcnt lgkmcnt(2)
    v_mfma_f32_16x16x32_bf16 v[24:27], v[12:15], v[136:139], v[24:27]
    ds_read_b64_tr_b16 v[20:21], v0 offset:0
    v_mfma_f32_16x16x32_bf16 v[28:31], v[12:15], v[140:143], v[28:31]
    ds_read_b64_tr_b16 v[22:23], v0 offset:128
    v_mfma_f32_16x16x32_bf16 v[32:35], v[12:15], v[144:147], v[32:35]
    s_mov_b32 s39, s31
    s_mul_i32 s33, s53, 5
    s_add_u32 s33, s33, s52
    v_mfma_f32_16x16x32_bf16 v[36:39], v[12:15], v[148:151], v[36:39]
    s_lshl_b32 s33, s33, 13
    s_add_u32 s33, s33, s38
    s_waitcnt lgkmcnt(2)
    v_mfma_f32_16x16x32_bf16 v[24:27], v[16:19], v[152:155], v[24:27]
    ds_read_b64_tr_b16 v[12:13], v0 offset:256
    v_mfma_f32_16x16x32_bf16 v[28:31], v[16:19], v[156:159], v[28:31]
    ds_read_b64_tr_b16 v[14:15], v0 offset:384
    s_mov_b32 s32, s37
    s_mov_b32 s37, s33
    v_mfma_f32_16x16x32_bf16 v[32:35], v[16:19], v[160:163], v[32:35]
    s_cmp_eq_u32 s34, 0
    s_nop 1
    v_mfma_f32_16x16x32_bf16 v[36:39], v[16:19], v[164:167], v[36:39]
    s_setprio 3
    v_cvt_pk_bf16_f32 v4, v24, v28
    v_cvt_pk_bf16_f32 v6, v25, v29
    v_cvt_pk_bf16_f32 v8, v26, v30
    v_cvt_pk_bf16_f32 v10, v27, v31
    s_setprio 0
    s_cbranch_scc1 gm_drain
    s_waitcnt lgkmcnt(2)
    v_mfma_f32_16x16x32_bf16 v[24:27], v[20:23], v[40:43], 0
    s_setprio 3
    v_cvt_pk_bf16_f32 v7, v33, v37
    v_cvt_pk_bf16_f32 v5, v32, v36
    ds_read_b64_tr_b16 v[16:17], v0 offset:15360
    s_setprio 0
    v_mfma_f32_16x16x32_bf16 v[28:31], v[20:23], v[44:47], 0
    s_setprio 3
    v_cvt_pk_bf16_f32 v11, v35, v39
    v_cvt_pk_bf16_f32 v9, v34, v38
    ds_read_b64_tr_b16 v[18:19], v0 offset:15488
    s_setprio 0
    v_mfma_f32_16x16x32_bf16 v[32:35], v[20:23], v[48:51], 0
    s_setprio 3
    v_mov_b32_dpp v2, v6 row_ror:8 row_mask:0xf bank_mask:0xf
    v_mov_b32_dpp v3, v7 row_ror:8 row_mask:0xf bank_mask:0xf
    s_setprio 0
    v_mfma_f32_16x16x32_bf16 v[36:39], v[20:23], v[52:55], 0
    s_setprio 3
    v_mov_b32_dpp v6, v4 row_ror:8 row_mask:0xf bank_mask:0x3
    v_mov_b32_dpp v7, v5 row_ror:8 row_mask:0xf bank_mask:0x3
    s_setprio 0
    s_waitcnt lgkmcnt(2)
    v_mfma_f32_16x16x32_bf16 v[24:27], v[12:15], v[56:59], v[24:27]
    s_setprio 3
    ds_read_b64_tr_b16 v[20:21], v0 offset:15616
    v_mov_b32_dpp v4, v2 quad_perm:[0,1,2,3] row_mask:0xf bank_mask:0xc
    s_setprio 0
    v_mfma_f32_16x16x32_bf16 v[28:31], v[12:15], v[60:63], v[28:31]
    s_setprio 3
    ds_read_b64_tr_b16 v[22:23], v0 offset:15744
    v_mov_b32_dpp v5, v3 quad_perm:[0,1,2,3] row_mask:0xf bank_mask:0xc
    s_setprio 0
    v_mfma_f32_16x16x32_bf16 v[32:35], v[12:15], v[64:67], v[32:35]
    s_setprio 3
    buffer_store_dwordx4 v[4:7], v1, s[12:15], s32 offen offset:0 sc0 sc1
    v_mov_b32_dpp v2, v10 row_ror:8 row_mask:0xf bank_mask:0xf
    s_setprio 0
    v_mfma_f32_16x16x32_bf16 v[36:39], v[12:15], v[68:71], v[36:39]
    s_setprio 3
    v_mov_b32_dpp v3, v11 row_ror:8 row_mask:0xf bank_mask:0xf
    v_mov_b32_dpp v10, v8 row_ror:8 row_mask:0xf bank_mask:0x3
    s_setprio 0
    s_waitcnt lgkmcnt(2)
    v_mfma_f32_16x16x32_bf16 v[24:27], v[16:19], v[72:75], v[24:27]
    s_setprio 3
    ds_read_b64_tr_b16 v[12:13], v0 offset:30720
    v_mov_b32_dpp v11, v9 row_ror:8 row_mask:0xf bank_mask:0x3
    s_setprio 0
    v_mfma_f32_16x16x32_bf16 v[28:31], v[16:19], v[76:79], v[28:31]
    s_setprio 3
    ds_read_b64_tr_b16 v[14:15], v0 offset:30848
    v_mov_b32_dpp v8, v2 quad_perm:[0,1,2,3] row_mask:0xf bank_mask:0xc
    s_setprio 0
    v_mfma_f32_16x16x32_bf16 v[32:35], v[16:19], v[80:83], v[32:35]
    s_setprio 3
    v_mov_b32_dpp v9, v3 quad_perm:[0,1,2,3] row_mask:0xf bank_mask:0xc
    buffer_store_dwordx4 v[8:11], v1, s[12:15], s32 offen offset:1024 sc0 sc1
    s_setprio 0
    v_mfma_f32_16x16x32_bf16 v[36:39], v[16:19], v[84:87], v[36:39]
    s_waitcnt lgkmcnt(2)
    v_mfma_f32_16x16x32_bf16 v[24:27], v[20:23], v[88:91], v[24:27]
    ds_read_b64_tr_b16 v[16:17], v0 offset:30976
    v_mfma_f32_16x16x32_bf16 v[28:31], v[20:23], v[92:95], v[28:31]
    ds_read_b64_tr_b16 v[18:19], v0 offset:31104
    v_mfma_f32_16x16x32_bf16 v[32:35], v[20:23], v[96:99], v[32:35]
    s_setprio 3
    v_mov_b32 v2, 0
    s_setprio 0
    v_mfma_f32_16x16x32_bf16 v[36:39], v[20:23], v[100:103], v[36:39]
    ds_read_b32 v2, v2 offset:276
    s_waitcnt lgkmcnt(3)
    v_mfma_f32_16x16x32_bf16 v[24:27], v[12:15], v[104:107], v[24:27]
    ds_read_b64_tr_b16 v[20:21], v0 offset:46080
    v_mfma_f32_16x16x32_bf16 v[28:31], v[12:15], v[108:111], v[28:31]
    ds_read_b64_tr_b16 v[22:23], v0 offset:46208
    v_mfma_f32_16x16x32_bf16 v[32:35], v[12:15], v[112:115], v[32:35]
    s_setprio 3
    s_waitcnt lgkmcnt(2)
    v_readfirstlane_b32 s52, v2
    s_and_b32 s52, s52, s36
    s_setprio 0
    v_mfma_f32_16x16x32_bf16 v[36:39], v[12:15], v[116:119], v[36:39]
    s_cselect_b32 s34, 1, 0
    s_ff1_i32_b32 s52, s52
    s_waitcnt lgkmcnt(2)
    v_mfma_f32_16x16x32_bf16 v[24:27], v[16:19], v[120:123], v[24:27]
    ds_read_b64_tr_b16 v[12:13], v0 offset:46336
    s_bitset0_b32 s36, s52
    s_mul_i32 s52, s52, 11
    v_mfma_f32_16x16x32_bf16 v[28:31], v[16:19], v[124:127], v[28:31]
    ds_read_b64_tr_b16 v[14:15], v0 offset:46464
    s_bfe_u32 s53, s52, 0x10005
    s_bfe_u32 s52, s52, 0x30006
    v_mfma_f32_16x16x32_bf16 v[32:35], v[16:19], v[128:131], v[32:35]
    s_mul_i32 s35, s53, 61440
    s_mul_i32 s31, s52, 2304
    s_add_u32 s31, s31, s35
    v_mfma_f32_16x16x32_bf16 v[36:39], v[16:19], v[132:135], v[36:39]
    s_setprio 3
    s_sub_u32 s35, s31, s39
    v_add_u32 v0, s35, v0
    s_setprio 0
    s_waitcnt lgkmcnt(2)
    v_mfma_f32_16x16x32_bf16 v[24:27], v[20:23], v[136:139], v[24:27]
    ds_read_b64_tr_b16 v[16:17], v0 offset:0
    v_mfma_f32_16x16x32_bf16 v[28:31], v[20:23], v[140:143], v[28:31]
    ds_read_b64_tr_b16 v[18:19], v0 offset:128
    v_mfma_f32_16x16x32_bf16 v[32:35], v[20:23], v[144:147], v[32:35]
    s_mov_b32 s39, s31
    s_mul_i32 s33, s53, 5
    s_add_u32 s33, s33, s52
    v_mfma_f32_16x16x32_bf16 v[36:39], v[20:23], v[148:151], v[36:39]
    s_lshl_b32 s33, s33, 13
    s_add_u32 s33, s33, s38
    s_waitcnt lgkmcnt(2)
    v_mfma_f32_16x16x32_bf16 v[24:27], v[12:15], v[152:155], v[24:27]
    ds_read_b64_tr_b16 v[20:21], v0 offset:256
    v_mfma_f32_16x16x32_bf16 v[28:31], v[12:15], v[156:159], v[28:31]
    ds_read_b64_tr_b16 v[22:23], v0 offset:384
    s_mov_b32 s32, s37
    s_mov_b32 s37, s33
    v_mfma_f32_16x16x32_bf16 v[32:35], v[12:15], v[160:163], v[32:35]
    s_cmp_eq_u32 s34, 0
    s_nop 1
    v_mfma_f32_16x16x32_bf16 v[36:39], v[12:15], v[164:167], v[36:39]
    s_setprio 3
    v_cvt_pk_bf16_f32 v4, v24, v28
    v_cvt_pk_bf16_f32 v6, v25, v29
    v_cvt_pk_bf16_f32 v8, v26, v30
    v_cvt_pk_bf16_f32 v10, v27, v31
    s_setprio 0
    s_cbranch_scc1 gm_drain
    s_waitcnt lgkmcnt(2)
    v_mfma_f32_16x16x32_bf16 v[24:27], v[16:19], v[40:43], 0
    s_setprio 3
    v_cvt_pk_bf16_f32 v7, v33, v37
    v_cvt_pk_bf16_f32 v5, v32, v36
    ds_read_b64_tr_b16 v[12:13], v0 offset:15360
    s_setprio 0
    v_mfma_f32_16x16x32_bf16 v[28:31], v[16:19], v[44:47], 0
    s_setprio 3
    v_cvt_pk_bf16_f32 v11, v35, v39
    v_cvt_pk_bf16_f32 v9, v34, v38
    ds_read_b64_tr_b16 v[14:15], v0 offset:15488
    s_setprio 0
    v_mfma_f32_16x16x32_bf16 v[32:35], v[16:19], v[48:51], 0
    s_setprio 3
    v_mov_b32_dpp v2, v6 row_ror:8 row_mask:0xf bank_mask:0xf
    v_mov_b32_dpp v3, v7 row_ror:8 row_mask:0xf bank_mask:0xf
    s_setprio 0
    v_mfma_f32_16x16x32_bf16 v[36:39], v[16:19], v[52:55], 0
    s_setprio 3
    v_mov_b32_dpp v6, v4 row_ror:8 row_mask:0xf bank_mask:0x3
    v_mov_b32_dpp v7, v5 row_ror:8 row_mask:0xf bank_mask:0x3
    s_setprio 0
    s_waitcnt lgkmcnt(2)
    v_mfma_f32_16x16x32_bf16 v[24:27], v[20:23], v[56:59], v[24:27]
    s_setprio 3
    ds_read_b64_tr_b16 v[16:17], v0 offset:15616
    v_mov_b32_dpp v4, v2 quad_perm:[0,1,2,3] row_mask:0xf bank_mask:0xc
    s_setprio 0
    v_mfma_f32_16x16x32_bf16 v[28:31], v[20:23], v[60:63], v[28:31]
    s_setprio 3
    ds_read_b64_tr_b16 v[18:19], v0 offset:15744
    v_mov_b32_dpp v5, v3 quad_perm:[0,1,2,3] row_mask:0xf bank_mask:0xc
    s_setprio 0
    v_mfma_f32_16x16x32_bf16 v[32:35], v[20:23], v[64:67], v[32:35]
    s_setprio 3
    buffer_store_dwordx4 v[4:7], v1, s[12:15], s32 offen offset:0 sc0 sc1
    v_mov_b32_dpp v2, v10 row_ror:8 row_mask:0xf bank_mask:0xf
    s_setprio 0
    v_mfma_f32_16x16x32_bf16 v[36:39], v[20:23], v[68:71], v[36:39]
    s_setprio 3
    v_mov_b32_dpp v3, v11 row_ror:8 row_mask:0xf bank_mask:0xf
    v_mov_b32_dpp v10, v8 row_ror:8 row_mask:0xf bank_mask:0x3
    s_setprio 0
    s_waitcnt lgkmcnt(2)
    v_mfma_f32_16x16x32_bf16 v[24:27], v[12:15], v[72:75], v[24:27]
    s_setprio 3
    ds_read_b64_tr_b16 v[20:21], v0 offset:30720
    v_mov_b32_dpp v11, v9 row_ror:8 row_mask:0xf bank_mask:0x3
    s_setprio 0
    v_mfma_f32_16x16x32_bf16 v[28:31], v[12:15], v[76:79], v[28:31]
    s_setprio 3
    ds_read_b64_tr_b16 v[22:23], v0 offset:30848
    v_mov_b32_dpp v8, v2 quad_perm:[0,1,2,3] row_mask:0xf bank_mask:0xc
    s_setprio 0
    v_mfma_f32_16x16x32_bf16 v[32:35], v[12:15], v[80:83], v[32:35]
    s_setprio 3
    v_mov_b32_dpp v9, v3 quad_perm:[0,1,2,3] row_mask:0xf bank_mask:0xc
    buffer_store_dwordx4 v[8:11], v1, s[12:15], s32 offen offset:1024 sc0 sc1
    s_setprio 0
    v_mfma_f32_16x16x32_bf16 v[36:39], v[12:15], v[84:87], v[36:39]
    s_waitcnt lgkmcnt(2)
    v_mfma_f32_16x16x32_bf16 v[24:27], v[16:19], v[88:91], v[24:27]
    ds_read_b64_tr_b16 v[12:13], v0 offset:30976
    v_mfma_f32_16x16x32_bf16 v[28:31], v[16:19], v[92:95], v[28:31]
    ds_read_b64_tr_b16 v[14:15], v0 offset:31104
    v_mfma_f32_16x16x32_bf16 v[32:35], v[16:19], v[96:99], v[32:35]
    s_setprio 3
    v_mov_b32 v2, 0
    s_setprio 0
    v_mfma_f32_16x16x32_bf16 v[36:39], v[16:19], v[100:103], v[36:39]
    ds_read_b32 v2, v2 offset:276
    s_waitcnt lgkmcnt(3)
    v_mfma_f32_16x16x32_bf16 v[24:27], v[20:23], v[104:107], v[24:27]
    ds_read_b64_tr_b16 v[16:17], v0 offset:46080
    v_mfma_f32_16x16x32_bf16 v[28:31], v[20:23], v[108:111], v[28:31]
    ds_read_b64_tr_b16 v[18:19], v0 offset:46208
    v_mfma_f32_16x16x32_bf16 v[32:35], v[20:23], v[112:115], v[32:35]
    s_setprio 3
    s_waitcnt lgkmcnt(2)
    v_readfirstlane_b32 s52, v2
    s_and_b32 s52, s52, s36
    s_setprio 0
    v_mfma_f32_16x16x32_bf16 v[36:39], v[20:23], v[116:119], v[36:39]
    s_cselect_b32 s34, 1, 0
    s_ff1_i32_b32 s52, s52
    s_waitcnt lgkmcnt(2)
    v_mfma_f32_16x16x32_bf16 v[24:27], v[12:15], v[120:123], v[24:27]
    ds_read_b64_tr_b16 v[20:21], v0 offset:46336
    s_bitset0_b32 s36, s52
    s_mul_i32 s52, s52, 11
    v_mfma_f32_16x16x32_bf16 v[28:31], v[12:15], v[124:127], v[28:31]
    ds_read_b64_tr_b16 v[22:23], v0 offset:46464
    s_bfe_u32 s53, s52, 0x10005
    s_bfe_u32 s52, s52, 0x30006
    v_mfma_f32_16x16x32_bf16 v[32:35], v[12:15], v[128:131], v[32:35]
    s_mul_i32 s35, s53, 61440
    s_mul_i32 s31, s52, 2304
    s_add_u32 s31, s31, s35
    v_mfma_f32_16x16x32_bf16 v[36:39], v[12:15], v[132:135], v[36:39]
    s_setprio 3
    s_sub_u32 s35, s31, s39
    v_add_u32 v0, s35, v0
    s_setprio 0
    s_waitcnt lgkmcnt(2)
    v_mfma_f32_16x16x32_bf16 v[24:27], v[16:19], v[136:139], v[24:27]
    ds_read_b64_tr_b16 v[12:13], v0 offset:0
    v_mfma_f32_16x16x32_bf16 v[28:31], v[16:19], v[140:143], v[28:31]
    ds_read_b64_tr_b16 v[14:15], v0 offset:128
    v_mfma_f32_16x16x32_bf16 v[32:35], v[16:19], v[144:147], v[32:35]
    s_mov_b32 s39, s31
    s_mul_i32 s33, s53, 5
    s_add_u32 s33, s33, s52
    v_mfma_f32_16x16x32_bf16 v[36:39], v[16:19], v[148:151], v[36:39]
    s_lshl_b32 s33, s33, 13
    s_add_u32 s33, s33, s38
    s_waitcnt lgkmcnt(2)
    v_mfma_f32_16x16x32_bf16 v[24:27], v[20:23], v[152:155], v[24:27]
    ds_read_b64_tr_b16 v[16:17], v0 offset:256
    v_mfma_f32_16x16x32_bf16 v[28:31], v[20:23], v[156:159], v[28:31]
    ds_read_b64_tr_b16 v[18:19], v0 offset:384
    s_mov_b32 s32, s37
    s_mov_b32 s37, s33
    v_mfma_f32_16x16x32_bf16 v[32:35], v[20:23], v[160:163], v[32:35]
    s_cmp_eq_u32 s34, 0
    s_nop 1
    v_mfma_f32_16x16x32_bf16 v[36:39], v[20:23], v[164:167], v[36:39]
    s_setprio 3
    v_cvt_pk_bf16_f32 v4, v24, v28
    v_cvt_pk_bf16_f32 v6, v25, v29
    v_cvt_pk_bf16_f32 v8, v26, v30
    v_cvt_pk_bf16_f32 v10, v27, v31
    s_setprio 0
    s_cbranch_scc0 gm_loop
gm_drain:
    s_nop 2
    s_setprio 3
    v_cvt_pk_bf16_f32 v7, v33, v37
    v_cvt_pk_bf16_f32 v5, v32, v36
    v_cvt_pk_bf16_f32 v11, v35, v39
    v_cvt_pk_bf16_f32 v9, v34, v38
    v_mov_b32_dpp v2, v6 row_ror:8 row_mask:0xf bank_mask:0xf
    v_mov_b32_dpp v3, v7 row_ror:8 row_mask:0xf bank_mask:0xf
    v_mov_b32_dpp v6, v4 row_ror:8 row_mask:0xf bank_mask:0x3
    v_mov_b32_dpp v7, v5 row_ror:8 row_mask:0xf bank_mask:0x3
    v_mov_b32_dpp v4, v2 quad_perm:[0,1,2,3] row_mask:0xf bank_mask:0xc
    v_mov_b32_dpp v5, v3 quad_perm:[0,1,2,3] row_mask:0xf bank_mask:0xc
    buffer_store_dwordx4 v[4:7], v1, s[12:15], s32 offen offset:0 sc0 sc1
    v_mov_b32_dpp v2, v10 row_ror:8 row_mask:0xf bank_mask:0xf
    v_mov_b32_dpp v3, v11 row_ror:8 row_mask:0xf bank_mask:0xf
    v_mov_b32_dpp v10, v8 row_ror:8 row_mask:0xf bank_mask:0x3
    v_mov_b32_dpp v11, v9 row_ror:8 row_mask:0xf bank_mask:0x3
    v_mov_b32_dpp v8, v2 quad_perm:[0,1,2,3] row_mask:0xf bank_mask:0xc
    v_mov_b32_dpp v9, v3 quad_perm:[0,1,2,3] row_mask:0xf bank_mask:0xc
    buffer_store_dwordx4 v[8:11], v1, s[12:15], s32 offen offset:1024 sc0 sc1
    s_setprio 0
    s_cmp_lg_u32 s36, 0
    s_cbranch_scc1 gm_poll
    s_endpgm
gm_ovf:
    s_movk_i32 s20, 4
    s_barrier
    s_barrier
    s_barrier
    s_branch gm_pass
gm_next:
    s_add_u32 s24, s24, s20
    s_barrier
    s_branch gm_pass
mn_w5:
    v_add_u32 v55, 16, v35
    v_add_u32 v55, s24, v55
    v_lshrrev_b32 v56, 16, v58
    v_mov_b32 v24, 0
    v_cmpx_lt_u32 vcc, v55, v56
    s_cbranch_execz mn_g0
    v_cmp_gt_u32 vcc, 16, v55
    v_and_b32 v56, 0xffff, v58
    v_add_lshl_u32 v56, v55, v56, 2
    v_add_u32 v56, v56, v46
    v_lshl_add_u32 v57, v0, 4, s22
    v_and_or_b32 v57, v55, 12, v57
    v_cndmask_b32 v56, v56, v57, vcc
    buffer_load_dword v24, v56, s[8:11], 0 offen
    s_waitcnt vmcnt(0)
mn_g0:
    s_mov_b64 exec, -1
mn_more:
    s_add_u32 s52, s24, s20
    v_lshrrev_b32 v56, 16, v58
    v_cmp_lt_u32 vcc, s52, v56
    s_cbranch_vccz mn_count
    v_mov_b32 v55, 272
    ds_write_b32 v55, v48
    s_branch mn_count
mn_ovf:
    s_movk_i32 s20, 4
    s_waitcnt vmcnt(0) lgkmcnt(0)
    s_barrier
    s_branch mn_again
mn_next:
    s_set_gpr_idx_off
    s_waitcnt vmcnt(0) lgkmcnt(0)
    s_nop 7
    s_add_u32 s24, s24, s20
    v_mbcnt_lo_u32_b32 v0, -1, 0
    v_mbcnt_hi_u32_b32 v0, -1, v0
    v_lshl_add_u32 v0, s16, 6, v0
    v_lshrrev_b32 v56, 6, v0
    v_lshlrev_b32 v55, 1, v0
    v_and_b32 v55, 0x78, v55
    v_or_b32 v55, v55, v56
    v_cmp_gt_u32 vcc, 125, v55
    v_mul_u32_u24 v46, 5120, v55
    v_add_u32 v46, 7340032, v46
    v_bfrev_b32 v56, 2
    v_lshlrev_b32 v55, 4, v0
    v_and_b32 v57, 0x1fc, v0
    v_cndmask_b32 v55, v56, v55, vcc
    v_cndmask_b32 v57, v56, v57, vcc
    v_and_b32 v51, 63, v0
    v_lshlrev_b32 v56, 3, v51
    buffer_load_dword v58, v57, s[8:11], s25 offen
    buffer_load_dwordx2 v[44:45], v56, s[8:11], s25 offen
    v_mov_b32 v48, 1
    v_lshlrev_b32 v47, 2, v51
    v_bfe_u32 v2, v0, 5, 1
    v_bfe_u32 v3, v0, 3, 2
    v_and_b32 v35, 3, v0
    v_lshl_add_u32 v3, v3, 2, v35
    v_mul_u32_u24 v49, 20, v2
    v_lshrrev_b32 v18, 2, v51
    v_lshl_add_u32 v18, v35, 4, v18
    v_mov_b32 v50, 0x3fff
    s_lshl_b32 s52, s16, 3
    s_bfm_b64 s[36:37], s52, 0
    s_andn2_b32 s39, s37, 2155905024
    s_mov_b32 s38, s36
mn_again:
    v_mov_b32 v55, 0
    ds_write_b32 v47, v55 offset:0
    ds_write_b32 v47, v55 offset:256
    s_waitcnt vmcnt(0) lgkmcnt(0)
    s_barrier
    v_add_u32 v55, 0, v35
    v_add_u32 v55, s24, v55
    v_lshrrev_b32 v56, 16, v58
    v_mov_b32 v20, 0
    v_cmpx_lt_u32 vcc, v55, v56
    s_cbranch_execz mn_g1
    v_cmp_gt_u32 vcc, 16, v55
    v_and_b32 v56, 0xffff, v58
    v_add_lshl_u32 v56, v55, v56, 2
    v_add_u32 v56, v56, v46
    v_lshl_add_u32 v57, v0, 4, s22
    v_and_or_b32 v57, v55, 12, v57
    v_cndmask_b32 v56, v56, v57, vcc
    buffer_load_dword v20, v56, s[8:11], 0 offen
    s_waitcnt vmcnt(0)
mn_g1:
    s_mov_b64 exec, -1
    v_mov_b32 v21, 0
    v_mov_b32 v22, 0
    v_mov_b32 v23, 0
    v_mov_b32 v24, 0
    s_cmp_le_u32 s20, 4
    s_cbranch_scc1 mn_more
    v_add_u32 v55, 4, v35
    v_add_u32 v55, s24, v55
    v_lshrrev_b32 v56, 16, v58
    v_mov_b32 v21, 0
    v_cmpx_lt_u32 vcc, v55, v56
    s_cbranch_execz mn_g2
    v_cmp_gt_u32 vcc, 16, v55
    v_and_b32 v56, 0xffff, v58
    v_add_lshl_u32 v56, v55, v56, 2
    v_add_u32 v56, v56, v46
    v_lshl_add_u32 v57, v0, 4, s22
    v_and_or_b32 v57, v55, 12, v57
    v_cndmask_b32 v56, v56, v57, vcc
    buffer_load_dword v21, v56, s[8:11], 0 offen
    s_waitcnt vmcnt(0)
mn_g2:
    s_mov_b64 exec, -1
    v_add_u32 v55, 8, v35
    v_add_u32 v55, s24, v55
    v_lshrrev_b32 v56, 16, v58
    v_mov_b32 v22, 0
    v_cmpx_lt_u32 vcc, v55, v56
    s_cbranch_execz mn_g3
    v_cmp_gt_u32 vcc, 16, v55
    v_and_b32 v56, 0xffff, v58
    v_add_lshl_u32 v56, v55, v56, 2
    v_add_u32 v56, v56, v46
    v_lshl_add_u32 v57, v0, 4, s22
    v_and_or_b32 v57, v55, 12, v57
    v_cndmask_b32 v56, v56, v57, vcc
    buffer_load_dword v22, v56, s[8:11], 0 offen
    s_waitcnt vmcnt(0)
mn_g3:
    s_mov_b64 exec, -1
    v_add_u32 v55, 12, v35
    v_add_u32 v55, s24, v55
    v_lshrrev_b32 v56, 16, v58
    v_mov_b32 v23, 0
    v_cmpx_lt_u32 vcc, v55, v56
    s_cbranch_execz mn_g4
    v_cmp_gt_u32 vcc, 16, v55
    v_and_b32 v56, 0xffff, v58
    v_add_lshl_u32 v56, v55, v56, 2
    v_add_u32 v56, v56, v46
    v_lshl_add_u32 v57, v0, 4, s22
    v_and_or_b32 v57, v55, 12, v57
    v_cndmask_b32 v56, v56, v57, vcc
    buffer_load_dword v23, v56, s[8:11], 0 offen
    s_waitcnt vmcnt(0)
mn_g4:
    s_mov_b64 exec, -1
    v_add_u32 v55, 16, v35
    v_add_u32 v55, s24, v55
    v_lshrrev_b32 v56, 16, v58
    v_mov_b32 v24, 0
    v_cmpx_lt_u32 vcc, v55, v56
    s_cbranch_execz mn_g5
    v_cmp_gt_u32 vcc, 16, v55
    v_and_b32 v56, 0xffff, v58
    v_add_lshl_u32 v56, v55, v56, 2
    v_add_u32 v56, v56, v46
    v_lshl_add_u32 v57, v0, 4, s22
    v_and_or_b32 v57, v55, 12, v57
    v_cndmask_b32 v56, v56, v57, vcc
    buffer_load_dword v24, v56, s[8:11], 0 offen
    s_waitcnt vmcnt(0)
mn_g5:
    s_mov_b64 exec, -1
    s_branch mn_more
mn_last:
    s_endpgm
.section .rodata,"a"
.p2align 6
.amdhsa_kernel ka_kernel
  .amdhsa_next_free_vgpr 88
  .amdhsa_next_free_sgpr 40
  .amdhsa_accum_offset 88
  .amdhsa_group_segment_fixed_size 0
  .amdhsa_kernarg_size 88
  .amdhsa_user_sgpr_count 2
  .amdhsa_user_sgpr_kernarg_segment_ptr 1
  .amdhsa_system_sgpr_workgroup_id_x 1
.end_amdhsa_kernel
.p2align 6
.amdhsa_kernel main_kernel
  .amdhsa_next_free_vgpr 168
  .amdhsa_next_free_sgpr 96
  .amdhsa_accum_offset 168
  .amdhsa_group_segment_fixed_size 0
  .amdhsa_kernarg_size 88
  .amdhsa_user_sgpr_count 2
  .amdhsa_user_sgpr_kernarg_segment_ptr 1
  .amdhsa_system_sgpr_workgroup_id_x 1
.end_amdhsa_kernel
```

```asm
; @launch kernel=ka_kernel grid=(256,1,1) block=(768,1,1) lds=83968
; @launch kernel=main_kernel grid=(256,1,1) block=(768,1,1) lds=163840
.amdgcn_target "amdgcn-amd-amdhsa--gfx950"
.text
.globl ka_kernel
.p2align 8
.type ka_kernel,@function
ka_kernel:
    s_cmp_ge_u32 s2, 256
    s_cbranch_scc1 ka_end
    s_cmp_lt_u32 s2, 128
    s_cbranch_scc1 ka_nospf
    s_getpc_b64 s[36:37]
ka_pc0:
    v_lshlrev_b32 v41, 7, v0
    v_min_u32 v41, mn_last-ka_pc0, v41
    global_load_dword v41, v41, s[36:37]
ka_nospf:
    s_load_dwordx8 s[4:11], s[0:1], 8
    s_load_dwordx2 s[16:17], s[0:1], 0
    s_load_dwordx2 s[14:15], s[0:1], 80
    s_load_dwordx2 s[32:33], s[0:1], 56
    v_lshrrev_b32 v9, 6, v0
    v_and_b32 v1, 63, v0
    v_readfirstlane_b32 s18, v9
    s_cmp_ge_u32 s2, 128
    s_cbranch_scc1 ka_pf
    s_cmp_ge_u32 s2, 125
    s_cbranch_scc1 ka_extra
    s_mul_i32 s3, s2, 1280
    v_add_u32 v4, s3, v0
    v_lshlrev_b32 v5, 2, v4
    s_mov_b32 s22, 12582912
    s_mov_b32 s23, 0x20000
    s_and_b32 s28, s2, 7
    s_lshl_b32 s28, s28, 4
    s_lshr_b32 s29, s2, 3
    s_add_u32 s28, s28, s29
    s_cmp_ge_u32 s18, 10
    s_waitcnt lgkmcnt(0)
    s_mov_b32 s20, s14
    s_cbranch_scc1 ka_dma
    global_load_dword v10, v5, s[6:7]
    global_load_dword v60, v5, s[6:7] offset:2560
    global_load_dword v11, v5, s[4:5]
    global_load_dword v61, v5, s[4:5] offset:2560
    v_lshlrev_b32 v2, 2, v0
    v_and_b32 v2, 0x3fc, v2
    v_lshlrev_b32 v5, 4, v0
    v_mov_b32 v44, 0
    v_mov_b32 v45, 0
    v_mov_b32 v46, 0
    v_mov_b32 v47, 0
    ds_write_b32 v2, v44
    ds_write_b128 v5, v[44:47] offset:11264
    ds_write_b128 v5, v[44:47] offset:17408
    s_and_b32 s21, s15, 0xffff
    s_lshl_b32 s28, s28, 2
    s_add_u32 s28, s28, 10485760
    v_mov_b32 v3, 1
    v_lshlrev_b32 v26, 4, v1
    s_lshl_b32 s19, s18, 10
    v_add_u32 v27, s19, v26
    v_mov_b32 v4, 0x40000
    s_movk_i32 s29, 625
    s_movk_i32 s38, 0x3fff
    s_waitcnt lgkmcnt(0)
    s_barrier
    v_mov_b32 v19, 73728
    v_lshl_add_u32 v18, v0, 1, 0
    v_mul_u32_u24 v16, 13108, v18
    v_lshrrev_b32 v16, 16, v16
    v_mad_i32_i24 v18, v16, -5, v18
    v_lshlrev_b32 v16, 2, v16
    v_cmp_eq_u32 vcc, 4, v18
    v_lshlrev_b32 v18, 3, v18
    v_add_u32 v18, 32768, v18
    v_cndmask_b32 v17, 5, 3, vcc
    v_cndmask_b32 v18, v18, v19, vcc
    v_lshl_add_u32 v14, v0, 1, 1
    v_mul_u32_u24 v12, 13108, v14
    v_lshrrev_b32 v12, 16, v12
    v_mad_i32_i24 v14, v12, -5, v14
    v_lshlrev_b32 v12, 2, v12
    v_cmp_eq_u32 vcc, 4, v14
    v_lshlrev_b32 v14, 3, v14
    v_add_u32 v14, 32768, v14
    v_cndmask_b32 v13, 5, 3, vcc
    v_cndmask_b32 v14, v14, v19, vcc
    s_mul_i32 s31, s2, 51200
    s_waitcnt vmcnt(3)
    v_mul_u32_u24 v32, 214749, v10
    v_lshrrev_b32 v32, 23, v32
    v_min_u32 v32, 255, v32
    v_and_b32 v35, 7, v32
    v_lshrrev_b32 v33, 3, v32
    v_lshl_add_u32 v35, v35, 5, v33
    v_lshlrev_b32 v35, 2, v35
    ds_add_rtn_u32 v36, v35, v3
    s_waitcnt vmcnt(2)
    v_mul_u32_u24 v62, 214749, v60
    v_lshrrev_b32 v62, 23, v62
    v_min_u32 v62, 255, v62
    v_and_b32 v66, 7, v62
    v_lshrrev_b32 v63, 3, v62
    v_lshl_add_u32 v66, v66, 5, v63
    v_lshlrev_b32 v66, 2, v66
    ds_add_rtn_u32 v67, v66, v3
    v_mad_u32_u24 v33, v32, s29, 15
    v_lshrrev_b32 v33, 4, v33
    v_sub_u32 v33, v10, v33
    v_subrev_u32 v32, 20, v33
    v_min_u32 v32, v32, v33
    v_min_u32 v32, 19, v32
    v_lshlrev_b32 v40, 4, v35
    v_add_u32 v35, s19, v35
    v_mad_u32_u24 v63, v62, s29, 15
    v_lshrrev_b32 v63, 4, v63
    v_sub_u32 v63, v60, v63
    v_subrev_u32 v62, 20, v63
    v_min_u32 v62, v62, v63
    v_min_u32 v62, 19, v62
    v_lshlrev_b32 v70, 4, v66
    v_add_u32 v66, s19, v66
    s_waitcnt vmcnt(0) lgkmcnt(0)
    v_mul_u32_u24 v39, 3330, v11
    v_lshrrev_b32 v39, 20, v39
    v_lshrrev_b32 v34, 2, v32
    v_cmp_gt_u32 vcc, 27, v39
    v_add_u32 v34, 27, v34
    v_lshlrev_b32 v23, 14, v32
    v_cndmask_b32 v39, v34, v39, vcc
    v_cmp_le_u32 vcc, 20, v33
    v_and_or_b32 v22, v11, s38, v23
    v_or_b32 v39, 64, v39
    v_add_u32 v34, 32, v39
    v_cndmask_b32 v39, v39, v34, vcc
    v_lshl_or_b32 v22, v39, 25, v22
    v_cmp_lt_u32 vcc, 15, v36
    v_and_b32 v34, 3, v36
    v_lshl_add_u32 v40, v34, 4, v40
    v_and_or_b32 v40, v36, 12, v40
    v_cndmask_b32 v40, v40, v4, vcc
    ds_write_b32 v40, v22 offset:11264
    v_mul_u32_u24 v68, 3330, v61
    v_lshrrev_b32 v68, 20, v68
    v_lshrrev_b32 v71, 2, v62
    v_cmp_gt_u32 vcc, 27, v68
    v_add_u32 v71, 27, v71
    v_lshlrev_b32 v75, 14, v62
    v_cndmask_b32 v68, v71, v68, vcc
    v_cmp_le_u32 vcc, 20, v63
    v_and_or_b32 v74, v61, s38, v75
    v_or_b32 v68, 64, v68
    v_add_u32 v71, 32, v68
    v_cndmask_b32 v68, v68, v71, vcc
    v_lshl_or_b32 v74, v68, 25, v74
    v_cmp_lt_u32 vcc, 15, v67
    v_and_b32 v71, 3, v67
    v_lshl_add_u32 v70, v71, 4, v70
    v_and_or_b32 v70, v67, 12, v70
    v_cndmask_b32 v70, v70, v4, vcc
    ds_write_b32 v70, v74 offset:11264
    s_waitcnt lgkmcnt(0)
    s_barrier
    ds_read_b128 v[44:47], v26
    ds_read_b32 v37, v2
    v_add_u32 v28, s19, v2
    v_lshlrev_b32 v29, 9, v0
    v_add_u32 v9, 640, v0
    v_max_u32 v8, v36, v67
    v_cmp_lt_u32 vcc, 15, v8
    s_waitcnt lgkmcnt(1)
    v_add_u32 v53, v44, v45
    v_add_u32 v54, v53, v46
    v_add_u32 v38, v54, v47
    v_mov_b32 v55, v38
    s_nop 0
    v_add_u32_dpp v38, v38, v38 row_shr:1 row_mask:0xf bank_mask:0xf
    s_nop 0
    s_nop 0
    v_add_u32_dpp v38, v38, v38 row_shr:2 row_mask:0xf bank_mask:0xf
    s_nop 0
    s_nop 0
    v_add_u32_dpp v38, v38, v38 row_shr:4 row_mask:0xf bank_mask:0xf
    s_nop 0
    s_nop 0
    v_add_u32_dpp v38, v38, v38 row_shr:8 row_mask:0xf bank_mask:0xf
    s_nop 0
    s_nop 0
    v_add_u32_dpp v38, v38, v38 row_bcast:15 row_mask:0xa bank_mask:0xf
    s_nop 0
    s_nop 0
    v_add_u32_dpp v38, v38, v38 row_bcast:31 row_mask:0xc bank_mask:0xf
    v_sub_u32 v56, v38, v55
    v_add_u32 v57, v56, v44
    v_add_u32 v58, v56, v53
    v_add_u32 v59, v56, v54
    ds_write_b128 v27, v[56:59] offset:1024
    ds_read_b32 v43, v35 offset:1024
    ds_read_b32 v69, v66 offset:1024
    ds_read_b32 v30, v28 offset:1024
    s_cmp_ge_u32 s18, 4
    s_waitcnt lgkmcnt(1)
    v_add_lshl_u32 v43, v43, v36, 2
    v_add_lshl_u32 v69, v69, v67, 2
    ds_write_b32 v43, v0 offset:27648
    ds_write_b32 v69, v9 offset:27648
    s_cbranch_scc1 ka_nohdr
    s_waitcnt lgkmcnt(2)
    v_lshl_or_b32 v30, v37, 16, v30
    buffer_store_dword v30, v29, s[20:23], s28 offen
ka_nohdr:
    s_cbranch_vccnz ka_ov
ka_ov_back:
    s_waitcnt lgkmcnt(0)
ka_copy:
    s_barrier
    ds_read_b32 v20, v16 offset:27648
    ds_read_b32 v21, v12 offset:27648
    ds_read_b32 v22, v16 offset:28672
    ds_read_b32 v23, v12 offset:28672
    ds_read_b32 v24, v16 offset:29696
    ds_read_b32 v25, v12 offset:29696
    ds_read_b32 v26, v16 offset:30720
    ds_read_b32 v27, v12 offset:30720
    ds_read_b32 v28, v16 offset:31744
    ds_read_b32 v29, v12 offset:31744
    s_waitcnt lgkmcnt(8)
    v_lshl_add_u32 v20, v20, v17, v18
    v_lshl_add_u32 v21, v21, v13, v14
    ds_read_b64 v[44:45], v20
    ds_read_b64 v[46:47], v21
    s_waitcnt lgkmcnt(8)
    v_lshl_add_u32 v22, v22, v17, v18
    v_lshl_add_u32 v23, v23, v13, v14
    ds_read_b64 v[48:49], v22
    ds_read_b64 v[50:51], v23
    s_waitcnt lgkmcnt(8)
    v_lshl_add_u32 v24, v24, v17, v18
    v_lshl_add_u32 v25, v25, v13, v14
    ds_read_b64 v[52:53], v24
    ds_read_b64 v[54:55], v25
    s_waitcnt lgkmcnt(8)
    v_lshl_add_u32 v26, v26, v17, v18
    v_lshl_add_u32 v27, v27, v13, v14
    ds_read_b64 v[56:57], v26
    ds_read_b64 v[58:59], v27
    s_waitcnt lgkmcnt(8)
    v_lshl_add_u32 v28, v28, v17, v18
    v_lshl_add_u32 v29, v29, v13, v14
    ds_read_b64 v[60:61], v28
    ds_read_b64 v[62:63], v29
    s_waitcnt lgkmcnt(8)
    buffer_store_dwordx4 v[44:47], v5, s[20:23], s31 offen sc1
    s_addk_i32 s31, 10240
    s_waitcnt lgkmcnt(6)
    buffer_store_dwordx4 v[48:51], v5, s[20:23], s31 offen sc1
    s_addk_i32 s31, 10240
    s_waitcnt lgkmcnt(4)
    buffer_store_dwordx4 v[52:55], v5, s[20:23], s31 offen sc1
    s_addk_i32 s31, 10240
    s_waitcnt lgkmcnt(2)
    buffer_store_dwordx4 v[56:59], v5, s[20:23], s31 offen sc1
    s_addk_i32 s31, 10240
    s_waitcnt lgkmcnt(0)
    buffer_store_dwordx4 v[60:63], v5, s[20:23], s31 offen sc1
    s_endpgm
ka_ov:
    s_mul_i32 s33, s2, 5120
    s_add_u32 s33, s33, 7340032
    buffer_store_dword v22, v43, s[20:23], s33 offen
    buffer_store_dword v74, v69, s[20:23], s33 offen
    s_branch ka_ov_back
ka_dma:
    s_and_b32 s21, s15, 0xffff
    s_sub_u32 s33, s18, 10
    s_lshl_b32 s34, s33, 10
    s_mul_i32 s35, s2, 40960
    s_add_u32 s35, s35, s34
    v_lshl_add_u32 v7, v1, 4, s35
    s_add_u32 m0, s34, 32768
    s_lshl_b32 s30, s28, 6
    s_add_u32 s30, s30, 8388608
    s_barrier
    s_mul_i32 s35, s2, 10240
    s_add_u32 s35, s35, s34
    v_lshl_add_u32 v8, v1, 4, s35
    s_add_u32 m0, s34, 73728
    s_nop 0
    global_load_lds_dwordx4 v8, s[8:9]
    s_add_u32 m0, m0, 2048
    v_add_u32 v8, 2048, v8
    s_nop 0
    global_load_lds_dwordx4 v8, s[8:9]
    s_add_u32 m0, m0, 2048
    v_add_u32 v8, 2048, v8
    s_nop 0
    global_load_lds_dwordx4 v8, s[8:9]
    s_add_u32 m0, m0, 2048
    v_add_u32 v8, 2048, v8
    s_nop 0
    global_load_lds_dwordx4 v8, s[8:9]
    s_add_u32 m0, m0, 2048
    v_add_u32 v8, 2048, v8
    s_nop 0
    global_load_lds_dwordx4 v8, s[8:9]
    s_add_u32 m0, m0, 2048
    v_add_u32 v8, 2048, v8
    s_add_u32 m0, s34, 32768
    s_nop 0
    global_load_lds_dwordx4 v7, s[10:11]
    s_add_u32 m0, m0, 2048
    v_add_u32 v7, 2048, v7
    global_load_lds_dwordx4 v7, s[10:11]
    s_add_u32 m0, m0, 2048
    v_add_u32 v7, 2048, v7
    global_load_lds_dwordx4 v7, s[10:11]
    s_add_u32 m0, m0, 2048
    v_add_u32 v7, 2048, v7
    s_barrier
    global_load_lds_dwordx4 v7, s[10:11]
    s_add_u32 m0, m0, 2048
    v_add_u32 v7, 2048, v7
    global_load_lds_dwordx4 v7, s[10:11]
    s_add_u32 m0, m0, 2048
    v_add_u32 v7, 2048, v7
    global_load_lds_dwordx4 v7, s[10:11]
    s_add_u32 m0, m0, 2048
    v_add_u32 v7, 2048, v7
    global_load_lds_dwordx4 v7, s[10:11]
    s_add_u32 m0, m0, 2048
    v_add_u32 v7, 2048, v7
    global_load_lds_dwordx4 v7, s[10:11]
    s_add_u32 m0, m0, 2048
    v_add_u32 v7, 2048, v7
    global_load_lds_dwordx4 v7, s[10:11]
    s_add_u32 m0, m0, 2048
    v_add_u32 v7, 2048, v7
    global_load_lds_dwordx4 v7, s[10:11]
    s_add_u32 m0, m0, 2048
    v_add_u32 v7, 2048, v7
    global_load_lds_dwordx4 v7, s[10:11]
    s_add_u32 m0, m0, 2048
    v_add_u32 v7, 2048, v7
    global_load_lds_dwordx4 v7, s[10:11]
    s_add_u32 m0, m0, 2048
    v_add_u32 v7, 2048, v7
    global_load_lds_dwordx4 v7, s[10:11]
    s_add_u32 m0, m0, 2048
    v_add_u32 v7, 2048, v7
    global_load_lds_dwordx4 v7, s[10:11]
    s_add_u32 m0, m0, 2048
    v_add_u32 v7, 2048, v7
    global_load_lds_dwordx4 v7, s[10:11]
    s_add_u32 m0, m0, 2048
    v_add_u32 v7, 2048, v7
    global_load_lds_dwordx4 v7, s[10:11]
    s_add_u32 m0, m0, 2048
    v_add_u32 v7, 2048, v7
    global_load_lds_dwordx4 v7, s[10:11]
    s_add_u32 m0, m0, 2048
    v_add_u32 v7, 2048, v7
    global_load_lds_dwordx4 v7, s[10:11]
    s_add_u32 m0, m0, 2048
    v_add_u32 v7, 2048, v7
    global_load_lds_dwordx4 v7, s[10:11]
    s_add_u32 m0, m0, 2048
    v_add_u32 v7, 2048, v7
    global_load_lds_dwordx4 v7, s[10:11]
    s_add_u32 m0, m0, 2048
    v_add_u32 v7, 2048, v7
    v_and_b32 v2, 0x7f, v0
    v_lshlrev_b32 v5, 4, v2
    v_lshrrev_b32 v6, 2, v2
    v_lshlrev_b32 v6, 13, v6
    v_and_or_b32 v6, v5, 0x30, v6
    ds_read_b128 v[44:47], v5 offset:11264
    ds_read_b128 v[48:51], v5 offset:13312
    ds_read_b128 v[52:55], v5 offset:15360
    ds_read_b128 v[56:59], v5 offset:17408
    ds_read_b128 v[60:63], v5 offset:19456
    ds_read_b128 v[64:67], v5 offset:21504
    ds_read_b128 v[68:71], v5 offset:23552
    ds_read_b128 v[72:75], v5 offset:25600
    s_waitcnt lgkmcnt(7)
    buffer_store_dwordx4 v[44:47], v6, s[20:23], s30 offen
    s_add_u32 s30, s30, 262144
    s_waitcnt lgkmcnt(6)
    buffer_store_dwordx4 v[48:51], v6, s[20:23], s30 offen
    s_add_u32 s30, s30, 262144
    s_waitcnt lgkmcnt(5)
    buffer_store_dwordx4 v[52:55], v6, s[20:23], s30 offen
    s_add_u32 s30, s30, 262144
    s_waitcnt lgkmcnt(4)
    buffer_store_dwordx4 v[56:59], v6, s[20:23], s30 offen
    s_add_u32 s30, s30, 262144
    s_waitcnt lgkmcnt(3)
    buffer_store_dwordx4 v[60:63], v6, s[20:23], s30 offen
    s_add_u32 s30, s30, 262144
    s_waitcnt lgkmcnt(2)
    buffer_store_dwordx4 v[64:67], v6, s[20:23], s30 offen
    s_add_u32 s30, s30, 262144
    s_waitcnt lgkmcnt(1)
    buffer_store_dwordx4 v[68:71], v6, s[20:23], s30 offen
    s_add_u32 s30, s30, 262144
    s_waitcnt lgkmcnt(0)
    buffer_store_dwordx4 v[72:75], v6, s[20:23], s30 offen
    s_waitcnt vmcnt(8)
    s_barrier
    s_endpgm
ka_pf:
    s_sub_u32 s34, s2, 127
    s_mul_i32 s34, s34, 40960
    s_sub_u32 s34, s34, 40960
    v_lshl_add_u32 v44, v0, 7, s34
    v_min_u32 v44, 5119996, v44
    s_waitcnt lgkmcnt(0)
    s_cmp_ge_u32 s18, 5
    s_cbranch_scc1 ka_nohlp
    global_load_dword v45, v44, s[10:11]
ka_nohlp:
    s_and_b32 s34, s2, 7
    s_mul_i32 s34, s34, 917504
    s_add_u32 s24, s16, s34
    s_addc_u32 s25, s17, 0
    s_and_b32 s25, s25, 0xffff
    s_mov_b32 s26, 917504
    s_mov_b32 s27, 0x20000
    s_bfe_u32 s30, s2, 0x40003
    v_lshlrev_b32 v40, 7, v0
    s_mul_i32 s30, s30, 57344
    s_cmp_lg_u32 s18, 9
    s_cbranch_scc1 ka_pf1
    s_bitcmp1_b32 s2, 3
    s_cbranch_scc1 ka_pf1
    s_and_b32 s35, s2, 7
    s_bfe_u32 s36, s2, 0x30004
    s_lshl_b32 s37, s35, 14
    s_lshr_b32 s38, s36, 1
    s_lshl_b32 s38, s38, 7
    s_add_u32 s37, s37, s38
    s_and_b32 s38, s36, 1
    s_lshl2_add_u32 s37, s38, s37
    v_lshrrev_b32 v44, 4, v1
    v_lshlrev_b32 v44, 11, v44
    v_and_b32 v45, 7, v1
    v_lshl_add_u32 v44, v45, 4, v44
    v_and_b32 v45, 8, v1
    v_add3_u32 v44, v44, v45, s37
    v_add_u32 v45, 0x2000, v44
    global_load_dword v48, v44, s[32:33] offset:0
    global_load_dword v49, v44, s[32:33] offset:512
    global_load_dword v50, v44, s[32:33] offset:1024
    global_load_dword v51, v44, s[32:33] offset:1536
    global_load_dword v52, v45, s[32:33] offset:0
    global_load_dword v53, v45, s[32:33] offset:512
    global_load_dword v54, v45, s[32:33] offset:1024
    global_load_dword v55, v45, s[32:33] offset:1536
    s_lshr_b32 s36, s36, 1
    s_lshl3_add_u32 s36, s36, s35
    s_lshl1_add_u32 s36, s36, s38
    s_lshl_b32 s36, s36, 11
    s_add_u32 s36, s36, 11534336
    v_lshl_add_u32 v46, v1, 4, s36
    s_mov_b32 s38, 0x05040100
    s_mov_b32 s39, 0x07060302
    s_waitcnt vmcnt(0)
    v_perm_b32 v56, v49, v48, s38
    v_perm_b32 v60, v49, v48, s39
    v_perm_b32 v57, v51, v50, s38
    v_perm_b32 v61, v51, v50, s39
    v_perm_b32 v58, v53, v52, s38
    v_perm_b32 v62, v53, v52, s39
    v_perm_b32 v59, v55, v54, s38
    v_perm_b32 v63, v55, v54, s39
    global_store_dwordx4 v46, v[56:59], s[14:15]
    global_store_dwordx4 v46, v[60:63], s[14:15] offset:1024
ka_pf1:
    s_cmp_ge_u32 s18, 7
    s_cbranch_scc1 ka_end
    s_waitcnt vmcnt(0)
    buffer_load_dword v42, v40, s[24:27], s30 offen
    s_cmp_ge_u32 s18, 0
    s_cbranch_scc1 ka_end
    s_add_u32 s30, s30, 81920
    buffer_load_dword v43, v40, s[24:27], s30 offen
    s_endpgm
ka_extra:
    s_cmp_lg_u32 s2, 125
    s_cbranch_scc1 ka_end
    s_cmp_ge_u32 s18, 5
    s_cbranch_scc1 ka_end
    s_load_dwordx4 s[36:39], s[0:1], 40
    s_lshl_b32 s34, s18, 11
    s_add_u32 s34, s34, 11665408
    v_lshl_add_u32 v46, v1, 4, s34
    s_cmp_eq_u32 s18, 5
    s_cbranch_scc1 ka_dum
    s_cmp_eq_u32 s18, 4
    s_cbranch_scc1 ka_cg
    v_lshrrev_b32 v44, 5, v1
    v_lshlrev_b32 v44, 12, v44
    v_and_b32 v45, 31, v1
    v_lshl_add_u32 v44, v45, 1, v44
    v_lshl_add_u32 v44, s18, 7, v44
    s_waitcnt lgkmcnt(0)
    global_load_ushort v48, v44, s[38:39] offset:0
    global_load_ushort v49, v44, s[38:39] offset:512
    global_load_ushort v50, v44, s[38:39] offset:1024
    global_load_ushort v51, v44, s[38:39] offset:1536
    global_load_ushort v52, v44, s[38:39] offset:2048
    global_load_ushort v53, v44, s[38:39] offset:2560
    global_load_ushort v54, v44, s[38:39] offset:3072
    global_load_ushort v55, v44, s[38:39] offset:3584
    global_load_ushort v56, v44, s[38:39] offset:64
    global_load_ushort v57, v44, s[38:39] offset:576
    global_load_ushort v58, v44, s[38:39] offset:1088
    global_load_ushort v59, v44, s[38:39] offset:1600
    global_load_ushort v60, v44, s[38:39] offset:2112
    global_load_ushort v61, v44, s[38:39] offset:2624
    global_load_ushort v62, v44, s[38:39] offset:3136
    global_load_ushort v63, v44, s[38:39] offset:3648
    s_branch ka_pk
ka_cg:
    v_and_b32 v44, 3, v1
    v_lshlrev_b32 v44, 1, v44
    s_waitcnt lgkmcnt(0)
    global_load_ushort v48, v44, s[36:37] offset:0
    global_load_ushort v49, v44, s[36:37] offset:8
    global_load_ushort v50, v44, s[36:37] offset:16
    global_load_ushort v51, v44, s[36:37] offset:24
    global_load_ushort v52, v44, s[36:37] offset:32
    global_load_ushort v53, v44, s[36:37] offset:40
    global_load_ushort v54, v44, s[36:37] offset:48
    global_load_ushort v55, v44, s[36:37] offset:56
    global_load_ushort v56, v44, s[36:37] offset:64
    global_load_ushort v57, v44, s[36:37] offset:72
    global_load_ushort v58, v44, s[36:37] offset:80
    global_load_ushort v59, v44, s[36:37] offset:88
    global_load_ushort v60, v44, s[36:37] offset:96
    global_load_ushort v61, v44, s[36:37] offset:104
    global_load_ushort v62, v44, s[36:37] offset:112
    global_load_ushort v63, v44, s[36:37] offset:120
ka_pk:
    s_waitcnt vmcnt(0)
    v_lshl_or_b32 v64, v49, 16, v48
    v_lshl_or_b32 v65, v51, 16, v50
    v_lshl_or_b32 v66, v53, 16, v52
    v_lshl_or_b32 v67, v55, 16, v54
    v_lshl_or_b32 v68, v57, 16, v56
    v_lshl_or_b32 v69, v59, 16, v58
    v_lshl_or_b32 v70, v61, 16, v60
    v_lshl_or_b32 v71, v63, 16, v62
    global_store_dwordx4 v46, v[64:67], s[14:15]
    global_store_dwordx4 v46, v[68:71], s[14:15] offset:1024
    s_endpgm
ka_dum:
    v_mov_b32 v46, 11677696
    v_mov_b32 v48, 0
    v_mov_b32 v49, 0
    v_mov_b32 v50, 0
    v_mov_b32 v51, 0
    v_mov_b32 v52, 0x3fff
    v_mov_b32 v53, 186843136
    s_mov_b64 exec, 1
    s_waitcnt lgkmcnt(0)
    global_store_dwordx4 v46, v[48:51], s[14:15]
    global_store_dwordx4 v46, v[48:51], s[14:15] offset:16
    global_store_dwordx4 v46, v[50:53], s[14:15] offset:32
ka_end:
    s_endpgm
.globl main_kernel
.p2align 8
.type main_kernel,@function
main_kernel:
    s_cmp_ge_u32 s2, 256
    s_cbranch_scc1 mn_end
    s_load_dwordx2 s[54:55], s[0:1], 80
    s_load_dwordx2 s[50:51], s[0:1], 0
    v_lshrrev_b32 v56, 6, v0
    s_and_b32 s48, s2, 7
    v_readfirstlane_b32 s16, v56
    s_lshr_b32 s47, s2, 3
    s_lshl_b32 s25, s48, 5
    s_add_u32 s25, s25, s47
    s_lshl_b32 s49, s25, 13
    s_add_u32 s49, s49, 8388608
    s_mov_b32 s22, s49
    s_lshl_b32 s25, s25, 9
    s_add_u32 s25, s25, 10485760
    s_mov_b32 s10, 12582912
    s_mov_b32 s11, 0x20000
    s_and_b32 s17, s16, 3
    s_movk_i32 s20, 20
    s_mov_b32 s24, 0
    s_cmp_ge_u32 s16, 8
    s_cbranch_scc1 gm_main
    v_lshrrev_b32 v56, 6, v0
    v_lshlrev_b32 v55, 1, v0
    v_and_b32 v55, 0x78, v55
    v_or_b32 v55, v55, v56
    v_cmp_gt_u32 vcc, 125, v55
    v_mul_u32_u24 v46, 5120, v55
    v_add_u32 v46, 7340032, v46
    v_bfrev_b32 v56, 2
    v_lshlrev_b32 v55, 4, v0
    v_and_b32 v57, 0x1fc, v0
    v_cndmask_b32 v55, v56, v55, vcc
    v_cndmask_b32 v57, v56, v57, vcc
    v_and_b32 v51, 63, v0
    v_lshlrev_b32 v56, 3, v51
    s_lshl_b32 s52, s17, 11
    s_add_u32 s52, s52, 11665408
    s_mov_b32 s53, 11673600
    v_lshlrev_b32 v52, 4, v51
    s_waitcnt lgkmcnt(0)
    s_mov_b32 s8, s54
    s_and_b32 s9, s55, 0xffff
    buffer_load_dwordx4 v[20:23], v55, s[8:11], s49 offen
    buffer_load_dword v58, v57, s[8:11], s25 offen
    buffer_load_dwordx2 v[44:45], v56, s[8:11], s25 offen
    s_barrier
    buffer_load_dwordx4 v[68:71], v52, s[8:11], s52 offen
    buffer_load_dwordx4 v[72:75], v52, s[8:11], s52 offen offset:1024
    buffer_load_dwordx4 v[76:79], v52, s[8:11], s53 offen
    buffer_load_dwordx4 v[80:83], v52, s[8:11], s53 offen offset:1024
    v_mov_b32 v24, 0
    s_lshr_b32 s18, s16, 2
    s_lshl_b32 s53, s17, 7
    s_add_u32 s4, s50, s53
    s_addc_u32 s5, s51, 0
    s_and_b32 s5, s5, 0xffff
    s_or_b32 s5, s5, 0x08000000
    s_movk_i32 s6, 10000
    s_mov_b32 s7, 0x20000
    s_mul_i32 s40, s16, 15360
    s_add_u32 s40, s40, 40960
    v_lshl_add_u32 v87, v51, 3, s40
    s_add_u32 s40, s40, 9216
    s_add_u32 s41, s40, 1024
    s_add_u32 s42, s40, 2048
    s_add_u32 s43, s40, 3072
    s_add_u32 s44, s40, 4096
    s_add_u32 s45, s40, 5120
    v_and_b32 v55, 3, v0
    v_bfe_u32 v56, v0, 2, 2
    v_bfe_u32 v57, v0, 4, 1
    v_bfe_u32 v53, v0, 5, 1
    v_lshlrev_b32 v1, 3, v55
    v_lshl_add_u32 v1, v57, 5, v1
    v_lshl_add_u32 v1, v56, 6, v1
    v_lshl_add_u32 v1, v53, 8, v1
    v_add_u32 v1, s40, v1
    v_lshlrev_b32 v5, 4, v55
    v_lshl_add_u32 v5, v57, 6, v5
    v_lshl_add_u32 v5, v56, 9, v5
    v_mov_b32 v7, v5
    v_bfe_u32 v55, v0, 2, 1
    v_lshlrev_b32 v86, 4, v53
    v_lshl_or_b32 v86, v55, 18, v86
    v_mov_b32 v48, 1
    v_lshlrev_b32 v47, 2, v51
    v_bfe_u32 v2, v0, 5, 1
    v_bfe_u32 v3, v0, 3, 2
    v_and_b32 v35, 3, v0
    v_lshl_add_u32 v3, v3, 2, v35
    v_mul_u32_u24 v49, 20, v2
    v_lshrrev_b32 v18, 2, v51
    v_lshl_add_u32 v18, v35, 4, v18
    v_mov_b32 v50, 0x3fff
    s_lshl_b32 s52, s16, 3
    s_bfm_b64 s[36:37], s52, 0
    s_andn2_b32 s39, s37, 2155905024
    s_mov_b32 s38, s36
    v_mov_b64 v[88:89], 0
    v_mov_b64 v[90:91], 0
    v_mov_b64 v[92:93], 0
    v_mov_b64 v[94:95], 0
    v_mov_b64 v[96:97], 0
    v_mov_b64 v[98:99], 0
    v_mov_b64 v[100:101], 0
    v_mov_b64 v[102:103], 0
    v_mov_b64 v[104:105], 0
    v_mov_b64 v[106:107], 0
    v_mov_b64 v[108:109], 0
    v_mov_b64 v[110:111], 0
    v_mov_b64 v[112:113], 0
    v_mov_b64 v[114:115], 0
    v_mov_b64 v[116:117], 0
    v_mov_b64 v[118:119], 0
    v_mov_b64 v[120:121], 0
    v_mov_b64 v[122:123], 0
    v_mov_b64 v[124:125], 0
    v_mov_b64 v[126:127], 0
    v_mov_b64 v[128:129], 0
    v_mov_b64 v[130:131], 0
    v_mov_b64 v[132:133], 0
    v_mov_b64 v[134:135], 0
    v_mov_b64 v[136:137], 0
    v_mov_b64 v[138:139], 0
    v_mov_b64 v[140:141], 0
    v_mov_b64 v[142:143], 0
    v_mov_b64 v[144:145], 0
    v_mov_b64 v[146:147], 0
    v_mov_b64 v[148:149], 0
    v_mov_b64 v[150:151], 0
    v_mov_b64 v[152:153], 0
    v_mov_b64 v[154:155], 0
    v_mov_b64 v[156:157], 0
    v_mov_b64 v[158:159], 0
    v_mov_b64 v[160:161], 0
    v_mov_b64 v[162:163], 0
    v_mov_b64 v[164:165], 0
    v_mov_b64 v[166:167], 0
    s_mov_b32 s52, 0x110000
    s_waitcnt vmcnt(4)
    v_cmp_le_u32 vcc, s52, v58
    s_cbranch_vccnz mn_w5
mn_count:
    v_cmpx_gt_i32 vcc, 0, v20
    s_cbranch_execz mn_cn_done
    v_lshrrev_b32 v25, 23, v20
    v_and_b32 v25, 0xfc, v25
    ds_add_rtn_u32 v30, v25, v48
    v_cmpx_gt_i32 vcc, 0, v21
    s_cbranch_execz mn_cn_done
    v_lshrrev_b32 v26, 23, v21
    v_and_b32 v26, 0xfc, v26
    ds_add_rtn_u32 v31, v26, v48
    v_cmpx_gt_i32 vcc, 0, v22
    s_cbranch_execz mn_cn_done
    v_lshrrev_b32 v27, 23, v22
    v_and_b32 v27, 0xfc, v27
    ds_add_rtn_u32 v32, v27, v48
    v_cmpx_gt_i32 vcc, 0, v23
    s_cbranch_execz mn_cn_done
    v_lshrrev_b32 v28, 23, v23
    v_and_b32 v28, 0xfc, v28
    ds_add_rtn_u32 v33, v28, v48
    v_cmpx_gt_i32 vcc, 0, v24
    s_cbranch_execz mn_cn_done
    v_lshrrev_b32 v29, 23, v24
    v_and_b32 v29, 0xfc, v29
    ds_add_rtn_u32 v34, v29, v48
mn_cn_done:
    s_mov_b64 exec, -1
    v_lshrrev_b32 v42, 16, v58
    v_subrev_u32 v42, s24, v42
    v_med3_i32 v42, v42, 0, s20
    v_lshrrev_b32 v55, 16, v44
    v_subrev_u32 v55, s24, v55
    v_med3_i32 v55, v55, 0, s20
    v_lshrrev_b32 v56, 16, v45
    v_subrev_u32 v56, s24, v56
    v_med3_i32 v56, v56, 0, s20
    v_mov_b32 v43, v42
    v_cndmask_b32 v55, 0, v55, s[36:37]
    v_cndmask_b32 v56, 0, v56, s[38:39]
    v_add_u32 v59, v55, v56
    v_mov_b32 v52, 0
    s_lshl_b32 s52, s18, 5
    s_add_u32 s53, s52, 31
    s_waitcnt lgkmcnt(0)
    s_barrier
    ds_read_b32 v53, v47 offset:0
    ds_read_b32 v52, v52 offset:272
    v_add_u32_dpp v59, v59, v59 row_shr:1 row_mask:0xf bank_mask:0xf
    s_nop 1
    v_add_u32_dpp v59, v59, v59 row_shr:2 row_mask:0xf bank_mask:0xf
    s_nop 1
    v_add_u32_dpp v59, v59, v59 row_shr:4 row_mask:0xf bank_mask:0xf
    v_add_u32_dpp v43, v43, v43 row_shr:4 row_mask:0xf bank_mask:0xf
    s_nop 0
    v_add_u32_dpp v59, v59, v59 row_shr:8 row_mask:0xf bank_mask:0xf
    v_add_u32_dpp v43, v43, v43 row_shr:8 row_mask:0xf bank_mask:0xf
    s_nop 0
    v_add_u32_dpp v59, v59, v59 row_bcast:15 row_mask:0xa bank_mask:0xf
    v_add_u32_dpp v43, v43, v43 row_bcast:15 row_mask:0xa bank_mask:0xf
    s_nop 0
    v_add_u32_dpp v59, v59, v59 row_bcast:31 row_mask:0xc bank_mask:0xf
    v_add_u32_dpp v43, v43, v43 row_bcast:31 row_mask:0xc bank_mask:0xf
    s_nop 0
    v_readlane_b32 s49, v59, 63
    v_sub_u32 v41, v43, v42
    s_movk_i32 s48, 0x3fff
    s_waitcnt lgkmcnt(1)
    v_mov_b32 v54, v53
    v_sub_u32 v53, v49, v53
    v_add3_u32 v41, v41, v35, s49
    v_add_u32_dpp v54, v54, v54 row_shr:1 row_mask:0xf bank_mask:0xf
    v_add_u32 v41, 72, v41
    v_lshlrev_b32 v41, 16, v41
    v_add_u32_dpp v54, v54, v54 row_shr:2 row_mask:0xf bank_mask:0xf
    v_and_or_b32 v36, v20, s48, v41
    v_add_u32 v41, 262144, v41
    v_add_u32_dpp v54, v54, v54 row_shr:4 row_mask:0xf bank_mask:0xf
    v_and_or_b32 v37, v21, s48, v41
    v_add_u32 v41, 262144, v41
    v_add_u32_dpp v54, v54, v54 row_shr:8 row_mask:0xf bank_mask:0xf
    v_and_or_b32 v38, v22, s48, v41
    v_add_u32 v41, 262144, v41
    v_add_u32_dpp v54, v54, v54 row_bcast:15 row_mask:0xa bank_mask:0xf
    v_and_or_b32 v39, v23, s48, v41
    v_add_u32 v41, 262144, v41
    v_add_u32_dpp v54, v54, v54 row_bcast:31 row_mask:0xc bank_mask:0xf
    v_add_u32 v53, v53, v54
    v_add_u32 v54, v54, v49
    ds_bpermute_b32 v25, v25, v53
    ds_bpermute_b32 v26, v26, v53
    ds_bpermute_b32 v27, v27, v53
    ds_bpermute_b32 v28, v28, v53
    ds_bpermute_b32 v29, v29, v53
    v_and_or_b32 v40, v24, s48, v41
    v_bfe_u32 v56, v20, 14, 5
    v_lshl_or_b32 v36, v56, 26, v36
    v_bfe_u32 v56, v21, 14, 5
    v_lshl_or_b32 v37, v56, 26, v37
    v_bfe_u32 v56, v22, 14, 5
    v_lshl_or_b32 v38, v56, 26, v38
    v_bfe_u32 v56, v23, 14, 5
    v_lshl_or_b32 v39, v56, 26, v39
    v_bfe_u32 v56, v24, 14, 5
    v_lshl_or_b32 v40, v56, 26, v40
    v_readlane_b32 s23, v54, 63
    v_readlane_b32 s33, v54, s53
    v_readlane_b32 s32, v53, s52
    s_cmp_gt_u32 s23, 793
    s_cbranch_scc1 mn_ovf
    v_add_lshl_u32 v55, s33, v51, 2
    s_mov_b32 exec_lo, 1048575
    s_mov_b32 exec_hi, 0
    ds_write_b32 v55, v50 offset:512
    s_mov_b64 exec, -1
    v_add_lshl_u32 v2, s32, v2, 2
    v_add_lshl_u32 v3, s32, v3, 2
    v_add_lshl_u32 v18, s32, v18, 2
    s_waitcnt lgkmcnt(1)
    v_readfirstlane_b32 s21, v52
    v_cmpx_gt_i32 vcc, 0, v20
    s_cbranch_execz mn_w2_done
    v_add_lshl_u32 v25, v25, v30, 2
    ds_write_b32 v25, v36 offset:512
    v_cmpx_gt_i32 vcc, 0, v21
    s_cbranch_execz mn_w2_done
    v_add_lshl_u32 v26, v26, v31, 2
    ds_write_b32 v26, v37 offset:512
    v_cmpx_gt_i32 vcc, 0, v22
    s_cbranch_execz mn_w2_done
    v_add_lshl_u32 v27, v27, v32, 2
    ds_write_b32 v27, v38 offset:512
    v_cmpx_gt_i32 vcc, 0, v23
    s_cbranch_execz mn_w2_done
    v_add_lshl_u32 v28, v28, v33, 2
    ds_write_b32 v28, v39 offset:512
    v_cmpx_gt_i32 vcc, 0, v24
    s_cbranch_execz mn_w2_done
    v_add_lshl_u32 v29, v29, v34, 2
    ds_write_b32 v29, v40 offset:512
mn_w2_done:
    s_mov_b64 exec, -1
    s_mov_b32 m0, s40
    s_sub_u32 s32, s32, 3
    s_sub_u32 s59, s33, s32
    s_lshr_b32 s59, s59, 2
    s_waitcnt lgkmcnt(0)
    s_barrier
    ds_read_u16 v4, v2 offset:512
    ds_read_u16 v6, v2 offset:520
    ds_read_u16 v8, v18 offset:514
    ds_read_u16 v84, v3 offset:514
    ds_read_u16 v22, v2 offset:528
    ds_read_u16 v23, v2 offset:536
    ds_read_u16 v24, v2 offset:544
    ds_read_u16 v25, v2 offset:552
    ds_read_u16 v26, v2 offset:560
    ds_read_u16 v27, v2 offset:568
    s_sub_u32 s53, s53, 4
    v_readlane_b32 s84, v54, s53
    s_add_u32 s53, s53, 1
    v_readlane_b32 s85, v54, s53
    s_add_u32 s53, s53, 1
    v_readlane_b32 s86, v54, s53
    s_add_u32 s53, s53, 1
    v_readlane_b32 s87, v54, s53
    s_waitcnt lgkmcnt(8)
    buffer_load_dwordx4 v[4:5], s[4:7], 0 idxen offen lds
    s_mov_b32 m0, s41
    s_waitcnt lgkmcnt(6)
    buffer_load_dwordx4 v[6:7], s[4:7], 0 idxen offen lds
    v_lshrrev_b32 v11, 8, v8
    v_and_b32 v8, 0x3ff, v8
    v_mul_u32_u24 v8, 48, v8
    v_and_b32 v84, 0x3ff, v84
    v_mad_u32_u24 v84, v84, 48, v86
    v_xor_b32 v85, 0x40000, v84
    s_waitcnt lgkmcnt(0)
    s_mov_b32 m0, s42
    v_mov_b32 v4, v22
    buffer_load_dwordx4 v[4:5], s[4:7], 0 idxen offen lds
    s_mov_b32 m0, s43
    v_mov_b32 v4, v23
    buffer_load_dwordx4 v[4:5], s[4:7], 0 idxen offen lds
    s_setprio 2
    s_waitcnt vmcnt(4) lgkmcnt(0)
    s_barrier
    ds_read_b64 v[8:9], v8 offset:352
    ds_read_b128 v[60:63], v84 offset:320
    ds_read_b128 v[64:67], v85 offset:320
    s_mov_b32 m0, s44
    v_mov_b32 v4, v24
    buffer_load_dwordx4 v[4:5], s[4:7], 0 idxen offen lds
    s_mov_b32 m0, s45
    v_mov_b32 v4, v25
    buffer_load_dwordx4 v[4:5], s[4:7], 0 idxen offen lds
    v_mov_b32 v4, v26
    v_mov_b32 v6, v27
    s_waitcnt vmcnt(4)
    ds_read_b64_tr_b16 v[20:21], v1 offset:0
    ds_read_b64_tr_b16 v[22:23], v1 offset:512
    ds_read_b64_tr_b16 v[24:25], v1 offset:1024
    ds_read_b64_tr_b16 v[26:27], v1 offset:1536
    s_waitcnt lgkmcnt(6)
    v_mfma_f32_4x4x4_16b_bf16 v[28:31], v[8:9], v[76:77], 0
    v_mfma_f32_4x4x4_16b_bf16 v[32:35], v[8:9], v[78:79], 0
    v_mfma_f32_4x4x4_16b_bf16 v[36:39], v[8:9], v[80:81], 0
    v_mfma_f32_4x4x4_16b_bf16 v[40:43], v[8:9], v[82:83], 0
    v_min_u32 v0, 1, v51
    v_lshlrev_b32 v0, 18, v0
    v_lshl_add_u32 v0, s17, 2, v0
    s_lshl_b32 s52, s18, 1
    s_sub_i32 s52, 1, s52
    s_mul_i32 s53, s52, s59
    s_add_i32 s53, s53, 0
    v_mov_b32 v19, s53
    v_and_b32 v11, 0x7c, v11
    v_or_b32 v11, 0xc000, v11
    v_lshlrev_b32 v10, 16, v11
    s_waitcnt lgkmcnt(4)
    v_mfma_f32_32x32x16_bf16 v[44:59], v[60:63], v[68:71], 0
    v_mfma_f32_32x32x16_bf16 v[44:59], v[64:67], v[72:75], v[44:59]
    s_mov_b32 m0, s40
    s_waitcnt lgkmcnt(0)
    buffer_load_dwordx4 v[4:5], s[4:7], 0 idxen offen lds
    s_mov_b32 m0, s41
    ds_add_u32 v0, v19 offset:288
    buffer_load_dwordx4 v[6:7], s[4:7], 0 idxen offen lds
    v_or_b32_dpp v19, v10, v11 row_shl:4 row_mask:0xf bank_mask:0xf bound_ctrl:0
    v_cvt_pk_bf16_f32 v12, v28, v32
    v_cvt_pk_bf16_f32 v14, v29, v33
    v_cvt_pk_bf16_f32 v16, v30, v34
    v_cvt_pk_bf16_f32 v13, v36, v40
    v_cvt_pk_bf16_f32 v15, v37, v41
    v_cvt_pk_bf16_f32 v17, v38, v42
    s_sub_u32 s84, s84, s32
    s_lshr_b32 s84, s84, 2
    s_sub_u32 s85, s85, s32
    s_lshr_b32 s85, s85, 2
    s_sub_u32 s86, s86, s32
    s_lshr_b32 s86, s86, 2
    s_sub_u32 s87, s87, s32
    s_lshr_b32 s87, s87, 2
    s_sub_u32 s88, s59, s87
    s_sub_u32 s87, s87, s86
    s_sub_u32 s86, s86, s85
    s_sub_u32 s85, s85, s84
    s_cmp_lg_u32 s21, 0
    s_cselect_b32 s19, s59, s84
    s_mov_b32 s58, 0
    s_mov_b32 s35, 0
    s_mov_b64 s[46:47], -1
    s_sub_i32 s34, s59, 4
    s_max_i32 s34, s34, 0
    s_mul_i32 s30, s52, -4
    s_lshl_b32 s26, s18, 31
    s_set_gpr_idx_on s40, gpr_idx(SRC2,DST)
    s_sub_u32 s19, s19, 1
    s_cbranch_scc1 mn_st12
mn_st12_back:
mn_loop:
    v_mfma_f32_4x4x4_16b_bf16 v[28:31], v[12:13], v[20:21], 0 cbsz:4 abid:0
    v_mfma_f32_4x4x4_16b_bf16 v[32:35], v[12:13], v[22:23], 0 cbsz:4 abid:1
    v_mfma_f32_4x4x4_16b_bf16 v[36:39], v[12:13], v[24:25], 0 cbsz:4 abid:2
    v_mfma_f32_4x4x4_16b_bf16 v[40:43], v[12:13], v[26:27], 0 cbsz:4 abid:3
    ds_read_u16 v4, v2 offset:576
    ds_read_u16 v6, v2 offset:584
    v_readlane_b32 s28, v19, 0
    v_readlane_b32 s29, v19, 8
    s_waitcnt vmcnt(5)
    ds_read_b64_tr_b16 v[20:21], v1 offset:2048
    ds_read_b64_tr_b16 v[22:23], v1 offset:2560
    s_waitcnt vmcnt(4)
    ds_read_b64_tr_b16 v[24:25], v1 offset:3072
    ds_read_b64_tr_b16 v[26:27], v1 offset:3584
    s_sub_u32 s34, s34, 1
    s_cmov_b32 s35, 0x30000
    s_mov_b32 m0, s28
    v_fmac_f32 v88, v28, v44
    v_fmac_f32 v89, v29, v44
    v_fmac_f32 v90, v30, v44
    v_fmac_f32 v91, v31, v44
    s_lshr_b32 m0, s28, 16
    v_fmac_f32 v88, v32, v45
    v_fmac_f32 v89, v33, v45
    v_fmac_f32 v90, v34, v45
    v_fmac_f32 v91, v35, v45
    s_mov_b32 m0, s29
    v_fmac_f32 v88, v36, v46
    v_fmac_f32 v89, v37, v46
    v_fmac_f32 v90, v38, v46
    v_fmac_f32 v91, v39, v46
    s_lshr_b32 m0, s29, 16
    v_fmac_f32 v88, v40, v47
    v_fmac_f32 v89, v41, v47
    v_fmac_f32 v90, v42, v47
    v_fmac_f32 v91, v43, v47
    s_or_b32 m0, s42, s35
    s_waitcnt lgkmcnt(2)
    buffer_load_dwordx4 v[4:5], s[4:7], 0 idxen offen lds
    s_or_b32 m0, s43, s35
    s_waitcnt lgkmcnt(0)
    buffer_load_dwordx4 v[6:7], s[4:7], 0 idxen offen lds
    s_sub_u32 s19, s19, 1
    s_cbranch_scc1 mn_st0
mn_st0_back:
    v_mfma_f32_4x4x4_16b_bf16 v[28:31], v[12:13], v[20:21], 0 cbsz:4 abid:4
    v_mfma_f32_4x4x4_16b_bf16 v[32:35], v[12:13], v[22:23], 0 cbsz:4 abid:5
    v_mfma_f32_4x4x4_16b_bf16 v[36:39], v[12:13], v[24:25], 0 cbsz:4 abid:6
    v_mfma_f32_4x4x4_16b_bf16 v[40:43], v[12:13], v[26:27], 0 cbsz:4 abid:7
    ds_read_u16 v4, v2 offset:592
    ds_read_u16 v6, v2 offset:600
    v_readlane_b32 s28, v19, 16
    v_readlane_b32 s29, v19, 24
    ds_read_u16 v84, v3 offset:578
    s_waitcnt vmcnt(5)
    ds_read_b64_tr_b16 v[20:21], v1 offset:4096
    ds_read_b64_tr_b16 v[22:23], v1 offset:4608
    s_waitcnt vmcnt(4)
    ds_read_b64_tr_b16 v[24:25], v1 offset:5120
    ds_read_b64_tr_b16 v[26:27], v1 offset:5632
    s_sub_u32 s34, s34, 1
    s_cmov_b32 s35, 0x30000
    s_mov_b32 m0, s28
    v_fmac_f32 v88, v28, v48
    v_fmac_f32 v89, v29, v48
    v_fmac_f32 v90, v30, v48
    v_fmac_f32 v91, v31, v48
    s_lshr_b32 m0, s28, 16
    v_fmac_f32 v88, v32, v49
    v_fmac_f32 v89, v33, v49
    v_fmac_f32 v90, v34, v49
    v_fmac_f32 v91, v35, v49
    s_mov_b32 m0, s29
    v_fmac_f32 v88, v36, v50
    v_fmac_f32 v89, v37, v50
    v_fmac_f32 v90, v38, v50
    v_fmac_f32 v91, v39, v50
    s_lshr_b32 m0, s29, 16
    v_fmac_f32 v88, v40, v51
    v_fmac_f32 v89, v41, v51
    v_fmac_f32 v90, v42, v51
    v_fmac_f32 v91, v43, v51
    s_or_b32 m0, s44, s35
    s_waitcnt lgkmcnt(2)
    buffer_load_dwordx4 v[4:5], s[4:7], 0 idxen offen lds
    s_or_b32 m0, s45, s35
    s_waitcnt lgkmcnt(0)
    buffer_load_dwordx4 v[6:7], s[4:7], 0 idxen offen lds
    s_sub_u32 s19, s19, 1
    s_cbranch_scc1 mn_st1
mn_st1_back:
    v_mfma_f32_4x4x4_16b_bf16 v[28:31], v[12:13], v[20:21], 0 cbsz:4 abid:8
    v_mfma_f32_4x4x4_16b_bf16 v[32:35], v[12:13], v[22:23], 0 cbsz:4 abid:9
    v_mfma_f32_4x4x4_16b_bf16 v[36:39], v[12:13], v[24:25], 0 cbsz:4 abid:10
    v_mfma_f32_4x4x4_16b_bf16 v[40:43], v[12:13], v[26:27], 0 cbsz:4 abid:11
    ds_read_u16 v4, v2 offset:608
    ds_read_u16 v6, v2 offset:616
    v_readlane_b32 s28, v19, 32
    v_readlane_b32 s29, v19, 40
    v_and_b32 v84, 0x3ff, v84
    v_mad_u32_u24 v84, v84, 48, v86
    v_xor_b32 v85, 0x40000, v84
    ds_read_b128 v[60:63], v84 offset:320
    ds_read_b128 v[64:67], v85 offset:320
    s_waitcnt vmcnt(5)
    ds_read_b64_tr_b16 v[20:21], v1 offset:0
    ds_read_b64_tr_b16 v[22:23], v1 offset:512
    s_waitcnt vmcnt(4)
    ds_read_b64_tr_b16 v[24:25], v1 offset:1024
    ds_read_b64_tr_b16 v[26:27], v1 offset:1536
    s_sub_u32 s34, s34, 1
    s_cmov_b32 s35, 0x30000
    s_mov_b32 m0, s28
    v_fmac_f32 v88, v28, v52
    v_fmac_f32 v89, v29, v52
    v_fmac_f32 v90, v30, v52
    v_fmac_f32 v91, v31, v52
    s_lshr_b32 m0, s28, 16
    v_fmac_f32 v88, v32, v53
    v_fmac_f32 v89, v33, v53
    v_fmac_f32 v90, v34, v53
    v_fmac_f32 v91, v35, v53
    s_mov_b32 m0, s29
    v_fmac_f32 v88, v36, v54
    v_fmac_f32 v89, v37, v54
    v_fmac_f32 v90, v38, v54
    v_fmac_f32 v91, v39, v54
    s_lshr_b32 m0, s29, 16
    v_fmac_f32 v88, v40, v55
    v_fmac_f32 v89, v41, v55
    v_fmac_f32 v90, v42, v55
    v_fmac_f32 v91, v43, v55
    s_or_b32 m0, s40, s35
    s_waitcnt lgkmcnt(2)
    buffer_load_dwordx4 v[4:5], s[4:7], 0 idxen offen lds
    s_or_b32 m0, s41, s35
    s_waitcnt lgkmcnt(0)
    buffer_load_dwordx4 v[6:7], s[4:7], 0 idxen offen lds
    s_sub_u32 s19, s19, 1
    s_cbranch_scc1 mn_st2
mn_st2_back:
    v_mfma_f32_4x4x4_16b_bf16 v[28:31], v[12:13], v[20:21], 0 cbsz:4 abid:12
    v_mfma_f32_4x4x4_16b_bf16 v[32:35], v[12:13], v[22:23], 0 cbsz:4 abid:13
    v_mfma_f32_4x4x4_16b_bf16 v[36:39], v[12:13], v[24:25], 0 cbsz:4 abid:14
    v_mfma_f32_4x4x4_16b_bf16 v[40:43], v[12:13], v[26:27], 0 cbsz:4 abid:15
    ds_read_u16 v4, v2 offset:624
    ds_read_u16 v6, v2 offset:632
    v_readlane_b32 s28, v19, 48
    v_readlane_b32 s29, v19, 56
    v_mov_b32 v85, s30
    ds_add_rtn_u32 v85, v0, v85 offset:288
    s_waitcnt vmcnt(5)
    ds_read_b64_tr_b16 v[20:21], v1 offset:2048
    ds_read_b64_tr_b16 v[22:23], v1 offset:2560
    s_waitcnt vmcnt(4)
    ds_read_b64_tr_b16 v[24:25], v1 offset:3072
    ds_read_b64_tr_b16 v[26:27], v1 offset:3584
    s_sub_u32 s34, s34, 1
    s_cmov_b32 s35, 0x30000
    s_mov_b32 m0, s28
    v_fmac_f32 v88, v28, v56
    v_fmac_f32 v89, v29, v56
    v_fmac_f32 v90, v30, v56
    v_fmac_f32 v91, v31, v56
    s_lshr_b32 m0, s28, 16
    v_fmac_f32 v88, v32, v57
    v_fmac_f32 v89, v33, v57
    v_fmac_f32 v90, v34, v57
    v_fmac_f32 v91, v35, v57
    s_mov_b32 m0, s29
    v_fmac_f32 v88, v36, v58
    v_fmac_f32 v89, v37, v58
    v_fmac_f32 v90, v38, v58
    v_fmac_f32 v91, v39, v58
    s_lshr_b32 m0, s29, 16
    v_fmac_f32 v88, v40, v59
    v_fmac_f32 v89, v41, v59
    v_fmac_f32 v90, v42, v59
    v_fmac_f32 v91, v43, v59
    s_or_b32 m0, s42, s35
    v_mfma_f32_32x32x16_bf16 v[44:59], v[60:63], v[68:71], 0
    v_mfma_f32_32x32x16_bf16 v[44:59], v[64:67], v[72:75], v[44:59]
    s_waitcnt lgkmcnt(2)
    buffer_load_dwordx4 v[4:5], s[4:7], 0 idxen offen lds
    s_or_b32 m0, s43, s35
    s_waitcnt lgkmcnt(0)
    buffer_load_dwordx4 v[6:7], s[4:7], 0 idxen offen lds
    v_readfirstlane_b32 s27, v85
    s_setprio 2
    s_xor_b32 s27, s27, s26
    s_cmp_ge_i32 s27, 0
    s_cbranch_scc1 mn_pr3
    s_setprio 1
mn_pr3:
    s_sub_u32 s19, s19, 1
    s_cbranch_scc1 mn_st3
mn_st3_back:
    v_mfma_f32_4x4x4_16b_bf16 v[28:31], v[14:15], v[20:21], 0 cbsz:4 abid:0
    v_mfma_f32_4x4x4_16b_bf16 v[32:35], v[14:15], v[22:23], 0 cbsz:4 abid:1
    v_mfma_f32_4x4x4_16b_bf16 v[36:39], v[14:15], v[24:25], 0 cbsz:4 abid:2
    v_mfma_f32_4x4x4_16b_bf16 v[40:43], v[14:15], v[26:27], 0 cbsz:4 abid:3
    ds_read_u16 v4, v2 offset:640
    ds_read_u16 v6, v2 offset:648
    v_readlane_b32 s28, v19, 1
    v_readlane_b32 s29, v19, 9
    s_waitcnt vmcnt(5)
    ds_read_b64_tr_b16 v[20:21], v1 offset:4096
    ds_read_b64_tr_b16 v[22:23], v1 offset:4608
    s_waitcnt vmcnt(4)
    ds_read_b64_tr_b16 v[24:25], v1 offset:5120
    ds_read_b64_tr_b16 v[26:27], v1 offset:5632
    s_sub_u32 s34, s34, 1
    s_cmov_b32 s35, 0x30000
    s_mov_b32 m0, s28
    v_fmac_f32 v88, v28, v44
    v_fmac_f32 v89, v29, v44
    v_fmac_f32 v90, v30, v44
    v_fmac_f32 v91, v31, v44
    s_lshr_b32 m0, s28, 16
    v_fmac_f32 v88, v32, v45
    v_fmac_f32 v89, v33, v45
    v_fmac_f32 v90, v34, v45
    v_fmac_f32 v91, v35, v45
    s_mov_b32 m0, s29
    v_fmac_f32 v88, v36, v46
    v_fmac_f32 v89, v37, v46
    v_fmac_f32 v90, v38, v46
    v_fmac_f32 v91, v39, v46
    s_lshr_b32 m0, s29, 16
    v_fmac_f32 v88, v40, v47
    v_fmac_f32 v89, v41, v47
    v_fmac_f32 v90, v42, v47
    v_fmac_f32 v91, v43, v47
    s_or_b32 m0, s44, s35
    s_waitcnt lgkmcnt(2)
    buffer_load_dwordx4 v[4:5], s[4:7], 0 idxen offen lds
    s_or_b32 m0, s45, s35
    s_waitcnt lgkmcnt(0)
    buffer_load_dwordx4 v[6:7], s[4:7], 0 idxen offen lds
    s_sub_u32 s19, s19, 1
    s_cbranch_scc1 mn_st4
mn_st4_back:
    v_mfma_f32_4x4x4_16b_bf16 v[28:31], v[14:15], v[20:21], 0 cbsz:4 abid:4
    v_mfma_f32_4x4x4_16b_bf16 v[32:35], v[14:15], v[22:23], 0 cbsz:4 abid:5
    v_mfma_f32_4x4x4_16b_bf16 v[36:39], v[14:15], v[24:25], 0 cbsz:4 abid:6
    v_mfma_f32_4x4x4_16b_bf16 v[40:43], v[14:15], v[26:27], 0 cbsz:4 abid:7
    ds_read_u16 v4, v2 offset:656
    ds_read_u16 v6, v2 offset:664
    v_readlane_b32 s28, v19, 17
    v_readlane_b32 s29, v19, 25
    ds_read_u16 v84, v3 offset:642
    s_waitcnt vmcnt(5)
    ds_read_b64_tr_b16 v[20:21], v1 offset:0
    ds_read_b64_tr_b16 v[22:23], v1 offset:512
    s_waitcnt vmcnt(4)
    ds_read_b64_tr_b16 v[24:25], v1 offset:1024
    ds_read_b64_tr_b16 v[26:27], v1 offset:1536
    s_sub_u32 s34, s34, 1
    s_cmov_b32 s35, 0x30000
    s_mov_b32 m0, s28
    v_fmac_f32 v88, v28, v48
    v_fmac_f32 v89, v29, v48
    v_fmac_f32 v90, v30, v48
    v_fmac_f32 v91, v31, v48
    s_lshr_b32 m0, s28, 16
    v_fmac_f32 v88, v32, v49
    v_fmac_f32 v89, v33, v49
    v_fmac_f32 v90, v34, v49
    v_fmac_f32 v91, v35, v49
    s_mov_b32 m0, s29
    v_fmac_f32 v88, v36, v50
    v_fmac_f32 v89, v37, v50
    v_fmac_f32 v90, v38, v50
    v_fmac_f32 v91, v39, v50
    s_lshr_b32 m0, s29, 16
    v_fmac_f32 v88, v40, v51
    v_fmac_f32 v89, v41, v51
    v_fmac_f32 v90, v42, v51
    v_fmac_f32 v91, v43, v51
    s_or_b32 m0, s40, s35
    s_waitcnt lgkmcnt(2)
    buffer_load_dwordx4 v[4:5], s[4:7], 0 idxen offen lds
    s_or_b32 m0, s41, s35
    s_waitcnt lgkmcnt(0)
    buffer_load_dwordx4 v[6:7], s[4:7], 0 idxen offen lds
    s_sub_u32 s19, s19, 1
    s_cbranch_scc1 mn_st5
mn_st5_back:
    v_mfma_f32_4x4x4_16b_bf16 v[28:31], v[14:15], v[20:21], 0 cbsz:4 abid:8
    v_mfma_f32_4x4x4_16b_bf16 v[32:35], v[14:15], v[22:23], 0 cbsz:4 abid:9
    v_mfma_f32_4x4x4_16b_bf16 v[36:39], v[14:15], v[24:25], 0 cbsz:4 abid:10
    v_mfma_f32_4x4x4_16b_bf16 v[40:43], v[14:15], v[26:27], 0 cbsz:4 abid:11
    ds_read_u16 v4, v2 offset:672
    ds_read_u16 v6, v2 offset:680
    v_readlane_b32 s28, v19, 33
    v_readlane_b32 s29, v19, 41
    v_and_b32 v84, 0x3ff, v84
    v_mad_u32_u24 v84, v84, 48, v86
    v_xor_b32 v85, 0x40000, v84
    ds_read_b128 v[60:63], v84 offset:320
    ds_read_b128 v[64:67], v85 offset:320
    s_waitcnt vmcnt(5)
    ds_read_b64_tr_b16 v[20:21], v1 offset:2048
    ds_read_b64_tr_b16 v[22:23], v1 offset:2560
    s_waitcnt vmcnt(4)
    ds_read_b64_tr_b16 v[24:25], v1 offset:3072
    ds_read_b64_tr_b16 v[26:27], v1 offset:3584
    s_sub_u32 s34, s34, 1
    s_cmov_b32 s35, 0x30000
    s_mov_b32 m0, s28
    v_fmac_f32 v88, v28, v52
    v_fmac_f32 v89, v29, v52
    v_fmac_f32 v90, v30, v52
    v_fmac_f32 v91, v31, v52
    s_lshr_b32 m0, s28, 16
    v_fmac_f32 v88, v32, v53
    v_fmac_f32 v89, v33, v53
    v_fmac_f32 v90, v34, v53
    v_fmac_f32 v91, v35, v53
    s_mov_b32 m0, s29
    v_fmac_f32 v88, v36, v54
    v_fmac_f32 v89, v37, v54
    v_fmac_f32 v90, v38, v54
    v_fmac_f32 v91, v39, v54
    s_lshr_b32 m0, s29, 16
    v_fmac_f32 v88, v40, v55
    v_fmac_f32 v89, v41, v55
    v_fmac_f32 v90, v42, v55
    v_fmac_f32 v91, v43, v55
    s_or_b32 m0, s42, s35
    s_waitcnt lgkmcnt(2)
    buffer_load_dwordx4 v[4:5], s[4:7], 0 idxen offen lds
    s_or_b32 m0, s43, s35
    s_waitcnt lgkmcnt(0)
    buffer_load_dwordx4 v[6:7], s[4:7], 0 idxen offen lds
    s_sub_u32 s19, s19, 1
    s_cbranch_scc1 mn_st6
mn_st6_back:
    v_mfma_f32_4x4x4_16b_bf16 v[28:31], v[14:15], v[20:21], 0 cbsz:4 abid:12
    v_mfma_f32_4x4x4_16b_bf16 v[32:35], v[14:15], v[22:23], 0 cbsz:4 abid:13
    v_mfma_f32_4x4x4_16b_bf16 v[36:39], v[14:15], v[24:25], 0 cbsz:4 abid:14
    v_mfma_f32_4x4x4_16b_bf16 v[40:43], v[14:15], v[26:27], 0 cbsz:4 abid:15
    ds_read_u16 v4, v2 offset:688
    ds_read_u16 v6, v2 offset:696
    v_readlane_b32 s28, v19, 49
    v_readlane_b32 s29, v19, 57
    v_mov_b32 v85, s30
    ds_add_rtn_u32 v85, v0, v85 offset:288
    s_waitcnt vmcnt(5)
    ds_read_b64_tr_b16 v[20:21], v1 offset:4096
    ds_read_b64_tr_b16 v[22:23], v1 offset:4608
    s_waitcnt vmcnt(4)
    ds_read_b64_tr_b16 v[24:25], v1 offset:5120
    ds_read_b64_tr_b16 v[26:27], v1 offset:5632
    s_sub_u32 s34, s34, 1
    s_cmov_b32 s35, 0x30000
    s_mov_b32 m0, s28
    v_fmac_f32 v88, v28, v56
    v_fmac_f32 v89, v29, v56
    v_fmac_f32 v90, v30, v56
    v_fmac_f32 v91, v31, v56
    s_lshr_b32 m0, s28, 16
    v_fmac_f32 v88, v32, v57
    v_fmac_f32 v89, v33, v57
    v_fmac_f32 v90, v34, v57
    v_fmac_f32 v91, v35, v57
    s_mov_b32 m0, s29
    v_fmac_f32 v88, v36, v58
    v_fmac_f32 v89, v37, v58
    v_fmac_f32 v90, v38, v58
    v_fmac_f32 v91, v39, v58
    s_lshr_b32 m0, s29, 16
    v_fmac_f32 v88, v40, v59
    v_fmac_f32 v89, v41, v59
    v_fmac_f32 v90, v42, v59
    v_fmac_f32 v91, v43, v59
    s_or_b32 m0, s44, s35
    v_mfma_f32_32x32x16_bf16 v[44:59], v[60:63], v[68:71], 0
    v_mfma_f32_32x32x16_bf16 v[44:59], v[64:67], v[72:75], v[44:59]
    s_waitcnt lgkmcnt(2)
    buffer_load_dwordx4 v[4:5], s[4:7], 0 idxen offen lds
    s_or_b32 m0, s45, s35
    s_waitcnt lgkmcnt(0)
    buffer_load_dwordx4 v[6:7], s[4:7], 0 idxen offen lds
    v_readfirstlane_b32 s27, v85
    s_setprio 2
    s_xor_b32 s27, s27, s26
    s_cmp_ge_i32 s27, 0
    s_cbranch_scc1 mn_pr7
    s_setprio 1
mn_pr7:
    s_sub_u32 s19, s19, 1
    s_cbranch_scc1 mn_st7
mn_st7_back:
    v_mfma_f32_4x4x4_16b_bf16 v[28:31], v[16:17], v[20:21], 0 cbsz:4 abid:0
    v_mfma_f32_4x4x4_16b_bf16 v[32:35], v[16:17], v[22:23], 0 cbsz:4 abid:1
    v_mfma_f32_4x4x4_16b_bf16 v[36:39], v[16:17], v[24:25], 0 cbsz:4 abid:2
    v_mfma_f32_4x4x4_16b_bf16 v[40:43], v[16:17], v[26:27], 0 cbsz:4 abid:3
    ds_read_u16 v4, v2 offset:704
    ds_read_u16 v6, v2 offset:712
    v_readlane_b32 s28, v19, 2
    v_readlane_b32 s29, v19, 10
    ds_read_u16 v8, v18 offset:706
    s_waitcnt vmcnt(5)
    ds_read_b64_tr_b16 v[20:21], v1 offset:0
    ds_read_b64_tr_b16 v[22:23], v1 offset:512
    s_waitcnt vmcnt(4)
    ds_read_b64_tr_b16 v[24:25], v1 offset:1024
    ds_read_b64_tr_b16 v[26:27], v1 offset:1536
    s_sub_u32 s34, s34, 1
    s_cmov_b32 s35, 0x30000
    s_mov_b32 m0, s28
    v_fmac_f32 v88, v28, v44
    v_fmac_f32 v89, v29, v44
    v_fmac_f32 v90, v30, v44
    v_fmac_f32 v91, v31, v44
    s_lshr_b32 m0, s28, 16
    v_fmac_f32 v88, v32, v45
    v_fmac_f32 v89, v33, v45
    v_fmac_f32 v90, v34, v45
    v_fmac_f32 v91, v35, v45
    s_mov_b32 m0, s29
    v_fmac_f32 v88, v36, v46
    v_fmac_f32 v89, v37, v46
    v_fmac_f32 v90, v38, v46
    v_fmac_f32 v91, v39, v46
    s_lshr_b32 m0, s29, 16
    v_fmac_f32 v88, v40, v47
    v_fmac_f32 v89, v41, v47
    v_fmac_f32 v90, v42, v47
    v_fmac_f32 v91, v43, v47
    s_or_b32 m0, s40, s35
    s_waitcnt lgkmcnt(2)
    buffer_load_dwordx4 v[4:5], s[4:7], 0 idxen offen lds
    s_or_b32 m0, s41, s35
    s_waitcnt lgkmcnt(0)
    buffer_load_dwordx4 v[6:7], s[4:7], 0 idxen offen lds
    s_sub_u32 s19, s19, 1
    s_cbranch_scc1 mn_st8
mn_st8_back:
    v_mfma_f32_4x4x4_16b_bf16 v[28:31], v[16:17], v[20:21], 0 cbsz:4 abid:4
    v_mfma_f32_4x4x4_16b_bf16 v[32:35], v[16:17], v[22:23], 0 cbsz:4 abid:5
    v_mfma_f32_4x4x4_16b_bf16 v[36:39], v[16:17], v[24:25], 0 cbsz:4 abid:6
    v_mfma_f32_4x4x4_16b_bf16 v[40:43], v[16:17], v[26:27], 0 cbsz:4 abid:7
    ds_read_u16 v4, v2 offset:720
    ds_read_u16 v6, v2 offset:728
    v_readlane_b32 s28, v19, 18
    v_readlane_b32 s29, v19, 26
    ds_read_u16 v84, v3 offset:706
    v_lshrrev_b32 v11, 8, v8
    v_and_b32 v8, 0x3ff, v8
    v_mul_u32_u24 v8, 48, v8
    ds_read_b64 v[8:9], v8 offset:352
    s_waitcnt vmcnt(5)
    ds_read_b64_tr_b16 v[20:21], v1 offset:2048
    ds_read_b64_tr_b16 v[22:23], v1 offset:2560
    s_waitcnt vmcnt(4)
    ds_read_b64_tr_b16 v[24:25], v1 offset:3072
    ds_read_b64_tr_b16 v[26:27], v1 offset:3584
    s_sub_u32 s34, s34, 1
    s_cmov_b32 s35, 0x30000
    s_mov_b32 m0, s28
    v_fmac_f32 v88, v28, v48
    v_fmac_f32 v89, v29, v48
    v_fmac_f32 v90, v30, v48
    v_fmac_f32 v91, v31, v48
    s_lshr_b32 m0, s28, 16
    v_fmac_f32 v88, v32, v49
    v_fmac_f32 v89, v33, v49
    v_fmac_f32 v90, v34, v49
    v_fmac_f32 v91, v35, v49
    s_mov_b32 m0, s29
    v_fmac_f32 v88, v36, v50
    v_fmac_f32 v89, v37, v50
    v_fmac_f32 v90, v38, v50
    v_fmac_f32 v91, v39, v50
    s_lshr_b32 m0, s29, 16
    v_fmac_f32 v88, v40, v51
    v_fmac_f32 v89, v41, v51
    v_fmac_f32 v90, v42, v51
    v_fmac_f32 v91, v43, v51
    s_or_b32 m0, s42, s35
    s_waitcnt lgkmcnt(2)
    buffer_load_dwordx4 v[4:5], s[4:7], 0 idxen offen lds
    s_or_b32 m0, s43, s35
    s_waitcnt lgkmcnt(0)
    buffer_load_dwordx4 v[6:7], s[4:7], 0 idxen offen lds
    s_sub_u32 s19, s19, 1
    s_cbranch_scc1 mn_st9
mn_st9_back:
    v_mfma_f32_4x4x4_16b_bf16 v[28:31], v[16:17], v[20:21], 0 cbsz:4 abid:8
    v_mfma_f32_4x4x4_16b_bf16 v[32:35], v[16:17], v[22:23], 0 cbsz:4 abid:9
    v_mfma_f32_4x4x4_16b_bf16 v[36:39], v[16:17], v[24:25], 0 cbsz:4 abid:10
    v_mfma_f32_4x4x4_16b_bf16 v[40:43], v[16:17], v[26:27], 0 cbsz:4 abid:11
    ds_read_u16 v4, v2 offset:736
    ds_read_u16 v6, v2 offset:744
    v_readlane_b32 s28, v19, 34
    v_readlane_b32 s29, v19, 42
    v_and_b32 v84, 0x3ff, v84
    v_mad_u32_u24 v84, v84, 48, v86
    v_xor_b32 v85, 0x40000, v84
    ds_read_b128 v[60:63], v84 offset:320
    ds_read_b128 v[64:67], v85 offset:320
    s_waitcnt vmcnt(5)
    ds_read_b64_tr_b16 v[20:21], v1 offset:4096
    ds_read_b64_tr_b16 v[22:23], v1 offset:4608
    s_waitcnt vmcnt(4)
    ds_read_b64_tr_b16 v[24:25], v1 offset:5120
    ds_read_b64_tr_b16 v[26:27], v1 offset:5632
    s_sub_u32 s34, s34, 1
    s_cmov_b32 s35, 0x30000
    s_mov_b32 m0, s28
    v_fmac_f32 v88, v28, v52
    v_fmac_f32 v89, v29, v52
    v_fmac_f32 v90, v30, v52
    v_fmac_f32 v91, v31, v52
    s_lshr_b32 m0, s28, 16
    v_fmac_f32 v88, v32, v53
    v_fmac_f32 v89, v33, v53
    v_fmac_f32 v90, v34, v53
    v_fmac_f32 v91, v35, v53
    s_mov_b32 m0, s29
    v_fmac_f32 v88, v36, v54
    v_fmac_f32 v89, v37, v54
    v_fmac_f32 v90, v38, v54
    v_fmac_f32 v91, v39, v54
    s_lshr_b32 m0, s29, 16
    v_fmac_f32 v88, v40, v55
    v_fmac_f32 v89, v41, v55
    v_fmac_f32 v90, v42, v55
    v_fmac_f32 v91, v43, v55
    s_or_b32 m0, s44, s35
    s_waitcnt lgkmcnt(2)
    buffer_load_dwordx4 v[4:5], s[4:7], 0 idxen offen lds
    s_or_b32 m0, s45, s35
    s_waitcnt lgkmcnt(0)
    buffer_load_dwordx4 v[6:7], s[4:7], 0 idxen offen lds
    v_and_b32 v11, 0x7c, v11
    v_or_b32 v11, 0xc000, v11
    v_lshlrev_b32 v10, 16, v11
    s_sub_u32 s19, s19, 1
    s_cbranch_scc1 mn_st10
mn_st10_back:
    v_mfma_f32_4x4x4_16b_bf16 v[28:31], v[16:17], v[20:21], 0 cbsz:4 abid:12
    v_mfma_f32_4x4x4_16b_bf16 v[32:35], v[16:17], v[22:23], 0 cbsz:4 abid:13
    v_mfma_f32_4x4x4_16b_bf16 v[36:39], v[16:17], v[24:25], 0 cbsz:4 abid:14
    v_mfma_f32_4x4x4_16b_bf16 v[40:43], v[16:17], v[26:27], 0 cbsz:4 abid:15
    ds_read_u16 v4, v2 offset:752
    ds_read_u16 v6, v2 offset:760
    v_readlane_b32 s28, v19, 50
    v_readlane_b32 s29, v19, 58
    v_mov_b32 v85, s30
    ds_add_rtn_u32 v85, v0, v85 offset:288
    s_waitcnt vmcnt(5)
    ds_read_b64_tr_b16 v[20:21], v1 offset:0
    ds_read_b64_tr_b16 v[22:23], v1 offset:512
    s_waitcnt vmcnt(4)
    ds_read_b64_tr_b16 v[24:25], v1 offset:1024
    ds_read_b64_tr_b16 v[26:27], v1 offset:1536
    s_sub_u32 s34, s34, 1
    s_cmov_b32 s35, 0x30000
    s_mov_b32 m0, s28
    v_fmac_f32 v88, v28, v56
    v_fmac_f32 v89, v29, v56
    v_fmac_f32 v90, v30, v56
    v_fmac_f32 v91, v31, v56
    s_lshr_b32 m0, s28, 16
    v_fmac_f32 v88, v32, v57
    v_fmac_f32 v89, v33, v57
    v_fmac_f32 v90, v34, v57
    v_fmac_f32 v91, v35, v57
    s_mov_b32 m0, s29
    v_fmac_f32 v88, v36, v58
    v_fmac_f32 v89, v37, v58
    v_fmac_f32 v90, v38, v58
    v_fmac_f32 v91, v39, v58
    s_lshr_b32 m0, s29, 16
    v_fmac_f32 v88, v40, v59
    v_fmac_f32 v89, v41, v59
    v_fmac_f32 v90, v42, v59
    v_fmac_f32 v91, v43, v59
    s_or_b32 m0, s40, s35
    v_mfma_f32_4x4x4_16b_bf16 v[28:31], v[8:9], v[76:77], 0
    v_mfma_f32_4x4x4_16b_bf16 v[32:35], v[8:9], v[78:79], 0
    v_mfma_f32_4x4x4_16b_bf16 v[36:39], v[8:9], v[80:81], 0
    v_mfma_f32_4x4x4_16b_bf16 v[40:43], v[8:9], v[82:83], 0
    v_mfma_f32_32x32x16_bf16 v[44:59], v[60:63], v[68:71], 0
    v_mfma_f32_32x32x16_bf16 v[44:59], v[64:67], v[72:75], v[44:59]
    s_waitcnt lgkmcnt(2)
    buffer_load_dwordx4 v[4:5], s[4:7], 0 idxen offen lds
    s_or_b32 m0, s41, s35
    s_waitcnt lgkmcnt(0)
    buffer_load_dwordx4 v[6:7], s[4:7], 0 idxen offen lds
    v_cvt_pk_bf16_f32 v12, v28, v32
    v_cvt_pk_bf16_f32 v14, v29, v33
    v_cvt_pk_bf16_f32 v16, v30, v34
    v_cvt_pk_bf16_f32 v13, v36, v40
    v_cvt_pk_bf16_f32 v15, v37, v41
    v_cvt_pk_bf16_f32 v17, v38, v42
    v_or_b32_dpp v19, v10, v11 row_shl:4 row_mask:0xf bank_mask:0xf bound_ctrl:0
    v_add_u32 v2, 192, v2
    v_add_u32 v3, 192, v3
    v_add_u32 v18, 192, v18
    v_readfirstlane_b32 s27, v85
    s_setprio 2
    s_xor_b32 s27, s27, s26
    s_cmp_ge_i32 s27, 0
    s_cbranch_scc1 mn_pr11
    s_setprio 1
mn_pr11:
    s_sub_u32 s19, s19, 1
    s_cbranch_scc1 mn_st11
mn_st11_back:
    s_branch mn_loop
mn_st0:
    s_cmp_lg_u32 s21, 0
    s_cbranch_scc1 mn_next
    s_call_b64 s[48:49], mn_flush
    s_branch mn_st0_back
mn_st1:
    s_cmp_lg_u32 s21, 0
    s_cbranch_scc1 mn_next
    s_call_b64 s[48:49], mn_flush
    s_branch mn_st1_back
mn_st2:
    s_cmp_lg_u32 s21, 0
    s_cbranch_scc1 mn_next
    s_call_b64 s[48:49], mn_flush
    s_branch mn_st2_back
mn_st3:
    s_cmp_lg_u32 s21, 0
    s_cbranch_scc1 mn_next
    s_call_b64 s[48:49], mn_flush
    s_branch mn_st3_back
mn_st4:
    s_cmp_lg_u32 s21, 0
    s_cbranch_scc1 mn_next
    s_call_b64 s[48:49], mn_flush
    s_branch mn_st4_back
mn_st5:
    s_cmp_lg_u32 s21, 0
    s_cbranch_scc1 mn_next
    s_call_b64 s[48:49], mn_flush
    s_branch mn_st5_back
mn_st6:
    s_cmp_lg_u32 s21, 0
    s_cbranch_scc1 mn_next
    s_call_b64 s[48:49], mn_flush
    s_branch mn_st6_back
mn_st7:
    s_cmp_lg_u32 s21, 0
    s_cbranch_scc1 mn_next
    s_call_b64 s[48:49], mn_flush
    s_branch mn_st7_back
mn_st8:
    s_cmp_lg_u32 s21, 0
    s_cbranch_scc1 mn_next
    s_call_b64 s[48:49], mn_flush
    s_branch mn_st8_back
mn_st9:
    s_cmp_lg_u32 s21, 0
    s_cbranch_scc1 mn_next
    s_call_b64 s[48:49], mn_flush
    s_branch mn_st9_back
mn_st10:
    s_cmp_lg_u32 s21, 0
    s_cbranch_scc1 mn_next
    s_call_b64 s[48:49], mn_flush
    s_branch mn_st10_back
mn_st11:
    s_cmp_lg_u32 s21, 0
    s_cbranch_scc1 mn_next
    s_call_b64 s[48:49], mn_flush
    s_branch mn_st11_back
mn_st12:
    s_cmp_lg_u32 s21, 0
    s_cbranch_scc1 mn_next
    s_call_b64 s[48:49], mn_flush
    s_branch mn_st12_back
mn_flush:
    s_cmp_eq_u32 s58, 4
    s_cbranch_scc1 mn_fl4
    s_cmp_eq_u32 s58, 3
    s_cbranch_scc1 mn_fl3
    s_cmp_eq_u32 s58, 2
    s_cbranch_scc1 mn_fl2
    s_cmp_eq_u32 s58, 1
    s_cbranch_scc1 mn_fl1
mn_fl0:
    v_cvt_pk_bf16_f32 v88, v88, v89
    v_cvt_pk_bf16_f32 v89, v90, v91
    ds_write_b64 v87, v[88:89] offset:0
    v_cvt_pk_bf16_f32 v92, v92, v93
    v_cvt_pk_bf16_f32 v93, v94, v95
    ds_write_b64 v87, v[92:93] offset:576
    v_cvt_pk_bf16_f32 v96, v96, v97
    v_cvt_pk_bf16_f32 v97, v98, v99
    ds_write_b64 v87, v[96:97] offset:1152
    v_cvt_pk_bf16_f32 v100, v100, v101
    v_cvt_pk_bf16_f32 v101, v102, v103
    ds_write_b64 v87, v[100:101] offset:1728
    s_mul_i32 s52, s18, 3
    s_lshl_b32 s52, 1, s52
    v_mov_b32 v90, s52
    v_mov_b32 v91, 0
    s_mov_b64 exec, 1
    ds_add_u32 v91, v90 offset:276
    s_mov_b64 exec, -1
    s_add_u32 s58, s58, 1
    s_sub_u32 s19, s85, 1
    s_cbranch_scc1 mn_fl1
    s_setpc_b64 s[48:49]
mn_fl1:
    v_cvt_pk_bf16_f32 v104, v104, v105
    v_cvt_pk_bf16_f32 v105, v106, v107
    ds_write_b64 v87, v[104:105] offset:2304
    v_cvt_pk_bf16_f32 v108, v108, v109
    v_cvt_pk_bf16_f32 v109, v110, v111
    ds_write_b64 v87, v[108:109] offset:2880
    v_cvt_pk_bf16_f32 v112, v112, v113
    v_cvt_pk_bf16_f32 v113, v114, v115
    ds_write_b64 v87, v[112:113] offset:3456
    v_cvt_pk_bf16_f32 v116, v116, v117
    v_cvt_pk_bf16_f32 v117, v118, v119
    ds_write_b64 v87, v[116:117] offset:4032
    s_mul_i32 s52, s18, 3
    s_lshl_b32 s52, 64, s52
    v_mov_b32 v106, s52
    v_mov_b32 v107, 0
    s_mov_b64 exec, 1
    ds_add_u32 v107, v106 offset:276
    s_mov_b64 exec, -1
    s_add_u32 s58, s58, 1
    s_sub_u32 s19, s86, 1
    s_cbranch_scc1 mn_fl2
    s_setpc_b64 s[48:49]
mn_fl2:
    v_cvt_pk_bf16_f32 v120, v120, v121
    v_cvt_pk_bf16_f32 v121, v122, v123
    ds_write_b64 v87, v[120:121] offset:4608
    v_cvt_pk_bf16_f32 v124, v124, v125
    v_cvt_pk_bf16_f32 v125, v126, v127
    ds_write_b64 v87, v[124:125] offset:5184
    v_cvt_pk_bf16_f32 v128, v128, v129
    v_cvt_pk_bf16_f32 v129, v130, v131
    ds_write_b64 v87, v[128:129] offset:5760
    v_cvt_pk_bf16_f32 v132, v132, v133
    v_cvt_pk_bf16_f32 v133, v134, v135
    ds_write_b64 v87, v[132:133] offset:6336
    s_mul_i32 s52, s18, 3
    s_lshl_b32 s52, 4096, s52
    v_mov_b32 v122, s52
    v_mov_b32 v123, 0
    s_mov_b64 exec, 1
    ds_add_u32 v123, v122 offset:276
    s_mov_b64 exec, -1
    s_add_u32 s58, s58, 1
    s_sub_u32 s19, s87, 1
    s_cbranch_scc1 mn_fl3
    s_setpc_b64 s[48:49]
mn_fl3:
    v_cvt_pk_bf16_f32 v136, v136, v137
    v_cvt_pk_bf16_f32 v137, v138, v139
    ds_write_b64 v87, v[136:137] offset:6912
    v_cvt_pk_bf16_f32 v140, v140, v141
    v_cvt_pk_bf16_f32 v141, v142, v143
    ds_write_b64 v87, v[140:141] offset:7488
    v_cvt_pk_bf16_f32 v144, v144, v145
    v_cvt_pk_bf16_f32 v145, v146, v147
    ds_write_b64 v87, v[144:145] offset:8064
    v_cvt_pk_bf16_f32 v148, v148, v149
    v_cvt_pk_bf16_f32 v149, v150, v151
    ds_write_b64 v87, v[148:149] offset:8640
    s_mul_i32 s52, s18, 3
    s_lshl_b32 s52, 262144, s52
    v_mov_b32 v138, s52
    v_mov_b32 v139, 0
    s_mov_b64 exec, 1
    ds_add_u32 v139, v138 offset:276
    s_mov_b64 exec, -1
    s_add_u32 s58, s58, 1
    s_sub_u32 s19, s88, 1
    s_cbranch_scc1 mn_fl4
    s_setpc_b64 s[48:49]
mn_fl4:
    s_cmp_ge_u32 s59, 4
    s_cbranch_scc1 mn_fl4b
    s_waitcnt vmcnt(0)
mn_fl4b:
    v_cvt_pk_bf16_f32 v152, v152, v153
    v_cvt_pk_bf16_f32 v153, v154, v155
    ds_write_b64 v87, v[152:153] offset:9216
    v_cvt_pk_bf16_f32 v156, v156, v157
    v_cvt_pk_bf16_f32 v157, v158, v159
    ds_write_b64 v87, v[156:157] offset:9792
    v_cvt_pk_bf16_f32 v160, v160, v161
    v_cvt_pk_bf16_f32 v161, v162, v163
    ds_write_b64 v87, v[160:161] offset:10368
    v_cvt_pk_bf16_f32 v164, v164, v165
    v_cvt_pk_bf16_f32 v165, v166, v167
    ds_write_b64 v87, v[164:165] offset:10944
    s_mul_i32 s52, s18, 3
    s_lshl_b32 s52, 16777216, s52
    v_mov_b32 v154, s52
    v_mov_b32 v155, 0
    s_mov_b64 exec, 1
    ds_add_u32 v155, v154 offset:276
    s_mov_b64 exec, -1
    s_waitcnt vmcnt(0) lgkmcnt(0)
mn_end:
    s_endpgm
gm_main:
    s_load_dwordx2 s[56:57], s[0:1], 64
    v_and_b32 v3, 63, v0
    v_and_b32 v11, 0x7f, v0
    v_lshlrev_b32 v11, 2, v11
    v_mov_b32 v10, 0
    ds_write_b32 v11, v10
    v_bfe_u32 v12, v0, 1, 7
    v_and_b32 v11, 15, v12
    v_lshrrev_b32 v10, 4, v12
    v_lshl_or_b32 v11, v11, 3, v10
    v_cmp_gt_u32 vcc, 125, v11
    v_mul_u32_u24 v13, 51200, v11
    v_bfrev_b32 v10, 2
    v_lshlrev_b32 v12, 2, v12
    v_cndmask_b32 v12, v10, v12, vcc
    v_lshlrev_b32 v11, 3, v3
    v_lshlrev_b32 v2, 4, v3
    s_lshl_b32 s40, s17, 15
    s_add_u32 s40, s40, 11534336
    s_waitcnt lgkmcnt(0)
    s_mov_b32 s8, s54
    s_and_b32 s9, s55, 0xffff
    buffer_load_dword v4, v12, s[8:11], s25 offen
    buffer_load_dwordx2 v[6:7], v11, s[8:11], s25 offen
    s_barrier
    s_lshl2_add_u32 s47, s47, s17
    s_mul_i32 s47, s47, 51200
    s_mul_i32 s48, s48, 6400
    s_add_u32 s47, s47, s48
    s_sub_i32 s47, s47, 896
    s_max_i32 s47, s47, 0
    v_lshlrev_b32 v11, 7, v3
    buffer_load_dword v39, v11, s[8:11], s47 offen
    s_mul_i32 s41, s2, 625
    s_add_u32 s52, s41, 640
    s_add_u32 s41, s41, 15
    s_lshr_b32 s41, s41, 4
    s_lshr_b32 s52, s52, 4
    s_mov_b32 s12, s56
    s_and_b32 s13, s57, 0xffff
    s_lshl_b32 s14, s52, 11
    s_mov_b32 s15, 0x20000
    s_mul_i32 s42, s17, 15360
    s_add_u32 s42, s42, 40960
    s_lshl_b32 s43, s17, 4
    s_sub_u32 s43, s43, 1
    s_mov_b32 s44, -1
    s_mov_b32 s45, 2139062271
    v_add_u32 v11, 0, v3
    v_mul_u32_u24 v10, 21846, v11
    v_lshrrev_b32 v10, 16, v10
    v_lshl_add_u32 v34, v10, 2, s42
    v_mad_i32_i24 v10, v10, -3, v11
    v_lshlrev_b32 v30, 4, v10
    v_add_u32 v11, 64, v3
    v_mul_u32_u24 v10, 21846, v11
    v_lshrrev_b32 v10, 16, v10
    v_lshl_add_u32 v35, v10, 2, s42
    v_mad_i32_i24 v10, v10, -3, v11
    v_lshlrev_b32 v31, 4, v10
    v_add_u32 v11, 128, v3
    v_mul_u32_u24 v10, 21846, v11
    v_lshrrev_b32 v10, 16, v10
    v_lshl_add_u32 v36, v10, 2, s42
    v_mad_i32_i24 v10, v10, -3, v11
    v_lshlrev_b32 v32, 4, v10
    s_waitcnt vmcnt(1)
gm_pass:
    v_lshrrev_b32 v8, 16, v4
    v_subrev_u32 v8, s24, v8
    v_med3_i32 v8, v8, 0, s20
    v_lshrrev_b32 v11, 16, v6
    v_subrev_u32 v11, s24, v11
    v_med3_i32 v11, v11, 0, s20
    v_lshrrev_b32 v10, 16, v7
    v_subrev_u32 v10, s24, v10
    v_med3_i32 v10, v10, 0, s20
    v_mov_b32 v9, v8
    v_cndmask_b32 v10, 0, v10, s[44:45]
    v_add_u32 v10, v11, v10
    v_and_b32 v12, 1, v0
    v_and_b32 v14, 0xffff, v4
    v_add_u32_dpp v10, v10, v10 row_shr:1 row_mask:0xf bank_mask:0xf
    s_nop 0
    v_add3_u32 v14, v14, v12, s24
    v_add_u32_dpp v10, v10, v10 row_shr:2 row_mask:0xf bank_mask:0xf
    v_add_u32_dpp v9, v9, v9 row_shr:2 row_mask:0xf bank_mask:0xf
    v_mad_u32_u24 v14, v14, 40, v13
    v_add_u32_dpp v10, v10, v10 row_shr:4 row_mask:0xf bank_mask:0xf
    v_add_u32_dpp v9, v9, v9 row_shr:4 row_mask:0xf bank_mask:0xf
    v_sub_u32 v15, v8, v12
    v_add_u32_dpp v10, v10, v10 row_shr:8 row_mask:0xf bank_mask:0xf
    v_add_u32_dpp v9, v9, v9 row_shr:8 row_mask:0xf bank_mask:0xf
    s_nop 0
    v_add_u32_dpp v10, v10, v10 row_bcast:15 row_mask:0xa bank_mask:0xf
    v_add_u32_dpp v9, v9, v9 row_bcast:15 row_mask:0xa bank_mask:0xf
    s_nop 0
    v_add_u32_dpp v10, v10, v10 row_bcast:31 row_mask:0xc bank_mask:0xf
    v_add_u32_dpp v9, v9, v9 row_bcast:31 row_mask:0xc bank_mask:0xf
    s_nop 0
    v_readlane_b32 s23, v10, 63
    v_readlane_b32 s46, v10, s43
    v_readlane_b32 s47, v9, 63
    v_sub_u32 v16, v9, v15
    v_lshl_add_u32 v16, v16, 2, s42
    s_cmp_gt_u32 s23, 773
    s_cbranch_scc1 gm_ovf
    s_cmp_eq_u32 s17, 0
    s_cmov_b32 s46, 0
    v_cmpx_lt_i32 vcc, 0, v15
    s_cbranch_execz gm_tb_done
    ds_write_b32 v16, v14 offset:0
    v_add_u32 v14, 80, v14
    v_cmpx_lt_i32 vcc, 2, v15
    s_cbranch_execz gm_tb_done
    ds_write_b32 v16, v14 offset:8
    v_add_u32 v14, 80, v14
    v_cmpx_lt_i32 vcc, 4, v15
    s_cbranch_execz gm_tb_done
    ds_write_b32 v16, v14 offset:16
    v_add_u32 v14, 80, v14
    v_cmpx_lt_i32 vcc, 6, v15
    s_cbranch_execz gm_tb_done
    ds_write_b32 v16, v14 offset:24
    v_add_u32 v14, 80, v14
    v_cmpx_lt_i32 vcc, 8, v15
    s_cbranch_execz gm_tb_done
    ds_write_b32 v16, v14 offset:32
    v_add_u32 v14, 80, v14
    v_cmpx_lt_i32 vcc, 10, v15
    s_cbranch_execz gm_tb_done
    ds_write_b32 v16, v14 offset:40
    v_add_u32 v14, 80, v14
    v_cmpx_lt_i32 vcc, 12, v15
    s_cbranch_execz gm_tb_done
    ds_write_b32 v16, v14 offset:48
    v_add_u32 v14, 80, v14
    v_cmpx_lt_i32 vcc, 14, v15
    s_cbranch_execz gm_tb_done
    ds_write_b32 v16, v14 offset:56
    v_add_u32 v14, 80, v14
    v_cmpx_lt_i32 vcc, 16, v15
    s_cbranch_execz gm_tb_done
    ds_write_b32 v16, v14 offset:64
    v_add_u32 v14, 80, v14
    v_cmpx_lt_i32 vcc, 18, v15
    s_cbranch_execz gm_tb_done
    ds_write_b32 v16, v14 offset:72
gm_tb_done:
    s_mov_b64 exec, -1
    s_mul_i32 s46, s46, 48
    s_add_u32 m0, s46, 3776
    s_mul_i32 s47, s47, 3
    s_mov_b32 s48, 1
    v_mov_b32 v11, v34
    v_mov_b32 v10, v35
    v_mov_b32 v14, v36
    s_barrier
gm_raw:
    ds_read_b32 v18, v11 offset:0
    ds_read_b32 v19, v10 offset:0
    ds_read_b32 v20, v14 offset:0
    ds_read_b32 v21, v11 offset:256
    ds_read_b32 v22, v10 offset:256
    ds_read_b32 v23, v14 offset:256
    ds_read_b32 v24, v11 offset:512
    ds_read_b32 v25, v10 offset:512
    ds_read_b32 v26, v14 offset:512
    v_cmpx_gt_i32 vcc, s47, v3
    s_cbranch_execz gm_raw_done
    s_waitcnt lgkmcnt(8)
    v_add_u32 v18, v18, v30
    buffer_load_dwordx4 v18, s[8:11], 0 offen lds
    s_add_u32 m0, m0, 1024
    s_sub_i32 s47, s47, 64
    v_cmpx_gt_i32 vcc, s47, v3
    s_cbranch_execz gm_raw_done
    s_waitcnt lgkmcnt(7)
    v_add_u32 v19, v19, v31
    buffer_load_dwordx4 v19, s[8:11], 0 offen lds
    s_add_u32 m0, m0, 1024
    s_sub_i32 s47, s47, 64
    v_cmpx_gt_i32 vcc, s47, v3
    s_cbranch_execz gm_raw_done
    s_waitcnt lgkmcnt(6)
    v_add_u32 v20, v20, v32
    buffer_load_dwordx4 v20, s[8:11], 0 offen lds
    s_add_u32 m0, m0, 1024
    s_sub_i32 s47, s47, 64
    v_cmpx_gt_i32 vcc, s47, v3
    s_cbranch_execz gm_raw_done
    s_waitcnt lgkmcnt(5)
    v_add_u32 v21, v21, v30
    buffer_load_dwordx4 v21, s[8:11], 0 offen lds
    s_add_u32 m0, m0, 1024
    s_sub_i32 s47, s47, 64
    v_cmpx_gt_i32 vcc, s47, v3
    s_cbranch_execz gm_raw_done
    s_waitcnt lgkmcnt(4)
    v_add_u32 v22, v22, v31
    buffer_load_dwordx4 v22, s[8:11], 0 offen lds
    s_add_u32 m0, m0, 1024
    s_sub_i32 s47, s47, 64
    v_cmpx_gt_i32 vcc, s47, v3
    s_cbranch_execz gm_raw_done
    s_waitcnt lgkmcnt(3)
    v_add_u32 v23, v23, v32
    buffer_load_dwordx4 v23, s[8:11], 0 offen lds
    s_add_u32 m0, m0, 1024
    s_sub_i32 s47, s47, 64
    v_cmpx_gt_i32 vcc, s47, v3
    s_cbranch_execz gm_raw_done
    s_waitcnt lgkmcnt(2)
    v_add_u32 v24, v24, v30
    buffer_load_dwordx4 v24, s[8:11], 0 offen lds
    s_add_u32 m0, m0, 1024
    s_sub_i32 s47, s47, 64
    v_cmpx_gt_i32 vcc, s47, v3
    s_cbranch_execz gm_raw_done
    s_waitcnt lgkmcnt(1)
    v_add_u32 v25, v25, v31
    buffer_load_dwordx4 v25, s[8:11], 0 offen lds
    s_add_u32 m0, m0, 1024
    s_sub_i32 s47, s47, 64
    v_cmpx_gt_i32 vcc, s47, v3
    s_cbranch_execz gm_raw_done
    s_waitcnt lgkmcnt(0)
    v_add_u32 v26, v26, v32
    buffer_load_dwordx4 v26, s[8:11], 0 offen lds
    s_add_u32 m0, m0, 1024
    s_sub_i32 s47, s47, 64
    v_add_u32 v11, 768, v11
    v_add_u32 v10, 768, v10
    v_add_u32 v14, 768, v14
    s_branch gm_raw
gm_raw_done:
    s_mov_b64 exec, -1
    v_mov_b32 v11, 0
    ds_read_b32 v11, v11 offset:272
    s_barrier
    s_waitcnt vmcnt(0) lgkmcnt(0)
    v_readfirstlane_b32 s21, v11
    s_barrier
    s_cmp_lg_u32 s21, 0
    s_cbranch_scc1 gm_next
    s_add_u32 s52, s40, 0
    buffer_load_dwordx4 v[40:43], v2, s[8:11], s52 offen offset:0
    buffer_load_dwordx4 v[44:47], v2, s[8:11], s52 offen offset:1024
    s_waitcnt vmcnt(1)
    buffer_load_dwordx4 v[48:51], v2, s[8:11], s52 offen offset:2048
    s_waitcnt vmcnt(1)
    buffer_load_dwordx4 v[52:55], v2, s[8:11], s52 offen offset:3072
    s_waitcnt vmcnt(1)
    s_add_u32 s52, s40, 4096
    buffer_load_dwordx4 v[56:59], v2, s[8:11], s52 offen offset:0
    s_waitcnt vmcnt(1)
    buffer_load_dwordx4 v[60:63], v2, s[8:11], s52 offen offset:1024
    s_waitcnt vmcnt(1)
    buffer_load_dwordx4 v[64:67], v2, s[8:11], s52 offen offset:2048
    s_waitcnt vmcnt(1)
    buffer_load_dwordx4 v[68:71], v2, s[8:11], s52 offen offset:3072
    s_waitcnt vmcnt(1)
    s_add_u32 s52, s40, 8192
    buffer_load_dwordx4 v[72:75], v2, s[8:11], s52 offen offset:0
    s_waitcnt vmcnt(1)
    buffer_load_dwordx4 v[76:79], v2, s[8:11], s52 offen offset:1024
    s_waitcnt vmcnt(1)
    buffer_load_dwordx4 v[80:83], v2, s[8:11], s52 offen offset:2048
    s_waitcnt vmcnt(1)
    buffer_load_dwordx4 v[84:87], v2, s[8:11], s52 offen offset:3072
    s_waitcnt vmcnt(1)
    s_add_u32 s52, s40, 12288
    buffer_load_dwordx4 v[88:91], v2, s[8:11], s52 offen offset:0
    s_waitcnt vmcnt(1)
    buffer_load_dwordx4 v[92:95], v2, s[8:11], s52 offen offset:1024
    s_waitcnt vmcnt(1)
    buffer_load_dwordx4 v[96:99], v2, s[8:11], s52 offen offset:2048
    s_waitcnt vmcnt(1)
    buffer_load_dwordx4 v[100:103], v2, s[8:11], s52 offen offset:3072
    s_waitcnt vmcnt(1)
    s_add_u32 s52, s40, 16384
    buffer_load_dwordx4 v[104:107], v2, s[8:11], s52 offen offset:0
    s_waitcnt vmcnt(1)
    buffer_load_dwordx4 v[108:111], v2, s[8:11], s52 offen offset:1024
    s_waitcnt vmcnt(1)
    buffer_load_dwordx4 v[112:115], v2, s[8:11], s52 offen offset:2048
    s_waitcnt vmcnt(1)
    buffer_load_dwordx4 v[116:119], v2, s[8:11], s52 offen offset:3072
    s_waitcnt vmcnt(1)
    s_add_u32 s52, s40, 20480
    buffer_load_dwordx4 v[120:123], v2, s[8:11], s52 offen offset:0
    s_waitcnt vmcnt(1)
    buffer_load_dwordx4 v[124:127], v2, s[8:11], s52 offen offset:1024
    s_waitcnt vmcnt(1)
    buffer_load_dwordx4 v[128:131], v2, s[8:11], s52 offen offset:2048
    s_waitcnt vmcnt(1)
    buffer_load_dwordx4 v[132:135], v2, s[8:11], s52 offen offset:3072
    s_waitcnt vmcnt(1)
    s_add_u32 s52, s40, 24576
    buffer_load_dwordx4 v[136:139], v2, s[8:11], s52 offen offset:0
    s_waitcnt vmcnt(1)
    buffer_load_dwordx4 v[140:143], v2, s[8:11], s52 offen offset:1024
    s_waitcnt vmcnt(1)
    buffer_load_dwordx4 v[144:147], v2, s[8:11], s52 offen offset:2048
    s_waitcnt vmcnt(1)
    buffer_load_dwordx4 v[148:151], v2, s[8:11], s52 offen offset:3072
    s_waitcnt vmcnt(1)
    s_add_u32 s52, s40, 28672
    buffer_load_dwordx4 v[152:155], v2, s[8:11], s52 offen offset:0
    s_waitcnt vmcnt(1)
    buffer_load_dwordx4 v[156:159], v2, s[8:11], s52 offen offset:1024
    s_waitcnt vmcnt(1)
    buffer_load_dwordx4 v[160:163], v2, s[8:11], s52 offen offset:2048
    s_waitcnt vmcnt(1)
    buffer_load_dwordx4 v[164:167], v2, s[8:11], s52 offen offset:3072
    s_waitcnt vmcnt(1)
    v_lshrrev_b32 v1, 4, v3
    v_lshlrev_b32 v1, 11, v1
    v_and_b32 v4, 7, v3
    v_lshl_add_u32 v1, v4, 4, v1
    v_bfe_u32 v4, v3, 3, 1
    v_lshl_add_u32 v1, v4, 9, v1
    v_and_b32 v4, 3, v3
    v_lshrrev_b32 v5, 2, v3
    v_mul_u32_u24 v0, 576, v4
    v_lshl_add_u32 v0, v5, 3, v0
    v_add_u32 v0, 40960, v0
    s_lshl_b32 s38, s41, 11
    s_lshl_b32 s53, s17, 7
    s_add_u32 s38, s38, s53
    s_mov_b32 s36, 0x24924924
    s_mov_b32 s39, 0
    s_waitcnt vmcnt(0)
gm_poll:
    v_mov_b32 v2, 0
    ds_read_b32 v2, v2 offset:276
    s_waitcnt lgkmcnt(0)
    v_readfirstlane_b32 s52, v2
    s_and_b32 s52, s52, s36
    s_cbranch_scc1 gm_go
    s_sleep 2
    s_branch gm_poll
gm_go:
    s_ff1_i32_b32 s52, s52
    s_bitset0_b32 s36, s52
    s_mul_i32 s52, s52, 11
    s_bfe_u32 s53, s52, 0x10005
    s_bfe_u32 s52, s52, 0x30006
    s_mul_i32 s35, s53, 61440
    s_mul_i32 s31, s52, 2304
    s_add_u32 s31, s31, s35
    s_sub_u32 s35, s31, s39
    v_add_u32 v0, s35, v0
    ds_read_b64_tr_b16 v[12:13], v0 offset:0
    ds_read_b64_tr_b16 v[14:15], v0 offset:128
    ds_read_b64_tr_b16 v[16:17], v0 offset:256
    ds_read_b64_tr_b16 v[18:19], v0 offset:384
    s_mov_b32 s39, s31
    s_mul_i32 s33, s53, 5
    s_add_u32 s33, s33, s52
    s_lshl_b32 s33, s33, 13
    s_add_u32 s33, s33, s38
    s_mov_b32 s37, s33
    s_mov_b32 s32, 0x7ffffff0
gm_loop:
    s_waitcnt lgkmcnt(2)
    v_mfma_f32_16x16x32_bf16 v[24:27], v[12:15], v[40:43], 0
    s_setprio 3
    v_cvt_pk_bf16_f32 v7, v33, v37
    v_cvt_pk_bf16_f32 v5, v32, v36
    ds_read_b64_tr_b16 v[20:21], v0 offset:15360
    s_setprio 0
    v_mfma_f32_16x16x32_bf16 v[28:31], v[12:15], v[44:47], 0
    s_setprio 3
    v_cvt_pk_bf16_f32 v11, v35, v39
    v_cvt_pk_bf16_f32 v9, v34, v38
    ds_read_b64_tr_b16 v[22:23], v0 offset:15488
    s_setprio 0
    v_mfma_f32_16x16x32_bf16 v[32:35], v[12:15], v[48:51], 0
    s_setprio 3
    v_mov_b32_dpp v2, v6 row_ror:8 row_mask:0xf bank_mask:0xf
    v_mov_b32_dpp v3, v7 row_ror:8 row_mask:0xf bank_mask:0xf
    s_setprio 0
    v_mfma_f32_16x16x32_bf16 v[36:39], v[12:15], v[52:55], 0
    s_setprio 3
    v_mov_b32_dpp v6, v4 row_ror:8 row_mask:0xf bank_mask:0x3
    v_mov_b32_dpp v7, v5 row_ror:8 row_mask:0xf bank_mask:0x3
    s_setprio 0
    s_waitcnt lgkmcnt(2)
    v_mfma_f32_16x16x32_bf16 v[24:27], v[16:19], v[56:59], v[24:27]
    s_setprio 3
    ds_read_b64_tr_b16 v[12:13], v0 offset:15616
    v_mov_b32_dpp v4, v2 quad_perm:[0,1,2,3] row_mask:0xf bank_mask:0xc
    s_setprio 0
    v_mfma_f32_16x16x32_bf16 v[28:31], v[16:19], v[60:63], v[28:31]
    s_setprio 3
    ds_read_b64_tr_b16 v[14:15], v0 offset:15744
    v_mov_b32_dpp v5, v3 quad_perm:[0,1,2,3] row_mask:0xf bank_mask:0xc
    s_setprio 0
    v_mfma_f32_16x16x32_bf16 v[32:35], v[16:19], v[64:67], v[32:35]
    s_setprio 3
    buffer_store_dwordx4 v[4:7], v1, s[12:15], s32 offen offset:0 sc0 sc1
    v_mov_b32_dpp v2, v10 row_ror:8 row_mask:0xf bank_mask:0xf
    s_setprio 0
    v_mfma_f32_16x16x32_bf16 v[36:39], v[16:19], v[68:71], v[36:39]
    s_setprio 3
    v_mov_b32_dpp v3, v11 row_ror:8 row_mask:0xf bank_mask:0xf
    v_mov_b32_dpp v10, v8 row_ror:8 row_mask:0xf bank_mask:0x3
    s_setprio 0
    s_waitcnt lgkmcnt(2)
    v_mfma_f32_16x16x32_bf16 v[24:27], v[20:23], v[72:75], v[24:27]
    s_setprio 3
    ds_read_b64_tr_b16 v[16:17], v0 offset:30720
    v_mov_b32_dpp v11, v9 row_ror:8 row_mask:0xf bank_mask:0x3
    s_setprio 0
    v_mfma_f32_16x16x32_bf16 v[28:31], v[20:23], v[76:79], v[28:31]
    s_setprio 3
    ds_read_b64_tr_b16 v[18:19], v0 offset:30848
    v_mov_b32_dpp v8, v2 quad_perm:[0,1,2,3] row_mask:0xf bank_mask:0xc
    s_setprio 0
    v_mfma_f32_16x16x32_bf16 v[32:35], v[20:23], v[80:83], v[32:35]
    s_setprio 3
    v_mov_b32_dpp v9, v3 quad_perm:[0,1,2,3] row_mask:0xf bank_mask:0xc
    buffer_store_dwordx4 v[8:11], v1, s[12:15], s32 offen offset:1024 sc0 sc1
    s_setprio 0
    v_mfma_f32_16x16x32_bf16 v[36:39], v[20:23], v[84:87], v[36:39]
    s_waitcnt lgkmcnt(2)
    v_mfma_f32_16x16x32_bf16 v[24:27], v[12:15], v[88:91], v[24:27]
    ds_read_b64_tr_b16 v[20:21], v0 offset:30976
    v_mfma_f32_16x16x32_bf16 v[28:31], v[12:15], v[92:95], v[28:31]
    ds_read_b64_tr_b16 v[22:23], v0 offset:31104
    v_mfma_f32_16x16x32_bf16 v[32:35], v[12:15], v[96:99], v[32:35]
    s_setprio 3
    v_mov_b32 v2, 0
    s_setprio 0
    v_mfma_f32_16x16x32_bf16 v[36:39], v[12:15], v[100:103], v[36:39]
    ds_read_b32 v2, v2 offset:276
    s_waitcnt lgkmcnt(3)
    v_mfma_f32_16x16x32_bf16 v[24:27], v[16:19], v[104:107], v[24:27]
    ds_read_b64_tr_b16 v[12:13], v0 offset:46080
    v_mfma_f32_16x16x32_bf16 v[28:31], v[16:19], v[108:111], v[28:31]
    ds_read_b64_tr_b16 v[14:15], v0 offset:46208
    v_mfma_f32_16x16x32_bf16 v[32:35], v[16:19], v[112:115], v[32:35]
    s_setprio 3
    s_waitcnt lgkmcnt(2)
    v_readfirstlane_b32 s52, v2
    s_and_b32 s52, s52, s36
    s_setprio 0
    v_mfma_f32_16x16x32_bf16 v[36:39], v[16:19], v[116:119], v[36:39]
    s_cselect_b32 s34, 1, 0
    s_ff1_i32_b32 s52, s52
    s_waitcnt lgkmcnt(2)
    v_mfma_f32_16x16x32_bf16 v[24:27], v[20:23], v[120:123], v[24:27]
    ds_read_b64_tr_b16 v[16:17], v0 offset:46336
    s_bitset0_b32 s36, s52
    s_mul_i32 s52, s52, 11
    v_mfma_f32_16x16x32_bf16 v[28:31], v[20:23], v[124:127], v[28:31]
    ds_read_b64_tr_b16 v[18:19], v0 offset:46464
    s_bfe_u32 s53, s52, 0x10005
    s_bfe_u32 s52, s52, 0x30006
    v_mfma_f32_16x16x32_bf16 v[32:35], v[20:23], v[128:131], v[32:35]
    s_mul_i32 s35, s53, 61440
    s_mul_i32 s31, s52, 2304
    s_add_u32 s31, s31, s35
    v_mfma_f32_16x16x32_bf16 v[36:39], v[20:23], v[132:135], v[36:39]
    s_setprio 3
    s_sub_u32 s35, s31, s39
    v_add_u32 v0, s35, v0
    s_setprio 0
    s_waitcnt lgkmcnt(2)
    v_mfma_f32_16x16x32_bf16 v[24:27], v[12:15], v[136:139], v[24:27]
    ds_read_b64_tr_b16 v[20:21], v0 offset:0
    v_mfma_f32_16x16x32_bf16 v[28:31], v[12:15], v[140:143], v[28:31]
    ds_read_b64_tr_b16 v[22:23], v0 offset:128
    v_mfma_f32_16x16x32_bf16 v[32:35], v[12:15], v[144:147], v[32:35]
    s_mov_b32 s39, s31
    s_mul_i32 s33, s53, 5
    s_add_u32 s33, s33, s52
    v_mfma_f32_16x16x32_bf16 v[36:39], v[12:15], v[148:151], v[36:39]
    s_lshl_b32 s33, s33, 13
    s_add_u32 s33, s33, s38
    s_waitcnt lgkmcnt(2)
    v_mfma_f32_16x16x32_bf16 v[24:27], v[16:19], v[152:155], v[24:27]
    ds_read_b64_tr_b16 v[12:13], v0 offset:256
    v_mfma_f32_16x16x32_bf16 v[28:31], v[16:19], v[156:159], v[28:31]
    ds_read_b64_tr_b16 v[14:15], v0 offset:384
    s_mov_b32 s32, s37
    s_mov_b32 s37, s33
    v_mfma_f32_16x16x32_bf16 v[32:35], v[16:19], v[160:163], v[32:35]
    s_cmp_eq_u32 s34, 0
    s_nop 1
    v_mfma_f32_16x16x32_bf16 v[36:39], v[16:19], v[164:167], v[36:39]
    s_setprio 3
    v_cvt_pk_bf16_f32 v4, v24, v28
    v_cvt_pk_bf16_f32 v6, v25, v29
    v_cvt_pk_bf16_f32 v8, v26, v30
    v_cvt_pk_bf16_f32 v10, v27, v31
    s_setprio 0
    s_cbranch_scc1 gm_drain
    s_waitcnt lgkmcnt(2)
    v_mfma_f32_16x16x32_bf16 v[24:27], v[20:23], v[40:43], 0
    s_setprio 3
    v_cvt_pk_bf16_f32 v7, v33, v37
    v_cvt_pk_bf16_f32 v5, v32, v36
    ds_read_b64_tr_b16 v[16:17], v0 offset:15360
    s_setprio 0
    v_mfma_f32_16x16x32_bf16 v[28:31], v[20:23], v[44:47], 0
    s_setprio 3
    v_cvt_pk_bf16_f32 v11, v35, v39
    v_cvt_pk_bf16_f32 v9, v34, v38
    ds_read_b64_tr_b16 v[18:19], v0 offset:15488
    s_setprio 0
    v_mfma_f32_16x16x32_bf16 v[32:35], v[20:23], v[48:51], 0
    s_setprio 3
    v_mov_b32_dpp v2, v6 row_ror:8 row_mask:0xf bank_mask:0xf
    v_mov_b32_dpp v3, v7 row_ror:8 row_mask:0xf bank_mask:0xf
    s_setprio 0
    v_mfma_f32_16x16x32_bf16 v[36:39], v[20:23], v[52:55], 0
    s_setprio 3
    v_mov_b32_dpp v6, v4 row_ror:8 row_mask:0xf bank_mask:0x3
    v_mov_b32_dpp v7, v5 row_ror:8 row_mask:0xf bank_mask:0x3
    s_setprio 0
    s_waitcnt lgkmcnt(2)
    v_mfma_f32_16x16x32_bf16 v[24:27], v[12:15], v[56:59], v[24:27]
    s_setprio 3
    ds_read_b64_tr_b16 v[20:21], v0 offset:15616
    v_mov_b32_dpp v4, v2 quad_perm:[0,1,2,3] row_mask:0xf bank_mask:0xc
    s_setprio 0
    v_mfma_f32_16x16x32_bf16 v[28:31], v[12:15], v[60:63], v[28:31]
    s_setprio 3
    ds_read_b64_tr_b16 v[22:23], v0 offset:15744
    v_mov_b32_dpp v5, v3 quad_perm:[0,1,2,3] row_mask:0xf bank_mask:0xc
    s_setprio 0
    v_mfma_f32_16x16x32_bf16 v[32:35], v[12:15], v[64:67], v[32:35]
    s_setprio 3
    buffer_store_dwordx4 v[4:7], v1, s[12:15], s32 offen offset:0 sc0 sc1
    v_mov_b32_dpp v2, v10 row_ror:8 row_mask:0xf bank_mask:0xf
    s_setprio 0
    v_mfma_f32_16x16x32_bf16 v[36:39], v[12:15], v[68:71], v[36:39]
    s_setprio 3
    v_mov_b32_dpp v3, v11 row_ror:8 row_mask:0xf bank_mask:0xf
    v_mov_b32_dpp v10, v8 row_ror:8 row_mask:0xf bank_mask:0x3
    s_setprio 0
    s_waitcnt lgkmcnt(2)
    v_mfma_f32_16x16x32_bf16 v[24:27], v[16:19], v[72:75], v[24:27]
    s_setprio 3
    ds_read_b64_tr_b16 v[12:13], v0 offset:30720
    v_mov_b32_dpp v11, v9 row_ror:8 row_mask:0xf bank_mask:0x3
    s_setprio 0
    v_mfma_f32_16x16x32_bf16 v[28:31], v[16:19], v[76:79], v[28:31]
    s_setprio 3
    ds_read_b64_tr_b16 v[14:15], v0 offset:30848
    v_mov_b32_dpp v8, v2 quad_perm:[0,1,2,3] row_mask:0xf bank_mask:0xc
    s_setprio 0
    v_mfma_f32_16x16x32_bf16 v[32:35], v[16:19], v[80:83], v[32:35]
    s_setprio 3
    v_mov_b32_dpp v9, v3 quad_perm:[0,1,2,3] row_mask:0xf bank_mask:0xc
    buffer_store_dwordx4 v[8:11], v1, s[12:15], s32 offen offset:1024 sc0 sc1
    s_setprio 0
    v_mfma_f32_16x16x32_bf16 v[36:39], v[16:19], v[84:87], v[36:39]
    s_waitcnt lgkmcnt(2)
    v_mfma_f32_16x16x32_bf16 v[24:27], v[20:23], v[88:91], v[24:27]
    ds_read_b64_tr_b16 v[16:17], v0 offset:30976
    v_mfma_f32_16x16x32_bf16 v[28:31], v[20:23], v[92:95], v[28:31]
    ds_read_b64_tr_b16 v[18:19], v0 offset:31104
    v_mfma_f32_16x16x32_bf16 v[32:35], v[20:23], v[96:99], v[32:35]
    s_setprio 3
    v_mov_b32 v2, 0
    s_setprio 0
    v_mfma_f32_16x16x32_bf16 v[36:39], v[20:23], v[100:103], v[36:39]
    ds_read_b32 v2, v2 offset:276
    s_waitcnt lgkmcnt(3)
    v_mfma_f32_16x16x32_bf16 v[24:27], v[12:15], v[104:107], v[24:27]
    ds_read_b64_tr_b16 v[20:21], v0 offset:46080
    v_mfma_f32_16x16x32_bf16 v[28:31], v[12:15], v[108:111], v[28:31]
    ds_read_b64_tr_b16 v[22:23], v0 offset:46208
    v_mfma_f32_16x16x32_bf16 v[32:35], v[12:15], v[112:115], v[32:35]
    s_setprio 3
    s_waitcnt lgkmcnt(2)
    v_readfirstlane_b32 s52, v2
    s_and_b32 s52, s52, s36
    s_setprio 0
    v_mfma_f32_16x16x32_bf16 v[36:39], v[12:15], v[116:119], v[36:39]
    s_cselect_b32 s34, 1, 0
    s_ff1_i32_b32 s52, s52
    s_waitcnt lgkmcnt(2)
    v_mfma_f32_16x16x32_bf16 v[24:27], v[16:19], v[120:123], v[24:27]
    ds_read_b64_tr_b16 v[12:13], v0 offset:46336
    s_bitset0_b32 s36, s52
    s_mul_i32 s52, s52, 11
    v_mfma_f32_16x16x32_bf16 v[28:31], v[16:19], v[124:127], v[28:31]
    ds_read_b64_tr_b16 v[14:15], v0 offset:46464
    s_bfe_u32 s53, s52, 0x10005
    s_bfe_u32 s52, s52, 0x30006
    v_mfma_f32_16x16x32_bf16 v[32:35], v[16:19], v[128:131], v[32:35]
    s_mul_i32 s35, s53, 61440
    s_mul_i32 s31, s52, 2304
    s_add_u32 s31, s31, s35
    v_mfma_f32_16x16x32_bf16 v[36:39], v[16:19], v[132:135], v[36:39]
    s_setprio 3
    s_sub_u32 s35, s31, s39
    v_add_u32 v0, s35, v0
    s_setprio 0
    s_waitcnt lgkmcnt(2)
    v_mfma_f32_16x16x32_bf16 v[24:27], v[20:23], v[136:139], v[24:27]
    ds_read_b64_tr_b16 v[16:17], v0 offset:0
    v_mfma_f32_16x16x32_bf16 v[28:31], v[20:23], v[140:143], v[28:31]
    ds_read_b64_tr_b16 v[18:19], v0 offset:128
    v_mfma_f32_16x16x32_bf16 v[32:35], v[20:23], v[144:147], v[32:35]
    s_mov_b32 s39, s31
    s_mul_i32 s33, s53, 5
    s_add_u32 s33, s33, s52
    v_mfma_f32_16x16x32_bf16 v[36:39], v[20:23], v[148:151], v[36:39]
    s_lshl_b32 s33, s33, 13
    s_add_u32 s33, s33, s38
    s_waitcnt lgkmcnt(2)
    v_mfma_f32_16x16x32_bf16 v[24:27], v[12:15], v[152:155], v[24:27]
    ds_read_b64_tr_b16 v[20:21], v0 offset:256
    v_mfma_f32_16x16x32_bf16 v[28:31], v[12:15], v[156:159], v[28:31]
    ds_read_b64_tr_b16 v[22:23], v0 offset:384
    s_mov_b32 s32, s37
    s_mov_b32 s37, s33
    v_mfma_f32_16x16x32_bf16 v[32:35], v[12:15], v[160:163], v[32:35]
    s_cmp_eq_u32 s34, 0
    s_nop 1
    v_mfma_f32_16x16x32_bf16 v[36:39], v[12:15], v[164:167], v[36:39]
    s_setprio 3
    v_cvt_pk_bf16_f32 v4, v24, v28
    v_cvt_pk_bf16_f32 v6, v25, v29
    v_cvt_pk_bf16_f32 v8, v26, v30
    v_cvt_pk_bf16_f32 v10, v27, v31
    s_setprio 0
    s_cbranch_scc1 gm_drain
    s_waitcnt lgkmcnt(2)
    v_mfma_f32_16x16x32_bf16 v[24:27], v[16:19], v[40:43], 0
    s_setprio 3
    v_cvt_pk_bf16_f32 v7, v33, v37
    v_cvt_pk_bf16_f32 v5, v32, v36
    ds_read_b64_tr_b16 v[12:13], v0 offset:15360
    s_setprio 0
    v_mfma_f32_16x16x32_bf16 v[28:31], v[16:19], v[44:47], 0
    s_setprio 3
    v_cvt_pk_bf16_f32 v11, v35, v39
    v_cvt_pk_bf16_f32 v9, v34, v38
    ds_read_b64_tr_b16 v[14:15], v0 offset:15488
    s_setprio 0
    v_mfma_f32_16x16x32_bf16 v[32:35], v[16:19], v[48:51], 0
    s_setprio 3
    v_mov_b32_dpp v2, v6 row_ror:8 row_mask:0xf bank_mask:0xf
    v_mov_b32_dpp v3, v7 row_ror:8 row_mask:0xf bank_mask:0xf
    s_setprio 0
    v_mfma_f32_16x16x32_bf16 v[36:39], v[16:19], v[52:55], 0
    s_setprio 3
    v_mov_b32_dpp v6, v4 row_ror:8 row_mask:0xf bank_mask:0x3
    v_mov_b32_dpp v7, v5 row_ror:8 row_mask:0xf bank_mask:0x3
    s_setprio 0
    s_waitcnt lgkmcnt(2)
    v_mfma_f32_16x16x32_bf16 v[24:27], v[20:23], v[56:59], v[24:27]
    s_setprio 3
    ds_read_b64_tr_b16 v[16:17], v0 offset:15616
    v_mov_b32_dpp v4, v2 quad_perm:[0,1,2,3] row_mask:0xf bank_mask:0xc
    s_setprio 0
    v_mfma_f32_16x16x32_bf16 v[28:31], v[20:23], v[60:63], v[28:31]
    s_setprio 3
    ds_read_b64_tr_b16 v[18:19], v0 offset:15744
    v_mov_b32_dpp v5, v3 quad_perm:[0,1,2,3] row_mask:0xf bank_mask:0xc
    s_setprio 0
    v_mfma_f32_16x16x32_bf16 v[32:35], v[20:23], v[64:67], v[32:35]
    s_setprio 3
    buffer_store_dwordx4 v[4:7], v1, s[12:15], s32 offen offset:0 sc0 sc1
    v_mov_b32_dpp v2, v10 row_ror:8 row_mask:0xf bank_mask:0xf
    s_setprio 0
    v_mfma_f32_16x16x32_bf16 v[36:39], v[20:23], v[68:71], v[36:39]
    s_setprio 3
    v_mov_b32_dpp v3, v11 row_ror:8 row_mask:0xf bank_mask:0xf
    v_mov_b32_dpp v10, v8 row_ror:8 row_mask:0xf bank_mask:0x3
    s_setprio 0
    s_waitcnt lgkmcnt(2)
    v_mfma_f32_16x16x32_bf16 v[24:27], v[12:15], v[72:75], v[24:27]
    s_setprio 3
    ds_read_b64_tr_b16 v[20:21], v0 offset:30720
    v_mov_b32_dpp v11, v9 row_ror:8 row_mask:0xf bank_mask:0x3
    s_setprio 0
    v_mfma_f32_16x16x32_bf16 v[28:31], v[12:15], v[76:79], v[28:31]
    s_setprio 3
    ds_read_b64_tr_b16 v[22:23], v0 offset:30848
    v_mov_b32_dpp v8, v2 quad_perm:[0,1,2,3] row_mask:0xf bank_mask:0xc
    s_setprio 0
    v_mfma_f32_16x16x32_bf16 v[32:35], v[12:15], v[80:83], v[32:35]
    s_setprio 3
    v_mov_b32_dpp v9, v3 quad_perm:[0,1,2,3] row_mask:0xf bank_mask:0xc
    buffer_store_dwordx4 v[8:11], v1, s[12:15], s32 offen offset:1024 sc0 sc1
    s_setprio 0
    v_mfma_f32_16x16x32_bf16 v[36:39], v[12:15], v[84:87], v[36:39]
    s_waitcnt lgkmcnt(2)
    v_mfma_f32_16x16x32_bf16 v[24:27], v[16:19], v[88:91], v[24:27]
    ds_read_b64_tr_b16 v[12:13], v0 offset:30976
    v_mfma_f32_16x16x32_bf16 v[28:31], v[16:19], v[92:95], v[28:31]
    ds_read_b64_tr_b16 v[14:15], v0 offset:31104
    v_mfma_f32_16x16x32_bf16 v[32:35], v[16:19], v[96:99], v[32:35]
    s_setprio 3
    v_mov_b32 v2, 0
    s_setprio 0
    v_mfma_f32_16x16x32_bf16 v[36:39], v[16:19], v[100:103], v[36:39]
    ds_read_b32 v2, v2 offset:276
    s_waitcnt lgkmcnt(3)
    v_mfma_f32_16x16x32_bf16 v[24:27], v[20:23], v[104:107], v[24:27]
    ds_read_b64_tr_b16 v[16:17], v0 offset:46080
    v_mfma_f32_16x16x32_bf16 v[28:31], v[20:23], v[108:111], v[28:31]
    ds_read_b64_tr_b16 v[18:19], v0 offset:46208
    v_mfma_f32_16x16x32_bf16 v[32:35], v[20:23], v[112:115], v[32:35]
    s_setprio 3
    s_waitcnt lgkmcnt(2)
    v_readfirstlane_b32 s52, v2
    s_and_b32 s52, s52, s36
    s_setprio 0
    v_mfma_f32_16x16x32_bf16 v[36:39], v[20:23], v[116:119], v[36:39]
    s_cselect_b32 s34, 1, 0
    s_ff1_i32_b32 s52, s52
    s_waitcnt lgkmcnt(2)
    v_mfma_f32_16x16x32_bf16 v[24:27], v[12:15], v[120:123], v[24:27]
    ds_read_b64_tr_b16 v[20:21], v0 offset:46336
    s_bitset0_b32 s36, s52
    s_mul_i32 s52, s52, 11
    v_mfma_f32_16x16x32_bf16 v[28:31], v[12:15], v[124:127], v[28:31]
    ds_read_b64_tr_b16 v[22:23], v0 offset:46464
    s_bfe_u32 s53, s52, 0x10005
    s_bfe_u32 s52, s52, 0x30006
    v_mfma_f32_16x16x32_bf16 v[32:35], v[12:15], v[128:131], v[32:35]
    s_mul_i32 s35, s53, 61440
    s_mul_i32 s31, s52, 2304
    s_add_u32 s31, s31, s35
    v_mfma_f32_16x16x32_bf16 v[36:39], v[12:15], v[132:135], v[36:39]
    s_setprio 3
    s_sub_u32 s35, s31, s39
    v_add_u32 v0, s35, v0
    s_setprio 0
    s_waitcnt lgkmcnt(2)
    v_mfma_f32_16x16x32_bf16 v[24:27], v[16:19], v[136:139], v[24:27]
    ds_read_b64_tr_b16 v[12:13], v0 offset:0
    v_mfma_f32_16x16x32_bf16 v[28:31], v[16:19], v[140:143], v[28:31]
    ds_read_b64_tr_b16 v[14:15], v0 offset:128
    v_mfma_f32_16x16x32_bf16 v[32:35], v[16:19], v[144:147], v[32:35]
    s_mov_b32 s39, s31
    s_mul_i32 s33, s53, 5
    s_add_u32 s33, s33, s52
    v_mfma_f32_16x16x32_bf16 v[36:39], v[16:19], v[148:151], v[36:39]
    s_lshl_b32 s33, s33, 13
    s_add_u32 s33, s33, s38
    s_waitcnt lgkmcnt(2)
    v_mfma_f32_16x16x32_bf16 v[24:27], v[20:23], v[152:155], v[24:27]
    ds_read_b64_tr_b16 v[16:17], v0 offset:256
    v_mfma_f32_16x16x32_bf16 v[28:31], v[20:23], v[156:159], v[28:31]
    ds_read_b64_tr_b16 v[18:19], v0 offset:384
    s_mov_b32 s32, s37
    s_mov_b32 s37, s33
    v_mfma_f32_16x16x32_bf16 v[32:35], v[20:23], v[160:163], v[32:35]
    s_cmp_eq_u32 s34, 0
    s_nop 1
    v_mfma_f32_16x16x32_bf16 v[36:39], v[20:23], v[164:167], v[36:39]
    s_setprio 3
    v_cvt_pk_bf16_f32 v4, v24, v28
    v_cvt_pk_bf16_f32 v6, v25, v29
    v_cvt_pk_bf16_f32 v8, v26, v30
    v_cvt_pk_bf16_f32 v10, v27, v31
    s_setprio 0
    s_cbranch_scc0 gm_loop
gm_drain:
    s_nop 2
    s_setprio 3
    v_cvt_pk_bf16_f32 v7, v33, v37
    v_cvt_pk_bf16_f32 v5, v32, v36
    v_cvt_pk_bf16_f32 v11, v35, v39
    v_cvt_pk_bf16_f32 v9, v34, v38
    v_mov_b32_dpp v2, v6 row_ror:8 row_mask:0xf bank_mask:0xf
    v_mov_b32_dpp v3, v7 row_ror:8 row_mask:0xf bank_mask:0xf
    v_mov_b32_dpp v6, v4 row_ror:8 row_mask:0xf bank_mask:0x3
    v_mov_b32_dpp v7, v5 row_ror:8 row_mask:0xf bank_mask:0x3
    v_mov_b32_dpp v4, v2 quad_perm:[0,1,2,3] row_mask:0xf bank_mask:0xc
    v_mov_b32_dpp v5, v3 quad_perm:[0,1,2,3] row_mask:0xf bank_mask:0xc
    buffer_store_dwordx4 v[4:7], v1, s[12:15], s32 offen offset:0 sc0 sc1
    v_mov_b32_dpp v2, v10 row_ror:8 row_mask:0xf bank_mask:0xf
    v_mov_b32_dpp v3, v11 row_ror:8 row_mask:0xf bank_mask:0xf
    v_mov_b32_dpp v10, v8 row_ror:8 row_mask:0xf bank_mask:0x3
    v_mov_b32_dpp v11, v9 row_ror:8 row_mask:0xf bank_mask:0x3
    v_mov_b32_dpp v8, v2 quad_perm:[0,1,2,3] row_mask:0xf bank_mask:0xc
    v_mov_b32_dpp v9, v3 quad_perm:[0,1,2,3] row_mask:0xf bank_mask:0xc
    buffer_store_dwordx4 v[8:11], v1, s[12:15], s32 offen offset:1024 sc0 sc1
    s_setprio 0
    s_cmp_lg_u32 s36, 0
    s_cbranch_scc1 gm_poll
    s_endpgm
gm_ovf:
    s_movk_i32 s20, 4
    s_barrier
    s_barrier
    s_barrier
    s_branch gm_pass
gm_next:
    s_add_u32 s24, s24, s20
    s_barrier
    s_branch gm_pass
mn_w5:
    v_add_u32 v55, 16, v35
    v_add_u32 v55, s24, v55
    v_lshrrev_b32 v56, 16, v58
    v_mov_b32 v24, 0
    v_cmpx_lt_u32 vcc, v55, v56
    s_cbranch_execz mn_g0
    v_cmp_gt_u32 vcc, 16, v55
    v_and_b32 v56, 0xffff, v58
    v_add_lshl_u32 v56, v55, v56, 2
    v_add_u32 v56, v56, v46
    v_lshl_add_u32 v57, v0, 4, s22
    v_and_or_b32 v57, v55, 12, v57
    v_cndmask_b32 v56, v56, v57, vcc
    buffer_load_dword v24, v56, s[8:11], 0 offen
    s_waitcnt vmcnt(0)
mn_g0:
    s_mov_b64 exec, -1
mn_more:
    s_add_u32 s52, s24, s20
    v_lshrrev_b32 v56, 16, v58
    v_cmp_lt_u32 vcc, s52, v56
    s_cbranch_vccz mn_count
    v_mov_b32 v55, 272
    ds_write_b32 v55, v48
    s_branch mn_count
mn_ovf:
    s_movk_i32 s20, 4
    s_waitcnt vmcnt(0) lgkmcnt(0)
    s_barrier
    s_branch mn_again
mn_next:
    s_set_gpr_idx_off
    s_waitcnt vmcnt(0) lgkmcnt(0)
    s_nop 7
    s_add_u32 s24, s24, s20
    v_mbcnt_lo_u32_b32 v0, -1, 0
    v_mbcnt_hi_u32_b32 v0, -1, v0
    v_lshl_add_u32 v0, s16, 6, v0
    v_lshrrev_b32 v56, 6, v0
    v_lshlrev_b32 v55, 1, v0
    v_and_b32 v55, 0x78, v55
    v_or_b32 v55, v55, v56
    v_cmp_gt_u32 vcc, 125, v55
    v_mul_u32_u24 v46, 5120, v55
    v_add_u32 v46, 7340032, v46
    v_bfrev_b32 v56, 2
    v_lshlrev_b32 v55, 4, v0
    v_and_b32 v57, 0x1fc, v0
    v_cndmask_b32 v55, v56, v55, vcc
    v_cndmask_b32 v57, v56, v57, vcc
    v_and_b32 v51, 63, v0
    v_lshlrev_b32 v56, 3, v51
    buffer_load_dword v58, v57, s[8:11], s25 offen
    buffer_load_dwordx2 v[44:45], v56, s[8:11], s25 offen
    v_mov_b32 v48, 1
    v_lshlrev_b32 v47, 2, v51
    v_bfe_u32 v2, v0, 5, 1
    v_bfe_u32 v3, v0, 3, 2
    v_and_b32 v35, 3, v0
    v_lshl_add_u32 v3, v3, 2, v35
    v_mul_u32_u24 v49, 20, v2
    v_lshrrev_b32 v18, 2, v51
    v_lshl_add_u32 v18, v35, 4, v18
    v_mov_b32 v50, 0x3fff
    s_lshl_b32 s52, s16, 3
    s_bfm_b64 s[36:37], s52, 0
    s_andn2_b32 s39, s37, 2155905024
    s_mov_b32 s38, s36
mn_again:
    v_mov_b32 v55, 0
    ds_write_b32 v47, v55 offset:0
    ds_write_b32 v47, v55 offset:256
    s_waitcnt vmcnt(0) lgkmcnt(0)
    s_barrier
    v_add_u32 v55, 0, v35
    v_add_u32 v55, s24, v55
    v_lshrrev_b32 v56, 16, v58
    v_mov_b32 v20, 0
    v_cmpx_lt_u32 vcc, v55, v56
    s_cbranch_execz mn_g1
    v_cmp_gt_u32 vcc, 16, v55
    v_and_b32 v56, 0xffff, v58
    v_add_lshl_u32 v56, v55, v56, 2
    v_add_u32 v56, v56, v46
    v_lshl_add_u32 v57, v0, 4, s22
    v_and_or_b32 v57, v55, 12, v57
    v_cndmask_b32 v56, v56, v57, vcc
    buffer_load_dword v20, v56, s[8:11], 0 offen
    s_waitcnt vmcnt(0)
mn_g1:
    s_mov_b64 exec, -1
    v_mov_b32 v21, 0
    v_mov_b32 v22, 0
    v_mov_b32 v23, 0
    v_mov_b32 v24, 0
    s_cmp_le_u32 s20, 4
    s_cbranch_scc1 mn_more
    v_add_u32 v55, 4, v35
    v_add_u32 v55, s24, v55
    v_lshrrev_b32 v56, 16, v58
    v_mov_b32 v21, 0
    v_cmpx_lt_u32 vcc, v55, v56
    s_cbranch_execz mn_g2
    v_cmp_gt_u32 vcc, 16, v55
    v_and_b32 v56, 0xffff, v58
    v_add_lshl_u32 v56, v55, v56, 2
    v_add_u32 v56, v56, v46
    v_lshl_add_u32 v57, v0, 4, s22
    v_and_or_b32 v57, v55, 12, v57
    v_cndmask_b32 v56, v56, v57, vcc
    buffer_load_dword v21, v56, s[8:11], 0 offen
    s_waitcnt vmcnt(0)
mn_g2:
    s_mov_b64 exec, -1
    v_add_u32 v55, 8, v35
    v_add_u32 v55, s24, v55
    v_lshrrev_b32 v56, 16, v58
    v_mov_b32 v22, 0
    v_cmpx_lt_u32 vcc, v55, v56
    s_cbranch_execz mn_g3
    v_cmp_gt_u32 vcc, 16, v55
    v_and_b32 v56, 0xffff, v58
    v_add_lshl_u32 v56, v55, v56, 2
    v_add_u32 v56, v56, v46
    v_lshl_add_u32 v57, v0, 4, s22
    v_and_or_b32 v57, v55, 12, v57
    v_cndmask_b32 v56, v56, v57, vcc
    buffer_load_dword v22, v56, s[8:11], 0 offen
    s_waitcnt vmcnt(0)
mn_g3:
    s_mov_b64 exec, -1
    v_add_u32 v55, 12, v35
    v_add_u32 v55, s24, v55
    v_lshrrev_b32 v56, 16, v58
    v_mov_b32 v23, 0
    v_cmpx_lt_u32 vcc, v55, v56
    s_cbranch_execz mn_g4
    v_cmp_gt_u32 vcc, 16, v55
    v_and_b32 v56, 0xffff, v58
    v_add_lshl_u32 v56, v55, v56, 2
    v_add_u32 v56, v56, v46
    v_lshl_add_u32 v57, v0, 4, s22
    v_and_or_b32 v57, v55, 12, v57
    v_cndmask_b32 v56, v56, v57, vcc
    buffer_load_dword v23, v56, s[8:11], 0 offen
    s_waitcnt vmcnt(0)
mn_g4:
    s_mov_b64 exec, -1
    v_add_u32 v55, 16, v35
    v_add_u32 v55, s24, v55
    v_lshrrev_b32 v56, 16, v58
    v_mov_b32 v24, 0
    v_cmpx_lt_u32 vcc, v55, v56
    s_cbranch_execz mn_g5
    v_cmp_gt_u32 vcc, 16, v55
    v_and_b32 v56, 0xffff, v58
    v_add_lshl_u32 v56, v55, v56, 2
    v_add_u32 v56, v56, v46
    v_lshl_add_u32 v57, v0, 4, s22
    v_and_or_b32 v57, v55, 12, v57
    v_cndmask_b32 v56, v56, v57, vcc
    buffer_load_dword v24, v56, s[8:11], 0 offen
    s_waitcnt vmcnt(0)
mn_g5:
    s_mov_b64 exec, -1
    s_branch mn_more
mn_last:
    s_endpgm
.section .rodata,"a"
.p2align 6
.amdhsa_kernel ka_kernel
  .amdhsa_next_free_vgpr 88
  .amdhsa_next_free_sgpr 40
  .amdhsa_accum_offset 88
  .amdhsa_group_segment_fixed_size 0
  .amdhsa_kernarg_size 88
  .amdhsa_user_sgpr_count 2
  .amdhsa_user_sgpr_kernarg_segment_ptr 1
  .amdhsa_system_sgpr_workgroup_id_x 1
.end_amdhsa_kernel
.p2align 6
.amdhsa_kernel main_kernel
  .amdhsa_next_free_vgpr 168
  .amdhsa_next_free_sgpr 96
  .amdhsa_accum_offset 168
  .amdhsa_group_segment_fixed_size 0
  .amdhsa_kernarg_size 88
  .amdhsa_user_sgpr_count 2
  .amdhsa_user_sgpr_kernarg_segment_ptr 1
  .amdhsa_system_sgpr_workgroup_id_x 1
.end_amdhsa_kernel
```

```asm
; @launch kernel=standalone__tensor_product_equiv_mace__graph_kernel grid=(256,1,1) block=(768,1,1) lds=163840
.amdgcn_target "amdgcn-amd-amdhsa--gfx950"
.text
.globl standalone__tensor_product_equiv_mace__graph_kernel
.p2align 8
.type standalone__tensor_product_equiv_mace__graph_kernel,@function
standalone__tensor_product_equiv_mace__graph_kernel:
    s_cmp_ge_u32 s2, 256
    s_cbranch_scc1 ka_end
    s_cmp_lt_u32 s2, 128
    s_cbranch_scc1 ka_nospf
    s_getpc_b64 s[36:37]
ka_pc0:
    v_lshlrev_b32 v41, 7, v0
    v_min_u32 v41, mn_last-ka_pc0, v41
    global_load_dword v41, v41, s[36:37]
ka_nospf:
    s_load_dwordx8 s[4:11], s[0:1], 8
    s_load_dwordx2 s[16:17], s[0:1], 0
    s_load_dwordx4 s[12:15], s[0:1], 72
    v_lshrrev_b32 v9, 6, v0
    v_and_b32 v1, 63, v0
    v_readfirstlane_b32 s18, v9
    s_cmp_lg_u32 s18, 11
    s_cbranch_scc1 ka_nomb
    s_and_b32 s3, s2, 7
    s_lshl_b32 s3, s3, 7
    s_add_u32 s3, s3, 11730944
    v_mov_b32 v86, s3
    s_waitcnt lgkmcnt(0)
    global_load_dword v87, v86, s[14:15] sc1
ka_nomb:
    s_and_b32 s3, s2, 127
    s_cmp_ge_u32 s3, 125
    s_cbranch_scc1 mn_start
    s_cmp_ge_u32 s2, 128
    s_cbranch_scc1 ka_pf
    s_mul_i32 s3, s2, 1280
    v_add_u32 v4, s3, v0
    v_lshlrev_b32 v5, 2, v4
    s_mov_b32 s22, 12582912
    s_mov_b32 s23, 0x20000
    s_and_b32 s28, s2, 7
    s_lshl_b32 s28, s28, 4
    s_lshr_b32 s29, s2, 3
    s_add_u32 s28, s28, s29
    s_cmp_ge_u32 s18, 10
    s_waitcnt lgkmcnt(0)
    s_mov_b32 s20, s14
    s_cbranch_scc1 ka_dma
    global_load_dword v10, v5, s[6:7]
    global_load_dword v60, v5, s[6:7] offset:2560
    global_load_dword v11, v5, s[4:5]
    global_load_dword v61, v5, s[4:5] offset:2560
    v_lshlrev_b32 v2, 2, v0
    v_and_b32 v2, 0x3fc, v2
    v_lshlrev_b32 v5, 4, v0
    v_mov_b32 v44, 0
    v_mov_b32 v45, 0
    v_mov_b32 v46, 0
    v_mov_b32 v47, 0
    ds_write_b32 v2, v44 offset:1024
    ds_write_b128 v5, v[44:47] offset:12288
    ds_write_b128 v5, v[44:47] offset:18432
    s_and_b32 s21, s15, 0xffff
    v_mov_b32 v3, 1
    v_lshlrev_b32 v26, 4, v1
    s_lshl_b32 s19, s18, 10
    v_add_u32 v27, s19, v26
    v_mov_b32 v4, 0x40000
    s_movk_i32 s29, 625
    s_movk_i32 s38, 0x3fff
    s_waitcnt lgkmcnt(0)
    s_barrier
    v_mov_b32 v19, 74752
    v_lshl_add_u32 v18, v0, 1, 0
    v_mul_u32_u24 v16, 13108, v18
    v_lshrrev_b32 v16, 16, v16
    v_mad_i32_i24 v18, v16, -5, v18
    v_lshlrev_b32 v16, 2, v16
    v_cmp_eq_u32 vcc, 4, v18
    v_lshlrev_b32 v18, 3, v18
    v_add_u32 v18, 33792, v18
    v_cndmask_b32 v17, 5, 3, vcc
    v_cndmask_b32 v18, v18, v19, vcc
    v_lshl_add_u32 v14, v0, 1, 1
    v_mul_u32_u24 v12, 13108, v14
    v_lshrrev_b32 v12, 16, v12
    v_mad_i32_i24 v14, v12, -5, v14
    v_lshlrev_b32 v12, 2, v12
    v_cmp_eq_u32 vcc, 4, v14
    v_lshlrev_b32 v14, 3, v14
    v_add_u32 v14, 33792, v14
    v_cndmask_b32 v13, 5, 3, vcc
    v_cndmask_b32 v14, v14, v19, vcc
    s_mul_i32 s31, s2, 51200
    s_waitcnt vmcnt(3)
    v_mul_u32_u24 v32, 214749, v10
    v_lshrrev_b32 v32, 23, v32
    v_min_u32 v32, 255, v32
    v_and_b32 v35, 7, v32
    v_lshrrev_b32 v33, 3, v32
    v_lshl_add_u32 v35, v35, 5, v33
    v_lshlrev_b32 v35, 2, v35
    ds_add_rtn_u32 v36, v35, v3 offset:1024
    s_waitcnt vmcnt(2)
    v_mul_u32_u24 v62, 214749, v60
    v_lshrrev_b32 v62, 23, v62
    v_min_u32 v62, 255, v62
    v_and_b32 v66, 7, v62
    v_lshrrev_b32 v63, 3, v62
    v_lshl_add_u32 v66, v66, 5, v63
    v_lshlrev_b32 v66, 2, v66
    ds_add_rtn_u32 v67, v66, v3 offset:1024
    v_mad_u32_u24 v33, v32, s29, 15
    v_lshrrev_b32 v33, 4, v33
    v_sub_u32 v33, v10, v33
    v_subrev_u32 v32, 20, v33
    v_min_u32 v32, v32, v33
    v_min_u32 v32, 19, v32
    v_lshlrev_b32 v40, 4, v35
    v_add_u32 v35, s19, v35
    v_mad_u32_u24 v63, v62, s29, 15
    v_lshrrev_b32 v63, 4, v63
    v_sub_u32 v63, v60, v63
    v_subrev_u32 v62, 20, v63
    v_min_u32 v62, v62, v63
    v_min_u32 v62, 19, v62
    v_lshlrev_b32 v70, 4, v66
    v_add_u32 v66, s19, v66
    s_waitcnt vmcnt(0) lgkmcnt(0)
    v_mul_u32_u24 v39, 3330, v11
    v_lshrrev_b32 v39, 20, v39
    v_lshrrev_b32 v34, 2, v32
    v_cmp_gt_u32 vcc, 27, v39
    v_add_u32 v34, 27, v34
    v_lshlrev_b32 v23, 14, v32
    v_cndmask_b32 v39, v34, v39, vcc
    v_cmp_le_u32 vcc, 20, v33
    v_and_or_b32 v22, v11, s38, v23
    v_or_b32 v39, 64, v39
    v_add_u32 v34, 32, v39
    v_cndmask_b32 v39, v39, v34, vcc
    v_lshl_or_b32 v22, v39, 25, v22
    v_cmp_lt_u32 vcc, 14, v36
    v_and_b32 v34, 3, v36
    v_lshl_add_u32 v40, v34, 4, v40
    v_and_or_b32 v40, v36, 12, v40
    v_cndmask_b32 v40, v40, v4, vcc
    ds_write_b32 v40, v22 offset:12288
    v_mul_u32_u24 v68, 3330, v61
    v_lshrrev_b32 v68, 20, v68
    v_lshrrev_b32 v71, 2, v62
    v_cmp_gt_u32 vcc, 27, v68
    v_add_u32 v71, 27, v71
    v_lshlrev_b32 v75, 14, v62
    v_cndmask_b32 v68, v71, v68, vcc
    v_cmp_le_u32 vcc, 20, v63
    v_and_or_b32 v74, v61, s38, v75
    v_or_b32 v68, 64, v68
    v_add_u32 v71, 32, v68
    v_cndmask_b32 v68, v68, v71, vcc
    v_lshl_or_b32 v74, v68, 25, v74
    v_cmp_lt_u32 vcc, 14, v67
    v_and_b32 v71, 3, v67
    v_lshl_add_u32 v70, v71, 4, v70
    v_and_or_b32 v70, v67, 12, v70
    v_cndmask_b32 v70, v70, v4, vcc
    ds_write_b32 v70, v74 offset:12288
    s_waitcnt lgkmcnt(0)
    s_barrier
    ds_read_b128 v[44:47], v26 offset:1024
    v_add_u32 v9, 640, v0
    v_max_u32 v8, v36, v67
    v_cmp_lt_u32 vcc, 14, v8
    s_waitcnt lgkmcnt(0)
    v_add_u32 v53, v44, v45
    v_add_u32 v54, v53, v46
    v_add_u32 v38, v54, v47
    v_mov_b32 v55, v38
    s_nop 0
    v_add_u32_dpp v38, v38, v38 row_shr:1 row_mask:0xf bank_mask:0xf
    s_nop 0
    s_nop 0
    v_add_u32_dpp v38, v38, v38 row_shr:2 row_mask:0xf bank_mask:0xf
    s_nop 0
    s_nop 0
    v_add_u32_dpp v38, v38, v38 row_shr:4 row_mask:0xf bank_mask:0xf
    s_nop 0
    s_nop 0
    v_add_u32_dpp v38, v38, v38 row_shr:8 row_mask:0xf bank_mask:0xf
    s_nop 0
    s_nop 0
    v_add_u32_dpp v38, v38, v38 row_bcast:15 row_mask:0xa bank_mask:0xf
    s_nop 0
    s_nop 0
    v_add_u32_dpp v38, v38, v38 row_bcast:31 row_mask:0xc bank_mask:0xf
    v_sub_u32 v56, v38, v55
    v_add_u32 v57, v56, v44
    v_add_u32 v58, v56, v53
    v_add_u32 v59, v56, v54
    ds_write_b128 v27, v[56:59] offset:2048
    ds_read_b32 v43, v35 offset:2048
    ds_read_b32 v69, v66 offset:2048
    s_waitcnt lgkmcnt(0)
    v_add_lshl_u32 v43, v43, v36, 2
    v_add_lshl_u32 v69, v69, v67, 2
    ds_write_b32 v43, v0 offset:28672
    ds_write_b32 v69, v9 offset:28672
    s_cbranch_vccnz ka_ov
ka_ov_back:
    s_waitcnt lgkmcnt(0)
ka_copy:
    s_barrier
    ds_read_b32 v20, v16 offset:28672
    ds_read_b32 v21, v12 offset:28672
    ds_read_b32 v22, v16 offset:29696
    ds_read_b32 v23, v12 offset:29696
    ds_read_b32 v24, v16 offset:30720
    ds_read_b32 v25, v12 offset:30720
    ds_read_b32 v26, v16 offset:31744
    ds_read_b32 v27, v12 offset:31744
    ds_read_b32 v28, v16 offset:32768
    ds_read_b32 v29, v12 offset:32768
    s_waitcnt lgkmcnt(8)
    v_lshl_add_u32 v20, v20, v17, v18
    v_lshl_add_u32 v21, v21, v13, v14
    ds_read_b64 v[44:45], v20
    ds_read_b64 v[46:47], v21
    s_waitcnt lgkmcnt(8)
    v_lshl_add_u32 v22, v22, v17, v18
    v_lshl_add_u32 v23, v23, v13, v14
    ds_read_b64 v[48:49], v22
    ds_read_b64 v[50:51], v23
    s_waitcnt lgkmcnt(8)
    v_lshl_add_u32 v24, v24, v17, v18
    v_lshl_add_u32 v25, v25, v13, v14
    ds_read_b64 v[52:53], v24
    ds_read_b64 v[54:55], v25
    s_waitcnt lgkmcnt(8)
    v_lshl_add_u32 v26, v26, v17, v18
    v_lshl_add_u32 v27, v27, v13, v14
    ds_read_b64 v[56:57], v26
    ds_read_b64 v[58:59], v27
    s_waitcnt lgkmcnt(8)
    v_lshl_add_u32 v28, v28, v17, v18
    v_lshl_add_u32 v29, v29, v13, v14
    ds_read_b64 v[60:61], v28
    ds_read_b64 v[62:63], v29
    s_waitcnt lgkmcnt(8)
    buffer_store_dwordx4 v[44:47], v5, s[20:23], s31 offen sc1
    s_addk_i32 s31, 10240
    s_waitcnt lgkmcnt(6)
    buffer_store_dwordx4 v[48:51], v5, s[20:23], s31 offen sc1
    s_addk_i32 s31, 10240
    s_waitcnt lgkmcnt(4)
    buffer_store_dwordx4 v[52:55], v5, s[20:23], s31 offen sc1
    s_addk_i32 s31, 10240
    s_waitcnt lgkmcnt(2)
    buffer_store_dwordx4 v[56:59], v5, s[20:23], s31 offen sc1
    s_addk_i32 s31, 10240
    s_waitcnt lgkmcnt(0)
    buffer_store_dwordx4 v[60:63], v5, s[20:23], s31 offen sc1
    s_waitcnt vmcnt(0)
    s_mov_b64 exec, 1
    v_mov_b32 v2, 0
    v_mov_b32 v3, 1
    ds_add_rtn_u32 v4, v2, v3 offset:448
    s_waitcnt lgkmcnt(0)
    v_readfirstlane_b32 s33, v4
    s_cmp_lg_u32 s33, 10
    s_cbranch_scc1 ka_arr
    s_and_b32 s34, s2, 1
    s_lshl_b32 s35, s34, 7
    s_mov_b32 s33, 1
    s_atomic_add s33, s[12:13], s35 glc
    s_lshl_b32 s34, s34, 3
    s_lshr_b32 s34, 15678, s34
    s_and_b32 s34, s34, 0xff
    s_waitcnt lgkmcnt(0)
    s_cmp_eq_u32 s33, s34
    s_cbranch_scc1 ka_bcast
ka_arr:
    s_mov_b64 exec, -1
    s_branch mn_start2
ka_ov:
    s_mul_i32 s33, s2, 5120
    s_add_u32 s33, s33, 7340032
    buffer_store_dword v22, v43, s[20:23], s33 offen sc1
    buffer_store_dword v74, v69, s[20:23], s33 offen sc1
    s_branch ka_ov_back
ka_dma:
    s_and_b32 s21, s15, 0xffff
    s_cmp_eq_u32 s18, 11
    s_cbranch_scc1 ka_cell
    s_mul_i32 s35, s2, 40960
    v_lshl_add_u32 v7, v1, 4, s35
    s_mul_i32 s35, s2, 10240
    v_lshl_add_u32 v8, v1, 4, s35
    s_mov_b32 m0, 74752
    s_barrier
    global_load_lds_dwordx4 v8, s[8:9] offset:0
    global_load_lds_dwordx4 v8, s[8:9] offset:1024
    s_add_u32 m0, m0, 2048
    v_add_u32 v8, 2048, v8
    global_load_lds_dwordx4 v8, s[8:9] offset:0
    global_load_lds_dwordx4 v8, s[8:9] offset:1024
    s_add_u32 m0, m0, 2048
    v_add_u32 v8, 2048, v8
    global_load_lds_dwordx4 v8, s[8:9] offset:0
    global_load_lds_dwordx4 v8, s[8:9] offset:1024
    s_add_u32 m0, m0, 2048
    v_add_u32 v8, 2048, v8
    global_load_lds_dwordx4 v8, s[8:9] offset:0
    global_load_lds_dwordx4 v8, s[8:9] offset:1024
    s_add_u32 m0, m0, 2048
    v_add_u32 v8, 2048, v8
    global_load_lds_dwordx4 v8, s[8:9] offset:0
    global_load_lds_dwordx4 v8, s[8:9] offset:1024
    s_add_u32 m0, m0, 2048
    v_add_u32 v8, 2048, v8
    s_mov_b32 m0, 33792
    s_nop 0
    global_load_lds_dwordx4 v7, s[10:11] offset:0
    global_load_lds_dwordx4 v7, s[10:11] offset:1024
    s_add_u32 m0, m0, 2048
    v_add_u32 v7, 2048, v7
    global_load_lds_dwordx4 v7, s[10:11] offset:0
    global_load_lds_dwordx4 v7, s[10:11] offset:1024
    s_add_u32 m0, m0, 2048
    v_add_u32 v7, 2048, v7
    global_load_lds_dwordx4 v7, s[10:11] offset:0
    global_load_lds_dwordx4 v7, s[10:11] offset:1024
    s_add_u32 m0, m0, 2048
    v_add_u32 v7, 2048, v7
    s_barrier
    global_load_lds_dwordx4 v7, s[10:11] offset:0
    global_load_lds_dwordx4 v7, s[10:11] offset:1024
    s_add_u32 m0, m0, 2048
    v_add_u32 v7, 2048, v7
    global_load_lds_dwordx4 v7, s[10:11] offset:0
    global_load_lds_dwordx4 v7, s[10:11] offset:1024
    s_add_u32 m0, m0, 2048
    v_add_u32 v7, 2048, v7
    global_load_lds_dwordx4 v7, s[10:11] offset:0
    global_load_lds_dwordx4 v7, s[10:11] offset:1024
    s_add_u32 m0, m0, 2048
    v_add_u32 v7, 2048, v7
    global_load_lds_dwordx4 v7, s[10:11] offset:0
    global_load_lds_dwordx4 v7, s[10:11] offset:1024
    s_add_u32 m0, m0, 2048
    v_add_u32 v7, 2048, v7
    global_load_lds_dwordx4 v7, s[10:11] offset:0
    global_load_lds_dwordx4 v7, s[10:11] offset:1024
    s_add_u32 m0, m0, 2048
    v_add_u32 v7, 2048, v7
    global_load_lds_dwordx4 v7, s[10:11] offset:0
    global_load_lds_dwordx4 v7, s[10:11] offset:1024
    s_add_u32 m0, m0, 2048
    v_add_u32 v7, 2048, v7
    global_load_lds_dwordx4 v7, s[10:11] offset:0
    global_load_lds_dwordx4 v7, s[10:11] offset:1024
    s_add_u32 m0, m0, 2048
    v_add_u32 v7, 2048, v7
    global_load_lds_dwordx4 v7, s[10:11] offset:0
    global_load_lds_dwordx4 v7, s[10:11] offset:1024
    s_add_u32 m0, m0, 2048
    v_add_u32 v7, 2048, v7
    global_load_lds_dwordx4 v7, s[10:11] offset:0
    global_load_lds_dwordx4 v7, s[10:11] offset:1024
    s_add_u32 m0, m0, 2048
    v_add_u32 v7, 2048, v7
    global_load_lds_dwordx4 v7, s[10:11] offset:0
    global_load_lds_dwordx4 v7, s[10:11] offset:1024
    s_add_u32 m0, m0, 2048
    v_add_u32 v7, 2048, v7
    global_load_lds_dwordx4 v7, s[10:11] offset:0
    global_load_lds_dwordx4 v7, s[10:11] offset:1024
    s_add_u32 m0, m0, 2048
    v_add_u32 v7, 2048, v7
    global_load_lds_dwordx4 v7, s[10:11] offset:0
    global_load_lds_dwordx4 v7, s[10:11] offset:1024
    s_add_u32 m0, m0, 2048
    v_add_u32 v7, 2048, v7
    global_load_lds_dwordx4 v7, s[10:11] offset:0
    global_load_lds_dwordx4 v7, s[10:11] offset:1024
    s_add_u32 m0, m0, 2048
    v_add_u32 v7, 2048, v7
    global_load_lds_dwordx4 v7, s[10:11] offset:0
    global_load_lds_dwordx4 v7, s[10:11] offset:1024
    s_add_u32 m0, m0, 2048
    v_add_u32 v7, 2048, v7
    global_load_lds_dwordx4 v7, s[10:11] offset:0
    global_load_lds_dwordx4 v7, s[10:11] offset:1024
    s_add_u32 m0, m0, 2048
    v_add_u32 v7, 2048, v7
    global_load_lds_dwordx4 v7, s[10:11] offset:0
    global_load_lds_dwordx4 v7, s[10:11] offset:1024
    s_add_u32 m0, m0, 2048
    v_add_u32 v7, 2048, v7
    global_load_lds_dwordx4 v7, s[10:11] offset:0
    global_load_lds_dwordx4 v7, s[10:11] offset:1024
    s_add_u32 m0, m0, 2048
    v_add_u32 v7, 2048, v7
    s_waitcnt vmcnt(0)
    s_barrier
    s_branch mn_start
ka_cell:
    s_lshl_b32 s30, s28, 6
    s_add_u32 s30, s30, 8388608
    v_lshlrev_b32 v3, 3, v1
    v_mov_b32 v4, 0
    v_mov_b32 v5, 0
    ds_write_b64 v3, v[4:5]
    v_lshlrev_b32 v26, 4, v1
    v_lshrrev_b32 v6, 2, v1
    v_lshlrev_b32 v6, 13, v6
    v_and_or_b32 v6, v26, 0x30, v6
    v_lshlrev_b32 v27, 8, v1
    s_waitcnt lgkmcnt(0)
    s_barrier
    s_barrier
    ds_read_b128 v[12:15], v26 offset:1024
    s_waitcnt lgkmcnt(0)
    v_add_u32 v17, v12, v13
    v_add_u32 v18, v17, v14
    v_add_u32 v16, v18, v15
    v_mov_b32 v19, v16
    v_lshlrev_b32 v20, 16, v12
    v_add_u32_dpp v16, v16, v16 row_shr:1 row_mask:0xf bank_mask:0xf
    v_lshl_add_u32 v21, v13, 16, v12
    s_nop 0
    v_add_u32_dpp v16, v16, v16 row_shr:2 row_mask:0xf bank_mask:0xf
    v_lshl_add_u32 v22, v14, 16, v17
    s_nop 0
    v_add_u32_dpp v16, v16, v16 row_shr:4 row_mask:0xf bank_mask:0xf
    v_lshl_add_u32 v23, v15, 16, v18
    s_nop 0
    v_add_u32_dpp v16, v16, v16 row_shr:8 row_mask:0xf bank_mask:0xf
    s_nop 1
    v_add_u32_dpp v16, v16, v16 row_bcast:15 row_mask:0xa bank_mask:0xf
    s_nop 1
    v_add_u32_dpp v16, v16, v16 row_bcast:31 row_mask:0xc bank_mask:0xf
    v_sub_u32 v16, v16, v19
    v_add_u32 v20, v20, v16
    ds_write_b32 v27, v20 offset:12348
    v_add_u32 v21, v21, v16
    ds_write_b32 v27, v21 offset:12412
    v_add_u32 v22, v22, v16
    ds_write_b32 v27, v22 offset:12476
    v_add_u32 v23, v23, v16
    ds_write_b32 v27, v23 offset:12540
    ds_read_b128 v[28:31], v26 offset:12288
    ds_read_b128 v[32:35], v26 offset:13312
    ds_read_b128 v[36:39], v26 offset:14336
    ds_read_b128 v[40:43], v26 offset:15360
    ds_read_b128 v[44:47], v26 offset:16384
    ds_read_b128 v[48:51], v26 offset:17408
    ds_read_b128 v[52:55], v26 offset:18432
    ds_read_b128 v[56:59], v26 offset:19456
    s_waitcnt lgkmcnt(7)
    buffer_store_dwordx4 v[28:31], v6, s[20:23], s30 offen sc1
    ds_read_b128 v[60:63], v26 offset:20480
    s_add_u32 s30, s30, 131072
    s_waitcnt lgkmcnt(7)
    buffer_store_dwordx4 v[32:35], v6, s[20:23], s30 offen sc1
    ds_read_b128 v[64:67], v26 offset:21504
    s_add_u32 s30, s30, 131072
    s_waitcnt lgkmcnt(7)
    buffer_store_dwordx4 v[36:39], v6, s[20:23], s30 offen sc1
    ds_read_b128 v[68:71], v26 offset:22528
    s_add_u32 s30, s30, 131072
    s_waitcnt lgkmcnt(7)
    buffer_store_dwordx4 v[40:43], v6, s[20:23], s30 offen sc1
    ds_read_b128 v[72:75], v26 offset:23552
    s_add_u32 s30, s30, 131072
    s_waitcnt lgkmcnt(7)
    buffer_store_dwordx4 v[44:47], v6, s[20:23], s30 offen sc1
    ds_read_b128 v[76:79], v26 offset:24576
    s_add_u32 s30, s30, 131072
    s_waitcnt lgkmcnt(7)
    buffer_store_dwordx4 v[48:51], v6, s[20:23], s30 offen sc1
    ds_read_b128 v[80:83], v26 offset:25600
    s_add_u32 s30, s30, 131072
    s_waitcnt lgkmcnt(7)
    buffer_store_dwordx4 v[52:55], v6, s[20:23], s30 offen sc1
    ds_read_b128 v[28:31], v26 offset:26624
    s_add_u32 s30, s30, 131072
    s_waitcnt lgkmcnt(7)
    buffer_store_dwordx4 v[56:59], v6, s[20:23], s30 offen sc1
    ds_read_b128 v[32:35], v26 offset:27648
    s_add_u32 s30, s30, 131072
    s_waitcnt lgkmcnt(7)
    buffer_store_dwordx4 v[60:63], v6, s[20:23], s30 offen sc1
    s_add_u32 s30, s30, 131072
    s_waitcnt lgkmcnt(6)
    buffer_store_dwordx4 v[64:67], v6, s[20:23], s30 offen sc1
    s_add_u32 s30, s30, 131072
    s_waitcnt lgkmcnt(5)
    buffer_store_dwordx4 v[68:71], v6, s[20:23], s30 offen sc1
    s_add_u32 s30, s30, 131072
    s_waitcnt lgkmcnt(4)
    buffer_store_dwordx4 v[72:75], v6, s[20:23], s30 offen sc1
    s_add_u32 s30, s30, 131072
    s_waitcnt lgkmcnt(3)
    buffer_store_dwordx4 v[76:79], v6, s[20:23], s30 offen sc1
    s_add_u32 s30, s30, 131072
    s_waitcnt lgkmcnt(2)
    buffer_store_dwordx4 v[80:83], v6, s[20:23], s30 offen sc1
    s_add_u32 s30, s30, 131072
    s_waitcnt lgkmcnt(1)
    buffer_store_dwordx4 v[28:31], v6, s[20:23], s30 offen sc1
    s_add_u32 s30, s30, 131072
    s_waitcnt lgkmcnt(0)
    buffer_store_dwordx4 v[32:35], v6, s[20:23], s30 offen sc1
    s_barrier
    s_waitcnt vmcnt(0)
    s_mov_b64 exec, 1
    v_mov_b32 v2, 0
    v_mov_b32 v3, 1
    ds_add_rtn_u32 v4, v2, v3 offset:448
    s_waitcnt lgkmcnt(0)
    v_readfirstlane_b32 s33, v4
    s_cmp_lg_u32 s33, 10
    s_cbranch_scc1 ka_arc
    s_and_b32 s34, s2, 1
    s_lshl_b32 s35, s34, 7
    s_mov_b32 s33, 1
    s_atomic_add s33, s[12:13], s35 glc
    s_lshl_b32 s34, s34, 3
    s_lshr_b32 s34, 15678, s34
    s_and_b32 s34, s34, 0xff
    s_waitcnt lgkmcnt(0)
    s_cmp_eq_u32 s33, s34
    s_cbranch_scc1 ka_bcast
ka_arc:
    s_mov_b64 exec, -1
    s_branch mn_start
ka_pf:
    s_sub_u32 s34, s2, 127
    s_mul_i32 s34, s34, 40960
    s_sub_u32 s34, s34, 40960
    v_lshl_add_u32 v44, v0, 7, s34
    v_min_u32 v44, 5119996, v44
    s_waitcnt lgkmcnt(0)
    s_cmp_ge_u32 s18, 5
    s_cbranch_scc1 ka_nohlp
    global_load_dword v45, v44, s[10:11]
ka_nohlp:
    s_and_b32 s34, s2, 7
    s_mul_i32 s34, s34, 917504
    s_add_u32 s24, s16, s34
    s_addc_u32 s25, s17, 0
    s_and_b32 s25, s25, 0xffff
    s_mov_b32 s26, 917504
    s_mov_b32 s27, 0x20000
    s_bfe_u32 s30, s2, 0x40003
    v_lshlrev_b32 v40, 7, v0
    s_mul_i32 s30, s30, 57344
ka_pf1:
    s_cmp_ge_u32 s18, 7
    s_cbranch_scc1 ka_pfe
    s_waitcnt vmcnt(0)
    buffer_load_dword v42, v40, s[24:27], s30 offen
    s_cmp_ge_u32 s18, 0
    s_cbranch_scc1 ka_pfe
    s_add_u32 s30, s30, 81920
    buffer_load_dword v43, v40, s[24:27], s30 offen
ka_pfe:
    s_barrier
    s_branch mn_start
ka_bcast:
    s_mov_b64 exec, -1
    s_mov_b32 s33, 1
    s_add_u32 s34, s14, 11730944
    s_addc_u32 s35, s15, 0
    s_atomic_add s33, s[34:35], 0
    s_atomic_add s33, s[34:35], 128
    s_atomic_add s33, s[34:35], 256
    s_atomic_add s33, s[34:35], 384
    s_atomic_add s33, s[34:35], 512
    s_atomic_add s33, s[34:35], 640
    s_atomic_add s33, s[34:35], 768
    s_atomic_add s33, s[34:35], 896
    s_branch mn_start
ka_end:
    s_endpgm
mn_start:
    s_waitcnt vmcnt(0) lgkmcnt(0)
mn_start2:
    s_cmp_ge_u32 s2, 256
    s_cbranch_scc1 mn_end
    s_load_dwordx2 s[54:55], s[0:1], 80
    s_load_dwordx2 s[50:51], s[0:1], 0
    s_load_dwordx2 s[60:61], s[0:1], 72
    v_lshrrev_b32 v56, 6, v0
    s_and_b32 s48, s2, 7
    v_readfirstlane_b32 s16, v56
    s_lshr_b32 s47, s2, 3
    s_lshl_b32 s22, s48, 5
    s_add_u32 s22, s22, s47
    s_lshl_b32 s22, s22, 13
    s_add_u32 s22, s22, 8388608
    s_mov_b32 s10, 12582912
    s_mov_b32 s11, 0x20000
    s_and_b32 s17, s16, 3
    s_movk_i32 s20, 20
    s_mov_b32 s24, 0
    s_cmp_ge_u32 s16, 8
    s_cbranch_scc1 gm_main
    v_lshrrev_b32 v56, 6, v0
    v_lshlrev_b32 v55, 1, v0
    v_and_b32 v55, 0x78, v55
    v_or_b32 v55, v55, v56
    v_cmp_gt_u32 vcc, 125, v55
    v_mul_u32_u24 v46, 5120, v55
    v_add_u32 v46, 7340032, v46
    v_bfrev_b32 v56, 2
    v_lshlrev_b32 v44, 4, v0
    v_cndmask_b32 v44, v56, v44, vcc
    v_and_b32 v51, 63, v0
    s_lshl_b32 s62, s17, 11
    s_add_u32 s62, s62, 11665408
    s_mov_b32 s63, 11673600
    v_lshlrev_b32 v52, 4, v51
    s_waitcnt lgkmcnt(0)
    s_mov_b32 s8, s54
    s_and_b32 s9, s55, 0xffff
    v_mov_b32 v24, 0
    s_lshr_b32 s18, s16, 2
    s_lshl_b32 s53, s17, 7
    s_add_u32 s4, s50, s53
    s_addc_u32 s5, s51, 0
    s_and_b32 s5, s5, 0xffff
    s_or_b32 s5, s5, 0x08000000
    s_movk_i32 s6, 10000
    s_mov_b32 s7, 0x20000
    s_mul_i32 s40, s16, 15360
    s_add_u32 s40, s40, 40960
    v_lshl_add_u32 v87, v51, 3, s40
    s_add_u32 s40, s40, 9216
    s_add_u32 s41, s40, 1024
    s_add_u32 s42, s40, 2048
    s_add_u32 s43, s40, 3072
    s_add_u32 s44, s40, 4096
    s_add_u32 s45, s40, 5120
    v_and_b32 v55, 3, v0
    v_bfe_u32 v56, v0, 2, 2
    v_bfe_u32 v57, v0, 4, 1
    v_bfe_u32 v53, v0, 5, 1
    v_lshlrev_b32 v1, 3, v55
    v_lshl_add_u32 v1, v57, 5, v1
    v_lshl_add_u32 v1, v56, 6, v1
    v_lshl_add_u32 v1, v53, 8, v1
    v_add_u32 v1, s40, v1
    v_lshlrev_b32 v5, 4, v55
    v_lshl_add_u32 v5, v57, 6, v5
    v_lshl_add_u32 v5, v56, 9, v5
    v_mov_b32 v7, v5
    v_bfe_u32 v55, v0, 2, 1
    v_lshlrev_b32 v86, 4, v53
    v_lshl_or_b32 v86, v55, 18, v86
    v_mov_b32 v48, 1
    v_lshlrev_b32 v47, 2, v51
    v_bfe_u32 v2, v0, 5, 1
    v_bfe_u32 v3, v0, 3, 2
    v_and_b32 v35, 3, v0
    v_lshl_add_u32 v3, v3, 2, v35
    v_mul_u32_u24 v49, 20, v2
    v_lshrrev_b32 v18, 2, v51
    v_lshl_add_u32 v18, v35, 4, v18
    v_mov_b32 v50, 0x3fff
    s_lshl_b32 s37, s16, 2
    v_mov_b32 v59, s37
    s_sub_u32 s36, s16, 1
    v_mov_b64 v[88:89], 0
    v_mov_b64 v[90:91], 0
    v_mov_b64 v[92:93], 0
    v_mov_b64 v[94:95], 0
    v_mov_b64 v[96:97], 0
    v_mov_b64 v[98:99], 0
    v_mov_b64 v[100:101], 0
    v_mov_b64 v[102:103], 0
    v_mov_b64 v[104:105], 0
    v_mov_b64 v[106:107], 0
    v_mov_b64 v[108:109], 0
    v_mov_b64 v[110:111], 0
    v_mov_b64 v[112:113], 0
    v_mov_b64 v[114:115], 0
    v_mov_b64 v[116:117], 0
    v_mov_b64 v[118:119], 0
    v_mov_b64 v[120:121], 0
    v_mov_b64 v[122:123], 0
    v_mov_b64 v[124:125], 0
    v_mov_b64 v[126:127], 0
    v_mov_b64 v[128:129], 0
    v_mov_b64 v[130:131], 0
    v_mov_b64 v[132:133], 0
    v_mov_b64 v[134:135], 0
    v_mov_b64 v[136:137], 0
    v_mov_b64 v[138:139], 0
    v_mov_b64 v[140:141], 0
    v_mov_b64 v[142:143], 0
    v_mov_b64 v[144:145], 0
    v_mov_b64 v[146:147], 0
    v_mov_b64 v[148:149], 0
    v_mov_b64 v[150:151], 0
    v_mov_b64 v[152:153], 0
    v_mov_b64 v[154:155], 0
    v_mov_b64 v[156:157], 0
    v_mov_b64 v[158:159], 0
    v_mov_b64 v[160:161], 0
    v_mov_b64 v[162:163], 0
    v_mov_b64 v[164:165], 0
    v_mov_b64 v[166:167], 0
    v_bfe_u32 v8, v0, 2, 2
    v_bfe_u32 v10, v0, 5, 1
    v_lshlrev_b32 v9, 3, v8
    v_add_u32 v9, 156672, v9
    v_lshl_add_u32 v8, v10, 3, v8
    v_lshlrev_b32 v8, 9, v8
    v_bfe_u32 v10, v0, 4, 1
    v_lshl_add_u32 v8, v10, 5, v8
    v_lshl_add_u32 v8, v35, 3, v8
    v_lshl_add_u32 v8, s17, 7, v8
    v_add_u32 v8, 148480, v8
    s_barrier
    buffer_load_dwordx4 v[20:23], v44, s[8:11], s22 offen sc1
    s_barrier
    ds_read_b64_tr_b16 v[76:77], v9
    ds_read_b64_tr_b16 v[78:79], v9 offset:32
    ds_read_b64_tr_b16 v[80:81], v9 offset:64
    ds_read_b64_tr_b16 v[82:83], v9 offset:96
    ds_read_b64_tr_b16 v[68:69], v8
    ds_read_b64_tr_b16 v[70:71], v8 offset:2048
    ds_read_b64_tr_b16 v[72:73], v8 offset:64
    ds_read_b64_tr_b16 v[74:75], v8 offset:2112
    s_mov_b32 s52, 0x100000
    s_waitcnt vmcnt(0)
    v_mov_b32_dpp v58, v23 quad_perm:[3,3,3,3] row_mask:0xf bank_mask:0xf
    v_cmp_le_u32 vcc, s52, v58
    s_cbranch_vccnz mn_w5
mn_count:
    v_cmpx_gt_i32 vcc, 0, v20
    s_cbranch_execz mn_cn_done
    v_lshrrev_b32 v25, 23, v20
    v_and_b32 v25, 0xfc, v25
    ds_add_rtn_u32 v30, v25, v48
    v_cmpx_gt_i32 vcc, 0, v21
    s_cbranch_execz mn_cn_done
    v_lshrrev_b32 v26, 23, v21
    v_and_b32 v26, 0xfc, v26
    ds_add_rtn_u32 v31, v26, v48
    v_cmpx_gt_i32 vcc, 0, v22
    s_cbranch_execz mn_cn_done
    v_lshrrev_b32 v27, 23, v22
    v_and_b32 v27, 0xfc, v27
    ds_add_rtn_u32 v32, v27, v48
    v_cmpx_gt_i32 vcc, 0, v23
    s_cbranch_execz mn_cn_done
    v_lshrrev_b32 v28, 23, v23
    v_and_b32 v28, 0xfc, v28
    ds_add_rtn_u32 v33, v28, v48
    v_cmpx_gt_i32 vcc, 0, v24
    s_cbranch_execz mn_cn_done
    v_lshrrev_b32 v29, 23, v24
    v_and_b32 v29, 0xfc, v29
    ds_add_rtn_u32 v34, v29, v48
mn_cn_done:
    s_mov_b64 exec, -1
    v_lshrrev_b32 v42, 16, v58
    v_subrev_u32 v42, s24, v42
    v_med3_i32 v42, v42, 0, s20
    v_mov_b32 v43, v42
    v_mov_b32 v52, 0
    s_lshl_b32 s52, s18, 5
    v_add_u32_dpp v43, v43, v43 row_shr:4 row_mask:0xf bank_mask:0xf
    s_add_u32 s53, s52, 31
    s_movk_i32 s48, 0x3fff
    v_add_u32_dpp v43, v43, v43 row_shr:8 row_mask:0xf bank_mask:0xf
    s_nop 0
    s_nop 0
    v_add_u32_dpp v43, v43, v43 row_bcast:15 row_mask:0xa bank_mask:0xf
    s_nop 0
    s_nop 0
    v_add_u32_dpp v43, v43, v43 row_bcast:31 row_mask:0xc bank_mask:0xf
    s_brev_b64 exec, 1
    ds_write_b32 v59, v43 offset:384
    s_mov_b64 exec, -1
    v_sub_u32 v41, v43, v42
    s_waitcnt lgkmcnt(0)
    s_barrier
    ds_read_b32 v55, v47 offset:384
    ds_read_b32 v53, v47 offset:0
    ds_read_b32 v52, v52 offset:272
    s_waitcnt lgkmcnt(2)
    v_add_u32_dpp v55, v55, v55 row_shr:1 row_mask:0xf bank_mask:0xf
    s_waitcnt lgkmcnt(1)
    v_mov_b32 v54, v53
    v_add_u32_dpp v55, v55, v55 row_shr:2 row_mask:0xf bank_mask:0xf
    v_sub_u32 v53, v49, v53
    v_add_u32 v41, v41, v35
    v_add_u32_dpp v55, v55, v55 row_shr:4 row_mask:0xf bank_mask:0xf
    s_cmp_eq_u32 s16, 0
    v_readlane_b32 s49, v55, s36
    s_cmov_b32 s49, 0
    s_add_u32 s49, s49, 72
    v_add_u32_dpp v54, v54, v54 row_shr:1 row_mask:0xf bank_mask:0xf
    v_add_u32 v41, s49, v41
    v_lshlrev_b32 v41, 16, v41
    v_add_u32_dpp v54, v54, v54 row_shr:2 row_mask:0xf bank_mask:0xf
    v_and_or_b32 v36, v20, s48, v41
    v_add_u32 v41, 262144, v41
    v_add_u32_dpp v54, v54, v54 row_shr:4 row_mask:0xf bank_mask:0xf
    v_and_or_b32 v37, v21, s48, v41
    v_add_u32 v41, 262144, v41
    v_add_u32_dpp v54, v54, v54 row_shr:8 row_mask:0xf bank_mask:0xf
    v_and_or_b32 v38, v22, s48, v41
    v_add_u32 v41, 262144, v41
    v_add_u32_dpp v54, v54, v54 row_bcast:15 row_mask:0xa bank_mask:0xf
    v_and_or_b32 v39, v23, s48, v41
    v_add_u32 v41, 262144, v41
    v_add_u32_dpp v54, v54, v54 row_bcast:31 row_mask:0xc bank_mask:0xf
    v_add_u32 v53, v53, v54
    v_add_u32 v54, v54, v49
    ds_bpermute_b32 v25, v25, v53
    ds_bpermute_b32 v26, v26, v53
    ds_bpermute_b32 v27, v27, v53
    ds_bpermute_b32 v28, v28, v53
    ds_bpermute_b32 v29, v29, v53
    v_and_or_b32 v40, v24, s48, v41
    v_bfe_u32 v56, v20, 14, 5
    v_lshl_or_b32 v36, v56, 26, v36
    v_bfe_u32 v56, v21, 14, 5
    v_lshl_or_b32 v37, v56, 26, v37
    v_bfe_u32 v56, v22, 14, 5
    v_lshl_or_b32 v38, v56, 26, v38
    v_bfe_u32 v56, v23, 14, 5
    v_lshl_or_b32 v39, v56, 26, v39
    v_bfe_u32 v56, v24, 14, 5
    v_lshl_or_b32 v40, v56, 26, v40
    v_readlane_b32 s23, v54, 63
    v_readlane_b32 s33, v54, s53
    v_readlane_b32 s32, v53, s52
    s_cmp_gt_u32 s23, 793
    s_cbranch_scc1 mn_ovf
    v_add_lshl_u32 v55, s33, v51, 2
    s_mov_b32 exec_lo, 1048575
    s_mov_b32 exec_hi, 0
    ds_write_b32 v55, v50 offset:512
    s_mov_b64 exec, -1
    v_add_lshl_u32 v2, s32, v2, 2
    v_add_lshl_u32 v3, s32, v3, 2
    v_add_lshl_u32 v18, s32, v18, 2
    s_waitcnt lgkmcnt(1)
    v_readfirstlane_b32 s21, v52
    v_cmpx_gt_i32 vcc, 0, v20
    s_cbranch_execz mn_w2_done
    v_add_lshl_u32 v25, v25, v30, 2
    ds_write_b32 v25, v36 offset:512
    v_cmpx_gt_i32 vcc, 0, v21
    s_cbranch_execz mn_w2_done
    v_add_lshl_u32 v26, v26, v31, 2
    ds_write_b32 v26, v37 offset:512
    v_cmpx_gt_i32 vcc, 0, v22
    s_cbranch_execz mn_w2_done
    v_add_lshl_u32 v27, v27, v32, 2
    ds_write_b32 v27, v38 offset:512
    v_cmpx_gt_i32 vcc, 0, v23
    s_cbranch_execz mn_w2_done
    v_add_lshl_u32 v28, v28, v33, 2
    ds_write_b32 v28, v39 offset:512
    v_cmpx_gt_i32 vcc, 0, v24
    s_cbranch_execz mn_w2_done
    v_add_lshl_u32 v29, v29, v34, 2
    ds_write_b32 v29, v40 offset:512
mn_w2_done:
    s_mov_b64 exec, -1
    s_mov_b32 m0, s40
    s_sub_u32 s32, s32, 3
    s_sub_u32 s59, s33, s32
    s_lshr_b32 s59, s59, 2
    s_waitcnt lgkmcnt(0)
    s_barrier
    ds_read_u16 v4, v2 offset:512
    ds_read_u16 v6, v2 offset:520
    ds_read_u16 v8, v18 offset:514
    ds_read_u16 v84, v3 offset:514
    ds_read_u16 v22, v2 offset:528
    ds_read_u16 v23, v2 offset:536
    ds_read_u16 v24, v2 offset:544
    ds_read_u16 v25, v2 offset:552
    ds_read_u16 v26, v2 offset:560
    ds_read_u16 v27, v2 offset:568
    s_sub_u32 s53, s53, 4
    v_readlane_b32 s84, v54, s53
    s_add_u32 s53, s53, 1
    v_readlane_b32 s85, v54, s53
    s_add_u32 s53, s53, 1
    v_readlane_b32 s86, v54, s53
    s_add_u32 s53, s53, 1
    v_readlane_b32 s87, v54, s53
    s_waitcnt lgkmcnt(8)
    buffer_load_dwordx4 v[4:5], s[4:7], 0 idxen offen lds
    s_mov_b32 m0, s41
    s_waitcnt lgkmcnt(6)
    buffer_load_dwordx4 v[6:7], s[4:7], 0 idxen offen lds
    v_lshrrev_b32 v11, 8, v8
    v_and_b32 v8, 0x3ff, v8
    v_mul_u32_u24 v8, 48, v8
    v_and_b32 v84, 0x3ff, v84
    v_mad_u32_u24 v84, v84, 48, v86
    v_xor_b32 v85, 0x40000, v84
    s_waitcnt lgkmcnt(0)
    s_mov_b32 m0, s42
    v_mov_b32 v4, v22
    buffer_load_dwordx4 v[4:5], s[4:7], 0 idxen offen lds
    s_mov_b32 m0, s43
    v_mov_b32 v4, v23
    buffer_load_dwordx4 v[4:5], s[4:7], 0 idxen offen lds
    s_setprio 2
    s_waitcnt vmcnt(4) lgkmcnt(0)
    s_barrier
    ds_read_b64 v[8:9], v8 offset:352
    ds_read_b128 v[60:63], v84 offset:320
    ds_read_b128 v[64:67], v85 offset:320
    s_mov_b32 m0, s44
    v_mov_b32 v4, v24
    buffer_load_dwordx4 v[4:5], s[4:7], 0 idxen offen lds
    s_mov_b32 m0, s45
    v_mov_b32 v4, v25
    buffer_load_dwordx4 v[4:5], s[4:7], 0 idxen offen lds
    v_mov_b32 v4, v26
    v_mov_b32 v6, v27
    s_waitcnt vmcnt(4)
    ds_read_b64_tr_b16 v[20:21], v1 offset:0
    ds_read_b64_tr_b16 v[22:23], v1 offset:512
    ds_read_b64_tr_b16 v[24:25], v1 offset:1024
    ds_read_b64_tr_b16 v[26:27], v1 offset:1536
    s_waitcnt lgkmcnt(6)
    v_mfma_f32_4x4x4_16b_bf16 v[28:31], v[8:9], v[76:77], 0
    v_mfma_f32_4x4x4_16b_bf16 v[32:35], v[8:9], v[78:79], 0
    v_mfma_f32_4x4x4_16b_bf16 v[36:39], v[8:9], v[80:81], 0
    v_mfma_f32_4x4x4_16b_bf16 v[40:43], v[8:9], v[82:83], 0
    v_min_u32 v0, 1, v51
    v_lshlrev_b32 v0, 18, v0
    v_lshl_add_u32 v0, s17, 2, v0
    s_lshl_b32 s52, s18, 1
    s_sub_i32 s52, 1, s52
    s_mul_i32 s53, s52, s59
    s_add_i32 s53, s53, 0
    v_mov_b32 v19, s53
    v_and_b32 v11, 0x7c, v11
    v_or_b32 v11, 0xc000, v11
    v_lshlrev_b32 v10, 16, v11
    s_waitcnt lgkmcnt(4)
    v_mfma_f32_32x32x16_bf16 v[44:59], v[60:63], v[68:71], 0
    v_mfma_f32_32x32x16_bf16 v[44:59], v[64:67], v[72:75], v[44:59]
    s_mov_b32 m0, s40
    s_waitcnt lgkmcnt(0)
    buffer_load_dwordx4 v[4:5], s[4:7], 0 idxen offen lds
    s_mov_b32 m0, s41
    ds_add_u32 v0, v19 offset:288
    buffer_load_dwordx4 v[6:7], s[4:7], 0 idxen offen lds
    v_or_b32_dpp v19, v10, v11 row_shl:4 row_mask:0xf bank_mask:0xf bound_ctrl:0
    v_cvt_pk_bf16_f32 v12, v28, v32
    v_cvt_pk_bf16_f32 v14, v29, v33
    v_cvt_pk_bf16_f32 v16, v30, v34
    v_cvt_pk_bf16_f32 v13, v36, v40
    v_cvt_pk_bf16_f32 v15, v37, v41
    v_cvt_pk_bf16_f32 v17, v38, v42
    s_sub_u32 s84, s84, s32
    s_lshr_b32 s84, s84, 2
    s_sub_u32 s85, s85, s32
    s_lshr_b32 s85, s85, 2
    s_sub_u32 s86, s86, s32
    s_lshr_b32 s86, s86, 2
    s_sub_u32 s87, s87, s32
    s_lshr_b32 s87, s87, 2
    s_sub_u32 s88, s59, s87
    s_sub_u32 s87, s87, s86
    s_sub_u32 s86, s86, s85
    s_sub_u32 s85, s85, s84
    s_cmp_lg_u32 s21, 0
    s_cselect_b32 s19, s59, s84
    s_mov_b32 s58, 0
    s_mov_b32 s35, 0
    s_mov_b64 s[46:47], -1
    s_sub_i32 s34, s59, 4
    s_max_i32 s34, s34, 0
    s_mul_i32 s30, s52, -4
    s_lshl_b32 s26, s18, 31
    s_set_gpr_idx_on s40, gpr_idx(SRC2,DST)
    s_sub_u32 s19, s19, 1
    s_cbranch_scc1 mn_st12
mn_st12_back:
mn_loop:
    v_mfma_f32_4x4x4_16b_bf16 v[28:31], v[12:13], v[20:21], 0 cbsz:4 abid:0
    v_mfma_f32_4x4x4_16b_bf16 v[32:35], v[12:13], v[22:23], 0 cbsz:4 abid:1
    v_mfma_f32_4x4x4_16b_bf16 v[36:39], v[12:13], v[24:25], 0 cbsz:4 abid:2
    v_mfma_f32_4x4x4_16b_bf16 v[40:43], v[12:13], v[26:27], 0 cbsz:4 abid:3
    ds_read_u16 v4, v2 offset:576
    ds_read_u16 v6, v2 offset:584
    v_readlane_b32 s28, v19, 0
    v_readlane_b32 s29, v19, 8
    s_waitcnt vmcnt(5)
    ds_read_b64_tr_b16 v[20:21], v1 offset:2048
    ds_read_b64_tr_b16 v[22:23], v1 offset:2560
    s_waitcnt vmcnt(4)
    ds_read_b64_tr_b16 v[24:25], v1 offset:3072
    ds_read_b64_tr_b16 v[26:27], v1 offset:3584
    s_sub_u32 s34, s34, 1
    s_cmov_b32 s35, 0x30000
    s_mov_b32 m0, s28
    v_fmac_f32 v88, v28, v44
    v_fmac_f32 v89, v29, v44
    v_fmac_f32 v90, v30, v44
    v_fmac_f32 v91, v31, v44
    s_lshr_b32 m0, s28, 16
    v_fmac_f32 v88, v32, v45
    v_fmac_f32 v89, v33, v45
    v_fmac_f32 v90, v34, v45
    v_fmac_f32 v91, v35, v45
    s_mov_b32 m0, s29
    v_fmac_f32 v88, v36, v46
    v_fmac_f32 v89, v37, v46
    v_fmac_f32 v90, v38, v46
    v_fmac_f32 v91, v39, v46
    s_lshr_b32 m0, s29, 16
    v_fmac_f32 v88, v40, v47
    v_fmac_f32 v89, v41, v47
    v_fmac_f32 v90, v42, v47
    v_fmac_f32 v91, v43, v47
    s_or_b32 m0, s42, s35
    s_waitcnt lgkmcnt(2)
    buffer_load_dwordx4 v[4:5], s[4:7], 0 idxen offen lds
    s_or_b32 m0, s43, s35
    s_waitcnt lgkmcnt(0)
    buffer_load_dwordx4 v[6:7], s[4:7], 0 idxen offen lds
    s_sub_u32 s19, s19, 1
    s_cbranch_scc1 mn_st0
mn_st0_back:
    v_mfma_f32_4x4x4_16b_bf16 v[28:31], v[12:13], v[20:21], 0 cbsz:4 abid:4
    v_mfma_f32_4x4x4_16b_bf16 v[32:35], v[12:13], v[22:23], 0 cbsz:4 abid:5
    v_mfma_f32_4x4x4_16b_bf16 v[36:39], v[12:13], v[24:25], 0 cbsz:4 abid:6
    v_mfma_f32_4x4x4_16b_bf16 v[40:43], v[12:13], v[26:27], 0 cbsz:4 abid:7
    ds_read_u16 v4, v2 offset:592
    ds_read_u16 v6, v2 offset:600
    v_readlane_b32 s28, v19, 16
    v_readlane_b32 s29, v19, 24
    ds_read_u16 v84, v3 offset:578
    s_waitcnt vmcnt(5)
    ds_read_b64_tr_b16 v[20:21], v1 offset:4096
    ds_read_b64_tr_b16 v[22:23], v1 offset:4608
    s_waitcnt vmcnt(4)
    ds_read_b64_tr_b16 v[24:25], v1 offset:5120
    ds_read_b64_tr_b16 v[26:27], v1 offset:5632
    s_sub_u32 s34, s34, 1
    s_cmov_b32 s35, 0x30000
    s_mov_b32 m0, s28
    v_fmac_f32 v88, v28, v48
    v_fmac_f32 v89, v29, v48
    v_fmac_f32 v90, v30, v48
    v_fmac_f32 v91, v31, v48
    s_lshr_b32 m0, s28, 16
    v_fmac_f32 v88, v32, v49
    v_fmac_f32 v89, v33, v49
    v_fmac_f32 v90, v34, v49
    v_fmac_f32 v91, v35, v49
    s_mov_b32 m0, s29
    v_fmac_f32 v88, v36, v50
    v_fmac_f32 v89, v37, v50
    v_fmac_f32 v90, v38, v50
    v_fmac_f32 v91, v39, v50
    s_lshr_b32 m0, s29, 16
    v_fmac_f32 v88, v40, v51
    v_fmac_f32 v89, v41, v51
    v_fmac_f32 v90, v42, v51
    v_fmac_f32 v91, v43, v51
    s_or_b32 m0, s44, s35
    s_waitcnt lgkmcnt(2)
    buffer_load_dwordx4 v[4:5], s[4:7], 0 idxen offen lds
    s_or_b32 m0, s45, s35
    s_waitcnt lgkmcnt(0)
    buffer_load_dwordx4 v[6:7], s[4:7], 0 idxen offen lds
    s_sub_u32 s19, s19, 1
    s_cbranch_scc1 mn_st1
mn_st1_back:
    v_mfma_f32_4x4x4_16b_bf16 v[28:31], v[12:13], v[20:21], 0 cbsz:4 abid:8
    v_mfma_f32_4x4x4_16b_bf16 v[32:35], v[12:13], v[22:23], 0 cbsz:4 abid:9
    v_mfma_f32_4x4x4_16b_bf16 v[36:39], v[12:13], v[24:25], 0 cbsz:4 abid:10
    v_mfma_f32_4x4x4_16b_bf16 v[40:43], v[12:13], v[26:27], 0 cbsz:4 abid:11
    ds_read_u16 v4, v2 offset:608
    ds_read_u16 v6, v2 offset:616
    v_readlane_b32 s28, v19, 32
    v_readlane_b32 s29, v19, 40
    v_and_b32 v84, 0x3ff, v84
    v_mad_u32_u24 v84, v84, 48, v86
    v_xor_b32 v85, 0x40000, v84
    ds_read_b128 v[60:63], v84 offset:320
    ds_read_b128 v[64:67], v85 offset:320
    s_waitcnt vmcnt(5)
    ds_read_b64_tr_b16 v[20:21], v1 offset:0
    ds_read_b64_tr_b16 v[22:23], v1 offset:512
    s_waitcnt vmcnt(4)
    ds_read_b64_tr_b16 v[24:25], v1 offset:1024
    ds_read_b64_tr_b16 v[26:27], v1 offset:1536
    s_sub_u32 s34, s34, 1
    s_cmov_b32 s35, 0x30000
    s_mov_b32 m0, s28
    v_fmac_f32 v88, v28, v52
    v_fmac_f32 v89, v29, v52
    v_fmac_f32 v90, v30, v52
    v_fmac_f32 v91, v31, v52
    s_lshr_b32 m0, s28, 16
    v_fmac_f32 v88, v32, v53
    v_fmac_f32 v89, v33, v53
    v_fmac_f32 v90, v34, v53
    v_fmac_f32 v91, v35, v53
    s_mov_b32 m0, s29
    v_fmac_f32 v88, v36, v54
    v_fmac_f32 v89, v37, v54
    v_fmac_f32 v90, v38, v54
    v_fmac_f32 v91, v39, v54
    s_lshr_b32 m0, s29, 16
    v_fmac_f32 v88, v40, v55
    v_fmac_f32 v89, v41, v55
    v_fmac_f32 v90, v42, v55
    v_fmac_f32 v91, v43, v55
    s_or_b32 m0, s40, s35
    s_waitcnt lgkmcnt(2)
    buffer_load_dwordx4 v[4:5], s[4:7], 0 idxen offen lds
    s_or_b32 m0, s41, s35
    s_waitcnt lgkmcnt(0)
    buffer_load_dwordx4 v[6:7], s[4:7], 0 idxen offen lds
    s_sub_u32 s19, s19, 1
    s_cbranch_scc1 mn_st2
mn_st2_back:
    v_mfma_f32_4x4x4_16b_bf16 v[28:31], v[12:13], v[20:21], 0 cbsz:4 abid:12
    v_mfma_f32_4x4x4_16b_bf16 v[32:35], v[12:13], v[22:23], 0 cbsz:4 abid:13
    v_mfma_f32_4x4x4_16b_bf16 v[36:39], v[12:13], v[24:25], 0 cbsz:4 abid:14
    v_mfma_f32_4x4x4_16b_bf16 v[40:43], v[12:13], v[26:27], 0 cbsz:4 abid:15
    ds_read_u16 v4, v2 offset:624
    ds_read_u16 v6, v2 offset:632
    v_readlane_b32 s28, v19, 48
    v_readlane_b32 s29, v19, 56
    v_mov_b32 v85, s30
    ds_add_rtn_u32 v85, v0, v85 offset:288
    s_waitcnt vmcnt(5)
    ds_read_b64_tr_b16 v[20:21], v1 offset:2048
    ds_read_b64_tr_b16 v[22:23], v1 offset:2560
    s_waitcnt vmcnt(4)
    ds_read_b64_tr_b16 v[24:25], v1 offset:3072
    ds_read_b64_tr_b16 v[26:27], v1 offset:3584
    s_sub_u32 s34, s34, 1
    s_cmov_b32 s35, 0x30000
    s_mov_b32 m0, s28
    v_fmac_f32 v88, v28, v56
    v_fmac_f32 v89, v29, v56
    v_fmac_f32 v90, v30, v56
    v_fmac_f32 v91, v31, v56
    s_lshr_b32 m0, s28, 16
    v_fmac_f32 v88, v32, v57
    v_fmac_f32 v89, v33, v57
    v_fmac_f32 v90, v34, v57
    v_fmac_f32 v91, v35, v57
    s_mov_b32 m0, s29
    v_fmac_f32 v88, v36, v58
    v_fmac_f32 v89, v37, v58
    v_fmac_f32 v90, v38, v58
    v_fmac_f32 v91, v39, v58
    s_lshr_b32 m0, s29, 16
    v_fmac_f32 v88, v40, v59
    v_fmac_f32 v89, v41, v59
    v_fmac_f32 v90, v42, v59
    v_fmac_f32 v91, v43, v59
    s_or_b32 m0, s42, s35
    v_mfma_f32_32x32x16_bf16 v[44:59], v[60:63], v[68:71], 0
    v_mfma_f32_32x32x16_bf16 v[44:59], v[64:67], v[72:75], v[44:59]
    s_waitcnt lgkmcnt(2)
    buffer_load_dwordx4 v[4:5], s[4:7], 0 idxen offen lds
    s_or_b32 m0, s43, s35
    s_waitcnt lgkmcnt(0)
    buffer_load_dwordx4 v[6:7], s[4:7], 0 idxen offen lds
    v_readfirstlane_b32 s27, v85
    s_setprio 2
    s_xor_b32 s27, s27, s26
    s_cmp_ge_i32 s27, 0
    s_cbranch_scc1 mn_pr3
    s_setprio 1
mn_pr3:
    s_sub_u32 s19, s19, 1
    s_cbranch_scc1 mn_st3
mn_st3_back:
    v_mfma_f32_4x4x4_16b_bf16 v[28:31], v[14:15], v[20:21], 0 cbsz:4 abid:0
    v_mfma_f32_4x4x4_16b_bf16 v[32:35], v[14:15], v[22:23], 0 cbsz:4 abid:1
    v_mfma_f32_4x4x4_16b_bf16 v[36:39], v[14:15], v[24:25], 0 cbsz:4 abid:2
    v_mfma_f32_4x4x4_16b_bf16 v[40:43], v[14:15], v[26:27], 0 cbsz:4 abid:3
    ds_read_u16 v4, v2 offset:640
    ds_read_u16 v6, v2 offset:648
    v_readlane_b32 s28, v19, 1
    v_readlane_b32 s29, v19, 9
    s_waitcnt vmcnt(5)
    ds_read_b64_tr_b16 v[20:21], v1 offset:4096
    ds_read_b64_tr_b16 v[22:23], v1 offset:4608
    s_waitcnt vmcnt(4)
    ds_read_b64_tr_b16 v[24:25], v1 offset:5120
    ds_read_b64_tr_b16 v[26:27], v1 offset:5632
    s_sub_u32 s34, s34, 1
    s_cmov_b32 s35, 0x30000
    s_mov_b32 m0, s28
    v_fmac_f32 v88, v28, v44
    v_fmac_f32 v89, v29, v44
    v_fmac_f32 v90, v30, v44
    v_fmac_f32 v91, v31, v44
    s_lshr_b32 m0, s28, 16
    v_fmac_f32 v88, v32, v45
    v_fmac_f32 v89, v33, v45
    v_fmac_f32 v90, v34, v45
    v_fmac_f32 v91, v35, v45
    s_mov_b32 m0, s29
    v_fmac_f32 v88, v36, v46
    v_fmac_f32 v89, v37, v46
    v_fmac_f32 v90, v38, v46
    v_fmac_f32 v91, v39, v46
    s_lshr_b32 m0, s29, 16
    v_fmac_f32 v88, v40, v47
    v_fmac_f32 v89, v41, v47
    v_fmac_f32 v90, v42, v47
    v_fmac_f32 v91, v43, v47
    s_or_b32 m0, s44, s35
    s_waitcnt lgkmcnt(2)
    buffer_load_dwordx4 v[4:5], s[4:7], 0 idxen offen lds
    s_or_b32 m0, s45, s35
    s_waitcnt lgkmcnt(0)
    buffer_load_dwordx4 v[6:7], s[4:7], 0 idxen offen lds
    s_sub_u32 s19, s19, 1
    s_cbranch_scc1 mn_st4
mn_st4_back:
    v_mfma_f32_4x4x4_16b_bf16 v[28:31], v[14:15], v[20:21], 0 cbsz:4 abid:4
    v_mfma_f32_4x4x4_16b_bf16 v[32:35], v[14:15], v[22:23], 0 cbsz:4 abid:5
    v_mfma_f32_4x4x4_16b_bf16 v[36:39], v[14:15], v[24:25], 0 cbsz:4 abid:6
    v_mfma_f32_4x4x4_16b_bf16 v[40:43], v[14:15], v[26:27], 0 cbsz:4 abid:7
    ds_read_u16 v4, v2 offset:656
    ds_read_u16 v6, v2 offset:664
    v_readlane_b32 s28, v19, 17
    v_readlane_b32 s29, v19, 25
    ds_read_u16 v84, v3 offset:642
    s_waitcnt vmcnt(5)
    ds_read_b64_tr_b16 v[20:21], v1 offset:0
    ds_read_b64_tr_b16 v[22:23], v1 offset:512
    s_waitcnt vmcnt(4)
    ds_read_b64_tr_b16 v[24:25], v1 offset:1024
    ds_read_b64_tr_b16 v[26:27], v1 offset:1536
    s_sub_u32 s34, s34, 1
    s_cmov_b32 s35, 0x30000
    s_mov_b32 m0, s28
    v_fmac_f32 v88, v28, v48
    v_fmac_f32 v89, v29, v48
    v_fmac_f32 v90, v30, v48
    v_fmac_f32 v91, v31, v48
    s_lshr_b32 m0, s28, 16
    v_fmac_f32 v88, v32, v49
    v_fmac_f32 v89, v33, v49
    v_fmac_f32 v90, v34, v49
    v_fmac_f32 v91, v35, v49
    s_mov_b32 m0, s29
    v_fmac_f32 v88, v36, v50
    v_fmac_f32 v89, v37, v50
    v_fmac_f32 v90, v38, v50
    v_fmac_f32 v91, v39, v50
    s_lshr_b32 m0, s29, 16
    v_fmac_f32 v88, v40, v51
    v_fmac_f32 v89, v41, v51
    v_fmac_f32 v90, v42, v51
    v_fmac_f32 v91, v43, v51
    s_or_b32 m0, s40, s35
    s_waitcnt lgkmcnt(2)
    buffer_load_dwordx4 v[4:5], s[4:7], 0 idxen offen lds
    s_or_b32 m0, s41, s35
    s_waitcnt lgkmcnt(0)
    buffer_load_dwordx4 v[6:7], s[4:7], 0 idxen offen lds
    s_sub_u32 s19, s19, 1
    s_cbranch_scc1 mn_st5
mn_st5_back:
    v_mfma_f32_4x4x4_16b_bf16 v[28:31], v[14:15], v[20:21], 0 cbsz:4 abid:8
    v_mfma_f32_4x4x4_16b_bf16 v[32:35], v[14:15], v[22:23], 0 cbsz:4 abid:9
    v_mfma_f32_4x4x4_16b_bf16 v[36:39], v[14:15], v[24:25], 0 cbsz:4 abid:10
    v_mfma_f32_4x4x4_16b_bf16 v[40:43], v[14:15], v[26:27], 0 cbsz:4 abid:11
    ds_read_u16 v4, v2 offset:672
    ds_read_u16 v6, v2 offset:680
    v_readlane_b32 s28, v19, 33
    v_readlane_b32 s29, v19, 41
    v_and_b32 v84, 0x3ff, v84
    v_mad_u32_u24 v84, v84, 48, v86
    v_xor_b32 v85, 0x40000, v84
    ds_read_b128 v[60:63], v84 offset:320
    ds_read_b128 v[64:67], v85 offset:320
    s_waitcnt vmcnt(5)
    ds_read_b64_tr_b16 v[20:21], v1 offset:2048
    ds_read_b64_tr_b16 v[22:23], v1 offset:2560
    s_waitcnt vmcnt(4)
    ds_read_b64_tr_b16 v[24:25], v1 offset:3072
    ds_read_b64_tr_b16 v[26:27], v1 offset:3584
    s_sub_u32 s34, s34, 1
    s_cmov_b32 s35, 0x30000
    s_mov_b32 m0, s28
    v_fmac_f32 v88, v28, v52
    v_fmac_f32 v89, v29, v52
    v_fmac_f32 v90, v30, v52
    v_fmac_f32 v91, v31, v52
    s_lshr_b32 m0, s28, 16
    v_fmac_f32 v88, v32, v53
    v_fmac_f32 v89, v33, v53
    v_fmac_f32 v90, v34, v53
    v_fmac_f32 v91, v35, v53
    s_mov_b32 m0, s29
    v_fmac_f32 v88, v36, v54
    v_fmac_f32 v89, v37, v54
    v_fmac_f32 v90, v38, v54
    v_fmac_f32 v91, v39, v54
    s_lshr_b32 m0, s29, 16
    v_fmac_f32 v88, v40, v55
    v_fmac_f32 v89, v41, v55
    v_fmac_f32 v90, v42, v55
    v_fmac_f32 v91, v43, v55
    s_or_b32 m0, s42, s35
    s_waitcnt lgkmcnt(2)
    buffer_load_dwordx4 v[4:5], s[4:7], 0 idxen offen lds
    s_or_b32 m0, s43, s35
    s_waitcnt lgkmcnt(0)
    buffer_load_dwordx4 v[6:7], s[4:7], 0 idxen offen lds
    s_sub_u32 s19, s19, 1
    s_cbranch_scc1 mn_st6
mn_st6_back:
    v_mfma_f32_4x4x4_16b_bf16 v[28:31], v[14:15], v[20:21], 0 cbsz:4 abid:12
    v_mfma_f32_4x4x4_16b_bf16 v[32:35], v[14:15], v[22:23], 0 cbsz:4 abid:13
    v_mfma_f32_4x4x4_16b_bf16 v[36:39], v[14:15], v[24:25], 0 cbsz:4 abid:14
    v_mfma_f32_4x4x4_16b_bf16 v[40:43], v[14:15], v[26:27], 0 cbsz:4 abid:15
    ds_read_u16 v4, v2 offset:688
    ds_read_u16 v6, v2 offset:696
    v_readlane_b32 s28, v19, 49
    v_readlane_b32 s29, v19, 57
    v_mov_b32 v85, s30
    ds_add_rtn_u32 v85, v0, v85 offset:288
    s_waitcnt vmcnt(5)
    ds_read_b64_tr_b16 v[20:21], v1 offset:4096
    ds_read_b64_tr_b16 v[22:23], v1 offset:4608
    s_waitcnt vmcnt(4)
    ds_read_b64_tr_b16 v[24:25], v1 offset:5120
    ds_read_b64_tr_b16 v[26:27], v1 offset:5632
    s_sub_u32 s34, s34, 1
    s_cmov_b32 s35, 0x30000
    s_mov_b32 m0, s28
    v_fmac_f32 v88, v28, v56
    v_fmac_f32 v89, v29, v56
    v_fmac_f32 v90, v30, v56
    v_fmac_f32 v91, v31, v56
    s_lshr_b32 m0, s28, 16
    v_fmac_f32 v88, v32, v57
    v_fmac_f32 v89, v33, v57
    v_fmac_f32 v90, v34, v57
    v_fmac_f32 v91, v35, v57
    s_mov_b32 m0, s29
    v_fmac_f32 v88, v36, v58
    v_fmac_f32 v89, v37, v58
    v_fmac_f32 v90, v38, v58
    v_fmac_f32 v91, v39, v58
    s_lshr_b32 m0, s29, 16
    v_fmac_f32 v88, v40, v59
    v_fmac_f32 v89, v41, v59
    v_fmac_f32 v90, v42, v59
    v_fmac_f32 v91, v43, v59
    s_or_b32 m0, s44, s35
    v_mfma_f32_32x32x16_bf16 v[44:59], v[60:63], v[68:71], 0
    v_mfma_f32_32x32x16_bf16 v[44:59], v[64:67], v[72:75], v[44:59]
    s_waitcnt lgkmcnt(2)
    buffer_load_dwordx4 v[4:5], s[4:7], 0 idxen offen lds
    s_or_b32 m0, s45, s35
    s_waitcnt lgkmcnt(0)
    buffer_load_dwordx4 v[6:7], s[4:7], 0 idxen offen lds
    v_readfirstlane_b32 s27, v85
    s_setprio 2
    s_xor_b32 s27, s27, s26
    s_cmp_ge_i32 s27, 0
    s_cbranch_scc1 mn_pr7
    s_setprio 1
mn_pr7:
    s_sub_u32 s19, s19, 1
    s_cbranch_scc1 mn_st7
mn_st7_back:
    v_mfma_f32_4x4x4_16b_bf16 v[28:31], v[16:17], v[20:21], 0 cbsz:4 abid:0
    v_mfma_f32_4x4x4_16b_bf16 v[32:35], v[16:17], v[22:23], 0 cbsz:4 abid:1
    v_mfma_f32_4x4x4_16b_bf16 v[36:39], v[16:17], v[24:25], 0 cbsz:4 abid:2
    v_mfma_f32_4x4x4_16b_bf16 v[40:43], v[16:17], v[26:27], 0 cbsz:4 abid:3
    ds_read_u16 v4, v2 offset:704
    ds_read_u16 v6, v2 offset:712
    v_readlane_b32 s28, v19, 2
    v_readlane_b32 s29, v19, 10
    ds_read_u16 v8, v18 offset:706
    s_waitcnt vmcnt(5)
    ds_read_b64_tr_b16 v[20:21], v1 offset:0
    ds_read_b64_tr_b16 v[22:23], v1 offset:512
    s_waitcnt vmcnt(4)
    ds_read_b64_tr_b16 v[24:25], v1 offset:1024
    ds_read_b64_tr_b16 v[26:27], v1 offset:1536
    s_sub_u32 s34, s34, 1
    s_cmov_b32 s35, 0x30000
    s_mov_b32 m0, s28
    v_fmac_f32 v88, v28, v44
    v_fmac_f32 v89, v29, v44
    v_fmac_f32 v90, v30, v44
    v_fmac_f32 v91, v31, v44
    s_lshr_b32 m0, s28, 16
    v_fmac_f32 v88, v32, v45
    v_fmac_f32 v89, v33, v45
    v_fmac_f32 v90, v34, v45
    v_fmac_f32 v91, v35, v45
    s_mov_b32 m0, s29
    v_fmac_f32 v88, v36, v46
    v_fmac_f32 v89, v37, v46
    v_fmac_f32 v90, v38, v46
    v_fmac_f32 v91, v39, v46
    s_lshr_b32 m0, s29, 16
    v_fmac_f32 v88, v40, v47
    v_fmac_f32 v89, v41, v47
    v_fmac_f32 v90, v42, v47
    v_fmac_f32 v91, v43, v47
    s_or_b32 m0, s40, s35
    s_waitcnt lgkmcnt(2)
    buffer_load_dwordx4 v[4:5], s[4:7], 0 idxen offen lds
    s_or_b32 m0, s41, s35
    s_waitcnt lgkmcnt(0)
    buffer_load_dwordx4 v[6:7], s[4:7], 0 idxen offen lds
    s_sub_u32 s19, s19, 1
    s_cbranch_scc1 mn_st8
mn_st8_back:
    v_mfma_f32_4x4x4_16b_bf16 v[28:31], v[16:17], v[20:21], 0 cbsz:4 abid:4
    v_mfma_f32_4x4x4_16b_bf16 v[32:35], v[16:17], v[22:23], 0 cbsz:4 abid:5
    v_mfma_f32_4x4x4_16b_bf16 v[36:39], v[16:17], v[24:25], 0 cbsz:4 abid:6
    v_mfma_f32_4x4x4_16b_bf16 v[40:43], v[16:17], v[26:27], 0 cbsz:4 abid:7
    ds_read_u16 v4, v2 offset:720
    ds_read_u16 v6, v2 offset:728
    v_readlane_b32 s28, v19, 18
    v_readlane_b32 s29, v19, 26
    ds_read_u16 v84, v3 offset:706
    v_lshrrev_b32 v11, 8, v8
    v_and_b32 v8, 0x3ff, v8
    v_mul_u32_u24 v8, 48, v8
    ds_read_b64 v[8:9], v8 offset:352
    s_waitcnt vmcnt(5)
    ds_read_b64_tr_b16 v[20:21], v1 offset:2048
    ds_read_b64_tr_b16 v[22:23], v1 offset:2560
    s_waitcnt vmcnt(4)
    ds_read_b64_tr_b16 v[24:25], v1 offset:3072
    ds_read_b64_tr_b16 v[26:27], v1 offset:3584
    s_sub_u32 s34, s34, 1
    s_cmov_b32 s35, 0x30000
    s_mov_b32 m0, s28
    v_fmac_f32 v88, v28, v48
    v_fmac_f32 v89, v29, v48
    v_fmac_f32 v90, v30, v48
    v_fmac_f32 v91, v31, v48
    s_lshr_b32 m0, s28, 16
    v_fmac_f32 v88, v32, v49
    v_fmac_f32 v89, v33, v49
    v_fmac_f32 v90, v34, v49
    v_fmac_f32 v91, v35, v49
    s_mov_b32 m0, s29
    v_fmac_f32 v88, v36, v50
    v_fmac_f32 v89, v37, v50
    v_fmac_f32 v90, v38, v50
    v_fmac_f32 v91, v39, v50
    s_lshr_b32 m0, s29, 16
    v_fmac_f32 v88, v40, v51
    v_fmac_f32 v89, v41, v51
    v_fmac_f32 v90, v42, v51
    v_fmac_f32 v91, v43, v51
    s_or_b32 m0, s42, s35
    s_waitcnt lgkmcnt(2)
    buffer_load_dwordx4 v[4:5], s[4:7], 0 idxen offen lds
    s_or_b32 m0, s43, s35
    s_waitcnt lgkmcnt(0)
    buffer_load_dwordx4 v[6:7], s[4:7], 0 idxen offen lds
    s_sub_u32 s19, s19, 1
    s_cbranch_scc1 mn_st9
mn_st9_back:
    v_mfma_f32_4x4x4_16b_bf16 v[28:31], v[16:17], v[20:21], 0 cbsz:4 abid:8
    v_mfma_f32_4x4x4_16b_bf16 v[32:35], v[16:17], v[22:23], 0 cbsz:4 abid:9
    v_mfma_f32_4x4x4_16b_bf16 v[36:39], v[16:17], v[24:25], 0 cbsz:4 abid:10
    v_mfma_f32_4x4x4_16b_bf16 v[40:43], v[16:17], v[26:27], 0 cbsz:4 abid:11
    ds_read_u16 v4, v2 offset:736
    ds_read_u16 v6, v2 offset:744
    v_readlane_b32 s28, v19, 34
    v_readlane_b32 s29, v19, 42
    v_and_b32 v84, 0x3ff, v84
    v_mad_u32_u24 v84, v84, 48, v86
    v_xor_b32 v85, 0x40000, v84
    ds_read_b128 v[60:63], v84 offset:320
    ds_read_b128 v[64:67], v85 offset:320
    s_waitcnt vmcnt(5)
    ds_read_b64_tr_b16 v[20:21], v1 offset:4096
    ds_read_b64_tr_b16 v[22:23], v1 offset:4608
    s_waitcnt vmcnt(4)
    ds_read_b64_tr_b16 v[24:25], v1 offset:5120
    ds_read_b64_tr_b16 v[26:27], v1 offset:5632
    s_sub_u32 s34, s34, 1
    s_cmov_b32 s35, 0x30000
    s_mov_b32 m0, s28
    v_fmac_f32 v88, v28, v52
    v_fmac_f32 v89, v29, v52
    v_fmac_f32 v90, v30, v52
    v_fmac_f32 v91, v31, v52
    s_lshr_b32 m0, s28, 16
    v_fmac_f32 v88, v32, v53
    v_fmac_f32 v89, v33, v53
    v_fmac_f32 v90, v34, v53
    v_fmac_f32 v91, v35, v53
    s_mov_b32 m0, s29
    v_fmac_f32 v88, v36, v54
    v_fmac_f32 v89, v37, v54
    v_fmac_f32 v90, v38, v54
    v_fmac_f32 v91, v39, v54
    s_lshr_b32 m0, s29, 16
    v_fmac_f32 v88, v40, v55
    v_fmac_f32 v89, v41, v55
    v_fmac_f32 v90, v42, v55
    v_fmac_f32 v91, v43, v55
    s_or_b32 m0, s44, s35
    s_waitcnt lgkmcnt(2)
    buffer_load_dwordx4 v[4:5], s[4:7], 0 idxen offen lds
    s_or_b32 m0, s45, s35
    s_waitcnt lgkmcnt(0)
    buffer_load_dwordx4 v[6:7], s[4:7], 0 idxen offen lds
    v_and_b32 v11, 0x7c, v11
    v_or_b32 v11, 0xc000, v11
    v_lshlrev_b32 v10, 16, v11
    s_sub_u32 s19, s19, 1
    s_cbranch_scc1 mn_st10
mn_st10_back:
    v_mfma_f32_4x4x4_16b_bf16 v[28:31], v[16:17], v[20:21], 0 cbsz:4 abid:12
    v_mfma_f32_4x4x4_16b_bf16 v[32:35], v[16:17], v[22:23], 0 cbsz:4 abid:13
    v_mfma_f32_4x4x4_16b_bf16 v[36:39], v[16:17], v[24:25], 0 cbsz:4 abid:14
    v_mfma_f32_4x4x4_16b_bf16 v[40:43], v[16:17], v[26:27], 0 cbsz:4 abid:15
    ds_read_u16 v4, v2 offset:752
    ds_read_u16 v6, v2 offset:760
    v_readlane_b32 s28, v19, 50
    v_readlane_b32 s29, v19, 58
    v_mov_b32 v85, s30
    ds_add_rtn_u32 v85, v0, v85 offset:288
    s_waitcnt vmcnt(5)
    ds_read_b64_tr_b16 v[20:21], v1 offset:0
    ds_read_b64_tr_b16 v[22:23], v1 offset:512
    s_waitcnt vmcnt(4)
    ds_read_b64_tr_b16 v[24:25], v1 offset:1024
    ds_read_b64_tr_b16 v[26:27], v1 offset:1536
    s_sub_u32 s34, s34, 1
    s_cmov_b32 s35, 0x30000
    s_mov_b32 m0, s28
    v_fmac_f32 v88, v28, v56
    v_fmac_f32 v89, v29, v56
    v_fmac_f32 v90, v30, v56
    v_fmac_f32 v91, v31, v56
    s_lshr_b32 m0, s28, 16
    v_fmac_f32 v88, v32, v57
    v_fmac_f32 v89, v33, v57
    v_fmac_f32 v90, v34, v57
    v_fmac_f32 v91, v35, v57
    s_mov_b32 m0, s29
    v_fmac_f32 v88, v36, v58
    v_fmac_f32 v89, v37, v58
    v_fmac_f32 v90, v38, v58
    v_fmac_f32 v91, v39, v58
    s_lshr_b32 m0, s29, 16
    v_fmac_f32 v88, v40, v59
    v_fmac_f32 v89, v41, v59
    v_fmac_f32 v90, v42, v59
    v_fmac_f32 v91, v43, v59
    s_or_b32 m0, s40, s35
    v_mfma_f32_4x4x4_16b_bf16 v[28:31], v[8:9], v[76:77], 0
    v_mfma_f32_4x4x4_16b_bf16 v[32:35], v[8:9], v[78:79], 0
    v_mfma_f32_4x4x4_16b_bf16 v[36:39], v[8:9], v[80:81], 0
    v_mfma_f32_4x4x4_16b_bf16 v[40:43], v[8:9], v[82:83], 0
    v_mfma_f32_32x32x16_bf16 v[44:59], v[60:63], v[68:71], 0
    v_mfma_f32_32x32x16_bf16 v[44:59], v[64:67], v[72:75], v[44:59]
    s_waitcnt lgkmcnt(2)
    buffer_load_dwordx4 v[4:5], s[4:7], 0 idxen offen lds
    s_or_b32 m0, s41, s35
    s_waitcnt lgkmcnt(0)
    buffer_load_dwordx4 v[6:7], s[4:7], 0 idxen offen lds
    v_cvt_pk_bf16_f32 v12, v28, v32
    v_cvt_pk_bf16_f32 v14, v29, v33
    v_cvt_pk_bf16_f32 v16, v30, v34
    v_cvt_pk_bf16_f32 v13, v36, v40
    v_cvt_pk_bf16_f32 v15, v37, v41
    v_cvt_pk_bf16_f32 v17, v38, v42
    v_or_b32_dpp v19, v10, v11 row_shl:4 row_mask:0xf bank_mask:0xf bound_ctrl:0
    v_add_u32 v2, 192, v2
    v_add_u32 v3, 192, v3
    v_add_u32 v18, 192, v18
    v_readfirstlane_b32 s27, v85
    s_setprio 2
    s_xor_b32 s27, s27, s26
    s_cmp_ge_i32 s27, 0
    s_cbranch_scc1 mn_pr11
    s_setprio 1
mn_pr11:
    s_sub_u32 s19, s19, 1
    s_cbranch_scc1 mn_st11
mn_st11_back:
    s_branch mn_loop
mn_st0:
    s_cmp_lg_u32 s21, 0
    s_cbranch_scc1 mn_next
    s_call_b64 s[48:49], mn_flush
    s_branch mn_st0_back
mn_st1:
    s_cmp_lg_u32 s21, 0
    s_cbranch_scc1 mn_next
    s_call_b64 s[48:49], mn_flush
    s_branch mn_st1_back
mn_st2:
    s_cmp_lg_u32 s21, 0
    s_cbranch_scc1 mn_next
    s_call_b64 s[48:49], mn_flush
    s_branch mn_st2_back
mn_st3:
    s_cmp_lg_u32 s21, 0
    s_cbranch_scc1 mn_next
    s_call_b64 s[48:49], mn_flush
    s_branch mn_st3_back
mn_st4:
    s_cmp_lg_u32 s21, 0
    s_cbranch_scc1 mn_next
    s_call_b64 s[48:49], mn_flush
    s_branch mn_st4_back
mn_st5:
    s_cmp_lg_u32 s21, 0
    s_cbranch_scc1 mn_next
    s_call_b64 s[48:49], mn_flush
    s_branch mn_st5_back
mn_st6:
    s_cmp_lg_u32 s21, 0
    s_cbranch_scc1 mn_next
    s_call_b64 s[48:49], mn_flush
    s_branch mn_st6_back
mn_st7:
    s_cmp_lg_u32 s21, 0
    s_cbranch_scc1 mn_next
    s_call_b64 s[48:49], mn_flush
    s_branch mn_st7_back
mn_st8:
    s_cmp_lg_u32 s21, 0
    s_cbranch_scc1 mn_next
    s_call_b64 s[48:49], mn_flush
    s_branch mn_st8_back
mn_st9:
    s_cmp_lg_u32 s21, 0
    s_cbranch_scc1 mn_next
    s_call_b64 s[48:49], mn_flush
    s_branch mn_st9_back
mn_st10:
    s_cmp_lg_u32 s21, 0
    s_cbranch_scc1 mn_next
    s_call_b64 s[48:49], mn_flush
    s_branch mn_st10_back
mn_st11:
    s_cmp_lg_u32 s21, 0
    s_cbranch_scc1 mn_next
    s_call_b64 s[48:49], mn_flush
    s_branch mn_st11_back
mn_st12:
    s_cmp_lg_u32 s21, 0
    s_cbranch_scc1 mn_next
    s_call_b64 s[48:49], mn_flush
    s_branch mn_st12_back
mn_flush:
    s_cmp_eq_u32 s58, 4
    s_cbranch_scc1 mn_fl4
    s_cmp_eq_u32 s58, 3
    s_cbranch_scc1 mn_fl3
    s_cmp_eq_u32 s58, 2
    s_cbranch_scc1 mn_fl2
    s_cmp_eq_u32 s58, 1
    s_cbranch_scc1 mn_fl1
mn_fl0:
    v_cvt_pk_bf16_f32 v88, v88, v89
    v_cvt_pk_bf16_f32 v89, v90, v91
    ds_write_b64 v87, v[88:89] offset:0
    v_cvt_pk_bf16_f32 v92, v92, v93
    v_cvt_pk_bf16_f32 v93, v94, v95
    ds_write_b64 v87, v[92:93] offset:576
    v_cvt_pk_bf16_f32 v96, v96, v97
    v_cvt_pk_bf16_f32 v97, v98, v99
    ds_write_b64 v87, v[96:97] offset:1152
    v_cvt_pk_bf16_f32 v100, v100, v101
    v_cvt_pk_bf16_f32 v101, v102, v103
    ds_write_b64 v87, v[100:101] offset:1728
    s_mul_i32 s52, s18, 3
    s_lshl_b32 s52, 1, s52
    v_mov_b32 v90, s52
    v_mov_b32 v91, 0
    s_mov_b64 exec, 1
    ds_add_u32 v91, v90 offset:276
    s_mov_b64 exec, -1
    s_add_u32 s58, s58, 1
    s_sub_u32 s19, s85, 1
    s_cbranch_scc1 mn_fl1
    s_setpc_b64 s[48:49]
mn_fl1:
    v_cvt_pk_bf16_f32 v104, v104, v105
    v_cvt_pk_bf16_f32 v105, v106, v107
    ds_write_b64 v87, v[104:105] offset:2304
    v_cvt_pk_bf16_f32 v108, v108, v109
    v_cvt_pk_bf16_f32 v109, v110, v111
    ds_write_b64 v87, v[108:109] offset:2880
    v_cvt_pk_bf16_f32 v112, v112, v113
    v_cvt_pk_bf16_f32 v113, v114, v115
    ds_write_b64 v87, v[112:113] offset:3456
    v_cvt_pk_bf16_f32 v116, v116, v117
    v_cvt_pk_bf16_f32 v117, v118, v119
    ds_write_b64 v87, v[116:117] offset:4032
    s_mul_i32 s52, s18, 3
    s_lshl_b32 s52, 64, s52
    v_mov_b32 v106, s52
    v_mov_b32 v107, 0
    s_mov_b64 exec, 1
    ds_add_u32 v107, v106 offset:276
    s_mov_b64 exec, -1
    s_add_u32 s58, s58, 1
    s_sub_u32 s19, s86, 1
    s_cbranch_scc1 mn_fl2
    s_setpc_b64 s[48:49]
mn_fl2:
    v_cvt_pk_bf16_f32 v120, v120, v121
    v_cvt_pk_bf16_f32 v121, v122, v123
    ds_write_b64 v87, v[120:121] offset:4608
    v_cvt_pk_bf16_f32 v124, v124, v125
    v_cvt_pk_bf16_f32 v125, v126, v127
    ds_write_b64 v87, v[124:125] offset:5184
    v_cvt_pk_bf16_f32 v128, v128, v129
    v_cvt_pk_bf16_f32 v129, v130, v131
    ds_write_b64 v87, v[128:129] offset:5760
    v_cvt_pk_bf16_f32 v132, v132, v133
    v_cvt_pk_bf16_f32 v133, v134, v135
    ds_write_b64 v87, v[132:133] offset:6336
    s_mul_i32 s52, s18, 3
    s_lshl_b32 s52, 4096, s52
    v_mov_b32 v122, s52
    v_mov_b32 v123, 0
    s_mov_b64 exec, 1
    ds_add_u32 v123, v122 offset:276
    s_mov_b64 exec, -1
    s_add_u32 s58, s58, 1
    s_sub_u32 s19, s87, 1
    s_cbranch_scc1 mn_fl3
    s_setpc_b64 s[48:49]
mn_fl3:
    v_cvt_pk_bf16_f32 v136, v136, v137
    v_cvt_pk_bf16_f32 v137, v138, v139
    ds_write_b64 v87, v[136:137] offset:6912
    v_cvt_pk_bf16_f32 v140, v140, v141
    v_cvt_pk_bf16_f32 v141, v142, v143
    ds_write_b64 v87, v[140:141] offset:7488
    v_cvt_pk_bf16_f32 v144, v144, v145
    v_cvt_pk_bf16_f32 v145, v146, v147
    ds_write_b64 v87, v[144:145] offset:8064
    v_cvt_pk_bf16_f32 v148, v148, v149
    v_cvt_pk_bf16_f32 v149, v150, v151
    ds_write_b64 v87, v[148:149] offset:8640
    s_mul_i32 s52, s18, 3
    s_lshl_b32 s52, 262144, s52
    v_mov_b32 v138, s52
    v_mov_b32 v139, 0
    s_mov_b64 exec, 1
    ds_add_u32 v139, v138 offset:276
    s_mov_b64 exec, -1
    s_add_u32 s58, s58, 1
    s_sub_u32 s19, s88, 1
    s_cbranch_scc1 mn_fl4
    s_setpc_b64 s[48:49]
mn_fl4:
    s_cmp_ge_u32 s59, 4
    s_cbranch_scc1 mn_fl4b
    s_waitcnt vmcnt(0)
mn_fl4b:
    v_cvt_pk_bf16_f32 v152, v152, v153
    v_cvt_pk_bf16_f32 v153, v154, v155
    ds_write_b64 v87, v[152:153] offset:9216
    v_cvt_pk_bf16_f32 v156, v156, v157
    v_cvt_pk_bf16_f32 v157, v158, v159
    ds_write_b64 v87, v[156:157] offset:9792
    v_cvt_pk_bf16_f32 v160, v160, v161
    v_cvt_pk_bf16_f32 v161, v162, v163
    ds_write_b64 v87, v[160:161] offset:10368
    v_cvt_pk_bf16_f32 v164, v164, v165
    v_cvt_pk_bf16_f32 v165, v166, v167
    ds_write_b64 v87, v[164:165] offset:10944
    s_mul_i32 s52, s18, 3
    s_lshl_b32 s52, 16777216, s52
    v_mov_b32 v154, s52
    v_mov_b32 v155, 0
    s_mov_b64 exec, 1
    ds_add_u32 v155, v154 offset:276
    s_mov_b64 exec, -1
    s_waitcnt vmcnt(0) lgkmcnt(0)
mn_end:
    s_endpgm
gm_main:
    s_load_dwordx2 s[56:57], s[0:1], 64
    s_load_dwordx4 s[28:31], s[0:1], 40
    s_load_dwordx2 s[26:27], s[0:1], 56
    v_readfirstlane_b32 s59, v87
    v_and_b32 v3, 63, v0
    v_and_b32 v11, 0x7f, v0
    v_min_u32 v11, 95, v11
    v_lshlrev_b32 v11, 2, v11
    v_mov_b32 v10, 0
    ds_write_b32 v11, v10
    v_bfe_u32 v12, v0, 1, 7
    v_and_b32 v11, 15, v12
    v_lshrrev_b32 v10, 4, v12
    v_lshl_or_b32 v11, v11, 3, v10
    v_cmp_gt_u32 vcc, 125, v11
    v_mul_u32_u24 v13, 51200, v11
    v_bfrev_b32 v10, 2
    v_lshlrev_b32 v12, 6, v12
    v_cndmask_b32 v12, v10, v12, vcc
    v_lshlrev_b32 v2, 4, v3
    s_lshl_b32 s40, s17, 15
    s_add_u32 s40, s40, 11534336
    s_waitcnt lgkmcnt(0)
    s_mov_b32 s8, s54
    s_and_b32 s9, s55, 0xffff
    s_cmp_lg_u32 s16, 10
    s_cbranch_scc1 gm_nowr
    s_mov_b32 m0, 148480
    v_add_u32 v10, 4096, v2
    global_load_lds_dwordx4 v2, s[30:31] offset:0
    global_load_lds_dwordx4 v2, s[30:31] offset:1024
    global_load_lds_dwordx4 v2, s[30:31] offset:2048
    global_load_lds_dwordx4 v2, s[30:31] offset:3072
    s_mov_b32 m0, 152576
    s_nop 0
    global_load_lds_dwordx4 v10, s[30:31] offset:0
    global_load_lds_dwordx4 v10, s[30:31] offset:1024
    global_load_lds_dwordx4 v10, s[30:31] offset:2048
    global_load_lds_dwordx4 v10, s[30:31] offset:3072
    s_mov_b32 m0, 156672
    s_mov_b64 exec, 0xff
    global_load_lds_dwordx4 v2, s[28:29]
    s_mov_b64 exec, -1
gm_nowr:
    v_lshrrev_b32 v11, 4, v3
    v_lshlrev_b32 v11, 11, v11
    v_and_b32 v10, 7, v3
    v_lshl_add_u32 v11, v10, 4, v11
    v_and_b32 v10, 8, v3
    v_lshlrev_b32 v10, 10, v10
    s_lshl_b32 s52, s17, 7
    s_add_u32 s52, s52, 114688
    v_add3_u32 v11, v11, v10, s52
    s_mov_b32 s44, 0x05040100
    s_mov_b32 s45, 0x07060302
    v_mov_b32 v5, v11
    s_cmp_ge_u32 s2, 125
    s_cbranch_scc1 gm_wgo
gm_wsp:
    v_mov_b32 v11, 0
    ds_read_b32 v11, v11 offset:448
    s_waitcnt lgkmcnt(0)
    v_readfirstlane_b32 s52, v11
    s_cmp_ge_u32 s52, 11
    s_cbranch_scc1 gm_wgo
    s_sleep 1
    s_branch gm_wsp
gm_wgo:
    global_load_dwordx4 v[136:139], v5, s[26:27] offset:0
    global_load_dwordx4 v[140:143], v5, s[26:27] offset:512
    global_load_dwordx4 v[144:147], v5, s[26:27] offset:1024
    global_load_dwordx4 v[148:151], v5, s[26:27] offset:1536
    v_subrev_u32 v5, 0x4000, v5
    global_load_dwordx4 v[120:123], v5, s[26:27] offset:0
    global_load_dwordx4 v[124:127], v5, s[26:27] offset:512
    global_load_dwordx4 v[128:131], v5, s[26:27] offset:1024
    global_load_dwordx4 v[132:135], v5, s[26:27] offset:1536
    v_subrev_u32 v5, 0x4000, v5
    global_load_dwordx4 v[104:107], v5, s[26:27] offset:0
    global_load_dwordx4 v[108:111], v5, s[26:27] offset:512
    global_load_dwordx4 v[112:115], v5, s[26:27] offset:1024
    global_load_dwordx4 v[116:119], v5, s[26:27] offset:1536
    v_subrev_u32 v5, 0x4000, v5
    global_load_dwordx4 v[88:91], v5, s[26:27] offset:0
    global_load_dwordx4 v[92:95], v5, s[26:27] offset:512
    global_load_dwordx4 v[96:99], v5, s[26:27] offset:1024
    global_load_dwordx4 v[100:103], v5, s[26:27] offset:1536
    v_subrev_u32 v5, 0x4000, v5
    s_waitcnt vmcnt(12)
    global_load_dwordx4 v[72:75], v5, s[26:27] offset:0
    global_load_dwordx4 v[76:79], v5, s[26:27] offset:512
    global_load_dwordx4 v[80:83], v5, s[26:27] offset:1024
    global_load_dwordx4 v[84:87], v5, s[26:27] offset:1536
    v_subrev_u32 v5, 0x4000, v5
    v_mov_b32_dpp v152, v138 row_ror:8 row_mask:0xf bank_mask:0xf
    v_mov_b32_dpp v153, v139 row_ror:8 row_mask:0xf bank_mask:0xf
    v_mov_b32_dpp v154, v142 row_ror:8 row_mask:0xf bank_mask:0xf
    v_mov_b32_dpp v155, v143 row_ror:8 row_mask:0xf bank_mask:0xf
    v_mov_b32_dpp v156, v146 row_ror:8 row_mask:0xf bank_mask:0xf
    v_mov_b32_dpp v157, v147 row_ror:8 row_mask:0xf bank_mask:0xf
    v_mov_b32_dpp v158, v150 row_ror:8 row_mask:0xf bank_mask:0xf
    v_mov_b32_dpp v159, v151 row_ror:8 row_mask:0xf bank_mask:0xf
    v_mov_b32_dpp v138, v136 row_ror:8 row_mask:0xf bank_mask:0x3
    v_mov_b32_dpp v139, v137 row_ror:8 row_mask:0xf bank_mask:0x3
    v_mov_b32_dpp v142, v140 row_ror:8 row_mask:0xf bank_mask:0x3
    v_mov_b32_dpp v143, v141 row_ror:8 row_mask:0xf bank_mask:0x3
    v_mov_b32_dpp v146, v144 row_ror:8 row_mask:0xf bank_mask:0x3
    v_mov_b32_dpp v147, v145 row_ror:8 row_mask:0xf bank_mask:0x3
    v_mov_b32_dpp v150, v148 row_ror:8 row_mask:0xf bank_mask:0x3
    v_mov_b32_dpp v151, v149 row_ror:8 row_mask:0xf bank_mask:0x3
    v_mov_b32_dpp v136, v152 quad_perm:[0,1,2,3] row_mask:0xf bank_mask:0xc
    v_mov_b32_dpp v137, v153 quad_perm:[0,1,2,3] row_mask:0xf bank_mask:0xc
    v_mov_b32_dpp v140, v154 quad_perm:[0,1,2,3] row_mask:0xf bank_mask:0xc
    v_mov_b32_dpp v141, v155 quad_perm:[0,1,2,3] row_mask:0xf bank_mask:0xc
    v_mov_b32_dpp v144, v156 quad_perm:[0,1,2,3] row_mask:0xf bank_mask:0xc
    v_mov_b32_dpp v145, v157 quad_perm:[0,1,2,3] row_mask:0xf bank_mask:0xc
    v_mov_b32_dpp v148, v158 quad_perm:[0,1,2,3] row_mask:0xf bank_mask:0xc
    v_mov_b32_dpp v149, v159 quad_perm:[0,1,2,3] row_mask:0xf bank_mask:0xc
    v_perm_b32 v152, v140, v136, s44
    v_perm_b32 v153, v148, v144, s44
    v_perm_b32 v154, v142, v138, s44
    v_perm_b32 v155, v150, v146, s44
    v_perm_b32 v156, v140, v136, s45
    v_perm_b32 v157, v148, v144, s45
    v_perm_b32 v158, v142, v138, s45
    v_perm_b32 v159, v150, v146, s45
    v_perm_b32 v160, v141, v137, s44
    v_perm_b32 v161, v149, v145, s44
    v_perm_b32 v162, v143, v139, s44
    v_perm_b32 v163, v151, v147, s44
    v_perm_b32 v164, v141, v137, s45
    v_perm_b32 v165, v149, v145, s45
    v_perm_b32 v166, v143, v139, s45
    v_perm_b32 v167, v151, v147, s45
    s_waitcnt vmcnt(12)
    v_mov_b32_dpp v136, v122 row_ror:8 row_mask:0xf bank_mask:0xf
    v_mov_b32_dpp v137, v123 row_ror:8 row_mask:0xf bank_mask:0xf
    v_mov_b32_dpp v138, v126 row_ror:8 row_mask:0xf bank_mask:0xf
    v_mov_b32_dpp v139, v127 row_ror:8 row_mask:0xf bank_mask:0xf
    v_mov_b32_dpp v140, v130 row_ror:8 row_mask:0xf bank_mask:0xf
    v_mov_b32_dpp v141, v131 row_ror:8 row_mask:0xf bank_mask:0xf
    v_mov_b32_dpp v142, v134 row_ror:8 row_mask:0xf bank_mask:0xf
    v_mov_b32_dpp v143, v135 row_ror:8 row_mask:0xf bank_mask:0xf
    v_mov_b32_dpp v122, v120 row_ror:8 row_mask:0xf bank_mask:0x3
    v_mov_b32_dpp v123, v121 row_ror:8 row_mask:0xf bank_mask:0x3
    v_mov_b32_dpp v126, v124 row_ror:8 row_mask:0xf bank_mask:0x3
    v_mov_b32_dpp v127, v125 row_ror:8 row_mask:0xf bank_mask:0x3
    v_mov_b32_dpp v130, v128 row_ror:8 row_mask:0xf bank_mask:0x3
    v_mov_b32_dpp v131, v129 row_ror:8 row_mask:0xf bank_mask:0x3
    v_mov_b32_dpp v134, v132 row_ror:8 row_mask:0xf bank_mask:0x3
    v_mov_b32_dpp v135, v133 row_ror:8 row_mask:0xf bank_mask:0x3
    v_mov_b32_dpp v120, v136 quad_perm:[0,1,2,3] row_mask:0xf bank_mask:0xc
    v_mov_b32_dpp v121, v137 quad_perm:[0,1,2,3] row_mask:0xf bank_mask:0xc
    v_mov_b32_dpp v124, v138 quad_perm:[0,1,2,3] row_mask:0xf bank_mask:0xc
    v_mov_b32_dpp v125, v139 quad_perm:[0,1,2,3] row_mask:0xf bank_mask:0xc
    v_mov_b32_dpp v128, v140 quad_perm:[0,1,2,3] row_mask:0xf bank_mask:0xc
    v_mov_b32_dpp v129, v141 quad_perm:[0,1,2,3] row_mask:0xf bank_mask:0xc
    v_mov_b32_dpp v132, v142 quad_perm:[0,1,2,3] row_mask:0xf bank_mask:0xc
    v_mov_b32_dpp v133, v143 quad_perm:[0,1,2,3] row_mask:0xf bank_mask:0xc
    v_perm_b32 v136, v124, v120, s44
    v_perm_b32 v137, v132, v128, s44
    v_perm_b32 v138, v126, v122, s44
    v_perm_b32 v139, v134, v130, s44
    v_perm_b32 v140, v124, v120, s45
    v_perm_b32 v141, v132, v128, s45
    v_perm_b32 v142, v126, v122, s45
    v_perm_b32 v143, v134, v130, s45
    v_perm_b32 v144, v125, v121, s44
    v_perm_b32 v145, v133, v129, s44
    v_perm_b32 v146, v127, v123, s44
    v_perm_b32 v147, v135, v131, s44
    v_perm_b32 v148, v125, v121, s45
    v_perm_b32 v149, v133, v129, s45
    v_perm_b32 v150, v127, v123, s45
    v_perm_b32 v151, v135, v131, s45
    s_waitcnt vmcnt(8)
    v_mov_b32_dpp v120, v106 row_ror:8 row_mask:0xf bank_mask:0xf
    v_mov_b32_dpp v121, v107 row_ror:8 row_mask:0xf bank_mask:0xf
    v_mov_b32_dpp v122, v110 row_ror:8 row_mask:0xf bank_mask:0xf
    v_mov_b32_dpp v123, v111 row_ror:8 row_mask:0xf bank_mask:0xf
    v_mov_b32_dpp v124, v114 row_ror:8 row_mask:0xf bank_mask:0xf
    v_mov_b32_dpp v125, v115 row_ror:8 row_mask:0xf bank_mask:0xf
    v_mov_b32_dpp v126, v118 row_ror:8 row_mask:0xf bank_mask:0xf
    v_mov_b32_dpp v127, v119 row_ror:8 row_mask:0xf bank_mask:0xf
    v_mov_b32_dpp v106, v104 row_ror:8 row_mask:0xf bank_mask:0x3
    v_mov_b32_dpp v107, v105 row_ror:8 row_mask:0xf bank_mask:0x3
    v_mov_b32_dpp v110, v108 row_ror:8 row_mask:0xf bank_mask:0x3
    v_mov_b32_dpp v111, v109 row_ror:8 row_mask:0xf bank_mask:0x3
    v_mov_b32_dpp v114, v112 row_ror:8 row_mask:0xf bank_mask:0x3
    v_mov_b32_dpp v115, v113 row_ror:8 row_mask:0xf bank_mask:0x3
    v_mov_b32_dpp v118, v116 row_ror:8 row_mask:0xf bank_mask:0x3
    v_mov_b32_dpp v119, v117 row_ror:8 row_mask:0xf bank_mask:0x3
    v_mov_b32_dpp v104, v120 quad_perm:[0,1,2,3] row_mask:0xf bank_mask:0xc
    v_mov_b32_dpp v105, v121 quad_perm:[0,1,2,3] row_mask:0xf bank_mask:0xc
    v_mov_b32_dpp v108, v122 quad_perm:[0,1,2,3] row_mask:0xf bank_mask:0xc
    v_mov_b32_dpp v109, v123 quad_perm:[0,1,2,3] row_mask:0xf bank_mask:0xc
    v_mov_b32_dpp v112, v124 quad_perm:[0,1,2,3] row_mask:0xf bank_mask:0xc
    v_mov_b32_dpp v113, v125 quad_perm:[0,1,2,3] row_mask:0xf bank_mask:0xc
    v_mov_b32_dpp v116, v126 quad_perm:[0,1,2,3] row_mask:0xf bank_mask:0xc
    v_mov_b32_dpp v117, v127 quad_perm:[0,1,2,3] row_mask:0xf bank_mask:0xc
    v_perm_b32 v120, v108, v104, s44
    v_perm_b32 v121, v116, v112, s44
    v_perm_b32 v122, v110, v106, s44
    v_perm_b32 v123, v118, v114, s44
    v_perm_b32 v124, v108, v104, s45
    v_perm_b32 v125, v116, v112, s45
    v_perm_b32 v126, v110, v106, s45
    v_perm_b32 v127, v118, v114, s45
    v_perm_b32 v128, v109, v105, s44
    v_perm_b32 v129, v117, v113, s44
    v_perm_b32 v130, v111, v107, s44
    v_perm_b32 v131, v119, v115, s44
    v_perm_b32 v132, v109, v105, s45
    v_perm_b32 v133, v117, v113, s45
    v_perm_b32 v134, v111, v107, s45
    v_perm_b32 v135, v119, v115, s45
    s_waitcnt vmcnt(4)
    v_mov_b32_dpp v104, v90 row_ror:8 row_mask:0xf bank_mask:0xf
    v_mov_b32_dpp v105, v91 row_ror:8 row_mask:0xf bank_mask:0xf
    v_mov_b32_dpp v106, v94 row_ror:8 row_mask:0xf bank_mask:0xf
    v_mov_b32_dpp v107, v95 row_ror:8 row_mask:0xf bank_mask:0xf
    v_mov_b32_dpp v108, v98 row_ror:8 row_mask:0xf bank_mask:0xf
    v_mov_b32_dpp v109, v99 row_ror:8 row_mask:0xf bank_mask:0xf
    v_mov_b32_dpp v110, v102 row_ror:8 row_mask:0xf bank_mask:0xf
    v_mov_b32_dpp v111, v103 row_ror:8 row_mask:0xf bank_mask:0xf
    v_mov_b32_dpp v90, v88 row_ror:8 row_mask:0xf bank_mask:0x3
    v_mov_b32_dpp v91, v89 row_ror:8 row_mask:0xf bank_mask:0x3
    v_mov_b32_dpp v94, v92 row_ror:8 row_mask:0xf bank_mask:0x3
    v_mov_b32_dpp v95, v93 row_ror:8 row_mask:0xf bank_mask:0x3
    v_mov_b32_dpp v98, v96 row_ror:8 row_mask:0xf bank_mask:0x3
    v_mov_b32_dpp v99, v97 row_ror:8 row_mask:0xf bank_mask:0x3
    v_mov_b32_dpp v102, v100 row_ror:8 row_mask:0xf bank_mask:0x3
    v_mov_b32_dpp v103, v101 row_ror:8 row_mask:0xf bank_mask:0x3
    v_mov_b32_dpp v88, v104 quad_perm:[0,1,2,3] row_mask:0xf bank_mask:0xc
    v_mov_b32_dpp v89, v105 quad_perm:[0,1,2,3] row_mask:0xf bank_mask:0xc
    v_mov_b32_dpp v92, v106 quad_perm:[0,1,2,3] row_mask:0xf bank_mask:0xc
    v_mov_b32_dpp v93, v107 quad_perm:[0,1,2,3] row_mask:0xf bank_mask:0xc
    v_mov_b32_dpp v96, v108 quad_perm:[0,1,2,3] row_mask:0xf bank_mask:0xc
    v_mov_b32_dpp v97, v109 quad_perm:[0,1,2,3] row_mask:0xf bank_mask:0xc
    v_mov_b32_dpp v100, v110 quad_perm:[0,1,2,3] row_mask:0xf bank_mask:0xc
    v_mov_b32_dpp v101, v111 quad_perm:[0,1,2,3] row_mask:0xf bank_mask:0xc
    v_perm_b32 v104, v92, v88, s44
    v_perm_b32 v105, v100, v96, s44
    v_perm_b32 v106, v94, v90, s44
    v_perm_b32 v107, v102, v98, s44
    v_perm_b32 v108, v92, v88, s45
    v_perm_b32 v109, v100, v96, s45
    v_perm_b32 v110, v94, v90, s45
    v_perm_b32 v111, v102, v98, s45
    v_perm_b32 v112, v93, v89, s44
    v_perm_b32 v113, v101, v97, s44
    v_perm_b32 v114, v95, v91, s44
    v_perm_b32 v115, v103, v99, s44
    v_perm_b32 v116, v93, v89, s45
    v_perm_b32 v117, v101, v97, s45
    v_perm_b32 v118, v95, v91, s45
    v_perm_b32 v119, v103, v99, s45
    s_waitcnt vmcnt(0)
    v_mov_b32_dpp v88, v74 row_ror:8 row_mask:0xf bank_mask:0xf
    v_mov_b32_dpp v89, v75 row_ror:8 row_mask:0xf bank_mask:0xf
    v_mov_b32_dpp v90, v78 row_ror:8 row_mask:0xf bank_mask:0xf
    v_mov_b32_dpp v91, v79 row_ror:8 row_mask:0xf bank_mask:0xf
    v_mov_b32_dpp v92, v82 row_ror:8 row_mask:0xf bank_mask:0xf
    v_mov_b32_dpp v93, v83 row_ror:8 row_mask:0xf bank_mask:0xf
    v_mov_b32_dpp v94, v86 row_ror:8 row_mask:0xf bank_mask:0xf
    v_mov_b32_dpp v95, v87 row_ror:8 row_mask:0xf bank_mask:0xf
    v_mov_b32_dpp v74, v72 row_ror:8 row_mask:0xf bank_mask:0x3
    v_mov_b32_dpp v75, v73 row_ror:8 row_mask:0xf bank_mask:0x3
    v_mov_b32_dpp v78, v76 row_ror:8 row_mask:0xf bank_mask:0x3
    v_mov_b32_dpp v79, v77 row_ror:8 row_mask:0xf bank_mask:0x3
    v_mov_b32_dpp v82, v80 row_ror:8 row_mask:0xf bank_mask:0x3
    v_mov_b32_dpp v83, v81 row_ror:8 row_mask:0xf bank_mask:0x3
    v_mov_b32_dpp v86, v84 row_ror:8 row_mask:0xf bank_mask:0x3
    v_mov_b32_dpp v87, v85 row_ror:8 row_mask:0xf bank_mask:0x3
    v_mov_b32_dpp v72, v88 quad_perm:[0,1,2,3] row_mask:0xf bank_mask:0xc
    v_mov_b32_dpp v73, v89 quad_perm:[0,1,2,3] row_mask:0xf bank_mask:0xc
    v_mov_b32_dpp v76, v90 quad_perm:[0,1,2,3] row_mask:0xf bank_mask:0xc
    v_mov_b32_dpp v77, v91 quad_perm:[0,1,2,3] row_mask:0xf bank_mask:0xc
    v_mov_b32_dpp v80, v92 quad_perm:[0,1,2,3] row_mask:0xf bank_mask:0xc
    v_mov_b32_dpp v81, v93 quad_perm:[0,1,2,3] row_mask:0xf bank_mask:0xc
    v_mov_b32_dpp v84, v94 quad_perm:[0,1,2,3] row_mask:0xf bank_mask:0xc
    v_mov_b32_dpp v85, v95 quad_perm:[0,1,2,3] row_mask:0xf bank_mask:0xc
    v_perm_b32 v88, v76, v72, s44
    v_perm_b32 v89, v84, v80, s44
    v_perm_b32 v90, v78, v74, s44
    v_perm_b32 v91, v86, v82, s44
    v_perm_b32 v92, v76, v72, s45
    v_perm_b32 v93, v84, v80, s45
    v_perm_b32 v94, v78, v74, s45
    v_perm_b32 v95, v86, v82, s45
    v_perm_b32 v96, v77, v73, s44
    v_perm_b32 v97, v85, v81, s44
    v_perm_b32 v98, v79, v75, s44
    v_perm_b32 v99, v87, v83, s44
    v_perm_b32 v100, v77, v73, s45
    v_perm_b32 v101, v85, v81, s45
    v_perm_b32 v102, v79, v75, s45
    v_perm_b32 v103, v87, v83, s45
    s_cmp_lt_u32 s2, 125
    s_cbranch_scc1 gm_wskip
    global_load_dwordx4 v[56:59], v5, s[26:27] offset:0
    global_load_dwordx4 v[60:63], v5, s[26:27] offset:512
    global_load_dwordx4 v[64:67], v5, s[26:27] offset:1024
    global_load_dwordx4 v[68:71], v5, s[26:27] offset:1536
    v_subrev_u32 v5, 0x4000, v5
    global_load_dwordx4 v[40:43], v5, s[26:27] offset:0
    global_load_dwordx4 v[44:47], v5, s[26:27] offset:512
    global_load_dwordx4 v[48:51], v5, s[26:27] offset:1024
    global_load_dwordx4 v[52:55], v5, s[26:27] offset:1536
    v_subrev_u32 v5, 0x4000, v5
    global_load_dwordx4 v[24:27], v5, s[26:27] offset:0
    global_load_dwordx4 v[28:31], v5, s[26:27] offset:512
    global_load_dwordx4 v[32:35], v5, s[26:27] offset:1024
    global_load_dwordx4 v[36:39], v5, s[26:27] offset:1536
    s_waitcnt vmcnt(8)
    v_mov_b32_dpp v72, v58 row_ror:8 row_mask:0xf bank_mask:0xf
    v_mov_b32_dpp v73, v59 row_ror:8 row_mask:0xf bank_mask:0xf
    v_mov_b32_dpp v74, v62 row_ror:8 row_mask:0xf bank_mask:0xf
    v_mov_b32_dpp v75, v63 row_ror:8 row_mask:0xf bank_mask:0xf
    v_mov_b32_dpp v76, v66 row_ror:8 row_mask:0xf bank_mask:0xf
    v_mov_b32_dpp v77, v67 row_ror:8 row_mask:0xf bank_mask:0xf
    v_mov_b32_dpp v78, v70 row_ror:8 row_mask:0xf bank_mask:0xf
    v_mov_b32_dpp v79, v71 row_ror:8 row_mask:0xf bank_mask:0xf
    v_mov_b32_dpp v58, v56 row_ror:8 row_mask:0xf bank_mask:0x3
    v_mov_b32_dpp v59, v57 row_ror:8 row_mask:0xf bank_mask:0x3
    v_mov_b32_dpp v62, v60 row_ror:8 row_mask:0xf bank_mask:0x3
    v_mov_b32_dpp v63, v61 row_ror:8 row_mask:0xf bank_mask:0x3
    v_mov_b32_dpp v66, v64 row_ror:8 row_mask:0xf bank_mask:0x3
    v_mov_b32_dpp v67, v65 row_ror:8 row_mask:0xf bank_mask:0x3
    v_mov_b32_dpp v70, v68 row_ror:8 row_mask:0xf bank_mask:0x3
    v_mov_b32_dpp v71, v69 row_ror:8 row_mask:0xf bank_mask:0x3
    v_mov_b32_dpp v56, v72 quad_perm:[0,1,2,3] row_mask:0xf bank_mask:0xc
    v_mov_b32_dpp v57, v73 quad_perm:[0,1,2,3] row_mask:0xf bank_mask:0xc
    v_mov_b32_dpp v60, v74 quad_perm:[0,1,2,3] row_mask:0xf bank_mask:0xc
    v_mov_b32_dpp v61, v75 quad_perm:[0,1,2,3] row_mask:0xf bank_mask:0xc
    v_mov_b32_dpp v64, v76 quad_perm:[0,1,2,3] row_mask:0xf bank_mask:0xc
    v_mov_b32_dpp v65, v77 quad_perm:[0,1,2,3] row_mask:0xf bank_mask:0xc
    v_mov_b32_dpp v68, v78 quad_perm:[0,1,2,3] row_mask:0xf bank_mask:0xc
    v_mov_b32_dpp v69, v79 quad_perm:[0,1,2,3] row_mask:0xf bank_mask:0xc
    v_perm_b32 v72, v60, v56, s44
    v_perm_b32 v73, v68, v64, s44
    v_perm_b32 v74, v62, v58, s44
    v_perm_b32 v75, v70, v66, s44
    v_perm_b32 v76, v60, v56, s45
    v_perm_b32 v77, v68, v64, s45
    v_perm_b32 v78, v62, v58, s45
    v_perm_b32 v79, v70, v66, s45
    v_perm_b32 v80, v61, v57, s44
    v_perm_b32 v81, v69, v65, s44
    v_perm_b32 v82, v63, v59, s44
    v_perm_b32 v83, v71, v67, s44
    v_perm_b32 v84, v61, v57, s45
    v_perm_b32 v85, v69, v65, s45
    v_perm_b32 v86, v63, v59, s45
    v_perm_b32 v87, v71, v67, s45
    s_waitcnt vmcnt(4)
    v_mov_b32_dpp v56, v42 row_ror:8 row_mask:0xf bank_mask:0xf
    v_mov_b32_dpp v57, v43 row_ror:8 row_mask:0xf bank_mask:0xf
    v_mov_b32_dpp v58, v46 row_ror:8 row_mask:0xf bank_mask:0xf
    v_mov_b32_dpp v59, v47 row_ror:8 row_mask:0xf bank_mask:0xf
    v_mov_b32_dpp v60, v50 row_ror:8 row_mask:0xf bank_mask:0xf
    v_mov_b32_dpp v61, v51 row_ror:8 row_mask:0xf bank_mask:0xf
    v_mov_b32_dpp v62, v54 row_ror:8 row_mask:0xf bank_mask:0xf
    v_mov_b32_dpp v63, v55 row_ror:8 row_mask:0xf bank_mask:0xf
    v_mov_b32_dpp v42, v40 row_ror:8 row_mask:0xf bank_mask:0x3
    v_mov_b32_dpp v43, v41 row_ror:8 row_mask:0xf bank_mask:0x3
    v_mov_b32_dpp v46, v44 row_ror:8 row_mask:0xf bank_mask:0x3
    v_mov_b32_dpp v47, v45 row_ror:8 row_mask:0xf bank_mask:0x3
    v_mov_b32_dpp v50, v48 row_ror:8 row_mask:0xf bank_mask:0x3
    v_mov_b32_dpp v51, v49 row_ror:8 row_mask:0xf bank_mask:0x3
    v_mov_b32_dpp v54, v52 row_ror:8 row_mask:0xf bank_mask:0x3
    v_mov_b32_dpp v55, v53 row_ror:8 row_mask:0xf bank_mask:0x3
    v_mov_b32_dpp v40, v56 quad_perm:[0,1,2,3] row_mask:0xf bank_mask:0xc
    v_mov_b32_dpp v41, v57 quad_perm:[0,1,2,3] row_mask:0xf bank_mask:0xc
    v_mov_b32_dpp v44, v58 quad_perm:[0,1,2,3] row_mask:0xf bank_mask:0xc
    v_mov_b32_dpp v45, v59 quad_perm:[0,1,2,3] row_mask:0xf bank_mask:0xc
    v_mov_b32_dpp v48, v60 quad_perm:[0,1,2,3] row_mask:0xf bank_mask:0xc
    v_mov_b32_dpp v49, v61 quad_perm:[0,1,2,3] row_mask:0xf bank_mask:0xc
    v_mov_b32_dpp v52, v62 quad_perm:[0,1,2,3] row_mask:0xf bank_mask:0xc
    v_mov_b32_dpp v53, v63 quad_perm:[0,1,2,3] row_mask:0xf bank_mask:0xc
    v_perm_b32 v56, v44, v40, s44
    v_perm_b32 v57, v52, v48, s44
    v_perm_b32 v58, v46, v42, s44
    v_perm_b32 v59, v54, v50, s44
    v_perm_b32 v60, v44, v40, s45
    v_perm_b32 v61, v52, v48, s45
    v_perm_b32 v62, v46, v42, s45
    v_perm_b32 v63, v54, v50, s45
    v_perm_b32 v64, v45, v41, s44
    v_perm_b32 v65, v53, v49, s44
    v_perm_b32 v66, v47, v43, s44
    v_perm_b32 v67, v55, v51, s44
    v_perm_b32 v68, v45, v41, s45
    v_perm_b32 v69, v53, v49, s45
    v_perm_b32 v70, v47, v43, s45
    v_perm_b32 v71, v55, v51, s45
    s_waitcnt vmcnt(0)
    v_mov_b32_dpp v40, v26 row_ror:8 row_mask:0xf bank_mask:0xf
    v_mov_b32_dpp v41, v27 row_ror:8 row_mask:0xf bank_mask:0xf
    v_mov_b32_dpp v42, v30 row_ror:8 row_mask:0xf bank_mask:0xf
    v_mov_b32_dpp v43, v31 row_ror:8 row_mask:0xf bank_mask:0xf
    v_mov_b32_dpp v44, v34 row_ror:8 row_mask:0xf bank_mask:0xf
    v_mov_b32_dpp v45, v35 row_ror:8 row_mask:0xf bank_mask:0xf
    v_mov_b32_dpp v46, v38 row_ror:8 row_mask:0xf bank_mask:0xf
    v_mov_b32_dpp v47, v39 row_ror:8 row_mask:0xf bank_mask:0xf
    v_mov_b32_dpp v26, v24 row_ror:8 row_mask:0xf bank_mask:0x3
    v_mov_b32_dpp v27, v25 row_ror:8 row_mask:0xf bank_mask:0x3
    v_mov_b32_dpp v30, v28 row_ror:8 row_mask:0xf bank_mask:0x3
    v_mov_b32_dpp v31, v29 row_ror:8 row_mask:0xf bank_mask:0x3
    v_mov_b32_dpp v34, v32 row_ror:8 row_mask:0xf bank_mask:0x3
    v_mov_b32_dpp v35, v33 row_ror:8 row_mask:0xf bank_mask:0x3
    v_mov_b32_dpp v38, v36 row_ror:8 row_mask:0xf bank_mask:0x3
    v_mov_b32_dpp v39, v37 row_ror:8 row_mask:0xf bank_mask:0x3
    v_mov_b32_dpp v24, v40 quad_perm:[0,1,2,3] row_mask:0xf bank_mask:0xc
    v_mov_b32_dpp v25, v41 quad_perm:[0,1,2,3] row_mask:0xf bank_mask:0xc
    v_mov_b32_dpp v28, v42 quad_perm:[0,1,2,3] row_mask:0xf bank_mask:0xc
    v_mov_b32_dpp v29, v43 quad_perm:[0,1,2,3] row_mask:0xf bank_mask:0xc
    v_mov_b32_dpp v32, v44 quad_perm:[0,1,2,3] row_mask:0xf bank_mask:0xc
    v_mov_b32_dpp v33, v45 quad_perm:[0,1,2,3] row_mask:0xf bank_mask:0xc
    v_mov_b32_dpp v36, v46 quad_perm:[0,1,2,3] row_mask:0xf bank_mask:0xc
    v_mov_b32_dpp v37, v47 quad_perm:[0,1,2,3] row_mask:0xf bank_mask:0xc
    v_perm_b32 v40, v28, v24, s44
    v_perm_b32 v41, v36, v32, s44
    v_perm_b32 v42, v30, v26, s44
    v_perm_b32 v43, v38, v34, s44
    v_perm_b32 v44, v28, v24, s45
    v_perm_b32 v45, v36, v32, s45
    v_perm_b32 v46, v30, v26, s45
    v_perm_b32 v47, v38, v34, s45
    v_perm_b32 v48, v29, v25, s44
    v_perm_b32 v49, v37, v33, s44
    v_perm_b32 v50, v31, v27, s44
    v_perm_b32 v51, v39, v35, s44
    v_perm_b32 v52, v29, v25, s45
    v_perm_b32 v53, v37, v33, s45
    v_perm_b32 v54, v31, v27, s45
    v_perm_b32 v55, v39, v35, s45
gm_wskip:
    s_waitcnt vmcnt(0)
    s_mul_i32 s41, s2, 625
    s_add_u32 s52, s41, 640
    s_add_u32 s41, s41, 15
    s_lshr_b32 s41, s41, 4
    s_lshr_b32 s52, s52, 4
    s_mov_b32 s12, s56
    s_and_b32 s13, s57, 0xffff
    s_lshl_b32 s14, s52, 11
    s_mov_b32 s15, 0x20000
    s_mul_i32 s42, s17, 15360
    s_add_u32 s42, s42, 40960
    s_lshl_b32 s43, s17, 1
    s_sub_u32 s43, s43, 1
    v_lshlrev_b32 v6, 2, v3
    v_add_u32 v11, 0, v3
    v_mul_u32_u24 v10, 21846, v11
    v_lshrrev_b32 v10, 16, v10
    v_lshl_add_u32 v34, v10, 2, s42
    v_mad_i32_i24 v10, v10, -3, v11
    v_lshlrev_b32 v30, 4, v10
    v_add_u32 v11, 64, v3
    v_mul_u32_u24 v10, 21846, v11
    v_lshrrev_b32 v10, 16, v10
    v_lshl_add_u32 v35, v10, 2, s42
    v_mad_i32_i24 v10, v10, -3, v11
    v_lshlrev_b32 v31, 4, v10
    v_add_u32 v11, 128, v3
    v_mul_u32_u24 v10, 21846, v11
    v_lshrrev_b32 v10, 16, v10
    v_lshl_add_u32 v36, v10, 2, s42
    v_mad_i32_i24 v10, v10, -3, v11
    v_lshlrev_b32 v32, 4, v10
    s_cmp_lg_u32 s16, 11
    s_cbranch_scc1 mn_poll1x
    s_and_b32 s62, s2, 7
    s_lshl_b32 s62, s62, 7
    s_add_u32 s62, s62, 11730944
    v_mov_b32 v11, s62
    s_add_u32 s59, s59, 2
    v_lshlrev_b32 v9, 6, v0
    v_and_b32 v9, 0xc0, v9
    s_mov_b32 s63, 0x100000
mn_poll1m:
    global_load_dword v10, v11, s[54:55] sc1
    s_sub_u32 s63, s63, 1
    s_cbranch_scc1 mn_poll1x
    s_waitcnt vmcnt(0)
    v_cmp_eq_u32 vcc, s59, v10
    s_cbranch_vccnz mn_poll1x
    s_sleep 4
    s_and_b32 s62, s63, 63
    s_cbranch_scc1 mn_poll1m
    global_load_dword v10, v9, s[60:61] sc1
    s_waitcnt vmcnt(0)
    v_add_u32_dpp v10, v10, v10 quad_perm:[1,0,3,2] row_mask:0xf bank_mask:0xf
    s_nop 1
    v_add_u32_dpp v10, v10, v10 quad_perm:[2,3,0,1] row_mask:0xf bank_mask:0xf
    v_cmp_ne_u32 vcc, 125, v10
    s_cbranch_vccnz mn_poll1m
mn_poll1x:
    s_barrier
    buffer_load_dword v4, v12, s[8:11], s22 offen offset:60 sc1
    s_barrier
    s_lshl2_add_u32 s47, s47, s17
    s_mul_i32 s47, s47, 51200
    s_mul_i32 s48, s48, 6400
    s_add_u32 s47, s47, s48
    s_sub_i32 s47, s47, 896
    s_max_i32 s47, s47, 0
    v_lshlrev_b32 v11, 7, v3
    buffer_load_dword v39, v11, s[8:11], s47 offen
    s_waitcnt vmcnt(1)
gm_pass:
    v_lshrrev_b32 v8, 16, v4
    v_subrev_u32 v8, s24, v8
    v_med3_i32 v8, v8, 0, s20
    v_mov_b32 v9, v8
    v_and_b32 v12, 1, v0
    v_and_b32 v14, 0xffff, v4
    v_add_u32_dpp v9, v9, v9 row_shr:2 row_mask:0xf bank_mask:0xf
    v_add3_u32 v14, v14, v12, s24
    s_nop 0
    v_add_u32_dpp v9, v9, v9 row_shr:4 row_mask:0xf bank_mask:0xf
    v_mad_u32_u24 v14, v14, 40, v13
    s_nop 0
    v_add_u32_dpp v9, v9, v9 row_shr:8 row_mask:0xf bank_mask:0xf
    v_sub_u32 v15, v8, v12
    s_nop 0
    v_add_u32_dpp v9, v9, v9 row_bcast:15 row_mask:0xa bank_mask:0xf
    s_nop 0
    s_nop 0
    v_add_u32_dpp v9, v9, v9 row_bcast:31 row_mask:0xc bank_mask:0xf
    s_nop 0
    s_nop 0
    v_readlane_b32 s47, v9, 63
    v_sub_u32 v16, v9, v15
    v_lshl_add_u32 v16, v16, 2, s42
    v_cmpx_lt_i32 vcc, 0, v15
    s_cbranch_execz gm_tb_done
    ds_write_b32 v16, v14 offset:0
    v_add_u32 v14, 80, v14
    v_cmpx_lt_i32 vcc, 2, v15
    s_cbranch_execz gm_tb_done
    ds_write_b32 v16, v14 offset:8
    v_add_u32 v14, 80, v14
    v_cmpx_lt_i32 vcc, 4, v15
    s_cbranch_execz gm_tb_done
    ds_write_b32 v16, v14 offset:16
    v_add_u32 v14, 80, v14
    v_cmpx_lt_i32 vcc, 6, v15
    s_cbranch_execz gm_tb_done
    ds_write_b32 v16, v14 offset:24
    v_add_u32 v14, 80, v14
    v_cmpx_lt_i32 vcc, 8, v15
    s_cbranch_execz gm_tb_done
    ds_write_b32 v16, v14 offset:32
    v_add_u32 v14, 80, v14
    v_cmpx_lt_i32 vcc, 10, v15
    s_cbranch_execz gm_tb_done
    ds_write_b32 v16, v14 offset:40
    v_add_u32 v14, 80, v14
    v_cmpx_lt_i32 vcc, 12, v15
    s_cbranch_execz gm_tb_done
    ds_write_b32 v16, v14 offset:48
    v_add_u32 v14, 80, v14
    v_cmpx_lt_i32 vcc, 14, v15
    s_cbranch_execz gm_tb_done
    ds_write_b32 v16, v14 offset:56
    v_add_u32 v14, 80, v14
    v_cmpx_lt_i32 vcc, 16, v15
    s_cbranch_execz gm_tb_done
    ds_write_b32 v16, v14 offset:64
    v_add_u32 v14, 80, v14
    v_cmpx_lt_i32 vcc, 18, v15
    s_cbranch_execz gm_tb_done
    ds_write_b32 v16, v14 offset:72
gm_tb_done:
    s_mov_b64 exec, -1
    s_mul_i32 s47, s47, 3
    v_mov_b32 v17, 0
    s_barrier
    ds_read_b32 v15, v6 offset:384
    ds_read_b32 v17, v17 offset:272
    v_mov_b32 v11, v34
    v_mov_b32 v10, v35
    v_mov_b32 v14, v36
    s_waitcnt lgkmcnt(1)
    v_add_u32_dpp v15, v15, v15 row_shr:1 row_mask:0xf bank_mask:0xf
    s_nop 1
    v_add_u32_dpp v15, v15, v15 row_shr:2 row_mask:0xf bank_mask:0xf
    s_nop 1
    v_add_u32_dpp v15, v15, v15 row_shr:4 row_mask:0xf bank_mask:0xf
    s_waitcnt lgkmcnt(0)
    v_readfirstlane_b32 s21, v17
    v_readlane_b32 s23, v15, 7
    v_readlane_b32 s46, v15, s43
    s_cmp_gt_u32 s23, 773
    s_cbranch_scc1 gm_ovf
    s_cmp_eq_u32 s17, 0
    s_cmov_b32 s46, 0
    s_mul_i32 s46, s46, 48
    s_add_u32 m0, s46, 3776
gm_go2:
gm_raw:
    ds_read_b32 v18, v11 offset:0
    ds_read_b32 v19, v10 offset:0
    ds_read_b32 v20, v14 offset:0
    ds_read_b32 v21, v11 offset:256
    ds_read_b32 v22, v10 offset:256
    ds_read_b32 v23, v14 offset:256
    ds_read_b32 v24, v11 offset:512
    ds_read_b32 v25, v10 offset:512
    ds_read_b32 v26, v14 offset:512
    v_cmpx_gt_i32 vcc, s47, v3
    s_cbranch_execz gm_raw_done
    s_waitcnt lgkmcnt(8)
    v_add_u32 v18, v18, v30
    buffer_load_dwordx4 v18, s[8:11], 0 offen sc1 lds
    s_add_u32 m0, m0, 1024
    s_sub_i32 s47, s47, 64
    v_cmpx_gt_i32 vcc, s47, v3
    s_cbranch_execz gm_raw_done
    s_waitcnt lgkmcnt(7)
    v_add_u32 v19, v19, v31
    buffer_load_dwordx4 v19, s[8:11], 0 offen sc1 lds
    s_add_u32 m0, m0, 1024
    s_sub_i32 s47, s47, 64
    v_cmpx_gt_i32 vcc, s47, v3
    s_cbranch_execz gm_raw_done
    s_waitcnt lgkmcnt(6)
    v_add_u32 v20, v20, v32
    buffer_load_dwordx4 v20, s[8:11], 0 offen sc1 lds
    s_add_u32 m0, m0, 1024
    s_sub_i32 s47, s47, 64
    v_cmpx_gt_i32 vcc, s47, v3
    s_cbranch_execz gm_raw_done
    s_waitcnt lgkmcnt(5)
    v_add_u32 v21, v21, v30
    buffer_load_dwordx4 v21, s[8:11], 0 offen sc1 lds
    s_add_u32 m0, m0, 1024
    s_sub_i32 s47, s47, 64
    v_cmpx_gt_i32 vcc, s47, v3
    s_cbranch_execz gm_raw_done
    s_waitcnt lgkmcnt(4)
    v_add_u32 v22, v22, v31
    buffer_load_dwordx4 v22, s[8:11], 0 offen sc1 lds
    s_add_u32 m0, m0, 1024
    s_sub_i32 s47, s47, 64
    v_cmpx_gt_i32 vcc, s47, v3
    s_cbranch_execz gm_raw_done
    s_waitcnt lgkmcnt(3)
    v_add_u32 v23, v23, v32
    buffer_load_dwordx4 v23, s[8:11], 0 offen sc1 lds
    s_add_u32 m0, m0, 1024
    s_sub_i32 s47, s47, 64
    v_cmpx_gt_i32 vcc, s47, v3
    s_cbranch_execz gm_raw_done
    s_waitcnt lgkmcnt(2)
    v_add_u32 v24, v24, v30
    buffer_load_dwordx4 v24, s[8:11], 0 offen sc1 lds
    s_add_u32 m0, m0, 1024
    s_sub_i32 s47, s47, 64
    v_cmpx_gt_i32 vcc, s47, v3
    s_cbranch_execz gm_raw_done
    s_waitcnt lgkmcnt(1)
    v_add_u32 v25, v25, v31
    buffer_load_dwordx4 v25, s[8:11], 0 offen sc1 lds
    s_add_u32 m0, m0, 1024
    s_sub_i32 s47, s47, 64
    v_cmpx_gt_i32 vcc, s47, v3
    s_cbranch_execz gm_raw_done
    s_waitcnt lgkmcnt(0)
    v_add_u32 v26, v26, v32
    buffer_load_dwordx4 v26, s[8:11], 0 offen sc1 lds
    s_add_u32 m0, m0, 1024
    s_sub_i32 s47, s47, 64
    v_add_u32 v11, 768, v11
    v_add_u32 v10, 768, v10
    v_add_u32 v14, 768, v14
    s_branch gm_raw
gm_raw_done:
    s_mov_b64 exec, -1
    s_barrier
    s_waitcnt vmcnt(0) lgkmcnt(0)
    s_barrier
    s_cmp_lg_u32 s21, 0
    s_cbranch_scc1 gm_next
    s_cmp_ge_u32 s2, 125
    s_cbranch_scc1 gm_wdone
    global_load_dwordx4 v[56:59], v5, s[26:27] offset:0
    global_load_dwordx4 v[60:63], v5, s[26:27] offset:512
    global_load_dwordx4 v[64:67], v5, s[26:27] offset:1024
    global_load_dwordx4 v[68:71], v5, s[26:27] offset:1536
    v_subrev_u32 v5, 0x4000, v5
    s_waitcnt vmcnt(0)
    global_load_dwordx4 v[40:43], v5, s[26:27] offset:0
    global_load_dwordx4 v[44:47], v5, s[26:27] offset:512
    global_load_dwordx4 v[48:51], v5, s[26:27] offset:1024
    global_load_dwordx4 v[52:55], v5, s[26:27] offset:1536
    v_subrev_u32 v5, 0x4000, v5
    v_mov_b32_dpp v72, v58 row_ror:8 row_mask:0xf bank_mask:0xf
    v_mov_b32_dpp v73, v59 row_ror:8 row_mask:0xf bank_mask:0xf
    v_mov_b32_dpp v74, v62 row_ror:8 row_mask:0xf bank_mask:0xf
    v_mov_b32_dpp v75, v63 row_ror:8 row_mask:0xf bank_mask:0xf
    v_mov_b32_dpp v76, v66 row_ror:8 row_mask:0xf bank_mask:0xf
    v_mov_b32_dpp v77, v67 row_ror:8 row_mask:0xf bank_mask:0xf
    v_mov_b32_dpp v78, v70 row_ror:8 row_mask:0xf bank_mask:0xf
    v_mov_b32_dpp v79, v71 row_ror:8 row_mask:0xf bank_mask:0xf
    v_mov_b32_dpp v58, v56 row_ror:8 row_mask:0xf bank_mask:0x3
    v_mov_b32_dpp v59, v57 row_ror:8 row_mask:0xf bank_mask:0x3
    v_mov_b32_dpp v62, v60 row_ror:8 row_mask:0xf bank_mask:0x3
    v_mov_b32_dpp v63, v61 row_ror:8 row_mask:0xf bank_mask:0x3
    v_mov_b32_dpp v66, v64 row_ror:8 row_mask:0xf bank_mask:0x3
    v_mov_b32_dpp v67, v65 row_ror:8 row_mask:0xf bank_mask:0x3
    v_mov_b32_dpp v70, v68 row_ror:8 row_mask:0xf bank_mask:0x3
    v_mov_b32_dpp v71, v69 row_ror:8 row_mask:0xf bank_mask:0x3
    v_mov_b32_dpp v56, v72 quad_perm:[0,1,2,3] row_mask:0xf bank_mask:0xc
    v_mov_b32_dpp v57, v73 quad_perm:[0,1,2,3] row_mask:0xf bank_mask:0xc
    v_mov_b32_dpp v60, v74 quad_perm:[0,1,2,3] row_mask:0xf bank_mask:0xc
    v_mov_b32_dpp v61, v75 quad_perm:[0,1,2,3] row_mask:0xf bank_mask:0xc
    v_mov_b32_dpp v64, v76 quad_perm:[0,1,2,3] row_mask:0xf bank_mask:0xc
    v_mov_b32_dpp v65, v77 quad_perm:[0,1,2,3] row_mask:0xf bank_mask:0xc
    v_mov_b32_dpp v68, v78 quad_perm:[0,1,2,3] row_mask:0xf bank_mask:0xc
    v_mov_b32_dpp v69, v79 quad_perm:[0,1,2,3] row_mask:0xf bank_mask:0xc
    v_perm_b32 v72, v60, v56, s44
    v_perm_b32 v73, v68, v64, s44
    v_perm_b32 v74, v62, v58, s44
    v_perm_b32 v75, v70, v66, s44
    v_perm_b32 v76, v60, v56, s45
    v_perm_b32 v77, v68, v64, s45
    v_perm_b32 v78, v62, v58, s45
    v_perm_b32 v79, v70, v66, s45
    v_perm_b32 v80, v61, v57, s44
    v_perm_b32 v81, v69, v65, s44
    v_perm_b32 v82, v63, v59, s44
    v_perm_b32 v83, v71, v67, s44
    v_perm_b32 v84, v61, v57, s45
    v_perm_b32 v85, v69, v65, s45
    v_perm_b32 v86, v63, v59, s45
    v_perm_b32 v87, v71, v67, s45
    s_waitcnt vmcnt(0)
    global_load_dwordx4 v[24:27], v5, s[26:27] offset:0
    global_load_dwordx4 v[28:31], v5, s[26:27] offset:512
    global_load_dwordx4 v[32:35], v5, s[26:27] offset:1024
    global_load_dwordx4 v[36:39], v5, s[26:27] offset:1536
    v_mov_b32_dpp v56, v42 row_ror:8 row_mask:0xf bank_mask:0xf
    v_mov_b32_dpp v57, v43 row_ror:8 row_mask:0xf bank_mask:0xf
    v_mov_b32_dpp v58, v46 row_ror:8 row_mask:0xf bank_mask:0xf
    v_mov_b32_dpp v59, v47 row_ror:8 row_mask:0xf bank_mask:0xf
    v_mov_b32_dpp v60, v50 row_ror:8 row_mask:0xf bank_mask:0xf
    v_mov_b32_dpp v61, v51 row_ror:8 row_mask:0xf bank_mask:0xf
    v_mov_b32_dpp v62, v54 row_ror:8 row_mask:0xf bank_mask:0xf
    v_mov_b32_dpp v63, v55 row_ror:8 row_mask:0xf bank_mask:0xf
    v_mov_b32_dpp v42, v40 row_ror:8 row_mask:0xf bank_mask:0x3
    v_mov_b32_dpp v43, v41 row_ror:8 row_mask:0xf bank_mask:0x3
    v_mov_b32_dpp v46, v44 row_ror:8 row_mask:0xf bank_mask:0x3
    v_mov_b32_dpp v47, v45 row_ror:8 row_mask:0xf bank_mask:0x3
    v_mov_b32_dpp v50, v48 row_ror:8 row_mask:0xf bank_mask:0x3
    v_mov_b32_dpp v51, v49 row_ror:8 row_mask:0xf bank_mask:0x3
    v_mov_b32_dpp v54, v52 row_ror:8 row_mask:0xf bank_mask:0x3
    v_mov_b32_dpp v55, v53 row_ror:8 row_mask:0xf bank_mask:0x3
    v_mov_b32_dpp v40, v56 quad_perm:[0,1,2,3] row_mask:0xf bank_mask:0xc
    v_mov_b32_dpp v41, v57 quad_perm:[0,1,2,3] row_mask:0xf bank_mask:0xc
    v_mov_b32_dpp v44, v58 quad_perm:[0,1,2,3] row_mask:0xf bank_mask:0xc
    v_mov_b32_dpp v45, v59 quad_perm:[0,1,2,3] row_mask:0xf bank_mask:0xc
    v_mov_b32_dpp v48, v60 quad_perm:[0,1,2,3] row_mask:0xf bank_mask:0xc
    v_mov_b32_dpp v49, v61 quad_perm:[0,1,2,3] row_mask:0xf bank_mask:0xc
    v_mov_b32_dpp v52, v62 quad_perm:[0,1,2,3] row_mask:0xf bank_mask:0xc
    v_mov_b32_dpp v53, v63 quad_perm:[0,1,2,3] row_mask:0xf bank_mask:0xc
    v_perm_b32 v56, v44, v40, s44
    v_perm_b32 v57, v52, v48, s44
    v_perm_b32 v58, v46, v42, s44
    v_perm_b32 v59, v54, v50, s44
    v_perm_b32 v60, v44, v40, s45
    v_perm_b32 v61, v52, v48, s45
    v_perm_b32 v62, v46, v42, s45
    v_perm_b32 v63, v54, v50, s45
    v_perm_b32 v64, v45, v41, s44
    v_perm_b32 v65, v53, v49, s44
    v_perm_b32 v66, v47, v43, s44
    v_perm_b32 v67, v55, v51, s44
    v_perm_b32 v68, v45, v41, s45
    v_perm_b32 v69, v53, v49, s45
    v_perm_b32 v70, v47, v43, s45
    v_perm_b32 v71, v55, v51, s45
    s_waitcnt vmcnt(0)
    v_mov_b32_dpp v40, v26 row_ror:8 row_mask:0xf bank_mask:0xf
    v_mov_b32_dpp v41, v27 row_ror:8 row_mask:0xf bank_mask:0xf
    v_mov_b32_dpp v42, v30 row_ror:8 row_mask:0xf bank_mask:0xf
    v_mov_b32_dpp v43, v31 row_ror:8 row_mask:0xf bank_mask:0xf
    v_mov_b32_dpp v44, v34 row_ror:8 row_mask:0xf bank_mask:0xf
    v_mov_b32_dpp v45, v35 row_ror:8 row_mask:0xf bank_mask:0xf
    v_mov_b32_dpp v46, v38 row_ror:8 row_mask:0xf bank_mask:0xf
    v_mov_b32_dpp v47, v39 row_ror:8 row_mask:0xf bank_mask:0xf
    v_mov_b32_dpp v26, v24 row_ror:8 row_mask:0xf bank_mask:0x3
    v_mov_b32_dpp v27, v25 row_ror:8 row_mask:0xf bank_mask:0x3
    v_mov_b32_dpp v30, v28 row_ror:8 row_mask:0xf bank_mask:0x3
    v_mov_b32_dpp v31, v29 row_ror:8 row_mask:0xf bank_mask:0x3
    v_mov_b32_dpp v34, v32 row_ror:8 row_mask:0xf bank_mask:0x3
    v_mov_b32_dpp v35, v33 row_ror:8 row_mask:0xf bank_mask:0x3
    v_mov_b32_dpp v38, v36 row_ror:8 row_mask:0xf bank_mask:0x3
    v_mov_b32_dpp v39, v37 row_ror:8 row_mask:0xf bank_mask:0x3
    v_mov_b32_dpp v24, v40 quad_perm:[0,1,2,3] row_mask:0xf bank_mask:0xc
    v_mov_b32_dpp v25, v41 quad_perm:[0,1,2,3] row_mask:0xf bank_mask:0xc
    v_mov_b32_dpp v28, v42 quad_perm:[0,1,2,3] row_mask:0xf bank_mask:0xc
    v_mov_b32_dpp v29, v43 quad_perm:[0,1,2,3] row_mask:0xf bank_mask:0xc
    v_mov_b32_dpp v32, v44 quad_perm:[0,1,2,3] row_mask:0xf bank_mask:0xc
    v_mov_b32_dpp v33, v45 quad_perm:[0,1,2,3] row_mask:0xf bank_mask:0xc
    v_mov_b32_dpp v36, v46 quad_perm:[0,1,2,3] row_mask:0xf bank_mask:0xc
    v_mov_b32_dpp v37, v47 quad_perm:[0,1,2,3] row_mask:0xf bank_mask:0xc
    v_perm_b32 v40, v28, v24, s44
    v_perm_b32 v41, v36, v32, s44
    v_perm_b32 v42, v30, v26, s44
    v_perm_b32 v43, v38, v34, s44
    v_perm_b32 v44, v28, v24, s45
    v_perm_b32 v45, v36, v32, s45
    v_perm_b32 v46, v30, v26, s45
    v_perm_b32 v47, v38, v34, s45
    v_perm_b32 v48, v29, v25, s44
    v_perm_b32 v49, v37, v33, s44
    v_perm_b32 v50, v31, v27, s44
    v_perm_b32 v51, v39, v35, s44
    v_perm_b32 v52, v29, v25, s45
    v_perm_b32 v53, v37, v33, s45
    v_perm_b32 v54, v31, v27, s45
    v_perm_b32 v55, v39, v35, s45
gm_wdone:
    v_lshrrev_b32 v1, 4, v3
    v_lshlrev_b32 v1, 11, v1
    v_and_b32 v4, 7, v3
    v_lshl_add_u32 v1, v4, 4, v1
    v_bfe_u32 v4, v3, 3, 1
    v_lshl_add_u32 v1, v4, 9, v1
    v_and_b32 v4, 3, v3
    v_lshrrev_b32 v5, 2, v3
    v_mul_u32_u24 v0, 576, v4
    v_lshl_add_u32 v0, v5, 3, v0
    v_add_u32 v0, 40960, v0
    s_lshl_b32 s38, s41, 11
    s_lshl_b32 s53, s17, 7
    s_add_u32 s38, s38, s53
    s_mov_b32 s36, 0x24924924
    s_mov_b32 s39, 0
    s_waitcnt vmcnt(0)
gm_poll:
    v_mov_b32 v2, 0
    ds_read_b32 v2, v2 offset:276
    s_waitcnt lgkmcnt(0)
    v_readfirstlane_b32 s52, v2
    s_and_b32 s52, s52, s36
    s_cbranch_scc1 gm_go
    s_sleep 2
    s_branch gm_poll
gm_go:
    s_ff1_i32_b32 s52, s52
    s_bitset0_b32 s36, s52
    s_mul_i32 s52, s52, 11
    s_bfe_u32 s53, s52, 0x10005
    s_bfe_u32 s52, s52, 0x30006
    s_mul_i32 s35, s53, 61440
    s_mul_i32 s31, s52, 2304
    s_add_u32 s31, s31, s35
    s_sub_u32 s35, s31, s39
    v_add_u32 v0, s35, v0
    ds_read_b64_tr_b16 v[12:13], v0 offset:0
    ds_read_b64_tr_b16 v[14:15], v0 offset:128
    ds_read_b64_tr_b16 v[16:17], v0 offset:256
    ds_read_b64_tr_b16 v[18:19], v0 offset:384
    s_mov_b32 s39, s31
    s_mul_i32 s33, s53, 5
    s_add_u32 s33, s33, s52
    s_lshl_b32 s33, s33, 13
    s_add_u32 s33, s33, s38
    s_mov_b32 s37, s33
    s_mov_b32 s32, 0x7ffffff0
gm_loop:
    s_waitcnt lgkmcnt(2)
    v_mfma_f32_16x16x32_bf16 v[24:27], v[12:15], v[40:43], 0
    s_setprio 3
    v_cvt_pk_bf16_f32 v7, v33, v37
    v_cvt_pk_bf16_f32 v5, v32, v36
    ds_read_b64_tr_b16 v[20:21], v0 offset:15360
    s_setprio 0
    v_mfma_f32_16x16x32_bf16 v[28:31], v[12:15], v[44:47], 0
    s_setprio 3
    v_cvt_pk_bf16_f32 v11, v35, v39
    v_cvt_pk_bf16_f32 v9, v34, v38
    ds_read_b64_tr_b16 v[22:23], v0 offset:15488
    s_setprio 0
    v_mfma_f32_16x16x32_bf16 v[32:35], v[12:15], v[48:51], 0
    s_setprio 3
    v_mov_b32_dpp v2, v6 row_ror:8 row_mask:0xf bank_mask:0xf
    v_mov_b32_dpp v3, v7 row_ror:8 row_mask:0xf bank_mask:0xf
    s_setprio 0
    v_mfma_f32_16x16x32_bf16 v[36:39], v[12:15], v[52:55], 0
    s_setprio 3
    v_mov_b32_dpp v6, v4 row_ror:8 row_mask:0xf bank_mask:0x3
    v_mov_b32_dpp v7, v5 row_ror:8 row_mask:0xf bank_mask:0x3
    s_setprio 0
    s_waitcnt lgkmcnt(2)
    v_mfma_f32_16x16x32_bf16 v[24:27], v[16:19], v[56:59], v[24:27]
    s_setprio 3
    ds_read_b64_tr_b16 v[12:13], v0 offset:15616
    v_mov_b32_dpp v4, v2 quad_perm:[0,1,2,3] row_mask:0xf bank_mask:0xc
    s_setprio 0
    v_mfma_f32_16x16x32_bf16 v[28:31], v[16:19], v[60:63], v[28:31]
    s_setprio 3
    ds_read_b64_tr_b16 v[14:15], v0 offset:15744
    v_mov_b32_dpp v5, v3 quad_perm:[0,1,2,3] row_mask:0xf bank_mask:0xc
    s_setprio 0
    v_mfma_f32_16x16x32_bf16 v[32:35], v[16:19], v[64:67], v[32:35]
    s_setprio 3
    buffer_store_dwordx4 v[4:7], v1, s[12:15], s32 offen offset:0 sc0 sc1
    v_mov_b32_dpp v2, v10 row_ror:8 row_mask:0xf bank_mask:0xf
    s_setprio 0
    v_mfma_f32_16x16x32_bf16 v[36:39], v[16:19], v[68:71], v[36:39]
    s_setprio 3
    v_mov_b32_dpp v3, v11 row_ror:8 row_mask:0xf bank_mask:0xf
    v_mov_b32_dpp v10, v8 row_ror:8 row_mask:0xf bank_mask:0x3
    s_setprio 0
    s_waitcnt lgkmcnt(2)
    v_mfma_f32_16x16x32_bf16 v[24:27], v[20:23], v[72:75], v[24:27]
    s_setprio 3
    ds_read_b64_tr_b16 v[16:17], v0 offset:30720
    v_mov_b32_dpp v11, v9 row_ror:8 row_mask:0xf bank_mask:0x3
    s_setprio 0
    v_mfma_f32_16x16x32_bf16 v[28:31], v[20:23], v[76:79], v[28:31]
    s_setprio 3
    ds_read_b64_tr_b16 v[18:19], v0 offset:30848
    v_mov_b32_dpp v8, v2 quad_perm:[0,1,2,3] row_mask:0xf bank_mask:0xc
    s_setprio 0
    v_mfma_f32_16x16x32_bf16 v[32:35], v[20:23], v[80:83], v[32:35]
    s_setprio 3
    v_mov_b32_dpp v9, v3 quad_perm:[0,1,2,3] row_mask:0xf bank_mask:0xc
    buffer_store_dwordx4 v[8:11], v1, s[12:15], s32 offen offset:1024 sc0 sc1
    s_setprio 0
    v_mfma_f32_16x16x32_bf16 v[36:39], v[20:23], v[84:87], v[36:39]
    s_waitcnt lgkmcnt(2)
    v_mfma_f32_16x16x32_bf16 v[24:27], v[12:15], v[88:91], v[24:27]
    ds_read_b64_tr_b16 v[20:21], v0 offset:30976
    v_mfma_f32_16x16x32_bf16 v[28:31], v[12:15], v[92:95], v[28:31]
    ds_read_b64_tr_b16 v[22:23], v0 offset:31104
    v_mfma_f32_16x16x32_bf16 v[32:35], v[12:15], v[96:99], v[32:35]
    s_setprio 3
    v_mov_b32 v2, 0
    s_setprio 0
    v_mfma_f32_16x16x32_bf16 v[36:39], v[12:15], v[100:103], v[36:39]
    ds_read_b32 v2, v2 offset:276
    s_waitcnt lgkmcnt(3)
    v_mfma_f32_16x16x32_bf16 v[24:27], v[16:19], v[104:107], v[24:27]
    ds_read_b64_tr_b16 v[12:13], v0 offset:46080
    v_mfma_f32_16x16x32_bf16 v[28:31], v[16:19], v[108:111], v[28:31]
    ds_read_b64_tr_b16 v[14:15], v0 offset:46208
    v_mfma_f32_16x16x32_bf16 v[32:35], v[16:19], v[112:115], v[32:35]
    s_setprio 3
    s_waitcnt lgkmcnt(2)
    v_readfirstlane_b32 s52, v2
    s_and_b32 s52, s52, s36
    s_setprio 0
    v_mfma_f32_16x16x32_bf16 v[36:39], v[16:19], v[116:119], v[36:39]
    s_cselect_b32 s34, 1, 0
    s_ff1_i32_b32 s52, s52
    s_waitcnt lgkmcnt(2)
    v_mfma_f32_16x16x32_bf16 v[24:27], v[20:23], v[120:123], v[24:27]
    ds_read_b64_tr_b16 v[16:17], v0 offset:46336
    s_bitset0_b32 s36, s52
    s_mul_i32 s52, s52, 11
    v_mfma_f32_16x16x32_bf16 v[28:31], v[20:23], v[124:127], v[28:31]
    ds_read_b64_tr_b16 v[18:19], v0 offset:46464
    s_bfe_u32 s53, s52, 0x10005
    s_bfe_u32 s52, s52, 0x30006
    v_mfma_f32_16x16x32_bf16 v[32:35], v[20:23], v[128:131], v[32:35]
    s_mul_i32 s35, s53, 61440
    s_mul_i32 s31, s52, 2304
    s_add_u32 s31, s31, s35
    v_mfma_f32_16x16x32_bf16 v[36:39], v[20:23], v[132:135], v[36:39]
    s_setprio 3
    s_sub_u32 s35, s31, s39
    v_add_u32 v0, s35, v0
    s_setprio 0
    s_waitcnt lgkmcnt(2)
    v_mfma_f32_16x16x32_bf16 v[24:27], v[12:15], v[136:139], v[24:27]
    ds_read_b64_tr_b16 v[20:21], v0 offset:0
    v_mfma_f32_16x16x32_bf16 v[28:31], v[12:15], v[140:143], v[28:31]
    ds_read_b64_tr_b16 v[22:23], v0 offset:128
    v_mfma_f32_16x16x32_bf16 v[32:35], v[12:15], v[144:147], v[32:35]
    s_mov_b32 s39, s31
    s_mul_i32 s33, s53, 5
    s_add_u32 s33, s33, s52
    v_mfma_f32_16x16x32_bf16 v[36:39], v[12:15], v[148:151], v[36:39]
    s_lshl_b32 s33, s33, 13
    s_add_u32 s33, s33, s38
    s_waitcnt lgkmcnt(2)
    v_mfma_f32_16x16x32_bf16 v[24:27], v[16:19], v[152:155], v[24:27]
    ds_read_b64_tr_b16 v[12:13], v0 offset:256
    v_mfma_f32_16x16x32_bf16 v[28:31], v[16:19], v[156:159], v[28:31]
    ds_read_b64_tr_b16 v[14:15], v0 offset:384
    s_mov_b32 s32, s37
    s_mov_b32 s37, s33
    v_mfma_f32_16x16x32_bf16 v[32:35], v[16:19], v[160:163], v[32:35]
    s_cmp_eq_u32 s34, 0
    s_nop 1
    v_mfma_f32_16x16x32_bf16 v[36:39], v[16:19], v[164:167], v[36:39]
    s_setprio 3
    v_cvt_pk_bf16_f32 v4, v24, v28
    v_cvt_pk_bf16_f32 v6, v25, v29
    v_cvt_pk_bf16_f32 v8, v26, v30
    v_cvt_pk_bf16_f32 v10, v27, v31
    s_setprio 0
    s_cbranch_scc1 gm_drain
    s_waitcnt lgkmcnt(2)
    v_mfma_f32_16x16x32_bf16 v[24:27], v[20:23], v[40:43], 0
    s_setprio 3
    v_cvt_pk_bf16_f32 v7, v33, v37
    v_cvt_pk_bf16_f32 v5, v32, v36
    ds_read_b64_tr_b16 v[16:17], v0 offset:15360
    s_setprio 0
    v_mfma_f32_16x16x32_bf16 v[28:31], v[20:23], v[44:47], 0
    s_setprio 3
    v_cvt_pk_bf16_f32 v11, v35, v39
    v_cvt_pk_bf16_f32 v9, v34, v38
    ds_read_b64_tr_b16 v[18:19], v0 offset:15488
    s_setprio 0
    v_mfma_f32_16x16x32_bf16 v[32:35], v[20:23], v[48:51], 0
    s_setprio 3
    v_mov_b32_dpp v2, v6 row_ror:8 row_mask:0xf bank_mask:0xf
    v_mov_b32_dpp v3, v7 row_ror:8 row_mask:0xf bank_mask:0xf
    s_setprio 0
    v_mfma_f32_16x16x32_bf16 v[36:39], v[20:23], v[52:55], 0
    s_setprio 3
    v_mov_b32_dpp v6, v4 row_ror:8 row_mask:0xf bank_mask:0x3
    v_mov_b32_dpp v7, v5 row_ror:8 row_mask:0xf bank_mask:0x3
    s_setprio 0
    s_waitcnt lgkmcnt(2)
    v_mfma_f32_16x16x32_bf16 v[24:27], v[12:15], v[56:59], v[24:27]
    s_setprio 3
    ds_read_b64_tr_b16 v[20:21], v0 offset:15616
    v_mov_b32_dpp v4, v2 quad_perm:[0,1,2,3] row_mask:0xf bank_mask:0xc
    s_setprio 0
    v_mfma_f32_16x16x32_bf16 v[28:31], v[12:15], v[60:63], v[28:31]
    s_setprio 3
    ds_read_b64_tr_b16 v[22:23], v0 offset:15744
    v_mov_b32_dpp v5, v3 quad_perm:[0,1,2,3] row_mask:0xf bank_mask:0xc
    s_setprio 0
    v_mfma_f32_16x16x32_bf16 v[32:35], v[12:15], v[64:67], v[32:35]
    s_setprio 3
    buffer_store_dwordx4 v[4:7], v1, s[12:15], s32 offen offset:0 sc0 sc1
    v_mov_b32_dpp v2, v10 row_ror:8 row_mask:0xf bank_mask:0xf
    s_setprio 0
    v_mfma_f32_16x16x32_bf16 v[36:39], v[12:15], v[68:71], v[36:39]
    s_setprio 3
    v_mov_b32_dpp v3, v11 row_ror:8 row_mask:0xf bank_mask:0xf
    v_mov_b32_dpp v10, v8 row_ror:8 row_mask:0xf bank_mask:0x3
    s_setprio 0
    s_waitcnt lgkmcnt(2)
    v_mfma_f32_16x16x32_bf16 v[24:27], v[16:19], v[72:75], v[24:27]
    s_setprio 3
    ds_read_b64_tr_b16 v[12:13], v0 offset:30720
    v_mov_b32_dpp v11, v9 row_ror:8 row_mask:0xf bank_mask:0x3
    s_setprio 0
    v_mfma_f32_16x16x32_bf16 v[28:31], v[16:19], v[76:79], v[28:31]
    s_setprio 3
    ds_read_b64_tr_b16 v[14:15], v0 offset:30848
    v_mov_b32_dpp v8, v2 quad_perm:[0,1,2,3] row_mask:0xf bank_mask:0xc
    s_setprio 0
    v_mfma_f32_16x16x32_bf16 v[32:35], v[16:19], v[80:83], v[32:35]
    s_setprio 3
    v_mov_b32_dpp v9, v3 quad_perm:[0,1,2,3] row_mask:0xf bank_mask:0xc
    buffer_store_dwordx4 v[8:11], v1, s[12:15], s32 offen offset:1024 sc0 sc1
    s_setprio 0
    v_mfma_f32_16x16x32_bf16 v[36:39], v[16:19], v[84:87], v[36:39]
    s_waitcnt lgkmcnt(2)
    v_mfma_f32_16x16x32_bf16 v[24:27], v[20:23], v[88:91], v[24:27]
    ds_read_b64_tr_b16 v[16:17], v0 offset:30976
    v_mfma_f32_16x16x32_bf16 v[28:31], v[20:23], v[92:95], v[28:31]
    ds_read_b64_tr_b16 v[18:19], v0 offset:31104
    v_mfma_f32_16x16x32_bf16 v[32:35], v[20:23], v[96:99], v[32:35]
    s_setprio 3
    v_mov_b32 v2, 0
    s_setprio 0
    v_mfma_f32_16x16x32_bf16 v[36:39], v[20:23], v[100:103], v[36:39]
    ds_read_b32 v2, v2 offset:276
    s_waitcnt lgkmcnt(3)
    v_mfma_f32_16x16x32_bf16 v[24:27], v[12:15], v[104:107], v[24:27]
    ds_read_b64_tr_b16 v[20:21], v0 offset:46080
    v_mfma_f32_16x16x32_bf16 v[28:31], v[12:15], v[108:111], v[28:31]
    ds_read_b64_tr_b16 v[22:23], v0 offset:46208
    v_mfma_f32_16x16x32_bf16 v[32:35], v[12:15], v[112:115], v[32:35]
    s_setprio 3
    s_waitcnt lgkmcnt(2)
    v_readfirstlane_b32 s52, v2
    s_and_b32 s52, s52, s36
    s_setprio 0
    v_mfma_f32_16x16x32_bf16 v[36:39], v[12:15], v[116:119], v[36:39]
    s_cselect_b32 s34, 1, 0
    s_ff1_i32_b32 s52, s52
    s_waitcnt lgkmcnt(2)
    v_mfma_f32_16x16x32_bf16 v[24:27], v[16:19], v[120:123], v[24:27]
    ds_read_b64_tr_b16 v[12:13], v0 offset:46336
    s_bitset0_b32 s36, s52
    s_mul_i32 s52, s52, 11
    v_mfma_f32_16x16x32_bf16 v[28:31], v[16:19], v[124:127], v[28:31]
    ds_read_b64_tr_b16 v[14:15], v0 offset:46464
    s_bfe_u32 s53, s52, 0x10005
    s_bfe_u32 s52, s52, 0x30006
    v_mfma_f32_16x16x32_bf16 v[32:35], v[16:19], v[128:131], v[32:35]
    s_mul_i32 s35, s53, 61440
    s_mul_i32 s31, s52, 2304
    s_add_u32 s31, s31, s35
    v_mfma_f32_16x16x32_bf16 v[36:39], v[16:19], v[132:135], v[36:39]
    s_setprio 3
    s_sub_u32 s35, s31, s39
    v_add_u32 v0, s35, v0
    s_setprio 0
    s_waitcnt lgkmcnt(2)
    v_mfma_f32_16x16x32_bf16 v[24:27], v[20:23], v[136:139], v[24:27]
    ds_read_b64_tr_b16 v[16:17], v0 offset:0
    v_mfma_f32_16x16x32_bf16 v[28:31], v[20:23], v[140:143], v[28:31]
    ds_read_b64_tr_b16 v[18:19], v0 offset:128
    v_mfma_f32_16x16x32_bf16 v[32:35], v[20:23], v[144:147], v[32:35]
    s_mov_b32 s39, s31
    s_mul_i32 s33, s53, 5
    s_add_u32 s33, s33, s52
    v_mfma_f32_16x16x32_bf16 v[36:39], v[20:23], v[148:151], v[36:39]
    s_lshl_b32 s33, s33, 13
    s_add_u32 s33, s33, s38
    s_waitcnt lgkmcnt(2)
    v_mfma_f32_16x16x32_bf16 v[24:27], v[12:15], v[152:155], v[24:27]
    ds_read_b64_tr_b16 v[20:21], v0 offset:256
    v_mfma_f32_16x16x32_bf16 v[28:31], v[12:15], v[156:159], v[28:31]
    ds_read_b64_tr_b16 v[22:23], v0 offset:384
    s_mov_b32 s32, s37
    s_mov_b32 s37, s33
    v_mfma_f32_16x16x32_bf16 v[32:35], v[12:15], v[160:163], v[32:35]
    s_cmp_eq_u32 s34, 0
    s_nop 1
    v_mfma_f32_16x16x32_bf16 v[36:39], v[12:15], v[164:167], v[36:39]
    s_setprio 3
    v_cvt_pk_bf16_f32 v4, v24, v28
    v_cvt_pk_bf16_f32 v6, v25, v29
    v_cvt_pk_bf16_f32 v8, v26, v30
    v_cvt_pk_bf16_f32 v10, v27, v31
    s_setprio 0
    s_cbranch_scc1 gm_drain
    s_waitcnt lgkmcnt(2)
    v_mfma_f32_16x16x32_bf16 v[24:27], v[16:19], v[40:43], 0
    s_setprio 3
    v_cvt_pk_bf16_f32 v7, v33, v37
    v_cvt_pk_bf16_f32 v5, v32, v36
    ds_read_b64_tr_b16 v[12:13], v0 offset:15360
    s_setprio 0
    v_mfma_f32_16x16x32_bf16 v[28:31], v[16:19], v[44:47], 0
    s_setprio 3
    v_cvt_pk_bf16_f32 v11, v35, v39
    v_cvt_pk_bf16_f32 v9, v34, v38
    ds_read_b64_tr_b16 v[14:15], v0 offset:15488
    s_setprio 0
    v_mfma_f32_16x16x32_bf16 v[32:35], v[16:19], v[48:51], 0
    s_setprio 3
    v_mov_b32_dpp v2, v6 row_ror:8 row_mask:0xf bank_mask:0xf
    v_mov_b32_dpp v3, v7 row_ror:8 row_mask:0xf bank_mask:0xf
    s_setprio 0
    v_mfma_f32_16x16x32_bf16 v[36:39], v[16:19], v[52:55], 0
    s_setprio 3
    v_mov_b32_dpp v6, v4 row_ror:8 row_mask:0xf bank_mask:0x3
    v_mov_b32_dpp v7, v5 row_ror:8 row_mask:0xf bank_mask:0x3
    s_setprio 0
    s_waitcnt lgkmcnt(2)
    v_mfma_f32_16x16x32_bf16 v[24:27], v[20:23], v[56:59], v[24:27]
    s_setprio 3
    ds_read_b64_tr_b16 v[16:17], v0 offset:15616
    v_mov_b32_dpp v4, v2 quad_perm:[0,1,2,3] row_mask:0xf bank_mask:0xc
    s_setprio 0
    v_mfma_f32_16x16x32_bf16 v[28:31], v[20:23], v[60:63], v[28:31]
    s_setprio 3
    ds_read_b64_tr_b16 v[18:19], v0 offset:15744
    v_mov_b32_dpp v5, v3 quad_perm:[0,1,2,3] row_mask:0xf bank_mask:0xc
    s_setprio 0
    v_mfma_f32_16x16x32_bf16 v[32:35], v[20:23], v[64:67], v[32:35]
    s_setprio 3
    buffer_store_dwordx4 v[4:7], v1, s[12:15], s32 offen offset:0 sc0 sc1
    v_mov_b32_dpp v2, v10 row_ror:8 row_mask:0xf bank_mask:0xf
    s_setprio 0
    v_mfma_f32_16x16x32_bf16 v[36:39], v[20:23], v[68:71], v[36:39]
    s_setprio 3
    v_mov_b32_dpp v3, v11 row_ror:8 row_mask:0xf bank_mask:0xf
    v_mov_b32_dpp v10, v8 row_ror:8 row_mask:0xf bank_mask:0x3
    s_setprio 0
    s_waitcnt lgkmcnt(2)
    v_mfma_f32_16x16x32_bf16 v[24:27], v[12:15], v[72:75], v[24:27]
    s_setprio 3
    ds_read_b64_tr_b16 v[20:21], v0 offset:30720
    v_mov_b32_dpp v11, v9 row_ror:8 row_mask:0xf bank_mask:0x3
    s_setprio 0
    v_mfma_f32_16x16x32_bf16 v[28:31], v[12:15], v[76:79], v[28:31]
    s_setprio 3
    ds_read_b64_tr_b16 v[22:23], v0 offset:30848
    v_mov_b32_dpp v8, v2 quad_perm:[0,1,2,3] row_mask:0xf bank_mask:0xc
    s_setprio 0
    v_mfma_f32_16x16x32_bf16 v[32:35], v[12:15], v[80:83], v[32:35]
    s_setprio 3
    v_mov_b32_dpp v9, v3 quad_perm:[0,1,2,3] row_mask:0xf bank_mask:0xc
    buffer_store_dwordx4 v[8:11], v1, s[12:15], s32 offen offset:1024 sc0 sc1
    s_setprio 0
    v_mfma_f32_16x16x32_bf16 v[36:39], v[12:15], v[84:87], v[36:39]
    s_waitcnt lgkmcnt(2)
    v_mfma_f32_16x16x32_bf16 v[24:27], v[16:19], v[88:91], v[24:27]
    ds_read_b64_tr_b16 v[12:13], v0 offset:30976
    v_mfma_f32_16x16x32_bf16 v[28:31], v[16:19], v[92:95], v[28:31]
    ds_read_b64_tr_b16 v[14:15], v0 offset:31104
    v_mfma_f32_16x16x32_bf16 v[32:35], v[16:19], v[96:99], v[32:35]
    s_setprio 3
    v_mov_b32 v2, 0
    s_setprio 0
    v_mfma_f32_16x16x32_bf16 v[36:39], v[16:19], v[100:103], v[36:39]
    ds_read_b32 v2, v2 offset:276
    s_waitcnt lgkmcnt(3)
    v_mfma_f32_16x16x32_bf16 v[24:27], v[20:23], v[104:107], v[24:27]
    ds_read_b64_tr_b16 v[16:17], v0 offset:46080
    v_mfma_f32_16x16x32_bf16 v[28:31], v[20:23], v[108:111], v[28:31]
    ds_read_b64_tr_b16 v[18:19], v0 offset:46208
    v_mfma_f32_16x16x32_bf16 v[32:35], v[20:23], v[112:115], v[32:35]
    s_setprio 3
    s_waitcnt lgkmcnt(2)
    v_readfirstlane_b32 s52, v2
    s_and_b32 s52, s52, s36
    s_setprio 0
    v_mfma_f32_16x16x32_bf16 v[36:39], v[20:23], v[116:119], v[36:39]
    s_cselect_b32 s34, 1, 0
    s_ff1_i32_b32 s52, s52
    s_waitcnt lgkmcnt(2)
    v_mfma_f32_16x16x32_bf16 v[24:27], v[12:15], v[120:123], v[24:27]
    ds_read_b64_tr_b16 v[20:21], v0 offset:46336
    s_bitset0_b32 s36, s52
    s_mul_i32 s52, s52, 11
    v_mfma_f32_16x16x32_bf16 v[28:31], v[12:15], v[124:127], v[28:31]
    ds_read_b64_tr_b16 v[22:23], v0 offset:46464
    s_bfe_u32 s53, s52, 0x10005
    s_bfe_u32 s52, s52, 0x30006
    v_mfma_f32_16x16x32_bf16 v[32:35], v[12:15], v[128:131], v[32:35]
    s_mul_i32 s35, s53, 61440
    s_mul_i32 s31, s52, 2304
    s_add_u32 s31, s31, s35
    v_mfma_f32_16x16x32_bf16 v[36:39], v[12:15], v[132:135], v[36:39]
    s_setprio 3
    s_sub_u32 s35, s31, s39
    v_add_u32 v0, s35, v0
    s_setprio 0
    s_waitcnt lgkmcnt(2)
    v_mfma_f32_16x16x32_bf16 v[24:27], v[16:19], v[136:139], v[24:27]
    ds_read_b64_tr_b16 v[12:13], v0 offset:0
    v_mfma_f32_16x16x32_bf16 v[28:31], v[16:19], v[140:143], v[28:31]
    ds_read_b64_tr_b16 v[14:15], v0 offset:128
    v_mfma_f32_16x16x32_bf16 v[32:35], v[16:19], v[144:147], v[32:35]
    s_mov_b32 s39, s31
    s_mul_i32 s33, s53, 5
    s_add_u32 s33, s33, s52
    v_mfma_f32_16x16x32_bf16 v[36:39], v[16:19], v[148:151], v[36:39]
    s_lshl_b32 s33, s33, 13
    s_add_u32 s33, s33, s38
    s_waitcnt lgkmcnt(2)
    v_mfma_f32_16x16x32_bf16 v[24:27], v[20:23], v[152:155], v[24:27]
    ds_read_b64_tr_b16 v[16:17], v0 offset:256
    v_mfma_f32_16x16x32_bf16 v[28:31], v[20:23], v[156:159], v[28:31]
    ds_read_b64_tr_b16 v[18:19], v0 offset:384
    s_mov_b32 s32, s37
    s_mov_b32 s37, s33
    v_mfma_f32_16x16x32_bf16 v[32:35], v[20:23], v[160:163], v[32:35]
    s_cmp_eq_u32 s34, 0
    s_nop 1
    v_mfma_f32_16x16x32_bf16 v[36:39], v[20:23], v[164:167], v[36:39]
    s_setprio 3
    v_cvt_pk_bf16_f32 v4, v24, v28
    v_cvt_pk_bf16_f32 v6, v25, v29
    v_cvt_pk_bf16_f32 v8, v26, v30
    v_cvt_pk_bf16_f32 v10, v27, v31
    s_setprio 0
    s_cbranch_scc0 gm_loop
gm_drain:
    s_nop 2
    s_setprio 3
    v_cvt_pk_bf16_f32 v7, v33, v37
    v_cvt_pk_bf16_f32 v5, v32, v36
    v_cvt_pk_bf16_f32 v11, v35, v39
    v_cvt_pk_bf16_f32 v9, v34, v38
    v_mov_b32_dpp v2, v6 row_ror:8 row_mask:0xf bank_mask:0xf
    v_mov_b32_dpp v3, v7 row_ror:8 row_mask:0xf bank_mask:0xf
    v_mov_b32_dpp v6, v4 row_ror:8 row_mask:0xf bank_mask:0x3
    v_mov_b32_dpp v7, v5 row_ror:8 row_mask:0xf bank_mask:0x3
    v_mov_b32_dpp v4, v2 quad_perm:[0,1,2,3] row_mask:0xf bank_mask:0xc
    v_mov_b32_dpp v5, v3 quad_perm:[0,1,2,3] row_mask:0xf bank_mask:0xc
    buffer_store_dwordx4 v[4:7], v1, s[12:15], s32 offen offset:0 sc0 sc1
    v_mov_b32_dpp v2, v10 row_ror:8 row_mask:0xf bank_mask:0xf
    v_mov_b32_dpp v3, v11 row_ror:8 row_mask:0xf bank_mask:0xf
    v_mov_b32_dpp v10, v8 row_ror:8 row_mask:0xf bank_mask:0x3
    v_mov_b32_dpp v11, v9 row_ror:8 row_mask:0xf bank_mask:0x3
    v_mov_b32_dpp v8, v2 quad_perm:[0,1,2,3] row_mask:0xf bank_mask:0xc
    v_mov_b32_dpp v9, v3 quad_perm:[0,1,2,3] row_mask:0xf bank_mask:0xc
    buffer_store_dwordx4 v[8:11], v1, s[12:15], s32 offen offset:1024 sc0 sc1
    s_setprio 0
    s_cmp_lg_u32 s36, 0
    s_cbranch_scc1 gm_poll
    s_endpgm
gm_wait2:
    v_mov_b32 v15, 0
    ds_read_b32 v17, v15 offset:304
    s_waitcnt lgkmcnt(0)
    v_readfirstlane_b32 s62, v17
    s_cmp_lg_u32 s62, 0
    s_cbranch_scc1 gm_go2
    s_sleep 1
    s_branch gm_wait2
gm_ovf:
    s_movk_i32 s20, 4
    s_barrier
    s_barrier
    s_branch gm_pass
gm_next:
    s_add_u32 s24, s24, s20
    s_barrier
    s_branch gm_pass
mn_w5:
    v_add_u32 v55, 12, v35
    v_add_u32 v55, s24, v55
    v_lshrrev_b32 v56, 16, v58
    v_mov_b32 v23, 0
    v_cmpx_lt_u32 vcc, v55, v56
    s_cbranch_execz mn_g0
    v_cmp_gt_u32 vcc, 15, v55
    v_and_b32 v56, 0xffff, v58
    v_add_lshl_u32 v56, v55, v56, 2
    v_add_u32 v56, v56, v46
    v_lshl_add_u32 v57, v0, 4, s22
    v_and_or_b32 v57, v55, 12, v57
    v_cndmask_b32 v56, v56, v57, vcc
    buffer_load_dword v23, v56, s[8:11], 0 offen sc1
    s_waitcnt vmcnt(0)
mn_g0:
    s_mov_b64 exec, -1
    v_add_u32 v55, 16, v35
    v_add_u32 v55, s24, v55
    v_lshrrev_b32 v56, 16, v58
    v_mov_b32 v24, 0
    v_cmpx_lt_u32 vcc, v55, v56
    s_cbranch_execz mn_g1
    v_cmp_gt_u32 vcc, 15, v55
    v_and_b32 v56, 0xffff, v58
    v_add_lshl_u32 v56, v55, v56, 2
    v_add_u32 v56, v56, v46
    v_lshl_add_u32 v57, v0, 4, s22
    v_and_or_b32 v57, v55, 12, v57
    v_cndmask_b32 v56, v56, v57, vcc
    buffer_load_dword v24, v56, s[8:11], 0 offen sc1
    s_waitcnt vmcnt(0)
mn_g1:
    s_mov_b64 exec, -1
mn_more:
    s_add_u32 s52, s24, s20
    v_lshrrev_b32 v56, 16, v58
    v_cmp_lt_u32 vcc, s52, v56
    s_cbranch_vccz mn_count
    v_mov_b32 v55, 272
    ds_write_b32 v55, v48
    s_branch mn_count
mn_ovf:
    s_movk_i32 s20, 4
    s_waitcnt vmcnt(0) lgkmcnt(0)
    s_barrier
    s_branch mn_again
mn_next:
    s_set_gpr_idx_off
    s_waitcnt vmcnt(0) lgkmcnt(0)
    s_nop 7
    s_add_u32 s24, s24, s20
    v_mbcnt_lo_u32_b32 v0, -1, 0
    v_mbcnt_hi_u32_b32 v0, -1, v0
    v_lshl_add_u32 v0, s16, 6, v0
    v_lshrrev_b32 v56, 6, v0
    v_lshlrev_b32 v55, 1, v0
    v_and_b32 v55, 0x78, v55
    v_or_b32 v55, v55, v56
    v_cmp_gt_u32 vcc, 125, v55
    v_mul_u32_u24 v46, 5120, v55
    v_add_u32 v46, 7340032, v46
    v_bfrev_b32 v56, 2
    v_lshlrev_b32 v44, 4, v0
    v_cndmask_b32 v44, v56, v44, vcc
    v_and_b32 v51, 63, v0
    buffer_load_dwordx4 v[20:23], v44, s[8:11], s22 offen sc1
    v_mov_b32 v48, 1
    v_lshlrev_b32 v47, 2, v51
    v_bfe_u32 v2, v0, 5, 1
    v_bfe_u32 v3, v0, 3, 2
    v_and_b32 v35, 3, v0
    v_lshl_add_u32 v3, v3, 2, v35
    v_mul_u32_u24 v49, 20, v2
    v_lshrrev_b32 v18, 2, v51
    v_lshl_add_u32 v18, v35, 4, v18
    v_mov_b32 v50, 0x3fff
    s_lshl_b32 s37, s16, 2
    v_mov_b32 v59, s37
    s_sub_u32 s36, s16, 1
    s_waitcnt vmcnt(0)
    v_mov_b32_dpp v58, v23 quad_perm:[3,3,3,3] row_mask:0xf bank_mask:0xf
mn_again:
    v_mov_b32 v55, 0
    ds_write_b32 v47, v55 offset:0
    ds_write_b32 v47, v55 offset:256
    s_waitcnt vmcnt(0) lgkmcnt(0)
    s_barrier
    v_add_u32 v55, 0, v35
    v_add_u32 v55, s24, v55
    v_lshrrev_b32 v56, 16, v58
    v_mov_b32 v20, 0
    v_cmpx_lt_u32 vcc, v55, v56
    s_cbranch_execz mn_g2
    v_cmp_gt_u32 vcc, 15, v55
    v_and_b32 v56, 0xffff, v58
    v_add_lshl_u32 v56, v55, v56, 2
    v_add_u32 v56, v56, v46
    v_lshl_add_u32 v57, v0, 4, s22
    v_and_or_b32 v57, v55, 12, v57
    v_cndmask_b32 v56, v56, v57, vcc
    buffer_load_dword v20, v56, s[8:11], 0 offen sc1
    s_waitcnt vmcnt(0)
mn_g2:
    s_mov_b64 exec, -1
    v_mov_b32 v21, 0
    v_mov_b32 v22, 0
    v_mov_b32 v23, 0
    v_mov_b32 v24, 0
    s_cmp_le_u32 s20, 4
    s_cbranch_scc1 mn_more
    v_add_u32 v55, 4, v35
    v_add_u32 v55, s24, v55
    v_lshrrev_b32 v56, 16, v58
    v_mov_b32 v21, 0
    v_cmpx_lt_u32 vcc, v55, v56
    s_cbranch_execz mn_g3
    v_cmp_gt_u32 vcc, 15, v55
    v_and_b32 v56, 0xffff, v58
    v_add_lshl_u32 v56, v55, v56, 2
    v_add_u32 v56, v56, v46
    v_lshl_add_u32 v57, v0, 4, s22
    v_and_or_b32 v57, v55, 12, v57
    v_cndmask_b32 v56, v56, v57, vcc
    buffer_load_dword v21, v56, s[8:11], 0 offen sc1
    s_waitcnt vmcnt(0)
mn_g3:
    s_mov_b64 exec, -1
    v_add_u32 v55, 8, v35
    v_add_u32 v55, s24, v55
    v_lshrrev_b32 v56, 16, v58
    v_mov_b32 v22, 0
    v_cmpx_lt_u32 vcc, v55, v56
    s_cbranch_execz mn_g4
    v_cmp_gt_u32 vcc, 15, v55
    v_and_b32 v56, 0xffff, v58
    v_add_lshl_u32 v56, v55, v56, 2
    v_add_u32 v56, v56, v46
    v_lshl_add_u32 v57, v0, 4, s22
    v_and_or_b32 v57, v55, 12, v57
    v_cndmask_b32 v56, v56, v57, vcc
    buffer_load_dword v22, v56, s[8:11], 0 offen sc1
    s_waitcnt vmcnt(0)
mn_g4:
    s_mov_b64 exec, -1
    v_add_u32 v55, 12, v35
    v_add_u32 v55, s24, v55
    v_lshrrev_b32 v56, 16, v58
    v_mov_b32 v23, 0
    v_cmpx_lt_u32 vcc, v55, v56
    s_cbranch_execz mn_g5
    v_cmp_gt_u32 vcc, 15, v55
    v_and_b32 v56, 0xffff, v58
    v_add_lshl_u32 v56, v55, v56, 2
    v_add_u32 v56, v56, v46
    v_lshl_add_u32 v57, v0, 4, s22
    v_and_or_b32 v57, v55, 12, v57
    v_cndmask_b32 v56, v56, v57, vcc
    buffer_load_dword v23, v56, s[8:11], 0 offen sc1
    s_waitcnt vmcnt(0)
mn_g5:
    s_mov_b64 exec, -1
    v_add_u32 v55, 16, v35
    v_add_u32 v55, s24, v55
    v_lshrrev_b32 v56, 16, v58
    v_mov_b32 v24, 0
    v_cmpx_lt_u32 vcc, v55, v56
    s_cbranch_execz mn_g6
    v_cmp_gt_u32 vcc, 15, v55
    v_and_b32 v56, 0xffff, v58
    v_add_lshl_u32 v56, v55, v56, 2
    v_add_u32 v56, v56, v46
    v_lshl_add_u32 v57, v0, 4, s22
    v_and_or_b32 v57, v55, 12, v57
    v_cndmask_b32 v56, v56, v57, vcc
    buffer_load_dword v24, v56, s[8:11], 0 offen sc1
    s_waitcnt vmcnt(0)
mn_g6:
    s_mov_b64 exec, -1
    s_branch mn_more
mn_last:
    s_endpgm
.section .rodata,"a"
.p2align 6
.amdhsa_kernel standalone__tensor_product_equiv_mace__graph_kernel
  .amdhsa_next_free_vgpr 168
  .amdhsa_next_free_sgpr 96
  .amdhsa_accum_offset 168
  .amdhsa_group_segment_fixed_size 0
  .amdhsa_kernarg_size 88
  .amdhsa_user_sgpr_count 2
  .amdhsa_user_sgpr_kernarg_segment_ptr 1
  .amdhsa_system_sgpr_workgroup_id_x 1
.end_amdhsa_kernel
```

```asm
; @launch kernel=standalone__tensor_product_equiv_mace__graph_kernel grid=(256,1,1) block=(768,1,1) lds=163840
.amdgcn_target "amdgcn-amd-amdhsa--gfx950"
.text
.globl standalone__tensor_product_equiv_mace__graph_kernel
.p2align 8
.type standalone__tensor_product_equiv_mace__graph_kernel,@function
standalone__tensor_product_equiv_mace__graph_kernel:
    s_cmp_ge_u32 s2, 256
    s_cbranch_scc1 ka_end
    s_cmp_lt_u32 s2, 128
    s_cbranch_scc1 ka_nospf
    s_getpc_b64 s[36:37]
ka_pc0:
    v_lshlrev_b32 v41, 7, v0
    v_min_u32 v41, mn_last-ka_pc0, v41
    global_load_dword v41, v41, s[36:37]
ka_nospf:
    s_load_dwordx8 s[4:11], s[0:1], 8
    s_load_dwordx2 s[16:17], s[0:1], 0
    s_load_dwordx4 s[12:15], s[0:1], 72
    s_load_dwordx2 s[32:33], s[0:1], 56
    v_lshrrev_b32 v9, 6, v0
    v_and_b32 v1, 63, v0
    v_readfirstlane_b32 s18, v9
    s_and_b32 s3, s2, 127
    s_cmp_ge_u32 s3, 125
    s_cbranch_scc1 ka_idle
    s_cmp_ge_u32 s2, 128
    s_cbranch_scc1 ka_pf
    s_mul_i32 s3, s2, 1280
    v_add_u32 v4, s3, v0
    v_lshlrev_b32 v5, 2, v4
    s_mov_b32 s22, 12582912
    s_mov_b32 s23, 0x20000
    s_and_b32 s28, s2, 7
    s_lshl_b32 s28, s28, 4
    s_lshr_b32 s29, s2, 3
    s_add_u32 s28, s28, s29
    s_cmp_ge_u32 s18, 10
    s_waitcnt lgkmcnt(0)
    s_mov_b32 s20, s14
    s_cbranch_scc1 ka_dma
    global_load_dword v10, v5, s[6:7]
    global_load_dword v60, v5, s[6:7] offset:2560
    global_load_dword v11, v5, s[4:5]
    global_load_dword v61, v5, s[4:5] offset:2560
    v_lshlrev_b32 v2, 2, v0
    v_and_b32 v2, 0x3fc, v2
    v_lshlrev_b32 v5, 4, v0
    v_mov_b32 v44, 0
    v_mov_b32 v45, 0
    v_mov_b32 v46, 0
    v_mov_b32 v47, 0
    ds_write_b32 v2, v44 offset:1024
    ds_write_b128 v5, v[44:47] offset:12288
    ds_write_b128 v5, v[44:47] offset:18432
    s_and_b32 s21, s15, 0xffff
    v_mov_b32 v3, 1
    v_lshlrev_b32 v26, 4, v1
    s_lshl_b32 s19, s18, 10
    v_add_u32 v27, s19, v26
    v_mov_b32 v4, 0x40000
    s_movk_i32 s29, 625
    s_movk_i32 s38, 0x3fff
    s_waitcnt lgkmcnt(0)
    s_barrier
    v_mov_b32 v19, 74752
    v_lshl_add_u32 v18, v0, 1, 0
    v_mul_u32_u24 v16, 13108, v18
    v_lshrrev_b32 v16, 16, v16
    v_mad_i32_i24 v18, v16, -5, v18
    v_lshlrev_b32 v16, 2, v16
    v_cmp_eq_u32 vcc, 4, v18
    v_lshlrev_b32 v18, 3, v18
    v_add_u32 v18, 33792, v18
    v_cndmask_b32 v17, 5, 3, vcc
    v_cndmask_b32 v18, v18, v19, vcc
    v_lshl_add_u32 v14, v0, 1, 1
    v_mul_u32_u24 v12, 13108, v14
    v_lshrrev_b32 v12, 16, v12
    v_mad_i32_i24 v14, v12, -5, v14
    v_lshlrev_b32 v12, 2, v12
    v_cmp_eq_u32 vcc, 4, v14
    v_lshlrev_b32 v14, 3, v14
    v_add_u32 v14, 33792, v14
    v_cndmask_b32 v13, 5, 3, vcc
    v_cndmask_b32 v14, v14, v19, vcc
    s_mul_i32 s31, s2, 51200
    s_waitcnt vmcnt(3)
    v_mul_u32_u24 v32, 214749, v10
    v_lshrrev_b32 v32, 23, v32
    v_min_u32 v32, 255, v32
    v_and_b32 v35, 7, v32
    v_lshrrev_b32 v33, 3, v32
    v_lshl_add_u32 v35, v35, 5, v33
    v_lshlrev_b32 v35, 2, v35
    ds_add_rtn_u32 v36, v35, v3 offset:1024
    s_waitcnt vmcnt(2)
    v_mul_u32_u24 v62, 214749, v60
    v_lshrrev_b32 v62, 23, v62
    v_min_u32 v62, 255, v62
    v_and_b32 v66, 7, v62
    v_lshrrev_b32 v63, 3, v62
    v_lshl_add_u32 v66, v66, 5, v63
    v_lshlrev_b32 v66, 2, v66
    ds_add_rtn_u32 v67, v66, v3 offset:1024
    v_mad_u32_u24 v33, v32, s29, 15
    v_lshrrev_b32 v33, 4, v33
    v_sub_u32 v33, v10, v33
    v_subrev_u32 v32, 20, v33
    v_min_u32 v32, v32, v33
    v_min_u32 v32, 19, v32
    v_lshlrev_b32 v40, 4, v35
    v_add_u32 v35, s19, v35
    v_mad_u32_u24 v63, v62, s29, 15
    v_lshrrev_b32 v63, 4, v63
    v_sub_u32 v63, v60, v63
    v_subrev_u32 v62, 20, v63
    v_min_u32 v62, v62, v63
    v_min_u32 v62, 19, v62
    v_lshlrev_b32 v70, 4, v66
    v_add_u32 v66, s19, v66
    s_waitcnt vmcnt(0) lgkmcnt(0)
    v_mul_u32_u24 v39, 3330, v11
    v_lshrrev_b32 v39, 20, v39
    v_lshrrev_b32 v34, 2, v32
    v_cmp_gt_u32 vcc, 27, v39
    v_add_u32 v34, 27, v34
    v_lshlrev_b32 v23, 14, v32
    v_cndmask_b32 v39, v34, v39, vcc
    v_cmp_le_u32 vcc, 20, v33
    v_and_or_b32 v22, v11, s38, v23
    v_or_b32 v39, 64, v39
    v_add_u32 v34, 32, v39
    v_cndmask_b32 v39, v39, v34, vcc
    v_lshl_or_b32 v22, v39, 25, v22
    v_cmp_lt_u32 vcc, 14, v36
    v_and_b32 v34, 3, v36
    v_lshl_add_u32 v40, v34, 4, v40
    v_and_or_b32 v40, v36, 12, v40
    v_cndmask_b32 v40, v40, v4, vcc
    ds_write_b32 v40, v22 offset:12288
    v_mul_u32_u24 v68, 3330, v61
    v_lshrrev_b32 v68, 20, v68
    v_lshrrev_b32 v71, 2, v62
    v_cmp_gt_u32 vcc, 27, v68
    v_add_u32 v71, 27, v71
    v_lshlrev_b32 v75, 14, v62
    v_cndmask_b32 v68, v71, v68, vcc
    v_cmp_le_u32 vcc, 20, v63
    v_and_or_b32 v74, v61, s38, v75
    v_or_b32 v68, 64, v68
    v_add_u32 v71, 32, v68
    v_cndmask_b32 v68, v68, v71, vcc
    v_lshl_or_b32 v74, v68, 25, v74
    v_cmp_lt_u32 vcc, 14, v67
    v_and_b32 v71, 3, v67
    v_lshl_add_u32 v70, v71, 4, v70
    v_and_or_b32 v70, v67, 12, v70
    v_cndmask_b32 v70, v70, v4, vcc
    ds_write_b32 v70, v74 offset:12288
    s_waitcnt lgkmcnt(0)
    s_barrier
    ds_read_b128 v[44:47], v26 offset:1024
    v_add_u32 v9, 640, v0
    v_max_u32 v8, v36, v67
    v_cmp_lt_u32 vcc, 14, v8
    s_waitcnt lgkmcnt(0)
    v_add_u32 v53, v44, v45
    v_add_u32 v54, v53, v46
    v_add_u32 v38, v54, v47
    v_mov_b32 v55, v38
    s_nop 0
    v_add_u32_dpp v38, v38, v38 row_shr:1 row_mask:0xf bank_mask:0xf
    s_nop 0
    s_nop 0
    v_add_u32_dpp v38, v38, v38 row_shr:2 row_mask:0xf bank_mask:0xf
    s_nop 0
    s_nop 0
    v_add_u32_dpp v38, v38, v38 row_shr:4 row_mask:0xf bank_mask:0xf
    s_nop 0
    s_nop 0
    v_add_u32_dpp v38, v38, v38 row_shr:8 row_mask:0xf bank_mask:0xf
    s_nop 0
    s_nop 0
    v_add_u32_dpp v38, v38, v38 row_bcast:15 row_mask:0xa bank_mask:0xf
    s_nop 0
    s_nop 0
    v_add_u32_dpp v38, v38, v38 row_bcast:31 row_mask:0xc bank_mask:0xf
    v_sub_u32 v56, v38, v55
    v_add_u32 v57, v56, v44
    v_add_u32 v58, v56, v53
    v_add_u32 v59, v56, v54
    ds_write_b128 v27, v[56:59] offset:2048
    ds_read_b32 v43, v35 offset:2048
    ds_read_b32 v69, v66 offset:2048
    s_waitcnt lgkmcnt(0)
    v_add_lshl_u32 v43, v43, v36, 2
    v_add_lshl_u32 v69, v69, v67, 2
    ds_write_b32 v43, v0 offset:28672
    ds_write_b32 v69, v9 offset:28672
    s_cbranch_vccnz ka_ov
ka_ov_back:
    s_waitcnt lgkmcnt(0)
ka_copy:
    s_barrier
    ds_read_b32 v20, v16 offset:28672
    ds_read_b32 v21, v12 offset:28672
    ds_read_b32 v22, v16 offset:29696
    ds_read_b32 v23, v12 offset:29696
    ds_read_b32 v24, v16 offset:30720
    ds_read_b32 v25, v12 offset:30720
    ds_read_b32 v26, v16 offset:31744
    ds_read_b32 v27, v12 offset:31744
    ds_read_b32 v28, v16 offset:32768
    ds_read_b32 v29, v12 offset:32768
    s_waitcnt lgkmcnt(8)
    v_lshl_add_u32 v20, v20, v17, v18
    v_lshl_add_u32 v21, v21, v13, v14
    ds_read_b64 v[44:45], v20
    ds_read_b64 v[46:47], v21
    s_waitcnt lgkmcnt(8)
    v_lshl_add_u32 v22, v22, v17, v18
    v_lshl_add_u32 v23, v23, v13, v14
    ds_read_b64 v[48:49], v22
    ds_read_b64 v[50:51], v23
    s_waitcnt lgkmcnt(8)
    v_lshl_add_u32 v24, v24, v17, v18
    v_lshl_add_u32 v25, v25, v13, v14
    ds_read_b64 v[52:53], v24
    ds_read_b64 v[54:55], v25
    s_waitcnt lgkmcnt(8)
    v_lshl_add_u32 v26, v26, v17, v18
    v_lshl_add_u32 v27, v27, v13, v14
    ds_read_b64 v[56:57], v26
    ds_read_b64 v[58:59], v27
    s_waitcnt lgkmcnt(8)
    v_lshl_add_u32 v28, v28, v17, v18
    v_lshl_add_u32 v29, v29, v13, v14
    ds_read_b64 v[60:61], v28
    ds_read_b64 v[62:63], v29
    s_waitcnt lgkmcnt(8)
    buffer_store_dwordx4 v[44:47], v5, s[20:23], s31 offen sc1
    s_addk_i32 s31, 10240
    s_waitcnt lgkmcnt(6)
    buffer_store_dwordx4 v[48:51], v5, s[20:23], s31 offen sc1
    s_addk_i32 s31, 10240
    s_waitcnt lgkmcnt(4)
    buffer_store_dwordx4 v[52:55], v5, s[20:23], s31 offen sc1
    s_addk_i32 s31, 10240
    s_waitcnt lgkmcnt(2)
    buffer_store_dwordx4 v[56:59], v5, s[20:23], s31 offen sc1
    s_addk_i32 s31, 10240
    s_waitcnt lgkmcnt(0)
    buffer_store_dwordx4 v[60:63], v5, s[20:23], s31 offen sc1
    s_branch mn_start2
ka_ov:
    s_mul_i32 s33, s2, 5120
    s_add_u32 s33, s33, 7340032
    buffer_store_dword v22, v43, s[20:23], s33 offen sc1
    buffer_store_dword v74, v69, s[20:23], s33 offen sc1
    s_branch ka_ov_back
ka_dma:
    s_and_b32 s21, s15, 0xffff
    s_cmp_eq_u32 s18, 11
    s_cbranch_scc1 ka_cell
    s_mul_i32 s35, s2, 40960
    v_lshl_add_u32 v7, v1, 4, s35
    s_mul_i32 s35, s2, 10240
    v_lshl_add_u32 v8, v1, 4, s35
    s_mov_b32 m0, 74752
    s_load_dwordx4 s[36:39], s[0:1], 40
    s_barrier
    global_load_lds_dwordx4 v8, s[8:9] offset:0
    global_load_lds_dwordx4 v8, s[8:9] offset:1024
    s_add_u32 m0, m0, 2048
    v_add_u32 v8, 2048, v8
    global_load_lds_dwordx4 v8, s[8:9] offset:0
    global_load_lds_dwordx4 v8, s[8:9] offset:1024
    s_add_u32 m0, m0, 2048
    v_add_u32 v8, 2048, v8
    global_load_lds_dwordx4 v8, s[8:9] offset:0
    global_load_lds_dwordx4 v8, s[8:9] offset:1024
    s_add_u32 m0, m0, 2048
    v_add_u32 v8, 2048, v8
    global_load_lds_dwordx4 v8, s[8:9] offset:0
    global_load_lds_dwordx4 v8, s[8:9] offset:1024
    s_add_u32 m0, m0, 2048
    v_add_u32 v8, 2048, v8
    global_load_lds_dwordx4 v8, s[8:9] offset:0
    global_load_lds_dwordx4 v8, s[8:9] offset:1024
    s_add_u32 m0, m0, 2048
    v_add_u32 v8, 2048, v8
    s_mov_b32 m0, 33792
    s_nop 0
    global_load_lds_dwordx4 v7, s[10:11] offset:0
    global_load_lds_dwordx4 v7, s[10:11] offset:1024
    s_add_u32 m0, m0, 2048
    v_add_u32 v7, 2048, v7
    global_load_lds_dwordx4 v7, s[10:11] offset:0
    global_load_lds_dwordx4 v7, s[10:11] offset:1024
    s_add_u32 m0, m0, 2048
    v_add_u32 v7, 2048, v7
    global_load_lds_dwordx4 v7, s[10:11] offset:0
    global_load_lds_dwordx4 v7, s[10:11] offset:1024
    s_add_u32 m0, m0, 2048
    v_add_u32 v7, 2048, v7
    s_barrier
    global_load_lds_dwordx4 v7, s[10:11] offset:0
    global_load_lds_dwordx4 v7, s[10:11] offset:1024
    s_add_u32 m0, m0, 2048
    v_add_u32 v7, 2048, v7
    global_load_lds_dwordx4 v7, s[10:11] offset:0
    global_load_lds_dwordx4 v7, s[10:11] offset:1024
    s_add_u32 m0, m0, 2048
    v_add_u32 v7, 2048, v7
    global_load_lds_dwordx4 v7, s[10:11] offset:0
    global_load_lds_dwordx4 v7, s[10:11] offset:1024
    s_add_u32 m0, m0, 2048
    v_add_u32 v7, 2048, v7
    global_load_lds_dwordx4 v7, s[10:11] offset:0
    global_load_lds_dwordx4 v7, s[10:11] offset:1024
    s_add_u32 m0, m0, 2048
    v_add_u32 v7, 2048, v7
    global_load_lds_dwordx4 v7, s[10:11] offset:0
    global_load_lds_dwordx4 v7, s[10:11] offset:1024
    s_add_u32 m0, m0, 2048
    v_add_u32 v7, 2048, v7
    global_load_lds_dwordx4 v7, s[10:11] offset:0
    global_load_lds_dwordx4 v7, s[10:11] offset:1024
    s_add_u32 m0, m0, 2048
    v_add_u32 v7, 2048, v7
    global_load_lds_dwordx4 v7, s[10:11] offset:0
    global_load_lds_dwordx4 v7, s[10:11] offset:1024
    s_add_u32 m0, m0, 2048
    v_add_u32 v7, 2048, v7
    global_load_lds_dwordx4 v7, s[10:11] offset:0
    global_load_lds_dwordx4 v7, s[10:11] offset:1024
    s_add_u32 m0, m0, 2048
    v_add_u32 v7, 2048, v7
    global_load_lds_dwordx4 v7, s[10:11] offset:0
    global_load_lds_dwordx4 v7, s[10:11] offset:1024
    s_add_u32 m0, m0, 2048
    v_add_u32 v7, 2048, v7
    global_load_lds_dwordx4 v7, s[10:11] offset:0
    global_load_lds_dwordx4 v7, s[10:11] offset:1024
    s_add_u32 m0, m0, 2048
    v_add_u32 v7, 2048, v7
    global_load_lds_dwordx4 v7, s[10:11] offset:0
    global_load_lds_dwordx4 v7, s[10:11] offset:1024
    s_add_u32 m0, m0, 2048
    v_add_u32 v7, 2048, v7
    global_load_lds_dwordx4 v7, s[10:11] offset:0
    global_load_lds_dwordx4 v7, s[10:11] offset:1024
    s_add_u32 m0, m0, 2048
    v_add_u32 v7, 2048, v7
    global_load_lds_dwordx4 v7, s[10:11] offset:0
    global_load_lds_dwordx4 v7, s[10:11] offset:1024
    s_add_u32 m0, m0, 2048
    v_add_u32 v7, 2048, v7
    global_load_lds_dwordx4 v7, s[10:11] offset:0
    global_load_lds_dwordx4 v7, s[10:11] offset:1024
    s_add_u32 m0, m0, 2048
    v_add_u32 v7, 2048, v7
    global_load_lds_dwordx4 v7, s[10:11] offset:0
    global_load_lds_dwordx4 v7, s[10:11] offset:1024
    s_add_u32 m0, m0, 2048
    v_add_u32 v7, 2048, v7
    global_load_lds_dwordx4 v7, s[10:11] offset:0
    global_load_lds_dwordx4 v7, s[10:11] offset:1024
    s_add_u32 m0, m0, 2048
    v_add_u32 v7, 2048, v7
    global_load_lds_dwordx4 v7, s[10:11] offset:0
    global_load_lds_dwordx4 v7, s[10:11] offset:1024
    s_add_u32 m0, m0, 2048
    v_add_u32 v7, 2048, v7
    s_mov_b32 s35, m0
    s_mov_b32 m0, 148480
    v_lshlrev_b32 v9, 4, v1
    v_add_u32 v10, 4096, v9
    s_waitcnt lgkmcnt(0)
    global_load_lds_dwordx4 v9, s[38:39]
    global_load_lds_dwordx4 v9, s[38:39] offset:1024
    global_load_lds_dwordx4 v9, s[38:39] offset:2048
    global_load_lds_dwordx4 v9, s[38:39] offset:3072
    s_mov_b32 m0, 152576
    s_nop 0
    global_load_lds_dwordx4 v10, s[38:39]
    global_load_lds_dwordx4 v10, s[38:39] offset:1024
    global_load_lds_dwordx4 v10, s[38:39] offset:2048
    global_load_lds_dwordx4 v10, s[38:39] offset:3072
    s_mov_b32 m0, 156672
    s_mov_b64 exec, 0xff
    global_load_lds_dwordx4 v9, s[36:37]
    s_mov_b64 exec, -1
    s_mov_b32 m0, s35
    s_waitcnt vmcnt(0)
    s_barrier
    s_branch mn_start
ka_cell:
    s_lshl_b32 s30, s28, 6
    s_add_u32 s30, s30, 8388608
    v_lshlrev_b32 v3, 3, v1
    v_mov_b32 v4, 0
    v_mov_b32 v5, 0
    ds_write_b64 v3, v[4:5]
    v_lshlrev_b32 v26, 4, v1
    v_lshrrev_b32 v6, 2, v1
    v_lshlrev_b32 v6, 13, v6
    v_and_or_b32 v6, v26, 0x30, v6
    v_lshlrev_b32 v27, 8, v1
    s_waitcnt lgkmcnt(0)
    s_barrier
    s_and_b32 s58, s2, 15
    s_lshl_b32 s58, s58, 7
    s_add_u32 s58, s58, 11730944
    v_mov_b32 v86, s58
    global_load_dword v87, v86, s[14:15] sc1
    s_barrier
    ds_read_b128 v[12:15], v26 offset:1024
    s_waitcnt lgkmcnt(0)
    v_add_u32 v17, v12, v13
    v_add_u32 v18, v17, v14
    v_add_u32 v16, v18, v15
    v_mov_b32 v19, v16
    v_lshlrev_b32 v20, 16, v12
    v_add_u32_dpp v16, v16, v16 row_shr:1 row_mask:0xf bank_mask:0xf
    v_lshl_add_u32 v21, v13, 16, v12
    s_nop 0
    v_add_u32_dpp v16, v16, v16 row_shr:2 row_mask:0xf bank_mask:0xf
    v_lshl_add_u32 v22, v14, 16, v17
    s_nop 0
    v_add_u32_dpp v16, v16, v16 row_shr:4 row_mask:0xf bank_mask:0xf
    v_lshl_add_u32 v23, v15, 16, v18
    s_nop 0
    v_add_u32_dpp v16, v16, v16 row_shr:8 row_mask:0xf bank_mask:0xf
    s_nop 1
    v_add_u32_dpp v16, v16, v16 row_bcast:15 row_mask:0xa bank_mask:0xf
    s_nop 1
    v_add_u32_dpp v16, v16, v16 row_bcast:31 row_mask:0xc bank_mask:0xf
    v_sub_u32 v16, v16, v19
    v_mov_b32 v86, 0
    s_waitcnt vmcnt(0)
    ds_write_b32 v86, v87 offset:456
    v_add_u32 v20, v20, v16
    ds_write_b32 v27, v20 offset:12348
    v_add_u32 v21, v21, v16
    ds_write_b32 v27, v21 offset:12412
    v_add_u32 v22, v22, v16
    ds_write_b32 v27, v22 offset:12476
    v_add_u32 v23, v23, v16
    ds_write_b32 v27, v23 offset:12540
    ds_read_b128 v[28:31], v26 offset:12288
    ds_read_b128 v[32:35], v26 offset:13312
    ds_read_b128 v[36:39], v26 offset:14336
    ds_read_b128 v[40:43], v26 offset:15360
    ds_read_b128 v[44:47], v26 offset:16384
    ds_read_b128 v[48:51], v26 offset:17408
    ds_read_b128 v[52:55], v26 offset:18432
    ds_read_b128 v[56:59], v26 offset:19456
    s_waitcnt lgkmcnt(7)
    buffer_store_dwordx4 v[28:31], v6, s[20:23], s30 offen sc1
    ds_read_b128 v[60:63], v26 offset:20480
    s_add_u32 s30, s30, 131072
    s_waitcnt lgkmcnt(7)
    buffer_store_dwordx4 v[32:35], v6, s[20:23], s30 offen sc1
    ds_read_b128 v[64:67], v26 offset:21504
    s_add_u32 s30, s30, 131072
    s_waitcnt lgkmcnt(7)
    buffer_store_dwordx4 v[36:39], v6, s[20:23], s30 offen sc1
    ds_read_b128 v[68:71], v26 offset:22528
    s_add_u32 s30, s30, 131072
    s_waitcnt lgkmcnt(7)
    buffer_store_dwordx4 v[40:43], v6, s[20:23], s30 offen sc1
    ds_read_b128 v[72:75], v26 offset:23552
    s_add_u32 s30, s30, 131072
    s_waitcnt lgkmcnt(7)
    buffer_store_dwordx4 v[44:47], v6, s[20:23], s30 offen sc1
    ds_read_b128 v[76:79], v26 offset:24576
    s_add_u32 s30, s30, 131072
    s_waitcnt lgkmcnt(7)
    buffer_store_dwordx4 v[48:51], v6, s[20:23], s30 offen sc1
    ds_read_b128 v[80:83], v26 offset:25600
    s_add_u32 s30, s30, 131072
    s_waitcnt lgkmcnt(7)
    buffer_store_dwordx4 v[52:55], v6, s[20:23], s30 offen sc1
    ds_read_b128 v[28:31], v26 offset:26624
    s_add_u32 s30, s30, 131072
    s_waitcnt lgkmcnt(7)
    buffer_store_dwordx4 v[56:59], v6, s[20:23], s30 offen sc1
    ds_read_b128 v[32:35], v26 offset:27648
    s_add_u32 s30, s30, 131072
    s_waitcnt lgkmcnt(7)
    buffer_store_dwordx4 v[60:63], v6, s[20:23], s30 offen sc1
    s_add_u32 s30, s30, 131072
    s_waitcnt lgkmcnt(6)
    buffer_store_dwordx4 v[64:67], v6, s[20:23], s30 offen sc1
    s_add_u32 s30, s30, 131072
    s_waitcnt lgkmcnt(5)
    buffer_store_dwordx4 v[68:71], v6, s[20:23], s30 offen sc1
    s_add_u32 s30, s30, 131072
    s_waitcnt lgkmcnt(4)
    buffer_store_dwordx4 v[72:75], v6, s[20:23], s30 offen sc1
    s_add_u32 s30, s30, 131072
    s_waitcnt lgkmcnt(3)
    buffer_store_dwordx4 v[76:79], v6, s[20:23], s30 offen sc1
    s_add_u32 s30, s30, 131072
    s_waitcnt lgkmcnt(2)
    buffer_store_dwordx4 v[80:83], v6, s[20:23], s30 offen sc1
    s_add_u32 s30, s30, 131072
    s_waitcnt lgkmcnt(1)
    buffer_store_dwordx4 v[28:31], v6, s[20:23], s30 offen sc1
    s_add_u32 s30, s30, 131072
    s_waitcnt lgkmcnt(0)
    buffer_store_dwordx4 v[32:35], v6, s[20:23], s30 offen sc1
    s_barrier
    s_waitcnt vmcnt(0)
    s_mov_b64 exec, 1
    v_mov_b32 v2, 0
    v_mov_b32 v3, 1
    s_and_b32 s34, s2, 1
    s_lshl_b32 s35, s34, 7
    s_add_u32 s35, s35, 0
    s_mov_b32 s33, 1
    s_atomic_add s33, s[12:13], s35 glc
    s_mov_b32 s36, 1
    s_lshl_b32 s34, s34, 3
    s_lshr_b32 s34, 15678, s34
    s_and_b32 s34, s34, 0xff
    s_waitcnt lgkmcnt(0)
    s_cmp_eq_u32 s33, s34
    s_cbranch_scc1 ka_bcast
ka_arc:
    s_mov_b64 exec, -1
    s_branch mn_start
ka_pf:
    s_sub_u32 s34, s2, 127
    s_mul_i32 s34, s34, 40960
    s_sub_u32 s34, s34, 40960
    v_lshl_add_u32 v44, v0, 7, s34
    v_min_u32 v44, 5119996, v44
    s_waitcnt lgkmcnt(0)
    s_cmp_ge_u32 s18, 5
    s_cbranch_scc1 ka_nohlp
    global_load_dword v45, v44, s[10:11]
ka_nohlp:
    s_and_b32 s34, s2, 7
    s_mul_i32 s34, s34, 917504
    s_add_u32 s24, s16, s34
    s_addc_u32 s25, s17, 0
    s_and_b32 s25, s25, 0xffff
    s_mov_b32 s26, 917504
    s_mov_b32 s27, 0x20000
    s_bfe_u32 s30, s2, 0x40003
    v_lshlrev_b32 v40, 7, v0
    s_mul_i32 s30, s30, 57344
    s_cmp_lg_u32 s18, 9
    s_cbranch_scc1 ka_nowt
    s_bfe_u32 s35, s2, 0x40003
    s_lshl_b32 s35, s35, 13
    v_lshl_add_u32 v46, v1, 7, s35
    global_load_dword v46, v46, s[32:33]
ka_nowt:
ka_pf1:
    s_cmp_ge_u32 s18, 7
    s_cbranch_scc1 ka_pfe
    s_waitcnt vmcnt(0)
    buffer_load_dword v42, v40, s[24:27], s30 offen
    s_cmp_ge_u32 s18, 0
    s_cbranch_scc1 ka_pfe
    s_add_u32 s30, s30, 81920
    buffer_load_dword v43, v40, s[24:27], s30 offen
    s_branch ka_pfe
ka_idle:
    s_waitcnt lgkmcnt(0)
ka_pfe:
    s_cmp_lt_u32 s18, 10
    s_cbranch_scc1 ka_pfb
    s_cmp_eq_u32 s18, 11
    s_cbranch_scc1 ka_pfz
    s_load_dwordx4 s[36:39], s[0:1], 40
    s_mov_b32 m0, 148480
    v_lshlrev_b32 v9, 4, v1
    v_add_u32 v10, 4096, v9
    s_waitcnt lgkmcnt(0)
    global_load_lds_dwordx4 v9, s[38:39]
    global_load_lds_dwordx4 v9, s[38:39] offset:1024
    global_load_lds_dwordx4 v9, s[38:39] offset:2048
    global_load_lds_dwordx4 v9, s[38:39] offset:3072
    s_mov_b32 m0, 152576
    s_nop 0
    global_load_lds_dwordx4 v10, s[38:39]
    global_load_lds_dwordx4 v10, s[38:39] offset:1024
    global_load_lds_dwordx4 v10, s[38:39] offset:2048
    global_load_lds_dwordx4 v10, s[38:39] offset:3072
    s_mov_b32 m0, 156672
    s_mov_b64 exec, 0xff
    global_load_lds_dwordx4 v9, s[36:37]
    s_mov_b64 exec, -1
    s_waitcnt vmcnt(0)
    s_branch ka_pfb
ka_pfz:
    s_and_b32 s58, s2, 15
    s_lshl_b32 s58, s58, 7
    s_add_u32 s58, s58, 11730944
    v_mov_b32 v86, s58
    global_load_dword v87, v86, s[14:15] sc1
    v_lshlrev_b32 v3, 3, v1
    v_mov_b32 v4, 0
    v_mov_b32 v5, 0
    ds_write_b64 v3, v[4:5]
    v_mov_b32 v86, 0
    s_waitcnt vmcnt(0)
    ds_write_b32 v86, v87 offset:456
    s_waitcnt lgkmcnt(0)
ka_pfb:
    s_barrier
    s_branch mn_start
ka_bcast:
    s_mov_b64 exec, -1
    s_add_u32 s34, s14, 11730944
    s_addc_u32 s35, s15, 0
    s_atomic_add s36, s[34:35], 0
    s_atomic_add s36, s[34:35], 128
    s_atomic_add s36, s[34:35], 256
    s_atomic_add s36, s[34:35], 384
    s_atomic_add s36, s[34:35], 512
    s_atomic_add s36, s[34:35], 640
    s_atomic_add s36, s[34:35], 768
    s_atomic_add s36, s[34:35], 896
    s_atomic_add s36, s[34:35], 1024
    s_atomic_add s36, s[34:35], 1152
    s_atomic_add s36, s[34:35], 1280
    s_atomic_add s36, s[34:35], 1408
    s_atomic_add s36, s[34:35], 1536
    s_atomic_add s36, s[34:35], 1664
    s_atomic_add s36, s[34:35], 1792
    s_atomic_add s36, s[34:35], 1920
    s_branch mn_start
ka_end:
    s_endpgm
mn_start:
    s_waitcnt vmcnt(0) lgkmcnt(0)
mn_start2:
    s_cmp_ge_u32 s2, 256
    s_cbranch_scc1 mn_end
    s_load_dwordx2 s[54:55], s[0:1], 80
    s_load_dwordx2 s[50:51], s[0:1], 0
    s_load_dwordx2 s[60:61], s[0:1], 72
    v_lshrrev_b32 v56, 6, v0
    s_and_b32 s48, s2, 7
    v_readfirstlane_b32 s16, v56
    s_lshr_b32 s47, s2, 3
    s_lshl_b32 s22, s48, 5
    s_add_u32 s22, s22, s47
    s_lshl_b32 s22, s22, 13
    s_add_u32 s22, s22, 8388608
    s_mov_b32 s10, 12582912
    s_mov_b32 s11, 0x20000
    s_and_b32 s17, s16, 3
    s_movk_i32 s20, 20
    s_mov_b32 s24, 0
    s_cmp_ge_u32 s16, 8
    s_cbranch_scc1 gm_main
    v_lshrrev_b32 v56, 6, v0
    v_lshlrev_b32 v55, 1, v0
    v_and_b32 v55, 0x78, v55
    v_or_b32 v55, v55, v56
    v_cmp_gt_u32 vcc, 125, v55
    v_mul_u32_u24 v46, 5120, v55
    v_add_u32 v46, 7340032, v46
    v_bfrev_b32 v56, 2
    v_lshlrev_b32 v44, 4, v0
    v_cndmask_b32 v44, v56, v44, vcc
    v_and_b32 v51, 63, v0
    s_waitcnt lgkmcnt(0)
    s_mov_b32 s8, s54
    s_and_b32 s9, s55, 0xffff
    v_mov_b32 v24, 0
    s_lshr_b32 s18, s16, 2
    s_lshl_b32 s53, s17, 7
    s_add_u32 s4, s50, s53
    s_addc_u32 s5, s51, 0
    s_and_b32 s5, s5, 0xffff
    s_or_b32 s5, s5, 0x08000000
    s_movk_i32 s6, 10000
    s_mov_b32 s7, 0x20000
    s_mul_i32 s40, s16, 15360
    s_add_u32 s40, s40, 40960
    v_lshl_add_u32 v87, v51, 3, s40
    s_add_u32 s40, s40, 9216
    s_add_u32 s41, s40, 1024
    s_add_u32 s42, s40, 2048
    s_add_u32 s43, s40, 3072
    s_add_u32 s44, s40, 4096
    s_add_u32 s45, s40, 5120
    v_and_b32 v55, 3, v0
    v_bfe_u32 v56, v0, 2, 2
    v_bfe_u32 v57, v0, 4, 1
    v_bfe_u32 v53, v0, 5, 1
    v_lshlrev_b32 v1, 3, v55
    v_lshl_add_u32 v1, v57, 5, v1
    v_lshl_add_u32 v1, v56, 6, v1
    v_lshl_add_u32 v1, v53, 8, v1
    v_add_u32 v1, s40, v1
    v_lshlrev_b32 v5, 4, v55
    v_lshl_add_u32 v5, v57, 6, v5
    v_lshl_add_u32 v5, v56, 9, v5
    v_mov_b32 v7, v5
    v_bfe_u32 v55, v0, 2, 1
    v_lshlrev_b32 v86, 4, v53
    v_lshl_or_b32 v86, v55, 18, v86
    v_mov_b32 v48, 1
    v_lshlrev_b32 v47, 2, v51
    v_bfe_u32 v2, v0, 5, 1
    v_bfe_u32 v3, v0, 3, 2
    v_and_b32 v35, 3, v0
    v_lshl_add_u32 v3, v3, 2, v35
    v_mul_u32_u24 v49, 20, v2
    v_lshrrev_b32 v18, 2, v51
    v_lshl_add_u32 v18, v35, 4, v18
    v_mov_b32 v50, 0x3fff
    s_lshl_b32 s37, s16, 2
    v_mov_b32 v59, s37
    s_sub_u32 s36, s16, 1
    v_mov_b64 v[88:89], 0
    v_mov_b64 v[90:91], 0
    v_mov_b64 v[92:93], 0
    v_mov_b64 v[94:95], 0
    v_mov_b64 v[96:97], 0
    v_mov_b64 v[98:99], 0
    v_mov_b64 v[100:101], 0
    v_mov_b64 v[102:103], 0
    v_mov_b64 v[104:105], 0
    v_mov_b64 v[106:107], 0
    v_mov_b64 v[108:109], 0
    v_mov_b64 v[110:111], 0
    v_mov_b64 v[112:113], 0
    v_mov_b64 v[114:115], 0
    v_mov_b64 v[116:117], 0
    v_mov_b64 v[118:119], 0
    v_mov_b64 v[120:121], 0
    v_mov_b64 v[122:123], 0
    v_mov_b64 v[124:125], 0
    v_mov_b64 v[126:127], 0
    v_mov_b64 v[128:129], 0
    v_mov_b64 v[130:131], 0
    v_mov_b64 v[132:133], 0
    v_mov_b64 v[134:135], 0
    v_mov_b64 v[136:137], 0
    v_mov_b64 v[138:139], 0
    v_mov_b64 v[140:141], 0
    v_mov_b64 v[142:143], 0
    v_mov_b64 v[144:145], 0
    v_mov_b64 v[146:147], 0
    v_mov_b64 v[148:149], 0
    v_mov_b64 v[150:151], 0
    v_mov_b64 v[152:153], 0
    v_mov_b64 v[154:155], 0
    v_mov_b64 v[156:157], 0
    v_mov_b64 v[158:159], 0
    v_mov_b64 v[160:161], 0
    v_mov_b64 v[162:163], 0
    v_mov_b64 v[164:165], 0
    v_mov_b64 v[166:167], 0
    v_bfe_u32 v8, v0, 2, 2
    v_bfe_u32 v10, v0, 5, 1
    v_lshlrev_b32 v9, 3, v8
    v_add_u32 v9, 156672, v9
    v_lshl_add_u32 v8, v10, 3, v8
    v_lshlrev_b32 v8, 9, v8
    v_bfe_u32 v10, v0, 4, 1
    v_lshl_add_u32 v8, v10, 5, v8
    v_lshl_add_u32 v8, v35, 3, v8
    v_lshl_add_u32 v8, s17, 7, v8
    v_add_u32 v8, 148480, v8
    ds_read_b64_tr_b16 v[76:77], v9
    ds_read_b64_tr_b16 v[78:79], v9 offset:32
    ds_read_b64_tr_b16 v[80:81], v9 offset:64
    ds_read_b64_tr_b16 v[82:83], v9 offset:96
    ds_read_b64_tr_b16 v[68:69], v8
    ds_read_b64_tr_b16 v[70:71], v8 offset:2048
    ds_read_b64_tr_b16 v[72:73], v8 offset:64
    ds_read_b64_tr_b16 v[74:75], v8 offset:2112
    s_cmp_ge_u32 s2, 125
    s_waitcnt vmcnt(0)
    s_cbranch_scc1 mn_noarr
    v_mov_b32 v55, 0
    v_mov_b32 v56, 1
    s_mov_b64 exec, 1
    ds_add_u32 v55, v56 offset:448
    s_mov_b64 exec, -1
mn_noarr:
    s_cmp_lg_u32 s16, 7
    s_cbranch_scc1 mn_sp1
    v_mov_b32 v57, 0
    ds_read_b32 v57, v57 offset:456
    s_waitcnt lgkmcnt(0)
    v_readfirstlane_b32 s59, v57
    s_and_b32 s62, s2, 15
    s_lshl_b32 s62, s62, 7
    s_add_u32 s62, s62, 11730944
    v_mov_b32 v55, s62
    v_lshlrev_b32 v56, 6, v0
    v_and_b32 v56, 0xc0, v56
    s_mov_b32 s63, 0x100000
mn_poll1m:
    s_sub_u32 s63, s63, 1
    s_cbranch_scc1 mn_poll1x
    global_load_dword v57, v55, s[54:55] sc1
    s_waitcnt vmcnt(0)
    v_readfirstlane_b32 s62, v57
    s_sub_u32 s62, s62, s59
    s_bfe_u32 s62, s62, 1048576
    s_cmp_eq_u32 s62, 2
    s_cbranch_scc1 mn_poll1x
    s_sleep 6
    s_and_b32 s62, s63, 63
    s_cbranch_scc1 mn_poll1m
    global_load_dword v57, v56, s[60:61] sc1
    s_waitcnt vmcnt(0)
    v_add_u32_dpp v57, v57, v57 quad_perm:[2,3,0,1] row_mask:0xf bank_mask:0xf
    s_nop 0
    v_readlane_b32 s62, v57, 0
    s_cmp_lg_u32 s62, 125
    s_cbranch_scc1 mn_poll1m
mn_poll1x:
    v_mov_b32 v55, 0
    ds_write_b32 v55, v48 offset:308
mn_sp1x:
    buffer_load_dwordx4 v[20:23], v44, s[8:11], s22 offen sc1
    s_mov_b32 s52, 0x100000
    s_waitcnt vmcnt(0)
    v_mov_b32_dpp v58, v23 quad_perm:[3,3,3,3] row_mask:0xf bank_mask:0xf
    v_cmp_le_u32 vcc, s52, v58
    s_cbranch_vccnz mn_w5
mn_count:
    v_cmpx_gt_i32 vcc, 0, v20
    s_cbranch_execz mn_cn_done
    v_lshrrev_b32 v25, 23, v20
    v_and_b32 v25, 0xfc, v25
    ds_add_rtn_u32 v30, v25, v48
    v_cmpx_gt_i32 vcc, 0, v21
    s_cbranch_execz mn_cn_done
    v_lshrrev_b32 v26, 23, v21
    v_and_b32 v26, 0xfc, v26
    ds_add_rtn_u32 v31, v26, v48
    v_cmpx_gt_i32 vcc, 0, v22
    s_cbranch_execz mn_cn_done
    v_lshrrev_b32 v27, 23, v22
    v_and_b32 v27, 0xfc, v27
    ds_add_rtn_u32 v32, v27, v48
    v_cmpx_gt_i32 vcc, 0, v23
    s_cbranch_execz mn_cn_done
    v_lshrrev_b32 v28, 23, v23
    v_and_b32 v28, 0xfc, v28
    ds_add_rtn_u32 v33, v28, v48
    v_cmpx_gt_i32 vcc, 0, v24
    s_cbranch_execz mn_cn_done
    v_lshrrev_b32 v29, 23, v24
    v_and_b32 v29, 0xfc, v29
    ds_add_rtn_u32 v34, v29, v48
mn_cn_done:
    s_mov_b64 exec, -1
    v_lshrrev_b32 v42, 16, v58
    v_subrev_u32 v42, s24, v42
    v_med3_i32 v42, v42, 0, s20
    v_mov_b32 v43, v42
    v_mov_b32 v52, 0
    s_lshl_b32 s52, s18, 5
    v_add_u32_dpp v43, v43, v43 row_shr:4 row_mask:0xf bank_mask:0xf
    s_add_u32 s53, s52, 31
    s_movk_i32 s48, 0x3fff
    v_add_u32_dpp v43, v43, v43 row_shr:8 row_mask:0xf bank_mask:0xf
    s_nop 0
    s_nop 0
    v_add_u32_dpp v43, v43, v43 row_bcast:15 row_mask:0xa bank_mask:0xf
    s_nop 0
    s_nop 0
    v_add_u32_dpp v43, v43, v43 row_bcast:31 row_mask:0xc bank_mask:0xf
    s_brev_b64 exec, 1
    ds_write_b32 v59, v43 offset:384
    s_mov_b64 exec, -1
    v_sub_u32 v41, v43, v42
    s_waitcnt lgkmcnt(0)
    s_barrier
    ds_read_b32 v55, v47 offset:384
    ds_read_b32 v53, v47 offset:0
    ds_read_b32 v52, v52 offset:272
    s_waitcnt lgkmcnt(2)
    v_add_u32_dpp v55, v55, v55 row_shr:1 row_mask:0xf bank_mask:0xf
    s_waitcnt lgkmcnt(1)
    v_mov_b32 v54, v53
    v_add_u32_dpp v55, v55, v55 row_shr:2 row_mask:0xf bank_mask:0xf
    v_sub_u32 v53, v49, v53
    v_add_u32 v41, v41, v35
    v_add_u32_dpp v55, v55, v55 row_shr:4 row_mask:0xf bank_mask:0xf
    s_cmp_eq_u32 s16, 0
    v_readlane_b32 s49, v55, s36
    s_cmov_b32 s49, 0
    s_add_u32 s49, s49, 72
    v_add_u32_dpp v54, v54, v54 row_shr:1 row_mask:0xf bank_mask:0xf
    v_add_u32 v41, s49, v41
    v_lshlrev_b32 v41, 16, v41
    v_add_u32_dpp v54, v54, v54 row_shr:2 row_mask:0xf bank_mask:0xf
    v_and_or_b32 v36, v20, s48, v41
    v_add_u32 v41, 262144, v41
    v_add_u32_dpp v54, v54, v54 row_shr:4 row_mask:0xf bank_mask:0xf
    v_and_or_b32 v37, v21, s48, v41
    v_add_u32 v41, 262144, v41
    v_add_u32_dpp v54, v54, v54 row_shr:8 row_mask:0xf bank_mask:0xf
    v_and_or_b32 v38, v22, s48, v41
    v_add_u32 v41, 262144, v41
    v_add_u32_dpp v54, v54, v54 row_bcast:15 row_mask:0xa bank_mask:0xf
    v_and_or_b32 v39, v23, s48, v41
    v_add_u32 v41, 262144, v41
    v_add_u32_dpp v54, v54, v54 row_bcast:31 row_mask:0xc bank_mask:0xf
    v_add_u32 v53, v53, v54
    v_add_u32 v54, v54, v49
    ds_bpermute_b32 v25, v25, v53
    ds_bpermute_b32 v26, v26, v53
    ds_bpermute_b32 v27, v27, v53
    ds_bpermute_b32 v28, v28, v53
    ds_bpermute_b32 v29, v29, v53
    v_and_or_b32 v40, v24, s48, v41
    v_bfe_u32 v56, v20, 14, 5
    v_lshl_or_b32 v36, v56, 26, v36
    v_bfe_u32 v56, v21, 14, 5
    v_lshl_or_b32 v37, v56, 26, v37
    v_bfe_u32 v56, v22, 14, 5
    v_lshl_or_b32 v38, v56, 26, v38
    v_bfe_u32 v56, v23, 14, 5
    v_lshl_or_b32 v39, v56, 26, v39
    v_bfe_u32 v56, v24, 14, 5
    v_lshl_or_b32 v40, v56, 26, v40
    v_readlane_b32 s23, v54, 63
    v_readlane_b32 s33, v54, s53
    v_readlane_b32 s32, v53, s52
    s_cmp_gt_u32 s23, 793
    s_cbranch_scc1 mn_ovf
    v_add_lshl_u32 v55, s33, v51, 2
    s_mov_b32 exec_lo, 1048575
    s_mov_b32 exec_hi, 0
    ds_write_b32 v55, v50 offset:512
    s_mov_b64 exec, -1
    v_add_lshl_u32 v2, s32, v2, 2
    v_add_lshl_u32 v3, s32, v3, 2
    v_add_lshl_u32 v18, s32, v18, 2
    s_waitcnt lgkmcnt(1)
    v_readfirstlane_b32 s21, v52
    v_cmpx_gt_i32 vcc, 0, v20
    s_cbranch_execz mn_w2_done
    v_add_lshl_u32 v25, v25, v30, 2
    ds_write_b32 v25, v36 offset:512
    v_cmpx_gt_i32 vcc, 0, v21
    s_cbranch_execz mn_w2_done
    v_add_lshl_u32 v26, v26, v31, 2
    ds_write_b32 v26, v37 offset:512
    v_cmpx_gt_i32 vcc, 0, v22
    s_cbranch_execz mn_w2_done
    v_add_lshl_u32 v27, v27, v32, 2
    ds_write_b32 v27, v38 offset:512
    v_cmpx_gt_i32 vcc, 0, v23
    s_cbranch_execz mn_w2_done
    v_add_lshl_u32 v28, v28, v33, 2
    ds_write_b32 v28, v39 offset:512
    v_cmpx_gt_i32 vcc, 0, v24
    s_cbranch_execz mn_w2_done
    v_add_lshl_u32 v29, v29, v34, 2
    ds_write_b32 v29, v40 offset:512
mn_w2_done:
    s_mov_b64 exec, -1
    s_mov_b32 m0, s40
    s_sub_u32 s32, s32, 3
    s_sub_u32 s57, s33, s32
    s_lshr_b32 s57, s57, 2
    s_waitcnt lgkmcnt(0)
    s_barrier
    ds_read_u16 v4, v2 offset:512
    ds_read_u16 v6, v2 offset:520
    ds_read_u16 v8, v18 offset:514
    ds_read_u16 v84, v3 offset:514
    ds_read_u16 v22, v2 offset:528
    ds_read_u16 v23, v2 offset:536
    ds_read_u16 v24, v2 offset:544
    ds_read_u16 v25, v2 offset:552
    ds_read_u16 v26, v2 offset:560
    ds_read_u16 v27, v2 offset:568
    s_sub_u32 s53, s53, 4
    v_readlane_b32 s84, v54, s53
    s_add_u32 s53, s53, 1
    v_readlane_b32 s85, v54, s53
    s_add_u32 s53, s53, 1
    v_readlane_b32 s86, v54, s53
    s_add_u32 s53, s53, 1
    v_readlane_b32 s87, v54, s53
    s_waitcnt lgkmcnt(8)
    buffer_load_dwordx4 v[4:5], s[4:7], 0 idxen offen lds
    s_mov_b32 m0, s41
    s_waitcnt lgkmcnt(6)
    buffer_load_dwordx4 v[6:7], s[4:7], 0 idxen offen lds
    v_lshrrev_b32 v11, 8, v8
    v_and_b32 v8, 0x3ff, v8
    v_mul_u32_u24 v8, 48, v8
    v_and_b32 v84, 0x3ff, v84
    v_mad_u32_u24 v84, v84, 48, v86
    v_xor_b32 v85, 0x40000, v84
    s_waitcnt lgkmcnt(0)
    s_mov_b32 m0, s42
    v_mov_b32 v4, v22
    buffer_load_dwordx4 v[4:5], s[4:7], 0 idxen offen lds
    s_mov_b32 m0, s43
    v_mov_b32 v4, v23
    buffer_load_dwordx4 v[4:5], s[4:7], 0 idxen offen lds
    s_setprio 2
    s_waitcnt vmcnt(4) lgkmcnt(0)
    s_barrier
    ds_read_b64 v[8:9], v8 offset:352
    ds_read_b128 v[60:63], v84 offset:320
    ds_read_b128 v[64:67], v85 offset:320
    s_mov_b32 m0, s44
    v_mov_b32 v4, v24
    buffer_load_dwordx4 v[4:5], s[4:7], 0 idxen offen lds
    s_mov_b32 m0, s45
    v_mov_b32 v4, v25
    buffer_load_dwordx4 v[4:5], s[4:7], 0 idxen offen lds
    v_mov_b32 v4, v26
    v_mov_b32 v6, v27
    s_waitcnt vmcnt(4)
    ds_read_b64_tr_b16 v[20:21], v1 offset:0
    ds_read_b64_tr_b16 v[22:23], v1 offset:512
    ds_read_b64_tr_b16 v[24:25], v1 offset:1024
    ds_read_b64_tr_b16 v[26:27], v1 offset:1536
    s_waitcnt lgkmcnt(6)
    v_mfma_f32_4x4x4_16b_bf16 v[28:31], v[8:9], v[76:77], 0
    v_mfma_f32_4x4x4_16b_bf16 v[32:35], v[8:9], v[78:79], 0
    v_mfma_f32_4x4x4_16b_bf16 v[36:39], v[8:9], v[80:81], 0
    v_mfma_f32_4x4x4_16b_bf16 v[40:43], v[8:9], v[82:83], 0
    v_min_u32 v0, 1, v51
    v_lshlrev_b32 v0, 18, v0
    v_lshl_add_u32 v0, s17, 2, v0
    s_lshl_b32 s52, s18, 1
    s_sub_i32 s52, 1, s52
    s_mul_i32 s53, s52, s57
    s_add_i32 s53, s53, 0
    v_mov_b32 v19, s53
    v_and_b32 v11, 0x7c, v11
    v_or_b32 v11, 0xc000, v11
    v_lshlrev_b32 v10, 16, v11
    s_waitcnt lgkmcnt(4)
    v_mfma_f32_32x32x16_bf16 v[44:59], v[60:63], v[68:71], 0
    v_mfma_f32_32x32x16_bf16 v[44:59], v[64:67], v[72:75], v[44:59]
    s_mov_b32 m0, s40
    s_waitcnt lgkmcnt(0)
    buffer_load_dwordx4 v[4:5], s[4:7], 0 idxen offen lds
    s_mov_b32 m0, s41
    ds_add_u32 v0, v19 offset:288
    buffer_load_dwordx4 v[6:7], s[4:7], 0 idxen offen lds
    v_or_b32_dpp v19, v10, v11 row_shl:4 row_mask:0xf bank_mask:0xf bound_ctrl:0
    v_cvt_pk_bf16_f32 v12, v28, v32
    v_cvt_pk_bf16_f32 v14, v29, v33
    v_cvt_pk_bf16_f32 v16, v30, v34
    v_cvt_pk_bf16_f32 v13, v36, v40
    v_cvt_pk_bf16_f32 v15, v37, v41
    v_cvt_pk_bf16_f32 v17, v38, v42
    s_sub_u32 s84, s84, s32
    s_lshr_b32 s84, s84, 2
    s_sub_u32 s85, s85, s32
    s_lshr_b32 s85, s85, 2
    s_sub_u32 s86, s86, s32
    s_lshr_b32 s86, s86, 2
    s_sub_u32 s87, s87, s32
    s_lshr_b32 s87, s87, 2
    s_sub_u32 s88, s57, s87
    s_sub_u32 s87, s87, s86
    s_sub_u32 s86, s86, s85
    s_sub_u32 s85, s85, s84
    s_cmp_lg_u32 s21, 0
    s_cselect_b32 s19, s57, s84
    s_mov_b32 s58, 0
    s_mov_b32 s35, 0
    s_mov_b64 s[46:47], -1
    s_sub_i32 s34, s57, 4
    s_max_i32 s34, s34, 0
    s_mul_i32 s30, s52, -4
    s_lshl_b32 s26, s18, 31
    s_set_gpr_idx_on s40, gpr_idx(SRC2,DST)
    s_sub_u32 s19, s19, 1
    s_cbranch_scc1 mn_st12
mn_st12_back:
mn_loop:
    v_mfma_f32_4x4x4_16b_bf16 v[28:31], v[12:13], v[20:21], 0 cbsz:4 abid:0
    v_mfma_f32_4x4x4_16b_bf16 v[32:35], v[12:13], v[22:23], 0 cbsz:4 abid:1
    v_mfma_f32_4x4x4_16b_bf16 v[36:39], v[12:13], v[24:25], 0 cbsz:4 abid:2
    v_mfma_f32_4x4x4_16b_bf16 v[40:43], v[12:13], v[26:27], 0 cbsz:4 abid:3
    ds_read_u16 v4, v2 offset:576
    ds_read_u16 v6, v2 offset:584
    v_readlane_b32 s28, v19, 0
    v_readlane_b32 s29, v19, 8
    s_waitcnt vmcnt(5)
    ds_read_b64_tr_b16 v[20:21], v1 offset:2048
    ds_read_b64_tr_b16 v[22:23], v1 offset:2560
    s_waitcnt vmcnt(4)
    ds_read_b64_tr_b16 v[24:25], v1 offset:3072
    ds_read_b64_tr_b16 v[26:27], v1 offset:3584
    s_sub_u32 s34, s34, 1
    s_cmov_b32 s35, 0x30000
    s_mov_b32 m0, s28
    v_fmac_f32 v88, v28, v44
    v_fmac_f32 v89, v29, v44
    v_fmac_f32 v90, v30, v44
    v_fmac_f32 v91, v31, v44
    s_lshr_b32 m0, s28, 16
    v_fmac_f32 v88, v32, v45
    v_fmac_f32 v89, v33, v45
    v_fmac_f32 v90, v34, v45
    v_fmac_f32 v91, v35, v45
    s_mov_b32 m0, s29
    v_fmac_f32 v88, v36, v46
    v_fmac_f32 v89, v37, v46
    v_fmac_f32 v90, v38, v46
    v_fmac_f32 v91, v39, v46
    s_lshr_b32 m0, s29, 16
    v_fmac_f32 v88, v40, v47
    v_fmac_f32 v89, v41, v47
    v_fmac_f32 v90, v42, v47
    v_fmac_f32 v91, v43, v47
    s_or_b32 m0, s42, s35
    s_waitcnt lgkmcnt(2)
    buffer_load_dwordx4 v[4:5], s[4:7], 0 idxen offen lds
    s_or_b32 m0, s43, s35
    s_waitcnt lgkmcnt(0)
    buffer_load_dwordx4 v[6:7], s[4:7], 0 idxen offen lds
    s_sub_u32 s19, s19, 1
    s_cbranch_scc1 mn_st0
mn_st0_back:
    v_mfma_f32_4x4x4_16b_bf16 v[28:31], v[12:13], v[20:21], 0 cbsz:4 abid:4
    v_mfma_f32_4x4x4_16b_bf16 v[32:35], v[12:13], v[22:23], 0 cbsz:4 abid:5
    v_mfma_f32_4x4x4_16b_bf16 v[36:39], v[12:13], v[24:25], 0 cbsz:4 abid:6
    v_mfma_f32_4x4x4_16b_bf16 v[40:43], v[12:13], v[26:27], 0 cbsz:4 abid:7
    ds_read_u16 v4, v2 offset:592
    ds_read_u16 v6, v2 offset:600
    v_readlane_b32 s28, v19, 16
    v_readlane_b32 s29, v19, 24
    ds_read_u16 v84, v3 offset:578
    s_waitcnt vmcnt(5)
    ds_read_b64_tr_b16 v[20:21], v1 offset:4096
    ds_read_b64_tr_b16 v[22:23], v1 offset:4608
    s_waitcnt vmcnt(4)
    ds_read_b64_tr_b16 v[24:25], v1 offset:5120
    ds_read_b64_tr_b16 v[26:27], v1 offset:5632
    s_sub_u32 s34, s34, 1
    s_cmov_b32 s35, 0x30000
    s_mov_b32 m0, s28
    v_fmac_f32 v88, v28, v48
    v_fmac_f32 v89, v29, v48
    v_fmac_f32 v90, v30, v48
    v_fmac_f32 v91, v31, v48
    s_lshr_b32 m0, s28, 16
    v_fmac_f32 v88, v32, v49
    v_fmac_f32 v89, v33, v49
    v_fmac_f32 v90, v34, v49
    v_fmac_f32 v91, v35, v49
    s_mov_b32 m0, s29
    v_fmac_f32 v88, v36, v50
    v_fmac_f32 v89, v37, v50
    v_fmac_f32 v90, v38, v50
    v_fmac_f32 v91, v39, v50
    s_lshr_b32 m0, s29, 16
    v_fmac_f32 v88, v40, v51
    v_fmac_f32 v89, v41, v51
    v_fmac_f32 v90, v42, v51
    v_fmac_f32 v91, v43, v51
    s_or_b32 m0, s44, s35
    s_waitcnt lgkmcnt(2)
    buffer_load_dwordx4 v[4:5], s[4:7], 0 idxen offen lds
    s_or_b32 m0, s45, s35
    s_waitcnt lgkmcnt(0)
    buffer_load_dwordx4 v[6:7], s[4:7], 0 idxen offen lds
    s_sub_u32 s19, s19, 1
    s_cbranch_scc1 mn_st1
mn_st1_back:
    v_mfma_f32_4x4x4_16b_bf16 v[28:31], v[12:13], v[20:21], 0 cbsz:4 abid:8
    v_mfma_f32_4x4x4_16b_bf16 v[32:35], v[12:13], v[22:23], 0 cbsz:4 abid:9
    v_mfma_f32_4x4x4_16b_bf16 v[36:39], v[12:13], v[24:25], 0 cbsz:4 abid:10
    v_mfma_f32_4x4x4_16b_bf16 v[40:43], v[12:13], v[26:27], 0 cbsz:4 abid:11
    ds_read_u16 v4, v2 offset:608
    ds_read_u16 v6, v2 offset:616
    v_readlane_b32 s28, v19, 32
    v_readlane_b32 s29, v19, 40
    v_and_b32 v84, 0x3ff, v84
    v_mad_u32_u24 v84, v84, 48, v86
    v_xor_b32 v85, 0x40000, v84
    ds_read_b128 v[60:63], v84 offset:320
    ds_read_b128 v[64:67], v85 offset:320
    s_waitcnt vmcnt(5)
    ds_read_b64_tr_b16 v[20:21], v1 offset:0
    ds_read_b64_tr_b16 v[22:23], v1 offset:512
    s_waitcnt vmcnt(4)
    ds_read_b64_tr_b16 v[24:25], v1 offset:1024
    ds_read_b64_tr_b16 v[26:27], v1 offset:1536
    s_sub_u32 s34, s34, 1
    s_cmov_b32 s35, 0x30000
    s_mov_b32 m0, s28
    v_fmac_f32 v88, v28, v52
    v_fmac_f32 v89, v29, v52
    v_fmac_f32 v90, v30, v52
    v_fmac_f32 v91, v31, v52
    s_lshr_b32 m0, s28, 16
    v_fmac_f32 v88, v32, v53
    v_fmac_f32 v89, v33, v53
    v_fmac_f32 v90, v34, v53
    v_fmac_f32 v91, v35, v53
    s_mov_b32 m0, s29
    v_fmac_f32 v88, v36, v54
    v_fmac_f32 v89, v37, v54
    v_fmac_f32 v90, v38, v54
    v_fmac_f32 v91, v39, v54
    s_lshr_b32 m0, s29, 16
    v_fmac_f32 v88, v40, v55
    v_fmac_f32 v89, v41, v55
    v_fmac_f32 v90, v42, v55
    v_fmac_f32 v91, v43, v55
    s_or_b32 m0, s40, s35
    s_waitcnt lgkmcnt(2)
    buffer_load_dwordx4 v[4:5], s[4:7], 0 idxen offen lds
    s_or_b32 m0, s41, s35
    s_waitcnt lgkmcnt(0)
    buffer_load_dwordx4 v[6:7], s[4:7], 0 idxen offen lds
    s_sub_u32 s19, s19, 1
    s_cbranch_scc1 mn_st2
mn_st2_back:
    v_mfma_f32_4x4x4_16b_bf16 v[28:31], v[12:13], v[20:21], 0 cbsz:4 abid:12
    v_mfma_f32_4x4x4_16b_bf16 v[32:35], v[12:13], v[22:23], 0 cbsz:4 abid:13
    v_mfma_f32_4x4x4_16b_bf16 v[36:39], v[12:13], v[24:25], 0 cbsz:4 abid:14
    v_mfma_f32_4x4x4_16b_bf16 v[40:43], v[12:13], v[26:27], 0 cbsz:4 abid:15
    ds_read_u16 v4, v2 offset:624
    ds_read_u16 v6, v2 offset:632
    v_readlane_b32 s28, v19, 48
    v_readlane_b32 s29, v19, 56
    v_mov_b32 v85, s30
    ds_add_rtn_u32 v85, v0, v85 offset:288
    s_waitcnt vmcnt(5)
    ds_read_b64_tr_b16 v[20:21], v1 offset:2048
    ds_read_b64_tr_b16 v[22:23], v1 offset:2560
    s_waitcnt vmcnt(4)
    ds_read_b64_tr_b16 v[24:25], v1 offset:3072
    ds_read_b64_tr_b16 v[26:27], v1 offset:3584
    s_sub_u32 s34, s34, 1
    s_cmov_b32 s35, 0x30000
    s_mov_b32 m0, s28
    v_fmac_f32 v88, v28, v56
    v_fmac_f32 v89, v29, v56
    v_fmac_f32 v90, v30, v56
    v_fmac_f32 v91, v31, v56
    s_lshr_b32 m0, s28, 16
    v_fmac_f32 v88, v32, v57
    v_fmac_f32 v89, v33, v57
    v_fmac_f32 v90, v34, v57
    v_fmac_f32 v91, v35, v57
    s_mov_b32 m0, s29
    v_fmac_f32 v88, v36, v58
    v_fmac_f32 v89, v37, v58
    v_fmac_f32 v90, v38, v58
    v_fmac_f32 v91, v39, v58
    s_lshr_b32 m0, s29, 16
    v_fmac_f32 v88, v40, v59
    v_fmac_f32 v89, v41, v59
    v_fmac_f32 v90, v42, v59
    v_fmac_f32 v91, v43, v59
    s_or_b32 m0, s42, s35
    v_mfma_f32_32x32x16_bf16 v[44:59], v[60:63], v[68:71], 0
    v_mfma_f32_32x32x16_bf16 v[44:59], v[64:67], v[72:75], v[44:59]
    s_waitcnt lgkmcnt(2)
    buffer_load_dwordx4 v[4:5], s[4:7], 0 idxen offen lds
    s_or_b32 m0, s43, s35
    s_waitcnt lgkmcnt(0)
    buffer_load_dwordx4 v[6:7], s[4:7], 0 idxen offen lds
    v_readfirstlane_b32 s27, v85
    s_setprio 2
    s_xor_b32 s27, s27, s26
    s_cmp_ge_i32 s27, 0
    s_cbranch_scc1 mn_pr3
    s_setprio 1
mn_pr3:
    s_sub_u32 s19, s19, 1
    s_cbranch_scc1 mn_st3
mn_st3_back:
    v_mfma_f32_4x4x4_16b_bf16 v[28:31], v[14:15], v[20:21], 0 cbsz:4 abid:0
    v_mfma_f32_4x4x4_16b_bf16 v[32:35], v[14:15], v[22:23], 0 cbsz:4 abid:1
    v_mfma_f32_4x4x4_16b_bf16 v[36:39], v[14:15], v[24:25], 0 cbsz:4 abid:2
    v_mfma_f32_4x4x4_16b_bf16 v[40:43], v[14:15], v[26:27], 0 cbsz:4 abid:3
    ds_read_u16 v4, v2 offset:640
    ds_read_u16 v6, v2 offset:648
    v_readlane_b32 s28, v19, 1
    v_readlane_b32 s29, v19, 9
    s_waitcnt vmcnt(5)
    ds_read_b64_tr_b16 v[20:21], v1 offset:4096
    ds_read_b64_tr_b16 v[22:23], v1 offset:4608
    s_waitcnt vmcnt(4)
    ds_read_b64_tr_b16 v[24:25], v1 offset:5120
    ds_read_b64_tr_b16 v[26:27], v1 offset:5632
    s_sub_u32 s34, s34, 1
    s_cmov_b32 s35, 0x30000
    s_mov_b32 m0, s28
    v_fmac_f32 v88, v28, v44
    v_fmac_f32 v89, v29, v44
    v_fmac_f32 v90, v30, v44
    v_fmac_f32 v91, v31, v44
    s_lshr_b32 m0, s28, 16
    v_fmac_f32 v88, v32, v45
    v_fmac_f32 v89, v33, v45
    v_fmac_f32 v90, v34, v45
    v_fmac_f32 v91, v35, v45
    s_mov_b32 m0, s29
    v_fmac_f32 v88, v36, v46
    v_fmac_f32 v89, v37, v46
    v_fmac_f32 v90, v38, v46
    v_fmac_f32 v91, v39, v46
    s_lshr_b32 m0, s29, 16
    v_fmac_f32 v88, v40, v47
    v_fmac_f32 v89, v41, v47
    v_fmac_f32 v90, v42, v47
    v_fmac_f32 v91, v43, v47
    s_or_b32 m0, s44, s35
    s_waitcnt lgkmcnt(2)
    buffer_load_dwordx4 v[4:5], s[4:7], 0 idxen offen lds
    s_or_b32 m0, s45, s35
    s_waitcnt lgkmcnt(0)
    buffer_load_dwordx4 v[6:7], s[4:7], 0 idxen offen lds
    s_sub_u32 s19, s19, 1
    s_cbranch_scc1 mn_st4
mn_st4_back:
    v_mfma_f32_4x4x4_16b_bf16 v[28:31], v[14:15], v[20:21], 0 cbsz:4 abid:4
    v_mfma_f32_4x4x4_16b_bf16 v[32:35], v[14:15], v[22:23], 0 cbsz:4 abid:5
    v_mfma_f32_4x4x4_16b_bf16 v[36:39], v[14:15], v[24:25], 0 cbsz:4 abid:6
    v_mfma_f32_4x4x4_16b_bf16 v[40:43], v[14:15], v[26:27], 0 cbsz:4 abid:7
    ds_read_u16 v4, v2 offset:656
    ds_read_u16 v6, v2 offset:664
    v_readlane_b32 s28, v19, 17
    v_readlane_b32 s29, v19, 25
    ds_read_u16 v84, v3 offset:642
    s_waitcnt vmcnt(5)
    ds_read_b64_tr_b16 v[20:21], v1 offset:0
    ds_read_b64_tr_b16 v[22:23], v1 offset:512
    s_waitcnt vmcnt(4)
    ds_read_b64_tr_b16 v[24:25], v1 offset:1024
    ds_read_b64_tr_b16 v[26:27], v1 offset:1536
    s_sub_u32 s34, s34, 1
    s_cmov_b32 s35, 0x30000
    s_mov_b32 m0, s28
    v_fmac_f32 v88, v28, v48
    v_fmac_f32 v89, v29, v48
    v_fmac_f32 v90, v30, v48
    v_fmac_f32 v91, v31, v48
    s_lshr_b32 m0, s28, 16
    v_fmac_f32 v88, v32, v49
    v_fmac_f32 v89, v33, v49
    v_fmac_f32 v90, v34, v49
    v_fmac_f32 v91, v35, v49
    s_mov_b32 m0, s29
    v_fmac_f32 v88, v36, v50
    v_fmac_f32 v89, v37, v50
    v_fmac_f32 v90, v38, v50
    v_fmac_f32 v91, v39, v50
    s_lshr_b32 m0, s29, 16
    v_fmac_f32 v88, v40, v51
    v_fmac_f32 v89, v41, v51
    v_fmac_f32 v90, v42, v51
    v_fmac_f32 v91, v43, v51
    s_or_b32 m0, s40, s35
    s_waitcnt lgkmcnt(2)
    buffer_load_dwordx4 v[4:5], s[4:7], 0 idxen offen lds
    s_or_b32 m0, s41, s35
    s_waitcnt lgkmcnt(0)
    buffer_load_dwordx4 v[6:7], s[4:7], 0 idxen offen lds
    s_sub_u32 s19, s19, 1
    s_cbranch_scc1 mn_st5
mn_st5_back:
    v_mfma_f32_4x4x4_16b_bf16 v[28:31], v[14:15], v[20:21], 0 cbsz:4 abid:8
    v_mfma_f32_4x4x4_16b_bf16 v[32:35], v[14:15], v[22:23], 0 cbsz:4 abid:9
    v_mfma_f32_4x4x4_16b_bf16 v[36:39], v[14:15], v[24:25], 0 cbsz:4 abid:10
    v_mfma_f32_4x4x4_16b_bf16 v[40:43], v[14:15], v[26:27], 0 cbsz:4 abid:11
    ds_read_u16 v4, v2 offset:672
    ds_read_u16 v6, v2 offset:680
    v_readlane_b32 s28, v19, 33
    v_readlane_b32 s29, v19, 41
    v_and_b32 v84, 0x3ff, v84
    v_mad_u32_u24 v84, v84, 48, v86
    v_xor_b32 v85, 0x40000, v84
    ds_read_b128 v[60:63], v84 offset:320
    ds_read_b128 v[64:67], v85 offset:320
    s_waitcnt vmcnt(5)
    ds_read_b64_tr_b16 v[20:21], v1 offset:2048
    ds_read_b64_tr_b16 v[22:23], v1 offset:2560
    s_waitcnt vmcnt(4)
    ds_read_b64_tr_b16 v[24:25], v1 offset:3072
    ds_read_b64_tr_b16 v[26:27], v1 offset:3584
    s_sub_u32 s34, s34, 1
    s_cmov_b32 s35, 0x30000
    s_mov_b32 m0, s28
    v_fmac_f32 v88, v28, v52
    v_fmac_f32 v89, v29, v52
    v_fmac_f32 v90, v30, v52
    v_fmac_f32 v91, v31, v52
    s_lshr_b32 m0, s28, 16
    v_fmac_f32 v88, v32, v53
    v_fmac_f32 v89, v33, v53
    v_fmac_f32 v90, v34, v53
    v_fmac_f32 v91, v35, v53
    s_mov_b32 m0, s29
    v_fmac_f32 v88, v36, v54
    v_fmac_f32 v89, v37, v54
    v_fmac_f32 v90, v38, v54
    v_fmac_f32 v91, v39, v54
    s_lshr_b32 m0, s29, 16
    v_fmac_f32 v88, v40, v55
    v_fmac_f32 v89, v41, v55
    v_fmac_f32 v90, v42, v55
    v_fmac_f32 v91, v43, v55
    s_or_b32 m0, s42, s35
    s_waitcnt lgkmcnt(2)
    buffer_load_dwordx4 v[4:5], s[4:7], 0 idxen offen lds
    s_or_b32 m0, s43, s35
    s_waitcnt lgkmcnt(0)
    buffer_load_dwordx4 v[6:7], s[4:7], 0 idxen offen lds
    s_sub_u32 s19, s19, 1
    s_cbranch_scc1 mn_st6
mn_st6_back:
    v_mfma_f32_4x4x4_16b_bf16 v[28:31], v[14:15], v[20:21], 0 cbsz:4 abid:12
    v_mfma_f32_4x4x4_16b_bf16 v[32:35], v[14:15], v[22:23], 0 cbsz:4 abid:13
    v_mfma_f32_4x4x4_16b_bf16 v[36:39], v[14:15], v[24:25], 0 cbsz:4 abid:14
    v_mfma_f32_4x4x4_16b_bf16 v[40:43], v[14:15], v[26:27], 0 cbsz:4 abid:15
    ds_read_u16 v4, v2 offset:688
    ds_read_u16 v6, v2 offset:696
    v_readlane_b32 s28, v19, 49
    v_readlane_b32 s29, v19, 57
    v_mov_b32 v85, s30
    ds_add_rtn_u32 v85, v0, v85 offset:288
    s_waitcnt vmcnt(5)
    ds_read_b64_tr_b16 v[20:21], v1 offset:4096
    ds_read_b64_tr_b16 v[22:23], v1 offset:4608
    s_waitcnt vmcnt(4)
    ds_read_b64_tr_b16 v[24:25], v1 offset:5120
    ds_read_b64_tr_b16 v[26:27], v1 offset:5632
    s_sub_u32 s34, s34, 1
    s_cmov_b32 s35, 0x30000
    s_mov_b32 m0, s28
    v_fmac_f32 v88, v28, v56
    v_fmac_f32 v89, v29, v56
    v_fmac_f32 v90, v30, v56
    v_fmac_f32 v91, v31, v56
    s_lshr_b32 m0, s28, 16
    v_fmac_f32 v88, v32, v57
    v_fmac_f32 v89, v33, v57
    v_fmac_f32 v90, v34, v57
    v_fmac_f32 v91, v35, v57
    s_mov_b32 m0, s29
    v_fmac_f32 v88, v36, v58
    v_fmac_f32 v89, v37, v58
    v_fmac_f32 v90, v38, v58
    v_fmac_f32 v91, v39, v58
    s_lshr_b32 m0, s29, 16
    v_fmac_f32 v88, v40, v59
    v_fmac_f32 v89, v41, v59
    v_fmac_f32 v90, v42, v59
    v_fmac_f32 v91, v43, v59
    s_or_b32 m0, s44, s35
    v_mfma_f32_32x32x16_bf16 v[44:59], v[60:63], v[68:71], 0
    v_mfma_f32_32x32x16_bf16 v[44:59], v[64:67], v[72:75], v[44:59]
    s_waitcnt lgkmcnt(2)
    buffer_load_dwordx4 v[4:5], s[4:7], 0 idxen offen lds
    s_or_b32 m0, s45, s35
    s_waitcnt lgkmcnt(0)
    buffer_load_dwordx4 v[6:7], s[4:7], 0 idxen offen lds
    v_readfirstlane_b32 s27, v85
    s_setprio 2
    s_xor_b32 s27, s27, s26
    s_cmp_ge_i32 s27, 0
    s_cbranch_scc1 mn_pr7
    s_setprio 1
mn_pr7:
    s_sub_u32 s19, s19, 1
    s_cbranch_scc1 mn_st7
mn_st7_back:
    v_mfma_f32_4x4x4_16b_bf16 v[28:31], v[16:17], v[20:21], 0 cbsz:4 abid:0
    v_mfma_f32_4x4x4_16b_bf16 v[32:35], v[16:17], v[22:23], 0 cbsz:4 abid:1
    v_mfma_f32_4x4x4_16b_bf16 v[36:39], v[16:17], v[24:25], 0 cbsz:4 abid:2
    v_mfma_f32_4x4x4_16b_bf16 v[40:43], v[16:17], v[26:27], 0 cbsz:4 abid:3
    ds_read_u16 v4, v2 offset:704
    ds_read_u16 v6, v2 offset:712
    v_readlane_b32 s28, v19, 2
    v_readlane_b32 s29, v19, 10
    ds_read_u16 v8, v18 offset:706
    s_waitcnt vmcnt(5)
    ds_read_b64_tr_b16 v[20:21], v1 offset:0
    ds_read_b64_tr_b16 v[22:23], v1 offset:512
    s_waitcnt vmcnt(4)
    ds_read_b64_tr_b16 v[24:25], v1 offset:1024
    ds_read_b64_tr_b16 v[26:27], v1 offset:1536
    s_sub_u32 s34, s34, 1
    s_cmov_b32 s35, 0x30000
    s_mov_b32 m0, s28
    v_fmac_f32 v88, v28, v44
    v_fmac_f32 v89, v29, v44
    v_fmac_f32 v90, v30, v44
    v_fmac_f32 v91, v31, v44
    s_lshr_b32 m0, s28, 16
    v_fmac_f32 v88, v32, v45
    v_fmac_f32 v89, v33, v45
    v_fmac_f32 v90, v34, v45
    v_fmac_f32 v91, v35, v45
    s_mov_b32 m0, s29
    v_fmac_f32 v88, v36, v46
    v_fmac_f32 v89, v37, v46
    v_fmac_f32 v90, v38, v46
    v_fmac_f32 v91, v39, v46
    s_lshr_b32 m0, s29, 16
    v_fmac_f32 v88, v40, v47
    v_fmac_f32 v89, v41, v47
    v_fmac_f32 v90, v42, v47
    v_fmac_f32 v91, v43, v47
    s_or_b32 m0, s40, s35
    s_waitcnt lgkmcnt(2)
    buffer_load_dwordx4 v[4:5], s[4:7], 0 idxen offen lds
    s_or_b32 m0, s41, s35
    s_waitcnt lgkmcnt(0)
    buffer_load_dwordx4 v[6:7], s[4:7], 0 idxen offen lds
    s_sub_u32 s19, s19, 1
    s_cbranch_scc1 mn_st8
mn_st8_back:
    v_mfma_f32_4x4x4_16b_bf16 v[28:31], v[16:17], v[20:21], 0 cbsz:4 abid:4
    v_mfma_f32_4x4x4_16b_bf16 v[32:35], v[16:17], v[22:23], 0 cbsz:4 abid:5
    v_mfma_f32_4x4x4_16b_bf16 v[36:39], v[16:17], v[24:25], 0 cbsz:4 abid:6
    v_mfma_f32_4x4x4_16b_bf16 v[40:43], v[16:17], v[26:27], 0 cbsz:4 abid:7
    ds_read_u16 v4, v2 offset:720
    ds_read_u16 v6, v2 offset:728
    v_readlane_b32 s28, v19, 18
    v_readlane_b32 s29, v19, 26
    ds_read_u16 v84, v3 offset:706
    v_lshrrev_b32 v11, 8, v8
    v_and_b32 v8, 0x3ff, v8
    v_mul_u32_u24 v8, 48, v8
    ds_read_b64 v[8:9], v8 offset:352
    s_waitcnt vmcnt(5)
    ds_read_b64_tr_b16 v[20:21], v1 offset:2048
    ds_read_b64_tr_b16 v[22:23], v1 offset:2560
    s_waitcnt vmcnt(4)
    ds_read_b64_tr_b16 v[24:25], v1 offset:3072
    ds_read_b64_tr_b16 v[26:27], v1 offset:3584
    s_sub_u32 s34, s34, 1
    s_cmov_b32 s35, 0x30000
    s_mov_b32 m0, s28
    v_fmac_f32 v88, v28, v48
    v_fmac_f32 v89, v29, v48
    v_fmac_f32 v90, v30, v48
    v_fmac_f32 v91, v31, v48
    s_lshr_b32 m0, s28, 16
    v_fmac_f32 v88, v32, v49
    v_fmac_f32 v89, v33, v49
    v_fmac_f32 v90, v34, v49
    v_fmac_f32 v91, v35, v49
    s_mov_b32 m0, s29
    v_fmac_f32 v88, v36, v50
    v_fmac_f32 v89, v37, v50
    v_fmac_f32 v90, v38, v50
    v_fmac_f32 v91, v39, v50
    s_lshr_b32 m0, s29, 16
    v_fmac_f32 v88, v40, v51
    v_fmac_f32 v89, v41, v51
    v_fmac_f32 v90, v42, v51
    v_fmac_f32 v91, v43, v51
    s_or_b32 m0, s42, s35
    s_waitcnt lgkmcnt(2)
    buffer_load_dwordx4 v[4:5], s[4:7], 0 idxen offen lds
    s_or_b32 m0, s43, s35
    s_waitcnt lgkmcnt(0)
    buffer_load_dwordx4 v[6:7], s[4:7], 0 idxen offen lds
    s_sub_u32 s19, s19, 1
    s_cbranch_scc1 mn_st9
mn_st9_back:
    v_mfma_f32_4x4x4_16b_bf16 v[28:31], v[16:17], v[20:21], 0 cbsz:4 abid:8
    v_mfma_f32_4x4x4_16b_bf16 v[32:35], v[16:17], v[22:23], 0 cbsz:4 abid:9
    v_mfma_f32_4x4x4_16b_bf16 v[36:39], v[16:17], v[24:25], 0 cbsz:4 abid:10
    v_mfma_f32_4x4x4_16b_bf16 v[40:43], v[16:17], v[26:27], 0 cbsz:4 abid:11
    ds_read_u16 v4, v2 offset:736
    ds_read_u16 v6, v2 offset:744
    v_readlane_b32 s28, v19, 34
    v_readlane_b32 s29, v19, 42
    v_and_b32 v84, 0x3ff, v84
    v_mad_u32_u24 v84, v84, 48, v86
    v_xor_b32 v85, 0x40000, v84
    ds_read_b128 v[60:63], v84 offset:320
    ds_read_b128 v[64:67], v85 offset:320
    s_waitcnt vmcnt(5)
    ds_read_b64_tr_b16 v[20:21], v1 offset:4096
    ds_read_b64_tr_b16 v[22:23], v1 offset:4608
    s_waitcnt vmcnt(4)
    ds_read_b64_tr_b16 v[24:25], v1 offset:5120
    ds_read_b64_tr_b16 v[26:27], v1 offset:5632
    s_sub_u32 s34, s34, 1
    s_cmov_b32 s35, 0x30000
    s_mov_b32 m0, s28
    v_fmac_f32 v88, v28, v52
    v_fmac_f32 v89, v29, v52
    v_fmac_f32 v90, v30, v52
    v_fmac_f32 v91, v31, v52
    s_lshr_b32 m0, s28, 16
    v_fmac_f32 v88, v32, v53
    v_fmac_f32 v89, v33, v53
    v_fmac_f32 v90, v34, v53
    v_fmac_f32 v91, v35, v53
    s_mov_b32 m0, s29
    v_fmac_f32 v88, v36, v54
    v_fmac_f32 v89, v37, v54
    v_fmac_f32 v90, v38, v54
    v_fmac_f32 v91, v39, v54
    s_lshr_b32 m0, s29, 16
    v_fmac_f32 v88, v40, v55
    v_fmac_f32 v89, v41, v55
    v_fmac_f32 v90, v42, v55
    v_fmac_f32 v91, v43, v55
    s_or_b32 m0, s44, s35
    s_waitcnt lgkmcnt(2)
    buffer_load_dwordx4 v[4:5], s[4:7], 0 idxen offen lds
    s_or_b32 m0, s45, s35
    s_waitcnt lgkmcnt(0)
    buffer_load_dwordx4 v[6:7], s[4:7], 0 idxen offen lds
    v_and_b32 v11, 0x7c, v11
    v_or_b32 v11, 0xc000, v11
    v_lshlrev_b32 v10, 16, v11
    s_sub_u32 s19, s19, 1
    s_cbranch_scc1 mn_st10
mn_st10_back:
    v_mfma_f32_4x4x4_16b_bf16 v[28:31], v[16:17], v[20:21], 0 cbsz:4 abid:12
    v_mfma_f32_4x4x4_16b_bf16 v[32:35], v[16:17], v[22:23], 0 cbsz:4 abid:13
    v_mfma_f32_4x4x4_16b_bf16 v[36:39], v[16:17], v[24:25], 0 cbsz:4 abid:14
    v_mfma_f32_4x4x4_16b_bf16 v[40:43], v[16:17], v[26:27], 0 cbsz:4 abid:15
    ds_read_u16 v4, v2 offset:752
    ds_read_u16 v6, v2 offset:760
    v_readlane_b32 s28, v19, 50
    v_readlane_b32 s29, v19, 58
    v_mov_b32 v85, s30
    ds_add_rtn_u32 v85, v0, v85 offset:288
    s_waitcnt vmcnt(5)
    ds_read_b64_tr_b16 v[20:21], v1 offset:0
    ds_read_b64_tr_b16 v[22:23], v1 offset:512
    s_waitcnt vmcnt(4)
    ds_read_b64_tr_b16 v[24:25], v1 offset:1024
    ds_read_b64_tr_b16 v[26:27], v1 offset:1536
    s_sub_u32 s34, s34, 1
    s_cmov_b32 s35, 0x30000
    s_mov_b32 m0, s28
    v_fmac_f32 v88, v28, v56
    v_fmac_f32 v89, v29, v56
    v_fmac_f32 v90, v30, v56
    v_fmac_f32 v91, v31, v56
    s_lshr_b32 m0, s28, 16
    v_fmac_f32 v88, v32, v57
    v_fmac_f32 v89, v33, v57
    v_fmac_f32 v90, v34, v57
    v_fmac_f32 v91, v35, v57
    s_mov_b32 m0, s29
    v_fmac_f32 v88, v36, v58
    v_fmac_f32 v89, v37, v58
    v_fmac_f32 v90, v38, v58
    v_fmac_f32 v91, v39, v58
    s_lshr_b32 m0, s29, 16
    v_fmac_f32 v88, v40, v59
    v_fmac_f32 v89, v41, v59
    v_fmac_f32 v90, v42, v59
    v_fmac_f32 v91, v43, v59
    s_or_b32 m0, s40, s35
    v_mfma_f32_4x4x4_16b_bf16 v[28:31], v[8:9], v[76:77], 0
    v_mfma_f32_4x4x4_16b_bf16 v[32:35], v[8:9], v[78:79], 0
    v_mfma_f32_4x4x4_16b_bf16 v[36:39], v[8:9], v[80:81], 0
    v_mfma_f32_4x4x4_16b_bf16 v[40:43], v[8:9], v[82:83], 0
    v_mfma_f32_32x32x16_bf16 v[44:59], v[60:63], v[68:71], 0
    v_mfma_f32_32x32x16_bf16 v[44:59], v[64:67], v[72:75], v[44:59]
    s_waitcnt lgkmcnt(2)
    buffer_load_dwordx4 v[4:5], s[4:7], 0 idxen offen lds
    s_or_b32 m0, s41, s35
    s_waitcnt lgkmcnt(0)
    buffer_load_dwordx4 v[6:7], s[4:7], 0 idxen offen lds
    v_cvt_pk_bf16_f32 v12, v28, v32
    v_cvt_pk_bf16_f32 v14, v29, v33
    v_cvt_pk_bf16_f32 v16, v30, v34
    v_cvt_pk_bf16_f32 v13, v36, v40
    v_cvt_pk_bf16_f32 v15, v37, v41
    v_cvt_pk_bf16_f32 v17, v38, v42
    v_or_b32_dpp v19, v10, v11 row_shl:4 row_mask:0xf bank_mask:0xf bound_ctrl:0
    v_add_u32 v2, 192, v2
    v_add_u32 v3, 192, v3
    v_add_u32 v18, 192, v18
    v_readfirstlane_b32 s27, v85
    s_setprio 2
    s_xor_b32 s27, s27, s26
    s_cmp_ge_i32 s27, 0
    s_cbranch_scc1 mn_pr11
    s_setprio 1
mn_pr11:
    s_sub_u32 s19, s19, 1
    s_cbranch_scc1 mn_st11
mn_st11_back:
    s_branch mn_loop
mn_st0:
    s_cmp_lg_u32 s21, 0
    s_cbranch_scc1 mn_next
    s_call_b64 s[48:49], mn_flush
    s_branch mn_st0_back
mn_st1:
    s_cmp_lg_u32 s21, 0
    s_cbranch_scc1 mn_next
    s_call_b64 s[48:49], mn_flush
    s_branch mn_st1_back
mn_st2:
    s_cmp_lg_u32 s21, 0
    s_cbranch_scc1 mn_next
    s_call_b64 s[48:49], mn_flush
    s_branch mn_st2_back
mn_st3:
    s_cmp_lg_u32 s21, 0
    s_cbranch_scc1 mn_next
    s_call_b64 s[48:49], mn_flush
    s_branch mn_st3_back
mn_st4:
    s_cmp_lg_u32 s21, 0
    s_cbranch_scc1 mn_next
    s_call_b64 s[48:49], mn_flush
    s_branch mn_st4_back
mn_st5:
    s_cmp_lg_u32 s21, 0
    s_cbranch_scc1 mn_next
    s_call_b64 s[48:49], mn_flush
    s_branch mn_st5_back
mn_st6:
    s_cmp_lg_u32 s21, 0
    s_cbranch_scc1 mn_next
    s_call_b64 s[48:49], mn_flush
    s_branch mn_st6_back
mn_st7:
    s_cmp_lg_u32 s21, 0
    s_cbranch_scc1 mn_next
    s_call_b64 s[48:49], mn_flush
    s_branch mn_st7_back
mn_st8:
    s_cmp_lg_u32 s21, 0
    s_cbranch_scc1 mn_next
    s_call_b64 s[48:49], mn_flush
    s_branch mn_st8_back
mn_st9:
    s_cmp_lg_u32 s21, 0
    s_cbranch_scc1 mn_next
    s_call_b64 s[48:49], mn_flush
    s_branch mn_st9_back
mn_st10:
    s_cmp_lg_u32 s21, 0
    s_cbranch_scc1 mn_next
    s_call_b64 s[48:49], mn_flush
    s_branch mn_st10_back
mn_st11:
    s_cmp_lg_u32 s21, 0
    s_cbranch_scc1 mn_next
    s_call_b64 s[48:49], mn_flush
    s_branch mn_st11_back
mn_st12:
    s_cmp_lg_u32 s21, 0
    s_cbranch_scc1 mn_next
    s_call_b64 s[48:49], mn_flush
    s_branch mn_st12_back
mn_flush:
    s_cmp_eq_u32 s58, 4
    s_cbranch_scc1 mn_fl4
    s_cmp_eq_u32 s58, 3
    s_cbranch_scc1 mn_fl3
    s_cmp_eq_u32 s58, 2
    s_cbranch_scc1 mn_fl2
    s_cmp_eq_u32 s58, 1
    s_cbranch_scc1 mn_fl1
mn_fl0:
    v_cvt_pk_bf16_f32 v88, v88, v89
    v_cvt_pk_bf16_f32 v89, v90, v91
    ds_write_b64 v87, v[88:89] offset:0
    v_cvt_pk_bf16_f32 v92, v92, v93
    v_cvt_pk_bf16_f32 v93, v94, v95
    ds_write_b64 v87, v[92:93] offset:576
    v_cvt_pk_bf16_f32 v96, v96, v97
    v_cvt_pk_bf16_f32 v97, v98, v99
    ds_write_b64 v87, v[96:97] offset:1152
    v_cvt_pk_bf16_f32 v100, v100, v101
    v_cvt_pk_bf16_f32 v101, v102, v103
    ds_write_b64 v87, v[100:101] offset:1728
    s_mul_i32 s52, s18, 3
    s_lshl_b32 s52, 1, s52
    v_mov_b32 v90, s52
    v_mov_b32 v91, 0
    s_mov_b64 exec, 1
    ds_add_u32 v91, v90 offset:276
    s_mov_b64 exec, -1
    s_add_u32 s58, s58, 1
    s_sub_u32 s19, s85, 1
    s_cbranch_scc1 mn_fl1
    s_setpc_b64 s[48:49]
mn_fl1:
    v_cvt_pk_bf16_f32 v104, v104, v105
    v_cvt_pk_bf16_f32 v105, v106, v107
    ds_write_b64 v87, v[104:105] offset:2304
    v_cvt_pk_bf16_f32 v108, v108, v109
    v_cvt_pk_bf16_f32 v109, v110, v111
    ds_write_b64 v87, v[108:109] offset:2880
    v_cvt_pk_bf16_f32 v112, v112, v113
    v_cvt_pk_bf16_f32 v113, v114, v115
    ds_write_b64 v87, v[112:113] offset:3456
    v_cvt_pk_bf16_f32 v116, v116, v117
    v_cvt_pk_bf16_f32 v117, v118, v119
    ds_write_b64 v87, v[116:117] offset:4032
    s_mul_i32 s52, s18, 3
    s_lshl_b32 s52, 64, s52
    v_mov_b32 v106, s52
    v_mov_b32 v107, 0
    s_mov_b64 exec, 1
    ds_add_u32 v107, v106 offset:276
    s_mov_b64 exec, -1
    s_add_u32 s58, s58, 1
    s_sub_u32 s19, s86, 1
    s_cbranch_scc1 mn_fl2
    s_setpc_b64 s[48:49]
mn_fl2:
    v_cvt_pk_bf16_f32 v120, v120, v121
    v_cvt_pk_bf16_f32 v121, v122, v123
    ds_write_b64 v87, v[120:121] offset:4608
    v_cvt_pk_bf16_f32 v124, v124, v125
    v_cvt_pk_bf16_f32 v125, v126, v127
    ds_write_b64 v87, v[124:125] offset:5184
    v_cvt_pk_bf16_f32 v128, v128, v129
    v_cvt_pk_bf16_f32 v129, v130, v131
    ds_write_b64 v87, v[128:129] offset:5760
    v_cvt_pk_bf16_f32 v132, v132, v133
    v_cvt_pk_bf16_f32 v133, v134, v135
    ds_write_b64 v87, v[132:133] offset:6336
    s_mul_i32 s52, s18, 3
    s_lshl_b32 s52, 4096, s52
    v_mov_b32 v122, s52
    v_mov_b32 v123, 0
    s_mov_b64 exec, 1
    ds_add_u32 v123, v122 offset:276
    s_mov_b64 exec, -1
    s_add_u32 s58, s58, 1
    s_sub_u32 s19, s87, 1
    s_cbranch_scc1 mn_fl3
    s_setpc_b64 s[48:49]
mn_fl3:
    v_cvt_pk_bf16_f32 v136, v136, v137
    v_cvt_pk_bf16_f32 v137, v138, v139
    ds_write_b64 v87, v[136:137] offset:6912
    v_cvt_pk_bf16_f32 v140, v140, v141
    v_cvt_pk_bf16_f32 v141, v142, v143
    ds_write_b64 v87, v[140:141] offset:7488
    v_cvt_pk_bf16_f32 v144, v144, v145
    v_cvt_pk_bf16_f32 v145, v146, v147
    ds_write_b64 v87, v[144:145] offset:8064
    v_cvt_pk_bf16_f32 v148, v148, v149
    v_cvt_pk_bf16_f32 v149, v150, v151
    ds_write_b64 v87, v[148:149] offset:8640
    s_mul_i32 s52, s18, 3
    s_lshl_b32 s52, 262144, s52
    v_mov_b32 v138, s52
    v_mov_b32 v139, 0
    s_mov_b64 exec, 1
    ds_add_u32 v139, v138 offset:276
    s_mov_b64 exec, -1
    s_add_u32 s58, s58, 1
    s_sub_u32 s19, s88, 1
    s_cbranch_scc1 mn_fl4
    s_setpc_b64 s[48:49]
mn_fl4:
    s_cmp_ge_u32 s57, 4
    s_cbranch_scc1 mn_fl4b
    s_waitcnt vmcnt(0)
mn_fl4b:
    v_cvt_pk_bf16_f32 v152, v152, v153
    v_cvt_pk_bf16_f32 v153, v154, v155
    ds_write_b64 v87, v[152:153] offset:9216
    v_cvt_pk_bf16_f32 v156, v156, v157
    v_cvt_pk_bf16_f32 v157, v158, v159
    ds_write_b64 v87, v[156:157] offset:9792
    v_cvt_pk_bf16_f32 v160, v160, v161
    v_cvt_pk_bf16_f32 v161, v162, v163
    ds_write_b64 v87, v[160:161] offset:10368
    v_cvt_pk_bf16_f32 v164, v164, v165
    v_cvt_pk_bf16_f32 v165, v166, v167
    ds_write_b64 v87, v[164:165] offset:10944
    s_mul_i32 s52, s18, 3
    s_lshl_b32 s52, 16777216, s52
    v_mov_b32 v154, s52
    v_mov_b32 v155, 0
    s_mov_b64 exec, 1
    ds_add_u32 v155, v154 offset:276
    s_mov_b64 exec, -1
    s_waitcnt vmcnt(0) lgkmcnt(0)
mn_end:
    s_endpgm
gm_main:
    s_load_dwordx2 s[56:57], s[0:1], 64
    s_load_dwordx2 s[26:27], s[0:1], 56
    v_and_b32 v3, 63, v0
    v_bfe_u32 v12, v0, 1, 7
    v_and_b32 v11, 15, v12
    v_lshrrev_b32 v10, 4, v12
    v_lshl_or_b32 v11, v11, 3, v10
    v_cmp_gt_u32 vcc, 125, v11
    v_mul_u32_u24 v13, 51200, v11
    v_bfrev_b32 v10, 2
    v_lshlrev_b32 v12, 6, v12
    v_cndmask_b32 v12, v10, v12, vcc
    v_lshlrev_b32 v2, 4, v3
    s_lshl_b32 s40, s17, 15
    s_add_u32 s40, s40, 11534336
    s_waitcnt lgkmcnt(0)
    s_mov_b32 s8, s54
    s_and_b32 s9, s55, 0xffff
    v_lshrrev_b32 v11, 4, v3
    v_lshlrev_b32 v11, 11, v11
    v_and_b32 v10, 7, v3
    v_lshl_add_u32 v11, v10, 4, v11
    v_and_b32 v10, 8, v3
    v_lshlrev_b32 v10, 10, v10
    s_lshl_b32 s52, s17, 7
    s_add_u32 s52, s52, 114688
    v_add3_u32 v11, v11, v10, s52
    s_mov_b32 s44, 0x05040100
    s_mov_b32 s45, 0x07060302
    v_mov_b32 v5, v11
    s_cmp_ge_u32 s2, 125
    s_cbranch_scc1 gm_wgo
    s_cmp_ge_u32 s16, 10
    s_cbranch_scc1 gm_wsp
    s_cmp_ge_u32 s2, 125
    s_waitcnt vmcnt(0)
    s_cbranch_scc1 gm_wsp
    v_mov_b32 v11, 0
    v_mov_b32 v10, 1
    s_mov_b64 exec, 1
    ds_add_u32 v11, v10 offset:448
    s_mov_b64 exec, -1
gm_dummy:
gm_wsp:
    v_mov_b32 v11, 0
    ds_read_b32 v11, v11 offset:448
    s_waitcnt lgkmcnt(0)
    v_readfirstlane_b32 s62, v11
    s_cmp_ge_u32 s62, 10
    s_cbranch_scc1 gm_wspx
    s_sleep 1
    s_branch gm_wsp
gm_wspx:
    s_cmp_lg_u32 s16, 10
    s_cbranch_scc1 gm_wgo
    s_and_b32 s52, s2, 1
    s_lshl_b32 s53, s52, 7
    s_add_u32 s53, s53, 64
    s_mov_b32 s62, 1
    s_atomic_add s62, s[60:61], s53 glc
    s_sub_u32 s52, 62, s52
    s_add_u32 s28, s54, 11730944
    s_addc_u32 s29, s55, 0
    s_mov_b32 s53, 0x10000
    s_waitcnt lgkmcnt(0)
    s_cmp_lg_u32 s62, s52
    s_cbranch_scc1 gm_wgo
    s_atomic_add s53, s[28:29], 0
    s_atomic_add s53, s[28:29], 128
    s_atomic_add s53, s[28:29], 256
    s_atomic_add s53, s[28:29], 384
    s_atomic_add s53, s[28:29], 512
    s_atomic_add s53, s[28:29], 640
    s_atomic_add s53, s[28:29], 768
    s_atomic_add s53, s[28:29], 896
    s_atomic_add s53, s[28:29], 1024
    s_atomic_add s53, s[28:29], 1152
    s_atomic_add s53, s[28:29], 1280
    s_atomic_add s53, s[28:29], 1408
    s_atomic_add s53, s[28:29], 1536
    s_atomic_add s53, s[28:29], 1664
    s_atomic_add s53, s[28:29], 1792
    s_atomic_add s53, s[28:29], 1920
gm_wgo:
    global_load_dwordx4 v[136:139], v5, s[26:27] offset:0
    global_load_dwordx4 v[140:143], v5, s[26:27] offset:512
    global_load_dwordx4 v[144:147], v5, s[26:27] offset:1024
    global_load_dwordx4 v[148:151], v5, s[26:27] offset:1536
    v_subrev_u32 v5, 0x4000, v5
    global_load_dwordx4 v[120:123], v5, s[26:27] offset:0
    global_load_dwordx4 v[124:127], v5, s[26:27] offset:512
    global_load_dwordx4 v[128:131], v5, s[26:27] offset:1024
    global_load_dwordx4 v[132:135], v5, s[26:27] offset:1536
    v_subrev_u32 v5, 0x4000, v5
    global_load_dwordx4 v[104:107], v5, s[26:27] offset:0
    global_load_dwordx4 v[108:111], v5, s[26:27] offset:512
    global_load_dwordx4 v[112:115], v5, s[26:27] offset:1024
    global_load_dwordx4 v[116:119], v5, s[26:27] offset:1536
    v_subrev_u32 v5, 0x4000, v5
    s_waitcnt vmcnt(8)
    v_mov_b32_dpp v152, v138 row_ror:8 row_mask:0xf bank_mask:0xf
    v_mov_b32_dpp v153, v139 row_ror:8 row_mask:0xf bank_mask:0xf
    v_mov_b32_dpp v154, v142 row_ror:8 row_mask:0xf bank_mask:0xf
    v_mov_b32_dpp v155, v143 row_ror:8 row_mask:0xf bank_mask:0xf
    v_mov_b32_dpp v156, v146 row_ror:8 row_mask:0xf bank_mask:0xf
    v_mov_b32_dpp v157, v147 row_ror:8 row_mask:0xf bank_mask:0xf
    v_mov_b32_dpp v158, v150 row_ror:8 row_mask:0xf bank_mask:0xf
    v_mov_b32_dpp v159, v151 row_ror:8 row_mask:0xf bank_mask:0xf
    v_mov_b32_dpp v138, v136 row_ror:8 row_mask:0xf bank_mask:0x3
    v_mov_b32_dpp v139, v137 row_ror:8 row_mask:0xf bank_mask:0x3
    v_mov_b32_dpp v142, v140 row_ror:8 row_mask:0xf bank_mask:0x3
    v_mov_b32_dpp v143, v141 row_ror:8 row_mask:0xf bank_mask:0x3
    v_mov_b32_dpp v146, v144 row_ror:8 row_mask:0xf bank_mask:0x3
    v_mov_b32_dpp v147, v145 row_ror:8 row_mask:0xf bank_mask:0x3
    v_mov_b32_dpp v150, v148 row_ror:8 row_mask:0xf bank_mask:0x3
    v_mov_b32_dpp v151, v149 row_ror:8 row_mask:0xf bank_mask:0x3
    v_mov_b32_dpp v136, v152 quad_perm:[0,1,2,3] row_mask:0xf bank_mask:0xc
    v_mov_b32_dpp v137, v153 quad_perm:[0,1,2,3] row_mask:0xf bank_mask:0xc
    v_mov_b32_dpp v140, v154 quad_perm:[0,1,2,3] row_mask:0xf bank_mask:0xc
    v_mov_b32_dpp v141, v155 quad_perm:[0,1,2,3] row_mask:0xf bank_mask:0xc
    v_mov_b32_dpp v144, v156 quad_perm:[0,1,2,3] row_mask:0xf bank_mask:0xc
    v_mov_b32_dpp v145, v157 quad_perm:[0,1,2,3] row_mask:0xf bank_mask:0xc
    v_mov_b32_dpp v148, v158 quad_perm:[0,1,2,3] row_mask:0xf bank_mask:0xc
    v_mov_b32_dpp v149, v159 quad_perm:[0,1,2,3] row_mask:0xf bank_mask:0xc
    v_perm_b32 v152, v140, v136, s44
    v_perm_b32 v153, v148, v144, s44
    v_perm_b32 v154, v142, v138, s44
    v_perm_b32 v155, v150, v146, s44
    v_perm_b32 v156, v140, v136, s45
    v_perm_b32 v157, v148, v144, s45
    v_perm_b32 v158, v142, v138, s45
    v_perm_b32 v159, v150, v146, s45
    v_perm_b32 v160, v141, v137, s44
    v_perm_b32 v161, v149, v145, s44
    v_perm_b32 v162, v143, v139, s44
    v_perm_b32 v163, v151, v147, s44
    v_perm_b32 v164, v141, v137, s45
    v_perm_b32 v165, v149, v145, s45
    v_perm_b32 v166, v143, v139, s45
    v_perm_b32 v167, v151, v147, s45
    s_waitcnt vmcnt(4)
    v_mov_b32_dpp v136, v122 row_ror:8 row_mask:0xf bank_mask:0xf
    v_mov_b32_dpp v137, v123 row_ror:8 row_mask:0xf bank_mask:0xf
    v_mov_b32_dpp v138, v126 row_ror:8 row_mask:0xf bank_mask:0xf
    v_mov_b32_dpp v139, v127 row_ror:8 row_mask:0xf bank_mask:0xf
    v_mov_b32_dpp v140, v130 row_ror:8 row_mask:0xf bank_mask:0xf
    v_mov_b32_dpp v141, v131 row_ror:8 row_mask:0xf bank_mask:0xf
    v_mov_b32_dpp v142, v134 row_ror:8 row_mask:0xf bank_mask:0xf
    v_mov_b32_dpp v143, v135 row_ror:8 row_mask:0xf bank_mask:0xf
    v_mov_b32_dpp v122, v120 row_ror:8 row_mask:0xf bank_mask:0x3
    v_mov_b32_dpp v123, v121 row_ror:8 row_mask:0xf bank_mask:0x3
    v_mov_b32_dpp v126, v124 row_ror:8 row_mask:0xf bank_mask:0x3
    v_mov_b32_dpp v127, v125 row_ror:8 row_mask:0xf bank_mask:0x3
    v_mov_b32_dpp v130, v128 row_ror:8 row_mask:0xf bank_mask:0x3
    v_mov_b32_dpp v131, v129 row_ror:8 row_mask:0xf bank_mask:0x3
    v_mov_b32_dpp v134, v132 row_ror:8 row_mask:0xf bank_mask:0x3
    v_mov_b32_dpp v135, v133 row_ror:8 row_mask:0xf bank_mask:0x3
    v_mov_b32_dpp v120, v136 quad_perm:[0,1,2,3] row_mask:0xf bank_mask:0xc
    v_mov_b32_dpp v121, v137 quad_perm:[0,1,2,3] row_mask:0xf bank_mask:0xc
    v_mov_b32_dpp v124, v138 quad_perm:[0,1,2,3] row_mask:0xf bank_mask:0xc
    v_mov_b32_dpp v125, v139 quad_perm:[0,1,2,3] row_mask:0xf bank_mask:0xc
    v_mov_b32_dpp v128, v140 quad_perm:[0,1,2,3] row_mask:0xf bank_mask:0xc
    v_mov_b32_dpp v129, v141 quad_perm:[0,1,2,3] row_mask:0xf bank_mask:0xc
    v_mov_b32_dpp v132, v142 quad_perm:[0,1,2,3] row_mask:0xf bank_mask:0xc
    v_mov_b32_dpp v133, v143 quad_perm:[0,1,2,3] row_mask:0xf bank_mask:0xc
    v_perm_b32 v136, v124, v120, s44
    v_perm_b32 v137, v132, v128, s44
    v_perm_b32 v138, v126, v122, s44
    v_perm_b32 v139, v134, v130, s44
    v_perm_b32 v140, v124, v120, s45
    v_perm_b32 v141, v132, v128, s45
    v_perm_b32 v142, v126, v122, s45
    v_perm_b32 v143, v134, v130, s45
    v_perm_b32 v144, v125, v121, s44
    v_perm_b32 v145, v133, v129, s44
    v_perm_b32 v146, v127, v123, s44
    v_perm_b32 v147, v135, v131, s44
    v_perm_b32 v148, v125, v121, s45
    v_perm_b32 v149, v133, v129, s45
    v_perm_b32 v150, v127, v123, s45
    v_perm_b32 v151, v135, v131, s45
    s_waitcnt vmcnt(0)
    v_mov_b32_dpp v120, v106 row_ror:8 row_mask:0xf bank_mask:0xf
    v_mov_b32_dpp v121, v107 row_ror:8 row_mask:0xf bank_mask:0xf
    v_mov_b32_dpp v122, v110 row_ror:8 row_mask:0xf bank_mask:0xf
    v_mov_b32_dpp v123, v111 row_ror:8 row_mask:0xf bank_mask:0xf
    v_mov_b32_dpp v124, v114 row_ror:8 row_mask:0xf bank_mask:0xf
    v_mov_b32_dpp v125, v115 row_ror:8 row_mask:0xf bank_mask:0xf
    v_mov_b32_dpp v126, v118 row_ror:8 row_mask:0xf bank_mask:0xf
    v_mov_b32_dpp v127, v119 row_ror:8 row_mask:0xf bank_mask:0xf
    v_mov_b32_dpp v106, v104 row_ror:8 row_mask:0xf bank_mask:0x3
    v_mov_b32_dpp v107, v105 row_ror:8 row_mask:0xf bank_mask:0x3
    v_mov_b32_dpp v110, v108 row_ror:8 row_mask:0xf bank_mask:0x3
    v_mov_b32_dpp v111, v109 row_ror:8 row_mask:0xf bank_mask:0x3
    v_mov_b32_dpp v114, v112 row_ror:8 row_mask:0xf bank_mask:0x3
    v_mov_b32_dpp v115, v113 row_ror:8 row_mask:0xf bank_mask:0x3
    v_mov_b32_dpp v118, v116 row_ror:8 row_mask:0xf bank_mask:0x3
    v_mov_b32_dpp v119, v117 row_ror:8 row_mask:0xf bank_mask:0x3
    v_mov_b32_dpp v104, v120 quad_perm:[0,1,2,3] row_mask:0xf bank_mask:0xc
    v_mov_b32_dpp v105, v121 quad_perm:[0,1,2,3] row_mask:0xf bank_mask:0xc
    v_mov_b32_dpp v108, v122 quad_perm:[0,1,2,3] row_mask:0xf bank_mask:0xc
    v_mov_b32_dpp v109, v123 quad_perm:[0,1,2,3] row_mask:0xf bank_mask:0xc
    v_mov_b32_dpp v112, v124 quad_perm:[0,1,2,3] row_mask:0xf bank_mask:0xc
    v_mov_b32_dpp v113, v125 quad_perm:[0,1,2,3] row_mask:0xf bank_mask:0xc
    v_mov_b32_dpp v116, v126 quad_perm:[0,1,2,3] row_mask:0xf bank_mask:0xc
    v_mov_b32_dpp v117, v127 quad_perm:[0,1,2,3] row_mask:0xf bank_mask:0xc
    v_perm_b32 v120, v108, v104, s44
    v_perm_b32 v121, v116, v112, s44
    v_perm_b32 v122, v110, v106, s44
    v_perm_b32 v123, v118, v114, s44
    v_perm_b32 v124, v108, v104, s45
    v_perm_b32 v125, v116, v112, s45
    v_perm_b32 v126, v110, v106, s45
    v_perm_b32 v127, v118, v114, s45
    v_perm_b32 v128, v109, v105, s44
    v_perm_b32 v129, v117, v113, s44
    v_perm_b32 v130, v111, v107, s44
    v_perm_b32 v131, v119, v115, s44
    v_perm_b32 v132, v109, v105, s45
    v_perm_b32 v133, v117, v113, s45
    v_perm_b32 v134, v111, v107, s45
    v_perm_b32 v135, v119, v115, s45
    s_cmp_lt_u32 s2, 125
    s_cbranch_scc1 gm_wskip
    global_load_dwordx4 v[88:91], v5, s[26:27] offset:0
    global_load_dwordx4 v[92:95], v5, s[26:27] offset:512
    global_load_dwordx4 v[96:99], v5, s[26:27] offset:1024
    global_load_dwordx4 v[100:103], v5, s[26:27] offset:1536
    v_subrev_u32 v5, 0x4000, v5
    global_load_dwordx4 v[72:75], v5, s[26:27] offset:0
    global_load_dwordx4 v[76:79], v5, s[26:27] offset:512
    global_load_dwordx4 v[80:83], v5, s[26:27] offset:1024
    global_load_dwordx4 v[84:87], v5, s[26:27] offset:1536
    v_subrev_u32 v5, 0x4000, v5
    global_load_dwordx4 v[56:59], v5, s[26:27] offset:0
    global_load_dwordx4 v[60:63], v5, s[26:27] offset:512
    global_load_dwordx4 v[64:67], v5, s[26:27] offset:1024
    global_load_dwordx4 v[68:71], v5, s[26:27] offset:1536
    v_subrev_u32 v5, 0x4000, v5
    global_load_dwordx4 v[40:43], v5, s[26:27] offset:0
    global_load_dwordx4 v[44:47], v5, s[26:27] offset:512
    global_load_dwordx4 v[48:51], v5, s[26:27] offset:1024
    global_load_dwordx4 v[52:55], v5, s[26:27] offset:1536
    v_subrev_u32 v5, 0x4000, v5
    s_waitcnt vmcnt(12)
    global_load_dwordx4 v[24:27], v5, s[26:27] offset:0
    global_load_dwordx4 v[28:31], v5, s[26:27] offset:512
    global_load_dwordx4 v[32:35], v5, s[26:27] offset:1024
    global_load_dwordx4 v[36:39], v5, s[26:27] offset:1536
    v_mov_b32_dpp v104, v90 row_ror:8 row_mask:0xf bank_mask:0xf
    v_mov_b32_dpp v105, v91 row_ror:8 row_mask:0xf bank_mask:0xf
    v_mov_b32_dpp v106, v94 row_ror:8 row_mask:0xf bank_mask:0xf
    v_mov_b32_dpp v107, v95 row_ror:8 row_mask:0xf bank_mask:0xf
    v_mov_b32_dpp v108, v98 row_ror:8 row_mask:0xf bank_mask:0xf
    v_mov_b32_dpp v109, v99 row_ror:8 row_mask:0xf bank_mask:0xf
    v_mov_b32_dpp v110, v102 row_ror:8 row_mask:0xf bank_mask:0xf
    v_mov_b32_dpp v111, v103 row_ror:8 row_mask:0xf bank_mask:0xf
    v_mov_b32_dpp v90, v88 row_ror:8 row_mask:0xf bank_mask:0x3
    v_mov_b32_dpp v91, v89 row_ror:8 row_mask:0xf bank_mask:0x3
    v_mov_b32_dpp v94, v92 row_ror:8 row_mask:0xf bank_mask:0x3
    v_mov_b32_dpp v95, v93 row_ror:8 row_mask:0xf bank_mask:0x3
    v_mov_b32_dpp v98, v96 row_ror:8 row_mask:0xf bank_mask:0x3
    v_mov_b32_dpp v99, v97 row_ror:8 row_mask:0xf bank_mask:0x3
    v_mov_b32_dpp v102, v100 row_ror:8 row_mask:0xf bank_mask:0x3
    v_mov_b32_dpp v103, v101 row_ror:8 row_mask:0xf bank_mask:0x3
    v_mov_b32_dpp v88, v104 quad_perm:[0,1,2,3] row_mask:0xf bank_mask:0xc
    v_mov_b32_dpp v89, v105 quad_perm:[0,1,2,3] row_mask:0xf bank_mask:0xc
    v_mov_b32_dpp v92, v106 quad_perm:[0,1,2,3] row_mask:0xf bank_mask:0xc
    v_mov_b32_dpp v93, v107 quad_perm:[0,1,2,3] row_mask:0xf bank_mask:0xc
    v_mov_b32_dpp v96, v108 quad_perm:[0,1,2,3] row_mask:0xf bank_mask:0xc
    v_mov_b32_dpp v97, v109 quad_perm:[0,1,2,3] row_mask:0xf bank_mask:0xc
    v_mov_b32_dpp v100, v110 quad_perm:[0,1,2,3] row_mask:0xf bank_mask:0xc
    v_mov_b32_dpp v101, v111 quad_perm:[0,1,2,3] row_mask:0xf bank_mask:0xc
    v_perm_b32 v104, v92, v88, s44
    v_perm_b32 v105, v100, v96, s44
    v_perm_b32 v106, v94, v90, s44
    v_perm_b32 v107, v102, v98, s44
    v_perm_b32 v108, v92, v88, s45
    v_perm_b32 v109, v100, v96, s45
    v_perm_b32 v110, v94, v90, s45
    v_perm_b32 v111, v102, v98, s45
    v_perm_b32 v112, v93, v89, s44
    v_perm_b32 v113, v101, v97, s44
    v_perm_b32 v114, v95, v91, s44
    v_perm_b32 v115, v103, v99, s44
    v_perm_b32 v116, v93, v89, s45
    v_perm_b32 v117, v101, v97, s45
    v_perm_b32 v118, v95, v91, s45
    v_perm_b32 v119, v103, v99, s45
    s_waitcnt vmcnt(12)
    v_mov_b32_dpp v88, v74 row_ror:8 row_mask:0xf bank_mask:0xf
    v_mov_b32_dpp v89, v75 row_ror:8 row_mask:0xf bank_mask:0xf
    v_mov_b32_dpp v90, v78 row_ror:8 row_mask:0xf bank_mask:0xf
    v_mov_b32_dpp v91, v79 row_ror:8 row_mask:0xf bank_mask:0xf
    v_mov_b32_dpp v92, v82 row_ror:8 row_mask:0xf bank_mask:0xf
    v_mov_b32_dpp v93, v83 row_ror:8 row_mask:0xf bank_mask:0xf
    v_mov_b32_dpp v94, v86 row_ror:8 row_mask:0xf bank_mask:0xf
    v_mov_b32_dpp v95, v87 row_ror:8 row_mask:0xf bank_mask:0xf
    v_mov_b32_dpp v74, v72 row_ror:8 row_mask:0xf bank_mask:0x3
    v_mov_b32_dpp v75, v73 row_ror:8 row_mask:0xf bank_mask:0x3
    v_mov_b32_dpp v78, v76 row_ror:8 row_mask:0xf bank_mask:0x3
    v_mov_b32_dpp v79, v77 row_ror:8 row_mask:0xf bank_mask:0x3
    v_mov_b32_dpp v82, v80 row_ror:8 row_mask:0xf bank_mask:0x3
    v_mov_b32_dpp v83, v81 row_ror:8 row_mask:0xf bank_mask:0x3
    v_mov_b32_dpp v86, v84 row_ror:8 row_mask:0xf bank_mask:0x3
    v_mov_b32_dpp v87, v85 row_ror:8 row_mask:0xf bank_mask:0x3
    v_mov_b32_dpp v72, v88 quad_perm:[0,1,2,3] row_mask:0xf bank_mask:0xc
    v_mov_b32_dpp v73, v89 quad_perm:[0,1,2,3] row_mask:0xf bank_mask:0xc
    v_mov_b32_dpp v76, v90 quad_perm:[0,1,2,3] row_mask:0xf bank_mask:0xc
    v_mov_b32_dpp v77, v91 quad_perm:[0,1,2,3] row_mask:0xf bank_mask:0xc
    v_mov_b32_dpp v80, v92 quad_perm:[0,1,2,3] row_mask:0xf bank_mask:0xc
    v_mov_b32_dpp v81, v93 quad_perm:[0,1,2,3] row_mask:0xf bank_mask:0xc
    v_mov_b32_dpp v84, v94 quad_perm:[0,1,2,3] row_mask:0xf bank_mask:0xc
    v_mov_b32_dpp v85, v95 quad_perm:[0,1,2,3] row_mask:0xf bank_mask:0xc
    v_perm_b32 v88, v76, v72, s44
    v_perm_b32 v89, v84, v80, s44
    v_perm_b32 v90, v78, v74, s44
    v_perm_b32 v91, v86, v82, s44
    v_perm_b32 v92, v76, v72, s45
    v_perm_b32 v93, v84, v80, s45
    v_perm_b32 v94, v78, v74, s45
    v_perm_b32 v95, v86, v82, s45
    v_perm_b32 v96, v77, v73, s44
    v_perm_b32 v97, v85, v81, s44
    v_perm_b32 v98, v79, v75, s44
    v_perm_b32 v99, v87, v83, s44
    v_perm_b32 v100, v77, v73, s45
    v_perm_b32 v101, v85, v81, s45
    v_perm_b32 v102, v79, v75, s45
    v_perm_b32 v103, v87, v83, s45
    s_waitcnt vmcnt(8)
    v_mov_b32_dpp v72, v58 row_ror:8 row_mask:0xf bank_mask:0xf
    v_mov_b32_dpp v73, v59 row_ror:8 row_mask:0xf bank_mask:0xf
    v_mov_b32_dpp v74, v62 row_ror:8 row_mask:0xf bank_mask:0xf
    v_mov_b32_dpp v75, v63 row_ror:8 row_mask:0xf bank_mask:0xf
    v_mov_b32_dpp v76, v66 row_ror:8 row_mask:0xf bank_mask:0xf
    v_mov_b32_dpp v77, v67 row_ror:8 row_mask:0xf bank_mask:0xf
    v_mov_b32_dpp v78, v70 row_ror:8 row_mask:0xf bank_mask:0xf
    v_mov_b32_dpp v79, v71 row_ror:8 row_mask:0xf bank_mask:0xf
    v_mov_b32_dpp v58, v56 row_ror:8 row_mask:0xf bank_mask:0x3
    v_mov_b32_dpp v59, v57 row_ror:8 row_mask:0xf bank_mask:0x3
    v_mov_b32_dpp v62, v60 row_ror:8 row_mask:0xf bank_mask:0x3
    v_mov_b32_dpp v63, v61 row_ror:8 row_mask:0xf bank_mask:0x3
    v_mov_b32_dpp v66, v64 row_ror:8 row_mask:0xf bank_mask:0x3
    v_mov_b32_dpp v67, v65 row_ror:8 row_mask:0xf bank_mask:0x3
    v_mov_b32_dpp v70, v68 row_ror:8 row_mask:0xf bank_mask:0x3
    v_mov_b32_dpp v71, v69 row_ror:8 row_mask:0xf bank_mask:0x3
    v_mov_b32_dpp v56, v72 quad_perm:[0,1,2,3] row_mask:0xf bank_mask:0xc
    v_mov_b32_dpp v57, v73 quad_perm:[0,1,2,3] row_mask:0xf bank_mask:0xc
    v_mov_b32_dpp v60, v74 quad_perm:[0,1,2,3] row_mask:0xf bank_mask:0xc
    v_mov_b32_dpp v61, v75 quad_perm:[0,1,2,3] row_mask:0xf bank_mask:0xc
    v_mov_b32_dpp v64, v76 quad_perm:[0,1,2,3] row_mask:0xf bank_mask:0xc
    v_mov_b32_dpp v65, v77 quad_perm:[0,1,2,3] row_mask:0xf bank_mask:0xc
    v_mov_b32_dpp v68, v78 quad_perm:[0,1,2,3] row_mask:0xf bank_mask:0xc
    v_mov_b32_dpp v69, v79 quad_perm:[0,1,2,3] row_mask:0xf bank_mask:0xc
    v_perm_b32 v72, v60, v56, s44
    v_perm_b32 v73, v68, v64, s44
    v_perm_b32 v74, v62, v58, s44
    v_perm_b32 v75, v70, v66, s44
    v_perm_b32 v76, v60, v56, s45
    v_perm_b32 v77, v68, v64, s45
    v_perm_b32 v78, v62, v58, s45
    v_perm_b32 v79, v70, v66, s45
    v_perm_b32 v80, v61, v57, s44
    v_perm_b32 v81, v69, v65, s44
    v_perm_b32 v82, v63, v59, s44
    v_perm_b32 v83, v71, v67, s44
    v_perm_b32 v84, v61, v57, s45
    v_perm_b32 v85, v69, v65, s45
    v_perm_b32 v86, v63, v59, s45
    v_perm_b32 v87, v71, v67, s45
    s_waitcnt vmcnt(4)
    v_mov_b32_dpp v56, v42 row_ror:8 row_mask:0xf bank_mask:0xf
    v_mov_b32_dpp v57, v43 row_ror:8 row_mask:0xf bank_mask:0xf
    v_mov_b32_dpp v58, v46 row_ror:8 row_mask:0xf bank_mask:0xf
    v_mov_b32_dpp v59, v47 row_ror:8 row_mask:0xf bank_mask:0xf
    v_mov_b32_dpp v60, v50 row_ror:8 row_mask:0xf bank_mask:0xf
    v_mov_b32_dpp v61, v51 row_ror:8 row_mask:0xf bank_mask:0xf
    v_mov_b32_dpp v62, v54 row_ror:8 row_mask:0xf bank_mask:0xf
    v_mov_b32_dpp v63, v55 row_ror:8 row_mask:0xf bank_mask:0xf
    v_mov_b32_dpp v42, v40 row_ror:8 row_mask:0xf bank_mask:0x3
    v_mov_b32_dpp v43, v41 row_ror:8 row_mask:0xf bank_mask:0x3
    v_mov_b32_dpp v46, v44 row_ror:8 row_mask:0xf bank_mask:0x3
    v_mov_b32_dpp v47, v45 row_ror:8 row_mask:0xf bank_mask:0x3
    v_mov_b32_dpp v50, v48 row_ror:8 row_mask:0xf bank_mask:0x3
    v_mov_b32_dpp v51, v49 row_ror:8 row_mask:0xf bank_mask:0x3
    v_mov_b32_dpp v54, v52 row_ror:8 row_mask:0xf bank_mask:0x3
    v_mov_b32_dpp v55, v53 row_ror:8 row_mask:0xf bank_mask:0x3
    v_mov_b32_dpp v40, v56 quad_perm:[0,1,2,3] row_mask:0xf bank_mask:0xc
    v_mov_b32_dpp v41, v57 quad_perm:[0,1,2,3] row_mask:0xf bank_mask:0xc
    v_mov_b32_dpp v44, v58 quad_perm:[0,1,2,3] row_mask:0xf bank_mask:0xc
    v_mov_b32_dpp v45, v59 quad_perm:[0,1,2,3] row_mask:0xf bank_mask:0xc
    v_mov_b32_dpp v48, v60 quad_perm:[0,1,2,3] row_mask:0xf bank_mask:0xc
    v_mov_b32_dpp v49, v61 quad_perm:[0,1,2,3] row_mask:0xf bank_mask:0xc
    v_mov_b32_dpp v52, v62 quad_perm:[0,1,2,3] row_mask:0xf bank_mask:0xc
    v_mov_b32_dpp v53, v63 quad_perm:[0,1,2,3] row_mask:0xf bank_mask:0xc
    v_perm_b32 v56, v44, v40, s44
    v_perm_b32 v57, v52, v48, s44
    v_perm_b32 v58, v46, v42, s44
    v_perm_b32 v59, v54, v50, s44
    v_perm_b32 v60, v44, v40, s45
    v_perm_b32 v61, v52, v48, s45
    v_perm_b32 v62, v46, v42, s45
    v_perm_b32 v63, v54, v50, s45
    v_perm_b32 v64, v45, v41, s44
    v_perm_b32 v65, v53, v49, s44
    v_perm_b32 v66, v47, v43, s44
    v_perm_b32 v67, v55, v51, s44
    v_perm_b32 v68, v45, v41, s45
    v_perm_b32 v69, v53, v49, s45
    v_perm_b32 v70, v47, v43, s45
    v_perm_b32 v71, v55, v51, s45
    s_waitcnt vmcnt(0)
    v_mov_b32_dpp v40, v26 row_ror:8 row_mask:0xf bank_mask:0xf
    v_mov_b32_dpp v41, v27 row_ror:8 row_mask:0xf bank_mask:0xf
    v_mov_b32_dpp v42, v30 row_ror:8 row_mask:0xf bank_mask:0xf
    v_mov_b32_dpp v43, v31 row_ror:8 row_mask:0xf bank_mask:0xf
    v_mov_b32_dpp v44, v34 row_ror:8 row_mask:0xf bank_mask:0xf
    v_mov_b32_dpp v45, v35 row_ror:8 row_mask:0xf bank_mask:0xf
    v_mov_b32_dpp v46, v38 row_ror:8 row_mask:0xf bank_mask:0xf
    v_mov_b32_dpp v47, v39 row_ror:8 row_mask:0xf bank_mask:0xf
    v_mov_b32_dpp v26, v24 row_ror:8 row_mask:0xf bank_mask:0x3
    v_mov_b32_dpp v27, v25 row_ror:8 row_mask:0xf bank_mask:0x3
    v_mov_b32_dpp v30, v28 row_ror:8 row_mask:0xf bank_mask:0x3
    v_mov_b32_dpp v31, v29 row_ror:8 row_mask:0xf bank_mask:0x3
    v_mov_b32_dpp v34, v32 row_ror:8 row_mask:0xf bank_mask:0x3
    v_mov_b32_dpp v35, v33 row_ror:8 row_mask:0xf bank_mask:0x3
    v_mov_b32_dpp v38, v36 row_ror:8 row_mask:0xf bank_mask:0x3
    v_mov_b32_dpp v39, v37 row_ror:8 row_mask:0xf bank_mask:0x3
    v_mov_b32_dpp v24, v40 quad_perm:[0,1,2,3] row_mask:0xf bank_mask:0xc
    v_mov_b32_dpp v25, v41 quad_perm:[0,1,2,3] row_mask:0xf bank_mask:0xc
    v_mov_b32_dpp v28, v42 quad_perm:[0,1,2,3] row_mask:0xf bank_mask:0xc
    v_mov_b32_dpp v29, v43 quad_perm:[0,1,2,3] row_mask:0xf bank_mask:0xc
    v_mov_b32_dpp v32, v44 quad_perm:[0,1,2,3] row_mask:0xf bank_mask:0xc
    v_mov_b32_dpp v33, v45 quad_perm:[0,1,2,3] row_mask:0xf bank_mask:0xc
    v_mov_b32_dpp v36, v46 quad_perm:[0,1,2,3] row_mask:0xf bank_mask:0xc
    v_mov_b32_dpp v37, v47 quad_perm:[0,1,2,3] row_mask:0xf bank_mask:0xc
    v_perm_b32 v40, v28, v24, s44
    v_perm_b32 v41, v36, v32, s44
    v_perm_b32 v42, v30, v26, s44
    v_perm_b32 v43, v38, v34, s44
    v_perm_b32 v44, v28, v24, s45
    v_perm_b32 v45, v36, v32, s45
    v_perm_b32 v46, v30, v26, s45
    v_perm_b32 v47, v38, v34, s45
    v_perm_b32 v48, v29, v25, s44
    v_perm_b32 v49, v37, v33, s44
    v_perm_b32 v50, v31, v27, s44
    v_perm_b32 v51, v39, v35, s44
    v_perm_b32 v52, v29, v25, s45
    v_perm_b32 v53, v37, v33, s45
    v_perm_b32 v54, v31, v27, s45
    v_perm_b32 v55, v39, v35, s45
gm_wskip:
    s_waitcnt vmcnt(0)
    s_mul_i32 s41, s2, 625
    s_add_u32 s52, s41, 640
    s_add_u32 s41, s41, 15
    s_lshr_b32 s41, s41, 4
    s_lshr_b32 s52, s52, 4
    s_mov_b32 s12, s56
    s_and_b32 s13, s57, 0xffff
    s_lshl_b32 s14, s52, 11
    s_mov_b32 s15, 0x20000
    s_mul_i32 s42, s17, 15360
    s_add_u32 s42, s42, 40960
    s_lshl_b32 s43, s17, 1
    s_sub_u32 s43, s43, 1
    v_lshlrev_b32 v6, 2, v3
    v_add_u32 v11, 0, v3
    v_mul_u32_u24 v10, 21846, v11
    v_lshrrev_b32 v10, 16, v10
    v_lshl_add_u32 v34, v10, 2, s42
    v_mad_i32_i24 v10, v10, -3, v11
    v_lshlrev_b32 v30, 4, v10
    v_add_u32 v11, 64, v3
    v_mul_u32_u24 v10, 21846, v11
    v_lshrrev_b32 v10, 16, v10
    v_lshl_add_u32 v35, v10, 2, s42
    v_mad_i32_i24 v10, v10, -3, v11
    v_lshlrev_b32 v31, 4, v10
    v_add_u32 v11, 128, v3
    v_mul_u32_u24 v10, 21846, v11
    v_lshrrev_b32 v10, 16, v10
    v_lshl_add_u32 v36, v10, 2, s42
    v_mad_i32_i24 v10, v10, -3, v11
    v_lshlrev_b32 v32, 4, v10
gm_sp1:
    v_mov_b32 v11, 0
    ds_read_b32 v11, v11 offset:308
    s_waitcnt lgkmcnt(0)
    v_readfirstlane_b32 s62, v11
    s_cmp_ge_u32 s62, 1
    s_cbranch_scc1 gm_sp1x
    s_sleep 1
    s_branch gm_sp1
gm_sp1x:
    buffer_load_dword v4, v12, s[8:11], s22 offen offset:60 sc1
    s_waitcnt vmcnt(0)
gm_pass:
    v_lshrrev_b32 v8, 16, v4
    v_subrev_u32 v8, s24, v8
    v_med3_i32 v8, v8, 0, s20
    v_mov_b32 v9, v8
    v_and_b32 v12, 1, v0
    v_and_b32 v14, 0xffff, v4
    v_add_u32_dpp v9, v9, v9 row_shr:2 row_mask:0xf bank_mask:0xf
    v_add3_u32 v14, v14, v12, s24
    s_nop 0
    v_add_u32_dpp v9, v9, v9 row_shr:4 row_mask:0xf bank_mask:0xf
    v_mad_u32_u24 v14, v14, 40, v13
    s_nop 0
    v_add_u32_dpp v9, v9, v9 row_shr:8 row_mask:0xf bank_mask:0xf
    v_sub_u32 v15, v8, v12
    s_nop 0
    v_add_u32_dpp v9, v9, v9 row_bcast:15 row_mask:0xa bank_mask:0xf
    s_nop 0
    s_nop 0
    v_add_u32_dpp v9, v9, v9 row_bcast:31 row_mask:0xc bank_mask:0xf
    s_nop 0
    s_nop 0
    v_readlane_b32 s47, v9, 63
    v_sub_u32 v16, v9, v15
    v_lshl_add_u32 v16, v16, 2, s42
    v_cmpx_lt_i32 vcc, 0, v15
    s_cbranch_execz gm_tb_done
    ds_write_b32 v16, v14 offset:0
    v_add_u32 v14, 80, v14
    v_cmpx_lt_i32 vcc, 2, v15
    s_cbranch_execz gm_tb_done
    ds_write_b32 v16, v14 offset:8
    v_add_u32 v14, 80, v14
    v_cmpx_lt_i32 vcc, 4, v15
    s_cbranch_execz gm_tb_done
    ds_write_b32 v16, v14 offset:16
    v_add_u32 v14, 80, v14
    v_cmpx_lt_i32 vcc, 6, v15
    s_cbranch_execz gm_tb_done
    ds_write_b32 v16, v14 offset:24
    v_add_u32 v14, 80, v14
    v_cmpx_lt_i32 vcc, 8, v15
    s_cbranch_execz gm_tb_done
    ds_write_b32 v16, v14 offset:32
    v_add_u32 v14, 80, v14
    v_cmpx_lt_i32 vcc, 10, v15
    s_cbranch_execz gm_tb_done
    ds_write_b32 v16, v14 offset:40
    v_add_u32 v14, 80, v14
    v_cmpx_lt_i32 vcc, 12, v15
    s_cbranch_execz gm_tb_done
    ds_write_b32 v16, v14 offset:48
    v_add_u32 v14, 80, v14
    v_cmpx_lt_i32 vcc, 14, v15
    s_cbranch_execz gm_tb_done
    ds_write_b32 v16, v14 offset:56
    v_add_u32 v14, 80, v14
    v_cmpx_lt_i32 vcc, 16, v15
    s_cbranch_execz gm_tb_done
    ds_write_b32 v16, v14 offset:64
    v_add_u32 v14, 80, v14
    v_cmpx_lt_i32 vcc, 18, v15
    s_cbranch_execz gm_tb_done
    ds_write_b32 v16, v14 offset:72
gm_tb_done:
    s_mov_b64 exec, -1
    s_mul_i32 s47, s47, 3
    v_mov_b32 v17, 0
    ds_read_b32 v29, v17 offset:456
    s_and_b32 s62, s2, 15
    s_lshl_b32 s62, s62, 7
    s_add_u32 s62, s62, 11730944
    v_mov_b32 v28, s62
    global_load_dword v27, v28, s[54:55] sc1
    s_barrier
    ds_read_b32 v15, v6 offset:384
    ds_read_b32 v17, v17 offset:272
    v_mov_b32 v11, v34
    v_mov_b32 v10, v35
    v_mov_b32 v14, v36
    s_waitcnt lgkmcnt(1)
    v_add_u32_dpp v15, v15, v15 row_shr:1 row_mask:0xf bank_mask:0xf
    s_nop 1
    v_add_u32_dpp v15, v15, v15 row_shr:2 row_mask:0xf bank_mask:0xf
    s_nop 1
    v_add_u32_dpp v15, v15, v15 row_shr:4 row_mask:0xf bank_mask:0xf
    s_waitcnt lgkmcnt(0)
    v_readfirstlane_b32 s21, v17
    v_readlane_b32 s23, v15, 7
    v_readlane_b32 s46, v15, s43
    s_cmp_gt_u32 s23, 773
    s_cbranch_scc1 gm_ovf
    s_cmp_eq_u32 s17, 0
    s_cmov_b32 s46, 0
    s_mul_i32 s46, s46, 48
    s_add_u32 m0, s46, 3776
    s_mov_b32 s63, 0x100000
gm_ep:
    s_waitcnt vmcnt(0)
    v_sub_u32 v27, v27, v29
    v_lshrrev_b32 v27, 16, v27
    v_cmp_eq_u32 vcc, 2, v27
    s_cbranch_vccnz gm_go2
    s_and_b32 s62, s63, 31
    s_sub_u32 s63, s63, 1
    s_cmp_eq_u32 s62, 1
    s_cbranch_scc1 gm_epd
    s_sleep 6
    global_load_dword v27, v28, s[54:55] sc1
    s_branch gm_ep
gm_epd:
    s_and_b32 s62, s2, 15
    s_lshl_b32 s62, s62, 7
    s_add_u32 s62, s62, 11730944
    v_mov_b32 v27, s62
    v_lshlrev_b32 v28, 6, v0
    v_and_b32 v28, 0xc0, v28
    s_mov_b32 s63, 0x100000
mn_poll2dem:
    s_sub_u32 s63, s63, 1
    s_cbranch_scc1 mn_poll2dex
    global_load_dword v29, v28, s[60:61] sc1
    s_waitcnt vmcnt(0)
    v_add_u32_dpp v29, v29, v29 quad_perm:[2,3,0,1] row_mask:0xf bank_mask:0xf
    s_sleep 8
    v_readlane_b32 s62, v29, 1
    s_cmp_lg_u32 s62, 125
    s_cbranch_scc1 mn_poll2dem
mn_poll2dex:
gm_go2:
gm_raw:
    ds_read_b32 v18, v11 offset:0
    ds_read_b32 v19, v10 offset:0
    ds_read_b32 v20, v14 offset:0
    ds_read_b32 v21, v11 offset:256
    ds_read_b32 v22, v10 offset:256
    ds_read_b32 v23, v14 offset:256
    ds_read_b32 v24, v11 offset:512
    ds_read_b32 v25, v10 offset:512
    ds_read_b32 v26, v14 offset:512
    v_cmpx_gt_i32 vcc, s47, v3
    s_cbranch_execz gm_raw_done
    s_waitcnt lgkmcnt(8)
    v_add_u32 v18, v18, v30
    buffer_load_dwordx4 v18, s[8:11], 0 offen sc1 lds
    s_add_u32 m0, m0, 1024
    s_sub_i32 s47, s47, 64
    v_cmpx_gt_i32 vcc, s47, v3
    s_cbranch_execz gm_raw_done
    s_waitcnt lgkmcnt(7)
    v_add_u32 v19, v19, v31
    buffer_load_dwordx4 v19, s[8:11], 0 offen sc1 lds
    s_add_u32 m0, m0, 1024
    s_sub_i32 s47, s47, 64
    v_cmpx_gt_i32 vcc, s47, v3
    s_cbranch_execz gm_raw_done
    s_waitcnt lgkmcnt(6)
    v_add_u32 v20, v20, v32
    buffer_load_dwordx4 v20, s[8:11], 0 offen sc1 lds
    s_add_u32 m0, m0, 1024
    s_sub_i32 s47, s47, 64
    v_cmpx_gt_i32 vcc, s47, v3
    s_cbranch_execz gm_raw_done
    s_waitcnt lgkmcnt(5)
    v_add_u32 v21, v21, v30
    buffer_load_dwordx4 v21, s[8:11], 0 offen sc1 lds
    s_add_u32 m0, m0, 1024
    s_sub_i32 s47, s47, 64
    v_cmpx_gt_i32 vcc, s47, v3
    s_cbranch_execz gm_raw_done
    s_waitcnt lgkmcnt(4)
    v_add_u32 v22, v22, v31
    buffer_load_dwordx4 v22, s[8:11], 0 offen sc1 lds
    s_add_u32 m0, m0, 1024
    s_sub_i32 s47, s47, 64
    v_cmpx_gt_i32 vcc, s47, v3
    s_cbranch_execz gm_raw_done
    s_waitcnt lgkmcnt(3)
    v_add_u32 v23, v23, v32
    buffer_load_dwordx4 v23, s[8:11], 0 offen sc1 lds
    s_add_u32 m0, m0, 1024
    s_sub_i32 s47, s47, 64
    v_cmpx_gt_i32 vcc, s47, v3
    s_cbranch_execz gm_raw_done
    s_waitcnt lgkmcnt(2)
    v_add_u32 v24, v24, v30
    buffer_load_dwordx4 v24, s[8:11], 0 offen sc1 lds
    s_add_u32 m0, m0, 1024
    s_sub_i32 s47, s47, 64
    v_cmpx_gt_i32 vcc, s47, v3
    s_cbranch_execz gm_raw_done
    s_waitcnt lgkmcnt(1)
    v_add_u32 v25, v25, v31
    buffer_load_dwordx4 v25, s[8:11], 0 offen sc1 lds
    s_add_u32 m0, m0, 1024
    s_sub_i32 s47, s47, 64
    v_cmpx_gt_i32 vcc, s47, v3
    s_cbranch_execz gm_raw_done
    s_waitcnt lgkmcnt(0)
    v_add_u32 v26, v26, v32
    buffer_load_dwordx4 v26, s[8:11], 0 offen sc1 lds
    s_add_u32 m0, m0, 1024
    s_sub_i32 s47, s47, 64
    v_add_u32 v11, 768, v11
    v_add_u32 v10, 768, v10
    v_add_u32 v14, 768, v14
    s_branch gm_raw
gm_raw_done:
    s_mov_b64 exec, -1
    s_barrier
    s_waitcnt vmcnt(0) lgkmcnt(0)
    s_barrier
    s_cmp_lg_u32 s21, 0
    s_cbranch_scc1 gm_next
    s_cmp_ge_u32 s2, 125
    s_cbranch_scc1 gm_wdone
    global_load_dwordx4 v[88:91], v5, s[26:27] offset:0
    global_load_dwordx4 v[92:95], v5, s[26:27] offset:512
    global_load_dwordx4 v[96:99], v5, s[26:27] offset:1024
    global_load_dwordx4 v[100:103], v5, s[26:27] offset:1536
    v_subrev_u32 v5, 0x4000, v5
    s_waitcnt vmcnt(0)
    global_load_dwordx4 v[72:75], v5, s[26:27] offset:0
    global_load_dwordx4 v[76:79], v5, s[26:27] offset:512
    global_load_dwordx4 v[80:83], v5, s[26:27] offset:1024
    global_load_dwordx4 v[84:87], v5, s[26:27] offset:1536
    v_subrev_u32 v5, 0x4000, v5
    v_mov_b32_dpp v104, v90 row_ror:8 row_mask:0xf bank_mask:0xf
    v_mov_b32_dpp v105, v91 row_ror:8 row_mask:0xf bank_mask:0xf
    v_mov_b32_dpp v106, v94 row_ror:8 row_mask:0xf bank_mask:0xf
    v_mov_b32_dpp v107, v95 row_ror:8 row_mask:0xf bank_mask:0xf
    v_mov_b32_dpp v108, v98 row_ror:8 row_mask:0xf bank_mask:0xf
    v_mov_b32_dpp v109, v99 row_ror:8 row_mask:0xf bank_mask:0xf
    v_mov_b32_dpp v110, v102 row_ror:8 row_mask:0xf bank_mask:0xf
    v_mov_b32_dpp v111, v103 row_ror:8 row_mask:0xf bank_mask:0xf
    v_mov_b32_dpp v90, v88 row_ror:8 row_mask:0xf bank_mask:0x3
    v_mov_b32_dpp v91, v89 row_ror:8 row_mask:0xf bank_mask:0x3
    v_mov_b32_dpp v94, v92 row_ror:8 row_mask:0xf bank_mask:0x3
    v_mov_b32_dpp v95, v93 row_ror:8 row_mask:0xf bank_mask:0x3
    v_mov_b32_dpp v98, v96 row_ror:8 row_mask:0xf bank_mask:0x3
    v_mov_b32_dpp v99, v97 row_ror:8 row_mask:0xf bank_mask:0x3
    v_mov_b32_dpp v102, v100 row_ror:8 row_mask:0xf bank_mask:0x3
    v_mov_b32_dpp v103, v101 row_ror:8 row_mask:0xf bank_mask:0x3
    v_mov_b32_dpp v88, v104 quad_perm:[0,1,2,3] row_mask:0xf bank_mask:0xc
    v_mov_b32_dpp v89, v105 quad_perm:[0,1,2,3] row_mask:0xf bank_mask:0xc
    v_mov_b32_dpp v92, v106 quad_perm:[0,1,2,3] row_mask:0xf bank_mask:0xc
    v_mov_b32_dpp v93, v107 quad_perm:[0,1,2,3] row_mask:0xf bank_mask:0xc
    v_mov_b32_dpp v96, v108 quad_perm:[0,1,2,3] row_mask:0xf bank_mask:0xc
    v_mov_b32_dpp v97, v109 quad_perm:[0,1,2,3] row_mask:0xf bank_mask:0xc
    v_mov_b32_dpp v100, v110 quad_perm:[0,1,2,3] row_mask:0xf bank_mask:0xc
    v_mov_b32_dpp v101, v111 quad_perm:[0,1,2,3] row_mask:0xf bank_mask:0xc
    v_perm_b32 v104, v92, v88, s44
    v_perm_b32 v105, v100, v96, s44
    v_perm_b32 v106, v94, v90, s44
    v_perm_b32 v107, v102, v98, s44
    v_perm_b32 v108, v92, v88, s45
    v_perm_b32 v109, v100, v96, s45
    v_perm_b32 v110, v94, v90, s45
    v_perm_b32 v111, v102, v98, s45
    v_perm_b32 v112, v93, v89, s44
    v_perm_b32 v113, v101, v97, s44
    v_perm_b32 v114, v95, v91, s44
    v_perm_b32 v115, v103, v99, s44
    v_perm_b32 v116, v93, v89, s45
    v_perm_b32 v117, v101, v97, s45
    v_perm_b32 v118, v95, v91, s45
    v_perm_b32 v119, v103, v99, s45
    s_waitcnt vmcnt(0)
    global_load_dwordx4 v[56:59], v5, s[26:27] offset:0
    global_load_dwordx4 v[60:63], v5, s[26:27] offset:512
    global_load_dwordx4 v[64:67], v5, s[26:27] offset:1024
    global_load_dwordx4 v[68:71], v5, s[26:27] offset:1536
    v_subrev_u32 v5, 0x4000, v5
    v_mov_b32_dpp v88, v74 row_ror:8 row_mask:0xf bank_mask:0xf
    v_mov_b32_dpp v89, v75 row_ror:8 row_mask:0xf bank_mask:0xf
    v_mov_b32_dpp v90, v78 row_ror:8 row_mask:0xf bank_mask:0xf
    v_mov_b32_dpp v91, v79 row_ror:8 row_mask:0xf bank_mask:0xf
    v_mov_b32_dpp v92, v82 row_ror:8 row_mask:0xf bank_mask:0xf
    v_mov_b32_dpp v93, v83 row_ror:8 row_mask:0xf bank_mask:0xf
    v_mov_b32_dpp v94, v86 row_ror:8 row_mask:0xf bank_mask:0xf
    v_mov_b32_dpp v95, v87 row_ror:8 row_mask:0xf bank_mask:0xf
    v_mov_b32_dpp v74, v72 row_ror:8 row_mask:0xf bank_mask:0x3
    v_mov_b32_dpp v75, v73 row_ror:8 row_mask:0xf bank_mask:0x3
    v_mov_b32_dpp v78, v76 row_ror:8 row_mask:0xf bank_mask:0x3
    v_mov_b32_dpp v79, v77 row_ror:8 row_mask:0xf bank_mask:0x3
    v_mov_b32_dpp v82, v80 row_ror:8 row_mask:0xf bank_mask:0x3
    v_mov_b32_dpp v83, v81 row_ror:8 row_mask:0xf bank_mask:0x3
    v_mov_b32_dpp v86, v84 row_ror:8 row_mask:0xf bank_mask:0x3
    v_mov_b32_dpp v87, v85 row_ror:8 row_mask:0xf bank_mask:0x3
    v_mov_b32_dpp v72, v88 quad_perm:[0,1,2,3] row_mask:0xf bank_mask:0xc
    v_mov_b32_dpp v73, v89 quad_perm:[0,1,2,3] row_mask:0xf bank_mask:0xc
    v_mov_b32_dpp v76, v90 quad_perm:[0,1,2,3] row_mask:0xf bank_mask:0xc
    v_mov_b32_dpp v77, v91 quad_perm:[0,1,2,3] row_mask:0xf bank_mask:0xc
    v_mov_b32_dpp v80, v92 quad_perm:[0,1,2,3] row_mask:0xf bank_mask:0xc
    v_mov_b32_dpp v81, v93 quad_perm:[0,1,2,3] row_mask:0xf bank_mask:0xc
    v_mov_b32_dpp v84, v94 quad_perm:[0,1,2,3] row_mask:0xf bank_mask:0xc
    v_mov_b32_dpp v85, v95 quad_perm:[0,1,2,3] row_mask:0xf bank_mask:0xc
    v_perm_b32 v88, v76, v72, s44
    v_perm_b32 v89, v84, v80, s44
    v_perm_b32 v90, v78, v74, s44
    v_perm_b32 v91, v86, v82, s44
    v_perm_b32 v92, v76, v72, s45
    v_perm_b32 v93, v84, v80, s45
    v_perm_b32 v94, v78, v74, s45
    v_perm_b32 v95, v86, v82, s45
    v_perm_b32 v96, v77, v73, s44
    v_perm_b32 v97, v85, v81, s44
    v_perm_b32 v98, v79, v75, s44
    v_perm_b32 v99, v87, v83, s44
    v_perm_b32 v100, v77, v73, s45
    v_perm_b32 v101, v85, v81, s45
    v_perm_b32 v102, v79, v75, s45
    v_perm_b32 v103, v87, v83, s45
    s_waitcnt vmcnt(0)
    global_load_dwordx4 v[40:43], v5, s[26:27] offset:0
    global_load_dwordx4 v[44:47], v5, s[26:27] offset:512
    global_load_dwordx4 v[48:51], v5, s[26:27] offset:1024
    global_load_dwordx4 v[52:55], v5, s[26:27] offset:1536
    v_subrev_u32 v5, 0x4000, v5
    v_mov_b32_dpp v72, v58 row_ror:8 row_mask:0xf bank_mask:0xf
    v_mov_b32_dpp v73, v59 row_ror:8 row_mask:0xf bank_mask:0xf
    v_mov_b32_dpp v74, v62 row_ror:8 row_mask:0xf bank_mask:0xf
    v_mov_b32_dpp v75, v63 row_ror:8 row_mask:0xf bank_mask:0xf
    v_mov_b32_dpp v76, v66 row_ror:8 row_mask:0xf bank_mask:0xf
    v_mov_b32_dpp v77, v67 row_ror:8 row_mask:0xf bank_mask:0xf
    v_mov_b32_dpp v78, v70 row_ror:8 row_mask:0xf bank_mask:0xf
    v_mov_b32_dpp v79, v71 row_ror:8 row_mask:0xf bank_mask:0xf
    v_mov_b32_dpp v58, v56 row_ror:8 row_mask:0xf bank_mask:0x3
    v_mov_b32_dpp v59, v57 row_ror:8 row_mask:0xf bank_mask:0x3
    v_mov_b32_dpp v62, v60 row_ror:8 row_mask:0xf bank_mask:0x3
    v_mov_b32_dpp v63, v61 row_ror:8 row_mask:0xf bank_mask:0x3
    v_mov_b32_dpp v66, v64 row_ror:8 row_mask:0xf bank_mask:0x3
    v_mov_b32_dpp v67, v65 row_ror:8 row_mask:0xf bank_mask:0x3
    v_mov_b32_dpp v70, v68 row_ror:8 row_mask:0xf bank_mask:0x3
    v_mov_b32_dpp v71, v69 row_ror:8 row_mask:0xf bank_mask:0x3
    v_mov_b32_dpp v56, v72 quad_perm:[0,1,2,3] row_mask:0xf bank_mask:0xc
    v_mov_b32_dpp v57, v73 quad_perm:[0,1,2,3] row_mask:0xf bank_mask:0xc
    v_mov_b32_dpp v60, v74 quad_perm:[0,1,2,3] row_mask:0xf bank_mask:0xc
    v_mov_b32_dpp v61, v75 quad_perm:[0,1,2,3] row_mask:0xf bank_mask:0xc
    v_mov_b32_dpp v64, v76 quad_perm:[0,1,2,3] row_mask:0xf bank_mask:0xc
    v_mov_b32_dpp v65, v77 quad_perm:[0,1,2,3] row_mask:0xf bank_mask:0xc
    v_mov_b32_dpp v68, v78 quad_perm:[0,1,2,3] row_mask:0xf bank_mask:0xc
    v_mov_b32_dpp v69, v79 quad_perm:[0,1,2,3] row_mask:0xf bank_mask:0xc
    v_perm_b32 v72, v60, v56, s44
    v_perm_b32 v73, v68, v64, s44
    v_perm_b32 v74, v62, v58, s44
    v_perm_b32 v75, v70, v66, s44
    v_perm_b32 v76, v60, v56, s45
    v_perm_b32 v77, v68, v64, s45
    v_perm_b32 v78, v62, v58, s45
    v_perm_b32 v79, v70, v66, s45
    v_perm_b32 v80, v61, v57, s44
    v_perm_b32 v81, v69, v65, s44
    v_perm_b32 v82, v63, v59, s44
    v_perm_b32 v83, v71, v67, s44
    v_perm_b32 v84, v61, v57, s45
    v_perm_b32 v85, v69, v65, s45
    v_perm_b32 v86, v63, v59, s45
    v_perm_b32 v87, v71, v67, s45
    s_waitcnt vmcnt(0)
    global_load_dwordx4 v[24:27], v5, s[26:27] offset:0
    global_load_dwordx4 v[28:31], v5, s[26:27] offset:512
    global_load_dwordx4 v[32:35], v5, s[26:27] offset:1024
    global_load_dwordx4 v[36:39], v5, s[26:27] offset:1536
    v_mov_b32_dpp v56, v42 row_ror:8 row_mask:0xf bank_mask:0xf
    v_mov_b32_dpp v57, v43 row_ror:8 row_mask:0xf bank_mask:0xf
    v_mov_b32_dpp v58, v46 row_ror:8 row_mask:0xf bank_mask:0xf
    v_mov_b32_dpp v59, v47 row_ror:8 row_mask:0xf bank_mask:0xf
    v_mov_b32_dpp v60, v50 row_ror:8 row_mask:0xf bank_mask:0xf
    v_mov_b32_dpp v61, v51 row_ror:8 row_mask:0xf bank_mask:0xf
    v_mov_b32_dpp v62, v54 row_ror:8 row_mask:0xf bank_mask:0xf
    v_mov_b32_dpp v63, v55 row_ror:8 row_mask:0xf bank_mask:0xf
    v_mov_b32_dpp v42, v40 row_ror:8 row_mask:0xf bank_mask:0x3
    v_mov_b32_dpp v43, v41 row_ror:8 row_mask:0xf bank_mask:0x3
    v_mov_b32_dpp v46, v44 row_ror:8 row_mask:0xf bank_mask:0x3
    v_mov_b32_dpp v47, v45 row_ror:8 row_mask:0xf bank_mask:0x3
    v_mov_b32_dpp v50, v48 row_ror:8 row_mask:0xf bank_mask:0x3
    v_mov_b32_dpp v51, v49 row_ror:8 row_mask:0xf bank_mask:0x3
    v_mov_b32_dpp v54, v52 row_ror:8 row_mask:0xf bank_mask:0x3
    v_mov_b32_dpp v55, v53 row_ror:8 row_mask:0xf bank_mask:0x3
    v_mov_b32_dpp v40, v56 quad_perm:[0,1,2,3] row_mask:0xf bank_mask:0xc
    v_mov_b32_dpp v41, v57 quad_perm:[0,1,2,3] row_mask:0xf bank_mask:0xc
    v_mov_b32_dpp v44, v58 quad_perm:[0,1,2,3] row_mask:0xf bank_mask:0xc
    v_mov_b32_dpp v45, v59 quad_perm:[0,1,2,3] row_mask:0xf bank_mask:0xc
    v_mov_b32_dpp v48, v60 quad_perm:[0,1,2,3] row_mask:0xf bank_mask:0xc
    v_mov_b32_dpp v49, v61 quad_perm:[0,1,2,3] row_mask:0xf bank_mask:0xc
    v_mov_b32_dpp v52, v62 quad_perm:[0,1,2,3] row_mask:0xf bank_mask:0xc
    v_mov_b32_dpp v53, v63 quad_perm:[0,1,2,3] row_mask:0xf bank_mask:0xc
    v_perm_b32 v56, v44, v40, s44
    v_perm_b32 v57, v52, v48, s44
    v_perm_b32 v58, v46, v42, s44
    v_perm_b32 v59, v54, v50, s44
    v_perm_b32 v60, v44, v40, s45
    v_perm_b32 v61, v52, v48, s45
    v_perm_b32 v62, v46, v42, s45
    v_perm_b32 v63, v54, v50, s45
    v_perm_b32 v64, v45, v41, s44
    v_perm_b32 v65, v53, v49, s44
    v_perm_b32 v66, v47, v43, s44
    v_perm_b32 v67, v55, v51, s44
    v_perm_b32 v68, v45, v41, s45
    v_perm_b32 v69, v53, v49, s45
    v_perm_b32 v70, v47, v43, s45
    v_perm_b32 v71, v55, v51, s45
    s_waitcnt vmcnt(0)
    v_mov_b32_dpp v40, v26 row_ror:8 row_mask:0xf bank_mask:0xf
    v_mov_b32_dpp v41, v27 row_ror:8 row_mask:0xf bank_mask:0xf
    v_mov_b32_dpp v42, v30 row_ror:8 row_mask:0xf bank_mask:0xf
    v_mov_b32_dpp v43, v31 row_ror:8 row_mask:0xf bank_mask:0xf
    v_mov_b32_dpp v44, v34 row_ror:8 row_mask:0xf bank_mask:0xf
    v_mov_b32_dpp v45, v35 row_ror:8 row_mask:0xf bank_mask:0xf
    v_mov_b32_dpp v46, v38 row_ror:8 row_mask:0xf bank_mask:0xf
    v_mov_b32_dpp v47, v39 row_ror:8 row_mask:0xf bank_mask:0xf
    v_mov_b32_dpp v26, v24 row_ror:8 row_mask:0xf bank_mask:0x3
    v_mov_b32_dpp v27, v25 row_ror:8 row_mask:0xf bank_mask:0x3
    v_mov_b32_dpp v30, v28 row_ror:8 row_mask:0xf bank_mask:0x3
    v_mov_b32_dpp v31, v29 row_ror:8 row_mask:0xf bank_mask:0x3
    v_mov_b32_dpp v34, v32 row_ror:8 row_mask:0xf bank_mask:0x3
    v_mov_b32_dpp v35, v33 row_ror:8 row_mask:0xf bank_mask:0x3
    v_mov_b32_dpp v38, v36 row_ror:8 row_mask:0xf bank_mask:0x3
    v_mov_b32_dpp v39, v37 row_ror:8 row_mask:0xf bank_mask:0x3
    v_mov_b32_dpp v24, v40 quad_perm:[0,1,2,3] row_mask:0xf bank_mask:0xc
    v_mov_b32_dpp v25, v41 quad_perm:[0,1,2,3] row_mask:0xf bank_mask:0xc
    v_mov_b32_dpp v28, v42 quad_perm:[0,1,2,3] row_mask:0xf bank_mask:0xc
    v_mov_b32_dpp v29, v43 quad_perm:[0,1,2,3] row_mask:0xf bank_mask:0xc
    v_mov_b32_dpp v32, v44 quad_perm:[0,1,2,3] row_mask:0xf bank_mask:0xc
    v_mov_b32_dpp v33, v45 quad_perm:[0,1,2,3] row_mask:0xf bank_mask:0xc
    v_mov_b32_dpp v36, v46 quad_perm:[0,1,2,3] row_mask:0xf bank_mask:0xc
    v_mov_b32_dpp v37, v47 quad_perm:[0,1,2,3] row_mask:0xf bank_mask:0xc
    v_perm_b32 v40, v28, v24, s44
    v_perm_b32 v41, v36, v32, s44
    v_perm_b32 v42, v30, v26, s44
    v_perm_b32 v43, v38, v34, s44
    v_perm_b32 v44, v28, v24, s45
    v_perm_b32 v45, v36, v32, s45
    v_perm_b32 v46, v30, v26, s45
    v_perm_b32 v47, v38, v34, s45
    v_perm_b32 v48, v29, v25, s44
    v_perm_b32 v49, v37, v33, s44
    v_perm_b32 v50, v31, v27, s44
    v_perm_b32 v51, v39, v35, s44
    v_perm_b32 v52, v29, v25, s45
    v_perm_b32 v53, v37, v33, s45
    v_perm_b32 v54, v31, v27, s45
    v_perm_b32 v55, v39, v35, s45
gm_wdone:
    v_lshrrev_b32 v1, 4, v3
    v_lshlrev_b32 v1, 11, v1
    v_and_b32 v4, 7, v3
    v_lshl_add_u32 v1, v4, 4, v1
    v_bfe_u32 v4, v3, 3, 1
    v_lshl_add_u32 v1, v4, 9, v1
    v_and_b32 v4, 3, v3
    v_lshrrev_b32 v5, 2, v3
    v_mul_u32_u24 v0, 576, v4
    v_lshl_add_u32 v0, v5, 3, v0
    v_add_u32 v0, 40960, v0
    s_lshl_b32 s38, s41, 11
    s_lshl_b32 s53, s17, 7
    s_add_u32 s38, s38, s53
    s_mov_b32 s36, 0x24924924
    s_mov_b32 s39, 0
    s_waitcnt vmcnt(0)
gm_poll:
    v_mov_b32 v2, 0
    ds_read_b32 v2, v2 offset:276
    s_waitcnt lgkmcnt(0)
    v_readfirstlane_b32 s52, v2
    s_and_b32 s52, s52, s36
    s_cbranch_scc1 gm_go
    s_sleep 2
    s_branch gm_poll
gm_go:
    s_ff1_i32_b32 s52, s52
    s_bitset0_b32 s36, s52
    s_mul_i32 s52, s52, 11
    s_bfe_u32 s53, s52, 0x10005
    s_bfe_u32 s52, s52, 0x30006
    s_mul_i32 s35, s53, 61440
    s_mul_i32 s31, s52, 2304
    s_add_u32 s31, s31, s35
    s_sub_u32 s35, s31, s39
    v_add_u32 v0, s35, v0
    ds_read_b64_tr_b16 v[12:13], v0 offset:0
    ds_read_b64_tr_b16 v[14:15], v0 offset:128
    ds_read_b64_tr_b16 v[16:17], v0 offset:256
    ds_read_b64_tr_b16 v[18:19], v0 offset:384
    s_mov_b32 s39, s31
    s_mul_i32 s33, s53, 5
    s_add_u32 s33, s33, s52
    s_lshl_b32 s33, s33, 13
    s_add_u32 s33, s33, s38
    s_mov_b32 s37, s33
    s_mov_b32 s32, 0x7ffffff0
gm_loop:
    s_waitcnt lgkmcnt(2)
    v_mfma_f32_16x16x32_bf16 v[24:27], v[12:15], v[40:43], 0
    s_setprio 3
    v_cvt_pk_bf16_f32 v7, v33, v37
    v_cvt_pk_bf16_f32 v5, v32, v36
    ds_read_b64_tr_b16 v[20:21], v0 offset:15360
    s_setprio 0
    v_mfma_f32_16x16x32_bf16 v[28:31], v[12:15], v[44:47], 0
    s_setprio 3
    v_cvt_pk_bf16_f32 v11, v35, v39
    v_cvt_pk_bf16_f32 v9, v34, v38
    ds_read_b64_tr_b16 v[22:23], v0 offset:15488
    s_setprio 0
    v_mfma_f32_16x16x32_bf16 v[32:35], v[12:15], v[48:51], 0
    s_setprio 3
    v_mov_b32_dpp v2, v6 row_ror:8 row_mask:0xf bank_mask:0xf
    v_mov_b32_dpp v3, v7 row_ror:8 row_mask:0xf bank_mask:0xf
    s_setprio 0
    v_mfma_f32_16x16x32_bf16 v[36:39], v[12:15], v[52:55], 0
    s_setprio 3
    v_mov_b32_dpp v6, v4 row_ror:8 row_mask:0xf bank_mask:0x3
    v_mov_b32_dpp v7, v5 row_ror:8 row_mask:0xf bank_mask:0x3
    s_setprio 0
    s_waitcnt lgkmcnt(2)
    v_mfma_f32_16x16x32_bf16 v[24:27], v[16:19], v[56:59], v[24:27]
    s_setprio 3
    ds_read_b64_tr_b16 v[12:13], v0 offset:15616
    v_mov_b32_dpp v4, v2 quad_perm:[0,1,2,3] row_mask:0xf bank_mask:0xc
    s_setprio 0
    v_mfma_f32_16x16x32_bf16 v[28:31], v[16:19], v[60:63], v[28:31]
    s_setprio 3
    ds_read_b64_tr_b16 v[14:15], v0 offset:15744
    v_mov_b32_dpp v5, v3 quad_perm:[0,1,2,3] row_mask:0xf bank_mask:0xc
    s_setprio 0
    v_mfma_f32_16x16x32_bf16 v[32:35], v[16:19], v[64:67], v[32:35]
    s_setprio 3
    buffer_store_dwordx4 v[4:7], v1, s[12:15], s32 offen offset:0 sc0 sc1
    v_mov_b32_dpp v2, v10 row_ror:8 row_mask:0xf bank_mask:0xf
    s_setprio 0
    v_mfma_f32_16x16x32_bf16 v[36:39], v[16:19], v[68:71], v[36:39]
    s_setprio 3
    v_mov_b32_dpp v3, v11 row_ror:8 row_mask:0xf bank_mask:0xf
    v_mov_b32_dpp v10, v8 row_ror:8 row_mask:0xf bank_mask:0x3
    s_setprio 0
    s_waitcnt lgkmcnt(2)
    v_mfma_f32_16x16x32_bf16 v[24:27], v[20:23], v[72:75], v[24:27]
    s_setprio 3
    ds_read_b64_tr_b16 v[16:17], v0 offset:30720
    v_mov_b32_dpp v11, v9 row_ror:8 row_mask:0xf bank_mask:0x3
    s_setprio 0
    v_mfma_f32_16x16x32_bf16 v[28:31], v[20:23], v[76:79], v[28:31]
    s_setprio 3
    ds_read_b64_tr_b16 v[18:19], v0 offset:30848
    v_mov_b32_dpp v8, v2 quad_perm:[0,1,2,3] row_mask:0xf bank_mask:0xc
    s_setprio 0
    v_mfma_f32_16x16x32_bf16 v[32:35], v[20:23], v[80:83], v[32:35]
    s_setprio 3
    v_mov_b32_dpp v9, v3 quad_perm:[0,1,2,3] row_mask:0xf bank_mask:0xc
    buffer_store_dwordx4 v[8:11], v1, s[12:15], s32 offen offset:1024 sc0 sc1
    s_setprio 0
    v_mfma_f32_16x16x32_bf16 v[36:39], v[20:23], v[84:87], v[36:39]
    s_waitcnt lgkmcnt(2)
    v_mfma_f32_16x16x32_bf16 v[24:27], v[12:15], v[88:91], v[24:27]
    ds_read_b64_tr_b16 v[20:21], v0 offset:30976
    v_mfma_f32_16x16x32_bf16 v[28:31], v[12:15], v[92:95], v[28:31]
    ds_read_b64_tr_b16 v[22:23], v0 offset:31104
    v_mfma_f32_16x16x32_bf16 v[32:35], v[12:15], v[96:99], v[32:35]
    s_setprio 3
    v_mov_b32 v2, 0
    s_setprio 0
    v_mfma_f32_16x16x32_bf16 v[36:39], v[12:15], v[100:103], v[36:39]
    ds_read_b32 v2, v2 offset:276
    s_waitcnt lgkmcnt(3)
    v_mfma_f32_16x16x32_bf16 v[24:27], v[16:19], v[104:107], v[24:27]
    ds_read_b64_tr_b16 v[12:13], v0 offset:46080
    v_mfma_f32_16x16x32_bf16 v[28:31], v[16:19], v[108:111], v[28:31]
    ds_read_b64_tr_b16 v[14:15], v0 offset:46208
    v_mfma_f32_16x16x32_bf16 v[32:35], v[16:19], v[112:115], v[32:35]
    s_setprio 3
    s_waitcnt lgkmcnt(2)
    v_readfirstlane_b32 s52, v2
    s_and_b32 s52, s52, s36
    s_setprio 0
    v_mfma_f32_16x16x32_bf16 v[36:39], v[16:19], v[116:119], v[36:39]
    s_cselect_b32 s34, 1, 0
    s_ff1_i32_b32 s52, s52
    s_waitcnt lgkmcnt(2)
    v_mfma_f32_16x16x32_bf16 v[24:27], v[20:23], v[120:123], v[24:27]
    ds_read_b64_tr_b16 v[16:17], v0 offset:46336
    s_bitset0_b32 s36, s52
    s_mul_i32 s52, s52, 11
    v_mfma_f32_16x16x32_bf16 v[28:31], v[20:23], v[124:127], v[28:31]
    ds_read_b64_tr_b16 v[18:19], v0 offset:46464
    s_bfe_u32 s53, s52, 0x10005
    s_bfe_u32 s52, s52, 0x30006
    v_mfma_f32_16x16x32_bf16 v[32:35], v[20:23], v[128:131], v[32:35]
    s_mul_i32 s35, s53, 61440
    s_mul_i32 s31, s52, 2304
    s_add_u32 s31, s31, s35
    v_mfma_f32_16x16x32_bf16 v[36:39], v[20:23], v[132:135], v[36:39]
    s_setprio 3
    s_sub_u32 s35, s31, s39
    v_add_u32 v0, s35, v0
    s_setprio 0
    s_waitcnt lgkmcnt(2)
    v_mfma_f32_16x16x32_bf16 v[24:27], v[12:15], v[136:139], v[24:27]
    ds_read_b64_tr_b16 v[20:21], v0 offset:0
    v_mfma_f32_16x16x32_bf16 v[28:31], v[12:15], v[140:143], v[28:31]
    ds_read_b64_tr_b16 v[22:23], v0 offset:128
    v_mfma_f32_16x16x32_bf16 v[32:35], v[12:15], v[144:147], v[32:35]
    s_mov_b32 s39, s31
    s_mul_i32 s33, s53, 5
    s_add_u32 s33, s33, s52
    v_mfma_f32_16x16x32_bf16 v[36:39], v[12:15], v[148:151], v[36:39]
    s_lshl_b32 s33, s33, 13
    s_add_u32 s33, s33, s38
    s_waitcnt lgkmcnt(2)
    v_mfma_f32_16x16x32_bf16 v[24:27], v[16:19], v[152:155], v[24:27]
    ds_read_b64_tr_b16 v[12:13], v0 offset:256
    v_mfma_f32_16x16x32_bf16 v[28:31], v[16:19], v[156:159], v[28:31]
    ds_read_b64_tr_b16 v[14:15], v0 offset:384
    s_mov_b32 s32, s37
    s_mov_b32 s37, s33
    v_mfma_f32_16x16x32_bf16 v[32:35], v[16:19], v[160:163], v[32:35]
    s_cmp_eq_u32 s34, 0
    s_nop 1
    v_mfma_f32_16x16x32_bf16 v[36:39], v[16:19], v[164:167], v[36:39]
    s_setprio 3
    v_cvt_pk_bf16_f32 v4, v24, v28
    v_cvt_pk_bf16_f32 v6, v25, v29
    v_cvt_pk_bf16_f32 v8, v26, v30
    v_cvt_pk_bf16_f32 v10, v27, v31
    s_setprio 0
    s_cbranch_scc1 gm_drain
    s_waitcnt lgkmcnt(2)
    v_mfma_f32_16x16x32_bf16 v[24:27], v[20:23], v[40:43], 0
    s_setprio 3
    v_cvt_pk_bf16_f32 v7, v33, v37
    v_cvt_pk_bf16_f32 v5, v32, v36
    ds_read_b64_tr_b16 v[16:17], v0 offset:15360
    s_setprio 0
    v_mfma_f32_16x16x32_bf16 v[28:31], v[20:23], v[44:47], 0
    s_setprio 3
    v_cvt_pk_bf16_f32 v11, v35, v39
    v_cvt_pk_bf16_f32 v9, v34, v38
    ds_read_b64_tr_b16 v[18:19], v0 offset:15488
    s_setprio 0
    v_mfma_f32_16x16x32_bf16 v[32:35], v[20:23], v[48:51], 0
    s_setprio 3
    v_mov_b32_dpp v2, v6 row_ror:8 row_mask:0xf bank_mask:0xf
    v_mov_b32_dpp v3, v7 row_ror:8 row_mask:0xf bank_mask:0xf
    s_setprio 0
    v_mfma_f32_16x16x32_bf16 v[36:39], v[20:23], v[52:55], 0
    s_setprio 3
    v_mov_b32_dpp v6, v4 row_ror:8 row_mask:0xf bank_mask:0x3
    v_mov_b32_dpp v7, v5 row_ror:8 row_mask:0xf bank_mask:0x3
    s_setprio 0
    s_waitcnt lgkmcnt(2)
    v_mfma_f32_16x16x32_bf16 v[24:27], v[12:15], v[56:59], v[24:27]
    s_setprio 3
    ds_read_b64_tr_b16 v[20:21], v0 offset:15616
    v_mov_b32_dpp v4, v2 quad_perm:[0,1,2,3] row_mask:0xf bank_mask:0xc
    s_setprio 0
    v_mfma_f32_16x16x32_bf16 v[28:31], v[12:15], v[60:63], v[28:31]
    s_setprio 3
    ds_read_b64_tr_b16 v[22:23], v0 offset:15744
    v_mov_b32_dpp v5, v3 quad_perm:[0,1,2,3] row_mask:0xf bank_mask:0xc
    s_setprio 0
    v_mfma_f32_16x16x32_bf16 v[32:35], v[12:15], v[64:67], v[32:35]
    s_setprio 3
    buffer_store_dwordx4 v[4:7], v1, s[12:15], s32 offen offset:0 sc0 sc1
    v_mov_b32_dpp v2, v10 row_ror:8 row_mask:0xf bank_mask:0xf
    s_setprio 0
    v_mfma_f32_16x16x32_bf16 v[36:39], v[12:15], v[68:71], v[36:39]
    s_setprio 3
    v_mov_b32_dpp v3, v11 row_ror:8 row_mask:0xf bank_mask:0xf
    v_mov_b32_dpp v10, v8 row_ror:8 row_mask:0xf bank_mask:0x3
    s_setprio 0
    s_waitcnt lgkmcnt(2)
    v_mfma_f32_16x16x32_bf16 v[24:27], v[16:19], v[72:75], v[24:27]
    s_setprio 3
    ds_read_b64_tr_b16 v[12:13], v0 offset:30720
    v_mov_b32_dpp v11, v9 row_ror:8 row_mask:0xf bank_mask:0x3
    s_setprio 0
    v_mfma_f32_16x16x32_bf16 v[28:31], v[16:19], v[76:79], v[28:31]
    s_setprio 3
    ds_read_b64_tr_b16 v[14:15], v0 offset:30848
    v_mov_b32_dpp v8, v2 quad_perm:[0,1,2,3] row_mask:0xf bank_mask:0xc
    s_setprio 0
    v_mfma_f32_16x16x32_bf16 v[32:35], v[16:19], v[80:83], v[32:35]
    s_setprio 3
    v_mov_b32_dpp v9, v3 quad_perm:[0,1,2,3] row_mask:0xf bank_mask:0xc
    buffer_store_dwordx4 v[8:11], v1, s[12:15], s32 offen offset:1024 sc0 sc1
    s_setprio 0
    v_mfma_f32_16x16x32_bf16 v[36:39], v[16:19], v[84:87], v[36:39]
    s_waitcnt lgkmcnt(2)
    v_mfma_f32_16x16x32_bf16 v[24:27], v[20:23], v[88:91], v[24:27]
    ds_read_b64_tr_b16 v[16:17], v0 offset:30976
    v_mfma_f32_16x16x32_bf16 v[28:31], v[20:23], v[92:95], v[28:31]
    ds_read_b64_tr_b16 v[18:19], v0 offset:31104
    v_mfma_f32_16x16x32_bf16 v[32:35], v[20:23], v[96:99], v[32:35]
    s_setprio 3
    v_mov_b32 v2, 0
    s_setprio 0
    v_mfma_f32_16x16x32_bf16 v[36:39], v[20:23], v[100:103], v[36:39]
    ds_read_b32 v2, v2 offset:276
    s_waitcnt lgkmcnt(3)
    v_mfma_f32_16x16x32_bf16 v[24:27], v[12:15], v[104:107], v[24:27]
    ds_read_b64_tr_b16 v[20:21], v0 offset:46080
    v_mfma_f32_16x16x32_bf16 v[28:31], v[12:15], v[108:111], v[28:31]
    ds_read_b64_tr_b16 v[22:23], v0 offset:46208
    v_mfma_f32_16x16x32_bf16 v[32:35], v[12:15], v[112:115], v[32:35]
    s_setprio 3
    s_waitcnt lgkmcnt(2)
    v_readfirstlane_b32 s52, v2
    s_and_b32 s52, s52, s36
    s_setprio 0
    v_mfma_f32_16x16x32_bf16 v[36:39], v[12:15], v[116:119], v[36:39]
    s_cselect_b32 s34, 1, 0
    s_ff1_i32_b32 s52, s52
    s_waitcnt lgkmcnt(2)
    v_mfma_f32_16x16x32_bf16 v[24:27], v[16:19], v[120:123], v[24:27]
    ds_read_b64_tr_b16 v[12:13], v0 offset:46336
    s_bitset0_b32 s36, s52
    s_mul_i32 s52, s52, 11
    v_mfma_f32_16x16x32_bf16 v[28:31], v[16:19], v[124:127], v[28:31]
    ds_read_b64_tr_b16 v[14:15], v0 offset:46464
    s_bfe_u32 s53, s52, 0x10005
    s_bfe_u32 s52, s52, 0x30006
    v_mfma_f32_16x16x32_bf16 v[32:35], v[16:19], v[128:131], v[32:35]
    s_mul_i32 s35, s53, 61440
    s_mul_i32 s31, s52, 2304
    s_add_u32 s31, s31, s35
    v_mfma_f32_16x16x32_bf16 v[36:39], v[16:19], v[132:135], v[36:39]
    s_setprio 3
    s_sub_u32 s35, s31, s39
    v_add_u32 v0, s35, v0
    s_setprio 0
    s_waitcnt lgkmcnt(2)
    v_mfma_f32_16x16x32_bf16 v[24:27], v[20:23], v[136:139], v[24:27]
    ds_read_b64_tr_b16 v[16:17], v0 offset:0
    v_mfma_f32_16x16x32_bf16 v[28:31], v[20:23], v[140:143], v[28:31]
    ds_read_b64_tr_b16 v[18:19], v0 offset:128
    v_mfma_f32_16x16x32_bf16 v[32:35], v[20:23], v[144:147], v[32:35]
    s_mov_b32 s39, s31
    s_mul_i32 s33, s53, 5
    s_add_u32 s33, s33, s52
    v_mfma_f32_16x16x32_bf16 v[36:39], v[20:23], v[148:151], v[36:39]
    s_lshl_b32 s33, s33, 13
    s_add_u32 s33, s33, s38
    s_waitcnt lgkmcnt(2)
    v_mfma_f32_16x16x32_bf16 v[24:27], v[12:15], v[152:155], v[24:27]
    ds_read_b64_tr_b16 v[20:21], v0 offset:256
    v_mfma_f32_16x16x32_bf16 v[28:31], v[12:15], v[156:159], v[28:31]
    ds_read_b64_tr_b16 v[22:23], v0 offset:384
    s_mov_b32 s32, s37
    s_mov_b32 s37, s33
    v_mfma_f32_16x16x32_bf16 v[32:35], v[12:15], v[160:163], v[32:35]
    s_cmp_eq_u32 s34, 0
    s_nop 1
    v_mfma_f32_16x16x32_bf16 v[36:39], v[12:15], v[164:167], v[36:39]
    s_setprio 3
    v_cvt_pk_bf16_f32 v4, v24, v28
    v_cvt_pk_bf16_f32 v6, v25, v29
    v_cvt_pk_bf16_f32 v8, v26, v30
    v_cvt_pk_bf16_f32 v10, v27, v31
    s_setprio 0
    s_cbranch_scc1 gm_drain
    s_waitcnt lgkmcnt(2)
    v_mfma_f32_16x16x32_bf16 v[24:27], v[16:19], v[40:43], 0
    s_setprio 3
    v_cvt_pk_bf16_f32 v7, v33, v37
    v_cvt_pk_bf16_f32 v5, v32, v36
    ds_read_b64_tr_b16 v[12:13], v0 offset:15360
    s_setprio 0
    v_mfma_f32_16x16x32_bf16 v[28:31], v[16:19], v[44:47], 0
    s_setprio 3
    v_cvt_pk_bf16_f32 v11, v35, v39
    v_cvt_pk_bf16_f32 v9, v34, v38
    ds_read_b64_tr_b16 v[14:15], v0 offset:15488
    s_setprio 0
    v_mfma_f32_16x16x32_bf16 v[32:35], v[16:19], v[48:51], 0
    s_setprio 3
    v_mov_b32_dpp v2, v6 row_ror:8 row_mask:0xf bank_mask:0xf
    v_mov_b32_dpp v3, v7 row_ror:8 row_mask:0xf bank_mask:0xf
    s_setprio 0
    v_mfma_f32_16x16x32_bf16 v[36:39], v[16:19], v[52:55], 0
    s_setprio 3
    v_mov_b32_dpp v6, v4 row_ror:8 row_mask:0xf bank_mask:0x3
    v_mov_b32_dpp v7, v5 row_ror:8 row_mask:0xf bank_mask:0x3
    s_setprio 0
    s_waitcnt lgkmcnt(2)
    v_mfma_f32_16x16x32_bf16 v[24:27], v[20:23], v[56:59], v[24:27]
    s_setprio 3
    ds_read_b64_tr_b16 v[16:17], v0 offset:15616
    v_mov_b32_dpp v4, v2 quad_perm:[0,1,2,3] row_mask:0xf bank_mask:0xc
    s_setprio 0
    v_mfma_f32_16x16x32_bf16 v[28:31], v[20:23], v[60:63], v[28:31]
    s_setprio 3
    ds_read_b64_tr_b16 v[18:19], v0 offset:15744
    v_mov_b32_dpp v5, v3 quad_perm:[0,1,2,3] row_mask:0xf bank_mask:0xc
    s_setprio 0
    v_mfma_f32_16x16x32_bf16 v[32:35], v[20:23], v[64:67], v[32:35]
    s_setprio 3
    buffer_store_dwordx4 v[4:7], v1, s[12:15], s32 offen offset:0 sc0 sc1
    v_mov_b32_dpp v2, v10 row_ror:8 row_mask:0xf bank_mask:0xf
    s_setprio 0
    v_mfma_f32_16x16x32_bf16 v[36:39], v[20:23], v[68:71], v[36:39]
    s_setprio 3
    v_mov_b32_dpp v3, v11 row_ror:8 row_mask:0xf bank_mask:0xf
    v_mov_b32_dpp v10, v8 row_ror:8 row_mask:0xf bank_mask:0x3
    s_setprio 0
    s_waitcnt lgkmcnt(2)
    v_mfma_f32_16x16x32_bf16 v[24:27], v[12:15], v[72:75], v[24:27]
    s_setprio 3
    ds_read_b64_tr_b16 v[20:21], v0 offset:30720
    v_mov_b32_dpp v11, v9 row_ror:8 row_mask:0xf bank_mask:0x3
    s_setprio 0
    v_mfma_f32_16x16x32_bf16 v[28:31], v[12:15], v[76:79], v[28:31]
    s_setprio 3
    ds_read_b64_tr_b16 v[22:23], v0 offset:30848
    v_mov_b32_dpp v8, v2 quad_perm:[0,1,2,3] row_mask:0xf bank_mask:0xc
    s_setprio 0
    v_mfma_f32_16x16x32_bf16 v[32:35], v[12:15], v[80:83], v[32:35]
    s_setprio 3
    v_mov_b32_dpp v9, v3 quad_perm:[0,1,2,3] row_mask:0xf bank_mask:0xc
    buffer_store_dwordx4 v[8:11], v1, s[12:15], s32 offen offset:1024 sc0 sc1
    s_setprio 0
    v_mfma_f32_16x16x32_bf16 v[36:39], v[12:15], v[84:87], v[36:39]
    s_waitcnt lgkmcnt(2)
    v_mfma_f32_16x16x32_bf16 v[24:27], v[16:19], v[88:91], v[24:27]
    ds_read_b64_tr_b16 v[12:13], v0 offset:30976
    v_mfma_f32_16x16x32_bf16 v[28:31], v[16:19], v[92:95], v[28:31]
    ds_read_b64_tr_b16 v[14:15], v0 offset:31104
    v_mfma_f32_16x16x32_bf16 v[32:35], v[16:19], v[96:99], v[32:35]
    s_setprio 3
    v_mov_b32 v2, 0
    s_setprio 0
    v_mfma_f32_16x16x32_bf16 v[36:39], v[16:19], v[100:103], v[36:39]
    ds_read_b32 v2, v2 offset:276
    s_waitcnt lgkmcnt(3)
    v_mfma_f32_16x16x32_bf16 v[24:27], v[20:23], v[104:107], v[24:27]
    ds_read_b64_tr_b16 v[16:17], v0 offset:46080
    v_mfma_f32_16x16x32_bf16 v[28:31], v[20:23], v[108:111], v[28:31]
    ds_read_b64_tr_b16 v[18:19], v0 offset:46208
    v_mfma_f32_16x16x32_bf16 v[32:35], v[20:23], v[112:115], v[32:35]
    s_setprio 3
    s_waitcnt lgkmcnt(2)
    v_readfirstlane_b32 s52, v2
    s_and_b32 s52, s52, s36
    s_setprio 0
    v_mfma_f32_16x16x32_bf16 v[36:39], v[20:23], v[116:119], v[36:39]
    s_cselect_b32 s34, 1, 0
    s_ff1_i32_b32 s52, s52
    s_waitcnt lgkmcnt(2)
    v_mfma_f32_16x16x32_bf16 v[24:27], v[12:15], v[120:123], v[24:27]
    ds_read_b64_tr_b16 v[20:21], v0 offset:46336
    s_bitset0_b32 s36, s52
    s_mul_i32 s52, s52, 11
    v_mfma_f32_16x16x32_bf16 v[28:31], v[12:15], v[124:127], v[28:31]
    ds_read_b64_tr_b16 v[22:23], v0 offset:46464
    s_bfe_u32 s53, s52, 0x10005
    s_bfe_u32 s52, s52, 0x30006
    v_mfma_f32_16x16x32_bf16 v[32:35], v[12:15], v[128:131], v[32:35]
    s_mul_i32 s35, s53, 61440
    s_mul_i32 s31, s52, 2304
    s_add_u32 s31, s31, s35
    v_mfma_f32_16x16x32_bf16 v[36:39], v[12:15], v[132:135], v[36:39]
    s_setprio 3
    s_sub_u32 s35, s31, s39
    v_add_u32 v0, s35, v0
    s_setprio 0
    s_waitcnt lgkmcnt(2)
    v_mfma_f32_16x16x32_bf16 v[24:27], v[16:19], v[136:139], v[24:27]
    ds_read_b64_tr_b16 v[12:13], v0 offset:0
    v_mfma_f32_16x16x32_bf16 v[28:31], v[16:19], v[140:143], v[28:31]
    ds_read_b64_tr_b16 v[14:15], v0 offset:128
    v_mfma_f32_16x16x32_bf16 v[32:35], v[16:19], v[144:147], v[32:35]
    s_mov_b32 s39, s31
    s_mul_i32 s33, s53, 5
    s_add_u32 s33, s33, s52
    v_mfma_f32_16x16x32_bf16 v[36:39], v[16:19], v[148:151], v[36:39]
    s_lshl_b32 s33, s33, 13
    s_add_u32 s33, s33, s38
    s_waitcnt lgkmcnt(2)
    v_mfma_f32_16x16x32_bf16 v[24:27], v[20:23], v[152:155], v[24:27]
    ds_read_b64_tr_b16 v[16:17], v0 offset:256
    v_mfma_f32_16x16x32_bf16 v[28:31], v[20:23], v[156:159], v[28:31]
    ds_read_b64_tr_b16 v[18:19], v0 offset:384
    s_mov_b32 s32, s37
    s_mov_b32 s37, s33
    v_mfma_f32_16x16x32_bf16 v[32:35], v[20:23], v[160:163], v[32:35]
    s_cmp_eq_u32 s34, 0
    s_nop 1
    v_mfma_f32_16x16x32_bf16 v[36:39], v[20:23], v[164:167], v[36:39]
    s_setprio 3
    v_cvt_pk_bf16_f32 v4, v24, v28
    v_cvt_pk_bf16_f32 v6, v25, v29
    v_cvt_pk_bf16_f32 v8, v26, v30
    v_cvt_pk_bf16_f32 v10, v27, v31
    s_setprio 0
    s_cbranch_scc0 gm_loop
gm_drain:
    s_nop 2
    s_setprio 3
    v_cvt_pk_bf16_f32 v7, v33, v37
    v_cvt_pk_bf16_f32 v5, v32, v36
    v_cvt_pk_bf16_f32 v11, v35, v39
    v_cvt_pk_bf16_f32 v9, v34, v38
    v_mov_b32_dpp v2, v6 row_ror:8 row_mask:0xf bank_mask:0xf
    v_mov_b32_dpp v3, v7 row_ror:8 row_mask:0xf bank_mask:0xf
    v_mov_b32_dpp v6, v4 row_ror:8 row_mask:0xf bank_mask:0x3
    v_mov_b32_dpp v7, v5 row_ror:8 row_mask:0xf bank_mask:0x3
    v_mov_b32_dpp v4, v2 quad_perm:[0,1,2,3] row_mask:0xf bank_mask:0xc
    v_mov_b32_dpp v5, v3 quad_perm:[0,1,2,3] row_mask:0xf bank_mask:0xc
    buffer_store_dwordx4 v[4:7], v1, s[12:15], s32 offen offset:0 sc0 sc1
    v_mov_b32_dpp v2, v10 row_ror:8 row_mask:0xf bank_mask:0xf
    v_mov_b32_dpp v3, v11 row_ror:8 row_mask:0xf bank_mask:0xf
    v_mov_b32_dpp v10, v8 row_ror:8 row_mask:0xf bank_mask:0x3
    v_mov_b32_dpp v11, v9 row_ror:8 row_mask:0xf bank_mask:0x3
    v_mov_b32_dpp v8, v2 quad_perm:[0,1,2,3] row_mask:0xf bank_mask:0xc
    v_mov_b32_dpp v9, v3 quad_perm:[0,1,2,3] row_mask:0xf bank_mask:0xc
    buffer_store_dwordx4 v[8:11], v1, s[12:15], s32 offen offset:1024 sc0 sc1
    s_setprio 0
    s_cmp_lg_u32 s36, 0
    s_cbranch_scc1 gm_poll
    s_endpgm
mn_sp1:
    v_mov_b32 v55, 0
    ds_read_b32 v55, v55 offset:308
    s_waitcnt lgkmcnt(0)
    v_readfirstlane_b32 s62, v55
    s_cmp_ge_u32 s62, 1
    s_cbranch_scc1 mn_sp1x
    s_sleep 1
    s_branch mn_sp1
gm_wait2:
    v_mov_b32 v15, 0
    ds_read_b32 v17, v15 offset:304
    s_waitcnt lgkmcnt(0)
    v_readfirstlane_b32 s62, v17
    s_cmp_lg_u32 s62, 0
    s_cbranch_scc1 gm_go2
    s_sleep 1
    s_branch gm_wait2
gm_ovf:
    s_movk_i32 s20, 4
    s_barrier
    s_barrier
    s_branch gm_pass
gm_next:
    s_add_u32 s24, s24, s20
    s_barrier
    s_branch gm_pass
mn_w5:
    s_and_b32 s62, s2, 15
    s_lshl_b32 s62, s62, 7
    s_add_u32 s62, s62, 11730944
    v_mov_b32 v55, s62
    v_lshlrev_b32 v56, 6, v0
    v_and_b32 v56, 0xc0, v56
    s_mov_b32 s63, 0x100000
mn_poll2dm:
    s_sub_u32 s63, s63, 1
    s_cbranch_scc1 mn_poll2dx
    global_load_dword v57, v56, s[60:61] sc1
    s_waitcnt vmcnt(0)
    v_add_u32_dpp v57, v57, v57 quad_perm:[2,3,0,1] row_mask:0xf bank_mask:0xf
    s_sleep 8
    v_readlane_b32 s62, v57, 1
    s_cmp_lg_u32 s62, 125
    s_cbranch_scc1 mn_poll2dm
mn_poll2dx:
    v_add_u32 v55, 12, v35
    v_add_u32 v55, s24, v55
    v_lshrrev_b32 v56, 16, v58
    v_mov_b32 v23, 0
    v_cmpx_lt_u32 vcc, v55, v56
    s_cbranch_execz mn_g0
    v_cmp_gt_u32 vcc, 15, v55
    v_and_b32 v56, 0xffff, v58
    v_add_lshl_u32 v56, v55, v56, 2
    v_add_u32 v56, v56, v46
    v_lshl_add_u32 v57, v0, 4, s22
    v_and_or_b32 v57, v55, 12, v57
    v_cndmask_b32 v56, v56, v57, vcc
    buffer_load_dword v23, v56, s[8:11], 0 offen sc1
    s_waitcnt vmcnt(0)
mn_g0:
    s_mov_b64 exec, -1
    v_add_u32 v55, 16, v35
    v_add_u32 v55, s24, v55
    v_lshrrev_b32 v56, 16, v58
    v_mov_b32 v24, 0
    v_cmpx_lt_u32 vcc, v55, v56
    s_cbranch_execz mn_g1
    v_cmp_gt_u32 vcc, 15, v55
    v_and_b32 v56, 0xffff, v58
    v_add_lshl_u32 v56, v55, v56, 2
    v_add_u32 v56, v56, v46
    v_lshl_add_u32 v57, v0, 4, s22
    v_and_or_b32 v57, v55, 12, v57
    v_cndmask_b32 v56, v56, v57, vcc
    buffer_load_dword v24, v56, s[8:11], 0 offen sc1
    s_waitcnt vmcnt(0)
mn_g1:
    s_mov_b64 exec, -1
mn_more:
    s_add_u32 s52, s24, s20
    v_lshrrev_b32 v56, 16, v58
    v_cmp_lt_u32 vcc, s52, v56
    s_cbranch_vccz mn_count
    v_mov_b32 v55, 272
    ds_write_b32 v55, v48
    s_branch mn_count
mn_ovf:
    s_movk_i32 s20, 4
    s_waitcnt vmcnt(0) lgkmcnt(0)
    s_barrier
    s_branch mn_again
mn_next:
    s_set_gpr_idx_off
    s_waitcnt vmcnt(0) lgkmcnt(0)
    s_nop 7
    s_add_u32 s24, s24, s20
    v_mbcnt_lo_u32_b32 v0, -1, 0
    v_mbcnt_hi_u32_b32 v0, -1, v0
    v_lshl_add_u32 v0, s16, 6, v0
    v_lshrrev_b32 v56, 6, v0
    v_lshlrev_b32 v55, 1, v0
    v_and_b32 v55, 0x78, v55
    v_or_b32 v55, v55, v56
    v_cmp_gt_u32 vcc, 125, v55
    v_mul_u32_u24 v46, 5120, v55
    v_add_u32 v46, 7340032, v46
    v_bfrev_b32 v56, 2
    v_lshlrev_b32 v44, 4, v0
    v_cndmask_b32 v44, v56, v44, vcc
    v_and_b32 v51, 63, v0
    buffer_load_dwordx4 v[20:23], v44, s[8:11], s22 offen sc1
    v_mov_b32 v48, 1
    v_lshlrev_b32 v47, 2, v51
    v_bfe_u32 v2, v0, 5, 1
    v_bfe_u32 v3, v0, 3, 2
    v_and_b32 v35, 3, v0
    v_lshl_add_u32 v3, v3, 2, v35
    v_mul_u32_u24 v49, 20, v2
    v_lshrrev_b32 v18, 2, v51
    v_lshl_add_u32 v18, v35, 4, v18
    v_mov_b32 v50, 0x3fff
    s_lshl_b32 s37, s16, 2
    v_mov_b32 v59, s37
    s_sub_u32 s36, s16, 1
    s_waitcnt vmcnt(0)
    v_mov_b32_dpp v58, v23 quad_perm:[3,3,3,3] row_mask:0xf bank_mask:0xf
mn_again:
    v_mov_b32 v55, 0
    ds_write_b32 v47, v55 offset:0
    ds_write_b32 v47, v55 offset:128
    s_waitcnt vmcnt(0) lgkmcnt(0)
    s_barrier
    v_add_u32 v55, 0, v35
    v_add_u32 v55, s24, v55
    v_lshrrev_b32 v56, 16, v58
    v_mov_b32 v20, 0
    v_cmpx_lt_u32 vcc, v55, v56
    s_cbranch_execz mn_g2
    v_cmp_gt_u32 vcc, 15, v55
    v_and_b32 v56, 0xffff, v58
    v_add_lshl_u32 v56, v55, v56, 2
    v_add_u32 v56, v56, v46
    v_lshl_add_u32 v57, v0, 4, s22
    v_and_or_b32 v57, v55, 12, v57
    v_cndmask_b32 v56, v56, v57, vcc
    buffer_load_dword v20, v56, s[8:11], 0 offen sc1
    s_waitcnt vmcnt(0)
mn_g2:
    s_mov_b64 exec, -1
    v_mov_b32 v21, 0
    v_mov_b32 v22, 0
    v_mov_b32 v23, 0
    v_mov_b32 v24, 0
    s_cmp_le_u32 s20, 4
    s_cbranch_scc1 mn_more
    v_add_u32 v55, 4, v35
    v_add_u32 v55, s24, v55
    v_lshrrev_b32 v56, 16, v58
    v_mov_b32 v21, 0
    v_cmpx_lt_u32 vcc, v55, v56
    s_cbranch_execz mn_g3
    v_cmp_gt_u32 vcc, 15, v55
    v_and_b32 v56, 0xffff, v58
    v_add_lshl_u32 v56, v55, v56, 2
    v_add_u32 v56, v56, v46
    v_lshl_add_u32 v57, v0, 4, s22
    v_and_or_b32 v57, v55, 12, v57
    v_cndmask_b32 v56, v56, v57, vcc
    buffer_load_dword v21, v56, s[8:11], 0 offen sc1
    s_waitcnt vmcnt(0)
mn_g3:
    s_mov_b64 exec, -1
    v_add_u32 v55, 8, v35
    v_add_u32 v55, s24, v55
    v_lshrrev_b32 v56, 16, v58
    v_mov_b32 v22, 0
    v_cmpx_lt_u32 vcc, v55, v56
    s_cbranch_execz mn_g4
    v_cmp_gt_u32 vcc, 15, v55
    v_and_b32 v56, 0xffff, v58
    v_add_lshl_u32 v56, v55, v56, 2
    v_add_u32 v56, v56, v46
    v_lshl_add_u32 v57, v0, 4, s22
    v_and_or_b32 v57, v55, 12, v57
    v_cndmask_b32 v56, v56, v57, vcc
    buffer_load_dword v22, v56, s[8:11], 0 offen sc1
    s_waitcnt vmcnt(0)
mn_g4:
    s_mov_b64 exec, -1
    v_add_u32 v55, 12, v35
    v_add_u32 v55, s24, v55
    v_lshrrev_b32 v56, 16, v58
    v_mov_b32 v23, 0
    v_cmpx_lt_u32 vcc, v55, v56
    s_cbranch_execz mn_g5
    v_cmp_gt_u32 vcc, 15, v55
    v_and_b32 v56, 0xffff, v58
    v_add_lshl_u32 v56, v55, v56, 2
    v_add_u32 v56, v56, v46
    v_lshl_add_u32 v57, v0, 4, s22
    v_and_or_b32 v57, v55, 12, v57
    v_cndmask_b32 v56, v56, v57, vcc
    buffer_load_dword v23, v56, s[8:11], 0 offen sc1
    s_waitcnt vmcnt(0)
mn_g5:
    s_mov_b64 exec, -1
    v_add_u32 v55, 16, v35
    v_add_u32 v55, s24, v55
    v_lshrrev_b32 v56, 16, v58
    v_mov_b32 v24, 0
    v_cmpx_lt_u32 vcc, v55, v56
    s_cbranch_execz mn_g6
    v_cmp_gt_u32 vcc, 15, v55
    v_and_b32 v56, 0xffff, v58
    v_add_lshl_u32 v56, v55, v56, 2
    v_add_u32 v56, v56, v46
    v_lshl_add_u32 v57, v0, 4, s22
    v_and_or_b32 v57, v55, 12, v57
    v_cndmask_b32 v56, v56, v57, vcc
    buffer_load_dword v24, v56, s[8:11], 0 offen sc1
    s_waitcnt vmcnt(0)
mn_g6:
    s_mov_b64 exec, -1
    s_branch mn_more
mn_last:
    s_endpgm
.section .rodata,"a"
.p2align 6
.amdhsa_kernel standalone__tensor_product_equiv_mace__graph_kernel
  .amdhsa_next_free_vgpr 168
  .amdhsa_next_free_sgpr 96
  .amdhsa_accum_offset 168
  .amdhsa_group_segment_fixed_size 0
  .amdhsa_kernarg_size 88
  .amdhsa_user_sgpr_count 2
  .amdhsa_user_sgpr_kernarg_segment_ptr 1
  .amdhsa_system_sgpr_workgroup_id_x 1
.end_amdhsa_kernel
```

```asm
; @launch grid=(256,1,1) block=(768,1,1) lds=163840
.amdgcn_target "amdgcn-amd-amdhsa--gfx950"
.text
.globl standalone__tensor_product_equiv_mace__graph_kernel
.p2align 8
.type standalone__tensor_product_equiv_mace__graph_kernel,@function
standalone__tensor_product_equiv_mace__graph_kernel:
    s_load_dwordx8 s[4:11], s[0:1], 8
    s_load_dwordx4 s[12:15], s[0:1], 72
    v_lshrrev_b32 v9, 6, v0
    s_and_b32 s3, s2, 127
    v_readfirstlane_b32 s18, v9
    v_and_b32 v1, 63, v0
    s_cmp_lt_u32 s2, 125
    s_cbranch_scc1 ka_bin
    s_cmp_ge_u32 s2, 256
    s_cbranch_scc1 ka_end
    s_getpc_b64 s[36:37]
ka_pc0:
    v_lshlrev_b32 v41, 7, v0
    s_mul_i32 s34, s3, 40960
    v_add_u32 v44, s34, v41
    v_min_u32 v41, mn_last-ka_pc0, v41
    global_load_dword v41, v41, s[36:37]
    s_cmp_ge_u32 s3, 125
    s_cbranch_scc1 ka_idle
    s_cmp_ge_u32 s18, 5
    s_cbranch_scc1 ka_pf
    s_waitcnt lgkmcnt(0)
    global_load_dword v45, v44, s[10:11]
    s_branch ka_pf
ka_bin:
    s_cmp_ge_u32 s18, 10
    s_cbranch_scc1 ka_dma
    s_mul_i32 s3, s2, 5120
    v_lshl_add_u32 v5, v0, 2, s3
    s_waitcnt lgkmcnt(0)
    global_load_dword v10, v5, s[6:7]
    global_load_dword v60, v5, s[6:7] offset:2560
    global_load_dword v11, v5, s[4:5]
    global_load_dword v61, v5, s[4:5] offset:2560
    v_lshlrev_b32 v2, 2, v0
    v_and_b32 v2, 0x3fc, v2
    v_lshlrev_b32 v5, 4, v0
    v_mov_b32 v44, 0
    v_mov_b32 v45, 0
    v_mov_b32 v46, 0
    v_mov_b32 v47, 0
    ds_write_b32 v2, v44 offset:1024
    ds_write_b128 v5, v[44:47] offset:12288
    ds_write_b128 v5, v[44:47] offset:18432
    s_and_b32 s21, s15, 0xffff
    s_mov_b32 s22, 12582912
    s_mov_b32 s23, 0x20000
    s_mov_b32 s20, s14
    v_mov_b32 v3, 1
    v_lshlrev_b32 v26, 4, v1
    s_lshl_b32 s19, s18, 10
    v_add_u32 v27, s19, v26
    v_mov_b32 v4, 0x40000
    s_movk_i32 s29, 625
    s_movk_i32 s38, 0x3fff
    s_waitcnt lgkmcnt(0)
    s_barrier
    v_mov_b32 v19, 74752
    v_lshl_add_u32 v18, v0, 1, 0
    v_mul_u32_u24 v16, 13108, v18
    v_lshrrev_b32 v16, 16, v16
    v_mad_i32_i24 v18, v16, -5, v18
    v_lshlrev_b32 v16, 2, v16
    v_cmp_eq_u32 vcc, 4, v18
    v_lshlrev_b32 v18, 3, v18
    v_add_u32 v18, 33792, v18
    v_cndmask_b32 v17, 5, 3, vcc
    v_cndmask_b32 v18, v18, v19, vcc
    v_lshl_add_u32 v14, v0, 1, 1
    v_mul_u32_u24 v12, 13108, v14
    v_lshrrev_b32 v12, 16, v12
    v_mad_i32_i24 v14, v12, -5, v14
    v_lshlrev_b32 v12, 2, v12
    v_cmp_eq_u32 vcc, 4, v14
    v_lshlrev_b32 v14, 3, v14
    v_add_u32 v14, 33792, v14
    v_cndmask_b32 v13, 5, 3, vcc
    v_cndmask_b32 v14, v14, v19, vcc
    s_mul_i32 s31, s2, 51200
    s_waitcnt vmcnt(3)
    v_mul_u32_u24 v32, 214749, v10
    v_lshrrev_b32 v32, 23, v32
    v_min_u32 v32, 255, v32
    v_and_b32 v35, 7, v32
    v_lshrrev_b32 v33, 3, v32
    v_lshl_add_u32 v35, v35, 5, v33
    v_lshlrev_b32 v35, 2, v35
    ds_add_rtn_u32 v36, v35, v3 offset:1024
    s_waitcnt vmcnt(2)
    v_mul_u32_u24 v62, 214749, v60
    v_lshrrev_b32 v62, 23, v62
    v_min_u32 v62, 255, v62
    v_and_b32 v66, 7, v62
    v_lshrrev_b32 v63, 3, v62
    v_lshl_add_u32 v66, v66, 5, v63
    v_lshlrev_b32 v66, 2, v66
    ds_add_rtn_u32 v67, v66, v3 offset:1024
    v_mad_u32_u24 v33, v32, s29, 15
    v_lshrrev_b32 v33, 4, v33
    v_sub_u32 v33, v10, v33
    v_subrev_u32 v32, 20, v33
    v_min_u32 v32, v32, v33
    v_min_u32 v32, 19, v32
    v_lshlrev_b32 v40, 4, v35
    v_add_u32 v35, s19, v35
    v_mad_u32_u24 v63, v62, s29, 15
    v_lshrrev_b32 v63, 4, v63
    v_sub_u32 v63, v60, v63
    v_subrev_u32 v62, 20, v63
    v_min_u32 v62, v62, v63
    v_min_u32 v62, 19, v62
    v_lshlrev_b32 v70, 4, v66
    v_add_u32 v66, s19, v66
    s_waitcnt vmcnt(0) lgkmcnt(0)
    v_mul_u32_u24 v39, 3330, v11
    v_lshrrev_b32 v39, 20, v39
    v_lshrrev_b32 v34, 2, v32
    v_cmp_gt_u32 vcc, 27, v39
    v_add_u32 v34, 27, v34
    v_lshlrev_b32 v23, 14, v32
    v_cndmask_b32 v39, v34, v39, vcc
    v_cmp_le_u32 vcc, 20, v33
    v_and_or_b32 v22, v11, s38, v23
    v_or_b32 v39, 64, v39
    v_add_u32 v34, 32, v39
    v_cndmask_b32 v39, v39, v34, vcc
    v_lshl_or_b32 v22, v39, 25, v22
    v_cmp_lt_u32 vcc, 14, v36
    v_and_b32 v34, 3, v36
    v_lshl_add_u32 v40, v34, 4, v40
    v_and_or_b32 v40, v36, 12, v40
    v_cndmask_b32 v40, v40, v4, vcc
    ds_write_b32 v40, v22 offset:12288
    v_mul_u32_u24 v68, 3330, v61
    v_lshrrev_b32 v68, 20, v68
    v_lshrrev_b32 v71, 2, v62
    v_cmp_gt_u32 vcc, 27, v68
    v_add_u32 v71, 27, v71
    v_lshlrev_b32 v75, 14, v62
    v_cndmask_b32 v68, v71, v68, vcc
    v_cmp_le_u32 vcc, 20, v63
    v_and_or_b32 v74, v61, s38, v75
    v_or_b32 v68, 64, v68
    v_add_u32 v71, 32, v68
    v_cndmask_b32 v68, v68, v71, vcc
    v_lshl_or_b32 v74, v68, 25, v74
    v_cmp_lt_u32 vcc, 14, v67
    v_and_b32 v71, 3, v67
    v_lshl_add_u32 v70, v71, 4, v70
    v_and_or_b32 v70, v67, 12, v70
    v_cndmask_b32 v70, v70, v4, vcc
    ds_write_b32 v70, v74 offset:12288
    s_waitcnt lgkmcnt(0)
    s_barrier
    ds_read_b128 v[44:47], v26 offset:1024
    v_add_u32 v9, 640, v0
    v_max_u32 v8, v36, v67
    v_cmp_lt_u32 vcc, 14, v8
    s_waitcnt lgkmcnt(0)
    v_add_u32 v53, v44, v45
    v_add_u32 v54, v53, v46
    v_add_u32 v38, v54, v47
    v_mov_b32 v55, v38
    s_nop 0
    v_add_u32_dpp v38, v38, v38 row_shr:1 row_mask:0xf bank_mask:0xf
    s_nop 0
    s_nop 0
    v_add_u32_dpp v38, v38, v38 row_shr:2 row_mask:0xf bank_mask:0xf
    s_nop 0
    s_nop 0
    v_add_u32_dpp v38, v38, v38 row_shr:4 row_mask:0xf bank_mask:0xf
    s_nop 0
    s_nop 0
    v_add_u32_dpp v38, v38, v38 row_shr:8 row_mask:0xf bank_mask:0xf
    s_nop 0
    s_nop 0
    v_add_u32_dpp v38, v38, v38 row_bcast:15 row_mask:0xa bank_mask:0xf
    s_nop 0
    s_nop 0
    v_add_u32_dpp v38, v38, v38 row_bcast:31 row_mask:0xc bank_mask:0xf
    v_sub_u32 v56, v38, v55
    v_add_u32 v57, v56, v44
    v_add_u32 v58, v56, v53
    v_add_u32 v59, v56, v54
    ds_write_b128 v27, v[56:59] offset:2048
    ds_read_b32 v43, v35 offset:2048
    ds_read_b32 v69, v66 offset:2048
    s_waitcnt lgkmcnt(0)
    v_add_lshl_u32 v43, v43, v36, 2
    v_add_lshl_u32 v69, v69, v67, 2
    ds_write_b32 v43, v0 offset:28672
    ds_write_b32 v69, v9 offset:28672
    s_cbranch_vccnz ka_ov
ka_ov_back:
    s_waitcnt lgkmcnt(0)
ka_copy:
    s_barrier
    ds_read_b32 v20, v16 offset:28672
    ds_read_b32 v21, v12 offset:28672
    ds_read_b32 v22, v16 offset:29696
    ds_read_b32 v23, v12 offset:29696
    ds_read_b32 v24, v16 offset:30720
    ds_read_b32 v25, v12 offset:30720
    ds_read_b32 v26, v16 offset:31744
    ds_read_b32 v27, v12 offset:31744
    ds_read_b32 v28, v16 offset:32768
    ds_read_b32 v29, v12 offset:32768
    s_waitcnt lgkmcnt(8)
    v_lshl_add_u32 v20, v20, v17, v18
    v_lshl_add_u32 v21, v21, v13, v14
    ds_read_b64 v[44:45], v20
    ds_read_b64 v[46:47], v21
    s_waitcnt lgkmcnt(8)
    v_lshl_add_u32 v22, v22, v17, v18
    v_lshl_add_u32 v23, v23, v13, v14
    ds_read_b64 v[48:49], v22
    ds_read_b64 v[50:51], v23
    s_waitcnt lgkmcnt(8)
    v_lshl_add_u32 v24, v24, v17, v18
    v_lshl_add_u32 v25, v25, v13, v14
    ds_read_b64 v[52:53], v24
    ds_read_b64 v[54:55], v25
    s_waitcnt lgkmcnt(8)
    v_lshl_add_u32 v26, v26, v17, v18
    v_lshl_add_u32 v27, v27, v13, v14
    ds_read_b64 v[56:57], v26
    ds_read_b64 v[58:59], v27
    s_waitcnt lgkmcnt(8)
    v_lshl_add_u32 v28, v28, v17, v18
    v_lshl_add_u32 v29, v29, v13, v14
    ds_read_b64 v[60:61], v28
    ds_read_b64 v[62:63], v29
    s_waitcnt lgkmcnt(8)
    buffer_store_dwordx4 v[44:47], v5, s[20:23], s31 offen sc1
    s_addk_i32 s31, 10240
    s_waitcnt lgkmcnt(6)
    buffer_store_dwordx4 v[48:51], v5, s[20:23], s31 offen sc1
    s_addk_i32 s31, 10240
    s_waitcnt lgkmcnt(4)
    buffer_store_dwordx4 v[52:55], v5, s[20:23], s31 offen sc1
    s_addk_i32 s31, 10240
    s_waitcnt lgkmcnt(2)
    buffer_store_dwordx4 v[56:59], v5, s[20:23], s31 offen sc1
    s_addk_i32 s31, 10240
    s_waitcnt lgkmcnt(0)
    buffer_store_dwordx4 v[60:63], v5, s[20:23], s31 offen sc1
    s_branch mn_start2
ka_ov:
    s_mul_i32 s33, s2, 5120
    s_add_u32 s33, s33, 7340032
    buffer_store_dword v22, v43, s[20:23], s33 offen sc1
    buffer_store_dword v74, v69, s[20:23], s33 offen sc1
    s_branch ka_ov_back
ka_dma:
    s_cmp_eq_u32 s18, 11
    s_cbranch_scc1 ka_cell
    s_mul_i32 s35, s2, 40960
    v_lshl_add_u32 v7, v1, 4, s35
    s_mul_i32 s35, s2, 10240
    v_lshl_add_u32 v8, v1, 4, s35
    s_mov_b32 m0, 74752
    s_waitcnt lgkmcnt(0)
    s_load_dwordx4 s[36:39], s[0:1], 40
    s_barrier
    global_load_lds_dwordx4 v8, s[8:9] offset:0
    global_load_lds_dwordx4 v8, s[8:9] offset:1024
    s_add_u32 m0, m0, 2048
    v_add_u32 v8, 2048, v8
    global_load_lds_dwordx4 v8, s[8:9] offset:0
    global_load_lds_dwordx4 v8, s[8:9] offset:1024
    s_add_u32 m0, m0, 2048
    v_add_u32 v8, 2048, v8
    global_load_lds_dwordx4 v8, s[8:9] offset:0
    global_load_lds_dwordx4 v8, s[8:9] offset:1024
    s_add_u32 m0, m0, 2048
    v_add_u32 v8, 2048, v8
    global_load_lds_dwordx4 v8, s[8:9] offset:0
    global_load_lds_dwordx4 v8, s[8:9] offset:1024
    s_add_u32 m0, m0, 2048
    v_add_u32 v8, 2048, v8
    global_load_lds_dwordx4 v8, s[8:9] offset:0
    global_load_lds_dwordx4 v8, s[8:9] offset:1024
    s_add_u32 m0, m0, 2048
    v_add_u32 v8, 2048, v8
    s_mov_b32 m0, 33792
    s_nop 0
    global_load_lds_dwordx4 v7, s[10:11] offset:0
    global_load_lds_dwordx4 v7, s[10:11] offset:1024
    s_add_u32 m0, m0, 2048
    v_add_u32 v7, 2048, v7
    global_load_lds_dwordx4 v7, s[10:11] offset:0
    global_load_lds_dwordx4 v7, s[10:11] offset:1024
    s_add_u32 m0, m0, 2048
    v_add_u32 v7, 2048, v7
    global_load_lds_dwordx4 v7, s[10:11] offset:0
    global_load_lds_dwordx4 v7, s[10:11] offset:1024
    s_add_u32 m0, m0, 2048
    v_add_u32 v7, 2048, v7
    s_barrier
    global_load_lds_dwordx4 v7, s[10:11] offset:0
    global_load_lds_dwordx4 v7, s[10:11] offset:1024
    s_add_u32 m0, m0, 2048
    v_add_u32 v7, 2048, v7
    global_load_lds_dwordx4 v7, s[10:11] offset:0
    global_load_lds_dwordx4 v7, s[10:11] offset:1024
    s_add_u32 m0, m0, 2048
    v_add_u32 v7, 2048, v7
    global_load_lds_dwordx4 v7, s[10:11] offset:0
    global_load_lds_dwordx4 v7, s[10:11] offset:1024
    s_add_u32 m0, m0, 2048
    v_add_u32 v7, 2048, v7
    global_load_lds_dwordx4 v7, s[10:11] offset:0
    global_load_lds_dwordx4 v7, s[10:11] offset:1024
    s_add_u32 m0, m0, 2048
    v_add_u32 v7, 2048, v7
    global_load_lds_dwordx4 v7, s[10:11] offset:0
    global_load_lds_dwordx4 v7, s[10:11] offset:1024
    s_add_u32 m0, m0, 2048
    v_add_u32 v7, 2048, v7
    global_load_lds_dwordx4 v7, s[10:11] offset:0
    global_load_lds_dwordx4 v7, s[10:11] offset:1024
    s_add_u32 m0, m0, 2048
    v_add_u32 v7, 2048, v7
    global_load_lds_dwordx4 v7, s[10:11] offset:0
    global_load_lds_dwordx4 v7, s[10:11] offset:1024
    s_add_u32 m0, m0, 2048
    v_add_u32 v7, 2048, v7
    global_load_lds_dwordx4 v7, s[10:11] offset:0
    global_load_lds_dwordx4 v7, s[10:11] offset:1024
    s_add_u32 m0, m0, 2048
    v_add_u32 v7, 2048, v7
    global_load_lds_dwordx4 v7, s[10:11] offset:0
    global_load_lds_dwordx4 v7, s[10:11] offset:1024
    s_add_u32 m0, m0, 2048
    v_add_u32 v7, 2048, v7
    global_load_lds_dwordx4 v7, s[10:11] offset:0
    global_load_lds_dwordx4 v7, s[10:11] offset:1024
    s_add_u32 m0, m0, 2048
    v_add_u32 v7, 2048, v7
    global_load_lds_dwordx4 v7, s[10:11] offset:0
    global_load_lds_dwordx4 v7, s[10:11] offset:1024
    s_add_u32 m0, m0, 2048
    v_add_u32 v7, 2048, v7
    global_load_lds_dwordx4 v7, s[10:11] offset:0
    global_load_lds_dwordx4 v7, s[10:11] offset:1024
    s_add_u32 m0, m0, 2048
    v_add_u32 v7, 2048, v7
    global_load_lds_dwordx4 v7, s[10:11] offset:0
    global_load_lds_dwordx4 v7, s[10:11] offset:1024
    s_add_u32 m0, m0, 2048
    v_add_u32 v7, 2048, v7
    global_load_lds_dwordx4 v7, s[10:11] offset:0
    global_load_lds_dwordx4 v7, s[10:11] offset:1024
    s_add_u32 m0, m0, 2048
    v_add_u32 v7, 2048, v7
    global_load_lds_dwordx4 v7, s[10:11] offset:0
    global_load_lds_dwordx4 v7, s[10:11] offset:1024
    s_add_u32 m0, m0, 2048
    v_add_u32 v7, 2048, v7
    global_load_lds_dwordx4 v7, s[10:11] offset:0
    global_load_lds_dwordx4 v7, s[10:11] offset:1024
    s_add_u32 m0, m0, 2048
    v_add_u32 v7, 2048, v7
    global_load_lds_dwordx4 v7, s[10:11] offset:0
    global_load_lds_dwordx4 v7, s[10:11] offset:1024
    s_add_u32 m0, m0, 2048
    v_add_u32 v7, 2048, v7
    s_mov_b32 s35, m0
    s_mov_b32 m0, 148480
    v_lshlrev_b32 v9, 4, v1
    v_add_u32 v10, 4096, v9
    s_waitcnt lgkmcnt(0)
    global_load_lds_dwordx4 v9, s[38:39]
    global_load_lds_dwordx4 v9, s[38:39] offset:1024
    global_load_lds_dwordx4 v9, s[38:39] offset:2048
    global_load_lds_dwordx4 v9, s[38:39] offset:3072
    s_mov_b32 m0, 152576
    s_nop 0
    global_load_lds_dwordx4 v10, s[38:39]
    global_load_lds_dwordx4 v10, s[38:39] offset:1024
    global_load_lds_dwordx4 v10, s[38:39] offset:2048
    global_load_lds_dwordx4 v10, s[38:39] offset:3072
    s_mov_b32 m0, 156672
    s_mov_b64 exec, 0xff
    global_load_lds_dwordx4 v9, s[36:37]
    s_mov_b64 exec, -1
    s_mov_b32 m0, s35
    s_waitcnt vmcnt(0)
    s_barrier
    s_branch mn_start
ka_cell:
    s_and_b32 s28, s2, 7
    s_lshl_b32 s28, s28, 4
    s_lshr_b32 s29, s2, 3
    s_add_u32 s28, s28, s29
    s_waitcnt lgkmcnt(0)
    s_and_b32 s21, s15, 0xffff
    s_mov_b32 s22, 12582912
    s_mov_b32 s23, 0x20000
    s_mov_b32 s20, s14
    s_lshl_b32 s30, s28, 6
    s_add_u32 s30, s30, 8388608
    v_lshlrev_b32 v3, 3, v1
    v_mov_b32 v4, 0
    v_mov_b32 v5, 0
    ds_write_b64 v3, v[4:5]
    v_lshlrev_b32 v26, 4, v1
    v_lshrrev_b32 v6, 2, v1
    v_lshlrev_b32 v6, 13, v6
    v_and_or_b32 v6, v26, 0x30, v6
    v_lshlrev_b32 v27, 8, v1
    s_waitcnt lgkmcnt(0)
    s_barrier
    s_and_b32 s58, s2, 15
    s_lshl_b32 s58, s58, 7
    s_add_u32 s58, s58, 11730944
    v_mov_b32 v86, s58
    global_load_dword v87, v86, s[14:15] sc1
    s_barrier
    ds_read_b128 v[12:15], v26 offset:1024
    s_waitcnt lgkmcnt(0)
    v_add_u32 v17, v12, v13
    v_add_u32 v18, v17, v14
    v_add_u32 v16, v18, v15
    v_mov_b32 v19, v16
    v_lshlrev_b32 v20, 16, v12
    v_add_u32_dpp v16, v16, v16 row_shr:1 row_mask:0xf bank_mask:0xf
    v_lshl_add_u32 v21, v13, 16, v12
    s_nop 0
    v_add_u32_dpp v16, v16, v16 row_shr:2 row_mask:0xf bank_mask:0xf
    v_lshl_add_u32 v22, v14, 16, v17
    s_nop 0
    v_add_u32_dpp v16, v16, v16 row_shr:4 row_mask:0xf bank_mask:0xf
    v_lshl_add_u32 v23, v15, 16, v18
    s_nop 0
    v_add_u32_dpp v16, v16, v16 row_shr:8 row_mask:0xf bank_mask:0xf
    s_nop 1
    v_add_u32_dpp v16, v16, v16 row_bcast:15 row_mask:0xa bank_mask:0xf
    s_nop 1
    v_add_u32_dpp v16, v16, v16 row_bcast:31 row_mask:0xc bank_mask:0xf
    v_sub_u32 v16, v16, v19
    v_mov_b32 v86, 0
    s_waitcnt vmcnt(0)
    ds_write_b32 v86, v87 offset:456
    v_add_u32 v20, v20, v16
    ds_write_b32 v27, v20 offset:12348
    v_add_u32 v21, v21, v16
    ds_write_b32 v27, v21 offset:12412
    v_add_u32 v22, v22, v16
    ds_write_b32 v27, v22 offset:12476
    v_add_u32 v23, v23, v16
    ds_write_b32 v27, v23 offset:12540
    ds_read_b128 v[28:31], v26 offset:12288
    ds_read_b128 v[32:35], v26 offset:13312
    ds_read_b128 v[36:39], v26 offset:14336
    ds_read_b128 v[40:43], v26 offset:15360
    ds_read_b128 v[44:47], v26 offset:16384
    ds_read_b128 v[48:51], v26 offset:17408
    ds_read_b128 v[52:55], v26 offset:18432
    ds_read_b128 v[56:59], v26 offset:19456
    s_waitcnt lgkmcnt(7)
    buffer_store_dwordx4 v[28:31], v6, s[20:23], s30 offen sc1
    ds_read_b128 v[60:63], v26 offset:20480
    s_add_u32 s30, s30, 131072
    s_waitcnt lgkmcnt(7)
    buffer_store_dwordx4 v[32:35], v6, s[20:23], s30 offen sc1
    ds_read_b128 v[64:67], v26 offset:21504
    s_add_u32 s30, s30, 131072
    s_waitcnt lgkmcnt(7)
    buffer_store_dwordx4 v[36:39], v6, s[20:23], s30 offen sc1
    ds_read_b128 v[68:71], v26 offset:22528
    s_add_u32 s30, s30, 131072
    s_waitcnt lgkmcnt(7)
    buffer_store_dwordx4 v[40:43], v6, s[20:23], s30 offen sc1
    ds_read_b128 v[72:75], v26 offset:23552
    s_add_u32 s30, s30, 131072
    s_waitcnt lgkmcnt(7)
    buffer_store_dwordx4 v[44:47], v6, s[20:23], s30 offen sc1
    ds_read_b128 v[76:79], v26 offset:24576
    s_add_u32 s30, s30, 131072
    s_waitcnt lgkmcnt(7)
    buffer_store_dwordx4 v[48:51], v6, s[20:23], s30 offen sc1
    ds_read_b128 v[80:83], v26 offset:25600
    s_add_u32 s30, s30, 131072
    s_waitcnt lgkmcnt(7)
    buffer_store_dwordx4 v[52:55], v6, s[20:23], s30 offen sc1
    ds_read_b128 v[28:31], v26 offset:26624
    s_add_u32 s30, s30, 131072
    s_waitcnt lgkmcnt(7)
    buffer_store_dwordx4 v[56:59], v6, s[20:23], s30 offen sc1
    ds_read_b128 v[32:35], v26 offset:27648
    s_add_u32 s30, s30, 131072
    s_waitcnt lgkmcnt(7)
    buffer_store_dwordx4 v[60:63], v6, s[20:23], s30 offen sc1
    s_add_u32 s30, s30, 131072
    s_waitcnt lgkmcnt(6)
    buffer_store_dwordx4 v[64:67], v6, s[20:23], s30 offen sc1
    s_add_u32 s30, s30, 131072
    s_waitcnt lgkmcnt(5)
    buffer_store_dwordx4 v[68:71], v6, s[20:23], s30 offen sc1
    s_add_u32 s30, s30, 131072
    s_waitcnt lgkmcnt(4)
    buffer_store_dwordx4 v[72:75], v6, s[20:23], s30 offen sc1
    s_add_u32 s30, s30, 131072
    s_waitcnt lgkmcnt(3)
    buffer_store_dwordx4 v[76:79], v6, s[20:23], s30 offen sc1
    s_add_u32 s30, s30, 131072
    s_waitcnt lgkmcnt(2)
    buffer_store_dwordx4 v[80:83], v6, s[20:23], s30 offen sc1
    s_add_u32 s30, s30, 131072
    s_waitcnt lgkmcnt(1)
    buffer_store_dwordx4 v[28:31], v6, s[20:23], s30 offen sc1
    s_add_u32 s30, s30, 131072
    s_waitcnt lgkmcnt(0)
    buffer_store_dwordx4 v[32:35], v6, s[20:23], s30 offen sc1
    s_barrier
    s_waitcnt vmcnt(0)
    s_mov_b64 exec, 1
    v_mov_b32 v2, 0
    v_mov_b32 v3, 1
    s_and_b32 s34, s2, 1
    s_lshl_b32 s35, s34, 7
    s_add_u32 s35, s35, 0
    s_mov_b32 s33, 1
    s_atomic_add s33, s[12:13], s35 glc
    s_mov_b32 s36, 1
    s_lshl_b32 s34, s34, 3
    s_lshr_b32 s34, 15678, s34
    s_and_b32 s34, s34, 0xff
    s_waitcnt lgkmcnt(0)
    s_cmp_eq_u32 s33, s34
    s_cbranch_scc1 ka_bcast
ka_arc:
    s_mov_b64 exec, -1
    s_branch mn_start
ka_pf:
    s_load_dwordx2 s[16:17], s[0:1], 0
    s_load_dwordx2 s[32:33], s[0:1], 56
    s_waitcnt lgkmcnt(0)
    s_and_b32 s34, s2, 7
    s_mul_i32 s34, s34, 917504
    s_add_u32 s24, s16, s34
    s_addc_u32 s25, s17, 0
    s_and_b32 s25, s25, 0xffff
    s_mov_b32 s26, 917504
    s_mov_b32 s27, 0x20000
    s_bfe_u32 s30, s2, 0x40003
    v_lshlrev_b32 v40, 7, v0
    s_mul_i32 s30, s30, 57344
    s_cmp_lg_u32 s18, 9
    s_cbranch_scc1 ka_nowt
    s_bfe_u32 s35, s2, 0x40003
    s_lshl_b32 s35, s35, 13
    v_lshl_add_u32 v46, v1, 7, s35
    global_load_dword v46, v46, s[32:33]
ka_nowt:
ka_pf1:
    s_cmp_ge_u32 s18, 7
    s_cbranch_scc1 ka_pfe
    s_waitcnt vmcnt(0)
    buffer_load_dword v42, v40, s[24:27], s30 offen
    s_cmp_ge_u32 s18, 0
    s_cbranch_scc1 ka_pfe
    s_add_u32 s30, s30, 81920
    buffer_load_dword v43, v40, s[24:27], s30 offen
    s_branch ka_pfe
ka_idle:
    s_waitcnt lgkmcnt(0)
ka_pfe:
    s_cmp_lt_u32 s18, 10
    s_cbranch_scc1 ka_pfb
    s_cmp_eq_u32 s18, 11
    s_cbranch_scc1 ka_pfz
    s_load_dwordx4 s[36:39], s[0:1], 40
    s_mov_b32 m0, 148480
    v_lshlrev_b32 v9, 4, v1
    v_add_u32 v10, 4096, v9
    s_waitcnt lgkmcnt(0)
    global_load_lds_dwordx4 v9, s[38:39]
    global_load_lds_dwordx4 v9, s[38:39] offset:1024
    global_load_lds_dwordx4 v9, s[38:39] offset:2048
    global_load_lds_dwordx4 v9, s[38:39] offset:3072
    s_mov_b32 m0, 152576
    s_nop 0
    global_load_lds_dwordx4 v10, s[38:39]
    global_load_lds_dwordx4 v10, s[38:39] offset:1024
    global_load_lds_dwordx4 v10, s[38:39] offset:2048
    global_load_lds_dwordx4 v10, s[38:39] offset:3072
    s_mov_b32 m0, 156672
    s_mov_b64 exec, 0xff
    global_load_lds_dwordx4 v9, s[36:37]
    s_mov_b64 exec, -1
    s_waitcnt vmcnt(0)
    s_branch ka_pfb
ka_pfz:
    s_and_b32 s58, s2, 15
    s_lshl_b32 s58, s58, 7
    s_add_u32 s58, s58, 11730944
    v_mov_b32 v86, s58
    global_load_dword v87, v86, s[14:15] sc1
    v_lshlrev_b32 v3, 3, v1
    v_mov_b32 v4, 0
    v_mov_b32 v5, 0
    ds_write_b64 v3, v[4:5]
    v_mov_b32 v86, 0
    s_waitcnt vmcnt(0)
    ds_write_b32 v86, v87 offset:456
    s_waitcnt lgkmcnt(0)
ka_pfb:
    s_barrier
    s_branch mn_start
ka_bcast:
    s_mov_b64 exec, -1
    s_add_u32 s34, s14, 11730944
    s_addc_u32 s35, s15, 0
    s_atomic_add s36, s[34:35], 0
    s_atomic_add s36, s[34:35], 128
    s_atomic_add s36, s[34:35], 256
    s_atomic_add s36, s[34:35], 384
    s_atomic_add s36, s[34:35], 512
    s_atomic_add s36, s[34:35], 640
    s_atomic_add s36, s[34:35], 768
    s_atomic_add s36, s[34:35], 896
    s_atomic_add s36, s[34:35], 1024
    s_atomic_add s36, s[34:35], 1152
    s_atomic_add s36, s[34:35], 1280
    s_atomic_add s36, s[34:35], 1408
    s_atomic_add s36, s[34:35], 1536
    s_atomic_add s36, s[34:35], 1664
    s_atomic_add s36, s[34:35], 1792
    s_atomic_add s36, s[34:35], 1920
    s_branch mn_start
ka_end:
    s_endpgm
mn_start:
    s_waitcnt vmcnt(0) lgkmcnt(0)
mn_start2:
    s_cmp_ge_u32 s2, 256
    s_cbranch_scc1 mn_end
    s_load_dwordx2 s[54:55], s[0:1], 80
    s_load_dwordx2 s[50:51], s[0:1], 0
    s_load_dwordx2 s[60:61], s[0:1], 72
    v_lshrrev_b32 v56, 6, v0
    s_and_b32 s48, s2, 7
    v_readfirstlane_b32 s16, v56
    s_lshr_b32 s47, s2, 3
    s_lshl_b32 s22, s48, 5
    s_add_u32 s22, s22, s47
    s_lshl_b32 s22, s22, 13
    s_add_u32 s22, s22, 8388608
    s_mov_b32 s10, 12582912
    s_mov_b32 s11, 0x20000
    s_and_b32 s17, s16, 3
    s_movk_i32 s20, 20
    s_mov_b32 s24, 0
    s_cmp_ge_u32 s16, 8
    s_cbranch_scc1 gm_main
    v_lshrrev_b32 v56, 6, v0
    v_lshlrev_b32 v55, 1, v0
    v_and_b32 v55, 0x78, v55
    v_or_b32 v55, v55, v56
    v_cmp_gt_u32 vcc, 125, v55
    v_mul_u32_u24 v46, 5120, v55
    v_add_u32 v46, 7340032, v46
    v_bfrev_b32 v56, 2
    v_lshlrev_b32 v44, 4, v0
    v_cndmask_b32 v44, v56, v44, vcc
    v_and_b32 v51, 63, v0
    s_waitcnt lgkmcnt(0)
    s_mov_b32 s8, s54
    s_and_b32 s9, s55, 0xffff
    v_mov_b32 v24, 0
    s_lshr_b32 s18, s16, 2
    s_lshl_b32 s53, s17, 7
    s_add_u32 s4, s50, s53
    s_addc_u32 s5, s51, 0
    s_and_b32 s5, s5, 0xffff
    s_or_b32 s5, s5, 0x08000000
    s_movk_i32 s6, 10000
    s_mov_b32 s7, 0x20000
    s_mul_i32 s40, s16, 15360
    s_add_u32 s40, s40, 40960
    v_lshl_add_u32 v87, v51, 3, s40
    s_add_u32 s40, s40, 9216
    s_add_u32 s41, s40, 1024
    s_add_u32 s42, s40, 2048
    s_add_u32 s43, s40, 3072
    s_add_u32 s44, s40, 4096
    s_add_u32 s45, s40, 5120
    v_and_b32 v55, 3, v0
    v_bfe_u32 v56, v0, 2, 2
    v_bfe_u32 v57, v0, 4, 1
    v_bfe_u32 v53, v0, 5, 1
    v_lshlrev_b32 v1, 3, v55
    v_lshl_add_u32 v1, v57, 5, v1
    v_lshl_add_u32 v1, v56, 6, v1
    v_lshl_add_u32 v1, v53, 8, v1
    v_add_u32 v1, s40, v1
    v_lshlrev_b32 v5, 4, v55
    v_lshl_add_u32 v5, v57, 6, v5
    v_lshl_add_u32 v5, v56, 9, v5
    v_mov_b32 v7, v5
    v_bfe_u32 v55, v0, 2, 1
    v_lshlrev_b32 v86, 4, v53
    v_lshl_or_b32 v86, v55, 18, v86
    v_mov_b32 v48, 1
    v_lshlrev_b32 v47, 2, v51
    v_bfe_u32 v2, v0, 5, 1
    v_bfe_u32 v3, v0, 3, 2
    v_and_b32 v35, 3, v0
    v_lshl_add_u32 v3, v3, 2, v35
    v_mul_u32_u24 v49, 20, v2
    v_lshrrev_b32 v18, 2, v51
    v_lshl_add_u32 v18, v35, 4, v18
    v_mov_b32 v50, 0x3fff
    s_lshl_b32 s37, s16, 2
    v_mov_b32 v59, s37
    s_sub_u32 s36, s16, 1
    v_mov_b64 v[88:89], 0
    v_mov_b64 v[90:91], 0
    v_mov_b64 v[92:93], 0
    v_mov_b64 v[94:95], 0
    v_mov_b64 v[96:97], 0
    v_mov_b64 v[98:99], 0
    v_mov_b64 v[100:101], 0
    v_mov_b64 v[102:103], 0
    v_mov_b64 v[104:105], 0
    v_mov_b64 v[106:107], 0
    v_mov_b64 v[108:109], 0
    v_mov_b64 v[110:111], 0
    v_mov_b64 v[112:113], 0
    v_mov_b64 v[114:115], 0
    v_mov_b64 v[116:117], 0
    v_mov_b64 v[118:119], 0
    v_mov_b64 v[120:121], 0
    v_mov_b64 v[122:123], 0
    v_mov_b64 v[124:125], 0
    v_mov_b64 v[126:127], 0
    v_mov_b64 v[128:129], 0
    v_mov_b64 v[130:131], 0
    v_mov_b64 v[132:133], 0
    v_mov_b64 v[134:135], 0
    v_mov_b64 v[136:137], 0
    v_mov_b64 v[138:139], 0
    v_mov_b64 v[140:141], 0
    v_mov_b64 v[142:143], 0
    v_mov_b64 v[144:145], 0
    v_mov_b64 v[146:147], 0
    v_mov_b64 v[148:149], 0
    v_mov_b64 v[150:151], 0
    v_mov_b64 v[152:153], 0
    v_mov_b64 v[154:155], 0
    v_mov_b64 v[156:157], 0
    v_mov_b64 v[158:159], 0
    v_mov_b64 v[160:161], 0
    v_mov_b64 v[162:163], 0
    v_mov_b64 v[164:165], 0
    v_mov_b64 v[166:167], 0
    v_bfe_u32 v8, v0, 2, 2
    v_bfe_u32 v10, v0, 5, 1
    v_lshlrev_b32 v9, 3, v8
    v_add_u32 v9, 156672, v9
    v_lshl_add_u32 v8, v10, 3, v8
    v_lshlrev_b32 v8, 9, v8
    v_bfe_u32 v10, v0, 4, 1
    v_lshl_add_u32 v8, v10, 5, v8
    v_lshl_add_u32 v8, v35, 3, v8
    v_lshl_add_u32 v8, s17, 7, v8
    v_add_u32 v8, 148480, v8
    ds_read_b64_tr_b16 v[76:77], v9
    ds_read_b64_tr_b16 v[78:79], v9 offset:32
    ds_read_b64_tr_b16 v[80:81], v9 offset:64
    ds_read_b64_tr_b16 v[82:83], v9 offset:96
    ds_read_b64_tr_b16 v[68:69], v8
    ds_read_b64_tr_b16 v[70:71], v8 offset:2048
    ds_read_b64_tr_b16 v[72:73], v8 offset:64
    ds_read_b64_tr_b16 v[74:75], v8 offset:2112
    s_cmp_ge_u32 s2, 125
    s_waitcnt vmcnt(0)
    s_cbranch_scc1 mn_noarr
    v_mov_b32 v55, 0
    v_mov_b32 v56, 1
    s_mov_b64 exec, 1
    ds_add_u32 v55, v56 offset:448
    s_mov_b64 exec, -1
mn_noarr:
    s_cmp_lg_u32 s16, 7
    s_cbranch_scc1 mn_sp1
    v_mov_b32 v57, 0
    ds_read_b32 v57, v57 offset:456
    s_waitcnt lgkmcnt(0)
    v_readfirstlane_b32 s59, v57
    s_and_b32 s62, s2, 15
    s_lshl_b32 s62, s62, 7
    s_add_u32 s62, s62, 11730944
    v_mov_b32 v55, s62
    v_lshlrev_b32 v56, 6, v0
    v_and_b32 v56, 0xc0, v56
    s_mov_b32 s63, 0x100000
mn_poll1m:
    s_sub_u32 s63, s63, 1
    s_cbranch_scc1 mn_poll1x
    global_load_dword v57, v55, s[54:55] sc1
    s_waitcnt vmcnt(0)
    v_readfirstlane_b32 s62, v57
    s_sub_u32 s62, s62, s59
    s_bfe_u32 s62, s62, 1048576
    s_cmp_eq_u32 s62, 2
    s_cbranch_scc1 mn_poll1x
    s_sleep 6
    s_and_b32 s62, s63, 63
    s_cbranch_scc1 mn_poll1m
    global_load_dword v57, v56, s[60:61] sc1
    s_waitcnt vmcnt(0)
    v_add_u32_dpp v57, v57, v57 quad_perm:[2,3,0,1] row_mask:0xf bank_mask:0xf
    s_nop 0
    v_readlane_b32 s62, v57, 0
    s_cmp_lt_u32 s62, 125
    s_cbranch_scc1 mn_poll1m
mn_poll1x:
    v_mov_b32 v55, 0
    ds_write_b32 v55, v48 offset:308
mn_sp1x:
    buffer_load_dwordx4 v[20:23], v44, s[8:11], s22 offen sc1
    s_mov_b32 s52, 0x100000
    s_waitcnt vmcnt(0)
    v_mov_b32_dpp v58, v23 quad_perm:[3,3,3,3] row_mask:0xf bank_mask:0xf
    v_cmp_le_u32 vcc, s52, v58
    s_cbranch_vccnz mn_w5
mn_count:
    v_cmpx_gt_i32 vcc, 0, v20
    s_cbranch_execz mn_cn_done
    v_lshrrev_b32 v25, 23, v20
    v_and_b32 v25, 0xfc, v25
    ds_add_rtn_u32 v30, v25, v48
    v_cmpx_gt_i32 vcc, 0, v21
    s_cbranch_execz mn_cn_done
    v_lshrrev_b32 v26, 23, v21
    v_and_b32 v26, 0xfc, v26
    ds_add_rtn_u32 v31, v26, v48
    v_cmpx_gt_i32 vcc, 0, v22
    s_cbranch_execz mn_cn_done
    v_lshrrev_b32 v27, 23, v22
    v_and_b32 v27, 0xfc, v27
    ds_add_rtn_u32 v32, v27, v48
    v_cmpx_gt_i32 vcc, 0, v23
    s_cbranch_execz mn_cn_done
    v_lshrrev_b32 v28, 23, v23
    v_and_b32 v28, 0xfc, v28
    ds_add_rtn_u32 v33, v28, v48
    v_cmpx_gt_i32 vcc, 0, v24
    s_cbranch_execz mn_cn_done
    v_lshrrev_b32 v29, 23, v24
    v_and_b32 v29, 0xfc, v29
    ds_add_rtn_u32 v34, v29, v48
mn_cn_done:
    s_mov_b64 exec, -1
    v_lshrrev_b32 v42, 16, v58
    v_subrev_u32 v42, s24, v42
    v_med3_i32 v42, v42, 0, s20
    v_mov_b32 v43, v42
    v_mov_b32 v52, 0
    s_lshl_b32 s52, s18, 5
    v_add_u32_dpp v43, v43, v43 row_shr:4 row_mask:0xf bank_mask:0xf
    s_add_u32 s53, s52, 31
    s_movk_i32 s48, 0x3fff
    v_add_u32_dpp v43, v43, v43 row_shr:8 row_mask:0xf bank_mask:0xf
    s_nop 0
    s_nop 0
    v_add_u32_dpp v43, v43, v43 row_bcast:15 row_mask:0xa bank_mask:0xf
    s_nop 0
    s_nop 0
    v_add_u32_dpp v43, v43, v43 row_bcast:31 row_mask:0xc bank_mask:0xf
    s_brev_b64 exec, 1
    ds_write_b32 v59, v43 offset:384
    s_mov_b64 exec, -1
    v_sub_u32 v41, v43, v42
    s_waitcnt lgkmcnt(0)
    s_barrier
    ds_read_b32 v55, v47 offset:384
    ds_read_b32 v53, v47 offset:0
    ds_read_b32 v52, v52 offset:272
    s_waitcnt lgkmcnt(2)
    v_add_u32_dpp v55, v55, v55 row_shr:1 row_mask:0xf bank_mask:0xf
    s_waitcnt lgkmcnt(1)
    v_mov_b32 v54, v53
    v_add_u32_dpp v55, v55, v55 row_shr:2 row_mask:0xf bank_mask:0xf
    v_sub_u32 v53, v49, v53
    v_add_u32 v41, v41, v35
    v_add_u32_dpp v55, v55, v55 row_shr:4 row_mask:0xf bank_mask:0xf
    s_cmp_eq_u32 s16, 0
    v_readlane_b32 s49, v55, s36
    s_cmov_b32 s49, 0
    s_add_u32 s49, s49, 72
    v_add_u32_dpp v54, v54, v54 row_shr:1 row_mask:0xf bank_mask:0xf
    v_add_u32 v41, s49, v41
    v_lshlrev_b32 v41, 16, v41
    v_add_u32_dpp v54, v54, v54 row_shr:2 row_mask:0xf bank_mask:0xf
    v_and_or_b32 v36, v20, s48, v41
    v_add_u32 v41, 262144, v41
    v_add_u32_dpp v54, v54, v54 row_shr:4 row_mask:0xf bank_mask:0xf
    v_and_or_b32 v37, v21, s48, v41
    v_add_u32 v41, 262144, v41
    v_add_u32_dpp v54, v54, v54 row_shr:8 row_mask:0xf bank_mask:0xf
    v_and_or_b32 v38, v22, s48, v41
    v_add_u32 v41, 262144, v41
    v_add_u32_dpp v54, v54, v54 row_bcast:15 row_mask:0xa bank_mask:0xf
    v_and_or_b32 v39, v23, s48, v41
    v_add_u32 v41, 262144, v41
    v_add_u32_dpp v54, v54, v54 row_bcast:31 row_mask:0xc bank_mask:0xf
    v_add_u32 v53, v53, v54
    v_add_u32 v54, v54, v49
    ds_bpermute_b32 v25, v25, v53
    ds_bpermute_b32 v26, v26, v53
    ds_bpermute_b32 v27, v27, v53
    ds_bpermute_b32 v28, v28, v53
    ds_bpermute_b32 v29, v29, v53
    v_and_or_b32 v40, v24, s48, v41
    v_bfe_u32 v56, v20, 14, 5
    v_lshl_or_b32 v36, v56, 26, v36
    v_bfe_u32 v56, v21, 14, 5
    v_lshl_or_b32 v37, v56, 26, v37
    v_bfe_u32 v56, v22, 14, 5
    v_lshl_or_b32 v38, v56, 26, v38
    v_bfe_u32 v56, v23, 14, 5
    v_lshl_or_b32 v39, v56, 26, v39
    v_bfe_u32 v56, v24, 14, 5
    v_lshl_or_b32 v40, v56, 26, v40
    v_readlane_b32 s23, v54, 63
    v_readlane_b32 s33, v54, s53
    v_readlane_b32 s32, v53, s52
    s_cmp_gt_u32 s23, 793
    s_cbranch_scc1 mn_ovf
    v_add_lshl_u32 v55, s33, v51, 2
    s_mov_b32 exec_lo, 1048575
    s_mov_b32 exec_hi, 0
    ds_write_b32 v55, v50 offset:512
    s_mov_b64 exec, -1
    v_add_lshl_u32 v2, s32, v2, 2
    v_add_lshl_u32 v3, s32, v3, 2
    v_add_lshl_u32 v18, s32, v18, 2
    s_waitcnt lgkmcnt(1)
    v_readfirstlane_b32 s21, v52
    v_cmpx_gt_i32 vcc, 0, v20
    s_cbranch_execz mn_w2_done
    v_add_lshl_u32 v25, v25, v30, 2
    ds_write_b32 v25, v36 offset:512
    v_cmpx_gt_i32 vcc, 0, v21
    s_cbranch_execz mn_w2_done
    v_add_lshl_u32 v26, v26, v31, 2
    ds_write_b32 v26, v37 offset:512
    v_cmpx_gt_i32 vcc, 0, v22
    s_cbranch_execz mn_w2_done
    v_add_lshl_u32 v27, v27, v32, 2
    ds_write_b32 v27, v38 offset:512
    v_cmpx_gt_i32 vcc, 0, v23
    s_cbranch_execz mn_w2_done
    v_add_lshl_u32 v28, v28, v33, 2
    ds_write_b32 v28, v39 offset:512
    v_cmpx_gt_i32 vcc, 0, v24
    s_cbranch_execz mn_w2_done
    v_add_lshl_u32 v29, v29, v34, 2
    ds_write_b32 v29, v40 offset:512
mn_w2_done:
    s_mov_b64 exec, -1
    s_mov_b32 m0, s40
    s_sub_u32 s32, s32, 3
    s_sub_u32 s57, s33, s32
    s_lshr_b32 s57, s57, 2
    s_waitcnt lgkmcnt(0)
    s_barrier
    ds_read_u16 v4, v2 offset:512
    ds_read_u16 v6, v2 offset:520
    ds_read_u16 v8, v18 offset:514
    ds_read_u16 v84, v3 offset:514
    ds_read_u16 v22, v2 offset:528
    ds_read_u16 v23, v2 offset:536
    ds_read_u16 v24, v2 offset:544
    ds_read_u16 v25, v2 offset:552
    ds_read_u16 v26, v2 offset:560
    ds_read_u16 v27, v2 offset:568
    s_sub_u32 s53, s53, 4
    v_readlane_b32 s84, v54, s53
    s_add_u32 s53, s53, 1
    v_readlane_b32 s85, v54, s53
    s_add_u32 s53, s53, 1
    v_readlane_b32 s86, v54, s53
    s_add_u32 s53, s53, 1
    v_readlane_b32 s87, v54, s53
    s_waitcnt lgkmcnt(8)
    buffer_load_dwordx4 v[4:5], s[4:7], 0 idxen offen lds
    s_mov_b32 m0, s41
    s_waitcnt lgkmcnt(6)
    buffer_load_dwordx4 v[6:7], s[4:7], 0 idxen offen lds
    v_lshrrev_b32 v11, 8, v8
    v_and_b32 v8, 0x3ff, v8
    v_mul_u32_u24 v8, 48, v8
    v_and_b32 v84, 0x3ff, v84
    v_mad_u32_u24 v84, v84, 48, v86
    v_xor_b32 v85, 0x40000, v84
    s_waitcnt lgkmcnt(0)
    s_mov_b32 m0, s42
    v_mov_b32 v4, v22
    buffer_load_dwordx4 v[4:5], s[4:7], 0 idxen offen lds
    s_mov_b32 m0, s43
    v_mov_b32 v4, v23
    buffer_load_dwordx4 v[4:5], s[4:7], 0 idxen offen lds
    s_setprio 2
    s_waitcnt lgkmcnt(0)
    s_barrier
    ds_read_b64 v[8:9], v8 offset:352
    ds_read_b128 v[60:63], v84 offset:320
    ds_read_b128 v[64:67], v85 offset:320
    s_mov_b32 m0, s44
    v_mov_b32 v4, v24
    buffer_load_dwordx4 v[4:5], s[4:7], 0 idxen offen lds
    s_mov_b32 m0, s45
    v_mov_b32 v4, v25
    buffer_load_dwordx4 v[4:5], s[4:7], 0 idxen offen lds
    v_mov_b32 v4, v26
    v_mov_b32 v6, v27
    s_waitcnt vmcnt(4)
    ds_read_b64_tr_b16 v[20:21], v1 offset:0
    ds_read_b64_tr_b16 v[22:23], v1 offset:512
    ds_read_b64_tr_b16 v[24:25], v1 offset:1024
    ds_read_b64_tr_b16 v[26:27], v1 offset:1536
    s_waitcnt lgkmcnt(6)
    v_mfma_f32_4x4x4_16b_bf16 v[28:31], v[8:9], v[76:77], 0
    v_mfma_f32_4x4x4_16b_bf16 v[32:35], v[8:9], v[78:79], 0
    v_mfma_f32_4x4x4_16b_bf16 v[36:39], v[8:9], v[80:81], 0
    v_mfma_f32_4x4x4_16b_bf16 v[40:43], v[8:9], v[82:83], 0
    v_min_u32 v0, 1, v51
    v_lshlrev_b32 v0, 18, v0
    v_lshl_add_u32 v0, s17, 2, v0
    s_lshl_b32 s52, s18, 1
    s_sub_i32 s52, 1, s52
    s_mul_i32 s53, s52, s57
    s_add_i32 s53, s53, 0
    v_mov_b32 v19, s53
    v_and_b32 v11, 0x7c, v11
    v_or_b32 v11, 0xc000, v11
    v_lshlrev_b32 v10, 16, v11
    s_waitcnt lgkmcnt(4)
    v_mfma_f32_32x32x16_bf16 v[44:59], v[60:63], v[68:71], 0
    v_mfma_f32_32x32x16_bf16 v[44:59], v[64:67], v[72:75], v[44:59]
    s_mov_b32 m0, s40
    s_waitcnt lgkmcnt(0)
    buffer_load_dwordx4 v[4:5], s[4:7], 0 idxen offen lds
    s_mov_b32 m0, s41
    ds_add_u32 v0, v19 offset:288
    buffer_load_dwordx4 v[6:7], s[4:7], 0 idxen offen lds
    v_or_b32_dpp v19, v10, v11 row_shl:4 row_mask:0xf bank_mask:0xf bound_ctrl:0
    v_cvt_pk_bf16_f32 v12, v28, v32
    v_cvt_pk_bf16_f32 v14, v29, v33
    v_cvt_pk_bf16_f32 v16, v30, v34
    v_cvt_pk_bf16_f32 v13, v36, v40
    v_cvt_pk_bf16_f32 v15, v37, v41
    v_cvt_pk_bf16_f32 v17, v38, v42
    s_sub_u32 s84, s84, s32
    s_lshr_b32 s84, s84, 2
    s_sub_u32 s85, s85, s32
    s_lshr_b32 s85, s85, 2
    s_sub_u32 s86, s86, s32
    s_lshr_b32 s86, s86, 2
    s_sub_u32 s87, s87, s32
    s_lshr_b32 s87, s87, 2
    s_sub_u32 s88, s57, s87
    s_sub_u32 s87, s87, s86
    s_sub_u32 s86, s86, s85
    s_sub_u32 s85, s85, s84
    s_cmp_lg_u32 s21, 0
    s_cselect_b32 s19, s57, s84
    s_mov_b32 s58, 0
    s_mov_b32 s35, 0
    s_mov_b64 s[46:47], -1
    s_sub_i32 s34, s57, 4
    s_max_i32 s34, s34, 0
    s_mul_i32 s30, s52, -4
    s_lshl_b32 s26, s18, 31
    s_set_gpr_idx_on s40, gpr_idx(SRC2,DST)
    s_sub_u32 s19, s19, 1
    s_cbranch_scc1 mn_st12
mn_st12_back:
mn_loop:
    v_mfma_f32_4x4x4_16b_bf16 v[28:31], v[12:13], v[20:21], 0 cbsz:4 abid:0
    v_mfma_f32_4x4x4_16b_bf16 v[32:35], v[12:13], v[22:23], 0 cbsz:4 abid:1
    v_mfma_f32_4x4x4_16b_bf16 v[36:39], v[12:13], v[24:25], 0 cbsz:4 abid:2
    v_mfma_f32_4x4x4_16b_bf16 v[40:43], v[12:13], v[26:27], 0 cbsz:4 abid:3
    ds_read_u16 v4, v2 offset:576
    ds_read_u16 v6, v2 offset:584
    v_readlane_b32 s28, v19, 0
    v_readlane_b32 s29, v19, 8
    s_waitcnt vmcnt(5)
    ds_read_b64_tr_b16 v[20:21], v1 offset:2048
    ds_read_b64_tr_b16 v[22:23], v1 offset:2560
    s_waitcnt vmcnt(4)
    ds_read_b64_tr_b16 v[24:25], v1 offset:3072
    ds_read_b64_tr_b16 v[26:27], v1 offset:3584
    s_sub_u32 s34, s34, 1
    s_cmov_b32 s35, 0x30000
    s_mov_b32 m0, s28
    v_fmac_f32 v88, v28, v44
    v_fmac_f32 v89, v29, v44
    v_fmac_f32 v90, v30, v44
    v_fmac_f32 v91, v31, v44
    s_lshr_b32 m0, s28, 16
    v_fmac_f32 v88, v32, v45
    v_fmac_f32 v89, v33, v45
    v_fmac_f32 v90, v34, v45
    v_fmac_f32 v91, v35, v45
    s_mov_b32 m0, s29
    v_fmac_f32 v88, v36, v46
    v_fmac_f32 v89, v37, v46
    v_fmac_f32 v90, v38, v46
    v_fmac_f32 v91, v39, v46
    s_lshr_b32 m0, s29, 16
    v_fmac_f32 v88, v40, v47
    v_fmac_f32 v89, v41, v47
    v_fmac_f32 v90, v42, v47
    v_fmac_f32 v91, v43, v47
    s_or_b32 m0, s42, s35
    s_waitcnt lgkmcnt(2)
    buffer_load_dwordx4 v[4:5], s[4:7], 0 idxen offen lds
    s_or_b32 m0, s43, s35
    s_waitcnt lgkmcnt(0)
    buffer_load_dwordx4 v[6:7], s[4:7], 0 idxen offen lds
    s_sub_u32 s19, s19, 1
    s_cbranch_scc1 mn_st0
mn_st0_back:
    v_mfma_f32_4x4x4_16b_bf16 v[28:31], v[12:13], v[20:21], 0 cbsz:4 abid:4
    v_mfma_f32_4x4x4_16b_bf16 v[32:35], v[12:13], v[22:23], 0 cbsz:4 abid:5
    v_mfma_f32_4x4x4_16b_bf16 v[36:39], v[12:13], v[24:25], 0 cbsz:4 abid:6
    v_mfma_f32_4x4x4_16b_bf16 v[40:43], v[12:13], v[26:27], 0 cbsz:4 abid:7
    ds_read_u16 v4, v2 offset:592
    ds_read_u16 v6, v2 offset:600
    v_readlane_b32 s28, v19, 16
    v_readlane_b32 s29, v19, 24
    ds_read_u16 v84, v3 offset:578
    s_waitcnt vmcnt(5)
    ds_read_b64_tr_b16 v[20:21], v1 offset:4096
    ds_read_b64_tr_b16 v[22:23], v1 offset:4608
    s_waitcnt vmcnt(4)
    ds_read_b64_tr_b16 v[24:25], v1 offset:5120
    ds_read_b64_tr_b16 v[26:27], v1 offset:5632
    s_sub_u32 s34, s34, 1
    s_cmov_b32 s35, 0x30000
    s_mov_b32 m0, s28
    v_fmac_f32 v88, v28, v48
    v_fmac_f32 v89, v29, v48
    v_fmac_f32 v90, v30, v48
    v_fmac_f32 v91, v31, v48
    s_lshr_b32 m0, s28, 16
    v_fmac_f32 v88, v32, v49
    v_fmac_f32 v89, v33, v49
    v_fmac_f32 v90, v34, v49
    v_fmac_f32 v91, v35, v49
    s_mov_b32 m0, s29
    v_fmac_f32 v88, v36, v50
    v_fmac_f32 v89, v37, v50
    v_fmac_f32 v90, v38, v50
    v_fmac_f32 v91, v39, v50
    s_lshr_b32 m0, s29, 16
    v_fmac_f32 v88, v40, v51
    v_fmac_f32 v89, v41, v51
    v_fmac_f32 v90, v42, v51
    v_fmac_f32 v91, v43, v51
    s_or_b32 m0, s44, s35
    s_waitcnt lgkmcnt(2)
    buffer_load_dwordx4 v[4:5], s[4:7], 0 idxen offen lds
    s_or_b32 m0, s45, s35
    s_waitcnt lgkmcnt(0)
    buffer_load_dwordx4 v[6:7], s[4:7], 0 idxen offen lds
    s_sub_u32 s19, s19, 1
    s_cbranch_scc1 mn_st1
mn_st1_back:
    v_mfma_f32_4x4x4_16b_bf16 v[28:31], v[12:13], v[20:21], 0 cbsz:4 abid:8
    v_mfma_f32_4x4x4_16b_bf16 v[32:35], v[12:13], v[22:23], 0 cbsz:4 abid:9
    v_mfma_f32_4x4x4_16b_bf16 v[36:39], v[12:13], v[24:25], 0 cbsz:4 abid:10
    v_mfma_f32_4x4x4_16b_bf16 v[40:43], v[12:13], v[26:27], 0 cbsz:4 abid:11
    ds_read_u16 v4, v2 offset:608
    ds_read_u16 v6, v2 offset:616
    v_readlane_b32 s28, v19, 32
    v_readlane_b32 s29, v19, 40
    v_and_b32 v84, 0x3ff, v84
    v_mad_u32_u24 v84, v84, 48, v86
    v_xor_b32 v85, 0x40000, v84
    ds_read_b128 v[60:63], v84 offset:320
    ds_read_b128 v[64:67], v85 offset:320
    s_waitcnt vmcnt(5)
    ds_read_b64_tr_b16 v[20:21], v1 offset:0
    ds_read_b64_tr_b16 v[22:23], v1 offset:512
    s_waitcnt vmcnt(4)
    ds_read_b64_tr_b16 v[24:25], v1 offset:1024
    ds_read_b64_tr_b16 v[26:27], v1 offset:1536
    s_sub_u32 s34, s34, 1
    s_cmov_b32 s35, 0x30000
    s_mov_b32 m0, s28
    v_fmac_f32 v88, v28, v52
    v_fmac_f32 v89, v29, v52
    v_fmac_f32 v90, v30, v52
    v_fmac_f32 v91, v31, v52
    s_lshr_b32 m0, s28, 16
    v_fmac_f32 v88, v32, v53
    v_fmac_f32 v89, v33, v53
    v_fmac_f32 v90, v34, v53
    v_fmac_f32 v91, v35, v53
    s_mov_b32 m0, s29
    v_fmac_f32 v88, v36, v54
    v_fmac_f32 v89, v37, v54
    v_fmac_f32 v90, v38, v54
    v_fmac_f32 v91, v39, v54
    s_lshr_b32 m0, s29, 16
    v_fmac_f32 v88, v40, v55
    v_fmac_f32 v89, v41, v55
    v_fmac_f32 v90, v42, v55
    v_fmac_f32 v91, v43, v55
    s_or_b32 m0, s40, s35
    s_waitcnt lgkmcnt(2)
    buffer_load_dwordx4 v[4:5], s[4:7], 0 idxen offen lds
    s_or_b32 m0, s41, s35
    s_waitcnt lgkmcnt(0)
    buffer_load_dwordx4 v[6:7], s[4:7], 0 idxen offen lds
    s_sub_u32 s19, s19, 1
    s_cbranch_scc1 mn_st2
mn_st2_back:
    v_mfma_f32_4x4x4_16b_bf16 v[28:31], v[12:13], v[20:21], 0 cbsz:4 abid:12
    v_mfma_f32_4x4x4_16b_bf16 v[32:35], v[12:13], v[22:23], 0 cbsz:4 abid:13
    v_mfma_f32_4x4x4_16b_bf16 v[36:39], v[12:13], v[24:25], 0 cbsz:4 abid:14
    v_mfma_f32_4x4x4_16b_bf16 v[40:43], v[12:13], v[26:27], 0 cbsz:4 abid:15
    ds_read_u16 v4, v2 offset:624
    ds_read_u16 v6, v2 offset:632
    v_readlane_b32 s28, v19, 48
    v_readlane_b32 s29, v19, 56
    v_mov_b32 v85, s30
    ds_add_rtn_u32 v85, v0, v85 offset:288
    s_waitcnt vmcnt(5)
    ds_read_b64_tr_b16 v[20:21], v1 offset:2048
    ds_read_b64_tr_b16 v[22:23], v1 offset:2560
    s_waitcnt vmcnt(4)
    ds_read_b64_tr_b16 v[24:25], v1 offset:3072
    ds_read_b64_tr_b16 v[26:27], v1 offset:3584
    s_sub_u32 s34, s34, 1
    s_cmov_b32 s35, 0x30000
    s_mov_b32 m0, s28
    v_fmac_f32 v88, v28, v56
    v_fmac_f32 v89, v29, v56
    v_fmac_f32 v90, v30, v56
    v_fmac_f32 v91, v31, v56
    s_lshr_b32 m0, s28, 16
    v_fmac_f32 v88, v32, v57
    v_fmac_f32 v89, v33, v57
    v_fmac_f32 v90, v34, v57
    v_fmac_f32 v91, v35, v57
    s_mov_b32 m0, s29
    v_fmac_f32 v88, v36, v58
    v_fmac_f32 v89, v37, v58
    v_fmac_f32 v90, v38, v58
    v_fmac_f32 v91, v39, v58
    s_lshr_b32 m0, s29, 16
    v_fmac_f32 v88, v40, v59
    v_fmac_f32 v89, v41, v59
    v_fmac_f32 v90, v42, v59
    v_fmac_f32 v91, v43, v59
    s_or_b32 m0, s42, s35
    v_mfma_f32_32x32x16_bf16 v[44:59], v[60:63], v[68:71], 0
    v_mfma_f32_32x32x16_bf16 v[44:59], v[64:67], v[72:75], v[44:59]
    s_waitcnt lgkmcnt(2)
    buffer_load_dwordx4 v[4:5], s[4:7], 0 idxen offen lds
    s_or_b32 m0, s43, s35
    s_waitcnt lgkmcnt(0)
    buffer_load_dwordx4 v[6:7], s[4:7], 0 idxen offen lds
    v_readfirstlane_b32 s27, v85
    s_setprio 2
    s_xor_b32 s27, s27, s26
    s_cmp_ge_i32 s27, 0
    s_cbranch_scc1 mn_pr3
    s_setprio 1
mn_pr3:
    s_sub_u32 s19, s19, 1
    s_cbranch_scc1 mn_st3
mn_st3_back:
    v_mfma_f32_4x4x4_16b_bf16 v[28:31], v[14:15], v[20:21], 0 cbsz:4 abid:0
    v_mfma_f32_4x4x4_16b_bf16 v[32:35], v[14:15], v[22:23], 0 cbsz:4 abid:1
    v_mfma_f32_4x4x4_16b_bf16 v[36:39], v[14:15], v[24:25], 0 cbsz:4 abid:2
    v_mfma_f32_4x4x4_16b_bf16 v[40:43], v[14:15], v[26:27], 0 cbsz:4 abid:3
    ds_read_u16 v4, v2 offset:640
    ds_read_u16 v6, v2 offset:648
    v_readlane_b32 s28, v19, 1
    v_readlane_b32 s29, v19, 9
    s_waitcnt vmcnt(5)
    ds_read_b64_tr_b16 v[20:21], v1 offset:4096
    ds_read_b64_tr_b16 v[22:23], v1 offset:4608
    s_waitcnt vmcnt(4)
    ds_read_b64_tr_b16 v[24:25], v1 offset:5120
    ds_read_b64_tr_b16 v[26:27], v1 offset:5632
    s_sub_u32 s34, s34, 1
    s_cmov_b32 s35, 0x30000
    s_mov_b32 m0, s28
    v_fmac_f32 v88, v28, v44
    v_fmac_f32 v89, v29, v44
    v_fmac_f32 v90, v30, v44
    v_fmac_f32 v91, v31, v44
    s_lshr_b32 m0, s28, 16
    v_fmac_f32 v88, v32, v45
    v_fmac_f32 v89, v33, v45
    v_fmac_f32 v90, v34, v45
    v_fmac_f32 v91, v35, v45
    s_mov_b32 m0, s29
    v_fmac_f32 v88, v36, v46
    v_fmac_f32 v89, v37, v46
    v_fmac_f32 v90, v38, v46
    v_fmac_f32 v91, v39, v46
    s_lshr_b32 m0, s29, 16
    v_fmac_f32 v88, v40, v47
    v_fmac_f32 v89, v41, v47
    v_fmac_f32 v90, v42, v47
    v_fmac_f32 v91, v43, v47
    s_or_b32 m0, s44, s35
    s_waitcnt lgkmcnt(2)
    buffer_load_dwordx4 v[4:5], s[4:7], 0 idxen offen lds
    s_or_b32 m0, s45, s35
    s_waitcnt lgkmcnt(0)
    buffer_load_dwordx4 v[6:7], s[4:7], 0 idxen offen lds
    s_sub_u32 s19, s19, 1
    s_cbranch_scc1 mn_st4
mn_st4_back:
    v_mfma_f32_4x4x4_16b_bf16 v[28:31], v[14:15], v[20:21], 0 cbsz:4 abid:4
    v_mfma_f32_4x4x4_16b_bf16 v[32:35], v[14:15], v[22:23], 0 cbsz:4 abid:5
    v_mfma_f32_4x4x4_16b_bf16 v[36:39], v[14:15], v[24:25], 0 cbsz:4 abid:6
    v_mfma_f32_4x4x4_16b_bf16 v[40:43], v[14:15], v[26:27], 0 cbsz:4 abid:7
    ds_read_u16 v4, v2 offset:656
    ds_read_u16 v6, v2 offset:664
    v_readlane_b32 s28, v19, 17
    v_readlane_b32 s29, v19, 25
    ds_read_u16 v84, v3 offset:642
    s_waitcnt vmcnt(5)
    ds_read_b64_tr_b16 v[20:21], v1 offset:0
    ds_read_b64_tr_b16 v[22:23], v1 offset:512
    s_waitcnt vmcnt(4)
    ds_read_b64_tr_b16 v[24:25], v1 offset:1024
    ds_read_b64_tr_b16 v[26:27], v1 offset:1536
    s_sub_u32 s34, s34, 1
    s_cmov_b32 s35, 0x30000
    s_mov_b32 m0, s28
    v_fmac_f32 v88, v28, v48
    v_fmac_f32 v89, v29, v48
    v_fmac_f32 v90, v30, v48
    v_fmac_f32 v91, v31, v48
    s_lshr_b32 m0, s28, 16
    v_fmac_f32 v88, v32, v49
    v_fmac_f32 v89, v33, v49
    v_fmac_f32 v90, v34, v49
    v_fmac_f32 v91, v35, v49
    s_mov_b32 m0, s29
    v_fmac_f32 v88, v36, v50
    v_fmac_f32 v89, v37, v50
    v_fmac_f32 v90, v38, v50
    v_fmac_f32 v91, v39, v50
    s_lshr_b32 m0, s29, 16
    v_fmac_f32 v88, v40, v51
    v_fmac_f32 v89, v41, v51
    v_fmac_f32 v90, v42, v51
    v_fmac_f32 v91, v43, v51
    s_or_b32 m0, s40, s35
    s_waitcnt lgkmcnt(2)
    buffer_load_dwordx4 v[4:5], s[4:7], 0 idxen offen lds
    s_or_b32 m0, s41, s35
    s_waitcnt lgkmcnt(0)
    buffer_load_dwordx4 v[6:7], s[4:7], 0 idxen offen lds
    s_sub_u32 s19, s19, 1
    s_cbranch_scc1 mn_st5
mn_st5_back:
    v_mfma_f32_4x4x4_16b_bf16 v[28:31], v[14:15], v[20:21], 0 cbsz:4 abid:8
    v_mfma_f32_4x4x4_16b_bf16 v[32:35], v[14:15], v[22:23], 0 cbsz:4 abid:9
    v_mfma_f32_4x4x4_16b_bf16 v[36:39], v[14:15], v[24:25], 0 cbsz:4 abid:10
    v_mfma_f32_4x4x4_16b_bf16 v[40:43], v[14:15], v[26:27], 0 cbsz:4 abid:11
    ds_read_u16 v4, v2 offset:672
    ds_read_u16 v6, v2 offset:680
    v_readlane_b32 s28, v19, 33
    v_readlane_b32 s29, v19, 41
    v_and_b32 v84, 0x3ff, v84
    v_mad_u32_u24 v84, v84, 48, v86
    v_xor_b32 v85, 0x40000, v84
    ds_read_b128 v[60:63], v84 offset:320
    ds_read_b128 v[64:67], v85 offset:320
    s_waitcnt vmcnt(5)
    ds_read_b64_tr_b16 v[20:21], v1 offset:2048
    ds_read_b64_tr_b16 v[22:23], v1 offset:2560
    s_waitcnt vmcnt(4)
    ds_read_b64_tr_b16 v[24:25], v1 offset:3072
    ds_read_b64_tr_b16 v[26:27], v1 offset:3584
    s_sub_u32 s34, s34, 1
    s_cmov_b32 s35, 0x30000
    s_mov_b32 m0, s28
    v_fmac_f32 v88, v28, v52
    v_fmac_f32 v89, v29, v52
    v_fmac_f32 v90, v30, v52
    v_fmac_f32 v91, v31, v52
    s_lshr_b32 m0, s28, 16
    v_fmac_f32 v88, v32, v53
    v_fmac_f32 v89, v33, v53
    v_fmac_f32 v90, v34, v53
    v_fmac_f32 v91, v35, v53
    s_mov_b32 m0, s29
    v_fmac_f32 v88, v36, v54
    v_fmac_f32 v89, v37, v54
    v_fmac_f32 v90, v38, v54
    v_fmac_f32 v91, v39, v54
    s_lshr_b32 m0, s29, 16
    v_fmac_f32 v88, v40, v55
    v_fmac_f32 v89, v41, v55
    v_fmac_f32 v90, v42, v55
    v_fmac_f32 v91, v43, v55
    s_or_b32 m0, s42, s35
    s_waitcnt lgkmcnt(2)
    buffer_load_dwordx4 v[4:5], s[4:7], 0 idxen offen lds
    s_or_b32 m0, s43, s35
    s_waitcnt lgkmcnt(0)
    buffer_load_dwordx4 v[6:7], s[4:7], 0 idxen offen lds
    s_sub_u32 s19, s19, 1
    s_cbranch_scc1 mn_st6
mn_st6_back:
    v_mfma_f32_4x4x4_16b_bf16 v[28:31], v[14:15], v[20:21], 0 cbsz:4 abid:12
    v_mfma_f32_4x4x4_16b_bf16 v[32:35], v[14:15], v[22:23], 0 cbsz:4 abid:13
    v_mfma_f32_4x4x4_16b_bf16 v[36:39], v[14:15], v[24:25], 0 cbsz:4 abid:14
    v_mfma_f32_4x4x4_16b_bf16 v[40:43], v[14:15], v[26:27], 0 cbsz:4 abid:15
    ds_read_u16 v4, v2 offset:688
    ds_read_u16 v6, v2 offset:696
    v_readlane_b32 s28, v19, 49
    v_readlane_b32 s29, v19, 57
    v_mov_b32 v85, s30
    ds_add_rtn_u32 v85, v0, v85 offset:288
    s_waitcnt vmcnt(5)
    ds_read_b64_tr_b16 v[20:21], v1 offset:4096
    ds_read_b64_tr_b16 v[22:23], v1 offset:4608
    s_waitcnt vmcnt(4)
    ds_read_b64_tr_b16 v[24:25], v1 offset:5120
    ds_read_b64_tr_b16 v[26:27], v1 offset:5632
    s_sub_u32 s34, s34, 1
    s_cmov_b32 s35, 0x30000
    s_mov_b32 m0, s28
    v_fmac_f32 v88, v28, v56
    v_fmac_f32 v89, v29, v56
    v_fmac_f32 v90, v30, v56
    v_fmac_f32 v91, v31, v56
    s_lshr_b32 m0, s28, 16
    v_fmac_f32 v88, v32, v57
    v_fmac_f32 v89, v33, v57
    v_fmac_f32 v90, v34, v57
    v_fmac_f32 v91, v35, v57
    s_mov_b32 m0, s29
    v_fmac_f32 v88, v36, v58
    v_fmac_f32 v89, v37, v58
    v_fmac_f32 v90, v38, v58
    v_fmac_f32 v91, v39, v58
    s_lshr_b32 m0, s29, 16
    v_fmac_f32 v88, v40, v59
    v_fmac_f32 v89, v41, v59
    v_fmac_f32 v90, v42, v59
    v_fmac_f32 v91, v43, v59
    s_or_b32 m0, s44, s35
    v_mfma_f32_32x32x16_bf16 v[44:59], v[60:63], v[68:71], 0
    v_mfma_f32_32x32x16_bf16 v[44:59], v[64:67], v[72:75], v[44:59]
    s_waitcnt lgkmcnt(2)
    buffer_load_dwordx4 v[4:5], s[4:7], 0 idxen offen lds
    s_or_b32 m0, s45, s35
    s_waitcnt lgkmcnt(0)
    buffer_load_dwordx4 v[6:7], s[4:7], 0 idxen offen lds
    v_readfirstlane_b32 s27, v85
    s_setprio 2
    s_xor_b32 s27, s27, s26
    s_cmp_ge_i32 s27, 0
    s_cbranch_scc1 mn_pr7
    s_setprio 1
mn_pr7:
    s_sub_u32 s19, s19, 1
    s_cbranch_scc1 mn_st7
mn_st7_back:
    v_mfma_f32_4x4x4_16b_bf16 v[28:31], v[16:17], v[20:21], 0 cbsz:4 abid:0
    v_mfma_f32_4x4x4_16b_bf16 v[32:35], v[16:17], v[22:23], 0 cbsz:4 abid:1
    v_mfma_f32_4x4x4_16b_bf16 v[36:39], v[16:17], v[24:25], 0 cbsz:4 abid:2
    v_mfma_f32_4x4x4_16b_bf16 v[40:43], v[16:17], v[26:27], 0 cbsz:4 abid:3
    ds_read_u16 v4, v2 offset:704
    ds_read_u16 v6, v2 offset:712
    v_readlane_b32 s28, v19, 2
    v_readlane_b32 s29, v19, 10
    ds_read_u16 v8, v18 offset:706
    s_waitcnt vmcnt(5)
    ds_read_b64_tr_b16 v[20:21], v1 offset:0
    ds_read_b64_tr_b16 v[22:23], v1 offset:512
    s_waitcnt vmcnt(4)
    ds_read_b64_tr_b16 v[24:25], v1 offset:1024
    ds_read_b64_tr_b16 v[26:27], v1 offset:1536
    s_sub_u32 s34, s34, 1
    s_cmov_b32 s35, 0x30000
    s_mov_b32 m0, s28
    v_fmac_f32 v88, v28, v44
    v_fmac_f32 v89, v29, v44
    v_fmac_f32 v90, v30, v44
    v_fmac_f32 v91, v31, v44
    s_lshr_b32 m0, s28, 16
    v_fmac_f32 v88, v32, v45
    v_fmac_f32 v89, v33, v45
    v_fmac_f32 v90, v34, v45
    v_fmac_f32 v91, v35, v45
    s_mov_b32 m0, s29
    v_fmac_f32 v88, v36, v46
    v_fmac_f32 v89, v37, v46
    v_fmac_f32 v90, v38, v46
    v_fmac_f32 v91, v39, v46
    s_lshr_b32 m0, s29, 16
    v_fmac_f32 v88, v40, v47
    v_fmac_f32 v89, v41, v47
    v_fmac_f32 v90, v42, v47
    v_fmac_f32 v91, v43, v47
    s_or_b32 m0, s40, s35
    s_waitcnt lgkmcnt(2)
    buffer_load_dwordx4 v[4:5], s[4:7], 0 idxen offen lds
    s_or_b32 m0, s41, s35
    s_waitcnt lgkmcnt(0)
    buffer_load_dwordx4 v[6:7], s[4:7], 0 idxen offen lds
    s_sub_u32 s19, s19, 1
    s_cbranch_scc1 mn_st8
mn_st8_back:
    v_mfma_f32_4x4x4_16b_bf16 v[28:31], v[16:17], v[20:21], 0 cbsz:4 abid:4
    v_mfma_f32_4x4x4_16b_bf16 v[32:35], v[16:17], v[22:23], 0 cbsz:4 abid:5
    v_mfma_f32_4x4x4_16b_bf16 v[36:39], v[16:17], v[24:25], 0 cbsz:4 abid:6
    v_mfma_f32_4x4x4_16b_bf16 v[40:43], v[16:17], v[26:27], 0 cbsz:4 abid:7
    ds_read_u16 v4, v2 offset:720
    ds_read_u16 v6, v2 offset:728
    v_readlane_b32 s28, v19, 18
    v_readlane_b32 s29, v19, 26
    ds_read_u16 v84, v3 offset:706
    v_lshrrev_b32 v11, 8, v8
    v_and_b32 v8, 0x3ff, v8
    v_mul_u32_u24 v8, 48, v8
    ds_read_b64 v[8:9], v8 offset:352
    s_waitcnt vmcnt(5)
    ds_read_b64_tr_b16 v[20:21], v1 offset:2048
    ds_read_b64_tr_b16 v[22:23], v1 offset:2560
    s_waitcnt vmcnt(4)
    ds_read_b64_tr_b16 v[24:25], v1 offset:3072
    ds_read_b64_tr_b16 v[26:27], v1 offset:3584
    s_sub_u32 s34, s34, 1
    s_cmov_b32 s35, 0x30000
    s_mov_b32 m0, s28
    v_fmac_f32 v88, v28, v48
    v_fmac_f32 v89, v29, v48
    v_fmac_f32 v90, v30, v48
    v_fmac_f32 v91, v31, v48
    s_lshr_b32 m0, s28, 16
    v_fmac_f32 v88, v32, v49
    v_fmac_f32 v89, v33, v49
    v_fmac_f32 v90, v34, v49
    v_fmac_f32 v91, v35, v49
    s_mov_b32 m0, s29
    v_fmac_f32 v88, v36, v50
    v_fmac_f32 v89, v37, v50
    v_fmac_f32 v90, v38, v50
    v_fmac_f32 v91, v39, v50
    s_lshr_b32 m0, s29, 16
    v_fmac_f32 v88, v40, v51
    v_fmac_f32 v89, v41, v51
    v_fmac_f32 v90, v42, v51
    v_fmac_f32 v91, v43, v51
    s_or_b32 m0, s42, s35
    s_waitcnt lgkmcnt(2)
    buffer_load_dwordx4 v[4:5], s[4:7], 0 idxen offen lds
    s_or_b32 m0, s43, s35
    s_waitcnt lgkmcnt(0)
    buffer_load_dwordx4 v[6:7], s[4:7], 0 idxen offen lds
    s_sub_u32 s19, s19, 1
    s_cbranch_scc1 mn_st9
mn_st9_back:
    v_mfma_f32_4x4x4_16b_bf16 v[28:31], v[16:17], v[20:21], 0 cbsz:4 abid:8
    v_mfma_f32_4x4x4_16b_bf16 v[32:35], v[16:17], v[22:23], 0 cbsz:4 abid:9
    v_mfma_f32_4x4x4_16b_bf16 v[36:39], v[16:17], v[24:25], 0 cbsz:4 abid:10
    v_mfma_f32_4x4x4_16b_bf16 v[40:43], v[16:17], v[26:27], 0 cbsz:4 abid:11
    ds_read_u16 v4, v2 offset:736
    ds_read_u16 v6, v2 offset:744
    v_readlane_b32 s28, v19, 34
    v_readlane_b32 s29, v19, 42
    v_and_b32 v84, 0x3ff, v84
    v_mad_u32_u24 v84, v84, 48, v86
    v_xor_b32 v85, 0x40000, v84
    ds_read_b128 v[60:63], v84 offset:320
    ds_read_b128 v[64:67], v85 offset:320
    s_waitcnt vmcnt(5)
    ds_read_b64_tr_b16 v[20:21], v1 offset:4096
    ds_read_b64_tr_b16 v[22:23], v1 offset:4608
    s_waitcnt vmcnt(4)
    ds_read_b64_tr_b16 v[24:25], v1 offset:5120
    ds_read_b64_tr_b16 v[26:27], v1 offset:5632
    s_sub_u32 s34, s34, 1
    s_cmov_b32 s35, 0x30000
    s_mov_b32 m0, s28
    v_fmac_f32 v88, v28, v52
    v_fmac_f32 v89, v29, v52
    v_fmac_f32 v90, v30, v52
    v_fmac_f32 v91, v31, v52
    s_lshr_b32 m0, s28, 16
    v_fmac_f32 v88, v32, v53
    v_fmac_f32 v89, v33, v53
    v_fmac_f32 v90, v34, v53
    v_fmac_f32 v91, v35, v53
    s_mov_b32 m0, s29
    v_fmac_f32 v88, v36, v54
    v_fmac_f32 v89, v37, v54
    v_fmac_f32 v90, v38, v54
    v_fmac_f32 v91, v39, v54
    s_lshr_b32 m0, s29, 16
    v_fmac_f32 v88, v40, v55
    v_fmac_f32 v89, v41, v55
    v_fmac_f32 v90, v42, v55
    v_fmac_f32 v91, v43, v55
    s_or_b32 m0, s44, s35
    s_waitcnt lgkmcnt(2)
    buffer_load_dwordx4 v[4:5], s[4:7], 0 idxen offen lds
    s_or_b32 m0, s45, s35
    s_waitcnt lgkmcnt(0)
    buffer_load_dwordx4 v[6:7], s[4:7], 0 idxen offen lds
    v_and_b32 v11, 0x7c, v11
    v_or_b32 v11, 0xc000, v11
    v_lshlrev_b32 v10, 16, v11
    s_sub_u32 s19, s19, 1
    s_cbranch_scc1 mn_st10
mn_st10_back:
    v_mfma_f32_4x4x4_16b_bf16 v[28:31], v[16:17], v[20:21], 0 cbsz:4 abid:12
    v_mfma_f32_4x4x4_16b_bf16 v[32:35], v[16:17], v[22:23], 0 cbsz:4 abid:13
    v_mfma_f32_4x4x4_16b_bf16 v[36:39], v[16:17], v[24:25], 0 cbsz:4 abid:14
    v_mfma_f32_4x4x4_16b_bf16 v[40:43], v[16:17], v[26:27], 0 cbsz:4 abid:15
    ds_read_u16 v4, v2 offset:752
    ds_read_u16 v6, v2 offset:760
    v_readlane_b32 s28, v19, 50
    v_readlane_b32 s29, v19, 58
    v_mov_b32 v85, s30
    ds_add_rtn_u32 v85, v0, v85 offset:288
    s_waitcnt vmcnt(5)
    ds_read_b64_tr_b16 v[20:21], v1 offset:0
    ds_read_b64_tr_b16 v[22:23], v1 offset:512
    s_waitcnt vmcnt(4)
    ds_read_b64_tr_b16 v[24:25], v1 offset:1024
    ds_read_b64_tr_b16 v[26:27], v1 offset:1536
    s_sub_u32 s34, s34, 1
    s_cmov_b32 s35, 0x30000
    s_mov_b32 m0, s28
    v_fmac_f32 v88, v28, v56
    v_fmac_f32 v89, v29, v56
    v_fmac_f32 v90, v30, v56
    v_fmac_f32 v91, v31, v56
    s_lshr_b32 m0, s28, 16
    v_fmac_f32 v88, v32, v57
    v_fmac_f32 v89, v33, v57
    v_fmac_f32 v90, v34, v57
    v_fmac_f32 v91, v35, v57
    s_mov_b32 m0, s29
    v_fmac_f32 v88, v36, v58
    v_fmac_f32 v89, v37, v58
    v_fmac_f32 v90, v38, v58
    v_fmac_f32 v91, v39, v58
    s_lshr_b32 m0, s29, 16
    v_fmac_f32 v88, v40, v59
    v_fmac_f32 v89, v41, v59
    v_fmac_f32 v90, v42, v59
    v_fmac_f32 v91, v43, v59
    s_or_b32 m0, s40, s35
    v_mfma_f32_4x4x4_16b_bf16 v[28:31], v[8:9], v[76:77], 0
    v_mfma_f32_4x4x4_16b_bf16 v[32:35], v[8:9], v[78:79], 0
    v_mfma_f32_4x4x4_16b_bf16 v[36:39], v[8:9], v[80:81], 0
    v_mfma_f32_4x4x4_16b_bf16 v[40:43], v[8:9], v[82:83], 0
    v_mfma_f32_32x32x16_bf16 v[44:59], v[60:63], v[68:71], 0
    v_mfma_f32_32x32x16_bf16 v[44:59], v[64:67], v[72:75], v[44:59]
    s_waitcnt lgkmcnt(2)
    buffer_load_dwordx4 v[4:5], s[4:7], 0 idxen offen lds
    s_or_b32 m0, s41, s35
    s_waitcnt lgkmcnt(0)
    buffer_load_dwordx4 v[6:7], s[4:7], 0 idxen offen lds
    v_cvt_pk_bf16_f32 v12, v28, v32
    v_cvt_pk_bf16_f32 v14, v29, v33
    v_cvt_pk_bf16_f32 v16, v30, v34
    v_cvt_pk_bf16_f32 v13, v36, v40
    v_cvt_pk_bf16_f32 v15, v37, v41
    v_cvt_pk_bf16_f32 v17, v38, v42
    v_or_b32_dpp v19, v10, v11 row_shl:4 row_mask:0xf bank_mask:0xf bound_ctrl:0
    v_add_u32 v2, 192, v2
    v_add_u32 v3, 192, v3
    v_add_u32 v18, 192, v18
    v_readfirstlane_b32 s27, v85
    s_setprio 2
    s_xor_b32 s27, s27, s26
    s_cmp_ge_i32 s27, 0
    s_cbranch_scc1 mn_pr11
    s_setprio 1
mn_pr11:
    s_sub_u32 s19, s19, 1
    s_cbranch_scc1 mn_st11
mn_st11_back:
    s_branch mn_loop
mn_st0:
    s_cmp_lg_u32 s21, 0
    s_cbranch_scc1 mn_next
    s_call_b64 s[48:49], mn_flush
    s_branch mn_st0_back
mn_st1:
    s_cmp_lg_u32 s21, 0
    s_cbranch_scc1 mn_next
    s_call_b64 s[48:49], mn_flush
    s_branch mn_st1_back
mn_st2:
    s_cmp_lg_u32 s21, 0
    s_cbranch_scc1 mn_next
    s_call_b64 s[48:49], mn_flush
    s_branch mn_st2_back
mn_st3:
    s_cmp_lg_u32 s21, 0
    s_cbranch_scc1 mn_next
    s_call_b64 s[48:49], mn_flush
    s_branch mn_st3_back
mn_st4:
    s_cmp_lg_u32 s21, 0
    s_cbranch_scc1 mn_next
    s_call_b64 s[48:49], mn_flush
    s_branch mn_st4_back
mn_st5:
    s_cmp_lg_u32 s21, 0
    s_cbranch_scc1 mn_next
    s_call_b64 s[48:49], mn_flush
    s_branch mn_st5_back
mn_st6:
    s_cmp_lg_u32 s21, 0
    s_cbranch_scc1 mn_next
    s_call_b64 s[48:49], mn_flush
    s_branch mn_st6_back
mn_st7:
    s_cmp_lg_u32 s21, 0
    s_cbranch_scc1 mn_next
    s_call_b64 s[48:49], mn_flush
    s_branch mn_st7_back
mn_st8:
    s_cmp_lg_u32 s21, 0
    s_cbranch_scc1 mn_next
    s_call_b64 s[48:49], mn_flush
    s_branch mn_st8_back
mn_st9:
    s_cmp_lg_u32 s21, 0
    s_cbranch_scc1 mn_next
    s_call_b64 s[48:49], mn_flush
    s_branch mn_st9_back
mn_st10:
    s_cmp_lg_u32 s21, 0
    s_cbranch_scc1 mn_next
    s_call_b64 s[48:49], mn_flush
    s_branch mn_st10_back
mn_st11:
    s_cmp_lg_u32 s21, 0
    s_cbranch_scc1 mn_next
    s_call_b64 s[48:49], mn_flush
    s_branch mn_st11_back
mn_st12:
    s_cmp_lg_u32 s21, 0
    s_cbranch_scc1 mn_next
    s_call_b64 s[48:49], mn_flush
    s_branch mn_st12_back
mn_flush:
    s_cmp_eq_u32 s58, 4
    s_cbranch_scc1 mn_fl4
    s_cmp_eq_u32 s58, 3
    s_cbranch_scc1 mn_fl3
    s_cmp_eq_u32 s58, 2
    s_cbranch_scc1 mn_fl2
    s_cmp_eq_u32 s58, 1
    s_cbranch_scc1 mn_fl1
mn_fl0:
    v_cvt_pk_bf16_f32 v88, v88, v89
    v_cvt_pk_bf16_f32 v89, v90, v91
    ds_write_b64 v87, v[88:89] offset:0
    v_cvt_pk_bf16_f32 v92, v92, v93
    v_cvt_pk_bf16_f32 v93, v94, v95
    ds_write_b64 v87, v[92:93] offset:576
    v_cvt_pk_bf16_f32 v96, v96, v97
    v_cvt_pk_bf16_f32 v97, v98, v99
    ds_write_b64 v87, v[96:97] offset:1152
    v_cvt_pk_bf16_f32 v100, v100, v101
    v_cvt_pk_bf16_f32 v101, v102, v103
    ds_write_b64 v87, v[100:101] offset:1728
    s_mul_i32 s52, s18, 3
    s_lshl_b32 s52, 1, s52
    v_mov_b32 v90, s52
    v_mov_b32 v91, 0
    s_mov_b64 exec, 1
    ds_add_u32 v91, v90 offset:276
    s_mov_b64 exec, -1
    s_add_u32 s58, s58, 1
    s_sub_u32 s19, s85, 1
    s_cbranch_scc1 mn_fl1
    s_setpc_b64 s[48:49]
mn_fl1:
    v_cvt_pk_bf16_f32 v104, v104, v105
    v_cvt_pk_bf16_f32 v105, v106, v107
    ds_write_b64 v87, v[104:105] offset:2304
    v_cvt_pk_bf16_f32 v108, v108, v109
    v_cvt_pk_bf16_f32 v109, v110, v111
    ds_write_b64 v87, v[108:109] offset:2880
    v_cvt_pk_bf16_f32 v112, v112, v113
    v_cvt_pk_bf16_f32 v113, v114, v115
    ds_write_b64 v87, v[112:113] offset:3456
    v_cvt_pk_bf16_f32 v116, v116, v117
    v_cvt_pk_bf16_f32 v117, v118, v119
    ds_write_b64 v87, v[116:117] offset:4032
    s_mul_i32 s52, s18, 3
    s_lshl_b32 s52, 64, s52
    v_mov_b32 v106, s52
    v_mov_b32 v107, 0
    s_mov_b64 exec, 1
    ds_add_u32 v107, v106 offset:276
    s_mov_b64 exec, -1
    s_add_u32 s58, s58, 1
    s_sub_u32 s19, s86, 1
    s_cbranch_scc1 mn_fl2
    s_setpc_b64 s[48:49]
mn_fl2:
    v_cvt_pk_bf16_f32 v120, v120, v121
    v_cvt_pk_bf16_f32 v121, v122, v123
    ds_write_b64 v87, v[120:121] offset:4608
    v_cvt_pk_bf16_f32 v124, v124, v125
    v_cvt_pk_bf16_f32 v125, v126, v127
    ds_write_b64 v87, v[124:125] offset:5184
    v_cvt_pk_bf16_f32 v128, v128, v129
    v_cvt_pk_bf16_f32 v129, v130, v131
    ds_write_b64 v87, v[128:129] offset:5760
    v_cvt_pk_bf16_f32 v132, v132, v133
    v_cvt_pk_bf16_f32 v133, v134, v135
    ds_write_b64 v87, v[132:133] offset:6336
    s_mul_i32 s52, s18, 3
    s_lshl_b32 s52, 4096, s52
    v_mov_b32 v122, s52
    v_mov_b32 v123, 0
    s_mov_b64 exec, 1
    ds_add_u32 v123, v122 offset:276
    s_mov_b64 exec, -1
    s_add_u32 s58, s58, 1
    s_sub_u32 s19, s87, 1
    s_cbranch_scc1 mn_fl3
    s_setpc_b64 s[48:49]
mn_fl3:
    v_cvt_pk_bf16_f32 v136, v136, v137
    v_cvt_pk_bf16_f32 v137, v138, v139
    ds_write_b64 v87, v[136:137] offset:6912
    v_cvt_pk_bf16_f32 v140, v140, v141
    v_cvt_pk_bf16_f32 v141, v142, v143
    ds_write_b64 v87, v[140:141] offset:7488
    v_cvt_pk_bf16_f32 v144, v144, v145
    v_cvt_pk_bf16_f32 v145, v146, v147
    ds_write_b64 v87, v[144:145] offset:8064
    v_cvt_pk_bf16_f32 v148, v148, v149
    v_cvt_pk_bf16_f32 v149, v150, v151
    ds_write_b64 v87, v[148:149] offset:8640
    s_mul_i32 s52, s18, 3
    s_lshl_b32 s52, 262144, s52
    v_mov_b32 v138, s52
    v_mov_b32 v139, 0
    s_mov_b64 exec, 1
    ds_add_u32 v139, v138 offset:276
    s_mov_b64 exec, -1
    s_add_u32 s58, s58, 1
    s_sub_u32 s19, s88, 1
    s_cbranch_scc1 mn_fl4
    s_setpc_b64 s[48:49]
mn_fl4:
    s_cmp_ge_u32 s57, 4
    s_cbranch_scc1 mn_fl4b
    s_waitcnt vmcnt(0)
mn_fl4b:
    v_cvt_pk_bf16_f32 v152, v152, v153
    v_cvt_pk_bf16_f32 v153, v154, v155
    ds_write_b64 v87, v[152:153] offset:9216
    v_cvt_pk_bf16_f32 v156, v156, v157
    v_cvt_pk_bf16_f32 v157, v158, v159
    ds_write_b64 v87, v[156:157] offset:9792
    v_cvt_pk_bf16_f32 v160, v160, v161
    v_cvt_pk_bf16_f32 v161, v162, v163
    ds_write_b64 v87, v[160:161] offset:10368
    v_cvt_pk_bf16_f32 v164, v164, v165
    v_cvt_pk_bf16_f32 v165, v166, v167
    ds_write_b64 v87, v[164:165] offset:10944
    s_mul_i32 s52, s18, 3
    s_lshl_b32 s52, 16777216, s52
    v_mov_b32 v154, s52
    v_mov_b32 v155, 0
    s_mov_b64 exec, 1
    ds_add_u32 v155, v154 offset:276
    s_mov_b64 exec, -1
    s_waitcnt vmcnt(0) lgkmcnt(0)
mn_end:
    s_endpgm
gm_main:
    s_load_dwordx2 s[56:57], s[0:1], 64
    s_load_dwordx2 s[26:27], s[0:1], 56
    v_and_b32 v3, 63, v0
    v_bfe_u32 v12, v0, 1, 7
    v_and_b32 v11, 15, v12
    v_lshrrev_b32 v10, 4, v12
    v_lshl_or_b32 v11, v11, 3, v10
    v_cmp_gt_u32 vcc, 125, v11
    v_mul_u32_u24 v13, 51200, v11
    v_bfrev_b32 v10, 2
    v_lshlrev_b32 v12, 6, v12
    v_cndmask_b32 v12, v10, v12, vcc
    v_lshlrev_b32 v2, 4, v3
    s_lshl_b32 s40, s17, 15
    s_add_u32 s40, s40, 11534336
    s_waitcnt lgkmcnt(0)
    s_mov_b32 s8, s54
    s_and_b32 s9, s55, 0xffff
    v_lshrrev_b32 v11, 4, v3
    v_lshlrev_b32 v11, 11, v11
    v_and_b32 v10, 7, v3
    v_lshl_add_u32 v11, v10, 4, v11
    v_and_b32 v10, 8, v3
    v_lshlrev_b32 v10, 10, v10
    s_lshl_b32 s52, s17, 7
    s_add_u32 s52, s52, 114688
    v_add3_u32 v11, v11, v10, s52
    s_mov_b32 s44, 0x05040100
    s_mov_b32 s45, 0x07060302
    v_mov_b32 v5, v11
    s_cmp_ge_u32 s2, 125
    s_cbranch_scc1 gm_wgo
    s_cmp_ge_u32 s16, 10
    s_cbranch_scc1 gm_wsp
    s_cmp_ge_u32 s2, 125
    s_waitcnt vmcnt(0)
    s_cbranch_scc1 gm_wsp
    v_mov_b32 v11, 0
    v_mov_b32 v10, 1
    s_mov_b64 exec, 1
    ds_add_u32 v11, v10 offset:448
    s_mov_b64 exec, -1
gm_dummy:
gm_wsp:
    v_mov_b32 v11, 0
    ds_read_b32 v11, v11 offset:448
    s_waitcnt lgkmcnt(0)
    v_readfirstlane_b32 s62, v11
    s_cmp_ge_u32 s62, 10
    s_cbranch_scc1 gm_wspx
    s_sleep 1
    s_branch gm_wsp
gm_wspx:
    s_cmp_lg_u32 s16, 10
    s_cbranch_scc1 gm_wgo
    s_and_b32 s52, s2, 1
    s_lshl_b32 s53, s52, 7
    s_add_u32 s53, s53, 64
    s_mov_b32 s62, 1
    s_atomic_add s62, s[60:61], s53 glc
    s_sub_u32 s52, 62, s52
    s_add_u32 s28, s54, 11730944
    s_addc_u32 s29, s55, 0
    s_mov_b32 s53, 0x10000
    s_waitcnt lgkmcnt(0)
    s_cmp_lg_u32 s62, s52
    s_cbranch_scc1 gm_wgo
    s_atomic_add s53, s[28:29], 0
    s_atomic_add s53, s[28:29], 128
    s_atomic_add s53, s[28:29], 256
    s_atomic_add s53, s[28:29], 384
    s_atomic_add s53, s[28:29], 512
    s_atomic_add s53, s[28:29], 640
    s_atomic_add s53, s[28:29], 768
    s_atomic_add s53, s[28:29], 896
    s_atomic_add s53, s[28:29], 1024
    s_atomic_add s53, s[28:29], 1152
    s_atomic_add s53, s[28:29], 1280
    s_atomic_add s53, s[28:29], 1408
    s_atomic_add s53, s[28:29], 1536
    s_atomic_add s53, s[28:29], 1664
    s_atomic_add s53, s[28:29], 1792
    s_atomic_add s53, s[28:29], 1920
gm_wgo:
    global_load_dwordx4 v[136:139], v5, s[26:27] offset:0
    global_load_dwordx4 v[140:143], v5, s[26:27] offset:512
    global_load_dwordx4 v[144:147], v5, s[26:27] offset:1024
    global_load_dwordx4 v[148:151], v5, s[26:27] offset:1536
    v_subrev_u32 v5, 0x4000, v5
    global_load_dwordx4 v[120:123], v5, s[26:27] offset:0
    global_load_dwordx4 v[124:127], v5, s[26:27] offset:512
    global_load_dwordx4 v[128:131], v5, s[26:27] offset:1024
    global_load_dwordx4 v[132:135], v5, s[26:27] offset:1536
    v_subrev_u32 v5, 0x4000, v5
    global_load_dwordx4 v[104:107], v5, s[26:27] offset:0
    global_load_dwordx4 v[108:111], v5, s[26:27] offset:512
    global_load_dwordx4 v[112:115], v5, s[26:27] offset:1024
    global_load_dwordx4 v[116:119], v5, s[26:27] offset:1536
    v_subrev_u32 v5, 0x4000, v5
    s_waitcnt vmcnt(8)
    v_mov_b32_dpp v152, v138 row_ror:8 row_mask:0xf bank_mask:0xf
    v_mov_b32_dpp v153, v139 row_ror:8 row_mask:0xf bank_mask:0xf
    v_mov_b32_dpp v154, v142 row_ror:8 row_mask:0xf bank_mask:0xf
    v_mov_b32_dpp v155, v143 row_ror:8 row_mask:0xf bank_mask:0xf
    v_mov_b32_dpp v156, v146 row_ror:8 row_mask:0xf bank_mask:0xf
    v_mov_b32_dpp v157, v147 row_ror:8 row_mask:0xf bank_mask:0xf
    v_mov_b32_dpp v158, v150 row_ror:8 row_mask:0xf bank_mask:0xf
    v_mov_b32_dpp v159, v151 row_ror:8 row_mask:0xf bank_mask:0xf
    v_mov_b32_dpp v138, v136 row_ror:8 row_mask:0xf bank_mask:0x3
    v_mov_b32_dpp v139, v137 row_ror:8 row_mask:0xf bank_mask:0x3
    v_mov_b32_dpp v142, v140 row_ror:8 row_mask:0xf bank_mask:0x3
    v_mov_b32_dpp v143, v141 row_ror:8 row_mask:0xf bank_mask:0x3
    v_mov_b32_dpp v146, v144 row_ror:8 row_mask:0xf bank_mask:0x3
    v_mov_b32_dpp v147, v145 row_ror:8 row_mask:0xf bank_mask:0x3
    v_mov_b32_dpp v150, v148 row_ror:8 row_mask:0xf bank_mask:0x3
    v_mov_b32_dpp v151, v149 row_ror:8 row_mask:0xf bank_mask:0x3
    v_mov_b32_dpp v136, v152 quad_perm:[0,1,2,3] row_mask:0xf bank_mask:0xc
    v_mov_b32_dpp v137, v153 quad_perm:[0,1,2,3] row_mask:0xf bank_mask:0xc
    v_mov_b32_dpp v140, v154 quad_perm:[0,1,2,3] row_mask:0xf bank_mask:0xc
    v_mov_b32_dpp v141, v155 quad_perm:[0,1,2,3] row_mask:0xf bank_mask:0xc
    v_mov_b32_dpp v144, v156 quad_perm:[0,1,2,3] row_mask:0xf bank_mask:0xc
    v_mov_b32_dpp v145, v157 quad_perm:[0,1,2,3] row_mask:0xf bank_mask:0xc
    v_mov_b32_dpp v148, v158 quad_perm:[0,1,2,3] row_mask:0xf bank_mask:0xc
    v_mov_b32_dpp v149, v159 quad_perm:[0,1,2,3] row_mask:0xf bank_mask:0xc
    v_perm_b32 v152, v140, v136, s44
    v_perm_b32 v153, v148, v144, s44
    v_perm_b32 v154, v142, v138, s44
    v_perm_b32 v155, v150, v146, s44
    v_perm_b32 v156, v140, v136, s45
    v_perm_b32 v157, v148, v144, s45
    v_perm_b32 v158, v142, v138, s45
    v_perm_b32 v159, v150, v146, s45
    v_perm_b32 v160, v141, v137, s44
    v_perm_b32 v161, v149, v145, s44
    v_perm_b32 v162, v143, v139, s44
    v_perm_b32 v163, v151, v147, s44
    v_perm_b32 v164, v141, v137, s45
    v_perm_b32 v165, v149, v145, s45
    v_perm_b32 v166, v143, v139, s45
    v_perm_b32 v167, v151, v147, s45
    s_waitcnt vmcnt(4)
    v_mov_b32_dpp v136, v122 row_ror:8 row_mask:0xf bank_mask:0xf
    v_mov_b32_dpp v137, v123 row_ror:8 row_mask:0xf bank_mask:0xf
    v_mov_b32_dpp v138, v126 row_ror:8 row_mask:0xf bank_mask:0xf
    v_mov_b32_dpp v139, v127 row_ror:8 row_mask:0xf bank_mask:0xf
    v_mov_b32_dpp v140, v130 row_ror:8 row_mask:0xf bank_mask:0xf
    v_mov_b32_dpp v141, v131 row_ror:8 row_mask:0xf bank_mask:0xf
    v_mov_b32_dpp v142, v134 row_ror:8 row_mask:0xf bank_mask:0xf
    v_mov_b32_dpp v143, v135 row_ror:8 row_mask:0xf bank_mask:0xf
    v_mov_b32_dpp v122, v120 row_ror:8 row_mask:0xf bank_mask:0x3
    v_mov_b32_dpp v123, v121 row_ror:8 row_mask:0xf bank_mask:0x3
    v_mov_b32_dpp v126, v124 row_ror:8 row_mask:0xf bank_mask:0x3
    v_mov_b32_dpp v127, v125 row_ror:8 row_mask:0xf bank_mask:0x3
    v_mov_b32_dpp v130, v128 row_ror:8 row_mask:0xf bank_mask:0x3
    v_mov_b32_dpp v131, v129 row_ror:8 row_mask:0xf bank_mask:0x3
    v_mov_b32_dpp v134, v132 row_ror:8 row_mask:0xf bank_mask:0x3
    v_mov_b32_dpp v135, v133 row_ror:8 row_mask:0xf bank_mask:0x3
    v_mov_b32_dpp v120, v136 quad_perm:[0,1,2,3] row_mask:0xf bank_mask:0xc
    v_mov_b32_dpp v121, v137 quad_perm:[0,1,2,3] row_mask:0xf bank_mask:0xc
    v_mov_b32_dpp v124, v138 quad_perm:[0,1,2,3] row_mask:0xf bank_mask:0xc
    v_mov_b32_dpp v125, v139 quad_perm:[0,1,2,3] row_mask:0xf bank_mask:0xc
    v_mov_b32_dpp v128, v140 quad_perm:[0,1,2,3] row_mask:0xf bank_mask:0xc
    v_mov_b32_dpp v129, v141 quad_perm:[0,1,2,3] row_mask:0xf bank_mask:0xc
    v_mov_b32_dpp v132, v142 quad_perm:[0,1,2,3] row_mask:0xf bank_mask:0xc
    v_mov_b32_dpp v133, v143 quad_perm:[0,1,2,3] row_mask:0xf bank_mask:0xc
    v_perm_b32 v136, v124, v120, s44
    v_perm_b32 v137, v132, v128, s44
    v_perm_b32 v138, v126, v122, s44
    v_perm_b32 v139, v134, v130, s44
    v_perm_b32 v140, v124, v120, s45
    v_perm_b32 v141, v132, v128, s45
    v_perm_b32 v142, v126, v122, s45
    v_perm_b32 v143, v134, v130, s45
    v_perm_b32 v144, v125, v121, s44
    v_perm_b32 v145, v133, v129, s44
    v_perm_b32 v146, v127, v123, s44
    v_perm_b32 v147, v135, v131, s44
    v_perm_b32 v148, v125, v121, s45
    v_perm_b32 v149, v133, v129, s45
    v_perm_b32 v150, v127, v123, s45
    v_perm_b32 v151, v135, v131, s45
    s_waitcnt vmcnt(0)
    v_mov_b32_dpp v120, v106 row_ror:8 row_mask:0xf bank_mask:0xf
    v_mov_b32_dpp v121, v107 row_ror:8 row_mask:0xf bank_mask:0xf
    v_mov_b32_dpp v122, v110 row_ror:8 row_mask:0xf bank_mask:0xf
    v_mov_b32_dpp v123, v111 row_ror:8 row_mask:0xf bank_mask:0xf
    v_mov_b32_dpp v124, v114 row_ror:8 row_mask:0xf bank_mask:0xf
    v_mov_b32_dpp v125, v115 row_ror:8 row_mask:0xf bank_mask:0xf
    v_mov_b32_dpp v126, v118 row_ror:8 row_mask:0xf bank_mask:0xf
    v_mov_b32_dpp v127, v119 row_ror:8 row_mask:0xf bank_mask:0xf
    v_mov_b32_dpp v106, v104 row_ror:8 row_mask:0xf bank_mask:0x3
    v_mov_b32_dpp v107, v105 row_ror:8 row_mask:0xf bank_mask:0x3
    v_mov_b32_dpp v110, v108 row_ror:8 row_mask:0xf bank_mask:0x3
    v_mov_b32_dpp v111, v109 row_ror:8 row_mask:0xf bank_mask:0x3
    v_mov_b32_dpp v114, v112 row_ror:8 row_mask:0xf bank_mask:0x3
    v_mov_b32_dpp v115, v113 row_ror:8 row_mask:0xf bank_mask:0x3
    v_mov_b32_dpp v118, v116 row_ror:8 row_mask:0xf bank_mask:0x3
    v_mov_b32_dpp v119, v117 row_ror:8 row_mask:0xf bank_mask:0x3
    v_mov_b32_dpp v104, v120 quad_perm:[0,1,2,3] row_mask:0xf bank_mask:0xc
    v_mov_b32_dpp v105, v121 quad_perm:[0,1,2,3] row_mask:0xf bank_mask:0xc
    v_mov_b32_dpp v108, v122 quad_perm:[0,1,2,3] row_mask:0xf bank_mask:0xc
    v_mov_b32_dpp v109, v123 quad_perm:[0,1,2,3] row_mask:0xf bank_mask:0xc
    v_mov_b32_dpp v112, v124 quad_perm:[0,1,2,3] row_mask:0xf bank_mask:0xc
    v_mov_b32_dpp v113, v125 quad_perm:[0,1,2,3] row_mask:0xf bank_mask:0xc
    v_mov_b32_dpp v116, v126 quad_perm:[0,1,2,3] row_mask:0xf bank_mask:0xc
    v_mov_b32_dpp v117, v127 quad_perm:[0,1,2,3] row_mask:0xf bank_mask:0xc
    v_perm_b32 v120, v108, v104, s44
    v_perm_b32 v121, v116, v112, s44
    v_perm_b32 v122, v110, v106, s44
    v_perm_b32 v123, v118, v114, s44
    v_perm_b32 v124, v108, v104, s45
    v_perm_b32 v125, v116, v112, s45
    v_perm_b32 v126, v110, v106, s45
    v_perm_b32 v127, v118, v114, s45
    v_perm_b32 v128, v109, v105, s44
    v_perm_b32 v129, v117, v113, s44
    v_perm_b32 v130, v111, v107, s44
    v_perm_b32 v131, v119, v115, s44
    v_perm_b32 v132, v109, v105, s45
    v_perm_b32 v133, v117, v113, s45
    v_perm_b32 v134, v111, v107, s45
    v_perm_b32 v135, v119, v115, s45
    s_cmp_lt_u32 s2, 125
    s_cbranch_scc1 gm_wskip
    global_load_dwordx4 v[88:91], v5, s[26:27] offset:0
    global_load_dwordx4 v[92:95], v5, s[26:27] offset:512
    global_load_dwordx4 v[96:99], v5, s[26:27] offset:1024
    global_load_dwordx4 v[100:103], v5, s[26:27] offset:1536
    v_subrev_u32 v5, 0x4000, v5
    global_load_dwordx4 v[72:75], v5, s[26:27] offset:0
    global_load_dwordx4 v[76:79], v5, s[26:27] offset:512
    global_load_dwordx4 v[80:83], v5, s[26:27] offset:1024
    global_load_dwordx4 v[84:87], v5, s[26:27] offset:1536
    v_subrev_u32 v5, 0x4000, v5
    global_load_dwordx4 v[56:59], v5, s[26:27] offset:0
    global_load_dwordx4 v[60:63], v5, s[26:27] offset:512
    global_load_dwordx4 v[64:67], v5, s[26:27] offset:1024
    global_load_dwordx4 v[68:71], v5, s[26:27] offset:1536
    v_subrev_u32 v5, 0x4000, v5
    global_load_dwordx4 v[40:43], v5, s[26:27] offset:0
    global_load_dwordx4 v[44:47], v5, s[26:27] offset:512
    global_load_dwordx4 v[48:51], v5, s[26:27] offset:1024
    global_load_dwordx4 v[52:55], v5, s[26:27] offset:1536
    v_subrev_u32 v5, 0x4000, v5
    s_waitcnt vmcnt(12)
    global_load_dwordx4 v[24:27], v5, s[26:27] offset:0
    global_load_dwordx4 v[28:31], v5, s[26:27] offset:512
    global_load_dwordx4 v[32:35], v5, s[26:27] offset:1024
    global_load_dwordx4 v[36:39], v5, s[26:27] offset:1536
    v_mov_b32_dpp v104, v90 row_ror:8 row_mask:0xf bank_mask:0xf
    v_mov_b32_dpp v105, v91 row_ror:8 row_mask:0xf bank_mask:0xf
    v_mov_b32_dpp v106, v94 row_ror:8 row_mask:0xf bank_mask:0xf
    v_mov_b32_dpp v107, v95 row_ror:8 row_mask:0xf bank_mask:0xf
    v_mov_b32_dpp v108, v98 row_ror:8 row_mask:0xf bank_mask:0xf
    v_mov_b32_dpp v109, v99 row_ror:8 row_mask:0xf bank_mask:0xf
    v_mov_b32_dpp v110, v102 row_ror:8 row_mask:0xf bank_mask:0xf
    v_mov_b32_dpp v111, v103 row_ror:8 row_mask:0xf bank_mask:0xf
    v_mov_b32_dpp v90, v88 row_ror:8 row_mask:0xf bank_mask:0x3
    v_mov_b32_dpp v91, v89 row_ror:8 row_mask:0xf bank_mask:0x3
    v_mov_b32_dpp v94, v92 row_ror:8 row_mask:0xf bank_mask:0x3
    v_mov_b32_dpp v95, v93 row_ror:8 row_mask:0xf bank_mask:0x3
    v_mov_b32_dpp v98, v96 row_ror:8 row_mask:0xf bank_mask:0x3
    v_mov_b32_dpp v99, v97 row_ror:8 row_mask:0xf bank_mask:0x3
    v_mov_b32_dpp v102, v100 row_ror:8 row_mask:0xf bank_mask:0x3
    v_mov_b32_dpp v103, v101 row_ror:8 row_mask:0xf bank_mask:0x3
    v_mov_b32_dpp v88, v104 quad_perm:[0,1,2,3] row_mask:0xf bank_mask:0xc
    v_mov_b32_dpp v89, v105 quad_perm:[0,1,2,3] row_mask:0xf bank_mask:0xc
    v_mov_b32_dpp v92, v106 quad_perm:[0,1,2,3] row_mask:0xf bank_mask:0xc
    v_mov_b32_dpp v93, v107 quad_perm:[0,1,2,3] row_mask:0xf bank_mask:0xc
    v_mov_b32_dpp v96, v108 quad_perm:[0,1,2,3] row_mask:0xf bank_mask:0xc
    v_mov_b32_dpp v97, v109 quad_perm:[0,1,2,3] row_mask:0xf bank_mask:0xc
    v_mov_b32_dpp v100, v110 quad_perm:[0,1,2,3] row_mask:0xf bank_mask:0xc
    v_mov_b32_dpp v101, v111 quad_perm:[0,1,2,3] row_mask:0xf bank_mask:0xc
    v_perm_b32 v104, v92, v88, s44
    v_perm_b32 v105, v100, v96, s44
    v_perm_b32 v106, v94, v90, s44
    v_perm_b32 v107, v102, v98, s44
    v_perm_b32 v108, v92, v88, s45
    v_perm_b32 v109, v100, v96, s45
    v_perm_b32 v110, v94, v90, s45
    v_perm_b32 v111, v102, v98, s45
    v_perm_b32 v112, v93, v89, s44
    v_perm_b32 v113, v101, v97, s44
    v_perm_b32 v114, v95, v91, s44
    v_perm_b32 v115, v103, v99, s44
    v_perm_b32 v116, v93, v89, s45
    v_perm_b32 v117, v101, v97, s45
    v_perm_b32 v118, v95, v91, s45
    v_perm_b32 v119, v103, v99, s45
    s_waitcnt vmcnt(12)
    v_mov_b32_dpp v88, v74 row_ror:8 row_mask:0xf bank_mask:0xf
    v_mov_b32_dpp v89, v75 row_ror:8 row_mask:0xf bank_mask:0xf
    v_mov_b32_dpp v90, v78 row_ror:8 row_mask:0xf bank_mask:0xf
    v_mov_b32_dpp v91, v79 row_ror:8 row_mask:0xf bank_mask:0xf
    v_mov_b32_dpp v92, v82 row_ror:8 row_mask:0xf bank_mask:0xf
    v_mov_b32_dpp v93, v83 row_ror:8 row_mask:0xf bank_mask:0xf
    v_mov_b32_dpp v94, v86 row_ror:8 row_mask:0xf bank_mask:0xf
    v_mov_b32_dpp v95, v87 row_ror:8 row_mask:0xf bank_mask:0xf
    v_mov_b32_dpp v74, v72 row_ror:8 row_mask:0xf bank_mask:0x3
    v_mov_b32_dpp v75, v73 row_ror:8 row_mask:0xf bank_mask:0x3
    v_mov_b32_dpp v78, v76 row_ror:8 row_mask:0xf bank_mask:0x3
    v_mov_b32_dpp v79, v77 row_ror:8 row_mask:0xf bank_mask:0x3
    v_mov_b32_dpp v82, v80 row_ror:8 row_mask:0xf bank_mask:0x3
    v_mov_b32_dpp v83, v81 row_ror:8 row_mask:0xf bank_mask:0x3
    v_mov_b32_dpp v86, v84 row_ror:8 row_mask:0xf bank_mask:0x3
    v_mov_b32_dpp v87, v85 row_ror:8 row_mask:0xf bank_mask:0x3
    v_mov_b32_dpp v72, v88 quad_perm:[0,1,2,3] row_mask:0xf bank_mask:0xc
    v_mov_b32_dpp v73, v89 quad_perm:[0,1,2,3] row_mask:0xf bank_mask:0xc
    v_mov_b32_dpp v76, v90 quad_perm:[0,1,2,3] row_mask:0xf bank_mask:0xc
    v_mov_b32_dpp v77, v91 quad_perm:[0,1,2,3] row_mask:0xf bank_mask:0xc
    v_mov_b32_dpp v80, v92 quad_perm:[0,1,2,3] row_mask:0xf bank_mask:0xc
    v_mov_b32_dpp v81, v93 quad_perm:[0,1,2,3] row_mask:0xf bank_mask:0xc
    v_mov_b32_dpp v84, v94 quad_perm:[0,1,2,3] row_mask:0xf bank_mask:0xc
    v_mov_b32_dpp v85, v95 quad_perm:[0,1,2,3] row_mask:0xf bank_mask:0xc
    v_perm_b32 v88, v76, v72, s44
    v_perm_b32 v89, v84, v80, s44
    v_perm_b32 v90, v78, v74, s44
    v_perm_b32 v91, v86, v82, s44
    v_perm_b32 v92, v76, v72, s45
    v_perm_b32 v93, v84, v80, s45
    v_perm_b32 v94, v78, v74, s45
    v_perm_b32 v95, v86, v82, s45
    v_perm_b32 v96, v77, v73, s44
    v_perm_b32 v97, v85, v81, s44
    v_perm_b32 v98, v79, v75, s44
    v_perm_b32 v99, v87, v83, s44
    v_perm_b32 v100, v77, v73, s45
    v_perm_b32 v101, v85, v81, s45
    v_perm_b32 v102, v79, v75, s45
    v_perm_b32 v103, v87, v83, s45
    s_waitcnt vmcnt(8)
    v_mov_b32_dpp v72, v58 row_ror:8 row_mask:0xf bank_mask:0xf
    v_mov_b32_dpp v73, v59 row_ror:8 row_mask:0xf bank_mask:0xf
    v_mov_b32_dpp v74, v62 row_ror:8 row_mask:0xf bank_mask:0xf
    v_mov_b32_dpp v75, v63 row_ror:8 row_mask:0xf bank_mask:0xf
    v_mov_b32_dpp v76, v66 row_ror:8 row_mask:0xf bank_mask:0xf
    v_mov_b32_dpp v77, v67 row_ror:8 row_mask:0xf bank_mask:0xf
    v_mov_b32_dpp v78, v70 row_ror:8 row_mask:0xf bank_mask:0xf
    v_mov_b32_dpp v79, v71 row_ror:8 row_mask:0xf bank_mask:0xf
    v_mov_b32_dpp v58, v56 row_ror:8 row_mask:0xf bank_mask:0x3
    v_mov_b32_dpp v59, v57 row_ror:8 row_mask:0xf bank_mask:0x3
    v_mov_b32_dpp v62, v60 row_ror:8 row_mask:0xf bank_mask:0x3
    v_mov_b32_dpp v63, v61 row_ror:8 row_mask:0xf bank_mask:0x3
    v_mov_b32_dpp v66, v64 row_ror:8 row_mask:0xf bank_mask:0x3
    v_mov_b32_dpp v67, v65 row_ror:8 row_mask:0xf bank_mask:0x3
    v_mov_b32_dpp v70, v68 row_ror:8 row_mask:0xf bank_mask:0x3
    v_mov_b32_dpp v71, v69 row_ror:8 row_mask:0xf bank_mask:0x3
    v_mov_b32_dpp v56, v72 quad_perm:[0,1,2,3] row_mask:0xf bank_mask:0xc
    v_mov_b32_dpp v57, v73 quad_perm:[0,1,2,3] row_mask:0xf bank_mask:0xc
    v_mov_b32_dpp v60, v74 quad_perm:[0,1,2,3] row_mask:0xf bank_mask:0xc
    v_mov_b32_dpp v61, v75 quad_perm:[0,1,2,3] row_mask:0xf bank_mask:0xc
    v_mov_b32_dpp v64, v76 quad_perm:[0,1,2,3] row_mask:0xf bank_mask:0xc
    v_mov_b32_dpp v65, v77 quad_perm:[0,1,2,3] row_mask:0xf bank_mask:0xc
    v_mov_b32_dpp v68, v78 quad_perm:[0,1,2,3] row_mask:0xf bank_mask:0xc
    v_mov_b32_dpp v69, v79 quad_perm:[0,1,2,3] row_mask:0xf bank_mask:0xc
    v_perm_b32 v72, v60, v56, s44
    v_perm_b32 v73, v68, v64, s44
    v_perm_b32 v74, v62, v58, s44
    v_perm_b32 v75, v70, v66, s44
    v_perm_b32 v76, v60, v56, s45
    v_perm_b32 v77, v68, v64, s45
    v_perm_b32 v78, v62, v58, s45
    v_perm_b32 v79, v70, v66, s45
    v_perm_b32 v80, v61, v57, s44
    v_perm_b32 v81, v69, v65, s44
    v_perm_b32 v82, v63, v59, s44
    v_perm_b32 v83, v71, v67, s44
    v_perm_b32 v84, v61, v57, s45
    v_perm_b32 v85, v69, v65, s45
    v_perm_b32 v86, v63, v59, s45
    v_perm_b32 v87, v71, v67, s45
    s_waitcnt vmcnt(4)
    v_mov_b32_dpp v56, v42 row_ror:8 row_mask:0xf bank_mask:0xf
    v_mov_b32_dpp v57, v43 row_ror:8 row_mask:0xf bank_mask:0xf
    v_mov_b32_dpp v58, v46 row_ror:8 row_mask:0xf bank_mask:0xf
    v_mov_b32_dpp v59, v47 row_ror:8 row_mask:0xf bank_mask:0xf
    v_mov_b32_dpp v60, v50 row_ror:8 row_mask:0xf bank_mask:0xf
    v_mov_b32_dpp v61, v51 row_ror:8 row_mask:0xf bank_mask:0xf
    v_mov_b32_dpp v62, v54 row_ror:8 row_mask:0xf bank_mask:0xf
    v_mov_b32_dpp v63, v55 row_ror:8 row_mask:0xf bank_mask:0xf
    v_mov_b32_dpp v42, v40 row_ror:8 row_mask:0xf bank_mask:0x3
    v_mov_b32_dpp v43, v41 row_ror:8 row_mask:0xf bank_mask:0x3
    v_mov_b32_dpp v46, v44 row_ror:8 row_mask:0xf bank_mask:0x3
    v_mov_b32_dpp v47, v45 row_ror:8 row_mask:0xf bank_mask:0x3
    v_mov_b32_dpp v50, v48 row_ror:8 row_mask:0xf bank_mask:0x3
    v_mov_b32_dpp v51, v49 row_ror:8 row_mask:0xf bank_mask:0x3
    v_mov_b32_dpp v54, v52 row_ror:8 row_mask:0xf bank_mask:0x3
    v_mov_b32_dpp v55, v53 row_ror:8 row_mask:0xf bank_mask:0x3
    v_mov_b32_dpp v40, v56 quad_perm:[0,1,2,3] row_mask:0xf bank_mask:0xc
    v_mov_b32_dpp v41, v57 quad_perm:[0,1,2,3] row_mask:0xf bank_mask:0xc
    v_mov_b32_dpp v44, v58 quad_perm:[0,1,2,3] row_mask:0xf bank_mask:0xc
    v_mov_b32_dpp v45, v59 quad_perm:[0,1,2,3] row_mask:0xf bank_mask:0xc
    v_mov_b32_dpp v48, v60 quad_perm:[0,1,2,3] row_mask:0xf bank_mask:0xc
    v_mov_b32_dpp v49, v61 quad_perm:[0,1,2,3] row_mask:0xf bank_mask:0xc
    v_mov_b32_dpp v52, v62 quad_perm:[0,1,2,3] row_mask:0xf bank_mask:0xc
    v_mov_b32_dpp v53, v63 quad_perm:[0,1,2,3] row_mask:0xf bank_mask:0xc
    v_perm_b32 v56, v44, v40, s44
    v_perm_b32 v57, v52, v48, s44
    v_perm_b32 v58, v46, v42, s44
    v_perm_b32 v59, v54, v50, s44
    v_perm_b32 v60, v44, v40, s45
    v_perm_b32 v61, v52, v48, s45
    v_perm_b32 v62, v46, v42, s45
    v_perm_b32 v63, v54, v50, s45
    v_perm_b32 v64, v45, v41, s44
    v_perm_b32 v65, v53, v49, s44
    v_perm_b32 v66, v47, v43, s44
    v_perm_b32 v67, v55, v51, s44
    v_perm_b32 v68, v45, v41, s45
    v_perm_b32 v69, v53, v49, s45
    v_perm_b32 v70, v47, v43, s45
    v_perm_b32 v71, v55, v51, s45
    s_waitcnt vmcnt(0)
    v_mov_b32_dpp v40, v26 row_ror:8 row_mask:0xf bank_mask:0xf
    v_mov_b32_dpp v41, v27 row_ror:8 row_mask:0xf bank_mask:0xf
    v_mov_b32_dpp v42, v30 row_ror:8 row_mask:0xf bank_mask:0xf
    v_mov_b32_dpp v43, v31 row_ror:8 row_mask:0xf bank_mask:0xf
    v_mov_b32_dpp v44, v34 row_ror:8 row_mask:0xf bank_mask:0xf
    v_mov_b32_dpp v45, v35 row_ror:8 row_mask:0xf bank_mask:0xf
    v_mov_b32_dpp v46, v38 row_ror:8 row_mask:0xf bank_mask:0xf
    v_mov_b32_dpp v47, v39 row_ror:8 row_mask:0xf bank_mask:0xf
    v_mov_b32_dpp v26, v24 row_ror:8 row_mask:0xf bank_mask:0x3
    v_mov_b32_dpp v27, v25 row_ror:8 row_mask:0xf bank_mask:0x3
    v_mov_b32_dpp v30, v28 row_ror:8 row_mask:0xf bank_mask:0x3
    v_mov_b32_dpp v31, v29 row_ror:8 row_mask:0xf bank_mask:0x3
    v_mov_b32_dpp v34, v32 row_ror:8 row_mask:0xf bank_mask:0x3
    v_mov_b32_dpp v35, v33 row_ror:8 row_mask:0xf bank_mask:0x3
    v_mov_b32_dpp v38, v36 row_ror:8 row_mask:0xf bank_mask:0x3
    v_mov_b32_dpp v39, v37 row_ror:8 row_mask:0xf bank_mask:0x3
    v_mov_b32_dpp v24, v40 quad_perm:[0,1,2,3] row_mask:0xf bank_mask:0xc
    v_mov_b32_dpp v25, v41 quad_perm:[0,1,2,3] row_mask:0xf bank_mask:0xc
    v_mov_b32_dpp v28, v42 quad_perm:[0,1,2,3] row_mask:0xf bank_mask:0xc
    v_mov_b32_dpp v29, v43 quad_perm:[0,1,2,3] row_mask:0xf bank_mask:0xc
    v_mov_b32_dpp v32, v44 quad_perm:[0,1,2,3] row_mask:0xf bank_mask:0xc
    v_mov_b32_dpp v33, v45 quad_perm:[0,1,2,3] row_mask:0xf bank_mask:0xc
    v_mov_b32_dpp v36, v46 quad_perm:[0,1,2,3] row_mask:0xf bank_mask:0xc
    v_mov_b32_dpp v37, v47 quad_perm:[0,1,2,3] row_mask:0xf bank_mask:0xc
    v_perm_b32 v40, v28, v24, s44
    v_perm_b32 v41, v36, v32, s44
    v_perm_b32 v42, v30, v26, s44
    v_perm_b32 v43, v38, v34, s44
    v_perm_b32 v44, v28, v24, s45
    v_perm_b32 v45, v36, v32, s45
    v_perm_b32 v46, v30, v26, s45
    v_perm_b32 v47, v38, v34, s45
    v_perm_b32 v48, v29, v25, s44
    v_perm_b32 v49, v37, v33, s44
    v_perm_b32 v50, v31, v27, s44
    v_perm_b32 v51, v39, v35, s44
    v_perm_b32 v52, v29, v25, s45
    v_perm_b32 v53, v37, v33, s45
    v_perm_b32 v54, v31, v27, s45
    v_perm_b32 v55, v39, v35, s45
gm_wskip:
    s_waitcnt vmcnt(0)
    s_mul_i32 s41, s2, 625
    s_add_u32 s52, s41, 640
    s_add_u32 s41, s41, 15
    s_lshr_b32 s41, s41, 4
    s_lshr_b32 s52, s52, 4
    s_mov_b32 s12, s56
    s_and_b32 s13, s57, 0xffff
    s_lshl_b32 s14, s52, 11
    s_mov_b32 s15, 0x20000
    s_mul_i32 s42, s17, 15360
    s_add_u32 s42, s42, 40960
    s_lshl_b32 s43, s17, 1
    s_sub_u32 s43, s43, 1
    v_lshlrev_b32 v6, 2, v3
    v_add_u32 v11, 0, v3
    v_mul_u32_u24 v10, 21846, v11
    v_lshrrev_b32 v10, 16, v10
    v_lshl_add_u32 v34, v10, 2, s42
    v_mad_i32_i24 v10, v10, -3, v11
    v_lshlrev_b32 v30, 4, v10
    v_add_u32 v11, 64, v3
    v_mul_u32_u24 v10, 21846, v11
    v_lshrrev_b32 v10, 16, v10
    v_lshl_add_u32 v35, v10, 2, s42
    v_mad_i32_i24 v10, v10, -3, v11
    v_lshlrev_b32 v31, 4, v10
    v_add_u32 v11, 128, v3
    v_mul_u32_u24 v10, 21846, v11
    v_lshrrev_b32 v10, 16, v10
    v_lshl_add_u32 v36, v10, 2, s42
    v_mad_i32_i24 v10, v10, -3, v11
    v_lshlrev_b32 v32, 4, v10
gm_sp1:
    v_mov_b32 v11, 0
    ds_read_b32 v11, v11 offset:308
    s_waitcnt lgkmcnt(0)
    v_readfirstlane_b32 s62, v11
    s_cmp_ge_u32 s62, 1
    s_cbranch_scc1 gm_sp1x
    s_sleep 1
    s_branch gm_sp1
gm_sp1x:
    buffer_load_dword v4, v12, s[8:11], s22 offen offset:60 sc1
    s_waitcnt vmcnt(0)
gm_pass:
    v_lshrrev_b32 v8, 16, v4
    v_subrev_u32 v8, s24, v8
    v_med3_i32 v8, v8, 0, s20
    v_mov_b32 v9, v8
    v_and_b32 v12, 1, v0
    v_and_b32 v14, 0xffff, v4
    v_add_u32_dpp v9, v9, v9 row_shr:2 row_mask:0xf bank_mask:0xf
    v_add3_u32 v14, v14, v12, s24
    s_nop 0
    v_add_u32_dpp v9, v9, v9 row_shr:4 row_mask:0xf bank_mask:0xf
    v_mad_u32_u24 v14, v14, 40, v13
    s_nop 0
    v_add_u32_dpp v9, v9, v9 row_shr:8 row_mask:0xf bank_mask:0xf
    v_sub_u32 v15, v8, v12
    s_nop 0
    v_add_u32_dpp v9, v9, v9 row_bcast:15 row_mask:0xa bank_mask:0xf
    s_nop 0
    s_nop 0
    v_add_u32_dpp v9, v9, v9 row_bcast:31 row_mask:0xc bank_mask:0xf
    s_nop 0
    s_nop 0
    v_readlane_b32 s47, v9, 63
    v_sub_u32 v16, v9, v15
    v_lshl_add_u32 v16, v16, 2, s42
    v_cmpx_lt_i32 vcc, 0, v15
    s_cbranch_execz gm_tb_done
    ds_write_b32 v16, v14 offset:0
    v_add_u32 v14, 80, v14
    v_cmpx_lt_i32 vcc, 2, v15
    s_cbranch_execz gm_tb_done
    ds_write_b32 v16, v14 offset:8
    v_add_u32 v14, 80, v14
    v_cmpx_lt_i32 vcc, 4, v15
    s_cbranch_execz gm_tb_done
    ds_write_b32 v16, v14 offset:16
    v_add_u32 v14, 80, v14
    v_cmpx_lt_i32 vcc, 6, v15
    s_cbranch_execz gm_tb_done
    ds_write_b32 v16, v14 offset:24
    v_add_u32 v14, 80, v14
    v_cmpx_lt_i32 vcc, 8, v15
    s_cbranch_execz gm_tb_done
    ds_write_b32 v16, v14 offset:32
    v_add_u32 v14, 80, v14
    v_cmpx_lt_i32 vcc, 10, v15
    s_cbranch_execz gm_tb_done
    ds_write_b32 v16, v14 offset:40
    v_add_u32 v14, 80, v14
    v_cmpx_lt_i32 vcc, 12, v15
    s_cbranch_execz gm_tb_done
    ds_write_b32 v16, v14 offset:48
    v_add_u32 v14, 80, v14
    v_cmpx_lt_i32 vcc, 14, v15
    s_cbranch_execz gm_tb_done
    ds_write_b32 v16, v14 offset:56
    v_add_u32 v14, 80, v14
    v_cmpx_lt_i32 vcc, 16, v15
    s_cbranch_execz gm_tb_done
    ds_write_b32 v16, v14 offset:64
    v_add_u32 v14, 80, v14
    v_cmpx_lt_i32 vcc, 18, v15
    s_cbranch_execz gm_tb_done
    ds_write_b32 v16, v14 offset:72
gm_tb_done:
    s_mov_b64 exec, -1
    s_mul_i32 s47, s47, 3
    v_mov_b32 v17, 0
    ds_read_b32 v29, v17 offset:456
    s_and_b32 s62, s2, 15
    s_lshl_b32 s62, s62, 7
    s_add_u32 s62, s62, 11730944
    v_mov_b32 v28, s62
    global_load_dword v27, v28, s[54:55] sc1
    s_barrier
    ds_read_b32 v15, v6 offset:384
    ds_read_b32 v17, v17 offset:272
    v_mov_b32 v11, v34
    v_mov_b32 v10, v35
    v_mov_b32 v14, v36
    s_waitcnt lgkmcnt(1)
    v_add_u32_dpp v15, v15, v15 row_shr:1 row_mask:0xf bank_mask:0xf
    s_nop 1
    v_add_u32_dpp v15, v15, v15 row_shr:2 row_mask:0xf bank_mask:0xf
    s_nop 1
    v_add_u32_dpp v15, v15, v15 row_shr:4 row_mask:0xf bank_mask:0xf
    s_waitcnt lgkmcnt(0)
    v_readfirstlane_b32 s21, v17
    v_readlane_b32 s23, v15, 7
    v_readlane_b32 s46, v15, s43
    s_cmp_gt_u32 s23, 773
    s_cbranch_scc1 gm_ovf
    s_cmp_eq_u32 s17, 0
    s_cmov_b32 s46, 0
    s_mul_i32 s46, s46, 48
    s_add_u32 m0, s46, 3776
    s_mov_b32 s63, 0x100000
gm_ep:
    s_waitcnt vmcnt(0)
    v_sub_u32 v27, v27, v29
    v_lshrrev_b32 v27, 16, v27
    v_cmp_eq_u32 vcc, 2, v27
    s_cbranch_vccnz gm_go2
    s_and_b32 s62, s63, 31
    s_sub_u32 s63, s63, 1
    s_cmp_eq_u32 s62, 1
    s_cbranch_scc1 gm_epd
    s_sleep 6
    global_load_dword v27, v28, s[54:55] sc1
    s_branch gm_ep
gm_epd:
    s_and_b32 s62, s2, 15
    s_lshl_b32 s62, s62, 7
    s_add_u32 s62, s62, 11730944
    v_mov_b32 v27, s62
    v_lshlrev_b32 v28, 6, v0
    v_and_b32 v28, 0xc0, v28
    s_mov_b32 s63, 0x100000
mn_poll2dem:
    s_sub_u32 s63, s63, 1
    s_cbranch_scc1 mn_poll2dex
    global_load_dword v29, v28, s[60:61] sc1
    s_waitcnt vmcnt(0)
    v_add_u32_dpp v29, v29, v29 quad_perm:[2,3,0,1] row_mask:0xf bank_mask:0xf
    s_sleep 8
    v_readlane_b32 s62, v29, 1
    s_cmp_lt_u32 s62, 125
    s_cbranch_scc1 mn_poll2dem
mn_poll2dex:
gm_go2:
gm_raw:
    ds_read_b32 v18, v11 offset:0
    ds_read_b32 v19, v10 offset:0
    ds_read_b32 v20, v14 offset:0
    ds_read_b32 v21, v11 offset:256
    ds_read_b32 v22, v10 offset:256
    ds_read_b32 v23, v14 offset:256
    ds_read_b32 v24, v11 offset:512
    ds_read_b32 v25, v10 offset:512
    ds_read_b32 v26, v14 offset:512
    v_cmpx_gt_i32 vcc, s47, v3
    s_cbranch_execz gm_raw_done
    s_waitcnt lgkmcnt(8)
    v_add_u32 v18, v18, v30
    buffer_load_dwordx4 v18, s[8:11], 0 offen sc1 lds
    s_add_u32 m0, m0, 1024
    s_sub_i32 s47, s47, 64
    v_cmpx_gt_i32 vcc, s47, v3
    s_cbranch_execz gm_raw_done
    s_waitcnt lgkmcnt(7)
    v_add_u32 v19, v19, v31
    buffer_load_dwordx4 v19, s[8:11], 0 offen sc1 lds
    s_add_u32 m0, m0, 1024
    s_sub_i32 s47, s47, 64
    v_cmpx_gt_i32 vcc, s47, v3
    s_cbranch_execz gm_raw_done
    s_waitcnt lgkmcnt(6)
    v_add_u32 v20, v20, v32
    buffer_load_dwordx4 v20, s[8:11], 0 offen sc1 lds
    s_add_u32 m0, m0, 1024
    s_sub_i32 s47, s47, 64
    v_cmpx_gt_i32 vcc, s47, v3
    s_cbranch_execz gm_raw_done
    s_waitcnt lgkmcnt(5)
    v_add_u32 v21, v21, v30
    buffer_load_dwordx4 v21, s[8:11], 0 offen sc1 lds
    s_add_u32 m0, m0, 1024
    s_sub_i32 s47, s47, 64
    v_cmpx_gt_i32 vcc, s47, v3
    s_cbranch_execz gm_raw_done
    s_waitcnt lgkmcnt(4)
    v_add_u32 v22, v22, v31
    buffer_load_dwordx4 v22, s[8:11], 0 offen sc1 lds
    s_add_u32 m0, m0, 1024
    s_sub_i32 s47, s47, 64
    v_cmpx_gt_i32 vcc, s47, v3
    s_cbranch_execz gm_raw_done
    s_waitcnt lgkmcnt(3)
    v_add_u32 v23, v23, v32
    buffer_load_dwordx4 v23, s[8:11], 0 offen sc1 lds
    s_add_u32 m0, m0, 1024
    s_sub_i32 s47, s47, 64
    v_cmpx_gt_i32 vcc, s47, v3
    s_cbranch_execz gm_raw_done
    s_waitcnt lgkmcnt(2)
    v_add_u32 v24, v24, v30
    buffer_load_dwordx4 v24, s[8:11], 0 offen sc1 lds
    s_add_u32 m0, m0, 1024
    s_sub_i32 s47, s47, 64
    v_cmpx_gt_i32 vcc, s47, v3
    s_cbranch_execz gm_raw_done
    s_waitcnt lgkmcnt(1)
    v_add_u32 v25, v25, v31
    buffer_load_dwordx4 v25, s[8:11], 0 offen sc1 lds
    s_add_u32 m0, m0, 1024
    s_sub_i32 s47, s47, 64
    v_cmpx_gt_i32 vcc, s47, v3
    s_cbranch_execz gm_raw_done
    s_waitcnt lgkmcnt(0)
    v_add_u32 v26, v26, v32
    buffer_load_dwordx4 v26, s[8:11], 0 offen sc1 lds
    s_add_u32 m0, m0, 1024
    s_sub_i32 s47, s47, 64
    v_add_u32 v11, 768, v11
    v_add_u32 v10, 768, v10
    v_add_u32 v14, 768, v14
    s_branch gm_raw
gm_raw_done:
    s_mov_b64 exec, -1
    s_barrier
    s_waitcnt vmcnt(0) lgkmcnt(0)
    s_barrier
    s_cmp_lg_u32 s21, 0
    s_cbranch_scc1 gm_next
    s_cmp_ge_u32 s2, 125
    s_cbranch_scc1 gm_wdone
    global_load_dwordx4 v[88:91], v5, s[26:27] offset:0
    global_load_dwordx4 v[92:95], v5, s[26:27] offset:512
    global_load_dwordx4 v[96:99], v5, s[26:27] offset:1024
    global_load_dwordx4 v[100:103], v5, s[26:27] offset:1536
    v_subrev_u32 v5, 0x4000, v5
    s_waitcnt vmcnt(0)
    global_load_dwordx4 v[72:75], v5, s[26:27] offset:0
    global_load_dwordx4 v[76:79], v5, s[26:27] offset:512
    global_load_dwordx4 v[80:83], v5, s[26:27] offset:1024
    global_load_dwordx4 v[84:87], v5, s[26:27] offset:1536
    v_subrev_u32 v5, 0x4000, v5
    v_mov_b32_dpp v104, v90 row_ror:8 row_mask:0xf bank_mask:0xf
    v_mov_b32_dpp v105, v91 row_ror:8 row_mask:0xf bank_mask:0xf
    v_mov_b32_dpp v106, v94 row_ror:8 row_mask:0xf bank_mask:0xf
    v_mov_b32_dpp v107, v95 row_ror:8 row_mask:0xf bank_mask:0xf
    v_mov_b32_dpp v108, v98 row_ror:8 row_mask:0xf bank_mask:0xf
    v_mov_b32_dpp v109, v99 row_ror:8 row_mask:0xf bank_mask:0xf
    v_mov_b32_dpp v110, v102 row_ror:8 row_mask:0xf bank_mask:0xf
    v_mov_b32_dpp v111, v103 row_ror:8 row_mask:0xf bank_mask:0xf
    v_mov_b32_dpp v90, v88 row_ror:8 row_mask:0xf bank_mask:0x3
    v_mov_b32_dpp v91, v89 row_ror:8 row_mask:0xf bank_mask:0x3
    v_mov_b32_dpp v94, v92 row_ror:8 row_mask:0xf bank_mask:0x3
    v_mov_b32_dpp v95, v93 row_ror:8 row_mask:0xf bank_mask:0x3
    v_mov_b32_dpp v98, v96 row_ror:8 row_mask:0xf bank_mask:0x3
    v_mov_b32_dpp v99, v97 row_ror:8 row_mask:0xf bank_mask:0x3
    v_mov_b32_dpp v102, v100 row_ror:8 row_mask:0xf bank_mask:0x3
    v_mov_b32_dpp v103, v101 row_ror:8 row_mask:0xf bank_mask:0x3
    v_mov_b32_dpp v88, v104 quad_perm:[0,1,2,3] row_mask:0xf bank_mask:0xc
    v_mov_b32_dpp v89, v105 quad_perm:[0,1,2,3] row_mask:0xf bank_mask:0xc
    v_mov_b32_dpp v92, v106 quad_perm:[0,1,2,3] row_mask:0xf bank_mask:0xc
    v_mov_b32_dpp v93, v107 quad_perm:[0,1,2,3] row_mask:0xf bank_mask:0xc
    v_mov_b32_dpp v96, v108 quad_perm:[0,1,2,3] row_mask:0xf bank_mask:0xc
    v_mov_b32_dpp v97, v109 quad_perm:[0,1,2,3] row_mask:0xf bank_mask:0xc
    v_mov_b32_dpp v100, v110 quad_perm:[0,1,2,3] row_mask:0xf bank_mask:0xc
    v_mov_b32_dpp v101, v111 quad_perm:[0,1,2,3] row_mask:0xf bank_mask:0xc
    v_perm_b32 v104, v92, v88, s44
    v_perm_b32 v105, v100, v96, s44
    v_perm_b32 v106, v94, v90, s44
    v_perm_b32 v107, v102, v98, s44
    v_perm_b32 v108, v92, v88, s45
    v_perm_b32 v109, v100, v96, s45
    v_perm_b32 v110, v94, v90, s45
    v_perm_b32 v111, v102, v98, s45
    v_perm_b32 v112, v93, v89, s44
    v_perm_b32 v113, v101, v97, s44
    v_perm_b32 v114, v95, v91, s44
    v_perm_b32 v115, v103, v99, s44
    v_perm_b32 v116, v93, v89, s45
    v_perm_b32 v117, v101, v97, s45
    v_perm_b32 v118, v95, v91, s45
    v_perm_b32 v119, v103, v99, s45
    s_waitcnt vmcnt(0)
    global_load_dwordx4 v[56:59], v5, s[26:27] offset:0
    global_load_dwordx4 v[60:63], v5, s[26:27] offset:512
    global_load_dwordx4 v[64:67], v5, s[26:27] offset:1024
    global_load_dwordx4 v[68:71], v5, s[26:27] offset:1536
    v_subrev_u32 v5, 0x4000, v5
    v_mov_b32_dpp v88, v74 row_ror:8 row_mask:0xf bank_mask:0xf
    v_mov_b32_dpp v89, v75 row_ror:8 row_mask:0xf bank_mask:0xf
    v_mov_b32_dpp v90, v78 row_ror:8 row_mask:0xf bank_mask:0xf
    v_mov_b32_dpp v91, v79 row_ror:8 row_mask:0xf bank_mask:0xf
    v_mov_b32_dpp v92, v82 row_ror:8 row_mask:0xf bank_mask:0xf
    v_mov_b32_dpp v93, v83 row_ror:8 row_mask:0xf bank_mask:0xf
    v_mov_b32_dpp v94, v86 row_ror:8 row_mask:0xf bank_mask:0xf
    v_mov_b32_dpp v95, v87 row_ror:8 row_mask:0xf bank_mask:0xf
    v_mov_b32_dpp v74, v72 row_ror:8 row_mask:0xf bank_mask:0x3
    v_mov_b32_dpp v75, v73 row_ror:8 row_mask:0xf bank_mask:0x3
    v_mov_b32_dpp v78, v76 row_ror:8 row_mask:0xf bank_mask:0x3
    v_mov_b32_dpp v79, v77 row_ror:8 row_mask:0xf bank_mask:0x3
    v_mov_b32_dpp v82, v80 row_ror:8 row_mask:0xf bank_mask:0x3
    v_mov_b32_dpp v83, v81 row_ror:8 row_mask:0xf bank_mask:0x3
    v_mov_b32_dpp v86, v84 row_ror:8 row_mask:0xf bank_mask:0x3
    v_mov_b32_dpp v87, v85 row_ror:8 row_mask:0xf bank_mask:0x3
    v_mov_b32_dpp v72, v88 quad_perm:[0,1,2,3] row_mask:0xf bank_mask:0xc
    v_mov_b32_dpp v73, v89 quad_perm:[0,1,2,3] row_mask:0xf bank_mask:0xc
    v_mov_b32_dpp v76, v90 quad_perm:[0,1,2,3] row_mask:0xf bank_mask:0xc
    v_mov_b32_dpp v77, v91 quad_perm:[0,1,2,3] row_mask:0xf bank_mask:0xc
    v_mov_b32_dpp v80, v92 quad_perm:[0,1,2,3] row_mask:0xf bank_mask:0xc
    v_mov_b32_dpp v81, v93 quad_perm:[0,1,2,3] row_mask:0xf bank_mask:0xc
    v_mov_b32_dpp v84, v94 quad_perm:[0,1,2,3] row_mask:0xf bank_mask:0xc
    v_mov_b32_dpp v85, v95 quad_perm:[0,1,2,3] row_mask:0xf bank_mask:0xc
    v_perm_b32 v88, v76, v72, s44
    v_perm_b32 v89, v84, v80, s44
    v_perm_b32 v90, v78, v74, s44
    v_perm_b32 v91, v86, v82, s44
    v_perm_b32 v92, v76, v72, s45
    v_perm_b32 v93, v84, v80, s45
    v_perm_b32 v94, v78, v74, s45
    v_perm_b32 v95, v86, v82, s45
    v_perm_b32 v96, v77, v73, s44
    v_perm_b32 v97, v85, v81, s44
    v_perm_b32 v98, v79, v75, s44
    v_perm_b32 v99, v87, v83, s44
    v_perm_b32 v100, v77, v73, s45
    v_perm_b32 v101, v85, v81, s45
    v_perm_b32 v102, v79, v75, s45
    v_perm_b32 v103, v87, v83, s45
    s_waitcnt vmcnt(0)
    global_load_dwordx4 v[40:43], v5, s[26:27] offset:0
    global_load_dwordx4 v[44:47], v5, s[26:27] offset:512
    global_load_dwordx4 v[48:51], v5, s[26:27] offset:1024
    global_load_dwordx4 v[52:55], v5, s[26:27] offset:1536
    v_subrev_u32 v5, 0x4000, v5
    v_mov_b32_dpp v72, v58 row_ror:8 row_mask:0xf bank_mask:0xf
    v_mov_b32_dpp v73, v59 row_ror:8 row_mask:0xf bank_mask:0xf
    v_mov_b32_dpp v74, v62 row_ror:8 row_mask:0xf bank_mask:0xf
    v_mov_b32_dpp v75, v63 row_ror:8 row_mask:0xf bank_mask:0xf
    v_mov_b32_dpp v76, v66 row_ror:8 row_mask:0xf bank_mask:0xf
    v_mov_b32_dpp v77, v67 row_ror:8 row_mask:0xf bank_mask:0xf
    v_mov_b32_dpp v78, v70 row_ror:8 row_mask:0xf bank_mask:0xf
    v_mov_b32_dpp v79, v71 row_ror:8 row_mask:0xf bank_mask:0xf
    v_mov_b32_dpp v58, v56 row_ror:8 row_mask:0xf bank_mask:0x3
    v_mov_b32_dpp v59, v57 row_ror:8 row_mask:0xf bank_mask:0x3
    v_mov_b32_dpp v62, v60 row_ror:8 row_mask:0xf bank_mask:0x3
    v_mov_b32_dpp v63, v61 row_ror:8 row_mask:0xf bank_mask:0x3
    v_mov_b32_dpp v66, v64 row_ror:8 row_mask:0xf bank_mask:0x3
    v_mov_b32_dpp v67, v65 row_ror:8 row_mask:0xf bank_mask:0x3
    v_mov_b32_dpp v70, v68 row_ror:8 row_mask:0xf bank_mask:0x3
    v_mov_b32_dpp v71, v69 row_ror:8 row_mask:0xf bank_mask:0x3
    v_mov_b32_dpp v56, v72 quad_perm:[0,1,2,3] row_mask:0xf bank_mask:0xc
    v_mov_b32_dpp v57, v73 quad_perm:[0,1,2,3] row_mask:0xf bank_mask:0xc
    v_mov_b32_dpp v60, v74 quad_perm:[0,1,2,3] row_mask:0xf bank_mask:0xc
    v_mov_b32_dpp v61, v75 quad_perm:[0,1,2,3] row_mask:0xf bank_mask:0xc
    v_mov_b32_dpp v64, v76 quad_perm:[0,1,2,3] row_mask:0xf bank_mask:0xc
    v_mov_b32_dpp v65, v77 quad_perm:[0,1,2,3] row_mask:0xf bank_mask:0xc
    v_mov_b32_dpp v68, v78 quad_perm:[0,1,2,3] row_mask:0xf bank_mask:0xc
    v_mov_b32_dpp v69, v79 quad_perm:[0,1,2,3] row_mask:0xf bank_mask:0xc
    v_perm_b32 v72, v60, v56, s44
    v_perm_b32 v73, v68, v64, s44
    v_perm_b32 v74, v62, v58, s44
    v_perm_b32 v75, v70, v66, s44
    v_perm_b32 v76, v60, v56, s45
    v_perm_b32 v77, v68, v64, s45
    v_perm_b32 v78, v62, v58, s45
    v_perm_b32 v79, v70, v66, s45
    v_perm_b32 v80, v61, v57, s44
    v_perm_b32 v81, v69, v65, s44
    v_perm_b32 v82, v63, v59, s44
    v_perm_b32 v83, v71, v67, s44
    v_perm_b32 v84, v61, v57, s45
    v_perm_b32 v85, v69, v65, s45
    v_perm_b32 v86, v63, v59, s45
    v_perm_b32 v87, v71, v67, s45
    s_waitcnt vmcnt(0)
    global_load_dwordx4 v[24:27], v5, s[26:27] offset:0
    global_load_dwordx4 v[28:31], v5, s[26:27] offset:512
    global_load_dwordx4 v[32:35], v5, s[26:27] offset:1024
    global_load_dwordx4 v[36:39], v5, s[26:27] offset:1536
    v_mov_b32_dpp v56, v42 row_ror:8 row_mask:0xf bank_mask:0xf
    v_mov_b32_dpp v57, v43 row_ror:8 row_mask:0xf bank_mask:0xf
    v_mov_b32_dpp v58, v46 row_ror:8 row_mask:0xf bank_mask:0xf
    v_mov_b32_dpp v59, v47 row_ror:8 row_mask:0xf bank_mask:0xf
    v_mov_b32_dpp v60, v50 row_ror:8 row_mask:0xf bank_mask:0xf
    v_mov_b32_dpp v61, v51 row_ror:8 row_mask:0xf bank_mask:0xf
    v_mov_b32_dpp v62, v54 row_ror:8 row_mask:0xf bank_mask:0xf
    v_mov_b32_dpp v63, v55 row_ror:8 row_mask:0xf bank_mask:0xf
    v_mov_b32_dpp v42, v40 row_ror:8 row_mask:0xf bank_mask:0x3
    v_mov_b32_dpp v43, v41 row_ror:8 row_mask:0xf bank_mask:0x3
    v_mov_b32_dpp v46, v44 row_ror:8 row_mask:0xf bank_mask:0x3
    v_mov_b32_dpp v47, v45 row_ror:8 row_mask:0xf bank_mask:0x3
    v_mov_b32_dpp v50, v48 row_ror:8 row_mask:0xf bank_mask:0x3
    v_mov_b32_dpp v51, v49 row_ror:8 row_mask:0xf bank_mask:0x3
    v_mov_b32_dpp v54, v52 row_ror:8 row_mask:0xf bank_mask:0x3
    v_mov_b32_dpp v55, v53 row_ror:8 row_mask:0xf bank_mask:0x3
    v_mov_b32_dpp v40, v56 quad_perm:[0,1,2,3] row_mask:0xf bank_mask:0xc
    v_mov_b32_dpp v41, v57 quad_perm:[0,1,2,3] row_mask:0xf bank_mask:0xc
    v_mov_b32_dpp v44, v58 quad_perm:[0,1,2,3] row_mask:0xf bank_mask:0xc
    v_mov_b32_dpp v45, v59 quad_perm:[0,1,2,3] row_mask:0xf bank_mask:0xc
    v_mov_b32_dpp v48, v60 quad_perm:[0,1,2,3] row_mask:0xf bank_mask:0xc
    v_mov_b32_dpp v49, v61 quad_perm:[0,1,2,3] row_mask:0xf bank_mask:0xc
    v_mov_b32_dpp v52, v62 quad_perm:[0,1,2,3] row_mask:0xf bank_mask:0xc
    v_mov_b32_dpp v53, v63 quad_perm:[0,1,2,3] row_mask:0xf bank_mask:0xc
    v_perm_b32 v56, v44, v40, s44
    v_perm_b32 v57, v52, v48, s44
    v_perm_b32 v58, v46, v42, s44
    v_perm_b32 v59, v54, v50, s44
    v_perm_b32 v60, v44, v40, s45
    v_perm_b32 v61, v52, v48, s45
    v_perm_b32 v62, v46, v42, s45
    v_perm_b32 v63, v54, v50, s45
    v_perm_b32 v64, v45, v41, s44
    v_perm_b32 v65, v53, v49, s44
    v_perm_b32 v66, v47, v43, s44
    v_perm_b32 v67, v55, v51, s44
    v_perm_b32 v68, v45, v41, s45
    v_perm_b32 v69, v53, v49, s45
    v_perm_b32 v70, v47, v43, s45
    v_perm_b32 v71, v55, v51, s45
    s_waitcnt vmcnt(0)
    v_mov_b32_dpp v40, v26 row_ror:8 row_mask:0xf bank_mask:0xf
    v_mov_b32_dpp v41, v27 row_ror:8 row_mask:0xf bank_mask:0xf
    v_mov_b32_dpp v42, v30 row_ror:8 row_mask:0xf bank_mask:0xf
    v_mov_b32_dpp v43, v31 row_ror:8 row_mask:0xf bank_mask:0xf
    v_mov_b32_dpp v44, v34 row_ror:8 row_mask:0xf bank_mask:0xf
    v_mov_b32_dpp v45, v35 row_ror:8 row_mask:0xf bank_mask:0xf
    v_mov_b32_dpp v46, v38 row_ror:8 row_mask:0xf bank_mask:0xf
    v_mov_b32_dpp v47, v39 row_ror:8 row_mask:0xf bank_mask:0xf
    v_mov_b32_dpp v26, v24 row_ror:8 row_mask:0xf bank_mask:0x3
    v_mov_b32_dpp v27, v25 row_ror:8 row_mask:0xf bank_mask:0x3
    v_mov_b32_dpp v30, v28 row_ror:8 row_mask:0xf bank_mask:0x3
    v_mov_b32_dpp v31, v29 row_ror:8 row_mask:0xf bank_mask:0x3
    v_mov_b32_dpp v34, v32 row_ror:8 row_mask:0xf bank_mask:0x3
    v_mov_b32_dpp v35, v33 row_ror:8 row_mask:0xf bank_mask:0x3
    v_mov_b32_dpp v38, v36 row_ror:8 row_mask:0xf bank_mask:0x3
    v_mov_b32_dpp v39, v37 row_ror:8 row_mask:0xf bank_mask:0x3
    v_mov_b32_dpp v24, v40 quad_perm:[0,1,2,3] row_mask:0xf bank_mask:0xc
    v_mov_b32_dpp v25, v41 quad_perm:[0,1,2,3] row_mask:0xf bank_mask:0xc
    v_mov_b32_dpp v28, v42 quad_perm:[0,1,2,3] row_mask:0xf bank_mask:0xc
    v_mov_b32_dpp v29, v43 quad_perm:[0,1,2,3] row_mask:0xf bank_mask:0xc
    v_mov_b32_dpp v32, v44 quad_perm:[0,1,2,3] row_mask:0xf bank_mask:0xc
    v_mov_b32_dpp v33, v45 quad_perm:[0,1,2,3] row_mask:0xf bank_mask:0xc
    v_mov_b32_dpp v36, v46 quad_perm:[0,1,2,3] row_mask:0xf bank_mask:0xc
    v_mov_b32_dpp v37, v47 quad_perm:[0,1,2,3] row_mask:0xf bank_mask:0xc
    v_perm_b32 v40, v28, v24, s44
    v_perm_b32 v41, v36, v32, s44
    v_perm_b32 v42, v30, v26, s44
    v_perm_b32 v43, v38, v34, s44
    v_perm_b32 v44, v28, v24, s45
    v_perm_b32 v45, v36, v32, s45
    v_perm_b32 v46, v30, v26, s45
    v_perm_b32 v47, v38, v34, s45
    v_perm_b32 v48, v29, v25, s44
    v_perm_b32 v49, v37, v33, s44
    v_perm_b32 v50, v31, v27, s44
    v_perm_b32 v51, v39, v35, s44
    v_perm_b32 v52, v29, v25, s45
    v_perm_b32 v53, v37, v33, s45
    v_perm_b32 v54, v31, v27, s45
    v_perm_b32 v55, v39, v35, s45
gm_wdone:
    v_lshrrev_b32 v1, 4, v3
    v_lshlrev_b32 v1, 11, v1
    v_and_b32 v4, 7, v3
    v_lshl_add_u32 v1, v4, 4, v1
    v_bfe_u32 v4, v3, 3, 1
    v_lshl_add_u32 v1, v4, 9, v1
    v_and_b32 v4, 3, v3
    v_lshrrev_b32 v5, 2, v3
    v_mul_u32_u24 v0, 576, v4
    v_lshl_add_u32 v0, v5, 3, v0
    v_add_u32 v0, 40960, v0
    s_lshl_b32 s38, s41, 11
    s_lshl_b32 s53, s17, 7
    s_add_u32 s38, s38, s53
    s_mov_b32 s36, 0x24924924
    s_mov_b32 s39, 0
    s_waitcnt vmcnt(0)
gm_poll:
    v_mov_b32 v2, 0
    ds_read_b32 v2, v2 offset:276
    s_waitcnt lgkmcnt(0)
    v_readfirstlane_b32 s52, v2
    s_and_b32 s52, s52, s36
    s_cbranch_scc1 gm_go
    s_sleep 2
    s_branch gm_poll
gm_go:
    s_ff1_i32_b32 s52, s52
    s_bitset0_b32 s36, s52
    s_mul_i32 s52, s52, 11
    s_bfe_u32 s53, s52, 0x10005
    s_bfe_u32 s52, s52, 0x30006
    s_mul_i32 s35, s53, 61440
    s_mul_i32 s31, s52, 2304
    s_add_u32 s31, s31, s35
    s_sub_u32 s35, s31, s39
    v_add_u32 v0, s35, v0
    ds_read_b64_tr_b16 v[12:13], v0 offset:0
    ds_read_b64_tr_b16 v[14:15], v0 offset:128
    ds_read_b64_tr_b16 v[16:17], v0 offset:256
    ds_read_b64_tr_b16 v[18:19], v0 offset:384
    s_mov_b32 s39, s31
    s_mul_i32 s33, s53, 5
    s_add_u32 s33, s33, s52
    s_lshl_b32 s33, s33, 13
    s_add_u32 s33, s33, s38
    s_mov_b32 s37, s33
    s_mov_b32 s32, 0x7ffffff0
gm_loop:
    s_waitcnt lgkmcnt(2)
    v_mfma_f32_16x16x32_bf16 v[24:27], v[12:15], v[40:43], 0
    s_setprio 3
    v_cvt_pk_bf16_f32 v7, v33, v37
    v_cvt_pk_bf16_f32 v5, v32, v36
    ds_read_b64_tr_b16 v[20:21], v0 offset:15360
    s_setprio 0
    v_mfma_f32_16x16x32_bf16 v[28:31], v[12:15], v[44:47], 0
    s_setprio 3
    v_cvt_pk_bf16_f32 v11, v35, v39
    v_cvt_pk_bf16_f32 v9, v34, v38
    ds_read_b64_tr_b16 v[22:23], v0 offset:15488
    s_setprio 0
    v_mfma_f32_16x16x32_bf16 v[32:35], v[12:15], v[48:51], 0
    s_setprio 3
    v_mov_b32_dpp v2, v6 row_ror:8 row_mask:0xf bank_mask:0xf
    v_mov_b32_dpp v3, v7 row_ror:8 row_mask:0xf bank_mask:0xf
    s_setprio 0
    v_mfma_f32_16x16x32_bf16 v[36:39], v[12:15], v[52:55], 0
    s_setprio 3
    v_mov_b32_dpp v6, v4 row_ror:8 row_mask:0xf bank_mask:0x3
    v_mov_b32_dpp v7, v5 row_ror:8 row_mask:0xf bank_mask:0x3
    s_setprio 0
    s_waitcnt lgkmcnt(2)
    v_mfma_f32_16x16x32_bf16 v[24:27], v[16:19], v[56:59], v[24:27]
    s_setprio 3
    ds_read_b64_tr_b16 v[12:13], v0 offset:15616
    v_mov_b32_dpp v4, v2 quad_perm:[0,1,2,3] row_mask:0xf bank_mask:0xc
    s_setprio 0
    v_mfma_f32_16x16x32_bf16 v[28:31], v[16:19], v[60:63], v[28:31]
    s_setprio 3
    ds_read_b64_tr_b16 v[14:15], v0 offset:15744
    v_mov_b32_dpp v5, v3 quad_perm:[0,1,2,3] row_mask:0xf bank_mask:0xc
    s_setprio 0
    v_mfma_f32_16x16x32_bf16 v[32:35], v[16:19], v[64:67], v[32:35]
    s_setprio 3
    buffer_store_dwordx4 v[4:7], v1, s[12:15], s32 offen offset:0 sc0 sc1
    v_mov_b32_dpp v2, v10 row_ror:8 row_mask:0xf bank_mask:0xf
    s_setprio 0
    v_mfma_f32_16x16x32_bf16 v[36:39], v[16:19], v[68:71], v[36:39]
    s_setprio 3
    v_mov_b32_dpp v3, v11 row_ror:8 row_mask:0xf bank_mask:0xf
    v_mov_b32_dpp v10, v8 row_ror:8 row_mask:0xf bank_mask:0x3
    s_setprio 0
    s_waitcnt lgkmcnt(2)
    v_mfma_f32_16x16x32_bf16 v[24:27], v[20:23], v[72:75], v[24:27]
    s_setprio 3
    ds_read_b64_tr_b16 v[16:17], v0 offset:30720
    v_mov_b32_dpp v11, v9 row_ror:8 row_mask:0xf bank_mask:0x3
    s_setprio 0
    v_mfma_f32_16x16x32_bf16 v[28:31], v[20:23], v[76:79], v[28:31]
    s_setprio 3
    ds_read_b64_tr_b16 v[18:19], v0 offset:30848
    v_mov_b32_dpp v8, v2 quad_perm:[0,1,2,3] row_mask:0xf bank_mask:0xc
    s_setprio 0
    v_mfma_f32_16x16x32_bf16 v[32:35], v[20:23], v[80:83], v[32:35]
    s_setprio 3
    v_mov_b32_dpp v9, v3 quad_perm:[0,1,2,3] row_mask:0xf bank_mask:0xc
    buffer_store_dwordx4 v[8:11], v1, s[12:15], s32 offen offset:1024 sc0 sc1
    s_setprio 0
    v_mfma_f32_16x16x32_bf16 v[36:39], v[20:23], v[84:87], v[36:39]
    s_waitcnt lgkmcnt(2)
    v_mfma_f32_16x16x32_bf16 v[24:27], v[12:15], v[88:91], v[24:27]
    ds_read_b64_tr_b16 v[20:21], v0 offset:30976
    v_mfma_f32_16x16x32_bf16 v[28:31], v[12:15], v[92:95], v[28:31]
    ds_read_b64_tr_b16 v[22:23], v0 offset:31104
    v_mfma_f32_16x16x32_bf16 v[32:35], v[12:15], v[96:99], v[32:35]
    s_setprio 3
    v_mov_b32 v2, 0
    s_setprio 0
    v_mfma_f32_16x16x32_bf16 v[36:39], v[12:15], v[100:103], v[36:39]
    ds_read_b32 v2, v2 offset:276
    s_waitcnt lgkmcnt(3)
    v_mfma_f32_16x16x32_bf16 v[24:27], v[16:19], v[104:107], v[24:27]
    ds_read_b64_tr_b16 v[12:13], v0 offset:46080
    v_mfma_f32_16x16x32_bf16 v[28:31], v[16:19], v[108:111], v[28:31]
    ds_read_b64_tr_b16 v[14:15], v0 offset:46208
    v_mfma_f32_16x16x32_bf16 v[32:35], v[16:19], v[112:115], v[32:35]
    s_setprio 3
    s_waitcnt lgkmcnt(2)
    v_readfirstlane_b32 s52, v2
    s_and_b32 s52, s52, s36
    s_setprio 0
    v_mfma_f32_16x16x32_bf16 v[36:39], v[16:19], v[116:119], v[36:39]
    s_cselect_b32 s34, 1, 0
    s_ff1_i32_b32 s52, s52
    s_waitcnt lgkmcnt(2)
    v_mfma_f32_16x16x32_bf16 v[24:27], v[20:23], v[120:123], v[24:27]
    ds_read_b64_tr_b16 v[16:17], v0 offset:46336
    s_bitset0_b32 s36, s52
    s_mul_i32 s52, s52, 11
    v_mfma_f32_16x16x32_bf16 v[28:31], v[20:23], v[124:127], v[28:31]
    ds_read_b64_tr_b16 v[18:19], v0 offset:46464
    s_bfe_u32 s53, s52, 0x10005
    s_bfe_u32 s52, s52, 0x30006
    v_mfma_f32_16x16x32_bf16 v[32:35], v[20:23], v[128:131], v[32:35]
    s_mul_i32 s35, s53, 61440
    s_mul_i32 s31, s52, 2304
    s_add_u32 s31, s31, s35
    v_mfma_f32_16x16x32_bf16 v[36:39], v[20:23], v[132:135], v[36:39]
    s_setprio 3
    s_sub_u32 s35, s31, s39
    v_add_u32 v0, s35, v0
    s_setprio 0
    s_waitcnt lgkmcnt(2)
    v_mfma_f32_16x16x32_bf16 v[24:27], v[12:15], v[136:139], v[24:27]
    ds_read_b64_tr_b16 v[20:21], v0 offset:0
    v_mfma_f32_16x16x32_bf16 v[28:31], v[12:15], v[140:143], v[28:31]
    ds_read_b64_tr_b16 v[22:23], v0 offset:128
    v_mfma_f32_16x16x32_bf16 v[32:35], v[12:15], v[144:147], v[32:35]
    s_mov_b32 s39, s31
    s_mul_i32 s33, s53, 5
    s_add_u32 s33, s33, s52
    v_mfma_f32_16x16x32_bf16 v[36:39], v[12:15], v[148:151], v[36:39]
    s_lshl_b32 s33, s33, 13
    s_add_u32 s33, s33, s38
    s_waitcnt lgkmcnt(2)
    v_mfma_f32_16x16x32_bf16 v[24:27], v[16:19], v[152:155], v[24:27]
    ds_read_b64_tr_b16 v[12:13], v0 offset:256
    v_mfma_f32_16x16x32_bf16 v[28:31], v[16:19], v[156:159], v[28:31]
    ds_read_b64_tr_b16 v[14:15], v0 offset:384
    s_mov_b32 s32, s37
    s_mov_b32 s37, s33
    v_mfma_f32_16x16x32_bf16 v[32:35], v[16:19], v[160:163], v[32:35]
    s_cmp_eq_u32 s34, 0
    s_nop 1
    v_mfma_f32_16x16x32_bf16 v[36:39], v[16:19], v[164:167], v[36:39]
    s_setprio 3
    v_cvt_pk_bf16_f32 v4, v24, v28
    v_cvt_pk_bf16_f32 v6, v25, v29
    v_cvt_pk_bf16_f32 v8, v26, v30
    v_cvt_pk_bf16_f32 v10, v27, v31
    s_setprio 0
    s_cbranch_scc1 gm_drain
    s_waitcnt lgkmcnt(2)
    v_mfma_f32_16x16x32_bf16 v[24:27], v[20:23], v[40:43], 0
    s_setprio 3
    v_cvt_pk_bf16_f32 v7, v33, v37
    v_cvt_pk_bf16_f32 v5, v32, v36
    ds_read_b64_tr_b16 v[16:17], v0 offset:15360
    s_setprio 0
    v_mfma_f32_16x16x32_bf16 v[28:31], v[20:23], v[44:47], 0
    s_setprio 3
    v_cvt_pk_bf16_f32 v11, v35, v39
    v_cvt_pk_bf16_f32 v9, v34, v38
    ds_read_b64_tr_b16 v[18:19], v0 offset:15488
    s_setprio 0
    v_mfma_f32_16x16x32_bf16 v[32:35], v[20:23], v[48:51], 0
    s_setprio 3
    v_mov_b32_dpp v2, v6 row_ror:8 row_mask:0xf bank_mask:0xf
    v_mov_b32_dpp v3, v7 row_ror:8 row_mask:0xf bank_mask:0xf
    s_setprio 0
    v_mfma_f32_16x16x32_bf16 v[36:39], v[20:23], v[52:55], 0
    s_setprio 3
    v_mov_b32_dpp v6, v4 row_ror:8 row_mask:0xf bank_mask:0x3
    v_mov_b32_dpp v7, v5 row_ror:8 row_mask:0xf bank_mask:0x3
    s_setprio 0
    s_waitcnt lgkmcnt(2)
    v_mfma_f32_16x16x32_bf16 v[24:27], v[12:15], v[56:59], v[24:27]
    s_setprio 3
    ds_read_b64_tr_b16 v[20:21], v0 offset:15616
    v_mov_b32_dpp v4, v2 quad_perm:[0,1,2,3] row_mask:0xf bank_mask:0xc
    s_setprio 0
    v_mfma_f32_16x16x32_bf16 v[28:31], v[12:15], v[60:63], v[28:31]
    s_setprio 3
    ds_read_b64_tr_b16 v[22:23], v0 offset:15744
    v_mov_b32_dpp v5, v3 quad_perm:[0,1,2,3] row_mask:0xf bank_mask:0xc
    s_setprio 0
    v_mfma_f32_16x16x32_bf16 v[32:35], v[12:15], v[64:67], v[32:35]
    s_setprio 3
    buffer_store_dwordx4 v[4:7], v1, s[12:15], s32 offen offset:0 sc0 sc1
    v_mov_b32_dpp v2, v10 row_ror:8 row_mask:0xf bank_mask:0xf
    s_setprio 0
    v_mfma_f32_16x16x32_bf16 v[36:39], v[12:15], v[68:71], v[36:39]
    s_setprio 3
    v_mov_b32_dpp v3, v11 row_ror:8 row_mask:0xf bank_mask:0xf
    v_mov_b32_dpp v10, v8 row_ror:8 row_mask:0xf bank_mask:0x3
    s_setprio 0
    s_waitcnt lgkmcnt(2)
    v_mfma_f32_16x16x32_bf16 v[24:27], v[16:19], v[72:75], v[24:27]
    s_setprio 3
    ds_read_b64_tr_b16 v[12:13], v0 offset:30720
    v_mov_b32_dpp v11, v9 row_ror:8 row_mask:0xf bank_mask:0x3
    s_setprio 0
    v_mfma_f32_16x16x32_bf16 v[28:31], v[16:19], v[76:79], v[28:31]
    s_setprio 3
    ds_read_b64_tr_b16 v[14:15], v0 offset:30848
    v_mov_b32_dpp v8, v2 quad_perm:[0,1,2,3] row_mask:0xf bank_mask:0xc
    s_setprio 0
    v_mfma_f32_16x16x32_bf16 v[32:35], v[16:19], v[80:83], v[32:35]
    s_setprio 3
    v_mov_b32_dpp v9, v3 quad_perm:[0,1,2,3] row_mask:0xf bank_mask:0xc
    buffer_store_dwordx4 v[8:11], v1, s[12:15], s32 offen offset:1024 sc0 sc1
    s_setprio 0
    v_mfma_f32_16x16x32_bf16 v[36:39], v[16:19], v[84:87], v[36:39]
    s_waitcnt lgkmcnt(2)
    v_mfma_f32_16x16x32_bf16 v[24:27], v[20:23], v[88:91], v[24:27]
    ds_read_b64_tr_b16 v[16:17], v0 offset:30976
    v_mfma_f32_16x16x32_bf16 v[28:31], v[20:23], v[92:95], v[28:31]
    ds_read_b64_tr_b16 v[18:19], v0 offset:31104
    v_mfma_f32_16x16x32_bf16 v[32:35], v[20:23], v[96:99], v[32:35]
    s_setprio 3
    v_mov_b32 v2, 0
    s_setprio 0
    v_mfma_f32_16x16x32_bf16 v[36:39], v[20:23], v[100:103], v[36:39]
    ds_read_b32 v2, v2 offset:276
    s_waitcnt lgkmcnt(3)
    v_mfma_f32_16x16x32_bf16 v[24:27], v[12:15], v[104:107], v[24:27]
    ds_read_b64_tr_b16 v[20:21], v0 offset:46080
    v_mfma_f32_16x16x32_bf16 v[28:31], v[12:15], v[108:111], v[28:31]
    ds_read_b64_tr_b16 v[22:23], v0 offset:46208
    v_mfma_f32_16x16x32_bf16 v[32:35], v[12:15], v[112:115], v[32:35]
    s_setprio 3
    s_waitcnt lgkmcnt(2)
    v_readfirstlane_b32 s52, v2
    s_and_b32 s52, s52, s36
    s_setprio 0
    v_mfma_f32_16x16x32_bf16 v[36:39], v[12:15], v[116:119], v[36:39]
    s_cselect_b32 s34, 1, 0
    s_ff1_i32_b32 s52, s52
    s_waitcnt lgkmcnt(2)
    v_mfma_f32_16x16x32_bf16 v[24:27], v[16:19], v[120:123], v[24:27]
    ds_read_b64_tr_b16 v[12:13], v0 offset:46336
    s_bitset0_b32 s36, s52
    s_mul_i32 s52, s52, 11
    v_mfma_f32_16x16x32_bf16 v[28:31], v[16:19], v[124:127], v[28:31]
    ds_read_b64_tr_b16 v[14:15], v0 offset:46464
    s_bfe_u32 s53, s52, 0x10005
    s_bfe_u32 s52, s52, 0x30006
    v_mfma_f32_16x16x32_bf16 v[32:35], v[16:19], v[128:131], v[32:35]
    s_mul_i32 s35, s53, 61440
    s_mul_i32 s31, s52, 2304
    s_add_u32 s31, s31, s35
    v_mfma_f32_16x16x32_bf16 v[36:39], v[16:19], v[132:135], v[36:39]
    s_setprio 3
    s_sub_u32 s35, s31, s39
    v_add_u32 v0, s35, v0
    s_setprio 0
    s_waitcnt lgkmcnt(2)
    v_mfma_f32_16x16x32_bf16 v[24:27], v[20:23], v[136:139], v[24:27]
    ds_read_b64_tr_b16 v[16:17], v0 offset:0
    v_mfma_f32_16x16x32_bf16 v[28:31], v[20:23], v[140:143], v[28:31]
    ds_read_b64_tr_b16 v[18:19], v0 offset:128
    v_mfma_f32_16x16x32_bf16 v[32:35], v[20:23], v[144:147], v[32:35]
    s_mov_b32 s39, s31
    s_mul_i32 s33, s53, 5
    s_add_u32 s33, s33, s52
    v_mfma_f32_16x16x32_bf16 v[36:39], v[20:23], v[148:151], v[36:39]
    s_lshl_b32 s33, s33, 13
    s_add_u32 s33, s33, s38
    s_waitcnt lgkmcnt(2)
    v_mfma_f32_16x16x32_bf16 v[24:27], v[12:15], v[152:155], v[24:27]
    ds_read_b64_tr_b16 v[20:21], v0 offset:256
    v_mfma_f32_16x16x32_bf16 v[28:31], v[12:15], v[156:159], v[28:31]
    ds_read_b64_tr_b16 v[22:23], v0 offset:384
    s_mov_b32 s32, s37
    s_mov_b32 s37, s33
    v_mfma_f32_16x16x32_bf16 v[32:35], v[12:15], v[160:163], v[32:35]
    s_cmp_eq_u32 s34, 0
    s_nop 1
    v_mfma_f32_16x16x32_bf16 v[36:39], v[12:15], v[164:167], v[36:39]
    s_setprio 3
    v_cvt_pk_bf16_f32 v4, v24, v28
    v_cvt_pk_bf16_f32 v6, v25, v29
    v_cvt_pk_bf16_f32 v8, v26, v30
    v_cvt_pk_bf16_f32 v10, v27, v31
    s_setprio 0
    s_cbranch_scc1 gm_drain
    s_waitcnt lgkmcnt(2)
    v_mfma_f32_16x16x32_bf16 v[24:27], v[16:19], v[40:43], 0
    s_setprio 3
    v_cvt_pk_bf16_f32 v7, v33, v37
    v_cvt_pk_bf16_f32 v5, v32, v36
    ds_read_b64_tr_b16 v[12:13], v0 offset:15360
    s_setprio 0
    v_mfma_f32_16x16x32_bf16 v[28:31], v[16:19], v[44:47], 0
    s_setprio 3
    v_cvt_pk_bf16_f32 v11, v35, v39
    v_cvt_pk_bf16_f32 v9, v34, v38
    ds_read_b64_tr_b16 v[14:15], v0 offset:15488
    s_setprio 0
    v_mfma_f32_16x16x32_bf16 v[32:35], v[16:19], v[48:51], 0
    s_setprio 3
    v_mov_b32_dpp v2, v6 row_ror:8 row_mask:0xf bank_mask:0xf
    v_mov_b32_dpp v3, v7 row_ror:8 row_mask:0xf bank_mask:0xf
    s_setprio 0
    v_mfma_f32_16x16x32_bf16 v[36:39], v[16:19], v[52:55], 0
    s_setprio 3
    v_mov_b32_dpp v6, v4 row_ror:8 row_mask:0xf bank_mask:0x3
    v_mov_b32_dpp v7, v5 row_ror:8 row_mask:0xf bank_mask:0x3
    s_setprio 0
    s_waitcnt lgkmcnt(2)
    v_mfma_f32_16x16x32_bf16 v[24:27], v[20:23], v[56:59], v[24:27]
    s_setprio 3
    ds_read_b64_tr_b16 v[16:17], v0 offset:15616
    v_mov_b32_dpp v4, v2 quad_perm:[0,1,2,3] row_mask:0xf bank_mask:0xc
    s_setprio 0
    v_mfma_f32_16x16x32_bf16 v[28:31], v[20:23], v[60:63], v[28:31]
    s_setprio 3
    ds_read_b64_tr_b16 v[18:19], v0 offset:15744
    v_mov_b32_dpp v5, v3 quad_perm:[0,1,2,3] row_mask:0xf bank_mask:0xc
    s_setprio 0
    v_mfma_f32_16x16x32_bf16 v[32:35], v[20:23], v[64:67], v[32:35]
    s_setprio 3
    buffer_store_dwordx4 v[4:7], v1, s[12:15], s32 offen offset:0 sc0 sc1
    v_mov_b32_dpp v2, v10 row_ror:8 row_mask:0xf bank_mask:0xf
    s_setprio 0
    v_mfma_f32_16x16x32_bf16 v[36:39], v[20:23], v[68:71], v[36:39]
    s_setprio 3
    v_mov_b32_dpp v3, v11 row_ror:8 row_mask:0xf bank_mask:0xf
    v_mov_b32_dpp v10, v8 row_ror:8 row_mask:0xf bank_mask:0x3
    s_setprio 0
    s_waitcnt lgkmcnt(2)
    v_mfma_f32_16x16x32_bf16 v[24:27], v[12:15], v[72:75], v[24:27]
    s_setprio 3
    ds_read_b64_tr_b16 v[20:21], v0 offset:30720
    v_mov_b32_dpp v11, v9 row_ror:8 row_mask:0xf bank_mask:0x3
    s_setprio 0
    v_mfma_f32_16x16x32_bf16 v[28:31], v[12:15], v[76:79], v[28:31]
    s_setprio 3
    ds_read_b64_tr_b16 v[22:23], v0 offset:30848
    v_mov_b32_dpp v8, v2 quad_perm:[0,1,2,3] row_mask:0xf bank_mask:0xc
    s_setprio 0
    v_mfma_f32_16x16x32_bf16 v[32:35], v[12:15], v[80:83], v[32:35]
    s_setprio 3
    v_mov_b32_dpp v9, v3 quad_perm:[0,1,2,3] row_mask:0xf bank_mask:0xc
    buffer_store_dwordx4 v[8:11], v1, s[12:15], s32 offen offset:1024 sc0 sc1
    s_setprio 0
    v_mfma_f32_16x16x32_bf16 v[36:39], v[12:15], v[84:87], v[36:39]
    s_waitcnt lgkmcnt(2)
    v_mfma_f32_16x16x32_bf16 v[24:27], v[16:19], v[88:91], v[24:27]
    ds_read_b64_tr_b16 v[12:13], v0 offset:30976
    v_mfma_f32_16x16x32_bf16 v[28:31], v[16:19], v[92:95], v[28:31]
    ds_read_b64_tr_b16 v[14:15], v0 offset:31104
    v_mfma_f32_16x16x32_bf16 v[32:35], v[16:19], v[96:99], v[32:35]
    s_setprio 3
    v_mov_b32 v2, 0
    s_setprio 0
    v_mfma_f32_16x16x32_bf16 v[36:39], v[16:19], v[100:103], v[36:39]
    ds_read_b32 v2, v2 offset:276
    s_waitcnt lgkmcnt(3)
    v_mfma_f32_16x16x32_bf16 v[24:27], v[20:23], v[104:107], v[24:27]
    ds_read_b64_tr_b16 v[16:17], v0 offset:46080
    v_mfma_f32_16x16x32_bf16 v[28:31], v[20:23], v[108:111], v[28:31]
    ds_read_b64_tr_b16 v[18:19], v0 offset:46208
    v_mfma_f32_16x16x32_bf16 v[32:35], v[20:23], v[112:115], v[32:35]
    s_setprio 3
    s_waitcnt lgkmcnt(2)
    v_readfirstlane_b32 s52, v2
    s_and_b32 s52, s52, s36
    s_setprio 0
    v_mfma_f32_16x16x32_bf16 v[36:39], v[20:23], v[116:119], v[36:39]
    s_cselect_b32 s34, 1, 0
    s_ff1_i32_b32 s52, s52
    s_waitcnt lgkmcnt(2)
    v_mfma_f32_16x16x32_bf16 v[24:27], v[12:15], v[120:123], v[24:27]
    ds_read_b64_tr_b16 v[20:21], v0 offset:46336
    s_bitset0_b32 s36, s52
    s_mul_i32 s52, s52, 11
    v_mfma_f32_16x16x32_bf16 v[28:31], v[12:15], v[124:127], v[28:31]
    ds_read_b64_tr_b16 v[22:23], v0 offset:46464
    s_bfe_u32 s53, s52, 0x10005
    s_bfe_u32 s52, s52, 0x30006
    v_mfma_f32_16x16x32_bf16 v[32:35], v[12:15], v[128:131], v[32:35]
    s_mul_i32 s35, s53, 61440
    s_mul_i32 s31, s52, 2304
    s_add_u32 s31, s31, s35
    v_mfma_f32_16x16x32_bf16 v[36:39], v[12:15], v[132:135], v[36:39]
    s_setprio 3
    s_sub_u32 s35, s31, s39
    v_add_u32 v0, s35, v0
    s_setprio 0
    s_waitcnt lgkmcnt(2)
    v_mfma_f32_16x16x32_bf16 v[24:27], v[16:19], v[136:139], v[24:27]
    ds_read_b64_tr_b16 v[12:13], v0 offset:0
    v_mfma_f32_16x16x32_bf16 v[28:31], v[16:19], v[140:143], v[28:31]
    ds_read_b64_tr_b16 v[14:15], v0 offset:128
    v_mfma_f32_16x16x32_bf16 v[32:35], v[16:19], v[144:147], v[32:35]
    s_mov_b32 s39, s31
    s_mul_i32 s33, s53, 5
    s_add_u32 s33, s33, s52
    v_mfma_f32_16x16x32_bf16 v[36:39], v[16:19], v[148:151], v[36:39]
    s_lshl_b32 s33, s33, 13
    s_add_u32 s33, s33, s38
    s_waitcnt lgkmcnt(2)
    v_mfma_f32_16x16x32_bf16 v[24:27], v[20:23], v[152:155], v[24:27]
    ds_read_b64_tr_b16 v[16:17], v0 offset:256
    v_mfma_f32_16x16x32_bf16 v[28:31], v[20:23], v[156:159], v[28:31]
    ds_read_b64_tr_b16 v[18:19], v0 offset:384
    s_mov_b32 s32, s37
    s_mov_b32 s37, s33
    v_mfma_f32_16x16x32_bf16 v[32:35], v[20:23], v[160:163], v[32:35]
    s_cmp_eq_u32 s34, 0
    s_nop 1
    v_mfma_f32_16x16x32_bf16 v[36:39], v[20:23], v[164:167], v[36:39]
    s_setprio 3
    v_cvt_pk_bf16_f32 v4, v24, v28
    v_cvt_pk_bf16_f32 v6, v25, v29
    v_cvt_pk_bf16_f32 v8, v26, v30
    v_cvt_pk_bf16_f32 v10, v27, v31
    s_setprio 0
    s_cbranch_scc0 gm_loop
gm_drain:
    s_nop 2
    s_setprio 3
    v_cvt_pk_bf16_f32 v7, v33, v37
    v_cvt_pk_bf16_f32 v5, v32, v36
    v_cvt_pk_bf16_f32 v11, v35, v39
    v_cvt_pk_bf16_f32 v9, v34, v38
    v_mov_b32_dpp v2, v6 row_ror:8 row_mask:0xf bank_mask:0xf
    v_mov_b32_dpp v3, v7 row_ror:8 row_mask:0xf bank_mask:0xf
    v_mov_b32_dpp v6, v4 row_ror:8 row_mask:0xf bank_mask:0x3
    v_mov_b32_dpp v7, v5 row_ror:8 row_mask:0xf bank_mask:0x3
    v_mov_b32_dpp v4, v2 quad_perm:[0,1,2,3] row_mask:0xf bank_mask:0xc
    v_mov_b32_dpp v5, v3 quad_perm:[0,1,2,3] row_mask:0xf bank_mask:0xc
    buffer_store_dwordx4 v[4:7], v1, s[12:15], s32 offen offset:0 sc0 sc1
    v_mov_b32_dpp v2, v10 row_ror:8 row_mask:0xf bank_mask:0xf
    v_mov_b32_dpp v3, v11 row_ror:8 row_mask:0xf bank_mask:0xf
    v_mov_b32_dpp v10, v8 row_ror:8 row_mask:0xf bank_mask:0x3
    v_mov_b32_dpp v11, v9 row_ror:8 row_mask:0xf bank_mask:0x3
    v_mov_b32_dpp v8, v2 quad_perm:[0,1,2,3] row_mask:0xf bank_mask:0xc
    v_mov_b32_dpp v9, v3 quad_perm:[0,1,2,3] row_mask:0xf bank_mask:0xc
    buffer_store_dwordx4 v[8:11], v1, s[12:15], s32 offen offset:1024 sc0 sc1
    s_setprio 0
    s_cmp_lg_u32 s36, 0
    s_cbranch_scc1 gm_poll
    s_endpgm
mn_sp1:
    v_mov_b32 v55, 0
    ds_read_b32 v55, v55 offset:308
    s_waitcnt lgkmcnt(0)
    v_readfirstlane_b32 s62, v55
    s_cmp_ge_u32 s62, 1
    s_cbranch_scc1 mn_sp1x
    s_sleep 1
    s_branch mn_sp1
gm_wait2:
    v_mov_b32 v15, 0
    ds_read_b32 v17, v15 offset:304
    s_waitcnt lgkmcnt(0)
    v_readfirstlane_b32 s62, v17
    s_cmp_lg_u32 s62, 0
    s_cbranch_scc1 gm_go2
    s_sleep 1
    s_branch gm_wait2
gm_ovf:
    s_movk_i32 s20, 4
    s_barrier
    s_barrier
    s_branch gm_pass
gm_next:
    s_add_u32 s24, s24, s20
    s_barrier
    s_branch gm_pass
mn_w5:
    s_and_b32 s62, s2, 15
    s_lshl_b32 s62, s62, 7
    s_add_u32 s62, s62, 11730944
    v_mov_b32 v55, s62
    v_lshlrev_b32 v56, 6, v0
    v_and_b32 v56, 0xc0, v56
    s_mov_b32 s63, 0x100000
mn_poll2dm:
    s_sub_u32 s63, s63, 1
    s_cbranch_scc1 mn_poll2dx
    global_load_dword v57, v56, s[60:61] sc1
    s_waitcnt vmcnt(0)
    v_add_u32_dpp v57, v57, v57 quad_perm:[2,3,0,1] row_mask:0xf bank_mask:0xf
    s_sleep 8
    v_readlane_b32 s62, v57, 1
    s_cmp_lt_u32 s62, 125
    s_cbranch_scc1 mn_poll2dm
mn_poll2dx:
    v_add_u32 v55, 12, v35
    v_add_u32 v55, s24, v55
    v_lshrrev_b32 v56, 16, v58
    v_mov_b32 v23, 0
    v_cmpx_lt_u32 vcc, v55, v56
    s_cbranch_execz mn_g0
    v_cmp_gt_u32 vcc, 15, v55
    v_and_b32 v56, 0xffff, v58
    v_add_lshl_u32 v56, v55, v56, 2
    v_add_u32 v56, v56, v46
    v_lshl_add_u32 v57, v0, 4, s22
    v_and_or_b32 v57, v55, 12, v57
    v_cndmask_b32 v56, v56, v57, vcc
    buffer_load_dword v23, v56, s[8:11], 0 offen sc1
    s_waitcnt vmcnt(0)
mn_g0:
    s_mov_b64 exec, -1
    v_add_u32 v55, 16, v35
    v_add_u32 v55, s24, v55
    v_lshrrev_b32 v56, 16, v58
    v_mov_b32 v24, 0
    v_cmpx_lt_u32 vcc, v55, v56
    s_cbranch_execz mn_g1
    v_cmp_gt_u32 vcc, 15, v55
    v_and_b32 v56, 0xffff, v58
    v_add_lshl_u32 v56, v55, v56, 2
    v_add_u32 v56, v56, v46
    v_lshl_add_u32 v57, v0, 4, s22
    v_and_or_b32 v57, v55, 12, v57
    v_cndmask_b32 v56, v56, v57, vcc
    buffer_load_dword v24, v56, s[8:11], 0 offen sc1
    s_waitcnt vmcnt(0)
mn_g1:
    s_mov_b64 exec, -1
mn_more:
    s_add_u32 s52, s24, s20
    v_lshrrev_b32 v56, 16, v58
    v_cmp_lt_u32 vcc, s52, v56
    s_cbranch_vccz mn_count
    v_mov_b32 v55, 272
    ds_write_b32 v55, v48
    s_branch mn_count
mn_ovf:
    s_movk_i32 s20, 4
    s_waitcnt vmcnt(0) lgkmcnt(0)
    s_barrier
    s_branch mn_again
mn_next:
    s_set_gpr_idx_off
    s_waitcnt vmcnt(0) lgkmcnt(0)
    s_nop 7
    s_add_u32 s24, s24, s20
    v_mbcnt_lo_u32_b32 v0, -1, 0
    v_mbcnt_hi_u32_b32 v0, -1, v0
    v_lshl_add_u32 v0, s16, 6, v0
    v_lshrrev_b32 v56, 6, v0
    v_lshlrev_b32 v55, 1, v0
    v_and_b32 v55, 0x78, v55
    v_or_b32 v55, v55, v56
    v_cmp_gt_u32 vcc, 125, v55
    v_mul_u32_u24 v46, 5120, v55
    v_add_u32 v46, 7340032, v46
    v_bfrev_b32 v56, 2
    v_lshlrev_b32 v44, 4, v0
    v_cndmask_b32 v44, v56, v44, vcc
    v_and_b32 v51, 63, v0
    buffer_load_dwordx4 v[20:23], v44, s[8:11], s22 offen sc1
    v_mov_b32 v48, 1
    v_lshlrev_b32 v47, 2, v51
    v_bfe_u32 v2, v0, 5, 1
    v_bfe_u32 v3, v0, 3, 2
    v_and_b32 v35, 3, v0
    v_lshl_add_u32 v3, v3, 2, v35
    v_mul_u32_u24 v49, 20, v2
    v_lshrrev_b32 v18, 2, v51
    v_lshl_add_u32 v18, v35, 4, v18
    v_mov_b32 v50, 0x3fff
    s_lshl_b32 s37, s16, 2
    v_mov_b32 v59, s37
    s_sub_u32 s36, s16, 1
    s_waitcnt vmcnt(0)
    v_mov_b32_dpp v58, v23 quad_perm:[3,3,3,3] row_mask:0xf bank_mask:0xf
mn_again:
    v_mov_b32 v55, 0
    ds_write_b32 v47, v55 offset:0
    ds_write_b32 v47, v55 offset:128
    s_waitcnt vmcnt(0) lgkmcnt(0)
    s_barrier
    v_add_u32 v55, 0, v35
    v_add_u32 v55, s24, v55
    v_lshrrev_b32 v56, 16, v58
    v_mov_b32 v20, 0
    v_cmpx_lt_u32 vcc, v55, v56
    s_cbranch_execz mn_g2
    v_cmp_gt_u32 vcc, 15, v55
    v_and_b32 v56, 0xffff, v58
    v_add_lshl_u32 v56, v55, v56, 2
    v_add_u32 v56, v56, v46
    v_lshl_add_u32 v57, v0, 4, s22
    v_and_or_b32 v57, v55, 12, v57
    v_cndmask_b32 v56, v56, v57, vcc
    buffer_load_dword v20, v56, s[8:11], 0 offen sc1
    s_waitcnt vmcnt(0)
mn_g2:
    s_mov_b64 exec, -1
    v_mov_b32 v21, 0
    v_mov_b32 v22, 0
    v_mov_b32 v23, 0
    v_mov_b32 v24, 0
    s_cmp_le_u32 s20, 4
    s_cbranch_scc1 mn_more
    v_add_u32 v55, 4, v35
    v_add_u32 v55, s24, v55
    v_lshrrev_b32 v56, 16, v58
    v_mov_b32 v21, 0
    v_cmpx_lt_u32 vcc, v55, v56
    s_cbranch_execz mn_g3
    v_cmp_gt_u32 vcc, 15, v55
    v_and_b32 v56, 0xffff, v58
    v_add_lshl_u32 v56, v55, v56, 2
    v_add_u32 v56, v56, v46
    v_lshl_add_u32 v57, v0, 4, s22
    v_and_or_b32 v57, v55, 12, v57
    v_cndmask_b32 v56, v56, v57, vcc
    buffer_load_dword v21, v56, s[8:11], 0 offen sc1
    s_waitcnt vmcnt(0)
mn_g3:
    s_mov_b64 exec, -1
    v_add_u32 v55, 8, v35
    v_add_u32 v55, s24, v55
    v_lshrrev_b32 v56, 16, v58
    v_mov_b32 v22, 0
    v_cmpx_lt_u32 vcc, v55, v56
    s_cbranch_execz mn_g4
    v_cmp_gt_u32 vcc, 15, v55
    v_and_b32 v56, 0xffff, v58
    v_add_lshl_u32 v56, v55, v56, 2
    v_add_u32 v56, v56, v46
    v_lshl_add_u32 v57, v0, 4, s22
    v_and_or_b32 v57, v55, 12, v57
    v_cndmask_b32 v56, v56, v57, vcc
    buffer_load_dword v22, v56, s[8:11], 0 offen sc1
    s_waitcnt vmcnt(0)
mn_g4:
    s_mov_b64 exec, -1
    v_add_u32 v55, 12, v35
    v_add_u32 v55, s24, v55
    v_lshrrev_b32 v56, 16, v58
    v_mov_b32 v23, 0
    v_cmpx_lt_u32 vcc, v55, v56
    s_cbranch_execz mn_g5
    v_cmp_gt_u32 vcc, 15, v55
    v_and_b32 v56, 0xffff, v58
    v_add_lshl_u32 v56, v55, v56, 2
    v_add_u32 v56, v56, v46
    v_lshl_add_u32 v57, v0, 4, s22
    v_and_or_b32 v57, v55, 12, v57
    v_cndmask_b32 v56, v56, v57, vcc
    buffer_load_dword v23, v56, s[8:11], 0 offen sc1
    s_waitcnt vmcnt(0)
mn_g5:
    s_mov_b64 exec, -1
    v_add_u32 v55, 16, v35
    v_add_u32 v55, s24, v55
    v_lshrrev_b32 v56, 16, v58
    v_mov_b32 v24, 0
    v_cmpx_lt_u32 vcc, v55, v56
    s_cbranch_execz mn_g6
    v_cmp_gt_u32 vcc, 15, v55
    v_and_b32 v56, 0xffff, v58
    v_add_lshl_u32 v56, v55, v56, 2
    v_add_u32 v56, v56, v46
    v_lshl_add_u32 v57, v0, 4, s22
    v_and_or_b32 v57, v55, 12, v57
    v_cndmask_b32 v56, v56, v57, vcc
    buffer_load_dword v24, v56, s[8:11], 0 offen sc1
    s_waitcnt vmcnt(0)
mn_g6:
    s_mov_b64 exec, -1
    s_branch mn_more
mn_last:
    s_endpgm
.section .rodata,"a"
.p2align 6
.amdhsa_kernel standalone__tensor_product_equiv_mace__graph_kernel
  .amdhsa_next_free_vgpr 168
  .amdhsa_next_free_sgpr 96
  .amdhsa_accum_offset 168
  .amdhsa_group_segment_fixed_size 0
  .amdhsa_kernarg_size 88
  .amdhsa_user_sgpr_count 2
  .amdhsa_user_sgpr_kernarg_segment_ptr 1
  .amdhsa_system_sgpr_workgroup_id_x 1
.end_amdhsa_kernel
```

```asm
; @launch grid=(256,1,1) block=(768,1,1) lds=163840
.amdgcn_target "amdgcn-amd-amdhsa--gfx950"
.text
.globl standalone__tensor_product_equiv_mace__graph_kernel
.p2align 8
.type standalone__tensor_product_equiv_mace__graph_kernel,@function
standalone__tensor_product_equiv_mace__graph_kernel:
    s_load_dwordx8 s[4:11], s[0:1], 8
    s_load_dwordx4 s[12:15], s[0:1], 72
    v_lshrrev_b32 v9, 6, v0
    s_and_b32 s3, s2, 127
    v_readfirstlane_b32 s18, v9
    v_and_b32 v1, 63, v0
    s_cmp_lt_u32 s2, 125
    s_cbranch_scc1 ka_bin
    s_cmp_ge_u32 s2, 256
    s_cbranch_scc1 ka_end
    s_getpc_b64 s[36:37]
ka_pc0:
    v_lshlrev_b32 v41, 7, v0
    s_mul_i32 s34, s3, 40960
    v_add_u32 v44, s34, v41
    v_min_u32 v41, mn_last-ka_pc0, v41
    global_load_dword v41, v41, s[36:37]
    s_cmp_ge_u32 s3, 125
    s_cbranch_scc1 ka_idle
    s_cmp_ge_u32 s18, 5
    s_cbranch_scc1 ka_pf
    s_waitcnt vmcnt(0) lgkmcnt(0)
    global_load_dword v45, v44, s[10:11]
    s_branch ka_pf
ka_bin:
    s_cmp_ge_u32 s18, 10
    s_cbranch_scc1 ka_dma
    s_mul_i32 s3, s2, 5120
    v_lshl_add_u32 v5, v0, 2, s3
    s_waitcnt lgkmcnt(0)
    global_load_dword v10, v5, s[6:7]
    global_load_dword v60, v5, s[6:7] offset:2560
    global_load_dword v11, v5, s[4:5]
    global_load_dword v61, v5, s[4:5] offset:2560
    v_lshlrev_b32 v2, 2, v0
    v_and_b32 v2, 0x3fc, v2
    v_lshlrev_b32 v5, 4, v0
    v_mov_b32 v44, 0
    v_mov_b32 v45, 0
    v_mov_b32 v46, 0
    v_mov_b32 v47, 0
    ds_write_b32 v2, v44 offset:1024
    ds_write_b128 v5, v[44:47] offset:12288
    ds_write_b128 v5, v[44:47] offset:18432
    s_and_b32 s21, s15, 0xffff
    s_mov_b32 s22, 12582912
    s_mov_b32 s23, 0x20000
    s_mov_b32 s20, s14
    v_mov_b32 v3, 1
    v_lshlrev_b32 v26, 4, v1
    s_lshl_b32 s19, s18, 10
    v_add_u32 v27, s19, v26
    v_mov_b32 v4, 0x40000
    s_movk_i32 s29, 625
    s_movk_i32 s38, 0x3fff
    s_waitcnt lgkmcnt(0)
    s_barrier
    v_mov_b32 v19, 74752
    v_lshl_add_u32 v18, v0, 1, 0
    v_mul_u32_u24 v16, 13108, v18
    v_lshrrev_b32 v16, 16, v16
    v_mad_i32_i24 v18, v16, -5, v18
    v_lshlrev_b32 v16, 2, v16
    v_cmp_eq_u32 vcc, 4, v18
    v_lshlrev_b32 v18, 3, v18
    v_add_u32 v18, 33792, v18
    v_cndmask_b32 v17, 5, 3, vcc
    v_cndmask_b32 v18, v18, v19, vcc
    v_lshl_add_u32 v14, v0, 1, 1
    v_mul_u32_u24 v12, 13108, v14
    v_lshrrev_b32 v12, 16, v12
    v_mad_i32_i24 v14, v12, -5, v14
    v_lshlrev_b32 v12, 2, v12
    v_cmp_eq_u32 vcc, 4, v14
    v_lshlrev_b32 v14, 3, v14
    v_add_u32 v14, 33792, v14
    v_cndmask_b32 v13, 5, 3, vcc
    v_cndmask_b32 v14, v14, v19, vcc
    s_mul_i32 s31, s2, 51200
    s_waitcnt vmcnt(3)
    v_mul_u32_u24 v32, 214749, v10
    v_lshrrev_b32 v32, 23, v32
    v_min_u32 v32, 255, v32
    v_and_b32 v35, 7, v32
    v_lshrrev_b32 v33, 3, v32
    v_lshl_add_u32 v35, v35, 5, v33
    v_lshlrev_b32 v35, 2, v35
    ds_add_rtn_u32 v36, v35, v3 offset:1024
    s_waitcnt vmcnt(2)
    v_mul_u32_u24 v62, 214749, v60
    v_lshrrev_b32 v62, 23, v62
    v_min_u32 v62, 255, v62
    v_and_b32 v66, 7, v62
    v_lshrrev_b32 v63, 3, v62
    v_lshl_add_u32 v66, v66, 5, v63
    v_lshlrev_b32 v66, 2, v66
    ds_add_rtn_u32 v67, v66, v3 offset:1024
    v_mad_u32_u24 v33, v32, s29, 15
    v_lshrrev_b32 v33, 4, v33
    v_sub_u32 v33, v10, v33
    v_subrev_u32 v32, 20, v33
    v_min_u32 v32, v32, v33
    v_min_u32 v32, 19, v32
    v_lshlrev_b32 v40, 4, v35
    v_add_u32 v35, s19, v35
    v_mad_u32_u24 v63, v62, s29, 15
    v_lshrrev_b32 v63, 4, v63
    v_sub_u32 v63, v60, v63
    v_subrev_u32 v62, 20, v63
    v_min_u32 v62, v62, v63
    v_min_u32 v62, 19, v62
    v_lshlrev_b32 v70, 4, v66
    v_add_u32 v66, s19, v66
    s_waitcnt vmcnt(0) lgkmcnt(0)
    v_mul_u32_u24 v39, 3330, v11
    v_lshrrev_b32 v39, 20, v39
    v_lshrrev_b32 v34, 2, v32
    v_cmp_gt_u32 vcc, 27, v39
    v_add_u32 v34, 27, v34
    v_lshlrev_b32 v23, 14, v32
    v_cndmask_b32 v39, v34, v39, vcc
    v_cmp_le_u32 vcc, 20, v33
    v_and_or_b32 v22, v11, s38, v23
    v_or_b32 v39, 64, v39
    v_add_u32 v34, 32, v39
    v_cndmask_b32 v39, v39, v34, vcc
    v_lshl_or_b32 v22, v39, 25, v22
    v_cmp_lt_u32 vcc, 14, v36
    v_and_b32 v34, 3, v36
    v_lshl_add_u32 v40, v34, 4, v40
    v_and_or_b32 v40, v36, 12, v40
    v_cndmask_b32 v40, v40, v4, vcc
    ds_write_b32 v40, v22 offset:12288
    v_mul_u32_u24 v68, 3330, v61
    v_lshrrev_b32 v68, 20, v68
    v_lshrrev_b32 v71, 2, v62
    v_cmp_gt_u32 vcc, 27, v68
    v_add_u32 v71, 27, v71
    v_lshlrev_b32 v75, 14, v62
    v_cndmask_b32 v68, v71, v68, vcc
    v_cmp_le_u32 vcc, 20, v63
    v_and_or_b32 v74, v61, s38, v75
    v_or_b32 v68, 64, v68
    v_add_u32 v71, 32, v68
    v_cndmask_b32 v68, v68, v71, vcc
    v_lshl_or_b32 v74, v68, 25, v74
    v_cmp_lt_u32 vcc, 14, v67
    v_and_b32 v71, 3, v67
    v_lshl_add_u32 v70, v71, 4, v70
    v_and_or_b32 v70, v67, 12, v70
    v_cndmask_b32 v70, v70, v4, vcc
    ds_write_b32 v70, v74 offset:12288
    s_waitcnt lgkmcnt(0)
    s_barrier
    ds_read_b128 v[44:47], v26 offset:1024
    v_add_u32 v9, 640, v0
    v_max_u32 v8, v36, v67
    v_cmp_lt_u32 vcc, 14, v8
    s_waitcnt lgkmcnt(0)
    v_add_u32 v53, v44, v45
    v_add_u32 v54, v53, v46
    v_add_u32 v38, v54, v47
    v_mov_b32 v55, v38
    s_nop 0
    v_add_u32_dpp v38, v38, v38 row_shr:1 row_mask:0xf bank_mask:0xf
    s_nop 0
    s_nop 0
    v_add_u32_dpp v38, v38, v38 row_shr:2 row_mask:0xf bank_mask:0xf
    s_nop 0
    s_nop 0
    v_add_u32_dpp v38, v38, v38 row_shr:4 row_mask:0xf bank_mask:0xf
    s_nop 0
    s_nop 0
    v_add_u32_dpp v38, v38, v38 row_shr:8 row_mask:0xf bank_mask:0xf
    s_nop 0
    s_nop 0
    v_add_u32_dpp v38, v38, v38 row_bcast:15 row_mask:0xa bank_mask:0xf
    s_nop 0
    s_nop 0
    v_add_u32_dpp v38, v38, v38 row_bcast:31 row_mask:0xc bank_mask:0xf
    v_sub_u32 v56, v38, v55
    v_add_u32 v57, v56, v44
    v_add_u32 v58, v56, v53
    v_add_u32 v59, v56, v54
    ds_write_b128 v27, v[56:59] offset:2048
    ds_read_b32 v43, v35 offset:2048
    ds_read_b32 v69, v66 offset:2048
    s_waitcnt lgkmcnt(0)
    v_add_lshl_u32 v43, v43, v36, 2
    v_add_lshl_u32 v69, v69, v67, 2
    ds_write_b32 v43, v0 offset:28672
    ds_write_b32 v69, v9 offset:28672
    s_cbranch_vccnz ka_ov
ka_ov_back:
    s_waitcnt lgkmcnt(0)
ka_copy:
    s_barrier
    ds_read_b32 v20, v16 offset:28672
    ds_read_b32 v21, v12 offset:28672
    ds_read_b32 v22, v16 offset:29696
    ds_read_b32 v23, v12 offset:29696
    ds_read_b32 v24, v16 offset:30720
    ds_read_b32 v25, v12 offset:30720
    ds_read_b32 v26, v16 offset:31744
    ds_read_b32 v27, v12 offset:31744
    ds_read_b32 v28, v16 offset:32768
    ds_read_b32 v29, v12 offset:32768
    s_waitcnt lgkmcnt(8)
    v_lshl_add_u32 v20, v20, v17, v18
    v_lshl_add_u32 v21, v21, v13, v14
    ds_read_b64 v[44:45], v20
    ds_read_b64 v[46:47], v21
    s_waitcnt lgkmcnt(8)
    v_lshl_add_u32 v22, v22, v17, v18
    v_lshl_add_u32 v23, v23, v13, v14
    ds_read_b64 v[48:49], v22
    ds_read_b64 v[50:51], v23
    s_waitcnt lgkmcnt(8)
    v_lshl_add_u32 v24, v24, v17, v18
    v_lshl_add_u32 v25, v25, v13, v14
    ds_read_b64 v[52:53], v24
    ds_read_b64 v[54:55], v25
    s_waitcnt lgkmcnt(8)
    v_lshl_add_u32 v26, v26, v17, v18
    v_lshl_add_u32 v27, v27, v13, v14
    ds_read_b64 v[56:57], v26
    ds_read_b64 v[58:59], v27
    s_waitcnt lgkmcnt(8)
    v_lshl_add_u32 v28, v28, v17, v18
    v_lshl_add_u32 v29, v29, v13, v14
    ds_read_b64 v[60:61], v28
    ds_read_b64 v[62:63], v29
    s_waitcnt lgkmcnt(8)
    buffer_store_dwordx4 v[44:47], v5, s[20:23], s31 offen sc1
    s_addk_i32 s31, 10240
    s_waitcnt lgkmcnt(6)
    buffer_store_dwordx4 v[48:51], v5, s[20:23], s31 offen sc1
    s_addk_i32 s31, 10240
    s_waitcnt lgkmcnt(4)
    buffer_store_dwordx4 v[52:55], v5, s[20:23], s31 offen sc1
    s_addk_i32 s31, 10240
    s_waitcnt lgkmcnt(2)
    buffer_store_dwordx4 v[56:59], v5, s[20:23], s31 offen sc1
    s_addk_i32 s31, 10240
    s_waitcnt lgkmcnt(0)
    buffer_store_dwordx4 v[60:63], v5, s[20:23], s31 offen sc1
    s_branch mn_start2
ka_ov:
    s_mul_i32 s33, s2, 5120
    s_add_u32 s33, s33, 7340032
    buffer_store_dword v22, v43, s[20:23], s33 offen sc1
    buffer_store_dword v74, v69, s[20:23], s33 offen sc1
    s_branch ka_ov_back
ka_dma:
    s_cmp_eq_u32 s18, 11
    s_cbranch_scc1 ka_cell
    s_mul_i32 s35, s2, 40960
    v_lshl_add_u32 v7, v1, 4, s35
    s_mul_i32 s35, s2, 10240
    v_lshl_add_u32 v8, v1, 4, s35
    s_mov_b32 m0, 74752
    s_waitcnt lgkmcnt(0)
    s_load_dwordx4 s[36:39], s[0:1], 40
    s_barrier
    global_load_lds_dwordx4 v8, s[8:9] offset:0
    global_load_lds_dwordx4 v8, s[8:9] offset:1024
    s_add_u32 m0, m0, 2048
    v_add_u32 v8, 2048, v8
    global_load_lds_dwordx4 v8, s[8:9] offset:0
    global_load_lds_dwordx4 v8, s[8:9] offset:1024
    s_add_u32 m0, m0, 2048
    v_add_u32 v8, 2048, v8
    global_load_lds_dwordx4 v8, s[8:9] offset:0
    global_load_lds_dwordx4 v8, s[8:9] offset:1024
    s_add_u32 m0, m0, 2048
    v_add_u32 v8, 2048, v8
    global_load_lds_dwordx4 v8, s[8:9] offset:0
    global_load_lds_dwordx4 v8, s[8:9] offset:1024
    s_add_u32 m0, m0, 2048
    v_add_u32 v8, 2048, v8
    global_load_lds_dwordx4 v8, s[8:9] offset:0
    global_load_lds_dwordx4 v8, s[8:9] offset:1024
    s_add_u32 m0, m0, 2048
    v_add_u32 v8, 2048, v8
    s_mov_b32 m0, 33792
    s_nop 0
    global_load_lds_dwordx4 v7, s[10:11] offset:0
    global_load_lds_dwordx4 v7, s[10:11] offset:1024
    s_add_u32 m0, m0, 2048
    v_add_u32 v7, 2048, v7
    global_load_lds_dwordx4 v7, s[10:11] offset:0
    global_load_lds_dwordx4 v7, s[10:11] offset:1024
    s_add_u32 m0, m0, 2048
    v_add_u32 v7, 2048, v7
    global_load_lds_dwordx4 v7, s[10:11] offset:0
    global_load_lds_dwordx4 v7, s[10:11] offset:1024
    s_add_u32 m0, m0, 2048
    v_add_u32 v7, 2048, v7
    s_barrier
    global_load_lds_dwordx4 v7, s[10:11] offset:0
    global_load_lds_dwordx4 v7, s[10:11] offset:1024
    s_add_u32 m0, m0, 2048
    v_add_u32 v7, 2048, v7
    global_load_lds_dwordx4 v7, s[10:11] offset:0
    global_load_lds_dwordx4 v7, s[10:11] offset:1024
    s_add_u32 m0, m0, 2048
    v_add_u32 v7, 2048, v7
    global_load_lds_dwordx4 v7, s[10:11] offset:0
    global_load_lds_dwordx4 v7, s[10:11] offset:1024
    s_add_u32 m0, m0, 2048
    v_add_u32 v7, 2048, v7
    global_load_lds_dwordx4 v7, s[10:11] offset:0
    global_load_lds_dwordx4 v7, s[10:11] offset:1024
    s_add_u32 m0, m0, 2048
    v_add_u32 v7, 2048, v7
    global_load_lds_dwordx4 v7, s[10:11] offset:0
    global_load_lds_dwordx4 v7, s[10:11] offset:1024
    s_add_u32 m0, m0, 2048
    v_add_u32 v7, 2048, v7
    global_load_lds_dwordx4 v7, s[10:11] offset:0
    global_load_lds_dwordx4 v7, s[10:11] offset:1024
    s_add_u32 m0, m0, 2048
    v_add_u32 v7, 2048, v7
    global_load_lds_dwordx4 v7, s[10:11] offset:0
    global_load_lds_dwordx4 v7, s[10:11] offset:1024
    s_add_u32 m0, m0, 2048
    v_add_u32 v7, 2048, v7
    global_load_lds_dwordx4 v7, s[10:11] offset:0
    global_load_lds_dwordx4 v7, s[10:11] offset:1024
    s_add_u32 m0, m0, 2048
    v_add_u32 v7, 2048, v7
    global_load_lds_dwordx4 v7, s[10:11] offset:0
    global_load_lds_dwordx4 v7, s[10:11] offset:1024
    s_add_u32 m0, m0, 2048
    v_add_u32 v7, 2048, v7
    global_load_lds_dwordx4 v7, s[10:11] offset:0
    global_load_lds_dwordx4 v7, s[10:11] offset:1024
    s_add_u32 m0, m0, 2048
    v_add_u32 v7, 2048, v7
    global_load_lds_dwordx4 v7, s[10:11] offset:0
    global_load_lds_dwordx4 v7, s[10:11] offset:1024
    s_add_u32 m0, m0, 2048
    v_add_u32 v7, 2048, v7
    global_load_lds_dwordx4 v7, s[10:11] offset:0
    global_load_lds_dwordx4 v7, s[10:11] offset:1024
    s_add_u32 m0, m0, 2048
    v_add_u32 v7, 2048, v7
    global_load_lds_dwordx4 v7, s[10:11] offset:0
    global_load_lds_dwordx4 v7, s[10:11] offset:1024
    s_add_u32 m0, m0, 2048
    v_add_u32 v7, 2048, v7
    global_load_lds_dwordx4 v7, s[10:11] offset:0
    global_load_lds_dwordx4 v7, s[10:11] offset:1024
    s_add_u32 m0, m0, 2048
    v_add_u32 v7, 2048, v7
    global_load_lds_dwordx4 v7, s[10:11] offset:0
    global_load_lds_dwordx4 v7, s[10:11] offset:1024
    s_add_u32 m0, m0, 2048
    v_add_u32 v7, 2048, v7
    global_load_lds_dwordx4 v7, s[10:11] offset:0
    global_load_lds_dwordx4 v7, s[10:11] offset:1024
    s_add_u32 m0, m0, 2048
    v_add_u32 v7, 2048, v7
    global_load_lds_dwordx4 v7, s[10:11] offset:0
    global_load_lds_dwordx4 v7, s[10:11] offset:1024
    s_add_u32 m0, m0, 2048
    v_add_u32 v7, 2048, v7
    s_mov_b32 s35, m0
    s_mov_b32 m0, 148480
    v_lshlrev_b32 v9, 4, v1
    v_add_u32 v10, 4096, v9
    s_waitcnt lgkmcnt(0)
    global_load_lds_dwordx4 v9, s[38:39]
    global_load_lds_dwordx4 v9, s[38:39] offset:1024
    global_load_lds_dwordx4 v9, s[38:39] offset:2048
    global_load_lds_dwordx4 v9, s[38:39] offset:3072
    s_mov_b32 m0, 152576
    s_nop 0
    global_load_lds_dwordx4 v10, s[38:39]
    global_load_lds_dwordx4 v10, s[38:39] offset:1024
    global_load_lds_dwordx4 v10, s[38:39] offset:2048
    global_load_lds_dwordx4 v10, s[38:39] offset:3072
    s_mov_b32 m0, 156672
    s_mov_b64 exec, 0xff
    global_load_lds_dwordx4 v9, s[36:37]
    s_mov_b64 exec, -1
    s_mov_b32 m0, s35
    s_waitcnt vmcnt(0)
    s_barrier
    s_branch mn_start
ka_cell:
    s_and_b32 s28, s2, 7
    s_lshl_b32 s28, s28, 4
    s_lshr_b32 s29, s2, 3
    s_add_u32 s28, s28, s29
    s_waitcnt lgkmcnt(0)
    s_and_b32 s21, s15, 0xffff
    s_mov_b32 s22, 12582912
    s_mov_b32 s23, 0x20000
    s_mov_b32 s20, s14
    s_lshl_b32 s30, s28, 6
    s_add_u32 s30, s30, 8388608
    v_lshlrev_b32 v3, 3, v1
    v_mov_b32 v4, 0
    v_mov_b32 v5, 0
    ds_write_b64 v3, v[4:5]
    v_lshlrev_b32 v26, 4, v1
    v_lshrrev_b32 v6, 2, v1
    v_lshlrev_b32 v6, 13, v6
    v_and_or_b32 v6, v26, 0x30, v6
    v_lshlrev_b32 v27, 8, v1
    s_waitcnt lgkmcnt(0)
    s_barrier
    s_and_b32 s58, s2, 15
    s_lshl_b32 s58, s58, 7
    s_add_u32 s58, s58, 11730944
    v_mov_b32 v86, s58
    global_load_dword v87, v86, s[14:15] sc1
    s_barrier
    ds_read_b128 v[12:15], v26 offset:1024
    s_waitcnt lgkmcnt(0)
    v_add_u32 v17, v12, v13
    v_add_u32 v18, v17, v14
    v_add_u32 v16, v18, v15
    v_mov_b32 v19, v16
    v_lshlrev_b32 v20, 16, v12
    v_add_u32_dpp v16, v16, v16 row_shr:1 row_mask:0xf bank_mask:0xf
    v_lshl_add_u32 v21, v13, 16, v12
    s_nop 0
    v_add_u32_dpp v16, v16, v16 row_shr:2 row_mask:0xf bank_mask:0xf
    v_lshl_add_u32 v22, v14, 16, v17
    s_nop 0
    v_add_u32_dpp v16, v16, v16 row_shr:4 row_mask:0xf bank_mask:0xf
    v_lshl_add_u32 v23, v15, 16, v18
    s_nop 0
    v_add_u32_dpp v16, v16, v16 row_shr:8 row_mask:0xf bank_mask:0xf
    s_nop 1
    v_add_u32_dpp v16, v16, v16 row_bcast:15 row_mask:0xa bank_mask:0xf
    s_nop 1
    v_add_u32_dpp v16, v16, v16 row_bcast:31 row_mask:0xc bank_mask:0xf
    v_sub_u32 v16, v16, v19
    v_mov_b32 v86, 0
    s_waitcnt vmcnt(0)
    ds_write_b32 v86, v87 offset:456
    v_add_u32 v20, v20, v16
    ds_write_b32 v27, v20 offset:12348
    v_add_u32 v21, v21, v16
    ds_write_b32 v27, v21 offset:12412
    v_add_u32 v22, v22, v16
    ds_write_b32 v27, v22 offset:12476
    v_add_u32 v23, v23, v16
    ds_write_b32 v27, v23 offset:12540
    ds_read_b128 v[28:31], v26 offset:12288
    ds_read_b128 v[32:35], v26 offset:13312
    ds_read_b128 v[36:39], v26 offset:14336
    ds_read_b128 v[40:43], v26 offset:15360
    ds_read_b128 v[44:47], v26 offset:16384
    ds_read_b128 v[48:51], v26 offset:17408
    ds_read_b128 v[52:55], v26 offset:18432
    ds_read_b128 v[56:59], v26 offset:19456
    s_waitcnt lgkmcnt(7)
    buffer_store_dwordx4 v[28:31], v6, s[20:23], s30 offen sc1
    ds_read_b128 v[60:63], v26 offset:20480
    s_add_u32 s30, s30, 131072
    s_waitcnt lgkmcnt(7)
    buffer_store_dwordx4 v[32:35], v6, s[20:23], s30 offen sc1
    ds_read_b128 v[64:67], v26 offset:21504
    s_add_u32 s30, s30, 131072
    s_waitcnt lgkmcnt(7)
    buffer_store_dwordx4 v[36:39], v6, s[20:23], s30 offen sc1
    ds_read_b128 v[68:71], v26 offset:22528
    s_add_u32 s30, s30, 131072
    s_waitcnt lgkmcnt(7)
    buffer_store_dwordx4 v[40:43], v6, s[20:23], s30 offen sc1
    ds_read_b128 v[72:75], v26 offset:23552
    s_add_u32 s30, s30, 131072
    s_waitcnt lgkmcnt(7)
    buffer_store_dwordx4 v[44:47], v6, s[20:23], s30 offen sc1
    ds_read_b128 v[76:79], v26 offset:24576
    s_add_u32 s30, s30, 131072
    s_waitcnt lgkmcnt(7)
    buffer_store_dwordx4 v[48:51], v6, s[20:23], s30 offen sc1
    ds_read_b128 v[80:83], v26 offset:25600
    s_add_u32 s30, s30, 131072
    s_waitcnt lgkmcnt(7)
    buffer_store_dwordx4 v[52:55], v6, s[20:23], s30 offen sc1
    ds_read_b128 v[28:31], v26 offset:26624
    s_add_u32 s30, s30, 131072
    s_waitcnt lgkmcnt(7)
    buffer_store_dwordx4 v[56:59], v6, s[20:23], s30 offen sc1
    ds_read_b128 v[32:35], v26 offset:27648
    s_add_u32 s30, s30, 131072
    s_waitcnt lgkmcnt(7)
    buffer_store_dwordx4 v[60:63], v6, s[20:23], s30 offen sc1
    s_add_u32 s30, s30, 131072
    s_waitcnt lgkmcnt(6)
    buffer_store_dwordx4 v[64:67], v6, s[20:23], s30 offen sc1
    s_add_u32 s30, s30, 131072
    s_waitcnt lgkmcnt(5)
    buffer_store_dwordx4 v[68:71], v6, s[20:23], s30 offen sc1
    s_add_u32 s30, s30, 131072
    s_waitcnt lgkmcnt(4)
    buffer_store_dwordx4 v[72:75], v6, s[20:23], s30 offen sc1
    s_add_u32 s30, s30, 131072
    s_waitcnt lgkmcnt(3)
    buffer_store_dwordx4 v[76:79], v6, s[20:23], s30 offen sc1
    s_add_u32 s30, s30, 131072
    s_waitcnt lgkmcnt(2)
    buffer_store_dwordx4 v[80:83], v6, s[20:23], s30 offen sc1
    s_add_u32 s30, s30, 131072
    s_waitcnt lgkmcnt(1)
    buffer_store_dwordx4 v[28:31], v6, s[20:23], s30 offen sc1
    s_add_u32 s30, s30, 131072
    s_waitcnt lgkmcnt(0)
    buffer_store_dwordx4 v[32:35], v6, s[20:23], s30 offen sc1
    s_barrier
    s_waitcnt vmcnt(0)
    s_mov_b64 exec, 1
    v_mov_b32 v2, 0
    v_mov_b32 v3, 1
    s_and_b32 s34, s2, 1
    s_lshl_b32 s35, s34, 7
    s_add_u32 s35, s35, 0
    s_mov_b32 s33, 1
    s_atomic_add s33, s[12:13], s35 glc
    s_mov_b32 s36, 1
    s_lshl_b32 s34, s34, 3
    s_lshr_b32 s34, 15678, s34
    s_and_b32 s34, s34, 0xff
    s_waitcnt lgkmcnt(0)
    s_cmp_eq_u32 s33, s34
    s_cbranch_scc1 ka_bcast
ka_arc:
    s_mov_b64 exec, -1
    s_branch mn_start
ka_pf:
    s_load_dwordx2 s[16:17], s[0:1], 0
    s_load_dwordx2 s[32:33], s[0:1], 56
    s_waitcnt lgkmcnt(0)
    s_and_b32 s34, s2, 7
    s_mul_i32 s34, s34, 917504
    s_add_u32 s24, s16, s34
    s_addc_u32 s25, s17, 0
    s_and_b32 s25, s25, 0xffff
    s_mov_b32 s26, 917504
    s_mov_b32 s27, 0x20000
    s_bfe_u32 s30, s2, 0x40003
    v_lshlrev_b32 v40, 7, v0
    s_mul_i32 s30, s30, 57344
    s_cmp_lg_u32 s18, 9
    s_cbranch_scc1 ka_nowt
    s_bfe_u32 s35, s2, 0x40003
    s_lshl_b32 s35, s35, 13
    v_lshl_add_u32 v46, v1, 7, s35
    global_load_dword v46, v46, s[32:33]
ka_nowt:
ka_pf1:
    s_cmp_ge_u32 s18, 7
    s_cbranch_scc1 ka_pfe
    s_waitcnt vmcnt(0)
    buffer_load_dword v42, v40, s[24:27], s30 offen
    s_cmp_ge_u32 s18, 0
    s_cbranch_scc1 ka_pfe
    s_add_u32 s30, s30, 81920
    buffer_load_dword v43, v40, s[24:27], s30 offen
    s_branch ka_pfe
ka_idle:
    s_waitcnt lgkmcnt(0)
ka_pfe:
    s_cmp_lt_u32 s18, 10
    s_cbranch_scc1 ka_pfb
    s_cmp_eq_u32 s18, 11
    s_cbranch_scc1 ka_pfz
    s_load_dwordx4 s[36:39], s[0:1], 40
    s_mov_b32 m0, 148480
    v_lshlrev_b32 v9, 4, v1
    v_add_u32 v10, 4096, v9
    s_waitcnt lgkmcnt(0)
    global_load_lds_dwordx4 v9, s[38:39]
    global_load_lds_dwordx4 v9, s[38:39] offset:1024
    global_load_lds_dwordx4 v9, s[38:39] offset:2048
    global_load_lds_dwordx4 v9, s[38:39] offset:3072
    s_mov_b32 m0, 152576
    s_nop 0
    global_load_lds_dwordx4 v10, s[38:39]
    global_load_lds_dwordx4 v10, s[38:39] offset:1024
    global_load_lds_dwordx4 v10, s[38:39] offset:2048
    global_load_lds_dwordx4 v10, s[38:39] offset:3072
    s_mov_b32 m0, 156672
    s_mov_b64 exec, 0xff
    global_load_lds_dwordx4 v9, s[36:37]
    s_mov_b64 exec, -1
    s_waitcnt vmcnt(0)
    s_branch ka_pfb
ka_pfz:
    s_and_b32 s58, s2, 15
    s_lshl_b32 s58, s58, 7
    s_add_u32 s58, s58, 11730944
    v_mov_b32 v86, s58
    global_load_dword v87, v86, s[14:15] sc1
    v_lshlrev_b32 v3, 3, v1
    v_mov_b32 v4, 0
    v_mov_b32 v5, 0
    ds_write_b64 v3, v[4:5]
    v_mov_b32 v86, 0
    s_waitcnt vmcnt(0)
    ds_write_b32 v86, v87 offset:456
    s_waitcnt lgkmcnt(0)
ka_pfb:
    s_barrier
    s_branch mn_start
ka_bcast:
    s_mov_b64 exec, -1
    s_add_u32 s34, s14, 11730944
    s_addc_u32 s35, s15, 0
    s_atomic_add s36, s[34:35], 0
    s_atomic_add s36, s[34:35], 128
    s_atomic_add s36, s[34:35], 256
    s_atomic_add s36, s[34:35], 384
    s_atomic_add s36, s[34:35], 512
    s_atomic_add s36, s[34:35], 640
    s_atomic_add s36, s[34:35], 768
    s_atomic_add s36, s[34:35], 896
    s_atomic_add s36, s[34:35], 1024
    s_atomic_add s36, s[34:35], 1152
    s_atomic_add s36, s[34:35], 1280
    s_atomic_add s36, s[34:35], 1408
    s_atomic_add s36, s[34:35], 1536
    s_atomic_add s36, s[34:35], 1664
    s_atomic_add s36, s[34:35], 1792
    s_atomic_add s36, s[34:35], 1920
    s_branch mn_start
ka_end:
    s_endpgm
mn_start:
    s_waitcnt vmcnt(0) lgkmcnt(0)
mn_start2:
    s_cmp_ge_u32 s2, 256
    s_cbranch_scc1 mn_end
    s_load_dwordx2 s[54:55], s[0:1], 80
    s_load_dwordx2 s[50:51], s[0:1], 0
    s_load_dwordx2 s[60:61], s[0:1], 72
    v_lshrrev_b32 v56, 6, v0
    s_and_b32 s48, s2, 7
    v_readfirstlane_b32 s16, v56
    s_lshr_b32 s47, s2, 3
    s_lshl_b32 s22, s48, 5
    s_add_u32 s22, s22, s47
    s_lshl_b32 s22, s22, 13
    s_add_u32 s22, s22, 8388608
    s_mov_b32 s10, 12582912
    s_mov_b32 s11, 0x20000
    s_and_b32 s17, s16, 3
    s_movk_i32 s20, 20
    s_mov_b32 s24, 0
    s_cmp_ge_u32 s16, 8
    s_cbranch_scc1 gm_main
    v_lshrrev_b32 v56, 6, v0
    v_lshlrev_b32 v55, 1, v0
    v_and_b32 v55, 0x78, v55
    v_or_b32 v55, v55, v56
    v_cmp_gt_u32 vcc, 125, v55
    v_mul_u32_u24 v46, 5120, v55
    v_add_u32 v46, 7340032, v46
    v_bfrev_b32 v56, 2
    v_lshlrev_b32 v44, 4, v0
    v_cndmask_b32 v44, v56, v44, vcc
    v_and_b32 v51, 63, v0
    s_waitcnt lgkmcnt(0)
    s_mov_b32 s8, s54
    s_and_b32 s9, s55, 0xffff
    v_mov_b32 v24, 0
    s_lshr_b32 s18, s16, 2
    s_lshl_b32 s53, s17, 7
    s_add_u32 s4, s50, s53
    s_addc_u32 s5, s51, 0
    s_and_b32 s5, s5, 0xffff
    s_or_b32 s5, s5, 0x08000000
    s_movk_i32 s6, 10000
    s_mov_b32 s7, 0x20000
    s_mul_i32 s40, s16, 15360
    s_add_u32 s40, s40, 40960
    v_lshl_add_u32 v87, v51, 3, s40
    s_add_u32 s40, s40, 9216
    s_add_u32 s41, s40, 1024
    s_add_u32 s42, s40, 2048
    s_add_u32 s43, s40, 3072
    s_add_u32 s44, s40, 4096
    s_add_u32 s45, s40, 5120
    v_and_b32 v55, 3, v0
    v_bfe_u32 v56, v0, 2, 2
    v_bfe_u32 v57, v0, 4, 1
    v_bfe_u32 v53, v0, 5, 1
    v_lshlrev_b32 v1, 3, v55
    v_lshl_add_u32 v1, v57, 5, v1
    v_lshl_add_u32 v1, v56, 6, v1
    v_lshl_add_u32 v1, v53, 8, v1
    v_add_u32 v1, s40, v1
    v_lshlrev_b32 v5, 4, v55
    v_lshl_add_u32 v5, v57, 6, v5
    v_lshl_add_u32 v5, v56, 9, v5
    v_mov_b32 v7, v5
    v_bfe_u32 v55, v0, 2, 1
    v_lshlrev_b32 v86, 4, v53
    v_lshl_or_b32 v86, v55, 18, v86
    v_mov_b32 v48, 1
    v_lshlrev_b32 v47, 2, v51
    v_bfe_u32 v2, v0, 5, 1
    v_bfe_u32 v3, v0, 3, 2
    v_and_b32 v35, 3, v0
    v_lshl_add_u32 v3, v3, 2, v35
    v_mul_u32_u24 v49, 20, v2
    v_lshrrev_b32 v18, 2, v51
    v_lshl_add_u32 v18, v35, 4, v18
    v_mov_b32 v50, 0x3fff
    s_lshl_b32 s37, s16, 2
    v_mov_b32 v59, s37
    s_sub_u32 s36, s16, 1
    v_mov_b64 v[88:89], 0
    v_mov_b64 v[90:91], 0
    v_mov_b64 v[92:93], 0
    v_mov_b64 v[94:95], 0
    v_mov_b64 v[96:97], 0
    v_mov_b64 v[98:99], 0
    v_mov_b64 v[100:101], 0
    v_mov_b64 v[102:103], 0
    v_mov_b64 v[104:105], 0
    v_mov_b64 v[106:107], 0
    v_mov_b64 v[108:109], 0
    v_mov_b64 v[110:111], 0
    v_mov_b64 v[112:113], 0
    v_mov_b64 v[114:115], 0
    v_mov_b64 v[116:117], 0
    v_mov_b64 v[118:119], 0
    v_mov_b64 v[120:121], 0
    v_mov_b64 v[122:123], 0
    v_mov_b64 v[124:125], 0
    v_mov_b64 v[126:127], 0
    v_mov_b64 v[128:129], 0
    v_mov_b64 v[130:131], 0
    v_mov_b64 v[132:133], 0
    v_mov_b64 v[134:135], 0
    v_mov_b64 v[136:137], 0
    v_mov_b64 v[138:139], 0
    v_mov_b64 v[140:141], 0
    v_mov_b64 v[142:143], 0
    v_mov_b64 v[144:145], 0
    v_mov_b64 v[146:147], 0
    v_mov_b64 v[148:149], 0
    v_mov_b64 v[150:151], 0
    v_mov_b64 v[152:153], 0
    v_mov_b64 v[154:155], 0
    v_mov_b64 v[156:157], 0
    v_mov_b64 v[158:159], 0
    v_mov_b64 v[160:161], 0
    v_mov_b64 v[162:163], 0
    v_mov_b64 v[164:165], 0
    v_mov_b64 v[166:167], 0
    v_bfe_u32 v8, v0, 2, 2
    v_bfe_u32 v10, v0, 5, 1
    v_lshlrev_b32 v9, 3, v8
    v_add_u32 v9, 156672, v9
    v_lshl_add_u32 v8, v10, 3, v8
    v_lshlrev_b32 v8, 9, v8
    v_bfe_u32 v10, v0, 4, 1
    v_lshl_add_u32 v8, v10, 5, v8
    v_lshl_add_u32 v8, v35, 3, v8
    v_lshl_add_u32 v8, s17, 7, v8
    v_add_u32 v8, 148480, v8
    ds_read_b64_tr_b16 v[76:77], v9
    ds_read_b64_tr_b16 v[78:79], v9 offset:32
    ds_read_b64_tr_b16 v[80:81], v9 offset:64
    ds_read_b64_tr_b16 v[82:83], v9 offset:96
    ds_read_b64_tr_b16 v[68:69], v8
    ds_read_b64_tr_b16 v[70:71], v8 offset:2048
    ds_read_b64_tr_b16 v[72:73], v8 offset:64
    ds_read_b64_tr_b16 v[74:75], v8 offset:2112
    s_cmp_ge_u32 s2, 125
    s_waitcnt vmcnt(0)
    s_cbranch_scc1 mn_noarr
    v_mov_b32 v55, 0
    v_mov_b32 v56, 1
    s_mov_b64 exec, 1
    ds_add_u32 v55, v56 offset:448
    s_mov_b64 exec, -1
mn_noarr:
    s_cmp_lg_u32 s16, 7
    s_cbranch_scc1 mn_sp1
    v_mov_b32 v57, 0
    ds_read_b32 v57, v57 offset:456
    s_waitcnt lgkmcnt(0)
    v_readfirstlane_b32 s59, v57
    s_and_b32 s62, s2, 15
    s_lshl_b32 s62, s62, 7
    s_add_u32 s62, s62, 11730944
    v_mov_b32 v55, s62
    v_lshlrev_b32 v56, 6, v0
    v_and_b32 v56, 0xc0, v56
    s_mov_b32 s63, 0x100000
mn_poll1m:
    s_sub_u32 s63, s63, 1
    s_cbranch_scc1 mn_poll1x
    global_load_dword v57, v55, s[54:55] sc1
    s_waitcnt vmcnt(0)
    v_readfirstlane_b32 s62, v57
    s_sub_u32 s62, s62, s59
    s_bfe_u32 s62, s62, 1048576
    s_cmp_eq_u32 s62, 2
    s_cbranch_scc1 mn_poll1x
    s_sleep 6
    s_and_b32 s62, s63, 63
    s_cbranch_scc1 mn_poll1m
    global_load_dword v57, v56, s[60:61] sc1
    s_waitcnt vmcnt(0)
    v_add_u32_dpp v57, v57, v57 quad_perm:[2,3,0,1] row_mask:0xf bank_mask:0xf
    s_nop 0
    v_readlane_b32 s62, v57, 0
    s_cmp_lt_u32 s62, 125
    s_cbranch_scc1 mn_poll1m
mn_poll1x:
    v_mov_b32 v55, 0
    ds_write_b32 v55, v48 offset:308
mn_sp1x:
    buffer_load_dwordx4 v[20:23], v44, s[8:11], s22 offen sc1
    s_mov_b32 s52, 0x100000
    s_waitcnt vmcnt(0)
    v_mov_b32_dpp v58, v23 quad_perm:[3,3,3,3] row_mask:0xf bank_mask:0xf
    v_cmp_le_u32 vcc, s52, v58
    s_cbranch_vccnz mn_w5
mn_count:
    v_cmpx_gt_i32 vcc, 0, v20
    s_cbranch_execz mn_cn_done
    v_lshrrev_b32 v25, 23, v20
    v_and_b32 v25, 0xfc, v25
    ds_add_rtn_u32 v30, v25, v48
    v_cmpx_gt_i32 vcc, 0, v21
    s_cbranch_execz mn_cn_done
    v_lshrrev_b32 v26, 23, v21
    v_and_b32 v26, 0xfc, v26
    ds_add_rtn_u32 v31, v26, v48
    v_cmpx_gt_i32 vcc, 0, v22
    s_cbranch_execz mn_cn_done
    v_lshrrev_b32 v27, 23, v22
    v_and_b32 v27, 0xfc, v27
    ds_add_rtn_u32 v32, v27, v48
    v_cmpx_gt_i32 vcc, 0, v23
    s_cbranch_execz mn_cn_done
    v_lshrrev_b32 v28, 23, v23
    v_and_b32 v28, 0xfc, v28
    ds_add_rtn_u32 v33, v28, v48
    v_cmpx_gt_i32 vcc, 0, v24
    s_cbranch_execz mn_cn_done
    v_lshrrev_b32 v29, 23, v24
    v_and_b32 v29, 0xfc, v29
    ds_add_rtn_u32 v34, v29, v48
mn_cn_done:
    s_mov_b64 exec, -1
    v_lshrrev_b32 v42, 16, v58
    v_subrev_u32 v42, s24, v42
    v_med3_i32 v42, v42, 0, s20
    v_mov_b32 v43, v42
    v_mov_b32 v52, 0
    s_lshl_b32 s52, s18, 5
    v_add_u32_dpp v43, v43, v43 row_shr:4 row_mask:0xf bank_mask:0xf
    s_add_u32 s53, s52, 31
    s_movk_i32 s48, 0x3fff
    v_add_u32_dpp v43, v43, v43 row_shr:8 row_mask:0xf bank_mask:0xf
    s_nop 0
    s_nop 0
    v_add_u32_dpp v43, v43, v43 row_bcast:15 row_mask:0xa bank_mask:0xf
    s_nop 0
    s_nop 0
    v_add_u32_dpp v43, v43, v43 row_bcast:31 row_mask:0xc bank_mask:0xf
    s_brev_b64 exec, 1
    ds_write_b32 v59, v43 offset:384
    s_mov_b64 exec, -1
    v_sub_u32 v41, v43, v42
    s_waitcnt lgkmcnt(0)
    s_barrier
    ds_read_b32 v55, v47 offset:384
    ds_read_b32 v53, v47 offset:0
    ds_read_b32 v52, v52 offset:272
    s_waitcnt lgkmcnt(2)
    v_add_u32_dpp v55, v55, v55 row_shr:1 row_mask:0xf bank_mask:0xf
    s_waitcnt lgkmcnt(1)
    v_mov_b32 v54, v53
    v_add_u32_dpp v55, v55, v55 row_shr:2 row_mask:0xf bank_mask:0xf
    v_sub_u32 v53, v49, v53
    v_add_u32 v41, v41, v35
    v_add_u32_dpp v55, v55, v55 row_shr:4 row_mask:0xf bank_mask:0xf
    s_cmp_eq_u32 s16, 0
    v_readlane_b32 s49, v55, s36
    v_readlane_b32 s23, v55, 7
    s_cmov_b32 s49, 0
    s_add_u32 s49, s49, 72
    v_add_u32_dpp v54, v54, v54 row_shr:1 row_mask:0xf bank_mask:0xf
    v_add_u32 v41, s49, v41
    v_lshlrev_b32 v41, 16, v41
    v_add_u32_dpp v54, v54, v54 row_shr:2 row_mask:0xf bank_mask:0xf
    v_and_or_b32 v36, v20, s48, v41
    v_add_u32 v41, 262144, v41
    v_add_u32_dpp v54, v54, v54 row_shr:4 row_mask:0xf bank_mask:0xf
    v_and_or_b32 v37, v21, s48, v41
    v_add_u32 v41, 262144, v41
    v_add_u32_dpp v54, v54, v54 row_shr:8 row_mask:0xf bank_mask:0xf
    v_and_or_b32 v38, v22, s48, v41
    v_add_u32 v41, 262144, v41
    v_add_u32_dpp v54, v54, v54 row_bcast:15 row_mask:0xa bank_mask:0xf
    v_and_or_b32 v39, v23, s48, v41
    v_add_u32 v41, 262144, v41
    v_add_u32_dpp v54, v54, v54 row_bcast:31 row_mask:0xc bank_mask:0xf
    v_add_u32 v53, v53, v54
    v_add_u32 v54, v54, v49
    ds_bpermute_b32 v25, v25, v53
    ds_bpermute_b32 v26, v26, v53
    ds_bpermute_b32 v27, v27, v53
    ds_bpermute_b32 v28, v28, v53
    ds_bpermute_b32 v29, v29, v53
    v_and_or_b32 v40, v24, s48, v41
    v_bfe_u32 v56, v20, 14, 5
    v_lshl_or_b32 v36, v56, 26, v36
    v_bfe_u32 v56, v21, 14, 5
    v_lshl_or_b32 v37, v56, 26, v37
    v_bfe_u32 v56, v22, 14, 5
    v_lshl_or_b32 v38, v56, 26, v38
    v_bfe_u32 v56, v23, 14, 5
    v_lshl_or_b32 v39, v56, 26, v39
    v_bfe_u32 v56, v24, 14, 5
    v_lshl_or_b32 v40, v56, 26, v40
    v_readlane_b32 s33, v54, s53
    v_readlane_b32 s32, v53, s52
    s_cmp_gt_u32 s23, 773
    s_cbranch_scc1 mn_ovf
    v_add_lshl_u32 v55, s33, v51, 2
    s_mov_b32 exec_lo, 1048575
    s_mov_b32 exec_hi, 0
    ds_write_b32 v55, v50 offset:512
    s_mov_b64 exec, -1
    v_add_lshl_u32 v2, s32, v2, 2
    v_add_lshl_u32 v3, s32, v3, 2
    v_add_lshl_u32 v18, s32, v18, 2
    s_waitcnt lgkmcnt(1)
    v_readfirstlane_b32 s21, v52
    v_cmpx_gt_i32 vcc, 0, v20
    s_cbranch_execz mn_w2_done
    v_add_lshl_u32 v25, v25, v30, 2
    ds_write_b32 v25, v36 offset:512
    v_cmpx_gt_i32 vcc, 0, v21
    s_cbranch_execz mn_w2_done
    v_add_lshl_u32 v26, v26, v31, 2
    ds_write_b32 v26, v37 offset:512
    v_cmpx_gt_i32 vcc, 0, v22
    s_cbranch_execz mn_w2_done
    v_add_lshl_u32 v27, v27, v32, 2
    ds_write_b32 v27, v38 offset:512
    v_cmpx_gt_i32 vcc, 0, v23
    s_cbranch_execz mn_w2_done
    v_add_lshl_u32 v28, v28, v33, 2
    ds_write_b32 v28, v39 offset:512
    v_cmpx_gt_i32 vcc, 0, v24
    s_cbranch_execz mn_w2_done
    v_add_lshl_u32 v29, v29, v34, 2
    ds_write_b32 v29, v40 offset:512
mn_w2_done:
    s_mov_b64 exec, -1
    s_mov_b32 m0, s40
    s_sub_u32 s32, s32, 3
    s_sub_u32 s57, s33, s32
    s_lshr_b32 s57, s57, 2
    s_waitcnt lgkmcnt(0)
    s_barrier
    ds_read_u16 v4, v2 offset:512
    ds_read_u16 v6, v2 offset:520
    ds_read_u16 v8, v18 offset:514
    ds_read_u16 v84, v3 offset:514
    ds_read_u16 v22, v2 offset:528
    ds_read_u16 v23, v2 offset:536
    ds_read_u16 v24, v2 offset:544
    ds_read_u16 v25, v2 offset:552
    ds_read_u16 v26, v2 offset:560
    ds_read_u16 v27, v2 offset:568
    s_sub_u32 s53, s53, 4
    v_readlane_b32 s84, v54, s53
    s_add_u32 s53, s53, 1
    v_readlane_b32 s85, v54, s53
    s_add_u32 s53, s53, 1
    v_readlane_b32 s86, v54, s53
    s_add_u32 s53, s53, 1
    v_readlane_b32 s87, v54, s53
    s_waitcnt lgkmcnt(8)
    buffer_load_dwordx4 v[4:5], s[4:7], 0 idxen offen lds
    s_mov_b32 m0, s41
    s_waitcnt lgkmcnt(6)
    buffer_load_dwordx4 v[6:7], s[4:7], 0 idxen offen lds
    v_lshrrev_b32 v11, 8, v8
    v_and_b32 v8, 0x3ff, v8
    v_mul_u32_u24 v8, 48, v8
    v_and_b32 v84, 0x3ff, v84
    v_mad_u32_u24 v84, v84, 48, v86
    v_xor_b32 v85, 0x40000, v84
    s_waitcnt lgkmcnt(0)
    s_mov_b32 m0, s42
    v_mov_b32 v4, v22
    buffer_load_dwordx4 v[4:5], s[4:7], 0 idxen offen lds
    s_mov_b32 m0, s43
    v_mov_b32 v4, v23
    buffer_load_dwordx4 v[4:5], s[4:7], 0 idxen offen lds
    s_mov_b32 m0, s44
    v_mov_b32 v4, v24
    buffer_load_dwordx4 v[4:5], s[4:7], 0 idxen offen lds
    s_mov_b32 m0, s45
    v_mov_b32 v4, v25
    buffer_load_dwordx4 v[4:5], s[4:7], 0 idxen offen lds
    s_sub_u32 s84, s84, s32
    s_lshr_b32 s84, s84, 2
    s_sub_u32 s85, s85, s32
    s_lshr_b32 s85, s85, 2
    s_sub_u32 s86, s86, s32
    s_lshr_b32 s86, s86, 2
    s_sub_u32 s87, s87, s32
    s_lshr_b32 s87, s87, 2
    s_sub_u32 s88, s57, s87
    s_sub_u32 s87, s87, s86
    s_sub_u32 s86, s86, s85
    s_sub_u32 s85, s85, s84
    s_cmp_lg_u32 s21, 0
    s_cselect_b32 s19, s57, s84
    s_mov_b32 s58, 0
    s_mov_b32 s35, 0
    s_sub_i32 s34, s57, 4
    s_max_i32 s34, s34, 0
    v_min_u32 v0, 1, v51
    v_lshlrev_b32 v0, 18, v0
    v_lshl_add_u32 v0, s17, 2, v0
    s_lshl_b32 s52, s18, 1
    s_sub_i32 s52, 1, s52
    s_mul_i32 s53, s52, s57
    s_add_i32 s53, s53, 0
    v_mov_b32 v19, s53
    ds_add_u32 v0, v19 offset:288
    s_mul_i32 s30, s52, -4
    s_lshl_b32 s26, s18, 31
    s_setprio 2
    v_and_b32 v11, 0x7c, v11
    v_or_b32 v11, 0xc000, v11
    v_lshlrev_b32 v10, 16, v11
    s_nop 1
    v_or_b32_dpp v19, v10, v11 row_shl:4 row_mask:0xf bank_mask:0xf bound_ctrl:0
    s_barrier
    ds_read_b64 v[8:9], v8 offset:352
    ds_read_b128 v[60:63], v84 offset:320
    ds_read_b128 v[64:67], v85 offset:320
    v_mov_b32 v4, v26
    v_mov_b32 v6, v27
    s_waitcnt lgkmcnt(2)
    v_mfma_f32_4x4x4_16b_bf16 v[28:31], v[8:9], v[76:77], 0
    v_mfma_f32_4x4x4_16b_bf16 v[32:35], v[8:9], v[78:79], 0
    v_mfma_f32_4x4x4_16b_bf16 v[36:39], v[8:9], v[80:81], 0
    v_mfma_f32_4x4x4_16b_bf16 v[40:43], v[8:9], v[82:83], 0
    s_waitcnt lgkmcnt(0)
    v_mfma_f32_32x32x16_bf16 v[44:59], v[60:63], v[68:71], 0
    v_mfma_f32_32x32x16_bf16 v[44:59], v[64:67], v[72:75], v[44:59]
    s_waitcnt vmcnt(4)
    ds_read_b64_tr_b16 v[20:21], v1 offset:0
    ds_read_b64_tr_b16 v[22:23], v1 offset:512
    ds_read_b64_tr_b16 v[24:25], v1 offset:1024
    ds_read_b64_tr_b16 v[26:27], v1 offset:1536
    v_cvt_pk_bf16_f32 v12, v28, v32
    v_cvt_pk_bf16_f32 v14, v29, v33
    v_cvt_pk_bf16_f32 v16, v30, v34
    v_cvt_pk_bf16_f32 v13, v36, v40
    v_cvt_pk_bf16_f32 v15, v37, v41
    v_cvt_pk_bf16_f32 v17, v38, v42
    s_set_gpr_idx_on s40, gpr_idx(SRC2,DST)
    s_mov_b32 m0, s40
    s_waitcnt lgkmcnt(2)
    buffer_load_dwordx4 v[4:5], s[4:7], 0 idxen offen lds
    s_mov_b32 m0, s41
    s_waitcnt lgkmcnt(0)
    buffer_load_dwordx4 v[6:7], s[4:7], 0 idxen offen lds
    s_sub_u32 s19, s19, 1
    s_cbranch_scc1 mn_st12
mn_st12_back:
mn_loop:
    v_mfma_f32_4x4x4_16b_bf16 v[28:31], v[12:13], v[20:21], 0 cbsz:4 abid:0
    v_mfma_f32_4x4x4_16b_bf16 v[32:35], v[12:13], v[22:23], 0 cbsz:4 abid:1
    v_mfma_f32_4x4x4_16b_bf16 v[36:39], v[12:13], v[24:25], 0 cbsz:4 abid:2
    v_mfma_f32_4x4x4_16b_bf16 v[40:43], v[12:13], v[26:27], 0 cbsz:4 abid:3
    ds_read_u16 v4, v2 offset:576
    ds_read_u16 v6, v2 offset:584
    v_readlane_b32 s28, v19, 0
    v_readlane_b32 s29, v19, 8
    s_waitcnt vmcnt(5)
    ds_read_b64_tr_b16 v[20:21], v1 offset:2048
    ds_read_b64_tr_b16 v[22:23], v1 offset:2560
    s_waitcnt vmcnt(4)
    ds_read_b64_tr_b16 v[24:25], v1 offset:3072
    ds_read_b64_tr_b16 v[26:27], v1 offset:3584
    s_sub_u32 s34, s34, 1
    s_cmov_b32 s35, 0x30000
    s_mov_b32 m0, s28
    v_fmac_f32 v88, v28, v44
    v_fmac_f32 v89, v29, v44
    v_fmac_f32 v90, v30, v44
    v_fmac_f32 v91, v31, v44
    s_lshr_b32 m0, s28, 16
    v_fmac_f32 v88, v32, v45
    v_fmac_f32 v89, v33, v45
    v_fmac_f32 v90, v34, v45
    v_fmac_f32 v91, v35, v45
    s_mov_b32 m0, s29
    v_fmac_f32 v88, v36, v46
    v_fmac_f32 v89, v37, v46
    v_fmac_f32 v90, v38, v46
    v_fmac_f32 v91, v39, v46
    s_lshr_b32 m0, s29, 16
    v_fmac_f32 v88, v40, v47
    v_fmac_f32 v89, v41, v47
    v_fmac_f32 v90, v42, v47
    v_fmac_f32 v91, v43, v47
    s_or_b32 m0, s42, s35
    s_waitcnt lgkmcnt(2)
    buffer_load_dwordx4 v[4:5], s[4:7], 0 idxen offen lds
    s_or_b32 m0, s43, s35
    s_waitcnt lgkmcnt(0)
    buffer_load_dwordx4 v[6:7], s[4:7], 0 idxen offen lds
    s_sub_u32 s19, s19, 1
    s_cbranch_scc1 mn_st0
mn_st0_back:
    v_mfma_f32_4x4x4_16b_bf16 v[28:31], v[12:13], v[20:21], 0 cbsz:4 abid:4
    v_mfma_f32_4x4x4_16b_bf16 v[32:35], v[12:13], v[22:23], 0 cbsz:4 abid:5
    v_mfma_f32_4x4x4_16b_bf16 v[36:39], v[12:13], v[24:25], 0 cbsz:4 abid:6
    v_mfma_f32_4x4x4_16b_bf16 v[40:43], v[12:13], v[26:27], 0 cbsz:4 abid:7
    ds_read_u16 v4, v2 offset:592
    ds_read_u16 v6, v2 offset:600
    v_readlane_b32 s28, v19, 16
    v_readlane_b32 s29, v19, 24
    ds_read_u16 v84, v3 offset:578
    s_waitcnt vmcnt(5)
    ds_read_b64_tr_b16 v[20:21], v1 offset:4096
    ds_read_b64_tr_b16 v[22:23], v1 offset:4608
    s_waitcnt vmcnt(4)
    ds_read_b64_tr_b16 v[24:25], v1 offset:5120
    ds_read_b64_tr_b16 v[26:27], v1 offset:5632
    s_sub_u32 s34, s34, 1
    s_cmov_b32 s35, 0x30000
    s_mov_b32 m0, s28
    v_fmac_f32 v88, v28, v48
    v_fmac_f32 v89, v29, v48
    v_fmac_f32 v90, v30, v48
    v_fmac_f32 v91, v31, v48
    s_lshr_b32 m0, s28, 16
    v_fmac_f32 v88, v32, v49
    v_fmac_f32 v89, v33, v49
    v_fmac_f32 v90, v34, v49
    v_fmac_f32 v91, v35, v49
    s_mov_b32 m0, s29
    v_fmac_f32 v88, v36, v50
    v_fmac_f32 v89, v37, v50
    v_fmac_f32 v90, v38, v50
    v_fmac_f32 v91, v39, v50
    s_lshr_b32 m0, s29, 16
    v_fmac_f32 v88, v40, v51
    v_fmac_f32 v89, v41, v51
    v_fmac_f32 v90, v42, v51
    v_fmac_f32 v91, v43, v51
    s_or_b32 m0, s44, s35
    s_waitcnt lgkmcnt(2)
    buffer_load_dwordx4 v[4:5], s[4:7], 0 idxen offen lds
    s_or_b32 m0, s45, s35
    s_waitcnt lgkmcnt(0)
    buffer_load_dwordx4 v[6:7], s[4:7], 0 idxen offen lds
    s_sub_u32 s19, s19, 1
    s_cbranch_scc1 mn_st1
mn_st1_back:
    v_mfma_f32_4x4x4_16b_bf16 v[28:31], v[12:13], v[20:21], 0 cbsz:4 abid:8
    v_mfma_f32_4x4x4_16b_bf16 v[32:35], v[12:13], v[22:23], 0 cbsz:4 abid:9
    v_mfma_f32_4x4x4_16b_bf16 v[36:39], v[12:13], v[24:25], 0 cbsz:4 abid:10
    v_mfma_f32_4x4x4_16b_bf16 v[40:43], v[12:13], v[26:27], 0 cbsz:4 abid:11
    ds_read_u16 v4, v2 offset:608
    ds_read_u16 v6, v2 offset:616
    v_readlane_b32 s28, v19, 32
    v_readlane_b32 s29, v19, 40
    v_and_b32 v84, 0x3ff, v84
    v_mad_u32_u24 v84, v84, 48, v86
    v_xor_b32 v85, 0x40000, v84
    ds_read_b128 v[60:63], v84 offset:320
    ds_read_b128 v[64:67], v85 offset:320
    s_waitcnt vmcnt(5)
    ds_read_b64_tr_b16 v[20:21], v1 offset:0
    ds_read_b64_tr_b16 v[22:23], v1 offset:512
    s_waitcnt vmcnt(4)
    ds_read_b64_tr_b16 v[24:25], v1 offset:1024
    ds_read_b64_tr_b16 v[26:27], v1 offset:1536
    s_sub_u32 s34, s34, 1
    s_cmov_b32 s35, 0x30000
    s_mov_b32 m0, s28
    v_fmac_f32 v88, v28, v52
    v_fmac_f32 v89, v29, v52
    v_fmac_f32 v90, v30, v52
    v_fmac_f32 v91, v31, v52
    s_lshr_b32 m0, s28, 16
    v_fmac_f32 v88, v32, v53
    v_fmac_f32 v89, v33, v53
    v_fmac_f32 v90, v34, v53
    v_fmac_f32 v91, v35, v53
    s_mov_b32 m0, s29
    v_fmac_f32 v88, v36, v54
    v_fmac_f32 v89, v37, v54
    v_fmac_f32 v90, v38, v54
    v_fmac_f32 v91, v39, v54
    s_lshr_b32 m0, s29, 16
    v_fmac_f32 v88, v40, v55
    v_fmac_f32 v89, v41, v55
    v_fmac_f32 v90, v42, v55
    v_fmac_f32 v91, v43, v55
    s_or_b32 m0, s40, s35
    s_waitcnt lgkmcnt(2)
    buffer_load_dwordx4 v[4:5], s[4:7], 0 idxen offen lds
    s_or_b32 m0, s41, s35
    s_waitcnt lgkmcnt(0)
    buffer_load_dwordx4 v[6:7], s[4:7], 0 idxen offen lds
    s_sub_u32 s19, s19, 1
    s_cbranch_scc1 mn_st2
mn_st2_back:
    v_mfma_f32_4x4x4_16b_bf16 v[28:31], v[12:13], v[20:21], 0 cbsz:4 abid:12
    v_mfma_f32_4x4x4_16b_bf16 v[32:35], v[12:13], v[22:23], 0 cbsz:4 abid:13
    v_mfma_f32_4x4x4_16b_bf16 v[36:39], v[12:13], v[24:25], 0 cbsz:4 abid:14
    v_mfma_f32_4x4x4_16b_bf16 v[40:43], v[12:13], v[26:27], 0 cbsz:4 abid:15
    ds_read_u16 v4, v2 offset:624
    ds_read_u16 v6, v2 offset:632
    v_readlane_b32 s28, v19, 48
    v_readlane_b32 s29, v19, 56
    v_mov_b32 v85, s30
    ds_add_rtn_u32 v85, v0, v85 offset:288
    s_waitcnt vmcnt(5)
    ds_read_b64_tr_b16 v[20:21], v1 offset:2048
    ds_read_b64_tr_b16 v[22:23], v1 offset:2560
    s_waitcnt vmcnt(4)
    ds_read_b64_tr_b16 v[24:25], v1 offset:3072
    ds_read_b64_tr_b16 v[26:27], v1 offset:3584
    s_sub_u32 s34, s34, 1
    s_cmov_b32 s35, 0x30000
    s_mov_b32 m0, s28
    v_fmac_f32 v88, v28, v56
    v_fmac_f32 v89, v29, v56
    v_fmac_f32 v90, v30, v56
    v_fmac_f32 v91, v31, v56
    s_lshr_b32 m0, s28, 16
    v_fmac_f32 v88, v32, v57
    v_fmac_f32 v89, v33, v57
    v_fmac_f32 v90, v34, v57
    v_fmac_f32 v91, v35, v57
    s_mov_b32 m0, s29
    v_fmac_f32 v88, v36, v58
    v_fmac_f32 v89, v37, v58
    v_fmac_f32 v90, v38, v58
    v_fmac_f32 v91, v39, v58
    s_lshr_b32 m0, s29, 16
    v_fmac_f32 v88, v40, v59
    v_fmac_f32 v89, v41, v59
    v_fmac_f32 v90, v42, v59
    v_fmac_f32 v91, v43, v59
    s_or_b32 m0, s42, s35
    v_mfma_f32_32x32x16_bf16 v[44:59], v[60:63], v[68:71], 0
    v_mfma_f32_32x32x16_bf16 v[44:59], v[64:67], v[72:75], v[44:59]
    s_waitcnt lgkmcnt(2)
    buffer_load_dwordx4 v[4:5], s[4:7], 0 idxen offen lds
    s_or_b32 m0, s43, s35
    s_waitcnt lgkmcnt(0)
    buffer_load_dwordx4 v[6:7], s[4:7], 0 idxen offen lds
    v_readfirstlane_b32 s27, v85
    s_setprio 2
    s_xor_b32 s27, s27, s26
    s_cmp_ge_i32 s27, 0
    s_cbranch_scc1 mn_pr3
    s_setprio 1
mn_pr3:
    s_sub_u32 s19, s19, 1
    s_cbranch_scc1 mn_st3
mn_st3_back:
    v_mfma_f32_4x4x4_16b_bf16 v[28:31], v[14:15], v[20:21], 0 cbsz:4 abid:0
    v_mfma_f32_4x4x4_16b_bf16 v[32:35], v[14:15], v[22:23], 0 cbsz:4 abid:1
    v_mfma_f32_4x4x4_16b_bf16 v[36:39], v[14:15], v[24:25], 0 cbsz:4 abid:2
    v_mfma_f32_4x4x4_16b_bf16 v[40:43], v[14:15], v[26:27], 0 cbsz:4 abid:3
    ds_read_u16 v4, v2 offset:640
    ds_read_u16 v6, v2 offset:648
    v_readlane_b32 s28, v19, 1
    v_readlane_b32 s29, v19, 9
    s_waitcnt vmcnt(5)
    ds_read_b64_tr_b16 v[20:21], v1 offset:4096
    ds_read_b64_tr_b16 v[22:23], v1 offset:4608
    s_waitcnt vmcnt(4)
    ds_read_b64_tr_b16 v[24:25], v1 offset:5120
    ds_read_b64_tr_b16 v[26:27], v1 offset:5632
    s_sub_u32 s34, s34, 1
    s_cmov_b32 s35, 0x30000
    s_mov_b32 m0, s28
    v_fmac_f32 v88, v28, v44
    v_fmac_f32 v89, v29, v44
    v_fmac_f32 v90, v30, v44
    v_fmac_f32 v91, v31, v44
    s_lshr_b32 m0, s28, 16
    v_fmac_f32 v88, v32, v45
    v_fmac_f32 v89, v33, v45
    v_fmac_f32 v90, v34, v45
    v_fmac_f32 v91, v35, v45
    s_mov_b32 m0, s29
    v_fmac_f32 v88, v36, v46
    v_fmac_f32 v89, v37, v46
    v_fmac_f32 v90, v38, v46
    v_fmac_f32 v91, v39, v46
    s_lshr_b32 m0, s29, 16
    v_fmac_f32 v88, v40, v47
    v_fmac_f32 v89, v41, v47
    v_fmac_f32 v90, v42, v47
    v_fmac_f32 v91, v43, v47
    s_or_b32 m0, s44, s35
    s_waitcnt lgkmcnt(2)
    buffer_load_dwordx4 v[4:5], s[4:7], 0 idxen offen lds
    s_or_b32 m0, s45, s35
    s_waitcnt lgkmcnt(0)
    buffer_load_dwordx4 v[6:7], s[4:7], 0 idxen offen lds
    s_sub_u32 s19, s19, 1
    s_cbranch_scc1 mn_st4
mn_st4_back:
    v_mfma_f32_4x4x4_16b_bf16 v[28:31], v[14:15], v[20:21], 0 cbsz:4 abid:4
    v_mfma_f32_4x4x4_16b_bf16 v[32:35], v[14:15], v[22:23], 0 cbsz:4 abid:5
    v_mfma_f32_4x4x4_16b_bf16 v[36:39], v[14:15], v[24:25], 0 cbsz:4 abid:6
    v_mfma_f32_4x4x4_16b_bf16 v[40:43], v[14:15], v[26:27], 0 cbsz:4 abid:7
    ds_read_u16 v4, v2 offset:656
    ds_read_u16 v6, v2 offset:664
    v_readlane_b32 s28, v19, 17
    v_readlane_b32 s29, v19, 25
    ds_read_u16 v84, v3 offset:642
    s_waitcnt vmcnt(5)
    ds_read_b64_tr_b16 v[20:21], v1 offset:0
    ds_read_b64_tr_b16 v[22:23], v1 offset:512
    s_waitcnt vmcnt(4)
    ds_read_b64_tr_b16 v[24:25], v1 offset:1024
    ds_read_b64_tr_b16 v[26:27], v1 offset:1536
    s_sub_u32 s34, s34, 1
    s_cmov_b32 s35, 0x30000
    s_mov_b32 m0, s28
    v_fmac_f32 v88, v28, v48
    v_fmac_f32 v89, v29, v48
    v_fmac_f32 v90, v30, v48
    v_fmac_f32 v91, v31, v48
    s_lshr_b32 m0, s28, 16
    v_fmac_f32 v88, v32, v49
    v_fmac_f32 v89, v33, v49
    v_fmac_f32 v90, v34, v49
    v_fmac_f32 v91, v35, v49
    s_mov_b32 m0, s29
    v_fmac_f32 v88, v36, v50
    v_fmac_f32 v89, v37, v50
    v_fmac_f32 v90, v38, v50
    v_fmac_f32 v91, v39, v50
    s_lshr_b32 m0, s29, 16
    v_fmac_f32 v88, v40, v51
    v_fmac_f32 v89, v41, v51
    v_fmac_f32 v90, v42, v51
    v_fmac_f32 v91, v43, v51
    s_or_b32 m0, s40, s35
    s_waitcnt lgkmcnt(2)
    buffer_load_dwordx4 v[4:5], s[4:7], 0 idxen offen lds
    s_or_b32 m0, s41, s35
    s_waitcnt lgkmcnt(0)
    buffer_load_dwordx4 v[6:7], s[4:7], 0 idxen offen lds
    s_sub_u32 s19, s19, 1
    s_cbranch_scc1 mn_st5
mn_st5_back:
    v_mfma_f32_4x4x4_16b_bf16 v[28:31], v[14:15], v[20:21], 0 cbsz:4 abid:8
    v_mfma_f32_4x4x4_16b_bf16 v[32:35], v[14:15], v[22:23], 0 cbsz:4 abid:9
    v_mfma_f32_4x4x4_16b_bf16 v[36:39], v[14:15], v[24:25], 0 cbsz:4 abid:10
    v_mfma_f32_4x4x4_16b_bf16 v[40:43], v[14:15], v[26:27], 0 cbsz:4 abid:11
    ds_read_u16 v4, v2 offset:672
    ds_read_u16 v6, v2 offset:680
    v_readlane_b32 s28, v19, 33
    v_readlane_b32 s29, v19, 41
    v_and_b32 v84, 0x3ff, v84
    v_mad_u32_u24 v84, v84, 48, v86
    v_xor_b32 v85, 0x40000, v84
    ds_read_b128 v[60:63], v84 offset:320
    ds_read_b128 v[64:67], v85 offset:320
    s_waitcnt vmcnt(5)
    ds_read_b64_tr_b16 v[20:21], v1 offset:2048
    ds_read_b64_tr_b16 v[22:23], v1 offset:2560
    s_waitcnt vmcnt(4)
    ds_read_b64_tr_b16 v[24:25], v1 offset:3072
    ds_read_b64_tr_b16 v[26:27], v1 offset:3584
    s_sub_u32 s34, s34, 1
    s_cmov_b32 s35, 0x30000
    s_mov_b32 m0, s28
    v_fmac_f32 v88, v28, v52
    v_fmac_f32 v89, v29, v52
    v_fmac_f32 v90, v30, v52
    v_fmac_f32 v91, v31, v52
    s_lshr_b32 m0, s28, 16
    v_fmac_f32 v88, v32, v53
    v_fmac_f32 v89, v33, v53
    v_fmac_f32 v90, v34, v53
    v_fmac_f32 v91, v35, v53
    s_mov_b32 m0, s29
    v_fmac_f32 v88, v36, v54
    v_fmac_f32 v89, v37, v54
    v_fmac_f32 v90, v38, v54
    v_fmac_f32 v91, v39, v54
    s_lshr_b32 m0, s29, 16
    v_fmac_f32 v88, v40, v55
    v_fmac_f32 v89, v41, v55
    v_fmac_f32 v90, v42, v55
    v_fmac_f32 v91, v43, v55
    s_or_b32 m0, s42, s35
    s_waitcnt lgkmcnt(2)
    buffer_load_dwordx4 v[4:5], s[4:7], 0 idxen offen lds
    s_or_b32 m0, s43, s35
    s_waitcnt lgkmcnt(0)
    buffer_load_dwordx4 v[6:7], s[4:7], 0 idxen offen lds
    s_sub_u32 s19, s19, 1
    s_cbranch_scc1 mn_st6
mn_st6_back:
    v_mfma_f32_4x4x4_16b_bf16 v[28:31], v[14:15], v[20:21], 0 cbsz:4 abid:12
    v_mfma_f32_4x4x4_16b_bf16 v[32:35], v[14:15], v[22:23], 0 cbsz:4 abid:13
    v_mfma_f32_4x4x4_16b_bf16 v[36:39], v[14:15], v[24:25], 0 cbsz:4 abid:14
    v_mfma_f32_4x4x4_16b_bf16 v[40:43], v[14:15], v[26:27], 0 cbsz:4 abid:15
    ds_read_u16 v4, v2 offset:688
    ds_read_u16 v6, v2 offset:696
    v_readlane_b32 s28, v19, 49
    v_readlane_b32 s29, v19, 57
    v_mov_b32 v85, s30
    ds_add_rtn_u32 v85, v0, v85 offset:288
    s_waitcnt vmcnt(5)
    ds_read_b64_tr_b16 v[20:21], v1 offset:4096
    ds_read_b64_tr_b16 v[22:23], v1 offset:4608
    s_waitcnt vmcnt(4)
    ds_read_b64_tr_b16 v[24:25], v1 offset:5120
    ds_read_b64_tr_b16 v[26:27], v1 offset:5632
    s_sub_u32 s34, s34, 1
    s_cmov_b32 s35, 0x30000
    s_mov_b32 m0, s28
    v_fmac_f32 v88, v28, v56
    v_fmac_f32 v89, v29, v56
    v_fmac_f32 v90, v30, v56
    v_fmac_f32 v91, v31, v56
    s_lshr_b32 m0, s28, 16
    v_fmac_f32 v88, v32, v57
    v_fmac_f32 v89, v33, v57
    v_fmac_f32 v90, v34, v57
    v_fmac_f32 v91, v35, v57
    s_mov_b32 m0, s29
    v_fmac_f32 v88, v36, v58
    v_fmac_f32 v89, v37, v58
    v_fmac_f32 v90, v38, v58
    v_fmac_f32 v91, v39, v58
    s_lshr_b32 m0, s29, 16
    v_fmac_f32 v88, v40, v59
    v_fmac_f32 v89, v41, v59
    v_fmac_f32 v90, v42, v59
    v_fmac_f32 v91, v43, v59
    s_or_b32 m0, s44, s35
    v_mfma_f32_32x32x16_bf16 v[44:59], v[60:63], v[68:71], 0
    v_mfma_f32_32x32x16_bf16 v[44:59], v[64:67], v[72:75], v[44:59]
    s_waitcnt lgkmcnt(2)
    buffer_load_dwordx4 v[4:5], s[4:7], 0 idxen offen lds
    s_or_b32 m0, s45, s35
    s_waitcnt lgkmcnt(0)
    buffer_load_dwordx4 v[6:7], s[4:7], 0 idxen offen lds
    v_readfirstlane_b32 s27, v85
    s_setprio 2
    s_xor_b32 s27, s27, s26
    s_cmp_ge_i32 s27, 0
    s_cbranch_scc1 mn_pr7
    s_setprio 1
mn_pr7:
    s_sub_u32 s19, s19, 1
    s_cbranch_scc1 mn_st7
mn_st7_back:
    v_mfma_f32_4x4x4_16b_bf16 v[28:31], v[16:17], v[20:21], 0 cbsz:4 abid:0
    v_mfma_f32_4x4x4_16b_bf16 v[32:35], v[16:17], v[22:23], 0 cbsz:4 abid:1
    v_mfma_f32_4x4x4_16b_bf16 v[36:39], v[16:17], v[24:25], 0 cbsz:4 abid:2
    v_mfma_f32_4x4x4_16b_bf16 v[40:43], v[16:17], v[26:27], 0 cbsz:4 abid:3
    ds_read_u16 v4, v2 offset:704
    ds_read_u16 v6, v2 offset:712
    v_readlane_b32 s28, v19, 2
    v_readlane_b32 s29, v19, 10
    ds_read_u16 v8, v18 offset:706
    s_waitcnt vmcnt(5)
    ds_read_b64_tr_b16 v[20:21], v1 offset:0
    ds_read_b64_tr_b16 v[22:23], v1 offset:512
    s_waitcnt vmcnt(4)
    ds_read_b64_tr_b16 v[24:25], v1 offset:1024
    ds_read_b64_tr_b16 v[26:27], v1 offset:1536
    s_sub_u32 s34, s34, 1
    s_cmov_b32 s35, 0x30000
    s_mov_b32 m0, s28
    v_fmac_f32 v88, v28, v44
    v_fmac_f32 v89, v29, v44
    v_fmac_f32 v90, v30, v44
    v_fmac_f32 v91, v31, v44
    s_lshr_b32 m0, s28, 16
    v_fmac_f32 v88, v32, v45
    v_fmac_f32 v89, v33, v45
    v_fmac_f32 v90, v34, v45
    v_fmac_f32 v91, v35, v45
    s_mov_b32 m0, s29
    v_fmac_f32 v88, v36, v46
    v_fmac_f32 v89, v37, v46
    v_fmac_f32 v90, v38, v46
    v_fmac_f32 v91, v39, v46
    s_lshr_b32 m0, s29, 16
    v_fmac_f32 v88, v40, v47
    v_fmac_f32 v89, v41, v47
    v_fmac_f32 v90, v42, v47
    v_fmac_f32 v91, v43, v47
    s_or_b32 m0, s40, s35
    s_waitcnt lgkmcnt(2)
    buffer_load_dwordx4 v[4:5], s[4:7], 0 idxen offen lds
    s_or_b32 m0, s41, s35
    s_waitcnt lgkmcnt(0)
    buffer_load_dwordx4 v[6:7], s[4:7], 0 idxen offen lds
    s_sub_u32 s19, s19, 1
    s_cbranch_scc1 mn_st8
mn_st8_back:
    v_mfma_f32_4x4x4_16b_bf16 v[28:31], v[16:17], v[20:21], 0 cbsz:4 abid:4
    v_mfma_f32_4x4x4_16b_bf16 v[32:35], v[16:17], v[22:23], 0 cbsz:4 abid:5
    v_mfma_f32_4x4x4_16b_bf16 v[36:39], v[16:17], v[24:25], 0 cbsz:4 abid:6
    v_mfma_f32_4x4x4_16b_bf16 v[40:43], v[16:17], v[26:27], 0 cbsz:4 abid:7
    ds_read_u16 v4, v2 offset:720
    ds_read_u16 v6, v2 offset:728
    v_readlane_b32 s28, v19, 18
    v_readlane_b32 s29, v19, 26
    ds_read_u16 v84, v3 offset:706
    v_lshrrev_b32 v11, 8, v8
    v_and_b32 v8, 0x3ff, v8
    v_mul_u32_u24 v8, 48, v8
    ds_read_b64 v[8:9], v8 offset:352
    s_waitcnt vmcnt(5)
    ds_read_b64_tr_b16 v[20:21], v1 offset:2048
    ds_read_b64_tr_b16 v[22:23], v1 offset:2560
    s_waitcnt vmcnt(4)
    ds_read_b64_tr_b16 v[24:25], v1 offset:3072
    ds_read_b64_tr_b16 v[26:27], v1 offset:3584
    s_sub_u32 s34, s34, 1
    s_cmov_b32 s35, 0x30000
    s_mov_b32 m0, s28
    v_fmac_f32 v88, v28, v48
    v_fmac_f32 v89, v29, v48
    v_fmac_f32 v90, v30, v48
    v_fmac_f32 v91, v31, v48
    s_lshr_b32 m0, s28, 16
    v_fmac_f32 v88, v32, v49
    v_fmac_f32 v89, v33, v49
    v_fmac_f32 v90, v34, v49
    v_fmac_f32 v91, v35, v49
    s_mov_b32 m0, s29
    v_fmac_f32 v88, v36, v50
    v_fmac_f32 v89, v37, v50
    v_fmac_f32 v90, v38, v50
    v_fmac_f32 v91, v39, v50
    s_lshr_b32 m0, s29, 16
    v_fmac_f32 v88, v40, v51
    v_fmac_f32 v89, v41, v51
    v_fmac_f32 v90, v42, v51
    v_fmac_f32 v91, v43, v51
    s_or_b32 m0, s42, s35
    s_waitcnt lgkmcnt(2)
    buffer_load_dwordx4 v[4:5], s[4:7], 0 idxen offen lds
    s_or_b32 m0, s43, s35
    s_waitcnt lgkmcnt(0)
    buffer_load_dwordx4 v[6:7], s[4:7], 0 idxen offen lds
    s_sub_u32 s19, s19, 1
    s_cbranch_scc1 mn_st9
mn_st9_back:
    v_mfma_f32_4x4x4_16b_bf16 v[28:31], v[16:17], v[20:21], 0 cbsz:4 abid:8
    v_mfma_f32_4x4x4_16b_bf16 v[32:35], v[16:17], v[22:23], 0 cbsz:4 abid:9
    v_mfma_f32_4x4x4_16b_bf16 v[36:39], v[16:17], v[24:25], 0 cbsz:4 abid:10
    v_mfma_f32_4x4x4_16b_bf16 v[40:43], v[16:17], v[26:27], 0 cbsz:4 abid:11
    ds_read_u16 v4, v2 offset:736
    ds_read_u16 v6, v2 offset:744
    v_readlane_b32 s28, v19, 34
    v_readlane_b32 s29, v19, 42
    v_and_b32 v84, 0x3ff, v84
    v_mad_u32_u24 v84, v84, 48, v86
    v_xor_b32 v85, 0x40000, v84
    ds_read_b128 v[60:63], v84 offset:320
    ds_read_b128 v[64:67], v85 offset:320
    s_waitcnt vmcnt(5)
    ds_read_b64_tr_b16 v[20:21], v1 offset:4096
    ds_read_b64_tr_b16 v[22:23], v1 offset:4608
    s_waitcnt vmcnt(4)
    ds_read_b64_tr_b16 v[24:25], v1 offset:5120
    ds_read_b64_tr_b16 v[26:27], v1 offset:5632
    s_sub_u32 s34, s34, 1
    s_cmov_b32 s35, 0x30000
    s_mov_b32 m0, s28
    v_fmac_f32 v88, v28, v52
    v_fmac_f32 v89, v29, v52
    v_fmac_f32 v90, v30, v52
    v_fmac_f32 v91, v31, v52
    s_lshr_b32 m0, s28, 16
    v_fmac_f32 v88, v32, v53
    v_fmac_f32 v89, v33, v53
    v_fmac_f32 v90, v34, v53
    v_fmac_f32 v91, v35, v53
    s_mov_b32 m0, s29
    v_fmac_f32 v88, v36, v54
    v_fmac_f32 v89, v37, v54
    v_fmac_f32 v90, v38, v54
    v_fmac_f32 v91, v39, v54
    s_lshr_b32 m0, s29, 16
    v_fmac_f32 v88, v40, v55
    v_fmac_f32 v89, v41, v55
    v_fmac_f32 v90, v42, v55
    v_fmac_f32 v91, v43, v55
    s_or_b32 m0, s44, s35
    s_waitcnt lgkmcnt(2)
    buffer_load_dwordx4 v[4:5], s[4:7], 0 idxen offen lds
    s_or_b32 m0, s45, s35
    s_waitcnt lgkmcnt(0)
    buffer_load_dwordx4 v[6:7], s[4:7], 0 idxen offen lds
    v_and_b32 v11, 0x7c, v11
    v_or_b32 v11, 0xc000, v11
    v_lshlrev_b32 v10, 16, v11
    s_sub_u32 s19, s19, 1
    s_cbranch_scc1 mn_st10
mn_st10_back:
    v_mfma_f32_4x4x4_16b_bf16 v[28:31], v[16:17], v[20:21], 0 cbsz:4 abid:12
    v_mfma_f32_4x4x4_16b_bf16 v[32:35], v[16:17], v[22:23], 0 cbsz:4 abid:13
    v_mfma_f32_4x4x4_16b_bf16 v[36:39], v[16:17], v[24:25], 0 cbsz:4 abid:14
    v_mfma_f32_4x4x4_16b_bf16 v[40:43], v[16:17], v[26:27], 0 cbsz:4 abid:15
    ds_read_u16 v4, v2 offset:752
    ds_read_u16 v6, v2 offset:760
    v_readlane_b32 s28, v19, 50
    v_readlane_b32 s29, v19, 58
    v_mov_b32 v85, s30
    ds_add_rtn_u32 v85, v0, v85 offset:288
    s_waitcnt vmcnt(5)
    ds_read_b64_tr_b16 v[20:21], v1 offset:0
    ds_read_b64_tr_b16 v[22:23], v1 offset:512
    s_waitcnt vmcnt(4)
    ds_read_b64_tr_b16 v[24:25], v1 offset:1024
    ds_read_b64_tr_b16 v[26:27], v1 offset:1536
    s_sub_u32 s34, s34, 1
    s_cmov_b32 s35, 0x30000
    s_mov_b32 m0, s28
    v_fmac_f32 v88, v28, v56
    v_fmac_f32 v89, v29, v56
    v_fmac_f32 v90, v30, v56
    v_fmac_f32 v91, v31, v56
    s_lshr_b32 m0, s28, 16
    v_fmac_f32 v88, v32, v57
    v_fmac_f32 v89, v33, v57
    v_fmac_f32 v90, v34, v57
    v_fmac_f32 v91, v35, v57
    s_mov_b32 m0, s29
    v_fmac_f32 v88, v36, v58
    v_fmac_f32 v89, v37, v58
    v_fmac_f32 v90, v38, v58
    v_fmac_f32 v91, v39, v58
    s_lshr_b32 m0, s29, 16
    v_fmac_f32 v88, v40, v59
    v_fmac_f32 v89, v41, v59
    v_fmac_f32 v90, v42, v59
    v_fmac_f32 v91, v43, v59
    s_or_b32 m0, s40, s35
    v_mfma_f32_4x4x4_16b_bf16 v[28:31], v[8:9], v[76:77], 0
    v_mfma_f32_4x4x4_16b_bf16 v[32:35], v[8:9], v[78:79], 0
    v_mfma_f32_4x4x4_16b_bf16 v[36:39], v[8:9], v[80:81], 0
    v_mfma_f32_4x4x4_16b_bf16 v[40:43], v[8:9], v[82:83], 0
    v_mfma_f32_32x32x16_bf16 v[44:59], v[60:63], v[68:71], 0
    v_mfma_f32_32x32x16_bf16 v[44:59], v[64:67], v[72:75], v[44:59]
    s_waitcnt lgkmcnt(2)
    buffer_load_dwordx4 v[4:5], s[4:7], 0 idxen offen lds
    s_or_b32 m0, s41, s35
    s_waitcnt lgkmcnt(0)
    buffer_load_dwordx4 v[6:7], s[4:7], 0 idxen offen lds
    v_cvt_pk_bf16_f32 v12, v28, v32
    v_cvt_pk_bf16_f32 v14, v29, v33
    v_cvt_pk_bf16_f32 v16, v30, v34
    v_cvt_pk_bf16_f32 v13, v36, v40
    v_cvt_pk_bf16_f32 v15, v37, v41
    v_cvt_pk_bf16_f32 v17, v38, v42
    v_or_b32_dpp v19, v10, v11 row_shl:4 row_mask:0xf bank_mask:0xf bound_ctrl:0
    v_add_u32 v2, 192, v2
    v_add_u32 v3, 192, v3
    v_add_u32 v18, 192, v18
    v_readfirstlane_b32 s27, v85
    s_setprio 2
    s_xor_b32 s27, s27, s26
    s_cmp_ge_i32 s27, 0
    s_cbranch_scc1 mn_pr11
    s_setprio 1
mn_pr11:
    s_sub_u32 s19, s19, 1
    s_cbranch_scc1 mn_st11
mn_st11_back:
    s_branch mn_loop
mn_st0:
    s_cmp_lg_u32 s21, 0
    s_cbranch_scc1 mn_next
    s_call_b64 s[48:49], mn_flush
    s_branch mn_st0_back
mn_st1:
    s_cmp_lg_u32 s21, 0
    s_cbranch_scc1 mn_next
    s_call_b64 s[48:49], mn_flush
    s_branch mn_st1_back
mn_st2:
    s_cmp_lg_u32 s21, 0
    s_cbranch_scc1 mn_next
    s_call_b64 s[48:49], mn_flush
    s_branch mn_st2_back
mn_st3:
    s_cmp_lg_u32 s21, 0
    s_cbranch_scc1 mn_next
    s_call_b64 s[48:49], mn_flush
    s_branch mn_st3_back
mn_st4:
    s_cmp_lg_u32 s21, 0
    s_cbranch_scc1 mn_next
    s_call_b64 s[48:49], mn_flush
    s_branch mn_st4_back
mn_st5:
    s_cmp_lg_u32 s21, 0
    s_cbranch_scc1 mn_next
    s_call_b64 s[48:49], mn_flush
    s_branch mn_st5_back
mn_st6:
    s_cmp_lg_u32 s21, 0
    s_cbranch_scc1 mn_next
    s_call_b64 s[48:49], mn_flush
    s_branch mn_st6_back
mn_st7:
    s_cmp_lg_u32 s21, 0
    s_cbranch_scc1 mn_next
    s_call_b64 s[48:49], mn_flush
    s_branch mn_st7_back
mn_st8:
    s_cmp_lg_u32 s21, 0
    s_cbranch_scc1 mn_next
    s_call_b64 s[48:49], mn_flush
    s_branch mn_st8_back
mn_st9:
    s_cmp_lg_u32 s21, 0
    s_cbranch_scc1 mn_next
    s_call_b64 s[48:49], mn_flush
    s_branch mn_st9_back
mn_st10:
    s_cmp_lg_u32 s21, 0
    s_cbranch_scc1 mn_next
    s_call_b64 s[48:49], mn_flush
    s_branch mn_st10_back
mn_st11:
    s_cmp_lg_u32 s21, 0
    s_cbranch_scc1 mn_next
    s_call_b64 s[48:49], mn_flush
    s_branch mn_st11_back
mn_st12:
    s_cmp_lg_u32 s21, 0
    s_cbranch_scc1 mn_next
    s_call_b64 s[48:49], mn_flush
    s_branch mn_st12_back
mn_flush:
    s_cmp_eq_u32 s58, 4
    s_cbranch_scc1 mn_fl4
    s_cmp_eq_u32 s58, 3
    s_cbranch_scc1 mn_fl3
    s_cmp_eq_u32 s58, 2
    s_cbranch_scc1 mn_fl2
    s_cmp_eq_u32 s58, 1
    s_cbranch_scc1 mn_fl1
mn_fl0:
    v_cvt_pk_bf16_f32 v88, v88, v89
    v_cvt_pk_bf16_f32 v89, v90, v91
    ds_write_b64 v87, v[88:89] offset:0
    v_cvt_pk_bf16_f32 v92, v92, v93
    v_cvt_pk_bf16_f32 v93, v94, v95
    ds_write_b64 v87, v[92:93] offset:576
    v_cvt_pk_bf16_f32 v96, v96, v97
    v_cvt_pk_bf16_f32 v97, v98, v99
    ds_write_b64 v87, v[96:97] offset:1152
    v_cvt_pk_bf16_f32 v100, v100, v101
    v_cvt_pk_bf16_f32 v101, v102, v103
    ds_write_b64 v87, v[100:101] offset:1728
    s_mul_i32 s52, s18, 3
    s_lshl_b32 s52, 1, s52
    v_mov_b32 v90, s52
    v_mov_b32 v91, 0
    s_mov_b64 exec, 1
    ds_add_u32 v91, v90 offset:276
    s_mov_b64 exec, -1
    s_add_u32 s58, s58, 1
    s_sub_u32 s19, s85, 1
    s_cbranch_scc1 mn_fl1
    s_setpc_b64 s[48:49]
mn_fl1:
    v_cvt_pk_bf16_f32 v104, v104, v105
    v_cvt_pk_bf16_f32 v105, v106, v107
    ds_write_b64 v87, v[104:105] offset:2304
    v_cvt_pk_bf16_f32 v108, v108, v109
    v_cvt_pk_bf16_f32 v109, v110, v111
    ds_write_b64 v87, v[108:109] offset:2880
    v_cvt_pk_bf16_f32 v112, v112, v113
    v_cvt_pk_bf16_f32 v113, v114, v115
    ds_write_b64 v87, v[112:113] offset:3456
    v_cvt_pk_bf16_f32 v116, v116, v117
    v_cvt_pk_bf16_f32 v117, v118, v119
    ds_write_b64 v87, v[116:117] offset:4032
    s_mul_i32 s52, s18, 3
    s_lshl_b32 s52, 64, s52
    v_mov_b32 v106, s52
    v_mov_b32 v107, 0
    s_mov_b64 exec, 1
    ds_add_u32 v107, v106 offset:276
    s_mov_b64 exec, -1
    s_add_u32 s58, s58, 1
    s_sub_u32 s19, s86, 1
    s_cbranch_scc1 mn_fl2
    s_setpc_b64 s[48:49]
mn_fl2:
    v_cvt_pk_bf16_f32 v120, v120, v121
    v_cvt_pk_bf16_f32 v121, v122, v123
    ds_write_b64 v87, v[120:121] offset:4608
    v_cvt_pk_bf16_f32 v124, v124, v125
    v_cvt_pk_bf16_f32 v125, v126, v127
    ds_write_b64 v87, v[124:125] offset:5184
    v_cvt_pk_bf16_f32 v128, v128, v129
    v_cvt_pk_bf16_f32 v129, v130, v131
    ds_write_b64 v87, v[128:129] offset:5760
    v_cvt_pk_bf16_f32 v132, v132, v133
    v_cvt_pk_bf16_f32 v133, v134, v135
    ds_write_b64 v87, v[132:133] offset:6336
    s_mul_i32 s52, s18, 3
    s_lshl_b32 s52, 4096, s52
    v_mov_b32 v122, s52
    v_mov_b32 v123, 0
    s_mov_b64 exec, 1
    ds_add_u32 v123, v122 offset:276
    s_mov_b64 exec, -1
    s_add_u32 s58, s58, 1
    s_sub_u32 s19, s87, 1
    s_cbranch_scc1 mn_fl3
    s_setpc_b64 s[48:49]
mn_fl3:
    v_cvt_pk_bf16_f32 v136, v136, v137
    v_cvt_pk_bf16_f32 v137, v138, v139
    ds_write_b64 v87, v[136:137] offset:6912
    v_cvt_pk_bf16_f32 v140, v140, v141
    v_cvt_pk_bf16_f32 v141, v142, v143
    ds_write_b64 v87, v[140:141] offset:7488
    v_cvt_pk_bf16_f32 v144, v144, v145
    v_cvt_pk_bf16_f32 v145, v146, v147
    ds_write_b64 v87, v[144:145] offset:8064
    v_cvt_pk_bf16_f32 v148, v148, v149
    v_cvt_pk_bf16_f32 v149, v150, v151
    ds_write_b64 v87, v[148:149] offset:8640
    s_mul_i32 s52, s18, 3
    s_lshl_b32 s52, 262144, s52
    v_mov_b32 v138, s52
    v_mov_b32 v139, 0
    s_mov_b64 exec, 1
    ds_add_u32 v139, v138 offset:276
    s_mov_b64 exec, -1
    s_add_u32 s58, s58, 1
    s_sub_u32 s19, s88, 1
    s_cbranch_scc1 mn_fl4
    s_setpc_b64 s[48:49]
mn_fl4:
    s_cmp_ge_u32 s57, 4
    s_cbranch_scc1 mn_fl4b
    s_waitcnt vmcnt(0)
mn_fl4b:
    v_cvt_pk_bf16_f32 v152, v152, v153
    v_cvt_pk_bf16_f32 v153, v154, v155
    ds_write_b64 v87, v[152:153] offset:9216
    v_cvt_pk_bf16_f32 v156, v156, v157
    v_cvt_pk_bf16_f32 v157, v158, v159
    ds_write_b64 v87, v[156:157] offset:9792
    v_cvt_pk_bf16_f32 v160, v160, v161
    v_cvt_pk_bf16_f32 v161, v162, v163
    ds_write_b64 v87, v[160:161] offset:10368
    v_cvt_pk_bf16_f32 v164, v164, v165
    v_cvt_pk_bf16_f32 v165, v166, v167
    ds_write_b64 v87, v[164:165] offset:10944
    s_mul_i32 s52, s18, 3
    s_lshl_b32 s52, 16777216, s52
    v_mov_b32 v154, s52
    v_mov_b32 v155, 0
    s_mov_b64 exec, 1
    ds_add_u32 v155, v154 offset:276
    s_mov_b64 exec, -1
    s_waitcnt vmcnt(0) lgkmcnt(0)
mn_end:
    s_endpgm
gm_main:
    s_load_dwordx2 s[56:57], s[0:1], 64
    s_load_dwordx2 s[26:27], s[0:1], 56
    v_and_b32 v3, 63, v0
    v_bfe_u32 v12, v0, 1, 7
    v_and_b32 v11, 15, v12
    v_lshrrev_b32 v10, 4, v12
    v_lshl_or_b32 v11, v11, 3, v10
    v_cmp_gt_u32 vcc, 125, v11
    v_mul_u32_u24 v13, 51200, v11
    v_bfrev_b32 v10, 2
    v_lshlrev_b32 v12, 6, v12
    v_cndmask_b32 v12, v10, v12, vcc
    v_lshlrev_b32 v2, 4, v3
    s_lshl_b32 s40, s17, 15
    s_add_u32 s40, s40, 11534336
    s_waitcnt lgkmcnt(0)
    s_mov_b32 s8, s54
    s_and_b32 s9, s55, 0xffff
    v_lshrrev_b32 v11, 4, v3
    v_lshlrev_b32 v11, 11, v11
    v_and_b32 v10, 7, v3
    v_lshl_add_u32 v11, v10, 4, v11
    v_and_b32 v10, 8, v3
    v_lshlrev_b32 v10, 10, v10
    s_lshl_b32 s52, s17, 7
    s_add_u32 s52, s52, 114688
    v_add3_u32 v11, v11, v10, s52
    s_mov_b32 s44, 0x05040100
    s_mov_b32 s45, 0x07060302
    v_mov_b32 v5, v11
    s_cmp_ge_u32 s2, 125
    s_cbranch_scc1 gm_wgo
    s_cmp_ge_u32 s16, 10
    s_cbranch_scc1 gm_wsp
    s_cmp_ge_u32 s2, 125
    s_waitcnt vmcnt(0)
    s_cbranch_scc1 gm_wsp
    v_mov_b32 v11, 0
    v_mov_b32 v10, 1
    s_mov_b64 exec, 1
    ds_add_u32 v11, v10 offset:448
    s_mov_b64 exec, -1
gm_dummy:
gm_wsp:
    v_mov_b32 v11, 0
    ds_read_b32 v11, v11 offset:448
    s_waitcnt lgkmcnt(0)
    v_readfirstlane_b32 s62, v11
    s_cmp_ge_u32 s62, 10
    s_cbranch_scc1 gm_wspx
    s_sleep 1
    s_branch gm_wsp
gm_wspx:
    s_cmp_lg_u32 s16, 10
    s_cbranch_scc1 gm_wgo
    s_and_b32 s52, s2, 1
    s_lshl_b32 s53, s52, 7
    s_add_u32 s53, s53, 64
    s_mov_b32 s62, 1
    s_atomic_add s62, s[60:61], s53 glc
    s_sub_u32 s52, 62, s52
    s_add_u32 s28, s54, 11730944
    s_addc_u32 s29, s55, 0
    s_mov_b32 s53, 0x10000
    s_waitcnt lgkmcnt(0)
    s_cmp_lg_u32 s62, s52
    s_cbranch_scc1 gm_wgo
    s_atomic_add s53, s[28:29], 0
    s_atomic_add s53, s[28:29], 128
    s_atomic_add s53, s[28:29], 256
    s_atomic_add s53, s[28:29], 384
    s_atomic_add s53, s[28:29], 512
    s_atomic_add s53, s[28:29], 640
    s_atomic_add s53, s[28:29], 768
    s_atomic_add s53, s[28:29], 896
    s_atomic_add s53, s[28:29], 1024
    s_atomic_add s53, s[28:29], 1152
    s_atomic_add s53, s[28:29], 1280
    s_atomic_add s53, s[28:29], 1408
    s_atomic_add s53, s[28:29], 1536
    s_atomic_add s53, s[28:29], 1664
    s_atomic_add s53, s[28:29], 1792
    s_atomic_add s53, s[28:29], 1920
gm_wgo:
    global_load_dwordx4 v[136:139], v5, s[26:27] offset:0
    global_load_dwordx4 v[140:143], v5, s[26:27] offset:512
    global_load_dwordx4 v[144:147], v5, s[26:27] offset:1024
    global_load_dwordx4 v[148:151], v5, s[26:27] offset:1536
    v_subrev_u32 v5, 0x4000, v5
    global_load_dwordx4 v[120:123], v5, s[26:27] offset:0
    global_load_dwordx4 v[124:127], v5, s[26:27] offset:512
    global_load_dwordx4 v[128:131], v5, s[26:27] offset:1024
    global_load_dwordx4 v[132:135], v5, s[26:27] offset:1536
    v_subrev_u32 v5, 0x4000, v5
    global_load_dwordx4 v[104:107], v5, s[26:27] offset:0
    global_load_dwordx4 v[108:111], v5, s[26:27] offset:512
    global_load_dwordx4 v[112:115], v5, s[26:27] offset:1024
    global_load_dwordx4 v[116:119], v5, s[26:27] offset:1536
    v_subrev_u32 v5, 0x4000, v5
    global_load_dwordx4 v[88:91], v5, s[26:27] offset:0
    global_load_dwordx4 v[92:95], v5, s[26:27] offset:512
    global_load_dwordx4 v[96:99], v5, s[26:27] offset:1024
    global_load_dwordx4 v[100:103], v5, s[26:27] offset:1536
    v_subrev_u32 v5, 0x4000, v5
    global_load_dwordx4 v[72:75], v5, s[26:27] offset:0
    global_load_dwordx4 v[76:79], v5, s[26:27] offset:512
    global_load_dwordx4 v[80:83], v5, s[26:27] offset:1024
    global_load_dwordx4 v[84:87], v5, s[26:27] offset:1536
    v_subrev_u32 v5, 0x4000, v5
    s_cmp_lt_u32 s2, 125
    s_cbranch_scc1 gm_wskip
    global_load_dwordx4 v[56:59], v5, s[26:27] offset:0
    global_load_dwordx4 v[60:63], v5, s[26:27] offset:512
    global_load_dwordx4 v[64:67], v5, s[26:27] offset:1024
    global_load_dwordx4 v[68:71], v5, s[26:27] offset:1536
    v_subrev_u32 v5, 0x4000, v5
    global_load_dwordx4 v[40:43], v5, s[26:27] offset:0
    global_load_dwordx4 v[44:47], v5, s[26:27] offset:512
    global_load_dwordx4 v[48:51], v5, s[26:27] offset:1024
    global_load_dwordx4 v[52:55], v5, s[26:27] offset:1536
    v_subrev_u32 v5, 0x4000, v5
gm_wskip:
    s_mul_i32 s41, s2, 625
    s_add_u32 s52, s41, 640
    s_add_u32 s41, s41, 15
    s_lshr_b32 s41, s41, 4
    s_lshr_b32 s52, s52, 4
    s_mov_b32 s12, s56
    s_and_b32 s13, s57, 0xffff
    s_lshl_b32 s14, s52, 11
    s_mov_b32 s15, 0x20000
    s_mul_i32 s42, s17, 15360
    s_add_u32 s42, s42, 40960
    s_lshl_b32 s43, s17, 1
    s_sub_u32 s43, s43, 1
    v_lshlrev_b32 v6, 2, v3
    v_add_u32 v11, 0, v3
    v_mul_u32_u24 v10, 21846, v11
    v_lshrrev_b32 v10, 16, v10
    v_lshl_add_u32 v34, v10, 2, s42
    v_mad_i32_i24 v10, v10, -3, v11
    v_lshlrev_b32 v30, 4, v10
    v_add_u32 v11, 64, v3
    v_mul_u32_u24 v10, 21846, v11
    v_lshrrev_b32 v10, 16, v10
    v_lshl_add_u32 v35, v10, 2, s42
    v_mad_i32_i24 v10, v10, -3, v11
    v_lshlrev_b32 v31, 4, v10
    v_add_u32 v11, 128, v3
    v_mul_u32_u24 v10, 21846, v11
    v_lshrrev_b32 v10, 16, v10
    v_lshl_add_u32 v36, v10, 2, s42
    v_mad_i32_i24 v10, v10, -3, v11
    v_lshlrev_b32 v32, 4, v10
gm_sp1:
    v_mov_b32 v11, 0
    ds_read_b32 v11, v11 offset:308
    s_waitcnt lgkmcnt(0)
    v_readfirstlane_b32 s62, v11
    s_cmp_ge_u32 s62, 1
    s_cbranch_scc1 gm_sp1x
    s_sleep 1
    s_branch gm_sp1
gm_sp1x:
    buffer_load_dword v4, v12, s[8:11], s22 offen offset:60 sc1
    s_waitcnt vmcnt(0)
gm_pass:
    v_lshrrev_b32 v8, 16, v4
    v_subrev_u32 v8, s24, v8
    v_med3_i32 v8, v8, 0, s20
    v_mov_b32 v9, v8
    v_and_b32 v12, 1, v0
    v_and_b32 v14, 0xffff, v4
    v_add_u32_dpp v9, v9, v9 row_shr:2 row_mask:0xf bank_mask:0xf
    v_add3_u32 v14, v14, v12, s24
    s_nop 0
    v_add_u32_dpp v9, v9, v9 row_shr:4 row_mask:0xf bank_mask:0xf
    v_mad_u32_u24 v14, v14, 40, v13
    s_nop 0
    v_add_u32_dpp v9, v9, v9 row_shr:8 row_mask:0xf bank_mask:0xf
    v_sub_u32 v15, v8, v12
    s_nop 0
    v_add_u32_dpp v9, v9, v9 row_bcast:15 row_mask:0xa bank_mask:0xf
    s_nop 0
    s_nop 0
    v_add_u32_dpp v9, v9, v9 row_bcast:31 row_mask:0xc bank_mask:0xf
    s_nop 0
    s_nop 0
    v_readlane_b32 s47, v9, 63
    v_sub_u32 v16, v9, v15
    v_lshl_add_u32 v16, v16, 2, s42
    v_cmpx_lt_i32 vcc, 0, v15
    s_cbranch_execz gm_tb_done
    ds_write_b32 v16, v14 offset:0
    v_add_u32 v14, 80, v14
    v_cmpx_lt_i32 vcc, 2, v15
    s_cbranch_execz gm_tb_done
    ds_write_b32 v16, v14 offset:8
    v_add_u32 v14, 80, v14
    v_cmpx_lt_i32 vcc, 4, v15
    s_cbranch_execz gm_tb_done
    ds_write_b32 v16, v14 offset:16
    v_add_u32 v14, 80, v14
    v_cmpx_lt_i32 vcc, 6, v15
    s_cbranch_execz gm_tb_done
    ds_write_b32 v16, v14 offset:24
    v_add_u32 v14, 80, v14
    v_cmpx_lt_i32 vcc, 8, v15
    s_cbranch_execz gm_tb_done
    ds_write_b32 v16, v14 offset:32
    v_add_u32 v14, 80, v14
    v_cmpx_lt_i32 vcc, 10, v15
    s_cbranch_execz gm_tb_done
    ds_write_b32 v16, v14 offset:40
    v_add_u32 v14, 80, v14
    v_cmpx_lt_i32 vcc, 12, v15
    s_cbranch_execz gm_tb_done
    ds_write_b32 v16, v14 offset:48
    v_add_u32 v14, 80, v14
    v_cmpx_lt_i32 vcc, 14, v15
    s_cbranch_execz gm_tb_done
    ds_write_b32 v16, v14 offset:56
    v_add_u32 v14, 80, v14
    v_cmpx_lt_i32 vcc, 16, v15
    s_cbranch_execz gm_tb_done
    ds_write_b32 v16, v14 offset:64
    v_add_u32 v14, 80, v14
    v_cmpx_lt_i32 vcc, 18, v15
    s_cbranch_execz gm_tb_done
    ds_write_b32 v16, v14 offset:72
gm_tb_done:
    s_mov_b64 exec, -1
    s_mul_i32 s47, s47, 3
    v_mov_b32 v17, 0
    ds_read_b32 v18, v34 offset:0
    ds_read_b32 v19, v35 offset:0
    ds_read_b32 v20, v36 offset:0
    ds_read_b32 v21, v34 offset:256
    ds_read_b32 v22, v35 offset:256
    ds_read_b32 v23, v36 offset:256
    ds_read_b32 v24, v34 offset:512
    ds_read_b32 v25, v35 offset:512
    ds_read_b32 v26, v36 offset:512
    ds_read_b32 v29, v17 offset:456
    s_and_b32 s62, s2, 15
    s_lshl_b32 s62, s62, 7
    s_add_u32 s62, s62, 11730944
    v_mov_b32 v28, s62
    global_load_dword v27, v28, s[54:55] sc1
    s_barrier
    ds_read_b32 v15, v6 offset:384
    ds_read_b32 v17, v17 offset:272
    v_mov_b32 v11, v34
    v_mov_b32 v10, v35
    v_mov_b32 v14, v36
    s_waitcnt lgkmcnt(1)
    v_add_u32_dpp v15, v15, v15 row_shr:1 row_mask:0xf bank_mask:0xf
    s_nop 1
    v_add_u32_dpp v15, v15, v15 row_shr:2 row_mask:0xf bank_mask:0xf
    s_nop 1
    v_add_u32_dpp v15, v15, v15 row_shr:4 row_mask:0xf bank_mask:0xf
    s_waitcnt lgkmcnt(0)
    v_readfirstlane_b32 s21, v17
    v_readlane_b32 s23, v15, 7
    v_readlane_b32 s46, v15, s43
    s_cmp_gt_u32 s23, 773
    s_cbranch_scc1 gm_ovf
    s_cmp_eq_u32 s17, 0
    s_cmov_b32 s46, 0
    s_mul_i32 s46, s46, 48
    s_add_u32 m0, s46, 3776
    v_add_u32 v18, v18, v30
    v_add_u32 v19, v19, v31
    v_add_u32 v20, v20, v32
    v_add_u32 v21, v21, v30
    v_add_u32 v22, v22, v31
    v_add_u32 v23, v23, v32
    v_add_u32 v24, v24, v30
    v_add_u32 v25, v25, v31
    v_add_u32 v26, v26, v32
    s_mov_b32 s63, 0x100000
gm_ep:
    s_waitcnt vmcnt(0)
    v_sub_u32 v27, v27, v29
    v_lshrrev_b32 v27, 16, v27
    v_cmp_eq_u32 vcc, 2, v27
    s_cbranch_vccnz gm_go2
    s_and_b32 s62, s63, 31
    s_sub_u32 s63, s63, 1
    s_cmp_eq_u32 s62, 1
    s_cbranch_scc1 gm_epd
    s_sleep 6
    global_load_dword v27, v28, s[54:55] sc1
    s_branch gm_ep
gm_epd:
    s_and_b32 s62, s2, 15
    s_lshl_b32 s62, s62, 7
    s_add_u32 s62, s62, 11730944
    v_mov_b32 v27, s62
    v_lshlrev_b32 v28, 6, v0
    v_and_b32 v28, 0xc0, v28
    s_mov_b32 s63, 0x100000
mn_poll2dem:
    s_sub_u32 s63, s63, 1
    s_cbranch_scc1 mn_poll2dex
    global_load_dword v29, v28, s[60:61] sc1
    s_waitcnt vmcnt(0)
    v_add_u32_dpp v29, v29, v29 quad_perm:[2,3,0,1] row_mask:0xf bank_mask:0xf
    s_sleep 8
    v_readlane_b32 s62, v29, 1
    s_cmp_lt_u32 s62, 125
    s_cbranch_scc1 mn_poll2dem
mn_poll2dex:
gm_go2:
    v_cmpx_gt_i32 vcc, s47, v3
    s_cbranch_execz gm_raw_done
    buffer_load_dwordx4 v18, s[8:11], 0 offen sc1 lds
    s_add_u32 m0, m0, 1024
    s_sub_i32 s47, s47, 64
    v_cmpx_gt_i32 vcc, s47, v3
    s_cbranch_execz gm_raw_done
    buffer_load_dwordx4 v19, s[8:11], 0 offen sc1 lds
    s_add_u32 m0, m0, 1024
    s_sub_i32 s47, s47, 64
    v_cmpx_gt_i32 vcc, s47, v3
    s_cbranch_execz gm_raw_done
    buffer_load_dwordx4 v20, s[8:11], 0 offen sc1 lds
    s_add_u32 m0, m0, 1024
    s_sub_i32 s47, s47, 64
    v_cmpx_gt_i32 vcc, s47, v3
    s_cbranch_execz gm_raw_done
    buffer_load_dwordx4 v21, s[8:11], 0 offen sc1 lds
    s_add_u32 m0, m0, 1024
    s_sub_i32 s47, s47, 64
    v_cmpx_gt_i32 vcc, s47, v3
    s_cbranch_execz gm_raw_done
    buffer_load_dwordx4 v22, s[8:11], 0 offen sc1 lds
    s_add_u32 m0, m0, 1024
    s_sub_i32 s47, s47, 64
    v_cmpx_gt_i32 vcc, s47, v3
    s_cbranch_execz gm_raw_done
    buffer_load_dwordx4 v23, s[8:11], 0 offen sc1 lds
    s_add_u32 m0, m0, 1024
    s_sub_i32 s47, s47, 64
    v_cmpx_gt_i32 vcc, s47, v3
    s_cbranch_execz gm_raw_done
    buffer_load_dwordx4 v24, s[8:11], 0 offen sc1 lds
    s_add_u32 m0, m0, 1024
    s_sub_i32 s47, s47, 64
    v_cmpx_gt_i32 vcc, s47, v3
    s_cbranch_execz gm_raw_done
    buffer_load_dwordx4 v25, s[8:11], 0 offen sc1 lds
    s_add_u32 m0, m0, 1024
    s_sub_i32 s47, s47, 64
    v_cmpx_gt_i32 vcc, s47, v3
    s_cbranch_execz gm_raw_done
    buffer_load_dwordx4 v26, s[8:11], 0 offen sc1 lds
    s_add_u32 m0, m0, 1024
    s_sub_i32 s47, s47, 64
    v_add_u32 v11, 768, v11
    v_add_u32 v10, 768, v10
    v_add_u32 v14, 768, v14
gm_raw:
    ds_read_b32 v18, v11 offset:0
    ds_read_b32 v19, v10 offset:0
    ds_read_b32 v20, v14 offset:0
    ds_read_b32 v21, v11 offset:256
    ds_read_b32 v22, v10 offset:256
    ds_read_b32 v23, v14 offset:256
    ds_read_b32 v24, v11 offset:512
    ds_read_b32 v25, v10 offset:512
    ds_read_b32 v26, v14 offset:512
    v_cmpx_gt_i32 vcc, s47, v3
    s_cbranch_execz gm_raw_done
    s_waitcnt lgkmcnt(8)
    v_add_u32 v18, v18, v30
    buffer_load_dwordx4 v18, s[8:11], 0 offen sc1 lds
    s_add_u32 m0, m0, 1024
    s_sub_i32 s47, s47, 64
    v_cmpx_gt_i32 vcc, s47, v3
    s_cbranch_execz gm_raw_done
    s_waitcnt lgkmcnt(7)
    v_add_u32 v19, v19, v31
    buffer_load_dwordx4 v19, s[8:11], 0 offen sc1 lds
    s_add_u32 m0, m0, 1024
    s_sub_i32 s47, s47, 64
    v_cmpx_gt_i32 vcc, s47, v3
    s_cbranch_execz gm_raw_done
    s_waitcnt lgkmcnt(6)
    v_add_u32 v20, v20, v32
    buffer_load_dwordx4 v20, s[8:11], 0 offen sc1 lds
    s_add_u32 m0, m0, 1024
    s_sub_i32 s47, s47, 64
    v_cmpx_gt_i32 vcc, s47, v3
    s_cbranch_execz gm_raw_done
    s_waitcnt lgkmcnt(5)
    v_add_u32 v21, v21, v30
    buffer_load_dwordx4 v21, s[8:11], 0 offen sc1 lds
    s_add_u32 m0, m0, 1024
    s_sub_i32 s47, s47, 64
    v_cmpx_gt_i32 vcc, s47, v3
    s_cbranch_execz gm_raw_done
    s_waitcnt lgkmcnt(4)
    v_add_u32 v22, v22, v31
    buffer_load_dwordx4 v22, s[8:11], 0 offen sc1 lds
    s_add_u32 m0, m0, 1024
    s_sub_i32 s47, s47, 64
    v_cmpx_gt_i32 vcc, s47, v3
    s_cbranch_execz gm_raw_done
    s_waitcnt lgkmcnt(3)
    v_add_u32 v23, v23, v32
    buffer_load_dwordx4 v23, s[8:11], 0 offen sc1 lds
    s_add_u32 m0, m0, 1024
    s_sub_i32 s47, s47, 64
    v_cmpx_gt_i32 vcc, s47, v3
    s_cbranch_execz gm_raw_done
    s_waitcnt lgkmcnt(2)
    v_add_u32 v24, v24, v30
    buffer_load_dwordx4 v24, s[8:11], 0 offen sc1 lds
    s_add_u32 m0, m0, 1024
    s_sub_i32 s47, s47, 64
    v_cmpx_gt_i32 vcc, s47, v3
    s_cbranch_execz gm_raw_done
    s_waitcnt lgkmcnt(1)
    v_add_u32 v25, v25, v31
    buffer_load_dwordx4 v25, s[8:11], 0 offen sc1 lds
    s_add_u32 m0, m0, 1024
    s_sub_i32 s47, s47, 64
    v_cmpx_gt_i32 vcc, s47, v3
    s_cbranch_execz gm_raw_done
    s_waitcnt lgkmcnt(0)
    v_add_u32 v26, v26, v32
    buffer_load_dwordx4 v26, s[8:11], 0 offen sc1 lds
    s_add_u32 m0, m0, 1024
    s_sub_i32 s47, s47, 64
    v_add_u32 v11, 768, v11
    v_add_u32 v10, 768, v10
    v_add_u32 v14, 768, v14
    s_branch gm_raw
gm_raw_done:
    s_mov_b64 exec, -1
    s_barrier
    s_waitcnt vmcnt(0) lgkmcnt(0)
    s_barrier
    s_cmp_lg_u32 s21, 0
    s_cbranch_scc1 gm_next
    s_cmp_ge_u32 s2, 125
    s_cbranch_scc1 gm_wdone
    global_load_dwordx4 v[56:59], v5, s[26:27] offset:0
    global_load_dwordx4 v[60:63], v5, s[26:27] offset:512
    global_load_dwordx4 v[64:67], v5, s[26:27] offset:1024
    global_load_dwordx4 v[68:71], v5, s[26:27] offset:1536
    v_subrev_u32 v5, 0x4000, v5
    s_waitcnt vmcnt(0)
    global_load_dwordx4 v[40:43], v5, s[26:27] offset:0
    global_load_dwordx4 v[44:47], v5, s[26:27] offset:512
    global_load_dwordx4 v[48:51], v5, s[26:27] offset:1024
    global_load_dwordx4 v[52:55], v5, s[26:27] offset:1536
    v_subrev_u32 v5, 0x4000, v5
    s_waitcnt vmcnt(0)
gm_wdone:
    global_load_dwordx4 v[24:27], v5, s[26:27] offset:0
    global_load_dwordx4 v[28:31], v5, s[26:27] offset:512
    global_load_dwordx4 v[32:35], v5, s[26:27] offset:1024
    global_load_dwordx4 v[36:39], v5, s[26:27] offset:1536
    v_mov_b32_dpp v152, v138 row_ror:8 row_mask:0xf bank_mask:0xf
    v_mov_b32_dpp v153, v139 row_ror:8 row_mask:0xf bank_mask:0xf
    v_mov_b32_dpp v154, v142 row_ror:8 row_mask:0xf bank_mask:0xf
    v_mov_b32_dpp v155, v143 row_ror:8 row_mask:0xf bank_mask:0xf
    v_mov_b32_dpp v156, v146 row_ror:8 row_mask:0xf bank_mask:0xf
    v_mov_b32_dpp v157, v147 row_ror:8 row_mask:0xf bank_mask:0xf
    v_mov_b32_dpp v158, v150 row_ror:8 row_mask:0xf bank_mask:0xf
    v_mov_b32_dpp v159, v151 row_ror:8 row_mask:0xf bank_mask:0xf
    v_mov_b32_dpp v138, v136 row_ror:8 row_mask:0xf bank_mask:0x3
    v_mov_b32_dpp v139, v137 row_ror:8 row_mask:0xf bank_mask:0x3
    v_mov_b32_dpp v142, v140 row_ror:8 row_mask:0xf bank_mask:0x3
    v_mov_b32_dpp v143, v141 row_ror:8 row_mask:0xf bank_mask:0x3
    v_mov_b32_dpp v146, v144 row_ror:8 row_mask:0xf bank_mask:0x3
    v_mov_b32_dpp v147, v145 row_ror:8 row_mask:0xf bank_mask:0x3
    v_mov_b32_dpp v150, v148 row_ror:8 row_mask:0xf bank_mask:0x3
    v_mov_b32_dpp v151, v149 row_ror:8 row_mask:0xf bank_mask:0x3
    v_mov_b32_dpp v136, v152 quad_perm:[0,1,2,3] row_mask:0xf bank_mask:0xc
    v_mov_b32_dpp v137, v153 quad_perm:[0,1,2,3] row_mask:0xf bank_mask:0xc
    v_mov_b32_dpp v140, v154 quad_perm:[0,1,2,3] row_mask:0xf bank_mask:0xc
    v_mov_b32_dpp v141, v155 quad_perm:[0,1,2,3] row_mask:0xf bank_mask:0xc
    v_mov_b32_dpp v144, v156 quad_perm:[0,1,2,3] row_mask:0xf bank_mask:0xc
    v_mov_b32_dpp v145, v157 quad_perm:[0,1,2,3] row_mask:0xf bank_mask:0xc
    v_mov_b32_dpp v148, v158 quad_perm:[0,1,2,3] row_mask:0xf bank_mask:0xc
    v_mov_b32_dpp v149, v159 quad_perm:[0,1,2,3] row_mask:0xf bank_mask:0xc
    v_perm_b32 v152, v140, v136, s44
    v_perm_b32 v153, v148, v144, s44
    v_perm_b32 v154, v142, v138, s44
    v_perm_b32 v155, v150, v146, s44
    v_perm_b32 v156, v140, v136, s45
    v_perm_b32 v157, v148, v144, s45
    v_perm_b32 v158, v142, v138, s45
    v_perm_b32 v159, v150, v146, s45
    v_perm_b32 v160, v141, v137, s44
    v_perm_b32 v161, v149, v145, s44
    v_perm_b32 v162, v143, v139, s44
    v_perm_b32 v163, v151, v147, s44
    v_perm_b32 v164, v141, v137, s45
    v_perm_b32 v165, v149, v145, s45
    v_perm_b32 v166, v143, v139, s45
    v_perm_b32 v167, v151, v147, s45
    v_mov_b32_dpp v136, v122 row_ror:8 row_mask:0xf bank_mask:0xf
    v_mov_b32_dpp v137, v123 row_ror:8 row_mask:0xf bank_mask:0xf
    v_mov_b32_dpp v138, v126 row_ror:8 row_mask:0xf bank_mask:0xf
    v_mov_b32_dpp v139, v127 row_ror:8 row_mask:0xf bank_mask:0xf
    v_mov_b32_dpp v140, v130 row_ror:8 row_mask:0xf bank_mask:0xf
    v_mov_b32_dpp v141, v131 row_ror:8 row_mask:0xf bank_mask:0xf
    v_mov_b32_dpp v142, v134 row_ror:8 row_mask:0xf bank_mask:0xf
    v_mov_b32_dpp v143, v135 row_ror:8 row_mask:0xf bank_mask:0xf
    v_mov_b32_dpp v122, v120 row_ror:8 row_mask:0xf bank_mask:0x3
    v_mov_b32_dpp v123, v121 row_ror:8 row_mask:0xf bank_mask:0x3
    v_mov_b32_dpp v126, v124 row_ror:8 row_mask:0xf bank_mask:0x3
    v_mov_b32_dpp v127, v125 row_ror:8 row_mask:0xf bank_mask:0x3
    v_mov_b32_dpp v130, v128 row_ror:8 row_mask:0xf bank_mask:0x3
    v_mov_b32_dpp v131, v129 row_ror:8 row_mask:0xf bank_mask:0x3
    v_mov_b32_dpp v134, v132 row_ror:8 row_mask:0xf bank_mask:0x3
    v_mov_b32_dpp v135, v133 row_ror:8 row_mask:0xf bank_mask:0x3
    v_mov_b32_dpp v120, v136 quad_perm:[0,1,2,3] row_mask:0xf bank_mask:0xc
    v_mov_b32_dpp v121, v137 quad_perm:[0,1,2,3] row_mask:0xf bank_mask:0xc
    v_mov_b32_dpp v124, v138 quad_perm:[0,1,2,3] row_mask:0xf bank_mask:0xc
    v_mov_b32_dpp v125, v139 quad_perm:[0,1,2,3] row_mask:0xf bank_mask:0xc
    v_mov_b32_dpp v128, v140 quad_perm:[0,1,2,3] row_mask:0xf bank_mask:0xc
    v_mov_b32_dpp v129, v141 quad_perm:[0,1,2,3] row_mask:0xf bank_mask:0xc
    v_mov_b32_dpp v132, v142 quad_perm:[0,1,2,3] row_mask:0xf bank_mask:0xc
    v_mov_b32_dpp v133, v143 quad_perm:[0,1,2,3] row_mask:0xf bank_mask:0xc
    v_perm_b32 v136, v124, v120, s44
    v_perm_b32 v137, v132, v128, s44
    v_perm_b32 v138, v126, v122, s44
    v_perm_b32 v139, v134, v130, s44
    v_perm_b32 v140, v124, v120, s45
    v_perm_b32 v141, v132, v128, s45
    v_perm_b32 v142, v126, v122, s45
    v_perm_b32 v143, v134, v130, s45
    v_perm_b32 v144, v125, v121, s44
    v_perm_b32 v145, v133, v129, s44
    v_perm_b32 v146, v127, v123, s44
    v_perm_b32 v147, v135, v131, s44
    v_perm_b32 v148, v125, v121, s45
    v_perm_b32 v149, v133, v129, s45
    v_perm_b32 v150, v127, v123, s45
    v_perm_b32 v151, v135, v131, s45
    v_mov_b32_dpp v120, v106 row_ror:8 row_mask:0xf bank_mask:0xf
    v_mov_b32_dpp v121, v107 row_ror:8 row_mask:0xf bank_mask:0xf
    v_mov_b32_dpp v122, v110 row_ror:8 row_mask:0xf bank_mask:0xf
    v_mov_b32_dpp v123, v111 row_ror:8 row_mask:0xf bank_mask:0xf
    v_mov_b32_dpp v124, v114 row_ror:8 row_mask:0xf bank_mask:0xf
    v_mov_b32_dpp v125, v115 row_ror:8 row_mask:0xf bank_mask:0xf
    v_mov_b32_dpp v126, v118 row_ror:8 row_mask:0xf bank_mask:0xf
    v_mov_b32_dpp v127, v119 row_ror:8 row_mask:0xf bank_mask:0xf
    v_mov_b32_dpp v106, v104 row_ror:8 row_mask:0xf bank_mask:0x3
    v_mov_b32_dpp v107, v105 row_ror:8 row_mask:0xf bank_mask:0x3
    v_mov_b32_dpp v110, v108 row_ror:8 row_mask:0xf bank_mask:0x3
    v_mov_b32_dpp v111, v109 row_ror:8 row_mask:0xf bank_mask:0x3
    v_mov_b32_dpp v114, v112 row_ror:8 row_mask:0xf bank_mask:0x3
    v_mov_b32_dpp v115, v113 row_ror:8 row_mask:0xf bank_mask:0x3
    v_mov_b32_dpp v118, v116 row_ror:8 row_mask:0xf bank_mask:0x3
    v_mov_b32_dpp v119, v117 row_ror:8 row_mask:0xf bank_mask:0x3
    v_mov_b32_dpp v104, v120 quad_perm:[0,1,2,3] row_mask:0xf bank_mask:0xc
    v_mov_b32_dpp v105, v121 quad_perm:[0,1,2,3] row_mask:0xf bank_mask:0xc
    v_mov_b32_dpp v108, v122 quad_perm:[0,1,2,3] row_mask:0xf bank_mask:0xc
    v_mov_b32_dpp v109, v123 quad_perm:[0,1,2,3] row_mask:0xf bank_mask:0xc
    v_mov_b32_dpp v112, v124 quad_perm:[0,1,2,3] row_mask:0xf bank_mask:0xc
    v_mov_b32_dpp v113, v125 quad_perm:[0,1,2,3] row_mask:0xf bank_mask:0xc
    v_mov_b32_dpp v116, v126 quad_perm:[0,1,2,3] row_mask:0xf bank_mask:0xc
    v_mov_b32_dpp v117, v127 quad_perm:[0,1,2,3] row_mask:0xf bank_mask:0xc
    v_perm_b32 v120, v108, v104, s44
    v_perm_b32 v121, v116, v112, s44
    v_perm_b32 v122, v110, v106, s44
    v_perm_b32 v123, v118, v114, s44
    v_perm_b32 v124, v108, v104, s45
    v_perm_b32 v125, v116, v112, s45
    v_perm_b32 v126, v110, v106, s45
    v_perm_b32 v127, v118, v114, s45
    v_perm_b32 v128, v109, v105, s44
    v_perm_b32 v129, v117, v113, s44
    v_perm_b32 v130, v111, v107, s44
    v_perm_b32 v131, v119, v115, s44
    v_perm_b32 v132, v109, v105, s45
    v_perm_b32 v133, v117, v113, s45
    v_perm_b32 v134, v111, v107, s45
    v_perm_b32 v135, v119, v115, s45
    v_mov_b32_dpp v104, v90 row_ror:8 row_mask:0xf bank_mask:0xf
    v_mov_b32_dpp v105, v91 row_ror:8 row_mask:0xf bank_mask:0xf
    v_mov_b32_dpp v106, v94 row_ror:8 row_mask:0xf bank_mask:0xf
    v_mov_b32_dpp v107, v95 row_ror:8 row_mask:0xf bank_mask:0xf
    v_mov_b32_dpp v108, v98 row_ror:8 row_mask:0xf bank_mask:0xf
    v_mov_b32_dpp v109, v99 row_ror:8 row_mask:0xf bank_mask:0xf
    v_mov_b32_dpp v110, v102 row_ror:8 row_mask:0xf bank_mask:0xf
    v_mov_b32_dpp v111, v103 row_ror:8 row_mask:0xf bank_mask:0xf
    v_mov_b32_dpp v90, v88 row_ror:8 row_mask:0xf bank_mask:0x3
    v_mov_b32_dpp v91, v89 row_ror:8 row_mask:0xf bank_mask:0x3
    v_mov_b32_dpp v94, v92 row_ror:8 row_mask:0xf bank_mask:0x3
    v_mov_b32_dpp v95, v93 row_ror:8 row_mask:0xf bank_mask:0x3
    v_mov_b32_dpp v98, v96 row_ror:8 row_mask:0xf bank_mask:0x3
    v_mov_b32_dpp v99, v97 row_ror:8 row_mask:0xf bank_mask:0x3
    v_mov_b32_dpp v102, v100 row_ror:8 row_mask:0xf bank_mask:0x3
    v_mov_b32_dpp v103, v101 row_ror:8 row_mask:0xf bank_mask:0x3
    v_mov_b32_dpp v88, v104 quad_perm:[0,1,2,3] row_mask:0xf bank_mask:0xc
    v_mov_b32_dpp v89, v105 quad_perm:[0,1,2,3] row_mask:0xf bank_mask:0xc
    v_mov_b32_dpp v92, v106 quad_perm:[0,1,2,3] row_mask:0xf bank_mask:0xc
    v_mov_b32_dpp v93, v107 quad_perm:[0,1,2,3] row_mask:0xf bank_mask:0xc
    v_mov_b32_dpp v96, v108 quad_perm:[0,1,2,3] row_mask:0xf bank_mask:0xc
    v_mov_b32_dpp v97, v109 quad_perm:[0,1,2,3] row_mask:0xf bank_mask:0xc
    v_mov_b32_dpp v100, v110 quad_perm:[0,1,2,3] row_mask:0xf bank_mask:0xc
    v_mov_b32_dpp v101, v111 quad_perm:[0,1,2,3] row_mask:0xf bank_mask:0xc
    v_perm_b32 v104, v92, v88, s44
    v_perm_b32 v105, v100, v96, s44
    v_perm_b32 v106, v94, v90, s44
    v_perm_b32 v107, v102, v98, s44
    v_perm_b32 v108, v92, v88, s45
    v_perm_b32 v109, v100, v96, s45
    v_perm_b32 v110, v94, v90, s45
    v_perm_b32 v111, v102, v98, s45
    v_perm_b32 v112, v93, v89, s44
    v_perm_b32 v113, v101, v97, s44
    v_perm_b32 v114, v95, v91, s44
    v_perm_b32 v115, v103, v99, s44
    v_perm_b32 v116, v93, v89, s45
    v_perm_b32 v117, v101, v97, s45
    v_perm_b32 v118, v95, v91, s45
    v_perm_b32 v119, v103, v99, s45
    v_mov_b32_dpp v88, v74 row_ror:8 row_mask:0xf bank_mask:0xf
    v_mov_b32_dpp v89, v75 row_ror:8 row_mask:0xf bank_mask:0xf
    v_mov_b32_dpp v90, v78 row_ror:8 row_mask:0xf bank_mask:0xf
    v_mov_b32_dpp v91, v79 row_ror:8 row_mask:0xf bank_mask:0xf
    v_mov_b32_dpp v92, v82 row_ror:8 row_mask:0xf bank_mask:0xf
    v_mov_b32_dpp v93, v83 row_ror:8 row_mask:0xf bank_mask:0xf
    v_mov_b32_dpp v94, v86 row_ror:8 row_mask:0xf bank_mask:0xf
    v_mov_b32_dpp v95, v87 row_ror:8 row_mask:0xf bank_mask:0xf
    v_mov_b32_dpp v74, v72 row_ror:8 row_mask:0xf bank_mask:0x3
    v_mov_b32_dpp v75, v73 row_ror:8 row_mask:0xf bank_mask:0x3
    v_mov_b32_dpp v78, v76 row_ror:8 row_mask:0xf bank_mask:0x3
    v_mov_b32_dpp v79, v77 row_ror:8 row_mask:0xf bank_mask:0x3
    v_mov_b32_dpp v82, v80 row_ror:8 row_mask:0xf bank_mask:0x3
    v_mov_b32_dpp v83, v81 row_ror:8 row_mask:0xf bank_mask:0x3
    v_mov_b32_dpp v86, v84 row_ror:8 row_mask:0xf bank_mask:0x3
    v_mov_b32_dpp v87, v85 row_ror:8 row_mask:0xf bank_mask:0x3
    v_mov_b32_dpp v72, v88 quad_perm:[0,1,2,3] row_mask:0xf bank_mask:0xc
    v_mov_b32_dpp v73, v89 quad_perm:[0,1,2,3] row_mask:0xf bank_mask:0xc
    v_mov_b32_dpp v76, v90 quad_perm:[0,1,2,3] row_mask:0xf bank_mask:0xc
    v_mov_b32_dpp v77, v91 quad_perm:[0,1,2,3] row_mask:0xf bank_mask:0xc
    v_mov_b32_dpp v80, v92 quad_perm:[0,1,2,3] row_mask:0xf bank_mask:0xc
    v_mov_b32_dpp v81, v93 quad_perm:[0,1,2,3] row_mask:0xf bank_mask:0xc
    v_mov_b32_dpp v84, v94 quad_perm:[0,1,2,3] row_mask:0xf bank_mask:0xc
    v_mov_b32_dpp v85, v95 quad_perm:[0,1,2,3] row_mask:0xf bank_mask:0xc
    v_perm_b32 v88, v76, v72, s44
    v_perm_b32 v89, v84, v80, s44
    v_perm_b32 v90, v78, v74, s44
    v_perm_b32 v91, v86, v82, s44
    v_perm_b32 v92, v76, v72, s45
    v_perm_b32 v93, v84, v80, s45
    v_perm_b32 v94, v78, v74, s45
    v_perm_b32 v95, v86, v82, s45
    v_perm_b32 v96, v77, v73, s44
    v_perm_b32 v97, v85, v81, s44
    v_perm_b32 v98, v79, v75, s44
    v_perm_b32 v99, v87, v83, s44
    v_perm_b32 v100, v77, v73, s45
    v_perm_b32 v101, v85, v81, s45
    v_perm_b32 v102, v79, v75, s45
    v_perm_b32 v103, v87, v83, s45
    v_mov_b32_dpp v72, v58 row_ror:8 row_mask:0xf bank_mask:0xf
    v_mov_b32_dpp v73, v59 row_ror:8 row_mask:0xf bank_mask:0xf
    v_mov_b32_dpp v74, v62 row_ror:8 row_mask:0xf bank_mask:0xf
    v_mov_b32_dpp v75, v63 row_ror:8 row_mask:0xf bank_mask:0xf
    v_mov_b32_dpp v76, v66 row_ror:8 row_mask:0xf bank_mask:0xf
    v_mov_b32_dpp v77, v67 row_ror:8 row_mask:0xf bank_mask:0xf
    v_mov_b32_dpp v78, v70 row_ror:8 row_mask:0xf bank_mask:0xf
    v_mov_b32_dpp v79, v71 row_ror:8 row_mask:0xf bank_mask:0xf
    v_mov_b32_dpp v58, v56 row_ror:8 row_mask:0xf bank_mask:0x3
    v_mov_b32_dpp v59, v57 row_ror:8 row_mask:0xf bank_mask:0x3
    v_mov_b32_dpp v62, v60 row_ror:8 row_mask:0xf bank_mask:0x3
    v_mov_b32_dpp v63, v61 row_ror:8 row_mask:0xf bank_mask:0x3
    v_mov_b32_dpp v66, v64 row_ror:8 row_mask:0xf bank_mask:0x3
    v_mov_b32_dpp v67, v65 row_ror:8 row_mask:0xf bank_mask:0x3
    v_mov_b32_dpp v70, v68 row_ror:8 row_mask:0xf bank_mask:0x3
    v_mov_b32_dpp v71, v69 row_ror:8 row_mask:0xf bank_mask:0x3
    v_mov_b32_dpp v56, v72 quad_perm:[0,1,2,3] row_mask:0xf bank_mask:0xc
    v_mov_b32_dpp v57, v73 quad_perm:[0,1,2,3] row_mask:0xf bank_mask:0xc
    v_mov_b32_dpp v60, v74 quad_perm:[0,1,2,3] row_mask:0xf bank_mask:0xc
    v_mov_b32_dpp v61, v75 quad_perm:[0,1,2,3] row_mask:0xf bank_mask:0xc
    v_mov_b32_dpp v64, v76 quad_perm:[0,1,2,3] row_mask:0xf bank_mask:0xc
    v_mov_b32_dpp v65, v77 quad_perm:[0,1,2,3] row_mask:0xf bank_mask:0xc
    v_mov_b32_dpp v68, v78 quad_perm:[0,1,2,3] row_mask:0xf bank_mask:0xc
    v_mov_b32_dpp v69, v79 quad_perm:[0,1,2,3] row_mask:0xf bank_mask:0xc
    v_perm_b32 v72, v60, v56, s44
    v_perm_b32 v73, v68, v64, s44
    v_perm_b32 v74, v62, v58, s44
    v_perm_b32 v75, v70, v66, s44
    v_perm_b32 v76, v60, v56, s45
    v_perm_b32 v77, v68, v64, s45
    v_perm_b32 v78, v62, v58, s45
    v_perm_b32 v79, v70, v66, s45
    v_perm_b32 v80, v61, v57, s44
    v_perm_b32 v81, v69, v65, s44
    v_perm_b32 v82, v63, v59, s44
    v_perm_b32 v83, v71, v67, s44
    v_perm_b32 v84, v61, v57, s45
    v_perm_b32 v85, v69, v65, s45
    v_perm_b32 v86, v63, v59, s45
    v_perm_b32 v87, v71, v67, s45
    v_mov_b32_dpp v56, v42 row_ror:8 row_mask:0xf bank_mask:0xf
    v_mov_b32_dpp v57, v43 row_ror:8 row_mask:0xf bank_mask:0xf
    v_mov_b32_dpp v58, v46 row_ror:8 row_mask:0xf bank_mask:0xf
    v_mov_b32_dpp v59, v47 row_ror:8 row_mask:0xf bank_mask:0xf
    v_mov_b32_dpp v60, v50 row_ror:8 row_mask:0xf bank_mask:0xf
    v_mov_b32_dpp v61, v51 row_ror:8 row_mask:0xf bank_mask:0xf
    v_mov_b32_dpp v62, v54 row_ror:8 row_mask:0xf bank_mask:0xf
    v_mov_b32_dpp v63, v55 row_ror:8 row_mask:0xf bank_mask:0xf
    v_mov_b32_dpp v42, v40 row_ror:8 row_mask:0xf bank_mask:0x3
    v_mov_b32_dpp v43, v41 row_ror:8 row_mask:0xf bank_mask:0x3
    v_mov_b32_dpp v46, v44 row_ror:8 row_mask:0xf bank_mask:0x3
    v_mov_b32_dpp v47, v45 row_ror:8 row_mask:0xf bank_mask:0x3
    v_mov_b32_dpp v50, v48 row_ror:8 row_mask:0xf bank_mask:0x3
    v_mov_b32_dpp v51, v49 row_ror:8 row_mask:0xf bank_mask:0x3
    v_mov_b32_dpp v54, v52 row_ror:8 row_mask:0xf bank_mask:0x3
    v_mov_b32_dpp v55, v53 row_ror:8 row_mask:0xf bank_mask:0x3
    v_mov_b32_dpp v40, v56 quad_perm:[0,1,2,3] row_mask:0xf bank_mask:0xc
    v_mov_b32_dpp v41, v57 quad_perm:[0,1,2,3] row_mask:0xf bank_mask:0xc
    v_mov_b32_dpp v44, v58 quad_perm:[0,1,2,3] row_mask:0xf bank_mask:0xc
    v_mov_b32_dpp v45, v59 quad_perm:[0,1,2,3] row_mask:0xf bank_mask:0xc
    v_mov_b32_dpp v48, v60 quad_perm:[0,1,2,3] row_mask:0xf bank_mask:0xc
    v_mov_b32_dpp v49, v61 quad_perm:[0,1,2,3] row_mask:0xf bank_mask:0xc
    v_mov_b32_dpp v52, v62 quad_perm:[0,1,2,3] row_mask:0xf bank_mask:0xc
    v_mov_b32_dpp v53, v63 quad_perm:[0,1,2,3] row_mask:0xf bank_mask:0xc
    v_perm_b32 v56, v44, v40, s44
    v_perm_b32 v57, v52, v48, s44
    v_perm_b32 v58, v46, v42, s44
    v_perm_b32 v59, v54, v50, s44
    v_perm_b32 v60, v44, v40, s45
    v_perm_b32 v61, v52, v48, s45
    v_perm_b32 v62, v46, v42, s45
    v_perm_b32 v63, v54, v50, s45
    v_perm_b32 v64, v45, v41, s44
    v_perm_b32 v65, v53, v49, s44
    v_perm_b32 v66, v47, v43, s44
    v_perm_b32 v67, v55, v51, s44
    v_perm_b32 v68, v45, v41, s45
    v_perm_b32 v69, v53, v49, s45
    v_perm_b32 v70, v47, v43, s45
    v_perm_b32 v71, v55, v51, s45
    s_waitcnt vmcnt(0)
    v_mov_b32_dpp v40, v26 row_ror:8 row_mask:0xf bank_mask:0xf
    v_mov_b32_dpp v41, v27 row_ror:8 row_mask:0xf bank_mask:0xf
    v_mov_b32_dpp v42, v30 row_ror:8 row_mask:0xf bank_mask:0xf
    v_mov_b32_dpp v43, v31 row_ror:8 row_mask:0xf bank_mask:0xf
    v_mov_b32_dpp v44, v34 row_ror:8 row_mask:0xf bank_mask:0xf
    v_mov_b32_dpp v45, v35 row_ror:8 row_mask:0xf bank_mask:0xf
    v_mov_b32_dpp v46, v38 row_ror:8 row_mask:0xf bank_mask:0xf
    v_mov_b32_dpp v47, v39 row_ror:8 row_mask:0xf bank_mask:0xf
    v_mov_b32_dpp v26, v24 row_ror:8 row_mask:0xf bank_mask:0x3
    v_mov_b32_dpp v27, v25 row_ror:8 row_mask:0xf bank_mask:0x3
    v_mov_b32_dpp v30, v28 row_ror:8 row_mask:0xf bank_mask:0x3
    v_mov_b32_dpp v31, v29 row_ror:8 row_mask:0xf bank_mask:0x3
    v_mov_b32_dpp v34, v32 row_ror:8 row_mask:0xf bank_mask:0x3
    v_mov_b32_dpp v35, v33 row_ror:8 row_mask:0xf bank_mask:0x3
    v_mov_b32_dpp v38, v36 row_ror:8 row_mask:0xf bank_mask:0x3
    v_mov_b32_dpp v39, v37 row_ror:8 row_mask:0xf bank_mask:0x3
    v_mov_b32_dpp v24, v40 quad_perm:[0,1,2,3] row_mask:0xf bank_mask:0xc
    v_mov_b32_dpp v25, v41 quad_perm:[0,1,2,3] row_mask:0xf bank_mask:0xc
    v_mov_b32_dpp v28, v42 quad_perm:[0,1,2,3] row_mask:0xf bank_mask:0xc
    v_mov_b32_dpp v29, v43 quad_perm:[0,1,2,3] row_mask:0xf bank_mask:0xc
    v_mov_b32_dpp v32, v44 quad_perm:[0,1,2,3] row_mask:0xf bank_mask:0xc
    v_mov_b32_dpp v33, v45 quad_perm:[0,1,2,3] row_mask:0xf bank_mask:0xc
    v_mov_b32_dpp v36, v46 quad_perm:[0,1,2,3] row_mask:0xf bank_mask:0xc
    v_mov_b32_dpp v37, v47 quad_perm:[0,1,2,3] row_mask:0xf bank_mask:0xc
    v_perm_b32 v40, v28, v24, s44
    v_perm_b32 v41, v36, v32, s44
    v_perm_b32 v42, v30, v26, s44
    v_perm_b32 v43, v38, v34, s44
    v_perm_b32 v44, v28, v24, s45
    v_perm_b32 v45, v36, v32, s45
    v_perm_b32 v46, v30, v26, s45
    v_perm_b32 v47, v38, v34, s45
    v_perm_b32 v48, v29, v25, s44
    v_perm_b32 v49, v37, v33, s44
    v_perm_b32 v50, v31, v27, s44
    v_perm_b32 v51, v39, v35, s44
    v_perm_b32 v52, v29, v25, s45
    v_perm_b32 v53, v37, v33, s45
    v_perm_b32 v54, v31, v27, s45
    v_perm_b32 v55, v39, v35, s45
    v_lshrrev_b32 v1, 4, v3
    v_lshlrev_b32 v1, 11, v1
    v_and_b32 v4, 7, v3
    v_lshl_add_u32 v1, v4, 4, v1
    v_bfe_u32 v4, v3, 3, 1
    v_lshl_add_u32 v1, v4, 9, v1
    v_and_b32 v4, 3, v3
    v_lshrrev_b32 v5, 2, v3
    v_mul_u32_u24 v0, 576, v4
    v_lshl_add_u32 v0, v5, 3, v0
    v_add_u32 v0, 40960, v0
    s_lshl_b32 s38, s41, 11
    s_lshl_b32 s53, s17, 7
    s_add_u32 s38, s38, s53
    s_mov_b32 s36, 0x24924924
    s_mov_b32 s39, 0
    s_waitcnt vmcnt(0)
gm_poll:
    v_mov_b32 v2, 0
    ds_read_b32 v2, v2 offset:276
    s_waitcnt lgkmcnt(0)
    v_readfirstlane_b32 s52, v2
    s_and_b32 s52, s52, s36
    s_cbranch_scc1 gm_go
    s_sleep 2
    s_branch gm_poll
gm_go:
    s_ff1_i32_b32 s52, s52
    s_bitset0_b32 s36, s52
    s_mul_i32 s52, s52, 11
    s_bfe_u32 s53, s52, 0x10005
    s_bfe_u32 s52, s52, 0x30006
    s_mul_i32 s35, s53, 61440
    s_mul_i32 s31, s52, 2304
    s_add_u32 s31, s31, s35
    s_sub_u32 s35, s31, s39
    v_add_u32 v0, s35, v0
    ds_read_b64_tr_b16 v[12:13], v0 offset:0
    ds_read_b64_tr_b16 v[14:15], v0 offset:128
    ds_read_b64_tr_b16 v[16:17], v0 offset:256
    ds_read_b64_tr_b16 v[18:19], v0 offset:384
    s_mov_b32 s39, s31
    s_mul_i32 s33, s53, 5
    s_add_u32 s33, s33, s52
    s_lshl_b32 s33, s33, 13
    s_add_u32 s33, s33, s38
    s_mov_b32 s37, s33
    s_mov_b32 s32, 0x7ffffff0
gm_loop:
    s_waitcnt lgkmcnt(2)
    v_mfma_f32_16x16x32_bf16 v[24:27], v[12:15], v[40:43], 0
    s_setprio 3
    v_cvt_pk_bf16_f32 v7, v33, v37
    v_cvt_pk_bf16_f32 v5, v32, v36
    ds_read_b64_tr_b16 v[20:21], v0 offset:15360
    s_setprio 0
    v_mfma_f32_16x16x32_bf16 v[28:31], v[12:15], v[44:47], 0
    s_setprio 3
    v_cvt_pk_bf16_f32 v11, v35, v39
    v_cvt_pk_bf16_f32 v9, v34, v38
    ds_read_b64_tr_b16 v[22:23], v0 offset:15488
    s_setprio 0
    v_mfma_f32_16x16x32_bf16 v[32:35], v[12:15], v[48:51], 0
    s_setprio 3
    v_mov_b32_dpp v2, v6 row_ror:8 row_mask:0xf bank_mask:0xf
    v_mov_b32_dpp v3, v7 row_ror:8 row_mask:0xf bank_mask:0xf
    s_setprio 0
    v_mfma_f32_16x16x32_bf16 v[36:39], v[12:15], v[52:55], 0
    s_setprio 3
    v_mov_b32_dpp v6, v4 row_ror:8 row_mask:0xf bank_mask:0x3
    v_mov_b32_dpp v7, v5 row_ror:8 row_mask:0xf bank_mask:0x3
    s_setprio 0
    s_waitcnt lgkmcnt(2)
    v_mfma_f32_16x16x32_bf16 v[24:27], v[16:19], v[56:59], v[24:27]
    s_setprio 3
    ds_read_b64_tr_b16 v[12:13], v0 offset:15616
    v_mov_b32_dpp v4, v2 quad_perm:[0,1,2,3] row_mask:0xf bank_mask:0xc
    s_setprio 0
    v_mfma_f32_16x16x32_bf16 v[28:31], v[16:19], v[60:63], v[28:31]
    s_setprio 3
    ds_read_b64_tr_b16 v[14:15], v0 offset:15744
    v_mov_b32_dpp v5, v3 quad_perm:[0,1,2,3] row_mask:0xf bank_mask:0xc
    s_setprio 0
    v_mfma_f32_16x16x32_bf16 v[32:35], v[16:19], v[64:67], v[32:35]
    s_setprio 3
    buffer_store_dwordx4 v[4:7], v1, s[12:15], s32 offen offset:0 sc0 sc1
    v_mov_b32_dpp v2, v10 row_ror:8 row_mask:0xf bank_mask:0xf
    s_setprio 0
    v_mfma_f32_16x16x32_bf16 v[36:39], v[16:19], v[68:71], v[36:39]
    s_setprio 3
    v_mov_b32_dpp v3, v11 row_ror:8 row_mask:0xf bank_mask:0xf
    v_mov_b32_dpp v10, v8 row_ror:8 row_mask:0xf bank_mask:0x3
    s_setprio 0
    s_waitcnt lgkmcnt(2)
    v_mfma_f32_16x16x32_bf16 v[24:27], v[20:23], v[72:75], v[24:27]
    s_setprio 3
    ds_read_b64_tr_b16 v[16:17], v0 offset:30720
    v_mov_b32_dpp v11, v9 row_ror:8 row_mask:0xf bank_mask:0x3
    s_setprio 0
    v_mfma_f32_16x16x32_bf16 v[28:31], v[20:23], v[76:79], v[28:31]
    s_setprio 3
    ds_read_b64_tr_b16 v[18:19], v0 offset:30848
    v_mov_b32_dpp v8, v2 quad_perm:[0,1,2,3] row_mask:0xf bank_mask:0xc
    s_setprio 0
    v_mfma_f32_16x16x32_bf16 v[32:35], v[20:23], v[80:83], v[32:35]
    s_setprio 3
    v_mov_b32_dpp v9, v3 quad_perm:[0,1,2,3] row_mask:0xf bank_mask:0xc
    buffer_store_dwordx4 v[8:11], v1, s[12:15], s32 offen offset:1024 sc0 sc1
    s_setprio 0
    v_mfma_f32_16x16x32_bf16 v[36:39], v[20:23], v[84:87], v[36:39]
    s_waitcnt lgkmcnt(2)
    v_mfma_f32_16x16x32_bf16 v[24:27], v[12:15], v[88:91], v[24:27]
    ds_read_b64_tr_b16 v[20:21], v0 offset:30976
    v_mfma_f32_16x16x32_bf16 v[28:31], v[12:15], v[92:95], v[28:31]
    ds_read_b64_tr_b16 v[22:23], v0 offset:31104
    v_mfma_f32_16x16x32_bf16 v[32:35], v[12:15], v[96:99], v[32:35]
    s_setprio 3
    v_mov_b32 v2, 0
    s_setprio 0
    v_mfma_f32_16x16x32_bf16 v[36:39], v[12:15], v[100:103], v[36:39]
    ds_read_b32 v2, v2 offset:276
    s_waitcnt lgkmcnt(3)
    v_mfma_f32_16x16x32_bf16 v[24:27], v[16:19], v[104:107], v[24:27]
    ds_read_b64_tr_b16 v[12:13], v0 offset:46080
    v_mfma_f32_16x16x32_bf16 v[28:31], v[16:19], v[108:111], v[28:31]
    ds_read_b64_tr_b16 v[14:15], v0 offset:46208
    v_mfma_f32_16x16x32_bf16 v[32:35], v[16:19], v[112:115], v[32:35]
    s_setprio 3
    s_waitcnt lgkmcnt(2)
    v_readfirstlane_b32 s52, v2
    s_and_b32 s52, s52, s36
    s_setprio 0
    v_mfma_f32_16x16x32_bf16 v[36:39], v[16:19], v[116:119], v[36:39]
    s_cselect_b32 s34, 1, 0
    s_ff1_i32_b32 s52, s52
    s_waitcnt lgkmcnt(2)
    v_mfma_f32_16x16x32_bf16 v[24:27], v[20:23], v[120:123], v[24:27]
    ds_read_b64_tr_b16 v[16:17], v0 offset:46336
    s_bitset0_b32 s36, s52
    s_mul_i32 s52, s52, 11
    v_mfma_f32_16x16x32_bf16 v[28:31], v[20:23], v[124:127], v[28:31]
    ds_read_b64_tr_b16 v[18:19], v0 offset:46464
    s_bfe_u32 s53, s52, 0x10005
    s_bfe_u32 s52, s52, 0x30006
    v_mfma_f32_16x16x32_bf16 v[32:35], v[20:23], v[128:131], v[32:35]
    s_mul_i32 s35, s53, 61440
    s_mul_i32 s31, s52, 2304
    s_add_u32 s31, s31, s35
    v_mfma_f32_16x16x32_bf16 v[36:39], v[20:23], v[132:135], v[36:39]
    s_setprio 3
    s_sub_u32 s35, s31, s39
    v_add_u32 v0, s35, v0
    s_setprio 0
    s_waitcnt lgkmcnt(2)
    v_mfma_f32_16x16x32_bf16 v[24:27], v[12:15], v[136:139], v[24:27]
    ds_read_b64_tr_b16 v[20:21], v0 offset:0
    v_mfma_f32_16x16x32_bf16 v[28:31], v[12:15], v[140:143], v[28:31]
    ds_read_b64_tr_b16 v[22:23], v0 offset:128
    v_mfma_f32_16x16x32_bf16 v[32:35], v[12:15], v[144:147], v[32:35]
    s_mov_b32 s39, s31
    s_mul_i32 s33, s53, 5
    s_add_u32 s33, s33, s52
    v_mfma_f32_16x16x32_bf16 v[36:39], v[12:15], v[148:151], v[36:39]
    s_lshl_b32 s33, s33, 13
    s_add_u32 s33, s33, s38
    s_waitcnt lgkmcnt(2)
    v_mfma_f32_16x16x32_bf16 v[24:27], v[16:19], v[152:155], v[24:27]
    ds_read_b64_tr_b16 v[12:13], v0 offset:256
    v_mfma_f32_16x16x32_bf16 v[28:31], v[16:19], v[156:159], v[28:31]
    ds_read_b64_tr_b16 v[14:15], v0 offset:384
    s_mov_b32 s32, s37
    s_mov_b32 s37, s33
    v_mfma_f32_16x16x32_bf16 v[32:35], v[16:19], v[160:163], v[32:35]
    s_cmp_eq_u32 s34, 0
    s_nop 1
    v_mfma_f32_16x16x32_bf16 v[36:39], v[16:19], v[164:167], v[36:39]
    s_setprio 3
    v_cvt_pk_bf16_f32 v4, v24, v28
    v_cvt_pk_bf16_f32 v6, v25, v29
    v_cvt_pk_bf16_f32 v8, v26, v30
    v_cvt_pk_bf16_f32 v10, v27, v31
    s_setprio 0
    s_cbranch_scc1 gm_drain
    s_waitcnt lgkmcnt(2)
    v_mfma_f32_16x16x32_bf16 v[24:27], v[20:23], v[40:43], 0
    s_setprio 3
    v_cvt_pk_bf16_f32 v7, v33, v37
    v_cvt_pk_bf16_f32 v5, v32, v36
    ds_read_b64_tr_b16 v[16:17], v0 offset:15360
    s_setprio 0
    v_mfma_f32_16x16x32_bf16 v[28:31], v[20:23], v[44:47], 0
    s_setprio 3
    v_cvt_pk_bf16_f32 v11, v35, v39
    v_cvt_pk_bf16_f32 v9, v34, v38
    ds_read_b64_tr_b16 v[18:19], v0 offset:15488
    s_setprio 0
    v_mfma_f32_16x16x32_bf16 v[32:35], v[20:23], v[48:51], 0
    s_setprio 3
    v_mov_b32_dpp v2, v6 row_ror:8 row_mask:0xf bank_mask:0xf
    v_mov_b32_dpp v3, v7 row_ror:8 row_mask:0xf bank_mask:0xf
    s_setprio 0
    v_mfma_f32_16x16x32_bf16 v[36:39], v[20:23], v[52:55], 0
    s_setprio 3
    v_mov_b32_dpp v6, v4 row_ror:8 row_mask:0xf bank_mask:0x3
    v_mov_b32_dpp v7, v5 row_ror:8 row_mask:0xf bank_mask:0x3
    s_setprio 0
    s_waitcnt lgkmcnt(2)
    v_mfma_f32_16x16x32_bf16 v[24:27], v[12:15], v[56:59], v[24:27]
    s_setprio 3
    ds_read_b64_tr_b16 v[20:21], v0 offset:15616
    v_mov_b32_dpp v4, v2 quad_perm:[0,1,2,3] row_mask:0xf bank_mask:0xc
    s_setprio 0
    v_mfma_f32_16x16x32_bf16 v[28:31], v[12:15], v[60:63], v[28:31]
    s_setprio 3
    ds_read_b64_tr_b16 v[22:23], v0 offset:15744
    v_mov_b32_dpp v5, v3 quad_perm:[0,1,2,3] row_mask:0xf bank_mask:0xc
    s_setprio 0
    v_mfma_f32_16x16x32_bf16 v[32:35], v[12:15], v[64:67], v[32:35]
    s_setprio 3
    buffer_store_dwordx4 v[4:7], v1, s[12:15], s32 offen offset:0 sc0 sc1
    v_mov_b32_dpp v2, v10 row_ror:8 row_mask:0xf bank_mask:0xf
    s_setprio 0
    v_mfma_f32_16x16x32_bf16 v[36:39], v[12:15], v[68:71], v[36:39]
    s_setprio 3
    v_mov_b32_dpp v3, v11 row_ror:8 row_mask:0xf bank_mask:0xf
    v_mov_b32_dpp v10, v8 row_ror:8 row_mask:0xf bank_mask:0x3
    s_setprio 0
    s_waitcnt lgkmcnt(2)
    v_mfma_f32_16x16x32_bf16 v[24:27], v[16:19], v[72:75], v[24:27]
    s_setprio 3
    ds_read_b64_tr_b16 v[12:13], v0 offset:30720
    v_mov_b32_dpp v11, v9 row_ror:8 row_mask:0xf bank_mask:0x3
    s_setprio 0
    v_mfma_f32_16x16x32_bf16 v[28:31], v[16:19], v[76:79], v[28:31]
    s_setprio 3
    ds_read_b64_tr_b16 v[14:15], v0 offset:30848
    v_mov_b32_dpp v8, v2 quad_perm:[0,1,2,3] row_mask:0xf bank_mask:0xc
    s_setprio 0
    v_mfma_f32_16x16x32_bf16 v[32:35], v[16:19], v[80:83], v[32:35]
    s_setprio 3
    v_mov_b32_dpp v9, v3 quad_perm:[0,1,2,3] row_mask:0xf bank_mask:0xc
    buffer_store_dwordx4 v[8:11], v1, s[12:15], s32 offen offset:1024 sc0 sc1
    s_setprio 0
    v_mfma_f32_16x16x32_bf16 v[36:39], v[16:19], v[84:87], v[36:39]
    s_waitcnt lgkmcnt(2)
    v_mfma_f32_16x16x32_bf16 v[24:27], v[20:23], v[88:91], v[24:27]
    ds_read_b64_tr_b16 v[16:17], v0 offset:30976
    v_mfma_f32_16x16x32_bf16 v[28:31], v[20:23], v[92:95], v[28:31]
    ds_read_b64_tr_b16 v[18:19], v0 offset:31104
    v_mfma_f32_16x16x32_bf16 v[32:35], v[20:23], v[96:99], v[32:35]
    s_setprio 3
    v_mov_b32 v2, 0
    s_setprio 0
    v_mfma_f32_16x16x32_bf16 v[36:39], v[20:23], v[100:103], v[36:39]
    ds_read_b32 v2, v2 offset:276
    s_waitcnt lgkmcnt(3)
    v_mfma_f32_16x16x32_bf16 v[24:27], v[12:15], v[104:107], v[24:27]
    ds_read_b64_tr_b16 v[20:21], v0 offset:46080
    v_mfma_f32_16x16x32_bf16 v[28:31], v[12:15], v[108:111], v[28:31]
    ds_read_b64_tr_b16 v[22:23], v0 offset:46208
    v_mfma_f32_16x16x32_bf16 v[32:35], v[12:15], v[112:115], v[32:35]
    s_setprio 3
    s_waitcnt lgkmcnt(2)
    v_readfirstlane_b32 s52, v2
    s_and_b32 s52, s52, s36
    s_setprio 0
    v_mfma_f32_16x16x32_bf16 v[36:39], v[12:15], v[116:119], v[36:39]
    s_cselect_b32 s34, 1, 0
    s_ff1_i32_b32 s52, s52
    s_waitcnt lgkmcnt(2)
    v_mfma_f32_16x16x32_bf16 v[24:27], v[16:19], v[120:123], v[24:27]
    ds_read_b64_tr_b16 v[12:13], v0 offset:46336
    s_bitset0_b32 s36, s52
    s_mul_i32 s52, s52, 11
    v_mfma_f32_16x16x32_bf16 v[28:31], v[16:19], v[124:127], v[28:31]
    ds_read_b64_tr_b16 v[14:15], v0 offset:46464
    s_bfe_u32 s53, s52, 0x10005
    s_bfe_u32 s52, s52, 0x30006
    v_mfma_f32_16x16x32_bf16 v[32:35], v[16:19], v[128:131], v[32:35]
    s_mul_i32 s35, s53, 61440
    s_mul_i32 s31, s52, 2304
    s_add_u32 s31, s31, s35
    v_mfma_f32_16x16x32_bf16 v[36:39], v[16:19], v[132:135], v[36:39]
    s_setprio 3
    s_sub_u32 s35, s31, s39
    v_add_u32 v0, s35, v0
    s_setprio 0
    s_waitcnt lgkmcnt(2)
    v_mfma_f32_16x16x32_bf16 v[24:27], v[20:23], v[136:139], v[24:27]
    ds_read_b64_tr_b16 v[16:17], v0 offset:0
    v_mfma_f32_16x16x32_bf16 v[28:31], v[20:23], v[140:143], v[28:31]
    ds_read_b64_tr_b16 v[18:19], v0 offset:128
    v_mfma_f32_16x16x32_bf16 v[32:35], v[20:23], v[144:147], v[32:35]
    s_mov_b32 s39, s31
    s_mul_i32 s33, s53, 5
    s_add_u32 s33, s33, s52
    v_mfma_f32_16x16x32_bf16 v[36:39], v[20:23], v[148:151], v[36:39]
    s_lshl_b32 s33, s33, 13
    s_add_u32 s33, s33, s38
    s_waitcnt lgkmcnt(2)
    v_mfma_f32_16x16x32_bf16 v[24:27], v[12:15], v[152:155], v[24:27]
    ds_read_b64_tr_b16 v[20:21], v0 offset:256
    v_mfma_f32_16x16x32_bf16 v[28:31], v[12:15], v[156:159], v[28:31]
    ds_read_b64_tr_b16 v[22:23], v0 offset:384
    s_mov_b32 s32, s37
    s_mov_b32 s37, s33
    v_mfma_f32_16x16x32_bf16 v[32:35], v[12:15], v[160:163], v[32:35]
    s_cmp_eq_u32 s34, 0
    s_nop 1
    v_mfma_f32_16x16x32_bf16 v[36:39], v[12:15], v[164:167], v[36:39]
    s_setprio 3
    v_cvt_pk_bf16_f32 v4, v24, v28
    v_cvt_pk_bf16_f32 v6, v25, v29
    v_cvt_pk_bf16_f32 v8, v26, v30
    v_cvt_pk_bf16_f32 v10, v27, v31
    s_setprio 0
    s_cbranch_scc1 gm_drain
    s_waitcnt lgkmcnt(2)
    v_mfma_f32_16x16x32_bf16 v[24:27], v[16:19], v[40:43], 0
    s_setprio 3
    v_cvt_pk_bf16_f32 v7, v33, v37
    v_cvt_pk_bf16_f32 v5, v32, v36
    ds_read_b64_tr_b16 v[12:13], v0 offset:15360
    s_setprio 0
    v_mfma_f32_16x16x32_bf16 v[28:31], v[16:19], v[44:47], 0
    s_setprio 3
    v_cvt_pk_bf16_f32 v11, v35, v39
    v_cvt_pk_bf16_f32 v9, v34, v38
    ds_read_b64_tr_b16 v[14:15], v0 offset:15488
    s_setprio 0
    v_mfma_f32_16x16x32_bf16 v[32:35], v[16:19], v[48:51], 0
    s_setprio 3
    v_mov_b32_dpp v2, v6 row_ror:8 row_mask:0xf bank_mask:0xf
    v_mov_b32_dpp v3, v7 row_ror:8 row_mask:0xf bank_mask:0xf
    s_setprio 0
    v_mfma_f32_16x16x32_bf16 v[36:39], v[16:19], v[52:55], 0
    s_setprio 3
    v_mov_b32_dpp v6, v4 row_ror:8 row_mask:0xf bank_mask:0x3
    v_mov_b32_dpp v7, v5 row_ror:8 row_mask:0xf bank_mask:0x3
    s_setprio 0
    s_waitcnt lgkmcnt(2)
    v_mfma_f32_16x16x32_bf16 v[24:27], v[20:23], v[56:59], v[24:27]
    s_setprio 3
    ds_read_b64_tr_b16 v[16:17], v0 offset:15616
    v_mov_b32_dpp v4, v2 quad_perm:[0,1,2,3] row_mask:0xf bank_mask:0xc
    s_setprio 0
    v_mfma_f32_16x16x32_bf16 v[28:31], v[20:23], v[60:63], v[28:31]
    s_setprio 3
    ds_read_b64_tr_b16 v[18:19], v0 offset:15744
    v_mov_b32_dpp v5, v3 quad_perm:[0,1,2,3] row_mask:0xf bank_mask:0xc
    s_setprio 0
    v_mfma_f32_16x16x32_bf16 v[32:35], v[20:23], v[64:67], v[32:35]
    s_setprio 3
    buffer_store_dwordx4 v[4:7], v1, s[12:15], s32 offen offset:0 sc0 sc1
    v_mov_b32_dpp v2, v10 row_ror:8 row_mask:0xf bank_mask:0xf
    s_setprio 0
    v_mfma_f32_16x16x32_bf16 v[36:39], v[20:23], v[68:71], v[36:39]
    s_setprio 3
    v_mov_b32_dpp v3, v11 row_ror:8 row_mask:0xf bank_mask:0xf
    v_mov_b32_dpp v10, v8 row_ror:8 row_mask:0xf bank_mask:0x3
    s_setprio 0
    s_waitcnt lgkmcnt(2)
    v_mfma_f32_16x16x32_bf16 v[24:27], v[12:15], v[72:75], v[24:27]
    s_setprio 3
    ds_read_b64_tr_b16 v[20:21], v0 offset:30720
    v_mov_b32_dpp v11, v9 row_ror:8 row_mask:0xf bank_mask:0x3
    s_setprio 0
    v_mfma_f32_16x16x32_bf16 v[28:31], v[12:15], v[76:79], v[28:31]
    s_setprio 3
    ds_read_b64_tr_b16 v[22:23], v0 offset:30848
    v_mov_b32_dpp v8, v2 quad_perm:[0,1,2,3] row_mask:0xf bank_mask:0xc
    s_setprio 0
    v_mfma_f32_16x16x32_bf16 v[32:35], v[12:15], v[80:83], v[32:35]
    s_setprio 3
    v_mov_b32_dpp v9, v3 quad_perm:[0,1,2,3] row_mask:0xf bank_mask:0xc
    buffer_store_dwordx4 v[8:11], v1, s[12:15], s32 offen offset:1024 sc0 sc1
    s_setprio 0
    v_mfma_f32_16x16x32_bf16 v[36:39], v[12:15], v[84:87], v[36:39]
    s_waitcnt lgkmcnt(2)
    v_mfma_f32_16x16x32_bf16 v[24:27], v[16:19], v[88:91], v[24:27]
    ds_read_b64_tr_b16 v[12:13], v0 offset:30976
    v_mfma_f32_16x16x32_bf16 v[28:31], v[16:19], v[92:95], v[28:31]
    ds_read_b64_tr_b16 v[14:15], v0 offset:31104
    v_mfma_f32_16x16x32_bf16 v[32:35], v[16:19], v[96:99], v[32:35]
    s_setprio 3
    v_mov_b32 v2, 0
    s_setprio 0
    v_mfma_f32_16x16x32_bf16 v[36:39], v[16:19], v[100:103], v[36:39]
    ds_read_b32 v2, v2 offset:276
    s_waitcnt lgkmcnt(3)
    v_mfma_f32_16x16x32_bf16 v[24:27], v[20:23], v[104:107], v[24:27]
    ds_read_b64_tr_b16 v[16:17], v0 offset:46080
    v_mfma_f32_16x16x32_bf16 v[28:31], v[20:23], v[108:111], v[28:31]
    ds_read_b64_tr_b16 v[18:19], v0 offset:46208
    v_mfma_f32_16x16x32_bf16 v[32:35], v[20:23], v[112:115], v[32:35]
    s_setprio 3
    s_waitcnt lgkmcnt(2)
    v_readfirstlane_b32 s52, v2
    s_and_b32 s52, s52, s36
    s_setprio 0
    v_mfma_f32_16x16x32_bf16 v[36:39], v[20:23], v[116:119], v[36:39]
    s_cselect_b32 s34, 1, 0
    s_ff1_i32_b32 s52, s52
    s_waitcnt lgkmcnt(2)
    v_mfma_f32_16x16x32_bf16 v[24:27], v[12:15], v[120:123], v[24:27]
    ds_read_b64_tr_b16 v[20:21], v0 offset:46336
    s_bitset0_b32 s36, s52
    s_mul_i32 s52, s52, 11
    v_mfma_f32_16x16x32_bf16 v[28:31], v[12:15], v[124:127], v[28:31]
    ds_read_b64_tr_b16 v[22:23], v0 offset:46464
    s_bfe_u32 s53, s52, 0x10005
    s_bfe_u32 s52, s52, 0x30006
    v_mfma_f32_16x16x32_bf16 v[32:35], v[12:15], v[128:131], v[32:35]
    s_mul_i32 s35, s53, 61440
    s_mul_i32 s31, s52, 2304
    s_add_u32 s31, s31, s35
    v_mfma_f32_16x16x32_bf16 v[36:39], v[12:15], v[132:135], v[36:39]
    s_setprio 3
    s_sub_u32 s35, s31, s39
    v_add_u32 v0, s35, v0
    s_setprio 0
    s_waitcnt lgkmcnt(2)
    v_mfma_f32_16x16x32_bf16 v[24:27], v[16:19], v[136:139], v[24:27]
    ds_read_b64_tr_b16 v[12:13], v0 offset:0
    v_mfma_f32_16x16x32_bf16 v[28:31], v[16:19], v[140:143], v[28:31]
    ds_read_b64_tr_b16 v[14:15], v0 offset:128
    v_mfma_f32_16x16x32_bf16 v[32:35], v[16:19], v[144:147], v[32:35]
    s_mov_b32 s39, s31
    s_mul_i32 s33, s53, 5
    s_add_u32 s33, s33, s52
    v_mfma_f32_16x16x32_bf16 v[36:39], v[16:19], v[148:151], v[36:39]
    s_lshl_b32 s33, s33, 13
    s_add_u32 s33, s33, s38
    s_waitcnt lgkmcnt(2)
    v_mfma_f32_16x16x32_bf16 v[24:27], v[20:23], v[152:155], v[24:27]
    ds_read_b64_tr_b16 v[16:17], v0 offset:256
    v_mfma_f32_16x16x32_bf16 v[28:31], v[20:23], v[156:159], v[28:31]
    ds_read_b64_tr_b16 v[18:19], v0 offset:384
    s_mov_b32 s32, s37
    s_mov_b32 s37, s33
    v_mfma_f32_16x16x32_bf16 v[32:35], v[20:23], v[160:163], v[32:35]
    s_cmp_eq_u32 s34, 0
    s_nop 1
    v_mfma_f32_16x16x32_bf16 v[36:39], v[20:23], v[164:167], v[36:39]
    s_setprio 3
    v_cvt_pk_bf16_f32 v4, v24, v28
    v_cvt_pk_bf16_f32 v6, v25, v29
    v_cvt_pk_bf16_f32 v8, v26, v30
    v_cvt_pk_bf16_f32 v10, v27, v31
    s_setprio 0
    s_cbranch_scc0 gm_loop
gm_drain:
    s_nop 2
    s_setprio 3
    v_cvt_pk_bf16_f32 v7, v33, v37
    v_cvt_pk_bf16_f32 v5, v32, v36
    v_cvt_pk_bf16_f32 v11, v35, v39
    v_cvt_pk_bf16_f32 v9, v34, v38
    v_mov_b32_dpp v2, v6 row_ror:8 row_mask:0xf bank_mask:0xf
    v_mov_b32_dpp v3, v7 row_ror:8 row_mask:0xf bank_mask:0xf
    v_mov_b32_dpp v6, v4 row_ror:8 row_mask:0xf bank_mask:0x3
    v_mov_b32_dpp v7, v5 row_ror:8 row_mask:0xf bank_mask:0x3
    v_mov_b32_dpp v4, v2 quad_perm:[0,1,2,3] row_mask:0xf bank_mask:0xc
    v_mov_b32_dpp v5, v3 quad_perm:[0,1,2,3] row_mask:0xf bank_mask:0xc
    buffer_store_dwordx4 v[4:7], v1, s[12:15], s32 offen offset:0 sc0 sc1
    v_mov_b32_dpp v2, v10 row_ror:8 row_mask:0xf bank_mask:0xf
    v_mov_b32_dpp v3, v11 row_ror:8 row_mask:0xf bank_mask:0xf
    v_mov_b32_dpp v10, v8 row_ror:8 row_mask:0xf bank_mask:0x3
    v_mov_b32_dpp v11, v9 row_ror:8 row_mask:0xf bank_mask:0x3
    v_mov_b32_dpp v8, v2 quad_perm:[0,1,2,3] row_mask:0xf bank_mask:0xc
    v_mov_b32_dpp v9, v3 quad_perm:[0,1,2,3] row_mask:0xf bank_mask:0xc
    buffer_store_dwordx4 v[8:11], v1, s[12:15], s32 offen offset:1024 sc0 sc1
    s_setprio 0
    s_cmp_lg_u32 s36, 0
    s_cbranch_scc1 gm_poll
    s_endpgm
mn_sp1:
    v_mov_b32 v55, 0
    ds_read_b32 v55, v55 offset:308
    s_waitcnt lgkmcnt(0)
    v_readfirstlane_b32 s62, v55
    s_cmp_ge_u32 s62, 1
    s_cbranch_scc1 mn_sp1x
    s_sleep 1
    s_branch mn_sp1
gm_wait2:
    v_mov_b32 v15, 0
    ds_read_b32 v17, v15 offset:304
    s_waitcnt lgkmcnt(0)
    v_readfirstlane_b32 s62, v17
    s_cmp_lg_u32 s62, 0
    s_cbranch_scc1 gm_go2
    s_sleep 1
    s_branch gm_wait2
gm_ovf:
    s_movk_i32 s20, 4
    s_barrier
    s_barrier
    s_branch gm_pass
gm_next:
    s_add_u32 s24, s24, s20
    s_barrier
    s_branch gm_pass
mn_w5:
    s_and_b32 s62, s2, 15
    s_lshl_b32 s62, s62, 7
    s_add_u32 s62, s62, 11730944
    v_mov_b32 v55, s62
    v_lshlrev_b32 v56, 6, v0
    v_and_b32 v56, 0xc0, v56
    s_mov_b32 s63, 0x100000
mn_poll2dm:
    s_sub_u32 s63, s63, 1
    s_cbranch_scc1 mn_poll2dx
    global_load_dword v57, v56, s[60:61] sc1
    s_waitcnt vmcnt(0)
    v_add_u32_dpp v57, v57, v57 quad_perm:[2,3,0,1] row_mask:0xf bank_mask:0xf
    s_sleep 8
    v_readlane_b32 s62, v57, 1
    s_cmp_lt_u32 s62, 125
    s_cbranch_scc1 mn_poll2dm
mn_poll2dx:
    v_add_u32 v55, 12, v35
    v_add_u32 v55, s24, v55
    v_lshrrev_b32 v56, 16, v58
    v_mov_b32 v23, 0
    v_cmpx_lt_u32 vcc, v55, v56
    s_cbranch_execz mn_g0
    v_cmp_gt_u32 vcc, 15, v55
    v_and_b32 v56, 0xffff, v58
    v_add_lshl_u32 v56, v55, v56, 2
    v_add_u32 v56, v56, v46
    v_lshl_add_u32 v57, v0, 4, s22
    v_and_or_b32 v57, v55, 12, v57
    v_cndmask_b32 v56, v56, v57, vcc
    buffer_load_dword v23, v56, s[8:11], 0 offen sc1
    s_waitcnt vmcnt(0)
mn_g0:
    s_mov_b64 exec, -1
    v_add_u32 v55, 16, v35
    v_add_u32 v55, s24, v55
    v_lshrrev_b32 v56, 16, v58
    v_mov_b32 v24, 0
    v_cmpx_lt_u32 vcc, v55, v56
    s_cbranch_execz mn_g1
    v_cmp_gt_u32 vcc, 15, v55
    v_and_b32 v56, 0xffff, v58
    v_add_lshl_u32 v56, v55, v56, 2
    v_add_u32 v56, v56, v46
    v_lshl_add_u32 v57, v0, 4, s22
    v_and_or_b32 v57, v55, 12, v57
    v_cndmask_b32 v56, v56, v57, vcc
    buffer_load_dword v24, v56, s[8:11], 0 offen sc1
    s_waitcnt vmcnt(0)
mn_g1:
    s_mov_b64 exec, -1
mn_more:
    s_add_u32 s52, s24, s20
    v_lshrrev_b32 v56, 16, v58
    v_cmp_lt_u32 vcc, s52, v56
    s_cbranch_vccz mn_count
    v_mov_b32 v55, 272
    ds_write_b32 v55, v48
    s_branch mn_count
mn_ovf:
    s_movk_i32 s20, 4
    s_waitcnt vmcnt(0) lgkmcnt(0)
    s_barrier
    s_branch mn_again
mn_next:
    s_set_gpr_idx_off
    s_waitcnt vmcnt(0) lgkmcnt(0)
    s_nop 7
    s_add_u32 s24, s24, s20
    v_mbcnt_lo_u32_b32 v0, -1, 0
    v_mbcnt_hi_u32_b32 v0, -1, v0
    v_lshl_add_u32 v0, s16, 6, v0
    v_lshrrev_b32 v56, 6, v0
    v_lshlrev_b32 v55, 1, v0
    v_and_b32 v55, 0x78, v55
    v_or_b32 v55, v55, v56
    v_cmp_gt_u32 vcc, 125, v55
    v_mul_u32_u24 v46, 5120, v55
    v_add_u32 v46, 7340032, v46
    v_bfrev_b32 v56, 2
    v_lshlrev_b32 v44, 4, v0
    v_cndmask_b32 v44, v56, v44, vcc
    v_and_b32 v51, 63, v0
    buffer_load_dwordx4 v[20:23], v44, s[8:11], s22 offen sc1
    v_mov_b32 v48, 1
    v_lshlrev_b32 v47, 2, v51
    v_bfe_u32 v2, v0, 5, 1
    v_bfe_u32 v3, v0, 3, 2
    v_and_b32 v35, 3, v0
    v_lshl_add_u32 v3, v3, 2, v35
    v_mul_u32_u24 v49, 20, v2
    v_lshrrev_b32 v18, 2, v51
    v_lshl_add_u32 v18, v35, 4, v18
    v_mov_b32 v50, 0x3fff
    s_lshl_b32 s37, s16, 2
    v_mov_b32 v59, s37
    s_sub_u32 s36, s16, 1
    s_waitcnt vmcnt(0)
    v_mov_b32_dpp v58, v23 quad_perm:[3,3,3,3] row_mask:0xf bank_mask:0xf
mn_again:
    v_mov_b32 v55, 0
    ds_write_b32 v47, v55 offset:0
    ds_write_b32 v47, v55 offset:128
    s_waitcnt vmcnt(0) lgkmcnt(0)
    s_barrier
    v_add_u32 v55, 0, v35
    v_add_u32 v55, s24, v55
    v_lshrrev_b32 v56, 16, v58
    v_mov_b32 v20, 0
    v_cmpx_lt_u32 vcc, v55, v56
    s_cbranch_execz mn_g2
    v_cmp_gt_u32 vcc, 15, v55
    v_and_b32 v56, 0xffff, v58
    v_add_lshl_u32 v56, v55, v56, 2
    v_add_u32 v56, v56, v46
    v_lshl_add_u32 v57, v0, 4, s22
    v_and_or_b32 v57, v55, 12, v57
    v_cndmask_b32 v56, v56, v57, vcc
    buffer_load_dword v20, v56, s[8:11], 0 offen sc1
    s_waitcnt vmcnt(0)
mn_g2:
    s_mov_b64 exec, -1
    v_mov_b32 v21, 0
    v_mov_b32 v22, 0
    v_mov_b32 v23, 0
    v_mov_b32 v24, 0
    s_cmp_le_u32 s20, 4
    s_cbranch_scc1 mn_more
    v_add_u32 v55, 4, v35
    v_add_u32 v55, s24, v55
    v_lshrrev_b32 v56, 16, v58
    v_mov_b32 v21, 0
    v_cmpx_lt_u32 vcc, v55, v56
    s_cbranch_execz mn_g3
    v_cmp_gt_u32 vcc, 15, v55
    v_and_b32 v56, 0xffff, v58
    v_add_lshl_u32 v56, v55, v56, 2
    v_add_u32 v56, v56, v46
    v_lshl_add_u32 v57, v0, 4, s22
    v_and_or_b32 v57, v55, 12, v57
    v_cndmask_b32 v56, v56, v57, vcc
    buffer_load_dword v21, v56, s[8:11], 0 offen sc1
    s_waitcnt vmcnt(0)
mn_g3:
    s_mov_b64 exec, -1
    v_add_u32 v55, 8, v35
    v_add_u32 v55, s24, v55
    v_lshrrev_b32 v56, 16, v58
    v_mov_b32 v22, 0
    v_cmpx_lt_u32 vcc, v55, v56
    s_cbranch_execz mn_g4
    v_cmp_gt_u32 vcc, 15, v55
    v_and_b32 v56, 0xffff, v58
    v_add_lshl_u32 v56, v55, v56, 2
    v_add_u32 v56, v56, v46
    v_lshl_add_u32 v57, v0, 4, s22
    v_and_or_b32 v57, v55, 12, v57
    v_cndmask_b32 v56, v56, v57, vcc
    buffer_load_dword v22, v56, s[8:11], 0 offen sc1
    s_waitcnt vmcnt(0)
mn_g4:
    s_mov_b64 exec, -1
    v_add_u32 v55, 12, v35
    v_add_u32 v55, s24, v55
    v_lshrrev_b32 v56, 16, v58
    v_mov_b32 v23, 0
    v_cmpx_lt_u32 vcc, v55, v56
    s_cbranch_execz mn_g5
    v_cmp_gt_u32 vcc, 15, v55
    v_and_b32 v56, 0xffff, v58
    v_add_lshl_u32 v56, v55, v56, 2
    v_add_u32 v56, v56, v46
    v_lshl_add_u32 v57, v0, 4, s22
    v_and_or_b32 v57, v55, 12, v57
    v_cndmask_b32 v56, v56, v57, vcc
    buffer_load_dword v23, v56, s[8:11], 0 offen sc1
    s_waitcnt vmcnt(0)
mn_g5:
    s_mov_b64 exec, -1
    v_add_u32 v55, 16, v35
    v_add_u32 v55, s24, v55
    v_lshrrev_b32 v56, 16, v58
    v_mov_b32 v24, 0
    v_cmpx_lt_u32 vcc, v55, v56
    s_cbranch_execz mn_g6
    v_cmp_gt_u32 vcc, 15, v55
    v_and_b32 v56, 0xffff, v58
    v_add_lshl_u32 v56, v55, v56, 2
    v_add_u32 v56, v56, v46
    v_lshl_add_u32 v57, v0, 4, s22
    v_and_or_b32 v57, v55, 12, v57
    v_cndmask_b32 v56, v56, v57, vcc
    buffer_load_dword v24, v56, s[8:11], 0 offen sc1
    s_waitcnt vmcnt(0)
mn_g6:
    s_mov_b64 exec, -1
    s_branch mn_more
mn_last:
    s_endpgm
.section .rodata,"a"
.p2align 6
.amdhsa_kernel standalone__tensor_product_equiv_mace__graph_kernel
  .amdhsa_next_free_vgpr 168
  .amdhsa_next_free_sgpr 96
  .amdhsa_accum_offset 168
  .amdhsa_group_segment_fixed_size 0
  .amdhsa_kernarg_size 88
  .amdhsa_user_sgpr_count 2
  .amdhsa_user_sgpr_kernarg_segment_ptr 1
  .amdhsa_system_sgpr_workgroup_id_x 1
.end_amdhsa_kernel
```

```asm
; @launch grid=(256,1,1) block=(768,1,1) lds=163840
.amdgcn_target "amdgcn-amd-amdhsa--gfx950"
.text
.globl standalone__tensor_product_equiv_mace__graph_kernel
.p2align 8
.type standalone__tensor_product_equiv_mace__graph_kernel,@function
standalone__tensor_product_equiv_mace__graph_kernel:
    s_load_dwordx8 s[4:11], s[0:1], 8
    s_load_dwordx4 s[12:15], s[0:1], 72
    v_lshrrev_b32 v9, 6, v0
    s_and_b32 s3, s2, 127
    v_readfirstlane_b32 s18, v9
    v_and_b32 v1, 63, v0
    s_cmp_lt_u32 s2, 125
    s_cbranch_scc1 ka_bin
    s_cmp_ge_u32 s2, 256
    s_cbranch_scc1 ka_end
    s_getpc_b64 s[36:37]
ka_pc0:
    v_lshlrev_b32 v41, 7, v0
    s_mul_i32 s34, s3, 40960
    v_add_u32 v44, s34, v41
    v_min_u32 v41, mn_last-ka_pc0, v41
    global_load_dword v41, v41, s[36:37]
    s_cmp_ge_u32 s3, 125
    s_cbranch_scc1 ka_idle
    s_cmp_ge_u32 s18, 5
    s_cbranch_scc1 ka_pf
    s_waitcnt vmcnt(0) lgkmcnt(0)
    global_load_dword v45, v44, s[10:11]
    s_branch ka_pf
ka_bin:
    s_cmp_ge_u32 s18, 10
    s_cbranch_scc1 ka_dma
    s_mul_i32 s3, s2, 5120
    v_lshl_add_u32 v5, v0, 2, s3
    s_waitcnt lgkmcnt(0)
    global_load_dword v10, v5, s[6:7]
    global_load_dword v60, v5, s[6:7] offset:2560
    global_load_dword v11, v5, s[4:5]
    global_load_dword v61, v5, s[4:5] offset:2560
    v_lshlrev_b32 v2, 2, v0
    v_and_b32 v2, 0x3fc, v2
    v_lshlrev_b32 v5, 4, v0
    v_mov_b32 v44, 0
    v_mov_b32 v45, 0
    v_mov_b32 v46, 0
    v_mov_b32 v47, 0
    ds_write_b32 v2, v44 offset:1024
    ds_write_b128 v5, v[44:47] offset:12288
    ds_write_b128 v5, v[44:47] offset:18432
    s_and_b32 s21, s15, 0xffff
    s_mov_b32 s22, 12582912
    s_mov_b32 s23, 0x20000
    s_mov_b32 s20, s14
    v_mov_b32 v3, 1
    v_lshlrev_b32 v26, 4, v1
    s_lshl_b32 s19, s18, 10
    v_add_u32 v27, s19, v26
    v_mov_b32 v4, 0x40000
    s_movk_i32 s29, 625
    s_movk_i32 s38, 0x3fff
    s_waitcnt lgkmcnt(0)
    s_barrier
    v_mov_b32 v19, 74752
    v_lshl_add_u32 v18, v0, 1, 0
    v_mul_u32_u24 v16, 13108, v18
    v_lshrrev_b32 v16, 16, v16
    v_mad_i32_i24 v18, v16, -5, v18
    v_lshlrev_b32 v16, 2, v16
    v_cmp_eq_u32 vcc, 4, v18
    v_lshlrev_b32 v18, 3, v18
    v_add_u32 v18, 33792, v18
    v_cndmask_b32 v17, 5, 3, vcc
    v_cndmask_b32 v18, v18, v19, vcc
    v_lshl_add_u32 v14, v0, 1, 1
    v_mul_u32_u24 v12, 13108, v14
    v_lshrrev_b32 v12, 16, v12
    v_mad_i32_i24 v14, v12, -5, v14
    v_lshlrev_b32 v12, 2, v12
    v_cmp_eq_u32 vcc, 4, v14
    v_lshlrev_b32 v14, 3, v14
    v_add_u32 v14, 33792, v14
    v_cndmask_b32 v13, 5, 3, vcc
    v_cndmask_b32 v14, v14, v19, vcc
    s_mul_i32 s31, s2, 51200
    s_waitcnt vmcnt(3)
    v_mul_u32_u24 v32, 214749, v10
    v_lshrrev_b32 v32, 23, v32
    v_min_u32 v32, 255, v32
    v_and_b32 v35, 7, v32
    v_lshrrev_b32 v33, 3, v32
    v_lshl_add_u32 v35, v35, 5, v33
    v_lshlrev_b32 v35, 2, v35
    ds_add_rtn_u32 v36, v35, v3 offset:1024
    s_waitcnt vmcnt(2)
    v_mul_u32_u24 v62, 214749, v60
    v_lshrrev_b32 v62, 23, v62
    v_min_u32 v62, 255, v62
    v_and_b32 v66, 7, v62
    v_lshrrev_b32 v63, 3, v62
    v_lshl_add_u32 v66, v66, 5, v63
    v_lshlrev_b32 v66, 2, v66
    ds_add_rtn_u32 v67, v66, v3 offset:1024
    v_mad_u32_u24 v33, v32, s29, 15
    v_lshrrev_b32 v33, 4, v33
    v_sub_u32 v33, v10, v33
    v_subrev_u32 v32, 20, v33
    v_min_u32 v32, v32, v33
    v_min_u32 v32, 19, v32
    v_lshlrev_b32 v40, 4, v35
    v_add_u32 v35, s19, v35
    v_mad_u32_u24 v63, v62, s29, 15
    v_lshrrev_b32 v63, 4, v63
    v_sub_u32 v63, v60, v63
    v_subrev_u32 v62, 20, v63
    v_min_u32 v62, v62, v63
    v_min_u32 v62, 19, v62
    v_lshlrev_b32 v70, 4, v66
    v_add_u32 v66, s19, v66
    s_waitcnt vmcnt(0) lgkmcnt(0)
    v_mul_u32_u24 v39, 3330, v11
    v_lshrrev_b32 v39, 20, v39
    v_lshrrev_b32 v34, 2, v32
    v_cmp_gt_u32 vcc, 27, v39
    v_add_u32 v34, 27, v34
    v_lshlrev_b32 v23, 14, v32
    v_cndmask_b32 v39, v34, v39, vcc
    v_cmp_le_u32 vcc, 20, v33
    v_and_or_b32 v22, v11, s38, v23
    v_or_b32 v39, 64, v39
    v_add_u32 v34, 32, v39
    v_cndmask_b32 v39, v39, v34, vcc
    v_lshl_or_b32 v22, v39, 25, v22
    v_cmp_lt_u32 vcc, 14, v36
    v_and_b32 v34, 3, v36
    v_lshl_add_u32 v40, v34, 4, v40
    v_and_or_b32 v40, v36, 12, v40
    v_cndmask_b32 v40, v40, v4, vcc
    ds_write_b32 v40, v22 offset:12288
    v_mul_u32_u24 v68, 3330, v61
    v_lshrrev_b32 v68, 20, v68
    v_lshrrev_b32 v71, 2, v62
    v_cmp_gt_u32 vcc, 27, v68
    v_add_u32 v71, 27, v71
    v_lshlrev_b32 v75, 14, v62
    v_cndmask_b32 v68, v71, v68, vcc
    v_cmp_le_u32 vcc, 20, v63
    v_and_or_b32 v74, v61, s38, v75
    v_or_b32 v68, 64, v68
    v_add_u32 v71, 32, v68
    v_cndmask_b32 v68, v68, v71, vcc
    v_lshl_or_b32 v74, v68, 25, v74
    v_cmp_lt_u32 vcc, 14, v67
    v_and_b32 v71, 3, v67
    v_lshl_add_u32 v70, v71, 4, v70
    v_and_or_b32 v70, v67, 12, v70
    v_cndmask_b32 v70, v70, v4, vcc
    ds_write_b32 v70, v74 offset:12288
    s_waitcnt lgkmcnt(0)
    s_barrier
    ds_read_b128 v[44:47], v26 offset:1024
    v_add_u32 v9, 640, v0
    v_max_u32 v8, v36, v67
    v_cmp_lt_u32 vcc, 14, v8
    s_waitcnt lgkmcnt(0)
    v_add_u32 v53, v44, v45
    v_add_u32 v54, v53, v46
    v_add_u32 v38, v54, v47
    v_mov_b32 v55, v38
    s_nop 0
    v_add_u32_dpp v38, v38, v38 row_shr:1 row_mask:0xf bank_mask:0xf
    s_nop 0
    s_nop 0
    v_add_u32_dpp v38, v38, v38 row_shr:2 row_mask:0xf bank_mask:0xf
    s_nop 0
    s_nop 0
    v_add_u32_dpp v38, v38, v38 row_shr:4 row_mask:0xf bank_mask:0xf
    s_nop 0
    s_nop 0
    v_add_u32_dpp v38, v38, v38 row_shr:8 row_mask:0xf bank_mask:0xf
    s_nop 0
    s_nop 0
    v_add_u32_dpp v38, v38, v38 row_bcast:15 row_mask:0xa bank_mask:0xf
    s_nop 0
    s_nop 0
    v_add_u32_dpp v38, v38, v38 row_bcast:31 row_mask:0xc bank_mask:0xf
    v_sub_u32 v56, v38, v55
    v_add_u32 v57, v56, v44
    v_add_u32 v58, v56, v53
    v_add_u32 v59, v56, v54
    ds_write_b128 v27, v[56:59] offset:2048
    ds_read_b32 v43, v35 offset:2048
    ds_read_b32 v69, v66 offset:2048
    s_waitcnt lgkmcnt(0)
    v_add_lshl_u32 v43, v43, v36, 2
    v_add_lshl_u32 v69, v69, v67, 2
    ds_write_b32 v43, v0 offset:28672
    ds_write_b32 v69, v9 offset:28672
    s_cbranch_vccnz ka_ov
ka_ov_back:
    s_waitcnt lgkmcnt(0)
ka_copy:
    s_barrier
    ds_read_b32 v20, v16 offset:28672
    ds_read_b32 v21, v12 offset:28672
    ds_read_b32 v22, v16 offset:29696
    ds_read_b32 v23, v12 offset:29696
    ds_read_b32 v24, v16 offset:30720
    ds_read_b32 v25, v12 offset:30720
    ds_read_b32 v26, v16 offset:31744
    ds_read_b32 v27, v12 offset:31744
    ds_read_b32 v28, v16 offset:32768
    ds_read_b32 v29, v12 offset:32768
    s_waitcnt lgkmcnt(8)
    v_lshl_add_u32 v20, v20, v17, v18
    v_lshl_add_u32 v21, v21, v13, v14
    ds_read_b64 v[44:45], v20
    ds_read_b64 v[46:47], v21
    s_waitcnt lgkmcnt(8)
    v_lshl_add_u32 v22, v22, v17, v18
    v_lshl_add_u32 v23, v23, v13, v14
    ds_read_b64 v[48:49], v22
    ds_read_b64 v[50:51], v23
    s_waitcnt lgkmcnt(8)
    v_lshl_add_u32 v24, v24, v17, v18
    v_lshl_add_u32 v25, v25, v13, v14
    ds_read_b64 v[52:53], v24
    ds_read_b64 v[54:55], v25
    s_waitcnt lgkmcnt(8)
    v_lshl_add_u32 v26, v26, v17, v18
    v_lshl_add_u32 v27, v27, v13, v14
    ds_read_b64 v[56:57], v26
    ds_read_b64 v[58:59], v27
    s_waitcnt lgkmcnt(8)
    v_lshl_add_u32 v28, v28, v17, v18
    v_lshl_add_u32 v29, v29, v13, v14
    ds_read_b64 v[60:61], v28
    ds_read_b64 v[62:63], v29
    s_waitcnt lgkmcnt(8)
    buffer_store_dwordx4 v[44:47], v5, s[20:23], s31 offen sc1
    s_addk_i32 s31, 10240
    s_waitcnt lgkmcnt(6)
    buffer_store_dwordx4 v[48:51], v5, s[20:23], s31 offen sc1
    s_addk_i32 s31, 10240
    s_waitcnt lgkmcnt(4)
    buffer_store_dwordx4 v[52:55], v5, s[20:23], s31 offen sc1
    s_addk_i32 s31, 10240
    s_waitcnt lgkmcnt(2)
    buffer_store_dwordx4 v[56:59], v5, s[20:23], s31 offen sc1
    s_addk_i32 s31, 10240
    s_waitcnt lgkmcnt(0)
    buffer_store_dwordx4 v[60:63], v5, s[20:23], s31 offen sc1
    s_branch mn_start2
ka_ov:
    s_mul_i32 s33, s2, 5120
    s_add_u32 s33, s33, 7340032
    buffer_store_dword v22, v43, s[20:23], s33 offen sc1
    buffer_store_dword v74, v69, s[20:23], s33 offen sc1
    s_branch ka_ov_back
ka_dma:
    s_cmp_eq_u32 s18, 11
    s_cbranch_scc1 ka_cell
    s_mul_i32 s35, s2, 40960
    v_lshl_add_u32 v7, v1, 4, s35
    s_mul_i32 s35, s2, 10240
    v_lshl_add_u32 v8, v1, 4, s35
    s_mov_b32 m0, 74752
    s_waitcnt lgkmcnt(0)
    s_load_dwordx4 s[36:39], s[0:1], 40
    s_barrier
    global_load_lds_dwordx4 v8, s[8:9] offset:0
    global_load_lds_dwordx4 v8, s[8:9] offset:1024
    s_add_u32 m0, m0, 2048
    v_add_u32 v8, 2048, v8
    global_load_lds_dwordx4 v8, s[8:9] offset:0
    global_load_lds_dwordx4 v8, s[8:9] offset:1024
    s_add_u32 m0, m0, 2048
    v_add_u32 v8, 2048, v8
    global_load_lds_dwordx4 v8, s[8:9] offset:0
    global_load_lds_dwordx4 v8, s[8:9] offset:1024
    s_add_u32 m0, m0, 2048
    v_add_u32 v8, 2048, v8
    global_load_lds_dwordx4 v8, s[8:9] offset:0
    global_load_lds_dwordx4 v8, s[8:9] offset:1024
    s_add_u32 m0, m0, 2048
    v_add_u32 v8, 2048, v8
    global_load_lds_dwordx4 v8, s[8:9] offset:0
    global_load_lds_dwordx4 v8, s[8:9] offset:1024
    s_add_u32 m0, m0, 2048
    v_add_u32 v8, 2048, v8
    s_mov_b32 m0, 33792
    s_nop 0
    global_load_lds_dwordx4 v7, s[10:11] offset:0
    global_load_lds_dwordx4 v7, s[10:11] offset:1024
    s_add_u32 m0, m0, 2048
    v_add_u32 v7, 2048, v7
    global_load_lds_dwordx4 v7, s[10:11] offset:0
    global_load_lds_dwordx4 v7, s[10:11] offset:1024
    s_add_u32 m0, m0, 2048
    v_add_u32 v7, 2048, v7
    global_load_lds_dwordx4 v7, s[10:11] offset:0
    global_load_lds_dwordx4 v7, s[10:11] offset:1024
    s_add_u32 m0, m0, 2048
    v_add_u32 v7, 2048, v7
    s_barrier
    global_load_lds_dwordx4 v7, s[10:11] offset:0
    global_load_lds_dwordx4 v7, s[10:11] offset:1024
    s_add_u32 m0, m0, 2048
    v_add_u32 v7, 2048, v7
    global_load_lds_dwordx4 v7, s[10:11] offset:0
    global_load_lds_dwordx4 v7, s[10:11] offset:1024
    s_add_u32 m0, m0, 2048
    v_add_u32 v7, 2048, v7
    global_load_lds_dwordx4 v7, s[10:11] offset:0
    global_load_lds_dwordx4 v7, s[10:11] offset:1024
    s_add_u32 m0, m0, 2048
    v_add_u32 v7, 2048, v7
    global_load_lds_dwordx4 v7, s[10:11] offset:0
    global_load_lds_dwordx4 v7, s[10:11] offset:1024
    s_add_u32 m0, m0, 2048
    v_add_u32 v7, 2048, v7
    global_load_lds_dwordx4 v7, s[10:11] offset:0
    global_load_lds_dwordx4 v7, s[10:11] offset:1024
    s_add_u32 m0, m0, 2048
    v_add_u32 v7, 2048, v7
    global_load_lds_dwordx4 v7, s[10:11] offset:0
    global_load_lds_dwordx4 v7, s[10:11] offset:1024
    s_add_u32 m0, m0, 2048
    v_add_u32 v7, 2048, v7
    global_load_lds_dwordx4 v7, s[10:11] offset:0
    global_load_lds_dwordx4 v7, s[10:11] offset:1024
    s_add_u32 m0, m0, 2048
    v_add_u32 v7, 2048, v7
    global_load_lds_dwordx4 v7, s[10:11] offset:0
    global_load_lds_dwordx4 v7, s[10:11] offset:1024
    s_add_u32 m0, m0, 2048
    v_add_u32 v7, 2048, v7
    global_load_lds_dwordx4 v7, s[10:11] offset:0
    global_load_lds_dwordx4 v7, s[10:11] offset:1024
    s_add_u32 m0, m0, 2048
    v_add_u32 v7, 2048, v7
    global_load_lds_dwordx4 v7, s[10:11] offset:0
    global_load_lds_dwordx4 v7, s[10:11] offset:1024
    s_add_u32 m0, m0, 2048
    v_add_u32 v7, 2048, v7
    global_load_lds_dwordx4 v7, s[10:11] offset:0
    global_load_lds_dwordx4 v7, s[10:11] offset:1024
    s_add_u32 m0, m0, 2048
    v_add_u32 v7, 2048, v7
    global_load_lds_dwordx4 v7, s[10:11] offset:0
    global_load_lds_dwordx4 v7, s[10:11] offset:1024
    s_add_u32 m0, m0, 2048
    v_add_u32 v7, 2048, v7
    global_load_lds_dwordx4 v7, s[10:11] offset:0
    global_load_lds_dwordx4 v7, s[10:11] offset:1024
    s_add_u32 m0, m0, 2048
    v_add_u32 v7, 2048, v7
    global_load_lds_dwordx4 v7, s[10:11] offset:0
    global_load_lds_dwordx4 v7, s[10:11] offset:1024
    s_add_u32 m0, m0, 2048
    v_add_u32 v7, 2048, v7
    global_load_lds_dwordx4 v7, s[10:11] offset:0
    global_load_lds_dwordx4 v7, s[10:11] offset:1024
    s_add_u32 m0, m0, 2048
    v_add_u32 v7, 2048, v7
    global_load_lds_dwordx4 v7, s[10:11] offset:0
    global_load_lds_dwordx4 v7, s[10:11] offset:1024
    s_add_u32 m0, m0, 2048
    v_add_u32 v7, 2048, v7
    global_load_lds_dwordx4 v7, s[10:11] offset:0
    global_load_lds_dwordx4 v7, s[10:11] offset:1024
    s_add_u32 m0, m0, 2048
    v_add_u32 v7, 2048, v7
    s_mov_b32 s35, m0
    s_mov_b32 m0, 148480
    v_lshlrev_b32 v9, 4, v1
    v_add_u32 v10, 4096, v9
    s_waitcnt lgkmcnt(0)
    global_load_lds_dwordx4 v9, s[38:39]
    global_load_lds_dwordx4 v9, s[38:39] offset:1024
    global_load_lds_dwordx4 v9, s[38:39] offset:2048
    global_load_lds_dwordx4 v9, s[38:39] offset:3072
    s_mov_b32 m0, 152576
    s_nop 0
    global_load_lds_dwordx4 v10, s[38:39]
    global_load_lds_dwordx4 v10, s[38:39] offset:1024
    global_load_lds_dwordx4 v10, s[38:39] offset:2048
    global_load_lds_dwordx4 v10, s[38:39] offset:3072
    s_mov_b32 m0, 156672
    s_mov_b64 exec, 0xff
    global_load_lds_dwordx4 v9, s[36:37]
    s_mov_b64 exec, -1
    s_mov_b32 m0, s35
    s_waitcnt vmcnt(0)
    s_barrier
    s_branch mn_start
ka_cell:
    s_and_b32 s28, s2, 7
    s_lshl_b32 s28, s28, 4
    s_lshr_b32 s29, s2, 3
    s_add_u32 s28, s28, s29
    s_waitcnt lgkmcnt(0)
    s_and_b32 s21, s15, 0xffff
    s_mov_b32 s22, 12582912
    s_mov_b32 s23, 0x20000
    s_mov_b32 s20, s14
    s_lshl_b32 s30, s28, 6
    s_add_u32 s30, s30, 8388608
    v_lshlrev_b32 v3, 3, v1
    v_mov_b32 v4, 0
    v_mov_b32 v5, 0
    ds_write_b64 v3, v[4:5]
    v_lshlrev_b32 v26, 4, v1
    v_lshrrev_b32 v6, 2, v1
    v_lshlrev_b32 v6, 13, v6
    v_and_or_b32 v6, v26, 0x30, v6
    v_lshlrev_b32 v27, 8, v1
    s_waitcnt lgkmcnt(0)
    s_barrier
    s_and_b32 s58, s2, 15
    s_lshl_b32 s58, s58, 7
    s_add_u32 s58, s58, 11730944
    v_mov_b32 v86, s58
    global_load_dword v87, v86, s[14:15] sc1
    s_barrier
    ds_read_b128 v[12:15], v26 offset:1024
    s_waitcnt lgkmcnt(0)
    v_add_u32 v17, v12, v13
    v_add_u32 v18, v17, v14
    v_add_u32 v16, v18, v15
    v_mov_b32 v19, v16
    v_lshlrev_b32 v20, 16, v12
    v_add_u32_dpp v16, v16, v16 row_shr:1 row_mask:0xf bank_mask:0xf
    v_lshl_add_u32 v21, v13, 16, v12
    s_nop 0
    v_add_u32_dpp v16, v16, v16 row_shr:2 row_mask:0xf bank_mask:0xf
    v_lshl_add_u32 v22, v14, 16, v17
    s_nop 0
    v_add_u32_dpp v16, v16, v16 row_shr:4 row_mask:0xf bank_mask:0xf
    v_lshl_add_u32 v23, v15, 16, v18
    s_nop 0
    v_add_u32_dpp v16, v16, v16 row_shr:8 row_mask:0xf bank_mask:0xf
    s_nop 1
    v_add_u32_dpp v16, v16, v16 row_bcast:15 row_mask:0xa bank_mask:0xf
    s_nop 1
    v_add_u32_dpp v16, v16, v16 row_bcast:31 row_mask:0xc bank_mask:0xf
    v_sub_u32 v16, v16, v19
    v_mov_b32 v86, 0
    s_waitcnt vmcnt(0)
    ds_write_b32 v86, v87 offset:456
    v_add_u32 v20, v20, v16
    ds_write_b32 v27, v20 offset:12348
    v_add_u32 v21, v21, v16
    ds_write_b32 v27, v21 offset:12412
    v_add_u32 v22, v22, v16
    ds_write_b32 v27, v22 offset:12476
    v_add_u32 v23, v23, v16
    ds_write_b32 v27, v23 offset:12540
    ds_read_b128 v[28:31], v26 offset:12288
    ds_read_b128 v[32:35], v26 offset:13312
    ds_read_b128 v[36:39], v26 offset:14336
    ds_read_b128 v[40:43], v26 offset:15360
    ds_read_b128 v[44:47], v26 offset:16384
    ds_read_b128 v[48:51], v26 offset:17408
    ds_read_b128 v[52:55], v26 offset:18432
    ds_read_b128 v[56:59], v26 offset:19456
    s_waitcnt lgkmcnt(7)
    buffer_store_dwordx4 v[28:31], v6, s[20:23], s30 offen sc1
    ds_read_b128 v[60:63], v26 offset:20480
    s_add_u32 s30, s30, 131072
    s_waitcnt lgkmcnt(7)
    buffer_store_dwordx4 v[32:35], v6, s[20:23], s30 offen sc1
    ds_read_b128 v[64:67], v26 offset:21504
    s_add_u32 s30, s30, 131072
    s_waitcnt lgkmcnt(7)
    buffer_store_dwordx4 v[36:39], v6, s[20:23], s30 offen sc1
    ds_read_b128 v[68:71], v26 offset:22528
    s_add_u32 s30, s30, 131072
    s_waitcnt lgkmcnt(7)
    buffer_store_dwordx4 v[40:43], v6, s[20:23], s30 offen sc1
    ds_read_b128 v[72:75], v26 offset:23552
    s_add_u32 s30, s30, 131072
    s_waitcnt lgkmcnt(7)
    buffer_store_dwordx4 v[44:47], v6, s[20:23], s30 offen sc1
    ds_read_b128 v[76:79], v26 offset:24576
    s_add_u32 s30, s30, 131072
    s_waitcnt lgkmcnt(7)
    buffer_store_dwordx4 v[48:51], v6, s[20:23], s30 offen sc1
    ds_read_b128 v[80:83], v26 offset:25600
    s_add_u32 s30, s30, 131072
    s_waitcnt lgkmcnt(7)
    buffer_store_dwordx4 v[52:55], v6, s[20:23], s30 offen sc1
    ds_read_b128 v[28:31], v26 offset:26624
    s_add_u32 s30, s30, 131072
    s_waitcnt lgkmcnt(7)
    buffer_store_dwordx4 v[56:59], v6, s[20:23], s30 offen sc1
    ds_read_b128 v[32:35], v26 offset:27648
    s_add_u32 s30, s30, 131072
    s_waitcnt lgkmcnt(7)
    buffer_store_dwordx4 v[60:63], v6, s[20:23], s30 offen sc1
    s_add_u32 s30, s30, 131072
    s_waitcnt lgkmcnt(6)
    buffer_store_dwordx4 v[64:67], v6, s[20:23], s30 offen sc1
    s_add_u32 s30, s30, 131072
    s_waitcnt lgkmcnt(5)
    buffer_store_dwordx4 v[68:71], v6, s[20:23], s30 offen sc1
    s_add_u32 s30, s30, 131072
    s_waitcnt lgkmcnt(4)
    buffer_store_dwordx4 v[72:75], v6, s[20:23], s30 offen sc1
    s_add_u32 s30, s30, 131072
    s_waitcnt lgkmcnt(3)
    buffer_store_dwordx4 v[76:79], v6, s[20:23], s30 offen sc1
    s_add_u32 s30, s30, 131072
    s_waitcnt lgkmcnt(2)
    buffer_store_dwordx4 v[80:83], v6, s[20:23], s30 offen sc1
    s_add_u32 s30, s30, 131072
    s_waitcnt lgkmcnt(1)
    buffer_store_dwordx4 v[28:31], v6, s[20:23], s30 offen sc1
    s_add_u32 s30, s30, 131072
    s_waitcnt lgkmcnt(0)
    buffer_store_dwordx4 v[32:35], v6, s[20:23], s30 offen sc1
    s_barrier
    s_waitcnt vmcnt(0)
    s_mov_b64 exec, 1
    v_mov_b32 v2, 0
    v_mov_b32 v3, 1
    s_and_b32 s34, s2, 1
    s_lshl_b32 s35, s34, 7
    s_add_u32 s35, s35, 0
    s_mov_b32 s33, 1
    s_atomic_add s33, s[12:13], s35 glc
    s_mov_b32 s36, 1
    s_lshl_b32 s34, s34, 3
    s_lshr_b32 s34, 15678, s34
    s_and_b32 s34, s34, 0xff
    s_waitcnt lgkmcnt(0)
    s_cmp_eq_u32 s33, s34
    s_cbranch_scc1 ka_bcast
ka_arc:
    s_mov_b64 exec, -1
    s_branch mn_start
ka_pf:
    s_load_dwordx2 s[16:17], s[0:1], 0
    s_load_dwordx2 s[32:33], s[0:1], 56
    s_waitcnt lgkmcnt(0)
    s_and_b32 s34, s2, 7
    s_mul_i32 s34, s34, 917504
    s_add_u32 s24, s16, s34
    s_addc_u32 s25, s17, 0
    s_and_b32 s25, s25, 0xffff
    s_mov_b32 s26, 917504
    s_mov_b32 s27, 0x20000
    s_bfe_u32 s30, s2, 0x40003
    v_lshlrev_b32 v40, 7, v0
    s_mul_i32 s30, s30, 57344
    s_cmp_lg_u32 s18, 9
    s_cbranch_scc1 ka_nowt
    s_bfe_u32 s35, s2, 0x40003
    s_lshl_b32 s35, s35, 13
    v_lshl_add_u32 v46, v1, 7, s35
    global_load_dword v46, v46, s[32:33]
ka_nowt:
ka_pf1:
    s_cmp_ge_u32 s18, 7
    s_cbranch_scc1 ka_pfe
    s_waitcnt vmcnt(0)
    buffer_load_dword v42, v40, s[24:27], s30 offen
    s_cmp_ge_u32 s18, 0
    s_cbranch_scc1 ka_pfe
    s_add_u32 s30, s30, 81920
    buffer_load_dword v43, v40, s[24:27], s30 offen
    s_branch ka_pfe
ka_idle:
    s_waitcnt lgkmcnt(0)
ka_pfe:
    s_cmp_lt_u32 s18, 10
    s_cbranch_scc1 ka_pfb
    s_cmp_eq_u32 s18, 11
    s_cbranch_scc1 ka_pfz
    s_load_dwordx4 s[36:39], s[0:1], 40
    s_mov_b32 m0, 148480
    v_lshlrev_b32 v9, 4, v1
    v_add_u32 v10, 4096, v9
    s_waitcnt lgkmcnt(0)
    global_load_lds_dwordx4 v9, s[38:39]
    global_load_lds_dwordx4 v9, s[38:39] offset:1024
    global_load_lds_dwordx4 v9, s[38:39] offset:2048
    global_load_lds_dwordx4 v9, s[38:39] offset:3072
    s_mov_b32 m0, 152576
    s_nop 0
    global_load_lds_dwordx4 v10, s[38:39]
    global_load_lds_dwordx4 v10, s[38:39] offset:1024
    global_load_lds_dwordx4 v10, s[38:39] offset:2048
    global_load_lds_dwordx4 v10, s[38:39] offset:3072
    s_mov_b32 m0, 156672
    s_mov_b64 exec, 0xff
    global_load_lds_dwordx4 v9, s[36:37]
    s_mov_b64 exec, -1
    s_waitcnt vmcnt(0)
    s_branch ka_pfb
ka_pfz:
    s_and_b32 s58, s2, 15
    s_lshl_b32 s58, s58, 7
    s_add_u32 s58, s58, 11730944
    v_mov_b32 v86, s58
    global_load_dword v87, v86, s[14:15] sc1
    v_lshlrev_b32 v3, 3, v1
    v_mov_b32 v4, 0
    v_mov_b32 v5, 0
    ds_write_b64 v3, v[4:5]
    v_mov_b32 v86, 0
    s_waitcnt vmcnt(0)
    ds_write_b32 v86, v87 offset:456
    s_waitcnt lgkmcnt(0)
ka_pfb:
    s_barrier
    s_branch mn_start
ka_bcast:
    s_mov_b64 exec, -1
    s_add_u32 s34, s14, 11730944
    s_addc_u32 s35, s15, 0
    s_atomic_add s36, s[34:35], 0
    s_atomic_add s36, s[34:35], 128
    s_atomic_add s36, s[34:35], 256
    s_atomic_add s36, s[34:35], 384
    s_atomic_add s36, s[34:35], 512
    s_atomic_add s36, s[34:35], 640
    s_atomic_add s36, s[34:35], 768
    s_atomic_add s36, s[34:35], 896
    s_atomic_add s36, s[34:35], 1024
    s_atomic_add s36, s[34:35], 1152
    s_atomic_add s36, s[34:35], 1280
    s_atomic_add s36, s[34:35], 1408
    s_atomic_add s36, s[34:35], 1536
    s_atomic_add s36, s[34:35], 1664
    s_atomic_add s36, s[34:35], 1792
    s_atomic_add s36, s[34:35], 1920
    s_branch mn_start
ka_end:
    s_endpgm
mn_start:
    s_waitcnt vmcnt(0) lgkmcnt(0)
mn_start2:
    s_cmp_ge_u32 s2, 256
    s_cbranch_scc1 mn_end
    s_load_dwordx2 s[54:55], s[0:1], 80
    s_load_dwordx2 s[50:51], s[0:1], 0
    s_load_dwordx2 s[60:61], s[0:1], 72
    v_lshrrev_b32 v56, 6, v0
    s_and_b32 s48, s2, 7
    v_readfirstlane_b32 s16, v56
    s_lshr_b32 s47, s2, 3
    s_lshl_b32 s22, s48, 5
    s_add_u32 s22, s22, s47
    s_lshl_b32 s22, s22, 13
    s_add_u32 s22, s22, 8388608
    s_mov_b32 s10, 12582912
    s_mov_b32 s11, 0x20000
    s_and_b32 s17, s16, 3
    s_movk_i32 s20, 20
    s_mov_b32 s24, 0
    s_cmp_ge_u32 s16, 8
    s_cbranch_scc1 gm_main
    v_lshrrev_b32 v56, 6, v0
    v_lshlrev_b32 v55, 1, v0
    v_and_b32 v55, 0x78, v55
    v_or_b32 v55, v55, v56
    v_cmp_gt_u32 vcc, 125, v55
    v_mul_u32_u24 v46, 5120, v55
    v_add_u32 v46, 7340032, v46
    v_bfrev_b32 v56, 2
    v_lshlrev_b32 v44, 4, v0
    v_cndmask_b32 v44, v56, v44, vcc
    v_and_b32 v51, 63, v0
    s_waitcnt lgkmcnt(0)
    s_mov_b32 s8, s54
    s_and_b32 s9, s55, 0xffff
    v_mov_b32 v24, 0
    s_lshr_b32 s18, s16, 2
    s_lshl_b32 s53, s17, 7
    s_add_u32 s4, s50, s53
    s_addc_u32 s5, s51, 0
    s_and_b32 s5, s5, 0xffff
    s_or_b32 s5, s5, 0x08000000
    s_movk_i32 s6, 10000
    s_mov_b32 s7, 0x20000
    s_sub_u32 s12, s4, 1024
    s_subb_u32 s13, s5, 0
    s_movk_i32 s14, 10000
    s_mov_b32 s15, 0x20000
    s_mul_i32 s40, s16, 15360
    s_add_u32 s40, s40, 40960
    v_lshl_add_u32 v87, v51, 3, s40
    s_add_u32 s40, s40, 9216
    s_add_u32 s41, s40, 1024
    s_add_u32 s42, s40, 2048
    s_add_u32 s43, s40, 3072
    s_add_u32 s44, s40, 4096
    s_add_u32 s45, s40, 5120
    v_and_b32 v55, 3, v0
    v_bfe_u32 v56, v0, 2, 2
    v_bfe_u32 v57, v0, 4, 1
    v_bfe_u32 v53, v0, 5, 1
    v_lshlrev_b32 v1, 3, v55
    v_lshl_add_u32 v1, v57, 5, v1
    v_lshl_add_u32 v1, v56, 6, v1
    v_lshl_add_u32 v1, v53, 8, v1
    v_add_u32 v1, s40, v1
    v_lshlrev_b32 v5, 4, v55
    v_lshl_add_u32 v5, v57, 6, v5
    v_lshl_add_u32 v5, v56, 9, v5
    v_mov_b32 v7, v5
    v_bfe_u32 v55, v0, 2, 1
    v_lshlrev_b32 v86, 4, v53
    v_lshl_or_b32 v86, v55, 18, v86
    v_mov_b32 v48, 1
    v_lshlrev_b32 v47, 2, v51
    v_bfe_u32 v2, v0, 5, 1
    v_bfe_u32 v3, v0, 3, 2
    v_and_b32 v35, 3, v0
    v_lshl_add_u32 v3, v3, 2, v35
    v_mul_u32_u24 v49, 20, v2
    v_lshrrev_b32 v18, 2, v51
    v_lshl_add_u32 v18, v35, 4, v18
    v_mov_b32 v50, 0x3fff
    s_lshl_b32 s37, s16, 2
    v_mov_b32 v59, s37
    s_sub_u32 s36, s16, 1
    v_mov_b64 v[88:89], 0
    v_mov_b64 v[90:91], 0
    v_mov_b64 v[92:93], 0
    v_mov_b64 v[94:95], 0
    v_mov_b64 v[96:97], 0
    v_mov_b64 v[98:99], 0
    v_mov_b64 v[100:101], 0
    v_mov_b64 v[102:103], 0
    v_mov_b64 v[104:105], 0
    v_mov_b64 v[106:107], 0
    v_mov_b64 v[108:109], 0
    v_mov_b64 v[110:111], 0
    v_mov_b64 v[112:113], 0
    v_mov_b64 v[114:115], 0
    v_mov_b64 v[116:117], 0
    v_mov_b64 v[118:119], 0
    v_mov_b64 v[120:121], 0
    v_mov_b64 v[122:123], 0
    v_mov_b64 v[124:125], 0
    v_mov_b64 v[126:127], 0
    v_mov_b64 v[128:129], 0
    v_mov_b64 v[130:131], 0
    v_mov_b64 v[132:133], 0
    v_mov_b64 v[134:135], 0
    v_mov_b64 v[136:137], 0
    v_mov_b64 v[138:139], 0
    v_mov_b64 v[140:141], 0
    v_mov_b64 v[142:143], 0
    v_mov_b64 v[144:145], 0
    v_mov_b64 v[146:147], 0
    v_mov_b64 v[148:149], 0
    v_mov_b64 v[150:151], 0
    v_mov_b64 v[152:153], 0
    v_mov_b64 v[154:155], 0
    v_mov_b64 v[156:157], 0
    v_mov_b64 v[158:159], 0
    v_mov_b64 v[160:161], 0
    v_mov_b64 v[162:163], 0
    v_mov_b64 v[164:165], 0
    v_mov_b64 v[166:167], 0
    v_bfe_u32 v8, v0, 2, 2
    v_bfe_u32 v10, v0, 5, 1
    v_lshlrev_b32 v9, 3, v8
    v_add_u32 v9, 156672, v9
    v_lshl_add_u32 v8, v10, 3, v8
    v_lshlrev_b32 v8, 9, v8
    v_bfe_u32 v10, v0, 4, 1
    v_lshl_add_u32 v8, v10, 5, v8
    v_lshl_add_u32 v8, v35, 3, v8
    v_lshl_add_u32 v8, s17, 7, v8
    v_add_u32 v8, 148480, v8
    ds_read_b64_tr_b16 v[76:77], v9
    ds_read_b64_tr_b16 v[78:79], v9 offset:32
    ds_read_b64_tr_b16 v[80:81], v9 offset:64
    ds_read_b64_tr_b16 v[82:83], v9 offset:96
    ds_read_b64_tr_b16 v[68:69], v8
    ds_read_b64_tr_b16 v[70:71], v8 offset:2048
    ds_read_b64_tr_b16 v[72:73], v8 offset:64
    ds_read_b64_tr_b16 v[74:75], v8 offset:2112
    s_cmp_ge_u32 s2, 125
    s_waitcnt vmcnt(0)
    s_cbranch_scc1 mn_noarr
    v_mov_b32 v55, 0
    v_mov_b32 v56, 1
    s_mov_b64 exec, 1
    ds_add_u32 v55, v56 offset:448
    s_mov_b64 exec, -1
mn_noarr:
    s_cmp_lg_u32 s16, 7
    s_cbranch_scc1 mn_sp1
    v_mov_b32 v57, 0
    ds_read_b32 v57, v57 offset:456
    s_waitcnt lgkmcnt(0)
    v_readfirstlane_b32 s59, v57
    s_and_b32 s62, s2, 15
    s_lshl_b32 s62, s62, 7
    s_add_u32 s62, s62, 11730944
    v_mov_b32 v55, s62
    v_lshlrev_b32 v56, 6, v0
    v_and_b32 v56, 0xc0, v56
    s_mov_b32 s63, 0x100000
mn_poll1m:
    s_sub_u32 s63, s63, 1
    s_cbranch_scc1 mn_poll1x
    global_load_dword v57, v55, s[54:55] sc1
    s_waitcnt vmcnt(0)
    v_readfirstlane_b32 s62, v57
    s_sub_u32 s62, s62, s59
    s_bfe_u32 s62, s62, 1048576
    s_cmp_eq_u32 s62, 2
    s_cbranch_scc1 mn_poll1x
    s_sleep 6
    s_and_b32 s62, s63, 63
    s_cbranch_scc1 mn_poll1m
    global_load_dword v57, v56, s[60:61] sc1
    s_waitcnt vmcnt(0)
    v_add_u32_dpp v57, v57, v57 quad_perm:[2,3,0,1] row_mask:0xf bank_mask:0xf
    s_nop 0
    v_readlane_b32 s62, v57, 0
    s_cmp_lt_u32 s62, 125
    s_cbranch_scc1 mn_poll1m
mn_poll1x:
    v_mov_b32 v55, 0
    ds_write_b32 v55, v48 offset:308
mn_sp1x:
    buffer_load_dwordx4 v[20:23], v44, s[8:11], s22 offen sc1
    s_mov_b32 s52, 0x100000
    s_waitcnt vmcnt(0)
    v_mov_b32_dpp v58, v23 quad_perm:[3,3,3,3] row_mask:0xf bank_mask:0xf
    v_cmp_le_u32 vcc, s52, v58
    s_cbranch_vccnz mn_w5
mn_count:
    v_cmpx_gt_i32 vcc, 0, v20
    s_cbranch_execz mn_cn_done
    v_lshrrev_b32 v25, 23, v20
    v_and_b32 v25, 0xfc, v25
    ds_add_rtn_u32 v30, v25, v48
    v_cmpx_gt_i32 vcc, 0, v21
    s_cbranch_execz mn_cn_done
    v_lshrrev_b32 v26, 23, v21
    v_and_b32 v26, 0xfc, v26
    ds_add_rtn_u32 v31, v26, v48
    v_cmpx_gt_i32 vcc, 0, v22
    s_cbranch_execz mn_cn_done
    v_lshrrev_b32 v27, 23, v22
    v_and_b32 v27, 0xfc, v27
    ds_add_rtn_u32 v32, v27, v48
    v_cmpx_gt_i32 vcc, 0, v23
    s_cbranch_execz mn_cn_done
    v_lshrrev_b32 v28, 23, v23
    v_and_b32 v28, 0xfc, v28
    ds_add_rtn_u32 v33, v28, v48
    v_cmpx_gt_i32 vcc, 0, v24
    s_cbranch_execz mn_cn_done
    v_lshrrev_b32 v29, 23, v24
    v_and_b32 v29, 0xfc, v29
    ds_add_rtn_u32 v34, v29, v48
mn_cn_done:
    s_mov_b64 exec, -1
    v_lshrrev_b32 v42, 16, v58
    v_subrev_u32 v42, s24, v42
    v_med3_i32 v42, v42, 0, s20
    v_mov_b32 v43, v42
    v_mov_b32 v52, 0
    s_lshl_b32 s52, s18, 5
    v_add_u32_dpp v43, v43, v43 row_shr:4 row_mask:0xf bank_mask:0xf
    s_add_u32 s53, s52, 31
    s_movk_i32 s48, 0x3fff
    v_add_u32_dpp v43, v43, v43 row_shr:8 row_mask:0xf bank_mask:0xf
    s_nop 0
    s_nop 0
    v_add_u32_dpp v43, v43, v43 row_bcast:15 row_mask:0xa bank_mask:0xf
    s_nop 0
    s_nop 0
    v_add_u32_dpp v43, v43, v43 row_bcast:31 row_mask:0xc bank_mask:0xf
    s_brev_b64 exec, 1
    ds_write_b32 v59, v43 offset:384
    s_mov_b64 exec, -1
    v_sub_u32 v41, v43, v42
    s_waitcnt lgkmcnt(0)
    s_barrier
    ds_read_b32 v55, v47 offset:384
    ds_read_b32 v53, v47 offset:0
    ds_read_b32 v52, v52 offset:272
    s_waitcnt lgkmcnt(2)
    v_add_u32_dpp v55, v55, v55 row_shr:1 row_mask:0xf bank_mask:0xf
    s_waitcnt lgkmcnt(1)
    v_mov_b32 v54, v53
    v_add_u32_dpp v55, v55, v55 row_shr:2 row_mask:0xf bank_mask:0xf
    v_sub_u32 v53, v49, v53
    v_add_u32 v41, v41, v35
    v_add_u32_dpp v55, v55, v55 row_shr:4 row_mask:0xf bank_mask:0xf
    s_cmp_eq_u32 s16, 0
    v_readlane_b32 s49, v55, s36
    v_readlane_b32 s23, v55, 7
    s_cmov_b32 s49, 0
    s_add_u32 s49, s49, 72
    v_add_u32_dpp v54, v54, v54 row_shr:1 row_mask:0xf bank_mask:0xf
    v_add_u32 v41, s49, v41
    v_lshlrev_b32 v41, 16, v41
    v_add_u32_dpp v54, v54, v54 row_shr:2 row_mask:0xf bank_mask:0xf
    v_and_or_b32 v36, v20, s48, v41
    v_add_u32 v41, 262144, v41
    v_add_u32_dpp v54, v54, v54 row_shr:4 row_mask:0xf bank_mask:0xf
    v_and_or_b32 v37, v21, s48, v41
    v_add_u32 v41, 262144, v41
    v_add_u32_dpp v54, v54, v54 row_shr:8 row_mask:0xf bank_mask:0xf
    v_and_or_b32 v38, v22, s48, v41
    v_add_u32 v41, 262144, v41
    v_add_u32_dpp v54, v54, v54 row_bcast:15 row_mask:0xa bank_mask:0xf
    v_and_or_b32 v39, v23, s48, v41
    v_add_u32 v41, 262144, v41
    v_add_u32_dpp v54, v54, v54 row_bcast:31 row_mask:0xc bank_mask:0xf
    v_add_u32 v53, v53, v54
    v_add_u32 v54, v54, v49
    ds_bpermute_b32 v25, v25, v53
    ds_bpermute_b32 v26, v26, v53
    ds_bpermute_b32 v27, v27, v53
    ds_bpermute_b32 v28, v28, v53
    ds_bpermute_b32 v29, v29, v53
    v_and_or_b32 v40, v24, s48, v41
    v_bfe_u32 v56, v20, 14, 5
    v_lshl_or_b32 v36, v56, 26, v36
    v_bfe_u32 v56, v21, 14, 5
    v_lshl_or_b32 v37, v56, 26, v37
    v_bfe_u32 v56, v22, 14, 5
    v_lshl_or_b32 v38, v56, 26, v38
    v_bfe_u32 v56, v23, 14, 5
    v_lshl_or_b32 v39, v56, 26, v39
    v_bfe_u32 v56, v24, 14, 5
    v_lshl_or_b32 v40, v56, 26, v40
    v_readlane_b32 s33, v54, s53
    v_readlane_b32 s32, v53, s52
    s_cmp_gt_u32 s23, 773
    s_cbranch_scc1 mn_ovf
    v_add_lshl_u32 v55, s33, v51, 2
    s_mov_b32 exec_lo, 1048575
    s_mov_b32 exec_hi, 0
    ds_write_b32 v55, v50 offset:512
    s_mov_b64 exec, -1
    v_add_lshl_u32 v2, s32, v2, 2
    v_add_lshl_u32 v3, s32, v3, 2
    v_add_lshl_u32 v18, s32, v18, 2
    s_waitcnt lgkmcnt(1)
    v_readfirstlane_b32 s21, v52
    v_cmpx_gt_i32 vcc, 0, v20
    s_cbranch_execz mn_w2_done
    v_add_lshl_u32 v25, v25, v30, 2
    ds_write_b32 v25, v36 offset:512
    v_cmpx_gt_i32 vcc, 0, v21
    s_cbranch_execz mn_w2_done
    v_add_lshl_u32 v26, v26, v31, 2
    ds_write_b32 v26, v37 offset:512
    v_cmpx_gt_i32 vcc, 0, v22
    s_cbranch_execz mn_w2_done
    v_add_lshl_u32 v27, v27, v32, 2
    ds_write_b32 v27, v38 offset:512
    v_cmpx_gt_i32 vcc, 0, v23
    s_cbranch_execz mn_w2_done
    v_add_lshl_u32 v28, v28, v33, 2
    ds_write_b32 v28, v39 offset:512
    v_cmpx_gt_i32 vcc, 0, v24
    s_cbranch_execz mn_w2_done
    v_add_lshl_u32 v29, v29, v34, 2
    ds_write_b32 v29, v40 offset:512
mn_w2_done:
    s_mov_b64 exec, -1
    s_mov_b32 m0, s40
    s_sub_u32 s32, s32, 3
    s_sub_u32 s57, s33, s32
    s_lshr_b32 s57, s57, 2
    s_waitcnt lgkmcnt(0)
    s_barrier
    ds_read_u16 v4, v2 offset:512
    ds_read_u16 v6, v2 offset:520
    ds_read_u16 v8, v18 offset:514
    ds_read_u16 v84, v3 offset:514
    ds_read_u16 v22, v2 offset:528
    ds_read_u16 v23, v2 offset:536
    ds_read_u16 v24, v2 offset:544
    ds_read_u16 v25, v2 offset:552
    ds_read_u16 v26, v2 offset:560
    ds_read_u16 v27, v2 offset:568
    s_sub_u32 s53, s53, 4
    v_readlane_b32 s84, v54, s53
    s_add_u32 s53, s53, 1
    v_readlane_b32 s85, v54, s53
    s_add_u32 s53, s53, 1
    v_readlane_b32 s86, v54, s53
    s_add_u32 s53, s53, 1
    v_readlane_b32 s87, v54, s53
    s_waitcnt lgkmcnt(8)
    buffer_load_dwordx4 v[4:5], s[4:7], 0 idxen offen lds
    s_mov_b32 m0, s41
    s_waitcnt lgkmcnt(6)
    buffer_load_dwordx4 v[6:7], s[4:7], 0 idxen offen lds
    v_lshrrev_b32 v11, 8, v8
    v_and_b32 v8, 0x3ff, v8
    v_mul_u32_u24 v8, 48, v8
    v_and_b32 v84, 0x3ff, v84
    v_mad_u32_u24 v84, v84, 48, v86
    v_xor_b32 v85, 0x40000, v84
    s_waitcnt lgkmcnt(0)
    s_mov_b32 m0, s42
    v_mov_b32 v4, v22
    buffer_load_dwordx4 v[4:5], s[4:7], 0 idxen offen lds
    s_mov_b32 m0, s43
    v_mov_b32 v4, v23
    buffer_load_dwordx4 v[4:5], s[4:7], 0 idxen offen lds
    s_mov_b32 m0, s44
    v_mov_b32 v4, v24
    buffer_load_dwordx4 v[4:5], s[4:7], 0 idxen offen lds
    s_mov_b32 m0, s45
    v_mov_b32 v4, v25
    buffer_load_dwordx4 v[4:5], s[4:7], 0 idxen offen lds
    s_sub_u32 s84, s84, s32
    s_lshr_b32 s84, s84, 2
    s_sub_u32 s85, s85, s32
    s_lshr_b32 s85, s85, 2
    s_sub_u32 s86, s86, s32
    s_lshr_b32 s86, s86, 2
    s_sub_u32 s87, s87, s32
    s_lshr_b32 s87, s87, 2
    s_sub_u32 s88, s57, s87
    s_sub_u32 s87, s87, s86
    s_sub_u32 s86, s86, s85
    s_sub_u32 s85, s85, s84
    s_cmp_lg_u32 s21, 0
    s_cselect_b32 s19, s57, s84
    s_mov_b32 s58, 0
    s_mov_b32 s35, 0
    s_sub_i32 s34, s57, 4
    s_max_i32 s34, s34, 0
    v_min_u32 v0, 1, v51
    v_lshlrev_b32 v0, 18, v0
    v_lshl_add_u32 v0, s17, 2, v0
    s_lshl_b32 s52, s18, 1
    s_sub_i32 s52, 1, s52
    s_mul_i32 s53, s52, s57
    s_add_i32 s53, s53, 0
    v_mov_b32 v19, s53
    ds_add_u32 v0, v19 offset:288
    s_mul_i32 s30, s52, -4
    s_lshl_b32 s26, s18, 31
    s_setprio 2
    v_and_b32 v11, 0x7c, v11
    v_or_b32 v11, 0xc000, v11
    v_lshlrev_b32 v10, 16, v11
    s_nop 1
    v_or_b32_dpp v19, v10, v11 row_shl:4 row_mask:0xf bank_mask:0xf bound_ctrl:0
    s_barrier
    ds_read_b64 v[8:9], v8 offset:352
    ds_read_b128 v[60:63], v84 offset:320
    ds_read_b128 v[64:67], v85 offset:320
    v_mov_b32 v4, v26
    v_mov_b32 v6, v27
    s_waitcnt lgkmcnt(2)
    v_mfma_f32_4x4x4_16b_bf16 v[28:31], v[8:9], v[76:77], 0
    v_mfma_f32_4x4x4_16b_bf16 v[32:35], v[8:9], v[78:79], 0
    v_mfma_f32_4x4x4_16b_bf16 v[36:39], v[8:9], v[80:81], 0
    v_mfma_f32_4x4x4_16b_bf16 v[40:43], v[8:9], v[82:83], 0
    s_waitcnt lgkmcnt(0)
    v_mfma_f32_32x32x16_bf16 v[44:59], v[60:63], v[68:71], 0
    v_mfma_f32_32x32x16_bf16 v[44:59], v[64:67], v[72:75], v[44:59]
    s_waitcnt vmcnt(4)
    ds_read_b64_tr_b16 v[20:21], v1 offset:0
    ds_read_b64_tr_b16 v[22:23], v1 offset:512
    ds_read_b64_tr_b16 v[24:25], v1 offset:1024
    ds_read_b64_tr_b16 v[26:27], v1 offset:1536
    v_cvt_pk_bf16_f32 v12, v28, v32
    v_cvt_pk_bf16_f32 v14, v29, v33
    v_cvt_pk_bf16_f32 v16, v30, v34
    v_cvt_pk_bf16_f32 v13, v36, v40
    v_cvt_pk_bf16_f32 v15, v37, v41
    v_cvt_pk_bf16_f32 v17, v38, v42
    s_set_gpr_idx_on s40, gpr_idx(SRC2,DST)
    s_mov_b32 m0, s40
    s_waitcnt lgkmcnt(2)
    buffer_load_dwordx4 v[4:5], s[4:7], 0 idxen offen lds
    s_mov_b32 m0, s41
    s_waitcnt lgkmcnt(0)
    buffer_load_dwordx4 v[6:7], s[4:7], 0 idxen offen lds
    s_sub_u32 s19, s19, 1
    s_cbranch_scc1 mn_st12
mn_st12_back:
mn_loop:
    v_mfma_f32_4x4x4_16b_bf16 v[28:31], v[12:13], v[20:21], 0 cbsz:4 abid:0
    v_mfma_f32_4x4x4_16b_bf16 v[32:35], v[12:13], v[22:23], 0 cbsz:4 abid:1
    v_mfma_f32_4x4x4_16b_bf16 v[36:39], v[12:13], v[24:25], 0 cbsz:4 abid:2
    v_mfma_f32_4x4x4_16b_bf16 v[40:43], v[12:13], v[26:27], 0 cbsz:4 abid:3
    ds_read_u16 v4, v2 offset:576
    ds_read_u16 v6, v2 offset:584
    v_readlane_b32 s28, v19, 0
    v_readlane_b32 s29, v19, 8
    s_waitcnt vmcnt(4)
    ds_read_b64_tr_b16 v[20:21], v1 offset:2048
    ds_read_b64_tr_b16 v[22:23], v1 offset:2560
    ds_read_b64_tr_b16 v[24:25], v1 offset:3072
    ds_read_b64_tr_b16 v[26:27], v1 offset:3584
    s_sub_u32 s34, s34, 1
    s_cmov_b32 s35, 0x30000
    s_mov_b32 m0, s28
    v_fmac_f32 v88, v28, v44
    v_fmac_f32 v89, v29, v44
    v_fmac_f32 v90, v30, v44
    v_fmac_f32 v91, v31, v44
    s_lshr_b32 m0, s28, 16
    v_fmac_f32 v88, v32, v45
    v_fmac_f32 v89, v33, v45
    v_fmac_f32 v90, v34, v45
    v_fmac_f32 v91, v35, v45
    s_mov_b32 m0, s29
    v_fmac_f32 v88, v36, v46
    v_fmac_f32 v89, v37, v46
    v_fmac_f32 v90, v38, v46
    v_fmac_f32 v91, v39, v46
    s_lshr_b32 m0, s29, 16
    v_fmac_f32 v88, v40, v47
    v_fmac_f32 v89, v41, v47
    v_fmac_f32 v90, v42, v47
    v_fmac_f32 v91, v43, v47
    s_or_b32 m0, s42, s35
    s_waitcnt lgkmcnt(0)
    buffer_load_dwordx4 v[4:5], s[4:7], 0 idxen offen lds
    buffer_load_dwordx4 v[6:7], s[12:15], 0 idxen offen offset:1024 lds
    s_sub_u32 s19, s19, 1
    s_cbranch_scc1 mn_st0
mn_st0_back:
    v_mfma_f32_4x4x4_16b_bf16 v[28:31], v[12:13], v[20:21], 0 cbsz:4 abid:4
    v_mfma_f32_4x4x4_16b_bf16 v[32:35], v[12:13], v[22:23], 0 cbsz:4 abid:5
    v_mfma_f32_4x4x4_16b_bf16 v[36:39], v[12:13], v[24:25], 0 cbsz:4 abid:6
    v_mfma_f32_4x4x4_16b_bf16 v[40:43], v[12:13], v[26:27], 0 cbsz:4 abid:7
    ds_read_u16 v4, v2 offset:592
    ds_read_u16 v6, v2 offset:600
    v_readlane_b32 s28, v19, 16
    v_readlane_b32 s29, v19, 24
    ds_read_u16 v84, v3 offset:578
    s_waitcnt vmcnt(4)
    ds_read_b64_tr_b16 v[20:21], v1 offset:4096
    ds_read_b64_tr_b16 v[22:23], v1 offset:4608
    ds_read_b64_tr_b16 v[24:25], v1 offset:5120
    ds_read_b64_tr_b16 v[26:27], v1 offset:5632
    s_sub_u32 s34, s34, 1
    s_cmov_b32 s35, 0x30000
    s_mov_b32 m0, s28
    v_fmac_f32 v88, v28, v48
    v_fmac_f32 v89, v29, v48
    v_fmac_f32 v90, v30, v48
    v_fmac_f32 v91, v31, v48
    s_lshr_b32 m0, s28, 16
    v_fmac_f32 v88, v32, v49
    v_fmac_f32 v89, v33, v49
    v_fmac_f32 v90, v34, v49
    v_fmac_f32 v91, v35, v49
    s_mov_b32 m0, s29
    v_fmac_f32 v88, v36, v50
    v_fmac_f32 v89, v37, v50
    v_fmac_f32 v90, v38, v50
    v_fmac_f32 v91, v39, v50
    s_lshr_b32 m0, s29, 16
    v_fmac_f32 v88, v40, v51
    v_fmac_f32 v89, v41, v51
    v_fmac_f32 v90, v42, v51
    v_fmac_f32 v91, v43, v51
    s_or_b32 m0, s44, s35
    s_waitcnt lgkmcnt(0)
    buffer_load_dwordx4 v[4:5], s[4:7], 0 idxen offen lds
    buffer_load_dwordx4 v[6:7], s[12:15], 0 idxen offen offset:1024 lds
    s_sub_u32 s19, s19, 1
    s_cbranch_scc1 mn_st1
mn_st1_back:
    v_mfma_f32_4x4x4_16b_bf16 v[28:31], v[12:13], v[20:21], 0 cbsz:4 abid:8
    v_mfma_f32_4x4x4_16b_bf16 v[32:35], v[12:13], v[22:23], 0 cbsz:4 abid:9
    v_mfma_f32_4x4x4_16b_bf16 v[36:39], v[12:13], v[24:25], 0 cbsz:4 abid:10
    v_mfma_f32_4x4x4_16b_bf16 v[40:43], v[12:13], v[26:27], 0 cbsz:4 abid:11
    ds_read_u16 v4, v2 offset:608
    ds_read_u16 v6, v2 offset:616
    v_readlane_b32 s28, v19, 32
    v_readlane_b32 s29, v19, 40
    v_and_b32 v84, 0x3ff, v84
    v_mad_u32_u24 v84, v84, 48, v86
    v_xor_b32 v85, 0x40000, v84
    ds_read_b128 v[60:63], v84 offset:320
    ds_read_b128 v[64:67], v85 offset:320
    s_waitcnt vmcnt(4)
    ds_read_b64_tr_b16 v[20:21], v1 offset:0
    ds_read_b64_tr_b16 v[22:23], v1 offset:512
    ds_read_b64_tr_b16 v[24:25], v1 offset:1024
    ds_read_b64_tr_b16 v[26:27], v1 offset:1536
    s_sub_u32 s34, s34, 1
    s_cmov_b32 s35, 0x30000
    s_mov_b32 m0, s28
    v_fmac_f32 v88, v28, v52
    v_fmac_f32 v89, v29, v52
    v_fmac_f32 v90, v30, v52
    v_fmac_f32 v91, v31, v52
    s_lshr_b32 m0, s28, 16
    v_fmac_f32 v88, v32, v53
    v_fmac_f32 v89, v33, v53
    v_fmac_f32 v90, v34, v53
    v_fmac_f32 v91, v35, v53
    s_mov_b32 m0, s29
    v_fmac_f32 v88, v36, v54
    v_fmac_f32 v89, v37, v54
    v_fmac_f32 v90, v38, v54
    v_fmac_f32 v91, v39, v54
    s_lshr_b32 m0, s29, 16
    v_fmac_f32 v88, v40, v55
    v_fmac_f32 v89, v41, v55
    v_fmac_f32 v90, v42, v55
    v_fmac_f32 v91, v43, v55
    s_or_b32 m0, s40, s35
    s_waitcnt lgkmcnt(0)
    buffer_load_dwordx4 v[4:5], s[4:7], 0 idxen offen lds
    buffer_load_dwordx4 v[6:7], s[12:15], 0 idxen offen offset:1024 lds
    s_sub_u32 s19, s19, 1
    s_cbranch_scc1 mn_st2
mn_st2_back:
    v_mfma_f32_4x4x4_16b_bf16 v[28:31], v[12:13], v[20:21], 0 cbsz:4 abid:12
    v_mfma_f32_4x4x4_16b_bf16 v[32:35], v[12:13], v[22:23], 0 cbsz:4 abid:13
    v_mfma_f32_4x4x4_16b_bf16 v[36:39], v[12:13], v[24:25], 0 cbsz:4 abid:14
    v_mfma_f32_4x4x4_16b_bf16 v[40:43], v[12:13], v[26:27], 0 cbsz:4 abid:15
    ds_read_u16 v4, v2 offset:624
    ds_read_u16 v6, v2 offset:632
    v_readlane_b32 s28, v19, 48
    v_readlane_b32 s29, v19, 56
    v_mov_b32 v85, s30
    ds_add_rtn_u32 v85, v0, v85 offset:288
    s_waitcnt vmcnt(4)
    ds_read_b64_tr_b16 v[20:21], v1 offset:2048
    ds_read_b64_tr_b16 v[22:23], v1 offset:2560
    ds_read_b64_tr_b16 v[24:25], v1 offset:3072
    ds_read_b64_tr_b16 v[26:27], v1 offset:3584
    s_sub_u32 s34, s34, 1
    s_cmov_b32 s35, 0x30000
    s_mov_b32 m0, s28
    v_fmac_f32 v88, v28, v56
    v_fmac_f32 v89, v29, v56
    v_fmac_f32 v90, v30, v56
    v_fmac_f32 v91, v31, v56
    s_lshr_b32 m0, s28, 16
    v_fmac_f32 v88, v32, v57
    v_fmac_f32 v89, v33, v57
    v_fmac_f32 v90, v34, v57
    v_fmac_f32 v91, v35, v57
    s_mov_b32 m0, s29
    v_fmac_f32 v88, v36, v58
    v_fmac_f32 v89, v37, v58
    v_fmac_f32 v90, v38, v58
    v_fmac_f32 v91, v39, v58
    s_lshr_b32 m0, s29, 16
    v_fmac_f32 v88, v40, v59
    v_fmac_f32 v89, v41, v59
    v_fmac_f32 v90, v42, v59
    v_fmac_f32 v91, v43, v59
    s_or_b32 m0, s42, s35
    v_mfma_f32_32x32x16_bf16 v[44:59], v[60:63], v[68:71], 0
    v_mfma_f32_32x32x16_bf16 v[44:59], v[64:67], v[72:75], v[44:59]
    s_waitcnt lgkmcnt(0)
    buffer_load_dwordx4 v[4:5], s[4:7], 0 idxen offen lds
    buffer_load_dwordx4 v[6:7], s[12:15], 0 idxen offen offset:1024 lds
    v_readfirstlane_b32 s27, v85
    s_setprio 2
    s_xor_b32 s27, s27, s26
    s_cmp_ge_i32 s27, 0
    s_cbranch_scc1 mn_pr3
    s_setprio 1
mn_pr3:
    s_sub_u32 s19, s19, 1
    s_cbranch_scc1 mn_st3
mn_st3_back:
    v_mfma_f32_4x4x4_16b_bf16 v[28:31], v[14:15], v[20:21], 0 cbsz:4 abid:0
    v_mfma_f32_4x4x4_16b_bf16 v[32:35], v[14:15], v[22:23], 0 cbsz:4 abid:1
    v_mfma_f32_4x4x4_16b_bf16 v[36:39], v[14:15], v[24:25], 0 cbsz:4 abid:2
    v_mfma_f32_4x4x4_16b_bf16 v[40:43], v[14:15], v[26:27], 0 cbsz:4 abid:3
    ds_read_u16 v4, v2 offset:640
    ds_read_u16 v6, v2 offset:648
    v_readlane_b32 s28, v19, 1
    v_readlane_b32 s29, v19, 9
    s_waitcnt vmcnt(4)
    ds_read_b64_tr_b16 v[20:21], v1 offset:4096
    ds_read_b64_tr_b16 v[22:23], v1 offset:4608
    ds_read_b64_tr_b16 v[24:25], v1 offset:5120
    ds_read_b64_tr_b16 v[26:27], v1 offset:5632
    s_sub_u32 s34, s34, 1
    s_cmov_b32 s35, 0x30000
    s_mov_b32 m0, s28
    v_fmac_f32 v88, v28, v44
    v_fmac_f32 v89, v29, v44
    v_fmac_f32 v90, v30, v44
    v_fmac_f32 v91, v31, v44
    s_lshr_b32 m0, s28, 16
    v_fmac_f32 v88, v32, v45
    v_fmac_f32 v89, v33, v45
    v_fmac_f32 v90, v34, v45
    v_fmac_f32 v91, v35, v45
    s_mov_b32 m0, s29
    v_fmac_f32 v88, v36, v46
    v_fmac_f32 v89, v37, v46
    v_fmac_f32 v90, v38, v46
    v_fmac_f32 v91, v39, v46
    s_lshr_b32 m0, s29, 16
    v_fmac_f32 v88, v40, v47
    v_fmac_f32 v89, v41, v47
    v_fmac_f32 v90, v42, v47
    v_fmac_f32 v91, v43, v47
    s_or_b32 m0, s44, s35
    s_waitcnt lgkmcnt(0)
    buffer_load_dwordx4 v[4:5], s[4:7], 0 idxen offen lds
    buffer_load_dwordx4 v[6:7], s[12:15], 0 idxen offen offset:1024 lds
    s_sub_u32 s19, s19, 1
    s_cbranch_scc1 mn_st4
mn_st4_back:
    v_mfma_f32_4x4x4_16b_bf16 v[28:31], v[14:15], v[20:21], 0 cbsz:4 abid:4
    v_mfma_f32_4x4x4_16b_bf16 v[32:35], v[14:15], v[22:23], 0 cbsz:4 abid:5
    v_mfma_f32_4x4x4_16b_bf16 v[36:39], v[14:15], v[24:25], 0 cbsz:4 abid:6
    v_mfma_f32_4x4x4_16b_bf16 v[40:43], v[14:15], v[26:27], 0 cbsz:4 abid:7
    ds_read_u16 v4, v2 offset:656
    ds_read_u16 v6, v2 offset:664
    v_readlane_b32 s28, v19, 17
    v_readlane_b32 s29, v19, 25
    ds_read_u16 v84, v3 offset:642
    s_waitcnt vmcnt(4)
    ds_read_b64_tr_b16 v[20:21], v1 offset:0
    ds_read_b64_tr_b16 v[22:23], v1 offset:512
    ds_read_b64_tr_b16 v[24:25], v1 offset:1024
    ds_read_b64_tr_b16 v[26:27], v1 offset:1536
    s_sub_u32 s34, s34, 1
    s_cmov_b32 s35, 0x30000
    s_mov_b32 m0, s28
    v_fmac_f32 v88, v28, v48
    v_fmac_f32 v89, v29, v48
    v_fmac_f32 v90, v30, v48
    v_fmac_f32 v91, v31, v48
    s_lshr_b32 m0, s28, 16
    v_fmac_f32 v88, v32, v49
    v_fmac_f32 v89, v33, v49
    v_fmac_f32 v90, v34, v49
    v_fmac_f32 v91, v35, v49
    s_mov_b32 m0, s29
    v_fmac_f32 v88, v36, v50
    v_fmac_f32 v89, v37, v50
    v_fmac_f32 v90, v38, v50
    v_fmac_f32 v91, v39, v50
    s_lshr_b32 m0, s29, 16
    v_fmac_f32 v88, v40, v51
    v_fmac_f32 v89, v41, v51
    v_fmac_f32 v90, v42, v51
    v_fmac_f32 v91, v43, v51
    s_or_b32 m0, s40, s35
    s_waitcnt lgkmcnt(0)
    buffer_load_dwordx4 v[4:5], s[4:7], 0 idxen offen lds
    buffer_load_dwordx4 v[6:7], s[12:15], 0 idxen offen offset:1024 lds
    s_sub_u32 s19, s19, 1
    s_cbranch_scc1 mn_st5
mn_st5_back:
    v_mfma_f32_4x4x4_16b_bf16 v[28:31], v[14:15], v[20:21], 0 cbsz:4 abid:8
    v_mfma_f32_4x4x4_16b_bf16 v[32:35], v[14:15], v[22:23], 0 cbsz:4 abid:9
    v_mfma_f32_4x4x4_16b_bf16 v[36:39], v[14:15], v[24:25], 0 cbsz:4 abid:10
    v_mfma_f32_4x4x4_16b_bf16 v[40:43], v[14:15], v[26:27], 0 cbsz:4 abid:11
    ds_read_u16 v4, v2 offset:672
    ds_read_u16 v6, v2 offset:680
    v_readlane_b32 s28, v19, 33
    v_readlane_b32 s29, v19, 41
    v_and_b32 v84, 0x3ff, v84
    v_mad_u32_u24 v84, v84, 48, v86
    v_xor_b32 v85, 0x40000, v84
    ds_read_b128 v[60:63], v84 offset:320
    ds_read_b128 v[64:67], v85 offset:320
    s_waitcnt vmcnt(4)
    ds_read_b64_tr_b16 v[20:21], v1 offset:2048
    ds_read_b64_tr_b16 v[22:23], v1 offset:2560
    ds_read_b64_tr_b16 v[24:25], v1 offset:3072
    ds_read_b64_tr_b16 v[26:27], v1 offset:3584
    s_sub_u32 s34, s34, 1
    s_cmov_b32 s35, 0x30000
    s_mov_b32 m0, s28
    v_fmac_f32 v88, v28, v52
    v_fmac_f32 v89, v29, v52
    v_fmac_f32 v90, v30, v52
    v_fmac_f32 v91, v31, v52
    s_lshr_b32 m0, s28, 16
    v_fmac_f32 v88, v32, v53
    v_fmac_f32 v89, v33, v53
    v_fmac_f32 v90, v34, v53
    v_fmac_f32 v91, v35, v53
    s_mov_b32 m0, s29
    v_fmac_f32 v88, v36, v54
    v_fmac_f32 v89, v37, v54
    v_fmac_f32 v90, v38, v54
    v_fmac_f32 v91, v39, v54
    s_lshr_b32 m0, s29, 16
    v_fmac_f32 v88, v40, v55
    v_fmac_f32 v89, v41, v55
    v_fmac_f32 v90, v42, v55
    v_fmac_f32 v91, v43, v55
    s_or_b32 m0, s42, s35
    s_waitcnt lgkmcnt(0)
    buffer_load_dwordx4 v[4:5], s[4:7], 0 idxen offen lds
    buffer_load_dwordx4 v[6:7], s[12:15], 0 idxen offen offset:1024 lds
    s_sub_u32 s19, s19, 1
    s_cbranch_scc1 mn_st6
mn_st6_back:
    v_mfma_f32_4x4x4_16b_bf16 v[28:31], v[14:15], v[20:21], 0 cbsz:4 abid:12
    v_mfma_f32_4x4x4_16b_bf16 v[32:35], v[14:15], v[22:23], 0 cbsz:4 abid:13
    v_mfma_f32_4x4x4_16b_bf16 v[36:39], v[14:15], v[24:25], 0 cbsz:4 abid:14
    v_mfma_f32_4x4x4_16b_bf16 v[40:43], v[14:15], v[26:27], 0 cbsz:4 abid:15
    ds_read_u16 v4, v2 offset:688
    ds_read_u16 v6, v2 offset:696
    v_readlane_b32 s28, v19, 49
    v_readlane_b32 s29, v19, 57
    v_mov_b32 v85, s30
    ds_add_rtn_u32 v85, v0, v85 offset:288
    s_waitcnt vmcnt(4)
    ds_read_b64_tr_b16 v[20:21], v1 offset:4096
    ds_read_b64_tr_b16 v[22:23], v1 offset:4608
    ds_read_b64_tr_b16 v[24:25], v1 offset:5120
    ds_read_b64_tr_b16 v[26:27], v1 offset:5632
    s_sub_u32 s34, s34, 1
    s_cmov_b32 s35, 0x30000
    s_mov_b32 m0, s28
    v_fmac_f32 v88, v28, v56
    v_fmac_f32 v89, v29, v56
    v_fmac_f32 v90, v30, v56
    v_fmac_f32 v91, v31, v56
    s_lshr_b32 m0, s28, 16
    v_fmac_f32 v88, v32, v57
    v_fmac_f32 v89, v33, v57
    v_fmac_f32 v90, v34, v57
    v_fmac_f32 v91, v35, v57
    s_mov_b32 m0, s29
    v_fmac_f32 v88, v36, v58
    v_fmac_f32 v89, v37, v58
    v_fmac_f32 v90, v38, v58
    v_fmac_f32 v91, v39, v58
    s_lshr_b32 m0, s29, 16
    v_fmac_f32 v88, v40, v59
    v_fmac_f32 v89, v41, v59
    v_fmac_f32 v90, v42, v59
    v_fmac_f32 v91, v43, v59
    s_or_b32 m0, s44, s35
    v_mfma_f32_32x32x16_bf16 v[44:59], v[60:63], v[68:71], 0
    v_mfma_f32_32x32x16_bf16 v[44:59], v[64:67], v[72:75], v[44:59]
    s_waitcnt lgkmcnt(0)
    buffer_load_dwordx4 v[4:5], s[4:7], 0 idxen offen lds
    buffer_load_dwordx4 v[6:7], s[12:15], 0 idxen offen offset:1024 lds
    v_readfirstlane_b32 s27, v85
    s_setprio 2
    s_xor_b32 s27, s27, s26
    s_cmp_ge_i32 s27, 0
    s_cbranch_scc1 mn_pr7
    s_setprio 1
mn_pr7:
    s_sub_u32 s19, s19, 1
    s_cbranch_scc1 mn_st7
mn_st7_back:
    v_mfma_f32_4x4x4_16b_bf16 v[28:31], v[16:17], v[20:21], 0 cbsz:4 abid:0
    v_mfma_f32_4x4x4_16b_bf16 v[32:35], v[16:17], v[22:23], 0 cbsz:4 abid:1
    v_mfma_f32_4x4x4_16b_bf16 v[36:39], v[16:17], v[24:25], 0 cbsz:4 abid:2
    v_mfma_f32_4x4x4_16b_bf16 v[40:43], v[16:17], v[26:27], 0 cbsz:4 abid:3
    ds_read_u16 v4, v2 offset:704
    ds_read_u16 v6, v2 offset:712
    v_readlane_b32 s28, v19, 2
    v_readlane_b32 s29, v19, 10
    ds_read_u16 v8, v18 offset:706
    s_waitcnt vmcnt(4)
    ds_read_b64_tr_b16 v[20:21], v1 offset:0
    ds_read_b64_tr_b16 v[22:23], v1 offset:512
    ds_read_b64_tr_b16 v[24:25], v1 offset:1024
    ds_read_b64_tr_b16 v[26:27], v1 offset:1536
    s_sub_u32 s34, s34, 1
    s_cmov_b32 s35, 0x30000
    s_mov_b32 m0, s28
    v_fmac_f32 v88, v28, v44
    v_fmac_f32 v89, v29, v44
    v_fmac_f32 v90, v30, v44
    v_fmac_f32 v91, v31, v44
    s_lshr_b32 m0, s28, 16
    v_fmac_f32 v88, v32, v45
    v_fmac_f32 v89, v33, v45
    v_fmac_f32 v90, v34, v45
    v_fmac_f32 v91, v35, v45
    s_mov_b32 m0, s29
    v_fmac_f32 v88, v36, v46
    v_fmac_f32 v89, v37, v46
    v_fmac_f32 v90, v38, v46
    v_fmac_f32 v91, v39, v46
    s_lshr_b32 m0, s29, 16
    v_fmac_f32 v88, v40, v47
    v_fmac_f32 v89, v41, v47
    v_fmac_f32 v90, v42, v47
    v_fmac_f32 v91, v43, v47
    s_or_b32 m0, s40, s35
    s_waitcnt lgkmcnt(0)
    buffer_load_dwordx4 v[4:5], s[4:7], 0 idxen offen lds
    buffer_load_dwordx4 v[6:7], s[12:15], 0 idxen offen offset:1024 lds
    s_sub_u32 s19, s19, 1
    s_cbranch_scc1 mn_st8
mn_st8_back:
    v_mfma_f32_4x4x4_16b_bf16 v[28:31], v[16:17], v[20:21], 0 cbsz:4 abid:4
    v_mfma_f32_4x4x4_16b_bf16 v[32:35], v[16:17], v[22:23], 0 cbsz:4 abid:5
    v_mfma_f32_4x4x4_16b_bf16 v[36:39], v[16:17], v[24:25], 0 cbsz:4 abid:6
    v_mfma_f32_4x4x4_16b_bf16 v[40:43], v[16:17], v[26:27], 0 cbsz:4 abid:7
    ds_read_u16 v4, v2 offset:720
    ds_read_u16 v6, v2 offset:728
    v_readlane_b32 s28, v19, 18
    v_readlane_b32 s29, v19, 26
    ds_read_u16 v84, v3 offset:706
    v_lshrrev_b32 v11, 8, v8
    v_and_b32 v8, 0x3ff, v8
    v_mul_u32_u24 v8, 48, v8
    ds_read_b64 v[8:9], v8 offset:352
    s_waitcnt vmcnt(4)
    ds_read_b64_tr_b16 v[20:21], v1 offset:2048
    ds_read_b64_tr_b16 v[22:23], v1 offset:2560
    ds_read_b64_tr_b16 v[24:25], v1 offset:3072
    ds_read_b64_tr_b16 v[26:27], v1 offset:3584
    s_sub_u32 s34, s34, 1
    s_cmov_b32 s35, 0x30000
    s_mov_b32 m0, s28
    v_fmac_f32 v88, v28, v48
    v_fmac_f32 v89, v29, v48
    v_fmac_f32 v90, v30, v48
    v_fmac_f32 v91, v31, v48
    s_lshr_b32 m0, s28, 16
    v_fmac_f32 v88, v32, v49
    v_fmac_f32 v89, v33, v49
    v_fmac_f32 v90, v34, v49
    v_fmac_f32 v91, v35, v49
    s_mov_b32 m0, s29
    v_fmac_f32 v88, v36, v50
    v_fmac_f32 v89, v37, v50
    v_fmac_f32 v90, v38, v50
    v_fmac_f32 v91, v39, v50
    s_lshr_b32 m0, s29, 16
    v_fmac_f32 v88, v40, v51
    v_fmac_f32 v89, v41, v51
    v_fmac_f32 v90, v42, v51
    v_fmac_f32 v91, v43, v51
    s_or_b32 m0, s42, s35
    s_waitcnt lgkmcnt(0)
    buffer_load_dwordx4 v[4:5], s[4:7], 0 idxen offen lds
    buffer_load_dwordx4 v[6:7], s[12:15], 0 idxen offen offset:1024 lds
    s_sub_u32 s19, s19, 1
    s_cbranch_scc1 mn_st9
mn_st9_back:
    v_mfma_f32_4x4x4_16b_bf16 v[28:31], v[16:17], v[20:21], 0 cbsz:4 abid:8
    v_mfma_f32_4x4x4_16b_bf16 v[32:35], v[16:17], v[22:23], 0 cbsz:4 abid:9
    v_mfma_f32_4x4x4_16b_bf16 v[36:39], v[16:17], v[24:25], 0 cbsz:4 abid:10
    v_mfma_f32_4x4x4_16b_bf16 v[40:43], v[16:17], v[26:27], 0 cbsz:4 abid:11
    ds_read_u16 v4, v2 offset:736
    ds_read_u16 v6, v2 offset:744
    v_readlane_b32 s28, v19, 34
    v_readlane_b32 s29, v19, 42
    v_and_b32 v84, 0x3ff, v84
    v_mad_u32_u24 v84, v84, 48, v86
    v_xor_b32 v85, 0x40000, v84
    ds_read_b128 v[60:63], v84 offset:320
    ds_read_b128 v[64:67], v85 offset:320
    s_waitcnt vmcnt(4)
    ds_read_b64_tr_b16 v[20:21], v1 offset:4096
    ds_read_b64_tr_b16 v[22:23], v1 offset:4608
    ds_read_b64_tr_b16 v[24:25], v1 offset:5120
    ds_read_b64_tr_b16 v[26:27], v1 offset:5632
    s_sub_u32 s34, s34, 1
    s_cmov_b32 s35, 0x30000
    s_mov_b32 m0, s28
    v_fmac_f32 v88, v28, v52
    v_fmac_f32 v89, v29, v52
    v_fmac_f32 v90, v30, v52
    v_fmac_f32 v91, v31, v52
    s_lshr_b32 m0, s28, 16
    v_fmac_f32 v88, v32, v53
    v_fmac_f32 v89, v33, v53
    v_fmac_f32 v90, v34, v53
    v_fmac_f32 v91, v35, v53
    s_mov_b32 m0, s29
    v_fmac_f32 v88, v36, v54
    v_fmac_f32 v89, v37, v54
    v_fmac_f32 v90, v38, v54
    v_fmac_f32 v91, v39, v54
    s_lshr_b32 m0, s29, 16
    v_fmac_f32 v88, v40, v55
    v_fmac_f32 v89, v41, v55
    v_fmac_f32 v90, v42, v55
    v_fmac_f32 v91, v43, v55
    s_or_b32 m0, s44, s35
    s_waitcnt lgkmcnt(0)
    buffer_load_dwordx4 v[4:5], s[4:7], 0 idxen offen lds
    buffer_load_dwordx4 v[6:7], s[12:15], 0 idxen offen offset:1024 lds
    v_and_b32 v11, 0x7c, v11
    v_or_b32 v11, 0xc000, v11
    v_lshlrev_b32 v10, 16, v11
    s_sub_u32 s19, s19, 1
    s_cbranch_scc1 mn_st10
mn_st10_back:
    v_mfma_f32_4x4x4_16b_bf16 v[28:31], v[16:17], v[20:21], 0 cbsz:4 abid:12
    v_mfma_f32_4x4x4_16b_bf16 v[32:35], v[16:17], v[22:23], 0 cbsz:4 abid:13
    v_mfma_f32_4x4x4_16b_bf16 v[36:39], v[16:17], v[24:25], 0 cbsz:4 abid:14
    v_mfma_f32_4x4x4_16b_bf16 v[40:43], v[16:17], v[26:27], 0 cbsz:4 abid:15
    ds_read_u16 v4, v2 offset:752
    ds_read_u16 v6, v2 offset:760
    v_readlane_b32 s28, v19, 50
    v_readlane_b32 s29, v19, 58
    v_mov_b32 v85, s30
    ds_add_rtn_u32 v85, v0, v85 offset:288
    s_waitcnt vmcnt(4)
    ds_read_b64_tr_b16 v[20:21], v1 offset:0
    ds_read_b64_tr_b16 v[22:23], v1 offset:512
    ds_read_b64_tr_b16 v[24:25], v1 offset:1024
    ds_read_b64_tr_b16 v[26:27], v1 offset:1536
    s_sub_u32 s34, s34, 1
    s_cmov_b32 s35, 0x30000
    s_mov_b32 m0, s28
    v_fmac_f32 v88, v28, v56
    v_fmac_f32 v89, v29, v56
    v_fmac_f32 v90, v30, v56
    v_fmac_f32 v91, v31, v56
    s_lshr_b32 m0, s28, 16
    v_fmac_f32 v88, v32, v57
    v_fmac_f32 v89, v33, v57
    v_fmac_f32 v90, v34, v57
    v_fmac_f32 v91, v35, v57
    s_mov_b32 m0, s29
    v_fmac_f32 v88, v36, v58
    v_fmac_f32 v89, v37, v58
    v_fmac_f32 v90, v38, v58
    v_fmac_f32 v91, v39, v58
    s_lshr_b32 m0, s29, 16
    v_fmac_f32 v88, v40, v59
    v_fmac_f32 v89, v41, v59
    v_fmac_f32 v90, v42, v59
    v_fmac_f32 v91, v43, v59
    s_or_b32 m0, s40, s35
    v_mfma_f32_4x4x4_16b_bf16 v[28:31], v[8:9], v[76:77], 0
    v_mfma_f32_4x4x4_16b_bf16 v[32:35], v[8:9], v[78:79], 0
    v_mfma_f32_4x4x4_16b_bf16 v[36:39], v[8:9], v[80:81], 0
    v_mfma_f32_4x4x4_16b_bf16 v[40:43], v[8:9], v[82:83], 0
    v_mfma_f32_32x32x16_bf16 v[44:59], v[60:63], v[68:71], 0
    v_mfma_f32_32x32x16_bf16 v[44:59], v[64:67], v[72:75], v[44:59]
    s_waitcnt lgkmcnt(0)
    buffer_load_dwordx4 v[4:5], s[4:7], 0 idxen offen lds
    buffer_load_dwordx4 v[6:7], s[12:15], 0 idxen offen offset:1024 lds
    v_cvt_pk_bf16_f32 v12, v28, v32
    v_cvt_pk_bf16_f32 v14, v29, v33
    v_cvt_pk_bf16_f32 v16, v30, v34
    v_cvt_pk_bf16_f32 v13, v36, v40
    v_cvt_pk_bf16_f32 v15, v37, v41
    v_cvt_pk_bf16_f32 v17, v38, v42
    v_or_b32_dpp v19, v10, v11 row_shl:4 row_mask:0xf bank_mask:0xf bound_ctrl:0
    v_add_u32 v2, 192, v2
    v_add_u32 v3, 192, v3
    v_add_u32 v18, 192, v18
    v_readfirstlane_b32 s27, v85
    s_setprio 2
    s_xor_b32 s27, s27, s26
    s_cmp_ge_i32 s27, 0
    s_cbranch_scc1 mn_pr11
    s_setprio 1
mn_pr11:
    s_sub_u32 s19, s19, 1
    s_cbranch_scc1 mn_st11
mn_st11_back:
    s_branch mn_loop
mn_st0:
    s_cmp_lg_u32 s21, 0
    s_cbranch_scc1 mn_next
    s_call_b64 s[48:49], mn_flush
    s_branch mn_st0_back
mn_st1:
    s_cmp_lg_u32 s21, 0
    s_cbranch_scc1 mn_next
    s_call_b64 s[48:49], mn_flush
    s_branch mn_st1_back
mn_st2:
    s_cmp_lg_u32 s21, 0
    s_cbranch_scc1 mn_next
    s_call_b64 s[48:49], mn_flush
    s_branch mn_st2_back
mn_st3:
    s_cmp_lg_u32 s21, 0
    s_cbranch_scc1 mn_next
    s_call_b64 s[48:49], mn_flush
    s_branch mn_st3_back
mn_st4:
    s_cmp_lg_u32 s21, 0
    s_cbranch_scc1 mn_next
    s_call_b64 s[48:49], mn_flush
    s_branch mn_st4_back
mn_st5:
    s_cmp_lg_u32 s21, 0
    s_cbranch_scc1 mn_next
    s_call_b64 s[48:49], mn_flush
    s_branch mn_st5_back
mn_st6:
    s_cmp_lg_u32 s21, 0
    s_cbranch_scc1 mn_next
    s_call_b64 s[48:49], mn_flush
    s_branch mn_st6_back
mn_st7:
    s_cmp_lg_u32 s21, 0
    s_cbranch_scc1 mn_next
    s_call_b64 s[48:49], mn_flush
    s_branch mn_st7_back
mn_st8:
    s_cmp_lg_u32 s21, 0
    s_cbranch_scc1 mn_next
    s_call_b64 s[48:49], mn_flush
    s_branch mn_st8_back
mn_st9:
    s_cmp_lg_u32 s21, 0
    s_cbranch_scc1 mn_next
    s_call_b64 s[48:49], mn_flush
    s_branch mn_st9_back
mn_st10:
    s_cmp_lg_u32 s21, 0
    s_cbranch_scc1 mn_next
    s_call_b64 s[48:49], mn_flush
    s_branch mn_st10_back
mn_st11:
    s_cmp_lg_u32 s21, 0
    s_cbranch_scc1 mn_next
    s_call_b64 s[48:49], mn_flush
    s_branch mn_st11_back
mn_st12:
    s_cmp_lg_u32 s21, 0
    s_cbranch_scc1 mn_next
    s_call_b64 s[48:49], mn_flush
    s_branch mn_st12_back
mn_flush:
    s_cmp_eq_u32 s58, 4
    s_cbranch_scc1 mn_fl4
    s_cmp_eq_u32 s58, 3
    s_cbranch_scc1 mn_fl3
    s_cmp_eq_u32 s58, 2
    s_cbranch_scc1 mn_fl2
    s_cmp_eq_u32 s58, 1
    s_cbranch_scc1 mn_fl1
mn_fl0:
    v_cvt_pk_bf16_f32 v88, v88, v89
    v_cvt_pk_bf16_f32 v89, v90, v91
    ds_write_b64 v87, v[88:89] offset:0
    v_cvt_pk_bf16_f32 v92, v92, v93
    v_cvt_pk_bf16_f32 v93, v94, v95
    ds_write_b64 v87, v[92:93] offset:576
    v_cvt_pk_bf16_f32 v96, v96, v97
    v_cvt_pk_bf16_f32 v97, v98, v99
    ds_write_b64 v87, v[96:97] offset:1152
    v_cvt_pk_bf16_f32 v100, v100, v101
    v_cvt_pk_bf16_f32 v101, v102, v103
    ds_write_b64 v87, v[100:101] offset:1728
    s_mul_i32 s52, s18, 3
    s_lshl_b32 s52, 1, s52
    v_mov_b32 v90, s52
    v_mov_b32 v91, 0
    s_mov_b64 exec, 1
    ds_add_u32 v91, v90 offset:276
    s_mov_b64 exec, -1
    s_add_u32 s58, s58, 1
    s_sub_u32 s19, s85, 1
    s_cbranch_scc1 mn_fl1
    s_setpc_b64 s[48:49]
mn_fl1:
    v_cvt_pk_bf16_f32 v104, v104, v105
    v_cvt_pk_bf16_f32 v105, v106, v107
    ds_write_b64 v87, v[104:105] offset:2304
    v_cvt_pk_bf16_f32 v108, v108, v109
    v_cvt_pk_bf16_f32 v109, v110, v111
    ds_write_b64 v87, v[108:109] offset:2880
    v_cvt_pk_bf16_f32 v112, v112, v113
    v_cvt_pk_bf16_f32 v113, v114, v115
    ds_write_b64 v87, v[112:113] offset:3456
    v_cvt_pk_bf16_f32 v116, v116, v117
    v_cvt_pk_bf16_f32 v117, v118, v119
    ds_write_b64 v87, v[116:117] offset:4032
    s_mul_i32 s52, s18, 3
    s_lshl_b32 s52, 64, s52
    v_mov_b32 v106, s52
    v_mov_b32 v107, 0
    s_mov_b64 exec, 1
    ds_add_u32 v107, v106 offset:276
    s_mov_b64 exec, -1
    s_add_u32 s58, s58, 1
    s_sub_u32 s19, s86, 1
    s_cbranch_scc1 mn_fl2
    s_setpc_b64 s[48:49]
mn_fl2:
    v_cvt_pk_bf16_f32 v120, v120, v121
    v_cvt_pk_bf16_f32 v121, v122, v123
    ds_write_b64 v87, v[120:121] offset:4608
    v_cvt_pk_bf16_f32 v124, v124, v125
    v_cvt_pk_bf16_f32 v125, v126, v127
    ds_write_b64 v87, v[124:125] offset:5184
    v_cvt_pk_bf16_f32 v128, v128, v129
    v_cvt_pk_bf16_f32 v129, v130, v131
    ds_write_b64 v87, v[128:129] offset:5760
    v_cvt_pk_bf16_f32 v132, v132, v133
    v_cvt_pk_bf16_f32 v133, v134, v135
    ds_write_b64 v87, v[132:133] offset:6336
    s_mul_i32 s52, s18, 3
    s_lshl_b32 s52, 4096, s52
    v_mov_b32 v122, s52
    v_mov_b32 v123, 0
    s_mov_b64 exec, 1
    ds_add_u32 v123, v122 offset:276
    s_mov_b64 exec, -1
    s_add_u32 s58, s58, 1
    s_sub_u32 s19, s87, 1
    s_cbranch_scc1 mn_fl3
    s_setpc_b64 s[48:49]
mn_fl3:
    v_cvt_pk_bf16_f32 v136, v136, v137
    v_cvt_pk_bf16_f32 v137, v138, v139
    ds_write_b64 v87, v[136:137] offset:6912
    v_cvt_pk_bf16_f32 v140, v140, v141
    v_cvt_pk_bf16_f32 v141, v142, v143
    ds_write_b64 v87, v[140:141] offset:7488
    v_cvt_pk_bf16_f32 v144, v144, v145
    v_cvt_pk_bf16_f32 v145, v146, v147
    ds_write_b64 v87, v[144:145] offset:8064
    v_cvt_pk_bf16_f32 v148, v148, v149
    v_cvt_pk_bf16_f32 v149, v150, v151
    ds_write_b64 v87, v[148:149] offset:8640
    s_mul_i32 s52, s18, 3
    s_lshl_b32 s52, 262144, s52
    v_mov_b32 v138, s52
    v_mov_b32 v139, 0
    s_mov_b64 exec, 1
    ds_add_u32 v139, v138 offset:276
    s_mov_b64 exec, -1
    s_add_u32 s58, s58, 1
    s_sub_u32 s19, s88, 1
    s_cbranch_scc1 mn_fl4
    s_setpc_b64 s[48:49]
mn_fl4:
    s_cmp_ge_u32 s57, 4
    s_cbranch_scc1 mn_fl4b
    s_waitcnt vmcnt(0)
mn_fl4b:
    v_cvt_pk_bf16_f32 v152, v152, v153
    v_cvt_pk_bf16_f32 v153, v154, v155
    ds_write_b64 v87, v[152:153] offset:9216
    v_cvt_pk_bf16_f32 v156, v156, v157
    v_cvt_pk_bf16_f32 v157, v158, v159
    ds_write_b64 v87, v[156:157] offset:9792
    v_cvt_pk_bf16_f32 v160, v160, v161
    v_cvt_pk_bf16_f32 v161, v162, v163
    ds_write_b64 v87, v[160:161] offset:10368
    v_cvt_pk_bf16_f32 v164, v164, v165
    v_cvt_pk_bf16_f32 v165, v166, v167
    ds_write_b64 v87, v[164:165] offset:10944
    s_mul_i32 s52, s18, 3
    s_lshl_b32 s52, 16777216, s52
    v_mov_b32 v154, s52
    v_mov_b32 v155, 0
    s_mov_b64 exec, 1
    ds_add_u32 v155, v154 offset:276
    s_mov_b64 exec, -1
    s_waitcnt vmcnt(0) lgkmcnt(0)
mn_end:
    s_endpgm
gm_main:
    s_load_dwordx2 s[56:57], s[0:1], 64
    s_load_dwordx2 s[26:27], s[0:1], 56
    v_and_b32 v3, 63, v0
    v_bfe_u32 v12, v0, 1, 7
    v_and_b32 v11, 15, v12
    v_lshrrev_b32 v10, 4, v12
    v_lshl_or_b32 v11, v11, 3, v10
    v_cmp_gt_u32 vcc, 125, v11
    v_mul_u32_u24 v13, 51200, v11
    v_bfrev_b32 v10, 2
    v_lshlrev_b32 v12, 6, v12
    v_cndmask_b32 v12, v10, v12, vcc
    v_lshlrev_b32 v2, 4, v3
    s_lshl_b32 s40, s17, 15
    s_add_u32 s40, s40, 11534336
    s_waitcnt lgkmcnt(0)
    s_mov_b32 s8, s54
    s_and_b32 s9, s55, 0xffff
    v_lshrrev_b32 v11, 4, v3
    v_lshlrev_b32 v11, 11, v11
    v_and_b32 v10, 7, v3
    v_lshl_add_u32 v11, v10, 4, v11
    v_and_b32 v10, 8, v3
    v_lshlrev_b32 v10, 10, v10
    s_lshl_b32 s52, s17, 7
    s_add_u32 s52, s52, 114688
    v_add3_u32 v11, v11, v10, s52
    s_mov_b32 s44, 0x05040100
    s_mov_b32 s45, 0x07060302
    v_mov_b32 v5, v11
    s_cmp_ge_u32 s2, 125
    s_cbranch_scc1 gm_wgo
    s_cmp_ge_u32 s16, 10
    s_cbranch_scc1 gm_wsp
    s_cmp_ge_u32 s2, 125
    s_waitcnt vmcnt(0)
    s_cbranch_scc1 gm_wsp
    v_mov_b32 v11, 0
    v_mov_b32 v10, 1
    s_mov_b64 exec, 1
    ds_add_u32 v11, v10 offset:448
    s_mov_b64 exec, -1
gm_dummy:
gm_wsp:
    v_mov_b32 v11, 0
    ds_read_b32 v11, v11 offset:448
    s_waitcnt lgkmcnt(0)
    v_readfirstlane_b32 s62, v11
    s_cmp_ge_u32 s62, 10
    s_cbranch_scc1 gm_wspx
    s_sleep 1
    s_branch gm_wsp
gm_wspx:
    s_cmp_lg_u32 s16, 10
    s_cbranch_scc1 gm_wgo
    s_and_b32 s52, s2, 1
    s_lshl_b32 s53, s52, 7
    s_add_u32 s53, s53, 64
    s_mov_b32 s62, 1
    s_atomic_add s62, s[60:61], s53 glc
    s_sub_u32 s52, 62, s52
    s_add_u32 s28, s54, 11730944
    s_addc_u32 s29, s55, 0
    s_mov_b32 s53, 0x10000
    s_waitcnt lgkmcnt(0)
    s_cmp_lg_u32 s62, s52
    s_cbranch_scc1 gm_wgo
    s_atomic_add s53, s[28:29], 0
    s_atomic_add s53, s[28:29], 128
    s_atomic_add s53, s[28:29], 256
    s_atomic_add s53, s[28:29], 384
    s_atomic_add s53, s[28:29], 512
    s_atomic_add s53, s[28:29], 640
    s_atomic_add s53, s[28:29], 768
    s_atomic_add s53, s[28:29], 896
    s_atomic_add s53, s[28:29], 1024
    s_atomic_add s53, s[28:29], 1152
    s_atomic_add s53, s[28:29], 1280
    s_atomic_add s53, s[28:29], 1408
    s_atomic_add s53, s[28:29], 1536
    s_atomic_add s53, s[28:29], 1664
    s_atomic_add s53, s[28:29], 1792
    s_atomic_add s53, s[28:29], 1920
gm_wgo:
    global_load_dwordx4 v[136:139], v5, s[26:27] offset:0
    global_load_dwordx4 v[140:143], v5, s[26:27] offset:512
    global_load_dwordx4 v[144:147], v5, s[26:27] offset:1024
    global_load_dwordx4 v[148:151], v5, s[26:27] offset:1536
    v_subrev_u32 v5, 0x4000, v5
    global_load_dwordx4 v[120:123], v5, s[26:27] offset:0
    global_load_dwordx4 v[124:127], v5, s[26:27] offset:512
    global_load_dwordx4 v[128:131], v5, s[26:27] offset:1024
    global_load_dwordx4 v[132:135], v5, s[26:27] offset:1536
    v_subrev_u32 v5, 0x4000, v5
    global_load_dwordx4 v[104:107], v5, s[26:27] offset:0
    global_load_dwordx4 v[108:111], v5, s[26:27] offset:512
    global_load_dwordx4 v[112:115], v5, s[26:27] offset:1024
    global_load_dwordx4 v[116:119], v5, s[26:27] offset:1536
    v_subrev_u32 v5, 0x4000, v5
    global_load_dwordx4 v[88:91], v5, s[26:27] offset:0
    global_load_dwordx4 v[92:95], v5, s[26:27] offset:512
    global_load_dwordx4 v[96:99], v5, s[26:27] offset:1024
    global_load_dwordx4 v[100:103], v5, s[26:27] offset:1536
    v_subrev_u32 v5, 0x4000, v5
    global_load_dwordx4 v[72:75], v5, s[26:27] offset:0
    global_load_dwordx4 v[76:79], v5, s[26:27] offset:512
    global_load_dwordx4 v[80:83], v5, s[26:27] offset:1024
    global_load_dwordx4 v[84:87], v5, s[26:27] offset:1536
    v_subrev_u32 v5, 0x4000, v5
    s_cmp_lt_u32 s2, 125
    s_cbranch_scc1 gm_wskip
    global_load_dwordx4 v[56:59], v5, s[26:27] offset:0
    global_load_dwordx4 v[60:63], v5, s[26:27] offset:512
    global_load_dwordx4 v[64:67], v5, s[26:27] offset:1024
    global_load_dwordx4 v[68:71], v5, s[26:27] offset:1536
    v_subrev_u32 v5, 0x4000, v5
    global_load_dwordx4 v[40:43], v5, s[26:27] offset:0
    global_load_dwordx4 v[44:47], v5, s[26:27] offset:512
    global_load_dwordx4 v[48:51], v5, s[26:27] offset:1024
    global_load_dwordx4 v[52:55], v5, s[26:27] offset:1536
    v_subrev_u32 v5, 0x4000, v5
gm_wskip:
    s_mul_i32 s41, s2, 625
    s_add_u32 s52, s41, 640
    s_add_u32 s41, s41, 15
    s_lshr_b32 s41, s41, 4
    s_lshr_b32 s52, s52, 4
    s_mov_b32 s12, s56
    s_and_b32 s13, s57, 0xffff
    s_lshl_b32 s14, s52, 11
    s_mov_b32 s15, 0x20000
    s_mul_i32 s42, s17, 15360
    s_add_u32 s42, s42, 40960
    s_lshl_b32 s43, s17, 1
    s_sub_u32 s43, s43, 1
    v_lshlrev_b32 v6, 2, v3
    v_add_u32 v11, 0, v3
    v_mul_u32_u24 v10, 21846, v11
    v_lshrrev_b32 v10, 16, v10
    v_lshl_add_u32 v34, v10, 2, s42
    v_mad_i32_i24 v10, v10, -3, v11
    v_lshlrev_b32 v30, 4, v10
    v_add_u32 v11, 64, v3
    v_mul_u32_u24 v10, 21846, v11
    v_lshrrev_b32 v10, 16, v10
    v_lshl_add_u32 v35, v10, 2, s42
    v_mad_i32_i24 v10, v10, -3, v11
    v_lshlrev_b32 v31, 4, v10
    v_add_u32 v11, 128, v3
    v_mul_u32_u24 v10, 21846, v11
    v_lshrrev_b32 v10, 16, v10
    v_lshl_add_u32 v36, v10, 2, s42
    v_mad_i32_i24 v10, v10, -3, v11
    v_lshlrev_b32 v32, 4, v10
gm_sp1:
    v_mov_b32 v11, 0
    ds_read_b32 v11, v11 offset:308
    s_waitcnt lgkmcnt(0)
    v_readfirstlane_b32 s62, v11
    s_cmp_ge_u32 s62, 1
    s_cbranch_scc1 gm_sp1x
    s_sleep 1
    s_branch gm_sp1
gm_sp1x:
    buffer_load_dword v4, v12, s[8:11], s22 offen offset:60 sc1
    s_waitcnt vmcnt(0)
gm_pass:
    v_lshrrev_b32 v8, 16, v4
    v_subrev_u32 v8, s24, v8
    v_med3_i32 v8, v8, 0, s20
    v_mov_b32 v9, v8
    v_and_b32 v12, 1, v0
    v_and_b32 v14, 0xffff, v4
    v_add_u32_dpp v9, v9, v9 row_shr:2 row_mask:0xf bank_mask:0xf
    v_add3_u32 v14, v14, v12, s24
    s_nop 0
    v_add_u32_dpp v9, v9, v9 row_shr:4 row_mask:0xf bank_mask:0xf
    v_mad_u32_u24 v14, v14, 40, v13
    s_nop 0
    v_add_u32_dpp v9, v9, v9 row_shr:8 row_mask:0xf bank_mask:0xf
    v_sub_u32 v15, v8, v12
    s_nop 0
    v_add_u32_dpp v9, v9, v9 row_bcast:15 row_mask:0xa bank_mask:0xf
    s_nop 0
    s_nop 0
    v_add_u32_dpp v9, v9, v9 row_bcast:31 row_mask:0xc bank_mask:0xf
    s_nop 0
    s_nop 0
    v_readlane_b32 s47, v9, 63
    v_sub_u32 v16, v9, v15
    v_lshl_add_u32 v16, v16, 2, s42
    v_cmpx_lt_i32 vcc, 0, v15
    s_cbranch_execz gm_tb_done
    ds_write_b32 v16, v14 offset:0
    v_add_u32 v14, 80, v14
    v_cmpx_lt_i32 vcc, 2, v15
    s_cbranch_execz gm_tb_done
    ds_write_b32 v16, v14 offset:8
    v_add_u32 v14, 80, v14
    v_cmpx_lt_i32 vcc, 4, v15
    s_cbranch_execz gm_tb_done
    ds_write_b32 v16, v14 offset:16
    v_add_u32 v14, 80, v14
    v_cmpx_lt_i32 vcc, 6, v15
    s_cbranch_execz gm_tb_done
    ds_write_b32 v16, v14 offset:24
    v_add_u32 v14, 80, v14
    v_cmpx_lt_i32 vcc, 8, v15
    s_cbranch_execz gm_tb_done
    ds_write_b32 v16, v14 offset:32
    v_add_u32 v14, 80, v14
    v_cmpx_lt_i32 vcc, 10, v15
    s_cbranch_execz gm_tb_done
    ds_write_b32 v16, v14 offset:40
    v_add_u32 v14, 80, v14
    v_cmpx_lt_i32 vcc, 12, v15
    s_cbranch_execz gm_tb_done
    ds_write_b32 v16, v14 offset:48
    v_add_u32 v14, 80, v14
    v_cmpx_lt_i32 vcc, 14, v15
    s_cbranch_execz gm_tb_done
    ds_write_b32 v16, v14 offset:56
    v_add_u32 v14, 80, v14
    v_cmpx_lt_i32 vcc, 16, v15
    s_cbranch_execz gm_tb_done
    ds_write_b32 v16, v14 offset:64
    v_add_u32 v14, 80, v14
    v_cmpx_lt_i32 vcc, 18, v15
    s_cbranch_execz gm_tb_done
    ds_write_b32 v16, v14 offset:72
gm_tb_done:
    s_mov_b64 exec, -1
    s_mul_i32 s47, s47, 3
    v_mov_b32 v17, 0
    ds_read_b32 v18, v34 offset:0
    ds_read_b32 v19, v35 offset:0
    ds_read_b32 v20, v36 offset:0
    ds_read_b32 v21, v34 offset:256
    ds_read_b32 v22, v35 offset:256
    ds_read_b32 v23, v36 offset:256
    ds_read_b32 v24, v34 offset:512
    ds_read_b32 v25, v35 offset:512
    ds_read_b32 v26, v36 offset:512
    ds_read_b32 v29, v17 offset:456
    s_and_b32 s62, s2, 15
    s_lshl_b32 s62, s62, 7
    s_add_u32 s62, s62, 11730944
    v_mov_b32 v28, s62
    global_load_dword v27, v28, s[54:55] sc1
    s_barrier
    ds_read_b32 v15, v6 offset:384
    ds_read_b32 v17, v17 offset:272
    v_mov_b32 v11, v34
    v_mov_b32 v10, v35
    v_mov_b32 v14, v36
    s_waitcnt lgkmcnt(1)
    v_add_u32_dpp v15, v15, v15 row_shr:1 row_mask:0xf bank_mask:0xf
    s_nop 1
    v_add_u32_dpp v15, v15, v15 row_shr:2 row_mask:0xf bank_mask:0xf
    s_nop 1
    v_add_u32_dpp v15, v15, v15 row_shr:4 row_mask:0xf bank_mask:0xf
    s_waitcnt lgkmcnt(0)
    v_readfirstlane_b32 s21, v17
    v_readlane_b32 s23, v15, 7
    v_readlane_b32 s46, v15, s43
    s_cmp_gt_u32 s23, 773
    s_cbranch_scc1 gm_ovf
    s_cmp_eq_u32 s17, 0
    s_cmov_b32 s46, 0
    s_mul_i32 s46, s46, 48
    s_add_u32 m0, s46, 3776
    v_add_u32 v18, v18, v30
    v_add_u32 v19, v19, v31
    v_add_u32 v20, v20, v32
    v_add_u32 v21, v21, v30
    v_add_u32 v22, v22, v31
    v_add_u32 v23, v23, v32
    v_add_u32 v24, v24, v30
    v_add_u32 v25, v25, v31
    v_add_u32 v26, v26, v32
    s_mov_b32 s63, 0x100000
gm_ep:
    s_waitcnt vmcnt(0)
    v_sub_u32 v27, v27, v29
    v_lshrrev_b32 v27, 16, v27
    v_cmp_eq_u32 vcc, 2, v27
    s_cbranch_vccnz gm_go2
    s_and_b32 s62, s63, 31
    s_sub_u32 s63, s63, 1
    s_cmp_eq_u32 s62, 1
    s_cbranch_scc1 gm_epd
    s_sleep 6
    global_load_dword v27, v28, s[54:55] sc1
    s_branch gm_ep
gm_epd:
    s_and_b32 s62, s2, 15
    s_lshl_b32 s62, s62, 7
    s_add_u32 s62, s62, 11730944
    v_mov_b32 v27, s62
    v_lshlrev_b32 v28, 6, v0
    v_and_b32 v28, 0xc0, v28
    s_mov_b32 s63, 0x100000
mn_poll2dem:
    s_sub_u32 s63, s63, 1
    s_cbranch_scc1 mn_poll2dex
    global_load_dword v29, v28, s[60:61] sc1
    s_waitcnt vmcnt(0)
    v_add_u32_dpp v29, v29, v29 quad_perm:[2,3,0,1] row_mask:0xf bank_mask:0xf
    s_sleep 8
    v_readlane_b32 s62, v29, 1
    s_cmp_lt_u32 s62, 125
    s_cbranch_scc1 mn_poll2dem
mn_poll2dex:
gm_go2:
    v_cmpx_gt_i32 vcc, s47, v3
    s_cbranch_execz gm_raw_done
    buffer_load_dwordx4 v18, s[8:11], 0 offen sc1 lds
    s_add_u32 m0, m0, 1024
    s_sub_i32 s47, s47, 64
    v_cmpx_gt_i32 vcc, s47, v3
    s_cbranch_execz gm_raw_done
    buffer_load_dwordx4 v19, s[8:11], 0 offen sc1 lds
    s_add_u32 m0, m0, 1024
    s_sub_i32 s47, s47, 64
    v_cmpx_gt_i32 vcc, s47, v3
    s_cbranch_execz gm_raw_done
    buffer_load_dwordx4 v20, s[8:11], 0 offen sc1 lds
    s_add_u32 m0, m0, 1024
    s_sub_i32 s47, s47, 64
    v_cmpx_gt_i32 vcc, s47, v3
    s_cbranch_execz gm_raw_done
    buffer_load_dwordx4 v21, s[8:11], 0 offen sc1 lds
    s_add_u32 m0, m0, 1024
    s_sub_i32 s47, s47, 64
    v_cmpx_gt_i32 vcc, s47, v3
    s_cbranch_execz gm_raw_done
    buffer_load_dwordx4 v22, s[8:11], 0 offen sc1 lds
    s_add_u32 m0, m0, 1024
    s_sub_i32 s47, s47, 64
    v_cmpx_gt_i32 vcc, s47, v3
    s_cbranch_execz gm_raw_done
    buffer_load_dwordx4 v23, s[8:11], 0 offen sc1 lds
    s_add_u32 m0, m0, 1024
    s_sub_i32 s47, s47, 64
    v_cmpx_gt_i32 vcc, s47, v3
    s_cbranch_execz gm_raw_done
    buffer_load_dwordx4 v24, s[8:11], 0 offen sc1 lds
    s_add_u32 m0, m0, 1024
    s_sub_i32 s47, s47, 64
    v_cmpx_gt_i32 vcc, s47, v3
    s_cbranch_execz gm_raw_done
    buffer_load_dwordx4 v25, s[8:11], 0 offen sc1 lds
    s_add_u32 m0, m0, 1024
    s_sub_i32 s47, s47, 64
    v_cmpx_gt_i32 vcc, s47, v3
    s_cbranch_execz gm_raw_done
    buffer_load_dwordx4 v26, s[8:11], 0 offen sc1 lds
    s_add_u32 m0, m0, 1024
    s_sub_i32 s47, s47, 64
    v_add_u32 v11, 768, v11
    v_add_u32 v10, 768, v10
    v_add_u32 v14, 768, v14
gm_raw:
    ds_read_b32 v18, v11 offset:0
    ds_read_b32 v19, v10 offset:0
    ds_read_b32 v20, v14 offset:0
    ds_read_b32 v21, v11 offset:256
    ds_read_b32 v22, v10 offset:256
    ds_read_b32 v23, v14 offset:256
    ds_read_b32 v24, v11 offset:512
    ds_read_b32 v25, v10 offset:512
    ds_read_b32 v26, v14 offset:512
    v_cmpx_gt_i32 vcc, s47, v3
    s_cbranch_execz gm_raw_done
    s_waitcnt lgkmcnt(8)
    v_add_u32 v18, v18, v30
    buffer_load_dwordx4 v18, s[8:11], 0 offen sc1 lds
    s_add_u32 m0, m0, 1024
    s_sub_i32 s47, s47, 64
    v_cmpx_gt_i32 vcc, s47, v3
    s_cbranch_execz gm_raw_done
    s_waitcnt lgkmcnt(7)
    v_add_u32 v19, v19, v31
    buffer_load_dwordx4 v19, s[8:11], 0 offen sc1 lds
    s_add_u32 m0, m0, 1024
    s_sub_i32 s47, s47, 64
    v_cmpx_gt_i32 vcc, s47, v3
    s_cbranch_execz gm_raw_done
    s_waitcnt lgkmcnt(6)
    v_add_u32 v20, v20, v32
    buffer_load_dwordx4 v20, s[8:11], 0 offen sc1 lds
    s_add_u32 m0, m0, 1024
    s_sub_i32 s47, s47, 64
    v_cmpx_gt_i32 vcc, s47, v3
    s_cbranch_execz gm_raw_done
    s_waitcnt lgkmcnt(5)
    v_add_u32 v21, v21, v30
    buffer_load_dwordx4 v21, s[8:11], 0 offen sc1 lds
    s_add_u32 m0, m0, 1024
    s_sub_i32 s47, s47, 64
    v_cmpx_gt_i32 vcc, s47, v3
    s_cbranch_execz gm_raw_done
    s_waitcnt lgkmcnt(4)
    v_add_u32 v22, v22, v31
    buffer_load_dwordx4 v22, s[8:11], 0 offen sc1 lds
    s_add_u32 m0, m0, 1024
    s_sub_i32 s47, s47, 64
    v_cmpx_gt_i32 vcc, s47, v3
    s_cbranch_execz gm_raw_done
    s_waitcnt lgkmcnt(3)
    v_add_u32 v23, v23, v32
    buffer_load_dwordx4 v23, s[8:11], 0 offen sc1 lds
    s_add_u32 m0, m0, 1024
    s_sub_i32 s47, s47, 64
    v_cmpx_gt_i32 vcc, s47, v3
    s_cbranch_execz gm_raw_done
    s_waitcnt lgkmcnt(2)
    v_add_u32 v24, v24, v30
    buffer_load_dwordx4 v24, s[8:11], 0 offen sc1 lds
    s_add_u32 m0, m0, 1024
    s_sub_i32 s47, s47, 64
    v_cmpx_gt_i32 vcc, s47, v3
    s_cbranch_execz gm_raw_done
    s_waitcnt lgkmcnt(1)
    v_add_u32 v25, v25, v31
    buffer_load_dwordx4 v25, s[8:11], 0 offen sc1 lds
    s_add_u32 m0, m0, 1024
    s_sub_i32 s47, s47, 64
    v_cmpx_gt_i32 vcc, s47, v3
    s_cbranch_execz gm_raw_done
    s_waitcnt lgkmcnt(0)
    v_add_u32 v26, v26, v32
    buffer_load_dwordx4 v26, s[8:11], 0 offen sc1 lds
    s_add_u32 m0, m0, 1024
    s_sub_i32 s47, s47, 64
    v_add_u32 v11, 768, v11
    v_add_u32 v10, 768, v10
    v_add_u32 v14, 768, v14
    s_branch gm_raw
gm_raw_done:
    s_mov_b64 exec, -1
    s_barrier
    s_waitcnt vmcnt(0) lgkmcnt(0)
    s_barrier
    s_cmp_lg_u32 s21, 0
    s_cbranch_scc1 gm_next
    s_cmp_ge_u32 s2, 125
    s_cbranch_scc1 gm_wdone
    global_load_dwordx4 v[56:59], v5, s[26:27] offset:0
    global_load_dwordx4 v[60:63], v5, s[26:27] offset:512
    global_load_dwordx4 v[64:67], v5, s[26:27] offset:1024
    global_load_dwordx4 v[68:71], v5, s[26:27] offset:1536
    v_subrev_u32 v5, 0x4000, v5
    s_waitcnt vmcnt(0)
    global_load_dwordx4 v[40:43], v5, s[26:27] offset:0
    global_load_dwordx4 v[44:47], v5, s[26:27] offset:512
    global_load_dwordx4 v[48:51], v5, s[26:27] offset:1024
    global_load_dwordx4 v[52:55], v5, s[26:27] offset:1536
    v_subrev_u32 v5, 0x4000, v5
    s_waitcnt vmcnt(0)
gm_wdone:
    global_load_dwordx4 v[24:27], v5, s[26:27] offset:0
    global_load_dwordx4 v[28:31], v5, s[26:27] offset:512
    global_load_dwordx4 v[32:35], v5, s[26:27] offset:1024
    global_load_dwordx4 v[36:39], v5, s[26:27] offset:1536
    v_mov_b32_dpp v152, v138 row_ror:8 row_mask:0xf bank_mask:0xf
    v_mov_b32_dpp v153, v139 row_ror:8 row_mask:0xf bank_mask:0xf
    v_mov_b32_dpp v154, v142 row_ror:8 row_mask:0xf bank_mask:0xf
    v_mov_b32_dpp v155, v143 row_ror:8 row_mask:0xf bank_mask:0xf
    v_mov_b32_dpp v156, v146 row_ror:8 row_mask:0xf bank_mask:0xf
    v_mov_b32_dpp v157, v147 row_ror:8 row_mask:0xf bank_mask:0xf
    v_mov_b32_dpp v158, v150 row_ror:8 row_mask:0xf bank_mask:0xf
    v_mov_b32_dpp v159, v151 row_ror:8 row_mask:0xf bank_mask:0xf
    v_mov_b32_dpp v138, v136 row_ror:8 row_mask:0xf bank_mask:0x3
    v_mov_b32_dpp v139, v137 row_ror:8 row_mask:0xf bank_mask:0x3
    v_mov_b32_dpp v142, v140 row_ror:8 row_mask:0xf bank_mask:0x3
    v_mov_b32_dpp v143, v141 row_ror:8 row_mask:0xf bank_mask:0x3
    v_mov_b32_dpp v146, v144 row_ror:8 row_mask:0xf bank_mask:0x3
    v_mov_b32_dpp v147, v145 row_ror:8 row_mask:0xf bank_mask:0x3
    v_mov_b32_dpp v150, v148 row_ror:8 row_mask:0xf bank_mask:0x3
    v_mov_b32_dpp v151, v149 row_ror:8 row_mask:0xf bank_mask:0x3
    v_mov_b32_dpp v136, v152 quad_perm:[0,1,2,3] row_mask:0xf bank_mask:0xc
    v_mov_b32_dpp v137, v153 quad_perm:[0,1,2,3] row_mask:0xf bank_mask:0xc
    v_mov_b32_dpp v140, v154 quad_perm:[0,1,2,3] row_mask:0xf bank_mask:0xc
    v_mov_b32_dpp v141, v155 quad_perm:[0,1,2,3] row_mask:0xf bank_mask:0xc
    v_mov_b32_dpp v144, v156 quad_perm:[0,1,2,3] row_mask:0xf bank_mask:0xc
    v_mov_b32_dpp v145, v157 quad_perm:[0,1,2,3] row_mask:0xf bank_mask:0xc
    v_mov_b32_dpp v148, v158 quad_perm:[0,1,2,3] row_mask:0xf bank_mask:0xc
    v_mov_b32_dpp v149, v159 quad_perm:[0,1,2,3] row_mask:0xf bank_mask:0xc
    v_perm_b32 v152, v140, v136, s44
    v_perm_b32 v153, v148, v144, s44
    v_perm_b32 v154, v142, v138, s44
    v_perm_b32 v155, v150, v146, s44
    v_perm_b32 v156, v140, v136, s45
    v_perm_b32 v157, v148, v144, s45
    v_perm_b32 v158, v142, v138, s45
    v_perm_b32 v159, v150, v146, s45
    v_perm_b32 v160, v141, v137, s44
    v_perm_b32 v161, v149, v145, s44
    v_perm_b32 v162, v143, v139, s44
    v_perm_b32 v163, v151, v147, s44
    v_perm_b32 v164, v141, v137, s45
    v_perm_b32 v165, v149, v145, s45
    v_perm_b32 v166, v143, v139, s45
    v_perm_b32 v167, v151, v147, s45
    v_mov_b32_dpp v136, v122 row_ror:8 row_mask:0xf bank_mask:0xf
    v_mov_b32_dpp v137, v123 row_ror:8 row_mask:0xf bank_mask:0xf
    v_mov_b32_dpp v138, v126 row_ror:8 row_mask:0xf bank_mask:0xf
    v_mov_b32_dpp v139, v127 row_ror:8 row_mask:0xf bank_mask:0xf
    v_mov_b32_dpp v140, v130 row_ror:8 row_mask:0xf bank_mask:0xf
    v_mov_b32_dpp v141, v131 row_ror:8 row_mask:0xf bank_mask:0xf
    v_mov_b32_dpp v142, v134 row_ror:8 row_mask:0xf bank_mask:0xf
    v_mov_b32_dpp v143, v135 row_ror:8 row_mask:0xf bank_mask:0xf
    v_mov_b32_dpp v122, v120 row_ror:8 row_mask:0xf bank_mask:0x3
    v_mov_b32_dpp v123, v121 row_ror:8 row_mask:0xf bank_mask:0x3
    v_mov_b32_dpp v126, v124 row_ror:8 row_mask:0xf bank_mask:0x3
    v_mov_b32_dpp v127, v125 row_ror:8 row_mask:0xf bank_mask:0x3
    v_mov_b32_dpp v130, v128 row_ror:8 row_mask:0xf bank_mask:0x3
    v_mov_b32_dpp v131, v129 row_ror:8 row_mask:0xf bank_mask:0x3
    v_mov_b32_dpp v134, v132 row_ror:8 row_mask:0xf bank_mask:0x3
    v_mov_b32_dpp v135, v133 row_ror:8 row_mask:0xf bank_mask:0x3
    v_mov_b32_dpp v120, v136 quad_perm:[0,1,2,3] row_mask:0xf bank_mask:0xc
    v_mov_b32_dpp v121, v137 quad_perm:[0,1,2,3] row_mask:0xf bank_mask:0xc
    v_mov_b32_dpp v124, v138 quad_perm:[0,1,2,3] row_mask:0xf bank_mask:0xc
    v_mov_b32_dpp v125, v139 quad_perm:[0,1,2,3] row_mask:0xf bank_mask:0xc
    v_mov_b32_dpp v128, v140 quad_perm:[0,1,2,3] row_mask:0xf bank_mask:0xc
    v_mov_b32_dpp v129, v141 quad_perm:[0,1,2,3] row_mask:0xf bank_mask:0xc
    v_mov_b32_dpp v132, v142 quad_perm:[0,1,2,3] row_mask:0xf bank_mask:0xc
    v_mov_b32_dpp v133, v143 quad_perm:[0,1,2,3] row_mask:0xf bank_mask:0xc
    v_perm_b32 v136, v124, v120, s44
    v_perm_b32 v137, v132, v128, s44
    v_perm_b32 v138, v126, v122, s44
    v_perm_b32 v139, v134, v130, s44
    v_perm_b32 v140, v124, v120, s45
    v_perm_b32 v141, v132, v128, s45
    v_perm_b32 v142, v126, v122, s45
    v_perm_b32 v143, v134, v130, s45
    v_perm_b32 v144, v125, v121, s44
    v_perm_b32 v145, v133, v129, s44
    v_perm_b32 v146, v127, v123, s44
    v_perm_b32 v147, v135, v131, s44
    v_perm_b32 v148, v125, v121, s45
    v_perm_b32 v149, v133, v129, s45
    v_perm_b32 v150, v127, v123, s45
    v_perm_b32 v151, v135, v131, s45
    v_mov_b32_dpp v120, v106 row_ror:8 row_mask:0xf bank_mask:0xf
    v_mov_b32_dpp v121, v107 row_ror:8 row_mask:0xf bank_mask:0xf
    v_mov_b32_dpp v122, v110 row_ror:8 row_mask:0xf bank_mask:0xf
    v_mov_b32_dpp v123, v111 row_ror:8 row_mask:0xf bank_mask:0xf
    v_mov_b32_dpp v124, v114 row_ror:8 row_mask:0xf bank_mask:0xf
    v_mov_b32_dpp v125, v115 row_ror:8 row_mask:0xf bank_mask:0xf
    v_mov_b32_dpp v126, v118 row_ror:8 row_mask:0xf bank_mask:0xf
    v_mov_b32_dpp v127, v119 row_ror:8 row_mask:0xf bank_mask:0xf
    v_mov_b32_dpp v106, v104 row_ror:8 row_mask:0xf bank_mask:0x3
    v_mov_b32_dpp v107, v105 row_ror:8 row_mask:0xf bank_mask:0x3
    v_mov_b32_dpp v110, v108 row_ror:8 row_mask:0xf bank_mask:0x3
    v_mov_b32_dpp v111, v109 row_ror:8 row_mask:0xf bank_mask:0x3
    v_mov_b32_dpp v114, v112 row_ror:8 row_mask:0xf bank_mask:0x3
    v_mov_b32_dpp v115, v113 row_ror:8 row_mask:0xf bank_mask:0x3
    v_mov_b32_dpp v118, v116 row_ror:8 row_mask:0xf bank_mask:0x3
    v_mov_b32_dpp v119, v117 row_ror:8 row_mask:0xf bank_mask:0x3
    v_mov_b32_dpp v104, v120 quad_perm:[0,1,2,3] row_mask:0xf bank_mask:0xc
    v_mov_b32_dpp v105, v121 quad_perm:[0,1,2,3] row_mask:0xf bank_mask:0xc
    v_mov_b32_dpp v108, v122 quad_perm:[0,1,2,3] row_mask:0xf bank_mask:0xc
    v_mov_b32_dpp v109, v123 quad_perm:[0,1,2,3] row_mask:0xf bank_mask:0xc
    v_mov_b32_dpp v112, v124 quad_perm:[0,1,2,3] row_mask:0xf bank_mask:0xc
    v_mov_b32_dpp v113, v125 quad_perm:[0,1,2,3] row_mask:0xf bank_mask:0xc
    v_mov_b32_dpp v116, v126 quad_perm:[0,1,2,3] row_mask:0xf bank_mask:0xc
    v_mov_b32_dpp v117, v127 quad_perm:[0,1,2,3] row_mask:0xf bank_mask:0xc
    v_perm_b32 v120, v108, v104, s44
    v_perm_b32 v121, v116, v112, s44
    v_perm_b32 v122, v110, v106, s44
    v_perm_b32 v123, v118, v114, s44
    v_perm_b32 v124, v108, v104, s45
    v_perm_b32 v125, v116, v112, s45
    v_perm_b32 v126, v110, v106, s45
    v_perm_b32 v127, v118, v114, s45
    v_perm_b32 v128, v109, v105, s44
    v_perm_b32 v129, v117, v113, s44
    v_perm_b32 v130, v111, v107, s44
    v_perm_b32 v131, v119, v115, s44
    v_perm_b32 v132, v109, v105, s45
    v_perm_b32 v133, v117, v113, s45
    v_perm_b32 v134, v111, v107, s45
    v_perm_b32 v135, v119, v115, s45
    v_mov_b32_dpp v104, v90 row_ror:8 row_mask:0xf bank_mask:0xf
    v_mov_b32_dpp v105, v91 row_ror:8 row_mask:0xf bank_mask:0xf
    v_mov_b32_dpp v106, v94 row_ror:8 row_mask:0xf bank_mask:0xf
    v_mov_b32_dpp v107, v95 row_ror:8 row_mask:0xf bank_mask:0xf
    v_mov_b32_dpp v108, v98 row_ror:8 row_mask:0xf bank_mask:0xf
    v_mov_b32_dpp v109, v99 row_ror:8 row_mask:0xf bank_mask:0xf
    v_mov_b32_dpp v110, v102 row_ror:8 row_mask:0xf bank_mask:0xf
    v_mov_b32_dpp v111, v103 row_ror:8 row_mask:0xf bank_mask:0xf
    v_mov_b32_dpp v90, v88 row_ror:8 row_mask:0xf bank_mask:0x3
    v_mov_b32_dpp v91, v89 row_ror:8 row_mask:0xf bank_mask:0x3
    v_mov_b32_dpp v94, v92 row_ror:8 row_mask:0xf bank_mask:0x3
    v_mov_b32_dpp v95, v93 row_ror:8 row_mask:0xf bank_mask:0x3
    v_mov_b32_dpp v98, v96 row_ror:8 row_mask:0xf bank_mask:0x3
    v_mov_b32_dpp v99, v97 row_ror:8 row_mask:0xf bank_mask:0x3
    v_mov_b32_dpp v102, v100 row_ror:8 row_mask:0xf bank_mask:0x3
    v_mov_b32_dpp v103, v101 row_ror:8 row_mask:0xf bank_mask:0x3
    v_mov_b32_dpp v88, v104 quad_perm:[0,1,2,3] row_mask:0xf bank_mask:0xc
    v_mov_b32_dpp v89, v105 quad_perm:[0,1,2,3] row_mask:0xf bank_mask:0xc
    v_mov_b32_dpp v92, v106 quad_perm:[0,1,2,3] row_mask:0xf bank_mask:0xc
    v_mov_b32_dpp v93, v107 quad_perm:[0,1,2,3] row_mask:0xf bank_mask:0xc
    v_mov_b32_dpp v96, v108 quad_perm:[0,1,2,3] row_mask:0xf bank_mask:0xc
    v_mov_b32_dpp v97, v109 quad_perm:[0,1,2,3] row_mask:0xf bank_mask:0xc
    v_mov_b32_dpp v100, v110 quad_perm:[0,1,2,3] row_mask:0xf bank_mask:0xc
    v_mov_b32_dpp v101, v111 quad_perm:[0,1,2,3] row_mask:0xf bank_mask:0xc
    v_perm_b32 v104, v92, v88, s44
    v_perm_b32 v105, v100, v96, s44
    v_perm_b32 v106, v94, v90, s44
    v_perm_b32 v107, v102, v98, s44
    v_perm_b32 v108, v92, v88, s45
    v_perm_b32 v109, v100, v96, s45
    v_perm_b32 v110, v94, v90, s45
    v_perm_b32 v111, v102, v98, s45
    v_perm_b32 v112, v93, v89, s44
    v_perm_b32 v113, v101, v97, s44
    v_perm_b32 v114, v95, v91, s44
    v_perm_b32 v115, v103, v99, s44
    v_perm_b32 v116, v93, v89, s45
    v_perm_b32 v117, v101, v97, s45
    v_perm_b32 v118, v95, v91, s45
    v_perm_b32 v119, v103, v99, s45
    v_mov_b32_dpp v88, v74 row_ror:8 row_mask:0xf bank_mask:0xf
    v_mov_b32_dpp v89, v75 row_ror:8 row_mask:0xf bank_mask:0xf
    v_mov_b32_dpp v90, v78 row_ror:8 row_mask:0xf bank_mask:0xf
    v_mov_b32_dpp v91, v79 row_ror:8 row_mask:0xf bank_mask:0xf
    v_mov_b32_dpp v92, v82 row_ror:8 row_mask:0xf bank_mask:0xf
    v_mov_b32_dpp v93, v83 row_ror:8 row_mask:0xf bank_mask:0xf
    v_mov_b32_dpp v94, v86 row_ror:8 row_mask:0xf bank_mask:0xf
    v_mov_b32_dpp v95, v87 row_ror:8 row_mask:0xf bank_mask:0xf
    v_mov_b32_dpp v74, v72 row_ror:8 row_mask:0xf bank_mask:0x3
    v_mov_b32_dpp v75, v73 row_ror:8 row_mask:0xf bank_mask:0x3
    v_mov_b32_dpp v78, v76 row_ror:8 row_mask:0xf bank_mask:0x3
    v_mov_b32_dpp v79, v77 row_ror:8 row_mask:0xf bank_mask:0x3
    v_mov_b32_dpp v82, v80 row_ror:8 row_mask:0xf bank_mask:0x3
    v_mov_b32_dpp v83, v81 row_ror:8 row_mask:0xf bank_mask:0x3
    v_mov_b32_dpp v86, v84 row_ror:8 row_mask:0xf bank_mask:0x3
    v_mov_b32_dpp v87, v85 row_ror:8 row_mask:0xf bank_mask:0x3
    v_mov_b32_dpp v72, v88 quad_perm:[0,1,2,3] row_mask:0xf bank_mask:0xc
    v_mov_b32_dpp v73, v89 quad_perm:[0,1,2,3] row_mask:0xf bank_mask:0xc
    v_mov_b32_dpp v76, v90 quad_perm:[0,1,2,3] row_mask:0xf bank_mask:0xc
    v_mov_b32_dpp v77, v91 quad_perm:[0,1,2,3] row_mask:0xf bank_mask:0xc
    v_mov_b32_dpp v80, v92 quad_perm:[0,1,2,3] row_mask:0xf bank_mask:0xc
    v_mov_b32_dpp v81, v93 quad_perm:[0,1,2,3] row_mask:0xf bank_mask:0xc
    v_mov_b32_dpp v84, v94 quad_perm:[0,1,2,3] row_mask:0xf bank_mask:0xc
    v_mov_b32_dpp v85, v95 quad_perm:[0,1,2,3] row_mask:0xf bank_mask:0xc
    v_perm_b32 v88, v76, v72, s44
    v_perm_b32 v89, v84, v80, s44
    v_perm_b32 v90, v78, v74, s44
    v_perm_b32 v91, v86, v82, s44
    v_perm_b32 v92, v76, v72, s45
    v_perm_b32 v93, v84, v80, s45
    v_perm_b32 v94, v78, v74, s45
    v_perm_b32 v95, v86, v82, s45
    v_perm_b32 v96, v77, v73, s44
    v_perm_b32 v97, v85, v81, s44
    v_perm_b32 v98, v79, v75, s44
    v_perm_b32 v99, v87, v83, s44
    v_perm_b32 v100, v77, v73, s45
    v_perm_b32 v101, v85, v81, s45
    v_perm_b32 v102, v79, v75, s45
    v_perm_b32 v103, v87, v83, s45
    v_mov_b32_dpp v72, v58 row_ror:8 row_mask:0xf bank_mask:0xf
    v_mov_b32_dpp v73, v59 row_ror:8 row_mask:0xf bank_mask:0xf
    v_mov_b32_dpp v74, v62 row_ror:8 row_mask:0xf bank_mask:0xf
    v_mov_b32_dpp v75, v63 row_ror:8 row_mask:0xf bank_mask:0xf
    v_mov_b32_dpp v76, v66 row_ror:8 row_mask:0xf bank_mask:0xf
    v_mov_b32_dpp v77, v67 row_ror:8 row_mask:0xf bank_mask:0xf
    v_mov_b32_dpp v78, v70 row_ror:8 row_mask:0xf bank_mask:0xf
    v_mov_b32_dpp v79, v71 row_ror:8 row_mask:0xf bank_mask:0xf
    v_mov_b32_dpp v58, v56 row_ror:8 row_mask:0xf bank_mask:0x3
    v_mov_b32_dpp v59, v57 row_ror:8 row_mask:0xf bank_mask:0x3
    v_mov_b32_dpp v62, v60 row_ror:8 row_mask:0xf bank_mask:0x3
    v_mov_b32_dpp v63, v61 row_ror:8 row_mask:0xf bank_mask:0x3
    v_mov_b32_dpp v66, v64 row_ror:8 row_mask:0xf bank_mask:0x3
    v_mov_b32_dpp v67, v65 row_ror:8 row_mask:0xf bank_mask:0x3
    v_mov_b32_dpp v70, v68 row_ror:8 row_mask:0xf bank_mask:0x3
    v_mov_b32_dpp v71, v69 row_ror:8 row_mask:0xf bank_mask:0x3
    v_mov_b32_dpp v56, v72 quad_perm:[0,1,2,3] row_mask:0xf bank_mask:0xc
    v_mov_b32_dpp v57, v73 quad_perm:[0,1,2,3] row_mask:0xf bank_mask:0xc
    v_mov_b32_dpp v60, v74 quad_perm:[0,1,2,3] row_mask:0xf bank_mask:0xc
    v_mov_b32_dpp v61, v75 quad_perm:[0,1,2,3] row_mask:0xf bank_mask:0xc
    v_mov_b32_dpp v64, v76 quad_perm:[0,1,2,3] row_mask:0xf bank_mask:0xc
    v_mov_b32_dpp v65, v77 quad_perm:[0,1,2,3] row_mask:0xf bank_mask:0xc
    v_mov_b32_dpp v68, v78 quad_perm:[0,1,2,3] row_mask:0xf bank_mask:0xc
    v_mov_b32_dpp v69, v79 quad_perm:[0,1,2,3] row_mask:0xf bank_mask:0xc
    v_perm_b32 v72, v60, v56, s44
    v_perm_b32 v73, v68, v64, s44
    v_perm_b32 v74, v62, v58, s44
    v_perm_b32 v75, v70, v66, s44
    v_perm_b32 v76, v60, v56, s45
    v_perm_b32 v77, v68, v64, s45
    v_perm_b32 v78, v62, v58, s45
    v_perm_b32 v79, v70, v66, s45
    v_perm_b32 v80, v61, v57, s44
    v_perm_b32 v81, v69, v65, s44
    v_perm_b32 v82, v63, v59, s44
    v_perm_b32 v83, v71, v67, s44
    v_perm_b32 v84, v61, v57, s45
    v_perm_b32 v85, v69, v65, s45
    v_perm_b32 v86, v63, v59, s45
    v_perm_b32 v87, v71, v67, s45
    v_mov_b32_dpp v56, v42 row_ror:8 row_mask:0xf bank_mask:0xf
    v_mov_b32_dpp v57, v43 row_ror:8 row_mask:0xf bank_mask:0xf
    v_mov_b32_dpp v58, v46 row_ror:8 row_mask:0xf bank_mask:0xf
    v_mov_b32_dpp v59, v47 row_ror:8 row_mask:0xf bank_mask:0xf
    v_mov_b32_dpp v60, v50 row_ror:8 row_mask:0xf bank_mask:0xf
    v_mov_b32_dpp v61, v51 row_ror:8 row_mask:0xf bank_mask:0xf
    v_mov_b32_dpp v62, v54 row_ror:8 row_mask:0xf bank_mask:0xf
    v_mov_b32_dpp v63, v55 row_ror:8 row_mask:0xf bank_mask:0xf
    v_mov_b32_dpp v42, v40 row_ror:8 row_mask:0xf bank_mask:0x3
    v_mov_b32_dpp v43, v41 row_ror:8 row_mask:0xf bank_mask:0x3
    v_mov_b32_dpp v46, v44 row_ror:8 row_mask:0xf bank_mask:0x3
    v_mov_b32_dpp v47, v45 row_ror:8 row_mask:0xf bank_mask:0x3
    v_mov_b32_dpp v50, v48 row_ror:8 row_mask:0xf bank_mask:0x3
    v_mov_b32_dpp v51, v49 row_ror:8 row_mask:0xf bank_mask:0x3
    v_mov_b32_dpp v54, v52 row_ror:8 row_mask:0xf bank_mask:0x3
    v_mov_b32_dpp v55, v53 row_ror:8 row_mask:0xf bank_mask:0x3
    v_mov_b32_dpp v40, v56 quad_perm:[0,1,2,3] row_mask:0xf bank_mask:0xc
    v_mov_b32_dpp v41, v57 quad_perm:[0,1,2,3] row_mask:0xf bank_mask:0xc
    v_mov_b32_dpp v44, v58 quad_perm:[0,1,2,3] row_mask:0xf bank_mask:0xc
    v_mov_b32_dpp v45, v59 quad_perm:[0,1,2,3] row_mask:0xf bank_mask:0xc
    v_mov_b32_dpp v48, v60 quad_perm:[0,1,2,3] row_mask:0xf bank_mask:0xc
    v_mov_b32_dpp v49, v61 quad_perm:[0,1,2,3] row_mask:0xf bank_mask:0xc
    v_mov_b32_dpp v52, v62 quad_perm:[0,1,2,3] row_mask:0xf bank_mask:0xc
    v_mov_b32_dpp v53, v63 quad_perm:[0,1,2,3] row_mask:0xf bank_mask:0xc
    v_perm_b32 v56, v44, v40, s44
    v_perm_b32 v57, v52, v48, s44
    v_perm_b32 v58, v46, v42, s44
    v_perm_b32 v59, v54, v50, s44
    v_perm_b32 v60, v44, v40, s45
    v_perm_b32 v61, v52, v48, s45
    v_perm_b32 v62, v46, v42, s45
    v_perm_b32 v63, v54, v50, s45
    v_perm_b32 v64, v45, v41, s44
    v_perm_b32 v65, v53, v49, s44
    v_perm_b32 v66, v47, v43, s44
    v_perm_b32 v67, v55, v51, s44
    v_perm_b32 v68, v45, v41, s45
    v_perm_b32 v69, v53, v49, s45
    v_perm_b32 v70, v47, v43, s45
    v_perm_b32 v71, v55, v51, s45
    s_waitcnt vmcnt(0)
    v_mov_b32_dpp v40, v26 row_ror:8 row_mask:0xf bank_mask:0xf
    v_mov_b32_dpp v41, v27 row_ror:8 row_mask:0xf bank_mask:0xf
    v_mov_b32_dpp v42, v30 row_ror:8 row_mask:0xf bank_mask:0xf
    v_mov_b32_dpp v43, v31 row_ror:8 row_mask:0xf bank_mask:0xf
    v_mov_b32_dpp v44, v34 row_ror:8 row_mask:0xf bank_mask:0xf
    v_mov_b32_dpp v45, v35 row_ror:8 row_mask:0xf bank_mask:0xf
    v_mov_b32_dpp v46, v38 row_ror:8 row_mask:0xf bank_mask:0xf
    v_mov_b32_dpp v47, v39 row_ror:8 row_mask:0xf bank_mask:0xf
    v_mov_b32_dpp v26, v24 row_ror:8 row_mask:0xf bank_mask:0x3
    v_mov_b32_dpp v27, v25 row_ror:8 row_mask:0xf bank_mask:0x3
    v_mov_b32_dpp v30, v28 row_ror:8 row_mask:0xf bank_mask:0x3
    v_mov_b32_dpp v31, v29 row_ror:8 row_mask:0xf bank_mask:0x3
    v_mov_b32_dpp v34, v32 row_ror:8 row_mask:0xf bank_mask:0x3
    v_mov_b32_dpp v35, v33 row_ror:8 row_mask:0xf bank_mask:0x3
    v_mov_b32_dpp v38, v36 row_ror:8 row_mask:0xf bank_mask:0x3
    v_mov_b32_dpp v39, v37 row_ror:8 row_mask:0xf bank_mask:0x3
    v_mov_b32_dpp v24, v40 quad_perm:[0,1,2,3] row_mask:0xf bank_mask:0xc
    v_mov_b32_dpp v25, v41 quad_perm:[0,1,2,3] row_mask:0xf bank_mask:0xc
    v_mov_b32_dpp v28, v42 quad_perm:[0,1,2,3] row_mask:0xf bank_mask:0xc
    v_mov_b32_dpp v29, v43 quad_perm:[0,1,2,3] row_mask:0xf bank_mask:0xc
    v_mov_b32_dpp v32, v44 quad_perm:[0,1,2,3] row_mask:0xf bank_mask:0xc
    v_mov_b32_dpp v33, v45 quad_perm:[0,1,2,3] row_mask:0xf bank_mask:0xc
    v_mov_b32_dpp v36, v46 quad_perm:[0,1,2,3] row_mask:0xf bank_mask:0xc
    v_mov_b32_dpp v37, v47 quad_perm:[0,1,2,3] row_mask:0xf bank_mask:0xc
    v_perm_b32 v40, v28, v24, s44
    v_perm_b32 v41, v36, v32, s44
    v_perm_b32 v42, v30, v26, s44
    v_perm_b32 v43, v38, v34, s44
    v_perm_b32 v44, v28, v24, s45
    v_perm_b32 v45, v36, v32, s45
    v_perm_b32 v46, v30, v26, s45
    v_perm_b32 v47, v38, v34, s45
    v_perm_b32 v48, v29, v25, s44
    v_perm_b32 v49, v37, v33, s44
    v_perm_b32 v50, v31, v27, s44
    v_perm_b32 v51, v39, v35, s44
    v_perm_b32 v52, v29, v25, s45
    v_perm_b32 v53, v37, v33, s45
    v_perm_b32 v54, v31, v27, s45
    v_perm_b32 v55, v39, v35, s45
    v_lshrrev_b32 v1, 4, v3
    v_lshlrev_b32 v1, 11, v1
    v_and_b32 v4, 7, v3
    v_lshl_add_u32 v1, v4, 4, v1
    v_bfe_u32 v4, v3, 3, 1
    v_lshl_add_u32 v1, v4, 9, v1
    v_and_b32 v4, 3, v3
    v_lshrrev_b32 v5, 2, v3
    v_mul_u32_u24 v0, 576, v4
    v_lshl_add_u32 v0, v5, 3, v0
    v_add_u32 v0, 40960, v0
    s_lshl_b32 s38, s41, 11
    s_lshl_b32 s53, s17, 7
    s_add_u32 s38, s38, s53
    s_mov_b32 s36, 0x24924924
    s_mov_b32 s39, 0
    s_waitcnt vmcnt(0)
gm_poll:
    v_mov_b32 v2, 0
    ds_read_b32 v2, v2 offset:276
    s_waitcnt lgkmcnt(0)
    v_readfirstlane_b32 s52, v2
    s_and_b32 s52, s52, s36
    s_cbranch_scc1 gm_go
    s_sleep 2
    s_branch gm_poll
gm_go:
    s_ff1_i32_b32 s52, s52
    s_bitset0_b32 s36, s52
    s_mul_i32 s52, s52, 11
    s_bfe_u32 s53, s52, 0x10005
    s_bfe_u32 s52, s52, 0x30006
    s_mul_i32 s35, s53, 61440
    s_mul_i32 s31, s52, 2304
    s_add_u32 s31, s31, s35
    s_sub_u32 s35, s31, s39
    v_add_u32 v0, s35, v0
    ds_read_b64_tr_b16 v[12:13], v0 offset:0
    ds_read_b64_tr_b16 v[14:15], v0 offset:128
    ds_read_b64_tr_b16 v[16:17], v0 offset:256
    ds_read_b64_tr_b16 v[18:19], v0 offset:384
    s_mov_b32 s39, s31
    s_mul_i32 s33, s53, 5
    s_add_u32 s33, s33, s52
    s_lshl_b32 s33, s33, 13
    s_add_u32 s33, s33, s38
    s_mov_b32 s37, s33
    s_mov_b32 s32, 0x7ffffff0
gm_loop:
    s_waitcnt lgkmcnt(2)
    v_mfma_f32_16x16x32_bf16 v[24:27], v[12:15], v[40:43], 0
    s_setprio 3
    v_cvt_pk_bf16_f32 v7, v33, v37
    v_cvt_pk_bf16_f32 v5, v32, v36
    ds_read_b64_tr_b16 v[20:21], v0 offset:15360
    s_setprio 0
    v_mfma_f32_16x16x32_bf16 v[28:31], v[12:15], v[44:47], 0
    s_setprio 3
    v_cvt_pk_bf16_f32 v11, v35, v39
    v_cvt_pk_bf16_f32 v9, v34, v38
    ds_read_b64_tr_b16 v[22:23], v0 offset:15488
    s_setprio 0
    v_mfma_f32_16x16x32_bf16 v[32:35], v[12:15], v[48:51], 0
    s_setprio 3
    v_mov_b32_dpp v2, v6 row_ror:8 row_mask:0xf bank_mask:0xf
    v_mov_b32_dpp v3, v7 row_ror:8 row_mask:0xf bank_mask:0xf
    s_setprio 0
    v_mfma_f32_16x16x32_bf16 v[36:39], v[12:15], v[52:55], 0
    s_setprio 3
    v_mov_b32_dpp v6, v4 row_ror:8 row_mask:0xf bank_mask:0x3
    v_mov_b32_dpp v7, v5 row_ror:8 row_mask:0xf bank_mask:0x3
    s_setprio 0
    s_waitcnt lgkmcnt(2)
    v_mfma_f32_16x16x32_bf16 v[24:27], v[16:19], v[56:59], v[24:27]
    s_setprio 3
    ds_read_b64_tr_b16 v[12:13], v0 offset:15616
    v_mov_b32_dpp v4, v2 quad_perm:[0,1,2,3] row_mask:0xf bank_mask:0xc
    s_setprio 0
    v_mfma_f32_16x16x32_bf16 v[28:31], v[16:19], v[60:63], v[28:31]
    s_setprio 3
    ds_read_b64_tr_b16 v[14:15], v0 offset:15744
    v_mov_b32_dpp v5, v3 quad_perm:[0,1,2,3] row_mask:0xf bank_mask:0xc
    s_setprio 0
    v_mfma_f32_16x16x32_bf16 v[32:35], v[16:19], v[64:67], v[32:35]
    s_setprio 3
    buffer_store_dwordx4 v[4:7], v1, s[12:15], s32 offen offset:0 sc0 sc1
    v_mov_b32_dpp v2, v10 row_ror:8 row_mask:0xf bank_mask:0xf
    s_setprio 0
    v_mfma_f32_16x16x32_bf16 v[36:39], v[16:19], v[68:71], v[36:39]
    s_setprio 3
    v_mov_b32_dpp v3, v11 row_ror:8 row_mask:0xf bank_mask:0xf
    v_mov_b32_dpp v10, v8 row_ror:8 row_mask:0xf bank_mask:0x3
    s_setprio 0
    s_waitcnt lgkmcnt(2)
    v_mfma_f32_16x16x32_bf16 v[24:27], v[20:23], v[72:75], v[24:27]
    s_setprio 3
    ds_read_b64_tr_b16 v[16:17], v0 offset:30720
    v_mov_b32_dpp v11, v9 row_ror:8 row_mask:0xf bank_mask:0x3
    s_setprio 0
    v_mfma_f32_16x16x32_bf16 v[28:31], v[20:23], v[76:79], v[28:31]
    s_setprio 3
    ds_read_b64_tr_b16 v[18:19], v0 offset:30848
    v_mov_b32_dpp v8, v2 quad_perm:[0,1,2,3] row_mask:0xf bank_mask:0xc
    s_setprio 0
    v_mfma_f32_16x16x32_bf16 v[32:35], v[20:23], v[80:83], v[32:35]
    s_setprio 3
    v_mov_b32_dpp v9, v3 quad_perm:[0,1,2,3] row_mask:0xf bank_mask:0xc
    buffer_store_dwordx4 v[8:11], v1, s[12:15], s32 offen offset:1024 sc0 sc1
    s_setprio 0
    v_mfma_f32_16x16x32_bf16 v[36:39], v[20:23], v[84:87], v[36:39]
    s_waitcnt lgkmcnt(2)
    v_mfma_f32_16x16x32_bf16 v[24:27], v[12:15], v[88:91], v[24:27]
    ds_read_b64_tr_b16 v[20:21], v0 offset:30976
    v_mfma_f32_16x16x32_bf16 v[28:31], v[12:15], v[92:95], v[28:31]
    ds_read_b64_tr_b16 v[22:23], v0 offset:31104
    v_mfma_f32_16x16x32_bf16 v[32:35], v[12:15], v[96:99], v[32:35]
    s_setprio 3
    v_mov_b32 v2, 0
    s_setprio 0
    v_mfma_f32_16x16x32_bf16 v[36:39], v[12:15], v[100:103], v[36:39]
    ds_read_b32 v2, v2 offset:276
    s_waitcnt lgkmcnt(3)
    v_mfma_f32_16x16x32_bf16 v[24:27], v[16:19], v[104:107], v[24:27]
    ds_read_b64_tr_b16 v[12:13], v0 offset:46080
    v_mfma_f32_16x16x32_bf16 v[28:31], v[16:19], v[108:111], v[28:31]
    ds_read_b64_tr_b16 v[14:15], v0 offset:46208
    v_mfma_f32_16x16x32_bf16 v[32:35], v[16:19], v[112:115], v[32:35]
    s_setprio 3
    s_waitcnt lgkmcnt(2)
    v_readfirstlane_b32 s52, v2
    s_and_b32 s52, s52, s36
    s_setprio 0
    v_mfma_f32_16x16x32_bf16 v[36:39], v[16:19], v[116:119], v[36:39]
    s_cselect_b32 s34, 1, 0
    s_ff1_i32_b32 s52, s52
    s_waitcnt lgkmcnt(2)
    v_mfma_f32_16x16x32_bf16 v[24:27], v[20:23], v[120:123], v[24:27]
    ds_read_b64_tr_b16 v[16:17], v0 offset:46336
    s_bitset0_b32 s36, s52
    s_mul_i32 s52, s52, 11
    v_mfma_f32_16x16x32_bf16 v[28:31], v[20:23], v[124:127], v[28:31]
    ds_read_b64_tr_b16 v[18:19], v0 offset:46464
    s_bfe_u32 s53, s52, 0x10005
    s_bfe_u32 s52, s52, 0x30006
    v_mfma_f32_16x16x32_bf16 v[32:35], v[20:23], v[128:131], v[32:35]
    s_mul_i32 s35, s53, 61440
    s_mul_i32 s31, s52, 2304
    s_add_u32 s31, s31, s35
    v_mfma_f32_16x16x32_bf16 v[36:39], v[20:23], v[132:135], v[36:39]
    s_setprio 3
    s_sub_u32 s35, s31, s39
    v_add_u32 v0, s35, v0
    s_setprio 0
    s_waitcnt lgkmcnt(2)
    v_mfma_f32_16x16x32_bf16 v[24:27], v[12:15], v[136:139], v[24:27]
    ds_read_b64_tr_b16 v[20:21], v0 offset:0
    v_mfma_f32_16x16x32_bf16 v[28:31], v[12:15], v[140:143], v[28:31]
    ds_read_b64_tr_b16 v[22:23], v0 offset:128
    v_mfma_f32_16x16x32_bf16 v[32:35], v[12:15], v[144:147], v[32:35]
    s_mov_b32 s39, s31
    s_mul_i32 s33, s53, 5
    s_add_u32 s33, s33, s52
    v_mfma_f32_16x16x32_bf16 v[36:39], v[12:15], v[148:151], v[36:39]
    s_lshl_b32 s33, s33, 13
    s_add_u32 s33, s33, s38
    s_waitcnt lgkmcnt(2)
    v_mfma_f32_16x16x32_bf16 v[24:27], v[16:19], v[152:155], v[24:27]
    ds_read_b64_tr_b16 v[12:13], v0 offset:256
    v_mfma_f32_16x16x32_bf16 v[28:31], v[16:19], v[156:159], v[28:31]
    ds_read_b64_tr_b16 v[14:15], v0 offset:384
    s_mov_b32 s32, s37
    s_mov_b32 s37, s33
    v_mfma_f32_16x16x32_bf16 v[32:35], v[16:19], v[160:163], v[32:35]
    s_cmp_eq_u32 s34, 0
    s_nop 1
    v_mfma_f32_16x16x32_bf16 v[36:39], v[16:19], v[164:167], v[36:39]
    s_setprio 3
    v_cvt_pk_bf16_f32 v4, v24, v28
    v_cvt_pk_bf16_f32 v6, v25, v29
    v_cvt_pk_bf16_f32 v8, v26, v30
    v_cvt_pk_bf16_f32 v10, v27, v31
    s_setprio 0
    s_cbranch_scc1 gm_drain
    s_waitcnt lgkmcnt(2)
    v_mfma_f32_16x16x32_bf16 v[24:27], v[20:23], v[40:43], 0
    s_setprio 3
    v_cvt_pk_bf16_f32 v7, v33, v37
    v_cvt_pk_bf16_f32 v5, v32, v36
    ds_read_b64_tr_b16 v[16:17], v0 offset:15360
    s_setprio 0
    v_mfma_f32_16x16x32_bf16 v[28:31], v[20:23], v[44:47], 0
    s_setprio 3
    v_cvt_pk_bf16_f32 v11, v35, v39
    v_cvt_pk_bf16_f32 v9, v34, v38
    ds_read_b64_tr_b16 v[18:19], v0 offset:15488
    s_setprio 0
    v_mfma_f32_16x16x32_bf16 v[32:35], v[20:23], v[48:51], 0
    s_setprio 3
    v_mov_b32_dpp v2, v6 row_ror:8 row_mask:0xf bank_mask:0xf
    v_mov_b32_dpp v3, v7 row_ror:8 row_mask:0xf bank_mask:0xf
    s_setprio 0
    v_mfma_f32_16x16x32_bf16 v[36:39], v[20:23], v[52:55], 0
    s_setprio 3
    v_mov_b32_dpp v6, v4 row_ror:8 row_mask:0xf bank_mask:0x3
    v_mov_b32_dpp v7, v5 row_ror:8 row_mask:0xf bank_mask:0x3
    s_setprio 0
    s_waitcnt lgkmcnt(2)
    v_mfma_f32_16x16x32_bf16 v[24:27], v[12:15], v[56:59], v[24:27]
    s_setprio 3
    ds_read_b64_tr_b16 v[20:21], v0 offset:15616
    v_mov_b32_dpp v4, v2 quad_perm:[0,1,2,3] row_mask:0xf bank_mask:0xc
    s_setprio 0
    v_mfma_f32_16x16x32_bf16 v[28:31], v[12:15], v[60:63], v[28:31]
    s_setprio 3
    ds_read_b64_tr_b16 v[22:23], v0 offset:15744
    v_mov_b32_dpp v5, v3 quad_perm:[0,1,2,3] row_mask:0xf bank_mask:0xc
    s_setprio 0
    v_mfma_f32_16x16x32_bf16 v[32:35], v[12:15], v[64:67], v[32:35]
    s_setprio 3
    buffer_store_dwordx4 v[4:7], v1, s[12:15], s32 offen offset:0 sc0 sc1
    v_mov_b32_dpp v2, v10 row_ror:8 row_mask:0xf bank_mask:0xf
    s_setprio 0
    v_mfma_f32_16x16x32_bf16 v[36:39], v[12:15], v[68:71], v[36:39]
    s_setprio 3
    v_mov_b32_dpp v3, v11 row_ror:8 row_mask:0xf bank_mask:0xf
    v_mov_b32_dpp v10, v8 row_ror:8 row_mask:0xf bank_mask:0x3
    s_setprio 0
    s_waitcnt lgkmcnt(2)
    v_mfma_f32_16x16x32_bf16 v[24:27], v[16:19], v[72:75], v[24:27]
    s_setprio 3
    ds_read_b64_tr_b16 v[12:13], v0 offset:30720
    v_mov_b32_dpp v11, v9 row_ror:8 row_mask:0xf bank_mask:0x3
    s_setprio 0
    v_mfma_f32_16x16x32_bf16 v[28:31], v[16:19], v[76:79], v[28:31]
    s_setprio 3
    ds_read_b64_tr_b16 v[14:15], v0 offset:30848
    v_mov_b32_dpp v8, v2 quad_perm:[0,1,2,3] row_mask:0xf bank_mask:0xc
    s_setprio 0
    v_mfma_f32_16x16x32_bf16 v[32:35], v[16:19], v[80:83], v[32:35]
    s_setprio 3
    v_mov_b32_dpp v9, v3 quad_perm:[0,1,2,3] row_mask:0xf bank_mask:0xc
    buffer_store_dwordx4 v[8:11], v1, s[12:15], s32 offen offset:1024 sc0 sc1
    s_setprio 0
    v_mfma_f32_16x16x32_bf16 v[36:39], v[16:19], v[84:87], v[36:39]
    s_waitcnt lgkmcnt(2)
    v_mfma_f32_16x16x32_bf16 v[24:27], v[20:23], v[88:91], v[24:27]
    ds_read_b64_tr_b16 v[16:17], v0 offset:30976
    v_mfma_f32_16x16x32_bf16 v[28:31], v[20:23], v[92:95], v[28:31]
    ds_read_b64_tr_b16 v[18:19], v0 offset:31104
    v_mfma_f32_16x16x32_bf16 v[32:35], v[20:23], v[96:99], v[32:35]
    s_setprio 3
    v_mov_b32 v2, 0
    s_setprio 0
    v_mfma_f32_16x16x32_bf16 v[36:39], v[20:23], v[100:103], v[36:39]
    ds_read_b32 v2, v2 offset:276
    s_waitcnt lgkmcnt(3)
    v_mfma_f32_16x16x32_bf16 v[24:27], v[12:15], v[104:107], v[24:27]
    ds_read_b64_tr_b16 v[20:21], v0 offset:46080
    v_mfma_f32_16x16x32_bf16 v[28:31], v[12:15], v[108:111], v[28:31]
    ds_read_b64_tr_b16 v[22:23], v0 offset:46208
    v_mfma_f32_16x16x32_bf16 v[32:35], v[12:15], v[112:115], v[32:35]
    s_setprio 3
    s_waitcnt lgkmcnt(2)
    v_readfirstlane_b32 s52, v2
    s_and_b32 s52, s52, s36
    s_setprio 0
    v_mfma_f32_16x16x32_bf16 v[36:39], v[12:15], v[116:119], v[36:39]
    s_cselect_b32 s34, 1, 0
    s_ff1_i32_b32 s52, s52
    s_waitcnt lgkmcnt(2)
    v_mfma_f32_16x16x32_bf16 v[24:27], v[16:19], v[120:123], v[24:27]
    ds_read_b64_tr_b16 v[12:13], v0 offset:46336
    s_bitset0_b32 s36, s52
    s_mul_i32 s52, s52, 11
    v_mfma_f32_16x16x32_bf16 v[28:31], v[16:19], v[124:127], v[28:31]
    ds_read_b64_tr_b16 v[14:15], v0 offset:46464
    s_bfe_u32 s53, s52, 0x10005
    s_bfe_u32 s52, s52, 0x30006
    v_mfma_f32_16x16x32_bf16 v[32:35], v[16:19], v[128:131], v[32:35]
    s_mul_i32 s35, s53, 61440
    s_mul_i32 s31, s52, 2304
    s_add_u32 s31, s31, s35
    v_mfma_f32_16x16x32_bf16 v[36:39], v[16:19], v[132:135], v[36:39]
    s_setprio 3
    s_sub_u32 s35, s31, s39
    v_add_u32 v0, s35, v0
    s_setprio 0
    s_waitcnt lgkmcnt(2)
    v_mfma_f32_16x16x32_bf16 v[24:27], v[20:23], v[136:139], v[24:27]
    ds_read_b64_tr_b16 v[16:17], v0 offset:0
    v_mfma_f32_16x16x32_bf16 v[28:31], v[20:23], v[140:143], v[28:31]
    ds_read_b64_tr_b16 v[18:19], v0 offset:128
    v_mfma_f32_16x16x32_bf16 v[32:35], v[20:23], v[144:147], v[32:35]
    s_mov_b32 s39, s31
    s_mul_i32 s33, s53, 5
    s_add_u32 s33, s33, s52
    v_mfma_f32_16x16x32_bf16 v[36:39], v[20:23], v[148:151], v[36:39]
    s_lshl_b32 s33, s33, 13
    s_add_u32 s33, s33, s38
    s_waitcnt lgkmcnt(2)
    v_mfma_f32_16x16x32_bf16 v[24:27], v[12:15], v[152:155], v[24:27]
    ds_read_b64_tr_b16 v[20:21], v0 offset:256
    v_mfma_f32_16x16x32_bf16 v[28:31], v[12:15], v[156:159], v[28:31]
    ds_read_b64_tr_b16 v[22:23], v0 offset:384
    s_mov_b32 s32, s37
    s_mov_b32 s37, s33
    v_mfma_f32_16x16x32_bf16 v[32:35], v[12:15], v[160:163], v[32:35]
    s_cmp_eq_u32 s34, 0
    s_nop 1
    v_mfma_f32_16x16x32_bf16 v[36:39], v[12:15], v[164:167], v[36:39]
    s_setprio 3
    v_cvt_pk_bf16_f32 v4, v24, v28
    v_cvt_pk_bf16_f32 v6, v25, v29
    v_cvt_pk_bf16_f32 v8, v26, v30
    v_cvt_pk_bf16_f32 v10, v27, v31
    s_setprio 0
    s_cbranch_scc1 gm_drain
    s_waitcnt lgkmcnt(2)
    v_mfma_f32_16x16x32_bf16 v[24:27], v[16:19], v[40:43], 0
    s_setprio 3
    v_cvt_pk_bf16_f32 v7, v33, v37
    v_cvt_pk_bf16_f32 v5, v32, v36
    ds_read_b64_tr_b16 v[12:13], v0 offset:15360
    s_setprio 0
    v_mfma_f32_16x16x32_bf16 v[28:31], v[16:19], v[44:47], 0
    s_setprio 3
    v_cvt_pk_bf16_f32 v11, v35, v39
    v_cvt_pk_bf16_f32 v9, v34, v38
    ds_read_b64_tr_b16 v[14:15], v0 offset:15488
    s_setprio 0
    v_mfma_f32_16x16x32_bf16 v[32:35], v[16:19], v[48:51], 0
    s_setprio 3
    v_mov_b32_dpp v2, v6 row_ror:8 row_mask:0xf bank_mask:0xf
    v_mov_b32_dpp v3, v7 row_ror:8 row_mask:0xf bank_mask:0xf
    s_setprio 0
    v_mfma_f32_16x16x32_bf16 v[36:39], v[16:19], v[52:55], 0
    s_setprio 3
    v_mov_b32_dpp v6, v4 row_ror:8 row_mask:0xf bank_mask:0x3
    v_mov_b32_dpp v7, v5 row_ror:8 row_mask:0xf bank_mask:0x3
    s_setprio 0
    s_waitcnt lgkmcnt(2)
    v_mfma_f32_16x16x32_bf16 v[24:27], v[20:23], v[56:59], v[24:27]
    s_setprio 3
    ds_read_b64_tr_b16 v[16:17], v0 offset:15616
    v_mov_b32_dpp v4, v2 quad_perm:[0,1,2,3] row_mask:0xf bank_mask:0xc
    s_setprio 0
    v_mfma_f32_16x16x32_bf16 v[28:31], v[20:23], v[60:63], v[28:31]
    s_setprio 3
    ds_read_b64_tr_b16 v[18:19], v0 offset:15744
    v_mov_b32_dpp v5, v3 quad_perm:[0,1,2,3] row_mask:0xf bank_mask:0xc
    s_setprio 0
    v_mfma_f32_16x16x32_bf16 v[32:35], v[20:23], v[64:67], v[32:35]
    s_setprio 3
    buffer_store_dwordx4 v[4:7], v1, s[12:15], s32 offen offset:0 sc0 sc1
    v_mov_b32_dpp v2, v10 row_ror:8 row_mask:0xf bank_mask:0xf
    s_setprio 0
    v_mfma_f32_16x16x32_bf16 v[36:39], v[20:23], v[68:71], v[36:39]
    s_setprio 3
    v_mov_b32_dpp v3, v11 row_ror:8 row_mask:0xf bank_mask:0xf
    v_mov_b32_dpp v10, v8 row_ror:8 row_mask:0xf bank_mask:0x3
    s_setprio 0
    s_waitcnt lgkmcnt(2)
    v_mfma_f32_16x16x32_bf16 v[24:27], v[12:15], v[72:75], v[24:27]
    s_setprio 3
    ds_read_b64_tr_b16 v[20:21], v0 offset:30720
    v_mov_b32_dpp v11, v9 row_ror:8 row_mask:0xf bank_mask:0x3
    s_setprio 0
    v_mfma_f32_16x16x32_bf16 v[28:31], v[12:15], v[76:79], v[28:31]
    s_setprio 3
    ds_read_b64_tr_b16 v[22:23], v0 offset:30848
    v_mov_b32_dpp v8, v2 quad_perm:[0,1,2,3] row_mask:0xf bank_mask:0xc
    s_setprio 0
    v_mfma_f32_16x16x32_bf16 v[32:35], v[12:15], v[80:83], v[32:35]
    s_setprio 3
    v_mov_b32_dpp v9, v3 quad_perm:[0,1,2,3] row_mask:0xf bank_mask:0xc
    buffer_store_dwordx4 v[8:11], v1, s[12:15], s32 offen offset:1024 sc0 sc1
    s_setprio 0
    v_mfma_f32_16x16x32_bf16 v[36:39], v[12:15], v[84:87], v[36:39]
    s_waitcnt lgkmcnt(2)
    v_mfma_f32_16x16x32_bf16 v[24:27], v[16:19], v[88:91], v[24:27]
    ds_read_b64_tr_b16 v[12:13], v0 offset:30976
    v_mfma_f32_16x16x32_bf16 v[28:31], v[16:19], v[92:95], v[28:31]
    ds_read_b64_tr_b16 v[14:15], v0 offset:31104
    v_mfma_f32_16x16x32_bf16 v[32:35], v[16:19], v[96:99], v[32:35]
    s_setprio 3
    v_mov_b32 v2, 0
    s_setprio 0
    v_mfma_f32_16x16x32_bf16 v[36:39], v[16:19], v[100:103], v[36:39]
    ds_read_b32 v2, v2 offset:276
    s_waitcnt lgkmcnt(3)
    v_mfma_f32_16x16x32_bf16 v[24:27], v[20:23], v[104:107], v[24:27]
    ds_read_b64_tr_b16 v[16:17], v0 offset:46080
    v_mfma_f32_16x16x32_bf16 v[28:31], v[20:23], v[108:111], v[28:31]
    ds_read_b64_tr_b16 v[18:19], v0 offset:46208
    v_mfma_f32_16x16x32_bf16 v[32:35], v[20:23], v[112:115], v[32:35]
    s_setprio 3
    s_waitcnt lgkmcnt(2)
    v_readfirstlane_b32 s52, v2
    s_and_b32 s52, s52, s36
    s_setprio 0
    v_mfma_f32_16x16x32_bf16 v[36:39], v[20:23], v[116:119], v[36:39]
    s_cselect_b32 s34, 1, 0
    s_ff1_i32_b32 s52, s52
    s_waitcnt lgkmcnt(2)
    v_mfma_f32_16x16x32_bf16 v[24:27], v[12:15], v[120:123], v[24:27]
    ds_read_b64_tr_b16 v[20:21], v0 offset:46336
    s_bitset0_b32 s36, s52
    s_mul_i32 s52, s52, 11
    v_mfma_f32_16x16x32_bf16 v[28:31], v[12:15], v[124:127], v[28:31]
    ds_read_b64_tr_b16 v[22:23], v0 offset:46464
    s_bfe_u32 s53, s52, 0x10005
    s_bfe_u32 s52, s52, 0x30006
    v_mfma_f32_16x16x32_bf16 v[32:35], v[12:15], v[128:131], v[32:35]
    s_mul_i32 s35, s53, 61440
    s_mul_i32 s31, s52, 2304
    s_add_u32 s31, s31, s35
    v_mfma_f32_16x16x32_bf16 v[36:39], v[12:15], v[132:135], v[36:39]
    s_setprio 3
    s_sub_u32 s35, s31, s39
    v_add_u32 v0, s35, v0
    s_setprio 0
    s_waitcnt lgkmcnt(2)
    v_mfma_f32_16x16x32_bf16 v[24:27], v[16:19], v[136:139], v[24:27]
    ds_read_b64_tr_b16 v[12:13], v0 offset:0
    v_mfma_f32_16x16x32_bf16 v[28:31], v[16:19], v[140:143], v[28:31]
    ds_read_b64_tr_b16 v[14:15], v0 offset:128
    v_mfma_f32_16x16x32_bf16 v[32:35], v[16:19], v[144:147], v[32:35]
    s_mov_b32 s39, s31
    s_mul_i32 s33, s53, 5
    s_add_u32 s33, s33, s52
    v_mfma_f32_16x16x32_bf16 v[36:39], v[16:19], v[148:151], v[36:39]
    s_lshl_b32 s33, s33, 13
    s_add_u32 s33, s33, s38
    s_waitcnt lgkmcnt(2)
    v_mfma_f32_16x16x32_bf16 v[24:27], v[20:23], v[152:155], v[24:27]
    ds_read_b64_tr_b16 v[16:17], v0 offset:256
    v_mfma_f32_16x16x32_bf16 v[28:31], v[20:23], v[156:159], v[28:31]
    ds_read_b64_tr_b16 v[18:19], v0 offset:384
    s_mov_b32 s32, s37
    s_mov_b32 s37, s33
    v_mfma_f32_16x16x32_bf16 v[32:35], v[20:23], v[160:163], v[32:35]
    s_cmp_eq_u32 s34, 0
    s_nop 1
    v_mfma_f32_16x16x32_bf16 v[36:39], v[20:23], v[164:167], v[36:39]
    s_setprio 3
    v_cvt_pk_bf16_f32 v4, v24, v28
    v_cvt_pk_bf16_f32 v6, v25, v29
    v_cvt_pk_bf16_f32 v8, v26, v30
    v_cvt_pk_bf16_f32 v10, v27, v31
    s_setprio 0
    s_cbranch_scc0 gm_loop
gm_drain:
    s_nop 2
    s_setprio 3
    v_cvt_pk_bf16_f32 v7, v33, v37
    v_cvt_pk_bf16_f32 v5, v32, v36
    v_cvt_pk_bf16_f32 v11, v35, v39
    v_cvt_pk_bf16_f32 v9, v34, v38
    v_mov_b32_dpp v2, v6 row_ror:8 row_mask:0xf bank_mask:0xf
    v_mov_b32_dpp v3, v7 row_ror:8 row_mask:0xf bank_mask:0xf
    v_mov_b32_dpp v6, v4 row_ror:8 row_mask:0xf bank_mask:0x3
    v_mov_b32_dpp v7, v5 row_ror:8 row_mask:0xf bank_mask:0x3
    v_mov_b32_dpp v4, v2 quad_perm:[0,1,2,3] row_mask:0xf bank_mask:0xc
    v_mov_b32_dpp v5, v3 quad_perm:[0,1,2,3] row_mask:0xf bank_mask:0xc
    buffer_store_dwordx4 v[4:7], v1, s[12:15], s32 offen offset:0 sc0 sc1
    v_mov_b32_dpp v2, v10 row_ror:8 row_mask:0xf bank_mask:0xf
    v_mov_b32_dpp v3, v11 row_ror:8 row_mask:0xf bank_mask:0xf
    v_mov_b32_dpp v10, v8 row_ror:8 row_mask:0xf bank_mask:0x3
    v_mov_b32_dpp v11, v9 row_ror:8 row_mask:0xf bank_mask:0x3
    v_mov_b32_dpp v8, v2 quad_perm:[0,1,2,3] row_mask:0xf bank_mask:0xc
    v_mov_b32_dpp v9, v3 quad_perm:[0,1,2,3] row_mask:0xf bank_mask:0xc
    buffer_store_dwordx4 v[8:11], v1, s[12:15], s32 offen offset:1024 sc0 sc1
    s_setprio 0
    s_cmp_lg_u32 s36, 0
    s_cbranch_scc1 gm_poll
    s_endpgm
mn_sp1:
    v_mov_b32 v55, 0
    ds_read_b32 v55, v55 offset:308
    s_waitcnt lgkmcnt(0)
    v_readfirstlane_b32 s62, v55
    s_cmp_ge_u32 s62, 1
    s_cbranch_scc1 mn_sp1x
    s_sleep 1
    s_branch mn_sp1
gm_wait2:
    v_mov_b32 v15, 0
    ds_read_b32 v17, v15 offset:304
    s_waitcnt lgkmcnt(0)
    v_readfirstlane_b32 s62, v17
    s_cmp_lg_u32 s62, 0
    s_cbranch_scc1 gm_go2
    s_sleep 1
    s_branch gm_wait2
gm_ovf:
    s_movk_i32 s20, 4
    s_barrier
    s_barrier
    s_branch gm_pass
gm_next:
    s_add_u32 s24, s24, s20
    s_barrier
    s_branch gm_pass
mn_w5:
    s_and_b32 s62, s2, 15
    s_lshl_b32 s62, s62, 7
    s_add_u32 s62, s62, 11730944
    v_mov_b32 v55, s62
    v_lshlrev_b32 v56, 6, v0
    v_and_b32 v56, 0xc0, v56
    s_mov_b32 s63, 0x100000
mn_poll2dm:
    s_sub_u32 s63, s63, 1
    s_cbranch_scc1 mn_poll2dx
    global_load_dword v57, v56, s[60:61] sc1
    s_waitcnt vmcnt(0)
    v_add_u32_dpp v57, v57, v57 quad_perm:[2,3,0,1] row_mask:0xf bank_mask:0xf
    s_sleep 8
    v_readlane_b32 s62, v57, 1
    s_cmp_lt_u32 s62, 125
    s_cbranch_scc1 mn_poll2dm
mn_poll2dx:
    v_add_u32 v55, 12, v35
    v_add_u32 v55, s24, v55
    v_lshrrev_b32 v56, 16, v58
    v_mov_b32 v23, 0
    v_cmpx_lt_u32 vcc, v55, v56
    s_cbranch_execz mn_g0
    v_cmp_gt_u32 vcc, 15, v55
    v_and_b32 v56, 0xffff, v58
    v_add_lshl_u32 v56, v55, v56, 2
    v_add_u32 v56, v56, v46
    v_lshl_add_u32 v57, v0, 4, s22
    v_and_or_b32 v57, v55, 12, v57
    v_cndmask_b32 v56, v56, v57, vcc
    buffer_load_dword v23, v56, s[8:11], 0 offen sc1
    s_waitcnt vmcnt(0)
mn_g0:
    s_mov_b64 exec, -1
    v_add_u32 v55, 16, v35
    v_add_u32 v55, s24, v55
    v_lshrrev_b32 v56, 16, v58
    v_mov_b32 v24, 0
    v_cmpx_lt_u32 vcc, v55, v56
    s_cbranch_execz mn_g1
    v_cmp_gt_u32 vcc, 15, v55
    v_and_b32 v56, 0xffff, v58
    v_add_lshl_u32 v56, v55, v56, 2
    v_add_u32 v56, v56, v46
    v_lshl_add_u32 v57, v0, 4, s22
    v_and_or_b32 v57, v55, 12, v57
    v_cndmask_b32 v56, v56, v57, vcc
    buffer_load_dword v24, v56, s[8:11], 0 offen sc1
    s_waitcnt vmcnt(0)
mn_g1:
    s_mov_b64 exec, -1
mn_more:
    s_add_u32 s52, s24, s20
    v_lshrrev_b32 v56, 16, v58
    v_cmp_lt_u32 vcc, s52, v56
    s_cbranch_vccz mn_count
    v_mov_b32 v55, 272
    ds_write_b32 v55, v48
    s_branch mn_count
mn_ovf:
    s_movk_i32 s20, 4
    s_waitcnt vmcnt(0) lgkmcnt(0)
    s_barrier
    s_branch mn_again
mn_next:
    s_set_gpr_idx_off
    s_waitcnt vmcnt(0) lgkmcnt(0)
    s_nop 7
    s_add_u32 s24, s24, s20
    v_mbcnt_lo_u32_b32 v0, -1, 0
    v_mbcnt_hi_u32_b32 v0, -1, v0
    v_lshl_add_u32 v0, s16, 6, v0
    v_lshrrev_b32 v56, 6, v0
    v_lshlrev_b32 v55, 1, v0
    v_and_b32 v55, 0x78, v55
    v_or_b32 v55, v55, v56
    v_cmp_gt_u32 vcc, 125, v55
    v_mul_u32_u24 v46, 5120, v55
    v_add_u32 v46, 7340032, v46
    v_bfrev_b32 v56, 2
    v_lshlrev_b32 v44, 4, v0
    v_cndmask_b32 v44, v56, v44, vcc
    v_and_b32 v51, 63, v0
    buffer_load_dwordx4 v[20:23], v44, s[8:11], s22 offen sc1
    v_mov_b32 v48, 1
    v_lshlrev_b32 v47, 2, v51
    v_bfe_u32 v2, v0, 5, 1
    v_bfe_u32 v3, v0, 3, 2
    v_and_b32 v35, 3, v0
    v_lshl_add_u32 v3, v3, 2, v35
    v_mul_u32_u24 v49, 20, v2
    v_lshrrev_b32 v18, 2, v51
    v_lshl_add_u32 v18, v35, 4, v18
    v_mov_b32 v50, 0x3fff
    s_lshl_b32 s37, s16, 2
    v_mov_b32 v59, s37
    s_sub_u32 s36, s16, 1
    s_waitcnt vmcnt(0)
    v_mov_b32_dpp v58, v23 quad_perm:[3,3,3,3] row_mask:0xf bank_mask:0xf
mn_again:
    v_mov_b32 v55, 0
    ds_write_b32 v47, v55 offset:0
    ds_write_b32 v47, v55 offset:128
    s_waitcnt vmcnt(0) lgkmcnt(0)
    s_barrier
    v_add_u32 v55, 0, v35
    v_add_u32 v55, s24, v55
    v_lshrrev_b32 v56, 16, v58
    v_mov_b32 v20, 0
    v_cmpx_lt_u32 vcc, v55, v56
    s_cbranch_execz mn_g2
    v_cmp_gt_u32 vcc, 15, v55
    v_and_b32 v56, 0xffff, v58
    v_add_lshl_u32 v56, v55, v56, 2
    v_add_u32 v56, v56, v46
    v_lshl_add_u32 v57, v0, 4, s22
    v_and_or_b32 v57, v55, 12, v57
    v_cndmask_b32 v56, v56, v57, vcc
    buffer_load_dword v20, v56, s[8:11], 0 offen sc1
    s_waitcnt vmcnt(0)
mn_g2:
    s_mov_b64 exec, -1
    v_mov_b32 v21, 0
    v_mov_b32 v22, 0
    v_mov_b32 v23, 0
    v_mov_b32 v24, 0
    s_cmp_le_u32 s20, 4
    s_cbranch_scc1 mn_more
    v_add_u32 v55, 4, v35
    v_add_u32 v55, s24, v55
    v_lshrrev_b32 v56, 16, v58
    v_mov_b32 v21, 0
    v_cmpx_lt_u32 vcc, v55, v56
    s_cbranch_execz mn_g3
    v_cmp_gt_u32 vcc, 15, v55
    v_and_b32 v56, 0xffff, v58
    v_add_lshl_u32 v56, v55, v56, 2
    v_add_u32 v56, v56, v46
    v_lshl_add_u32 v57, v0, 4, s22
    v_and_or_b32 v57, v55, 12, v57
    v_cndmask_b32 v56, v56, v57, vcc
    buffer_load_dword v21, v56, s[8:11], 0 offen sc1
    s_waitcnt vmcnt(0)
mn_g3:
    s_mov_b64 exec, -1
    v_add_u32 v55, 8, v35
    v_add_u32 v55, s24, v55
    v_lshrrev_b32 v56, 16, v58
    v_mov_b32 v22, 0
    v_cmpx_lt_u32 vcc, v55, v56
    s_cbranch_execz mn_g4
    v_cmp_gt_u32 vcc, 15, v55
    v_and_b32 v56, 0xffff, v58
    v_add_lshl_u32 v56, v55, v56, 2
    v_add_u32 v56, v56, v46
    v_lshl_add_u32 v57, v0, 4, s22
    v_and_or_b32 v57, v55, 12, v57
    v_cndmask_b32 v56, v56, v57, vcc
    buffer_load_dword v22, v56, s[8:11], 0 offen sc1
    s_waitcnt vmcnt(0)
mn_g4:
    s_mov_b64 exec, -1
    v_add_u32 v55, 12, v35
    v_add_u32 v55, s24, v55
    v_lshrrev_b32 v56, 16, v58
    v_mov_b32 v23, 0
    v_cmpx_lt_u32 vcc, v55, v56
    s_cbranch_execz mn_g5
    v_cmp_gt_u32 vcc, 15, v55
    v_and_b32 v56, 0xffff, v58
    v_add_lshl_u32 v56, v55, v56, 2
    v_add_u32 v56, v56, v46
    v_lshl_add_u32 v57, v0, 4, s22
    v_and_or_b32 v57, v55, 12, v57
    v_cndmask_b32 v56, v56, v57, vcc
    buffer_load_dword v23, v56, s[8:11], 0 offen sc1
    s_waitcnt vmcnt(0)
mn_g5:
    s_mov_b64 exec, -1
    v_add_u32 v55, 16, v35
    v_add_u32 v55, s24, v55
    v_lshrrev_b32 v56, 16, v58
    v_mov_b32 v24, 0
    v_cmpx_lt_u32 vcc, v55, v56
    s_cbranch_execz mn_g6
    v_cmp_gt_u32 vcc, 15, v55
    v_and_b32 v56, 0xffff, v58
    v_add_lshl_u32 v56, v55, v56, 2
    v_add_u32 v56, v56, v46
    v_lshl_add_u32 v57, v0, 4, s22
    v_and_or_b32 v57, v55, 12, v57
    v_cndmask_b32 v56, v56, v57, vcc
    buffer_load_dword v24, v56, s[8:11], 0 offen sc1
    s_waitcnt vmcnt(0)
mn_g6:
    s_mov_b64 exec, -1
    s_branch mn_more
mn_last:
    s_endpgm
.section .rodata,"a"
.p2align 6
.amdhsa_kernel standalone__tensor_product_equiv_mace__graph_kernel
  .amdhsa_next_free_vgpr 168
  .amdhsa_next_free_sgpr 96
  .amdhsa_accum_offset 168
  .amdhsa_group_segment_fixed_size 0
  .amdhsa_kernarg_size 88
  .amdhsa_user_sgpr_count 2
  .amdhsa_user_sgpr_kernarg_segment_ptr 1
  .amdhsa_system_sgpr_workgroup_id_x 1
.end_amdhsa_kernel
```

```asm
; @launch grid=(256,1,1) block=(768,1,1) lds=163840
.amdgcn_target "amdgcn-amd-amdhsa--gfx950"
.text
.globl standalone__tensor_product_equiv_mace__graph_kernel
.p2align 8
.type standalone__tensor_product_equiv_mace__graph_kernel,@function
standalone__tensor_product_equiv_mace__graph_kernel:
    s_load_dwordx8 s[4:11], s[0:1], 8
    s_load_dwordx4 s[12:15], s[0:1], 72
    v_lshrrev_b32 v9, 6, v0
    s_and_b32 s3, s2, 127
    v_readfirstlane_b32 s18, v9
    v_and_b32 v1, 63, v0
    s_cmp_lt_u32 s2, 125
    s_cbranch_scc1 ka_bin
    s_cmp_ge_u32 s2, 256
    s_cbranch_scc1 ka_end
    s_getpc_b64 s[36:37]
ka_pc0:
    v_lshlrev_b32 v41, 7, v0
    s_mul_i32 s34, s3, 40960
    v_add_u32 v44, s34, v41
    v_min_u32 v41, mn_last-ka_pc0, v41
    global_load_dword v41, v41, s[36:37]
    s_cmp_ge_u32 s3, 125
    s_cbranch_scc1 ka_idle
    s_cmp_ge_u32 s18, 5
    s_cbranch_scc1 ka_pf
    s_waitcnt vmcnt(0) lgkmcnt(0)
    global_load_dword v45, v44, s[10:11]
    s_branch ka_pf
ka_bin:
    s_cmp_ge_u32 s18, 10
    s_cbranch_scc1 ka_dma
    s_mul_i32 s3, s2, 5120
    v_lshl_add_u32 v5, v0, 2, s3
    s_waitcnt lgkmcnt(0)
    global_load_dword v10, v5, s[6:7]
    global_load_dword v60, v5, s[6:7] offset:2560
    global_load_dword v11, v5, s[4:5]
    global_load_dword v61, v5, s[4:5] offset:2560
    v_lshlrev_b32 v2, 2, v0
    v_and_b32 v2, 0x3fc, v2
    v_lshlrev_b32 v5, 4, v0
    v_mov_b32 v44, 0
    v_mov_b32 v45, 0
    v_mov_b32 v46, 0
    v_mov_b32 v47, 0
    ds_write_b32 v2, v44 offset:1024
    ds_write_b128 v5, v[44:47] offset:12288
    ds_write_b128 v5, v[44:47] offset:18432
    s_and_b32 s21, s15, 0xffff
    s_mov_b32 s22, 12582912
    s_mov_b32 s23, 0x20000
    s_mov_b32 s20, s14
    v_mov_b32 v3, 1
    v_lshlrev_b32 v26, 4, v1
    s_lshl_b32 s19, s18, 10
    v_add_u32 v27, s19, v26
    v_mov_b32 v4, 0x40000
    s_movk_i32 s29, 625
    s_movk_i32 s38, 0x3fff
    s_movk_i32 s39, 4096
    s_waitcnt lgkmcnt(0)
    s_barrier
    v_mov_b32 v19, 74752
    v_lshl_add_u32 v18, v0, 1, 0
    v_mul_u32_u24 v16, 13108, v18
    v_lshrrev_b32 v16, 16, v16
    v_mad_i32_i24 v18, v16, -5, v18
    v_lshlrev_b32 v16, 2, v16
    v_cmp_eq_u32 vcc, 4, v18
    v_lshlrev_b32 v18, 3, v18
    v_add_u32 v18, 33792, v18
    v_cndmask_b32 v17, 5, 3, vcc
    v_cndmask_b32 v18, v18, v19, vcc
    v_lshl_add_u32 v14, v0, 1, 1
    v_mul_u32_u24 v12, 13108, v14
    v_lshrrev_b32 v12, 16, v12
    v_mad_i32_i24 v14, v12, -5, v14
    v_lshlrev_b32 v12, 2, v12
    v_cmp_eq_u32 vcc, 4, v14
    v_lshlrev_b32 v14, 3, v14
    v_add_u32 v14, 33792, v14
    v_cndmask_b32 v13, 5, 3, vcc
    v_cndmask_b32 v14, v14, v19, vcc
    s_mul_i32 s31, s2, 51200
    s_waitcnt vmcnt(3)
    v_mul_u32_u24 v32, 214749, v10
    v_lshrrev_b32 v32, 23, v32
    v_min_u32 v32, 255, v32
    v_and_b32 v35, 7, v32
    v_lshrrev_b32 v33, 3, v32
    v_lshl_add_u32 v35, v35, 5, v33
    v_lshlrev_b32 v35, 2, v35
    ds_add_rtn_u32 v36, v35, v3 offset:1024
    s_waitcnt vmcnt(2)
    v_mul_u32_u24 v62, 214749, v60
    v_lshrrev_b32 v62, 23, v62
    v_min_u32 v62, 255, v62
    v_and_b32 v66, 7, v62
    v_lshrrev_b32 v63, 3, v62
    v_lshl_add_u32 v66, v66, 5, v63
    v_lshlrev_b32 v66, 2, v66
    ds_add_rtn_u32 v67, v66, v3 offset:1024
    v_mad_u32_u24 v33, v32, s29, 15
    v_lshrrev_b32 v33, 4, v33
    v_sub_u32 v33, v10, v33
    v_subrev_u32 v32, 20, v33
    v_min_u32 v32, v32, v33
    v_min_u32 v32, 19, v32
    v_lshlrev_b32 v40, 4, v35
    v_add_u32 v35, s19, v35
    v_mad_u32_u24 v63, v62, s29, 15
    v_lshrrev_b32 v63, 4, v63
    v_sub_u32 v63, v60, v63
    v_subrev_u32 v62, 20, v63
    v_min_u32 v62, v62, v63
    v_min_u32 v62, 19, v62
    v_lshlrev_b32 v70, 4, v66
    v_add_u32 v66, s19, v66
    s_waitcnt vmcnt(0) lgkmcnt(0)
    v_lshrrev_b32 v34, 11, v40
    v_mul_u32_u24 v34, 512, v34
    v_sub_u32 v34, v11, v34
    v_cmp_gt_u32 vcc, s39, v11
    v_add_u32 v39, s39, v34
    v_min_u32 v34, v34, v39
    v_cndmask_b32 v34, v11, v34, vcc
    v_mul_u32_u24 v39, 3330, v34
    v_lshrrev_b32 v39, 20, v39
    v_lshrrev_b32 v34, 2, v32
    v_cmp_gt_u32 vcc, 27, v39
    v_add_u32 v34, 27, v34
    v_lshlrev_b32 v23, 14, v32
    v_cndmask_b32 v39, v34, v39, vcc
    v_cmp_le_u32 vcc, 20, v33
    v_and_or_b32 v22, v11, s38, v23
    v_or_b32 v39, 64, v39
    v_add_u32 v34, 32, v39
    v_cndmask_b32 v39, v39, v34, vcc
    v_lshl_or_b32 v22, v39, 25, v22
    v_cmp_lt_u32 vcc, 14, v36
    v_and_b32 v34, 3, v36
    v_lshl_add_u32 v40, v34, 4, v40
    v_and_or_b32 v40, v36, 12, v40
    v_cndmask_b32 v40, v40, v4, vcc
    ds_write_b32 v40, v22 offset:12288
    v_lshrrev_b32 v71, 11, v70
    v_mul_u32_u24 v71, 512, v71
    v_sub_u32 v71, v61, v71
    v_cmp_gt_u32 vcc, s39, v61
    v_add_u32 v68, s39, v71
    v_min_u32 v71, v71, v68
    v_cndmask_b32 v71, v61, v71, vcc
    v_mul_u32_u24 v68, 3330, v71
    v_lshrrev_b32 v68, 20, v68
    v_lshrrev_b32 v71, 2, v62
    v_cmp_gt_u32 vcc, 27, v68
    v_add_u32 v71, 27, v71
    v_lshlrev_b32 v75, 14, v62
    v_cndmask_b32 v68, v71, v68, vcc
    v_cmp_le_u32 vcc, 20, v63
    v_and_or_b32 v74, v61, s38, v75
    v_or_b32 v68, 64, v68
    v_add_u32 v71, 32, v68
    v_cndmask_b32 v68, v68, v71, vcc
    v_lshl_or_b32 v74, v68, 25, v74
    v_cmp_lt_u32 vcc, 14, v67
    v_and_b32 v71, 3, v67
    v_lshl_add_u32 v70, v71, 4, v70
    v_and_or_b32 v70, v67, 12, v70
    v_cndmask_b32 v70, v70, v4, vcc
    ds_write_b32 v70, v74 offset:12288
    s_waitcnt lgkmcnt(0)
    s_barrier
    ds_read_b128 v[44:47], v26 offset:1024
    v_add_u32 v9, 640, v0
    v_max_u32 v8, v36, v67
    v_cmp_lt_u32 vcc, 14, v8
    s_waitcnt lgkmcnt(0)
    v_add_u32 v53, v44, v45
    v_add_u32 v54, v53, v46
    v_add_u32 v38, v54, v47
    v_mov_b32 v55, v38
    s_nop 0
    v_add_u32_dpp v38, v38, v38 row_shr:1 row_mask:0xf bank_mask:0xf
    s_nop 0
    s_nop 0
    v_add_u32_dpp v38, v38, v38 row_shr:2 row_mask:0xf bank_mask:0xf
    s_nop 0
    s_nop 0
    v_add_u32_dpp v38, v38, v38 row_shr:4 row_mask:0xf bank_mask:0xf
    s_nop 0
    s_nop 0
    v_add_u32_dpp v38, v38, v38 row_shr:8 row_mask:0xf bank_mask:0xf
    s_nop 0
    s_nop 0
    v_add_u32_dpp v38, v38, v38 row_bcast:15 row_mask:0xa bank_mask:0xf
    s_nop 0
    s_nop 0
    v_add_u32_dpp v38, v38, v38 row_bcast:31 row_mask:0xc bank_mask:0xf
    v_sub_u32 v56, v38, v55
    v_add_u32 v57, v56, v44
    v_add_u32 v58, v56, v53
    v_add_u32 v59, v56, v54
    ds_write_b128 v27, v[56:59] offset:2048
    ds_read_b32 v43, v35 offset:2048
    ds_read_b32 v69, v66 offset:2048
    s_waitcnt lgkmcnt(0)
    v_add_lshl_u32 v43, v43, v36, 2
    v_add_lshl_u32 v69, v69, v67, 2
    ds_write_b32 v43, v0 offset:28672
    ds_write_b32 v69, v9 offset:28672
    s_cbranch_vccnz ka_ov
ka_ov_back:
    s_waitcnt lgkmcnt(0)
ka_copy:
    s_barrier
    ds_read_b32 v20, v16 offset:28672
    ds_read_b32 v21, v12 offset:28672
    ds_read_b32 v22, v16 offset:29696
    ds_read_b32 v23, v12 offset:29696
    ds_read_b32 v24, v16 offset:30720
    ds_read_b32 v25, v12 offset:30720
    ds_read_b32 v26, v16 offset:31744
    ds_read_b32 v27, v12 offset:31744
    ds_read_b32 v28, v16 offset:32768
    ds_read_b32 v29, v12 offset:32768
    s_waitcnt lgkmcnt(8)
    v_lshl_add_u32 v20, v20, v17, v18
    v_lshl_add_u32 v21, v21, v13, v14
    ds_read_b64 v[44:45], v20
    ds_read_b64 v[46:47], v21
    s_waitcnt lgkmcnt(8)
    v_lshl_add_u32 v22, v22, v17, v18
    v_lshl_add_u32 v23, v23, v13, v14
    ds_read_b64 v[48:49], v22
    ds_read_b64 v[50:51], v23
    s_waitcnt lgkmcnt(8)
    v_lshl_add_u32 v24, v24, v17, v18
    v_lshl_add_u32 v25, v25, v13, v14
    ds_read_b64 v[52:53], v24
    ds_read_b64 v[54:55], v25
    s_waitcnt lgkmcnt(8)
    v_lshl_add_u32 v26, v26, v17, v18
    v_lshl_add_u32 v27, v27, v13, v14
    ds_read_b64 v[56:57], v26
    ds_read_b64 v[58:59], v27
    s_waitcnt lgkmcnt(8)
    v_lshl_add_u32 v28, v28, v17, v18
    v_lshl_add_u32 v29, v29, v13, v14
    ds_read_b64 v[60:61], v28
    ds_read_b64 v[62:63], v29
    s_waitcnt lgkmcnt(8)
    buffer_store_dwordx4 v[44:47], v5, s[20:23], s31 offen sc1
    s_addk_i32 s31, 10240
    s_waitcnt lgkmcnt(6)
    buffer_store_dwordx4 v[48:51], v5, s[20:23], s31 offen sc1
    s_addk_i32 s31, 10240
    s_waitcnt lgkmcnt(4)
    buffer_store_dwordx4 v[52:55], v5, s[20:23], s31 offen sc1
    s_addk_i32 s31, 10240
    s_waitcnt lgkmcnt(2)
    buffer_store_dwordx4 v[56:59], v5, s[20:23], s31 offen sc1
    s_addk_i32 s31, 10240
    s_waitcnt lgkmcnt(0)
    buffer_store_dwordx4 v[60:63], v5, s[20:23], s31 offen sc1
    s_branch mn_start2
ka_ov:
    s_mul_i32 s33, s2, 5120
    s_add_u32 s33, s33, 7340032
    buffer_store_dword v22, v43, s[20:23], s33 offen sc1
    buffer_store_dword v74, v69, s[20:23], s33 offen sc1
    s_branch ka_ov_back
ka_dma:
    s_cmp_eq_u32 s18, 11
    s_cbranch_scc1 ka_cell
    s_mul_i32 s35, s2, 40960
    v_lshl_add_u32 v7, v1, 4, s35
    s_mul_i32 s35, s2, 10240
    v_lshl_add_u32 v8, v1, 4, s35
    s_mov_b32 m0, 74752
    s_waitcnt lgkmcnt(0)
    s_load_dwordx4 s[36:39], s[0:1], 40
    s_barrier
    global_load_lds_dwordx4 v8, s[8:9] offset:0
    global_load_lds_dwordx4 v8, s[8:9] offset:1024
    s_add_u32 m0, m0, 2048
    v_add_u32 v8, 2048, v8
    global_load_lds_dwordx4 v8, s[8:9] offset:0
    global_load_lds_dwordx4 v8, s[8:9] offset:1024
    s_add_u32 m0, m0, 2048
    v_add_u32 v8, 2048, v8
    global_load_lds_dwordx4 v8, s[8:9] offset:0
    global_load_lds_dwordx4 v8, s[8:9] offset:1024
    s_add_u32 m0, m0, 2048
    v_add_u32 v8, 2048, v8
    global_load_lds_dwordx4 v8, s[8:9] offset:0
    global_load_lds_dwordx4 v8, s[8:9] offset:1024
    s_add_u32 m0, m0, 2048
    v_add_u32 v8, 2048, v8
    global_load_lds_dwordx4 v8, s[8:9] offset:0
    global_load_lds_dwordx4 v8, s[8:9] offset:1024
    s_add_u32 m0, m0, 2048
    v_add_u32 v8, 2048, v8
    s_mov_b32 m0, 33792
    s_nop 0
    global_load_lds_dwordx4 v7, s[10:11] offset:0
    global_load_lds_dwordx4 v7, s[10:11] offset:1024
    s_add_u32 m0, m0, 2048
    v_add_u32 v7, 2048, v7
    global_load_lds_dwordx4 v7, s[10:11] offset:0
    global_load_lds_dwordx4 v7, s[10:11] offset:1024
    s_add_u32 m0, m0, 2048
    v_add_u32 v7, 2048, v7
    global_load_lds_dwordx4 v7, s[10:11] offset:0
    global_load_lds_dwordx4 v7, s[10:11] offset:1024
    s_add_u32 m0, m0, 2048
    v_add_u32 v7, 2048, v7
    s_barrier
    global_load_lds_dwordx4 v7, s[10:11] offset:0
    global_load_lds_dwordx4 v7, s[10:11] offset:1024
    s_add_u32 m0, m0, 2048
    v_add_u32 v7, 2048, v7
    global_load_lds_dwordx4 v7, s[10:11] offset:0
    global_load_lds_dwordx4 v7, s[10:11] offset:1024
    s_add_u32 m0, m0, 2048
    v_add_u32 v7, 2048, v7
    global_load_lds_dwordx4 v7, s[10:11] offset:0
    global_load_lds_dwordx4 v7, s[10:11] offset:1024
    s_add_u32 m0, m0, 2048
    v_add_u32 v7, 2048, v7
    global_load_lds_dwordx4 v7, s[10:11] offset:0
    global_load_lds_dwordx4 v7, s[10:11] offset:1024
    s_add_u32 m0, m0, 2048
    v_add_u32 v7, 2048, v7
    global_load_lds_dwordx4 v7, s[10:11] offset:0
    global_load_lds_dwordx4 v7, s[10:11] offset:1024
    s_add_u32 m0, m0, 2048
    v_add_u32 v7, 2048, v7
    global_load_lds_dwordx4 v7, s[10:11] offset:0
    global_load_lds_dwordx4 v7, s[10:11] offset:1024
    s_add_u32 m0, m0, 2048
    v_add_u32 v7, 2048, v7
    global_load_lds_dwordx4 v7, s[10:11] offset:0
    global_load_lds_dwordx4 v7, s[10:11] offset:1024
    s_add_u32 m0, m0, 2048
    v_add_u32 v7, 2048, v7
    global_load_lds_dwordx4 v7, s[10:11] offset:0
    global_load_lds_dwordx4 v7, s[10:11] offset:1024
    s_add_u32 m0, m0, 2048
    v_add_u32 v7, 2048, v7
    global_load_lds_dwordx4 v7, s[10:11] offset:0
    global_load_lds_dwordx4 v7, s[10:11] offset:1024
    s_add_u32 m0, m0, 2048
    v_add_u32 v7, 2048, v7
    global_load_lds_dwordx4 v7, s[10:11] offset:0
    global_load_lds_dwordx4 v7, s[10:11] offset:1024
    s_add_u32 m0, m0, 2048
    v_add_u32 v7, 2048, v7
    global_load_lds_dwordx4 v7, s[10:11] offset:0
    global_load_lds_dwordx4 v7, s[10:11] offset:1024
    s_add_u32 m0, m0, 2048
    v_add_u32 v7, 2048, v7
    global_load_lds_dwordx4 v7, s[10:11] offset:0
    global_load_lds_dwordx4 v7, s[10:11] offset:1024
    s_add_u32 m0, m0, 2048
    v_add_u32 v7, 2048, v7
    global_load_lds_dwordx4 v7, s[10:11] offset:0
    global_load_lds_dwordx4 v7, s[10:11] offset:1024
    s_add_u32 m0, m0, 2048
    v_add_u32 v7, 2048, v7
    global_load_lds_dwordx4 v7, s[10:11] offset:0
    global_load_lds_dwordx4 v7, s[10:11] offset:1024
    s_add_u32 m0, m0, 2048
    v_add_u32 v7, 2048, v7
    global_load_lds_dwordx4 v7, s[10:11] offset:0
    global_load_lds_dwordx4 v7, s[10:11] offset:1024
    s_add_u32 m0, m0, 2048
    v_add_u32 v7, 2048, v7
    global_load_lds_dwordx4 v7, s[10:11] offset:0
    global_load_lds_dwordx4 v7, s[10:11] offset:1024
    s_add_u32 m0, m0, 2048
    v_add_u32 v7, 2048, v7
    global_load_lds_dwordx4 v7, s[10:11] offset:0
    global_load_lds_dwordx4 v7, s[10:11] offset:1024
    s_add_u32 m0, m0, 2048
    v_add_u32 v7, 2048, v7
    s_mov_b32 s35, m0
    s_mov_b32 m0, 148480
    v_lshlrev_b32 v9, 4, v1
    v_add_u32 v10, 4096, v9
    s_waitcnt lgkmcnt(0)
    global_load_lds_dwordx4 v9, s[38:39]
    global_load_lds_dwordx4 v9, s[38:39] offset:1024
    global_load_lds_dwordx4 v9, s[38:39] offset:2048
    global_load_lds_dwordx4 v9, s[38:39] offset:3072
    s_mov_b32 m0, 152576
    s_nop 0
    global_load_lds_dwordx4 v10, s[38:39]
    global_load_lds_dwordx4 v10, s[38:39] offset:1024
    global_load_lds_dwordx4 v10, s[38:39] offset:2048
    global_load_lds_dwordx4 v10, s[38:39] offset:3072
    s_mov_b32 m0, 156672
    s_mov_b64 exec, 0xff
    global_load_lds_dwordx4 v9, s[36:37]
    s_mov_b64 exec, -1
    s_mov_b32 m0, s35
    s_waitcnt vmcnt(0)
    s_barrier
    s_branch mn_start
ka_cell:
    s_and_b32 s28, s2, 7
    s_lshl_b32 s28, s28, 4
    s_lshr_b32 s29, s2, 3
    s_add_u32 s28, s28, s29
    s_waitcnt lgkmcnt(0)
    s_and_b32 s21, s15, 0xffff
    s_mov_b32 s22, 12582912
    s_mov_b32 s23, 0x20000
    s_mov_b32 s20, s14
    s_lshl_b32 s30, s28, 6
    s_add_u32 s30, s30, 8388608
    v_lshlrev_b32 v3, 3, v1
    v_mov_b32 v4, 0
    v_mov_b32 v5, 0
    ds_write_b64 v3, v[4:5]
    v_lshlrev_b32 v26, 4, v1
    v_lshrrev_b32 v6, 2, v1
    v_lshlrev_b32 v6, 13, v6
    v_and_or_b32 v6, v26, 0x30, v6
    v_lshlrev_b32 v27, 8, v1
    s_waitcnt lgkmcnt(0)
    s_barrier
    s_and_b32 s58, s2, 15
    s_lshl_b32 s58, s58, 7
    s_add_u32 s58, s58, 11730944
    v_mov_b32 v86, s58
    global_load_dword v87, v86, s[14:15] sc1
    s_barrier
    ds_read_b128 v[12:15], v26 offset:1024
    s_waitcnt lgkmcnt(0)
    v_add_u32 v17, v12, v13
    v_add_u32 v18, v17, v14
    v_add_u32 v16, v18, v15
    v_mov_b32 v19, v16
    v_lshlrev_b32 v20, 16, v12
    v_add_u32_dpp v16, v16, v16 row_shr:1 row_mask:0xf bank_mask:0xf
    v_lshl_add_u32 v21, v13, 16, v12
    s_nop 0
    v_add_u32_dpp v16, v16, v16 row_shr:2 row_mask:0xf bank_mask:0xf
    v_lshl_add_u32 v22, v14, 16, v17
    s_nop 0
    v_add_u32_dpp v16, v16, v16 row_shr:4 row_mask:0xf bank_mask:0xf
    v_lshl_add_u32 v23, v15, 16, v18
    s_nop 0
    v_add_u32_dpp v16, v16, v16 row_shr:8 row_mask:0xf bank_mask:0xf
    s_nop 1
    v_add_u32_dpp v16, v16, v16 row_bcast:15 row_mask:0xa bank_mask:0xf
    s_nop 1
    v_add_u32_dpp v16, v16, v16 row_bcast:31 row_mask:0xc bank_mask:0xf
    v_sub_u32 v16, v16, v19
    v_mov_b32 v86, 0
    s_waitcnt vmcnt(0)
    ds_write_b32 v86, v87 offset:456
    v_add_u32 v20, v20, v16
    ds_write_b32 v27, v20 offset:12348
    v_add_u32 v21, v21, v16
    ds_write_b32 v27, v21 offset:12412
    v_add_u32 v22, v22, v16
    ds_write_b32 v27, v22 offset:12476
    v_add_u32 v23, v23, v16
    ds_write_b32 v27, v23 offset:12540
    ds_read_b128 v[28:31], v26 offset:12288
    ds_read_b128 v[32:35], v26 offset:13312
    ds_read_b128 v[36:39], v26 offset:14336
    ds_read_b128 v[40:43], v26 offset:15360
    ds_read_b128 v[44:47], v26 offset:16384
    ds_read_b128 v[48:51], v26 offset:17408
    ds_read_b128 v[52:55], v26 offset:18432
    ds_read_b128 v[56:59], v26 offset:19456
    s_waitcnt lgkmcnt(7)
    buffer_store_dwordx4 v[28:31], v6, s[20:23], s30 offen sc1
    ds_read_b128 v[60:63], v26 offset:20480
    s_add_u32 s30, s30, 131072
    s_waitcnt lgkmcnt(7)
    buffer_store_dwordx4 v[32:35], v6, s[20:23], s30 offen sc1
    ds_read_b128 v[64:67], v26 offset:21504
    s_add_u32 s30, s30, 131072
    s_waitcnt lgkmcnt(7)
    buffer_store_dwordx4 v[36:39], v6, s[20:23], s30 offen sc1
    ds_read_b128 v[68:71], v26 offset:22528
    s_add_u32 s30, s30, 131072
    s_waitcnt lgkmcnt(7)
    buffer_store_dwordx4 v[40:43], v6, s[20:23], s30 offen sc1
    ds_read_b128 v[72:75], v26 offset:23552
    s_add_u32 s30, s30, 131072
    s_waitcnt lgkmcnt(7)
    buffer_store_dwordx4 v[44:47], v6, s[20:23], s30 offen sc1
    ds_read_b128 v[76:79], v26 offset:24576
    s_add_u32 s30, s30, 131072
    s_waitcnt lgkmcnt(7)
    buffer_store_dwordx4 v[48:51], v6, s[20:23], s30 offen sc1
    ds_read_b128 v[80:83], v26 offset:25600
    s_add_u32 s30, s30, 131072
    s_waitcnt lgkmcnt(7)
    buffer_store_dwordx4 v[52:55], v6, s[20:23], s30 offen sc1
    ds_read_b128 v[28:31], v26 offset:26624
    s_add_u32 s30, s30, 131072
    s_waitcnt lgkmcnt(7)
    buffer_store_dwordx4 v[56:59], v6, s[20:23], s30 offen sc1
    ds_read_b128 v[32:35], v26 offset:27648
    s_add_u32 s30, s30, 131072
    s_waitcnt lgkmcnt(7)
    buffer_store_dwordx4 v[60:63], v6, s[20:23], s30 offen sc1
    s_add_u32 s30, s30, 131072
    s_waitcnt lgkmcnt(6)
    buffer_store_dwordx4 v[64:67], v6, s[20:23], s30 offen sc1
    s_add_u32 s30, s30, 131072
    s_waitcnt lgkmcnt(5)
    buffer_store_dwordx4 v[68:71], v6, s[20:23], s30 offen sc1
    s_add_u32 s30, s30, 131072
    s_waitcnt lgkmcnt(4)
    buffer_store_dwordx4 v[72:75], v6, s[20:23], s30 offen sc1
    s_add_u32 s30, s30, 131072
    s_waitcnt lgkmcnt(3)
    buffer_store_dwordx4 v[76:79], v6, s[20:23], s30 offen sc1
    s_add_u32 s30, s30, 131072
    s_waitcnt lgkmcnt(2)
    buffer_store_dwordx4 v[80:83], v6, s[20:23], s30 offen sc1
    s_add_u32 s30, s30, 131072
    s_waitcnt lgkmcnt(1)
    buffer_store_dwordx4 v[28:31], v6, s[20:23], s30 offen sc1
    s_add_u32 s30, s30, 131072
    s_waitcnt lgkmcnt(0)
    buffer_store_dwordx4 v[32:35], v6, s[20:23], s30 offen sc1
    s_barrier
    s_waitcnt vmcnt(0)
    s_mov_b64 exec, 1
    v_mov_b32 v2, 0
    v_mov_b32 v3, 1
    s_and_b32 s34, s2, 1
    s_lshl_b32 s35, s34, 7
    s_add_u32 s35, s35, 0
    s_mov_b32 s33, 1
    s_atomic_add s33, s[12:13], s35 glc
    s_mov_b32 s36, 1
    s_lshl_b32 s34, s34, 3
    s_lshr_b32 s34, 15678, s34
    s_and_b32 s34, s34, 0xff
    s_waitcnt lgkmcnt(0)
    s_cmp_eq_u32 s33, s34
    s_cbranch_scc1 ka_bcast
ka_arc:
    s_mov_b64 exec, -1
    s_branch mn_start
ka_pf:
    s_load_dwordx2 s[16:17], s[0:1], 0
    s_load_dwordx2 s[32:33], s[0:1], 56
    s_waitcnt lgkmcnt(0)
    s_and_b32 s34, s2, 7
    s_mul_i32 s34, s34, 1048576
    s_add_u32 s24, s16, s34
    s_addc_u32 s25, s17, 0
    s_and_b32 s25, s25, 0xffff
    s_mov_b32 s26, 1048576
    s_mov_b32 s27, 0x20000
    s_bfe_u32 s30, s2, 0x40003
    v_lshlrev_b32 v40, 7, v0
    s_mul_i32 s30, s30, 65536
    s_cmp_lg_u32 s18, 9
    s_cbranch_scc1 ka_nowt
    s_bfe_u32 s35, s2, 0x40003
    s_lshl_b32 s35, s35, 13
    v_lshl_add_u32 v46, v1, 7, s35
    global_load_dword v46, v46, s[32:33]
ka_nowt:
ka_pf1:
    s_cmp_ge_u32 s18, 8
    s_cbranch_scc1 ka_pfe
    s_waitcnt vmcnt(0)
    buffer_load_dword v42, v40, s[24:27], s30 offen
    s_cmp_ge_u32 s18, 0
    s_cbranch_scc1 ka_pfe
    s_add_u32 s30, s30, 81920
    buffer_load_dword v43, v40, s[24:27], s30 offen
    s_branch ka_pfe
ka_idle:
    s_waitcnt lgkmcnt(0)
ka_pfe:
    s_cmp_lt_u32 s18, 10
    s_cbranch_scc1 ka_pfb
    s_cmp_eq_u32 s18, 11
    s_cbranch_scc1 ka_pfz
    s_load_dwordx4 s[36:39], s[0:1], 40
    s_mov_b32 m0, 148480
    v_lshlrev_b32 v9, 4, v1
    v_add_u32 v10, 4096, v9
    s_waitcnt lgkmcnt(0)
    global_load_lds_dwordx4 v9, s[38:39]
    global_load_lds_dwordx4 v9, s[38:39] offset:1024
    global_load_lds_dwordx4 v9, s[38:39] offset:2048
    global_load_lds_dwordx4 v9, s[38:39] offset:3072
    s_mov_b32 m0, 152576
    s_nop 0
    global_load_lds_dwordx4 v10, s[38:39]
    global_load_lds_dwordx4 v10, s[38:39] offset:1024
    global_load_lds_dwordx4 v10, s[38:39] offset:2048
    global_load_lds_dwordx4 v10, s[38:39] offset:3072
    s_mov_b32 m0, 156672
    s_mov_b64 exec, 0xff
    global_load_lds_dwordx4 v9, s[36:37]
    s_mov_b64 exec, -1
    s_waitcnt vmcnt(0)
    s_branch ka_pfb
ka_pfz:
    s_and_b32 s58, s2, 15
    s_lshl_b32 s58, s58, 7
    s_add_u32 s58, s58, 11730944
    v_mov_b32 v86, s58
    global_load_dword v87, v86, s[14:15] sc1
    v_lshlrev_b32 v3, 3, v1
    v_mov_b32 v4, 0
    v_mov_b32 v5, 0
    ds_write_b64 v3, v[4:5]
    v_mov_b32 v86, 0
    s_waitcnt vmcnt(0)
    ds_write_b32 v86, v87 offset:456
    s_waitcnt lgkmcnt(0)
ka_pfb:
    s_barrier
    s_branch mn_start
ka_bcast:
    s_mov_b64 exec, -1
    s_add_u32 s34, s14, 11730944
    s_addc_u32 s35, s15, 0
    s_atomic_add s36, s[34:35], 0
    s_atomic_add s36, s[34:35], 128
    s_atomic_add s36, s[34:35], 256
    s_atomic_add s36, s[34:35], 384
    s_atomic_add s36, s[34:35], 512
    s_atomic_add s36, s[34:35], 640
    s_atomic_add s36, s[34:35], 768
    s_atomic_add s36, s[34:35], 896
    s_atomic_add s36, s[34:35], 1024
    s_atomic_add s36, s[34:35], 1152
    s_atomic_add s36, s[34:35], 1280
    s_atomic_add s36, s[34:35], 1408
    s_atomic_add s36, s[34:35], 1536
    s_atomic_add s36, s[34:35], 1664
    s_atomic_add s36, s[34:35], 1792
    s_atomic_add s36, s[34:35], 1920
    s_branch mn_start
ka_end:
    s_endpgm
mn_start:
    s_waitcnt vmcnt(0) lgkmcnt(0)
mn_start2:
    s_cmp_ge_u32 s2, 256
    s_cbranch_scc1 mn_end
    s_load_dwordx2 s[54:55], s[0:1], 80
    s_load_dwordx2 s[50:51], s[0:1], 0
    s_load_dwordx2 s[60:61], s[0:1], 72
    v_lshrrev_b32 v56, 6, v0
    s_and_b32 s48, s2, 7
    v_readfirstlane_b32 s16, v56
    s_lshr_b32 s47, s2, 3
    s_lshl_b32 s22, s48, 5
    s_add_u32 s22, s22, s47
    s_lshl_b32 s22, s22, 13
    s_add_u32 s22, s22, 8388608
    s_mov_b32 s10, 12582912
    s_mov_b32 s11, 0x20000
    s_and_b32 s17, s16, 3
    s_movk_i32 s20, 20
    s_mov_b32 s24, 0
    s_cmp_ge_u32 s16, 8
    s_cbranch_scc1 gm_main
    v_lshrrev_b32 v56, 6, v0
    v_lshlrev_b32 v55, 1, v0
    v_and_b32 v55, 0x78, v55
    v_or_b32 v55, v55, v56
    v_cmp_gt_u32 vcc, 125, v55
    v_mul_u32_u24 v46, 5120, v55
    v_add_u32 v46, 7340032, v46
    v_bfrev_b32 v56, 2
    v_lshlrev_b32 v44, 4, v0
    v_cndmask_b32 v44, v56, v44, vcc
    v_and_b32 v51, 63, v0
    s_waitcnt lgkmcnt(0)
    s_mov_b32 s8, s54
    s_and_b32 s9, s55, 0xffff
    v_mov_b32 v24, 0
    s_lshr_b32 s18, s16, 2
    s_lshl_b32 s53, s17, 7
    s_add_u32 s4, s50, s53
    s_addc_u32 s5, s51, 0
    s_and_b32 s5, s5, 0xffff
    s_or_b32 s5, s5, 0x08000000
    s_movk_i32 s6, 10000
    s_mov_b32 s7, 0x20000
    s_sub_u32 s12, s4, 1024
    s_subb_u32 s13, s5, 0
    s_movk_i32 s14, 10000
    s_mov_b32 s15, 0x20000
    s_mul_i32 s40, s16, 15360
    s_add_u32 s40, s40, 40960
    v_lshl_add_u32 v87, v51, 3, s40
    s_add_u32 s40, s40, 9216
    s_add_u32 s41, s40, 1024
    s_add_u32 s42, s40, 2048
    s_add_u32 s43, s40, 3072
    s_add_u32 s44, s40, 4096
    s_add_u32 s45, s40, 5120
    v_and_b32 v55, 3, v0
    v_bfe_u32 v56, v0, 2, 2
    v_bfe_u32 v57, v0, 4, 1
    v_bfe_u32 v53, v0, 5, 1
    v_lshlrev_b32 v1, 3, v55
    v_lshl_add_u32 v1, v57, 5, v1
    v_lshl_add_u32 v1, v56, 6, v1
    v_lshl_add_u32 v1, v53, 8, v1
    v_add_u32 v1, s40, v1
    v_lshlrev_b32 v5, 4, v55
    v_lshl_add_u32 v5, v57, 6, v5
    v_lshl_add_u32 v5, v56, 9, v5
    v_mov_b32 v7, v5
    v_bfe_u32 v55, v0, 2, 1
    v_lshlrev_b32 v86, 4, v53
    v_lshl_or_b32 v86, v55, 18, v86
    v_mov_b32 v48, 1
    v_lshlrev_b32 v47, 2, v51
    v_bfe_u32 v2, v0, 5, 1
    v_bfe_u32 v3, v0, 3, 2
    v_and_b32 v35, 3, v0
    v_lshl_add_u32 v3, v3, 2, v35
    v_mul_u32_u24 v49, 20, v2
    v_lshrrev_b32 v18, 2, v51
    v_lshl_add_u32 v18, v35, 4, v18
    v_mov_b32 v50, 0x3fff
    s_lshl_b32 s37, s16, 2
    v_mov_b32 v59, s37
    s_sub_u32 s36, s16, 1
    v_mov_b64 v[88:89], 0
    v_mov_b64 v[90:91], 0
    v_mov_b64 v[92:93], 0
    v_mov_b64 v[94:95], 0
    v_mov_b64 v[96:97], 0
    v_mov_b64 v[98:99], 0
    v_mov_b64 v[100:101], 0
    v_mov_b64 v[102:103], 0
    v_mov_b64 v[104:105], 0
    v_mov_b64 v[106:107], 0
    v_mov_b64 v[108:109], 0
    v_mov_b64 v[110:111], 0
    v_mov_b64 v[112:113], 0
    v_mov_b64 v[114:115], 0
    v_mov_b64 v[116:117], 0
    v_mov_b64 v[118:119], 0
    v_mov_b64 v[120:121], 0
    v_mov_b64 v[122:123], 0
    v_mov_b64 v[124:125], 0
    v_mov_b64 v[126:127], 0
    v_mov_b64 v[128:129], 0
    v_mov_b64 v[130:131], 0
    v_mov_b64 v[132:133], 0
    v_mov_b64 v[134:135], 0
    v_mov_b64 v[136:137], 0
    v_mov_b64 v[138:139], 0
    v_mov_b64 v[140:141], 0
    v_mov_b64 v[142:143], 0
    v_mov_b64 v[144:145], 0
    v_mov_b64 v[146:147], 0
    v_mov_b64 v[148:149], 0
    v_mov_b64 v[150:151], 0
    v_mov_b64 v[152:153], 0
    v_mov_b64 v[154:155], 0
    v_mov_b64 v[156:157], 0
    v_mov_b64 v[158:159], 0
    v_mov_b64 v[160:161], 0
    v_mov_b64 v[162:163], 0
    v_mov_b64 v[164:165], 0
    v_mov_b64 v[166:167], 0
    v_bfe_u32 v8, v0, 2, 2
    v_bfe_u32 v10, v0, 5, 1
    v_lshlrev_b32 v9, 3, v8
    v_add_u32 v9, 156672, v9
    v_lshl_add_u32 v8, v10, 3, v8
    v_lshlrev_b32 v8, 9, v8
    v_bfe_u32 v10, v0, 4, 1
    v_lshl_add_u32 v8, v10, 5, v8
    v_lshl_add_u32 v8, v35, 3, v8
    v_lshl_add_u32 v8, s17, 7, v8
    v_add_u32 v8, 148480, v8
    ds_read_b64_tr_b16 v[76:77], v9
    ds_read_b64_tr_b16 v[78:79], v9 offset:32
    ds_read_b64_tr_b16 v[80:81], v9 offset:64
    ds_read_b64_tr_b16 v[82:83], v9 offset:96
    ds_read_b64_tr_b16 v[68:69], v8
    ds_read_b64_tr_b16 v[70:71], v8 offset:2048
    ds_read_b64_tr_b16 v[72:73], v8 offset:64
    ds_read_b64_tr_b16 v[74:75], v8 offset:2112
    s_cmp_ge_u32 s2, 125
    s_waitcnt vmcnt(0)
    s_cbranch_scc1 mn_noarr
    v_mov_b32 v55, 0
    v_mov_b32 v56, 1
    s_mov_b64 exec, 1
    ds_add_u32 v55, v56 offset:448
    s_mov_b64 exec, -1
mn_noarr:
    s_cmp_lg_u32 s16, 7
    s_cbranch_scc1 mn_sp1
    v_mov_b32 v57, 0
    ds_read_b32 v57, v57 offset:456
    s_waitcnt lgkmcnt(0)
    v_readfirstlane_b32 s59, v57
    s_and_b32 s62, s2, 15
    s_lshl_b32 s62, s62, 7
    s_add_u32 s62, s62, 11730944
    v_mov_b32 v55, s62
    v_lshlrev_b32 v56, 6, v0
    v_and_b32 v56, 0xc0, v56
    s_mov_b32 s63, 0x100000
mn_poll1m:
    s_sub_u32 s63, s63, 1
    s_cbranch_scc1 mn_poll1x
    global_load_dword v57, v55, s[54:55] sc1
    s_waitcnt vmcnt(0)
    v_readfirstlane_b32 s62, v57
    s_sub_u32 s62, s62, s59
    s_bfe_u32 s62, s62, 1048576
    s_cmp_eq_u32 s62, 2
    s_cbranch_scc1 mn_poll1x
    s_sleep 6
    s_and_b32 s62, s63, 63
    s_cbranch_scc1 mn_poll1m
    global_load_dword v57, v56, s[60:61] sc1
    s_waitcnt vmcnt(0)
    v_add_u32_dpp v57, v57, v57 quad_perm:[2,3,0,1] row_mask:0xf bank_mask:0xf
    s_nop 0
    v_readlane_b32 s62, v57, 0
    s_cmp_lt_u32 s62, 125
    s_cbranch_scc1 mn_poll1m
mn_poll1x:
    v_mov_b32 v55, 0
    ds_write_b32 v55, v48 offset:308
mn_sp1x:
    buffer_load_dwordx4 v[20:23], v44, s[8:11], s22 offen sc1
    s_mov_b32 s52, 0x100000
    s_waitcnt vmcnt(0)
    v_mov_b32_dpp v58, v23 quad_perm:[3,3,3,3] row_mask:0xf bank_mask:0xf
    v_cmp_le_u32 vcc, s52, v58
    s_cbranch_vccnz mn_w5
mn_count:
    v_cmpx_gt_i32 vcc, 0, v20
    s_cbranch_execz mn_cn_done
    v_lshrrev_b32 v25, 23, v20
    v_and_b32 v25, 0xfc, v25
    ds_add_rtn_u32 v30, v25, v48
    v_cmpx_gt_i32 vcc, 0, v21
    s_cbranch_execz mn_cn_done
    v_lshrrev_b32 v26, 23, v21
    v_and_b32 v26, 0xfc, v26
    ds_add_rtn_u32 v31, v26, v48
    v_cmpx_gt_i32 vcc, 0, v22
    s_cbranch_execz mn_cn_done
    v_lshrrev_b32 v27, 23, v22
    v_and_b32 v27, 0xfc, v27
    ds_add_rtn_u32 v32, v27, v48
    v_cmpx_gt_i32 vcc, 0, v23
    s_cbranch_execz mn_cn_done
    v_lshrrev_b32 v28, 23, v23
    v_and_b32 v28, 0xfc, v28
    ds_add_rtn_u32 v33, v28, v48
    v_cmpx_gt_i32 vcc, 0, v24
    s_cbranch_execz mn_cn_done
    v_lshrrev_b32 v29, 23, v24
    v_and_b32 v29, 0xfc, v29
    ds_add_rtn_u32 v34, v29, v48
mn_cn_done:
    s_mov_b64 exec, -1
    v_lshrrev_b32 v42, 16, v58
    v_subrev_u32 v42, s24, v42
    v_med3_i32 v42, v42, 0, s20
    v_mov_b32 v43, v42
    v_mov_b32 v52, 0
    s_lshl_b32 s52, s18, 5
    v_add_u32_dpp v43, v43, v43 row_shr:4 row_mask:0xf bank_mask:0xf
    s_add_u32 s53, s52, 31
    s_movk_i32 s48, 0x3fff
    v_add_u32_dpp v43, v43, v43 row_shr:8 row_mask:0xf bank_mask:0xf
    s_nop 0
    s_nop 0
    v_add_u32_dpp v43, v43, v43 row_bcast:15 row_mask:0xa bank_mask:0xf
    s_nop 0
    s_nop 0
    v_add_u32_dpp v43, v43, v43 row_bcast:31 row_mask:0xc bank_mask:0xf
    s_brev_b64 exec, 1
    ds_write_b32 v59, v43 offset:384
    s_mov_b64 exec, -1
    v_sub_u32 v41, v43, v42
    s_waitcnt lgkmcnt(0)
    s_barrier
    ds_read_b32 v55, v47 offset:384
    ds_read_b32 v53, v47 offset:0
    ds_read_b32 v52, v52 offset:272
    s_waitcnt lgkmcnt(2)
    v_add_u32_dpp v55, v55, v55 row_shr:1 row_mask:0xf bank_mask:0xf
    s_waitcnt lgkmcnt(1)
    v_mov_b32 v54, v53
    v_add_u32_dpp v55, v55, v55 row_shr:2 row_mask:0xf bank_mask:0xf
    v_sub_u32 v53, v49, v53
    v_add_u32 v41, v41, v35
    v_add_u32_dpp v55, v55, v55 row_shr:4 row_mask:0xf bank_mask:0xf
    s_cmp_eq_u32 s16, 0
    v_readlane_b32 s49, v55, s36
    v_readlane_b32 s23, v55, 7
    s_cmov_b32 s49, 0
    s_add_u32 s49, s49, 72
    v_add_u32_dpp v54, v54, v54 row_shr:1 row_mask:0xf bank_mask:0xf
    v_add_u32 v41, s49, v41
    v_lshlrev_b32 v41, 16, v41
    v_add_u32_dpp v54, v54, v54 row_shr:2 row_mask:0xf bank_mask:0xf
    v_and_or_b32 v36, v20, s48, v41
    v_add_u32 v41, 262144, v41
    v_add_u32_dpp v54, v54, v54 row_shr:4 row_mask:0xf bank_mask:0xf
    v_and_or_b32 v37, v21, s48, v41
    v_add_u32 v41, 262144, v41
    v_add_u32_dpp v54, v54, v54 row_shr:8 row_mask:0xf bank_mask:0xf
    v_and_or_b32 v38, v22, s48, v41
    v_add_u32 v41, 262144, v41
    v_add_u32_dpp v54, v54, v54 row_bcast:15 row_mask:0xa bank_mask:0xf
    v_and_or_b32 v39, v23, s48, v41
    v_add_u32 v41, 262144, v41
    v_add_u32_dpp v54, v54, v54 row_bcast:31 row_mask:0xc bank_mask:0xf
    v_add_u32 v53, v53, v54
    v_add_u32 v54, v54, v49
    ds_bpermute_b32 v25, v25, v53
    ds_bpermute_b32 v26, v26, v53
    ds_bpermute_b32 v27, v27, v53
    ds_bpermute_b32 v28, v28, v53
    ds_bpermute_b32 v29, v29, v53
    v_and_or_b32 v40, v24, s48, v41
    v_bfe_u32 v56, v20, 14, 5
    v_lshl_or_b32 v36, v56, 26, v36
    v_bfe_u32 v56, v21, 14, 5
    v_lshl_or_b32 v37, v56, 26, v37
    v_bfe_u32 v56, v22, 14, 5
    v_lshl_or_b32 v38, v56, 26, v38
    v_bfe_u32 v56, v23, 14, 5
    v_lshl_or_b32 v39, v56, 26, v39
    v_bfe_u32 v56, v24, 14, 5
    v_lshl_or_b32 v40, v56, 26, v40
    v_readlane_b32 s33, v54, s53
    v_readlane_b32 s32, v53, s52
    s_cmp_gt_u32 s23, 773
    s_cbranch_scc1 mn_ovf
    v_add_lshl_u32 v55, s33, v51, 2
    s_mov_b32 exec_lo, 1048575
    s_mov_b32 exec_hi, 0
    ds_write_b32 v55, v50 offset:512
    s_mov_b64 exec, -1
    v_add_lshl_u32 v2, s32, v2, 2
    v_add_lshl_u32 v3, s32, v3, 2
    v_add_lshl_u32 v18, s32, v18, 2
    s_waitcnt lgkmcnt(1)
    v_readfirstlane_b32 s21, v52
    v_cmpx_gt_i32 vcc, 0, v20
    s_cbranch_execz mn_w2_done
    v_add_lshl_u32 v25, v25, v30, 2
    ds_write_b32 v25, v36 offset:512
    v_cmpx_gt_i32 vcc, 0, v21
    s_cbranch_execz mn_w2_done
    v_add_lshl_u32 v26, v26, v31, 2
    ds_write_b32 v26, v37 offset:512
    v_cmpx_gt_i32 vcc, 0, v22
    s_cbranch_execz mn_w2_done
    v_add_lshl_u32 v27, v27, v32, 2
    ds_write_b32 v27, v38 offset:512
    v_cmpx_gt_i32 vcc, 0, v23
    s_cbranch_execz mn_w2_done
    v_add_lshl_u32 v28, v28, v33, 2
    ds_write_b32 v28, v39 offset:512
    v_cmpx_gt_i32 vcc, 0, v24
    s_cbranch_execz mn_w2_done
    v_add_lshl_u32 v29, v29, v34, 2
    ds_write_b32 v29, v40 offset:512
mn_w2_done:
    s_mov_b64 exec, -1
    s_mov_b32 m0, s40
    s_sub_u32 s32, s32, 3
    s_sub_u32 s57, s33, s32
    s_lshr_b32 s57, s57, 2
    s_waitcnt lgkmcnt(0)
    s_barrier
    ds_read_u16 v4, v2 offset:512
    ds_read_u16 v6, v2 offset:520
    ds_read_u16 v8, v18 offset:514
    ds_read_u16 v84, v3 offset:514
    ds_read_u16 v22, v2 offset:528
    ds_read_u16 v23, v2 offset:536
    ds_read_u16 v24, v2 offset:544
    ds_read_u16 v25, v2 offset:552
    ds_read_u16 v26, v2 offset:560
    ds_read_u16 v27, v2 offset:568
    s_sub_u32 s53, s53, 4
    v_readlane_b32 s84, v54, s53
    s_add_u32 s53, s53, 1
    v_readlane_b32 s85, v54, s53
    s_add_u32 s53, s53, 1
    v_readlane_b32 s86, v54, s53
    s_add_u32 s53, s53, 1
    v_readlane_b32 s87, v54, s53
    s_waitcnt lgkmcnt(8)
    buffer_load_dwordx4 v[4:5], s[4:7], 0 idxen offen lds
    s_mov_b32 m0, s41
    s_waitcnt lgkmcnt(6)
    buffer_load_dwordx4 v[6:7], s[4:7], 0 idxen offen lds
    v_lshrrev_b32 v11, 8, v8
    v_and_b32 v8, 0x3ff, v8
    v_mul_u32_u24 v8, 48, v8
    v_and_b32 v84, 0x3ff, v84
    v_mad_u32_u24 v84, v84, 48, v86
    v_xor_b32 v85, 0x40000, v84
    s_waitcnt lgkmcnt(0)
    s_mov_b32 m0, s42
    v_mov_b32 v4, v22
    buffer_load_dwordx4 v[4:5], s[4:7], 0 idxen offen lds
    s_mov_b32 m0, s43
    v_mov_b32 v4, v23
    buffer_load_dwordx4 v[4:5], s[4:7], 0 idxen offen lds
    s_mov_b32 m0, s44
    v_mov_b32 v4, v24
    buffer_load_dwordx4 v[4:5], s[4:7], 0 idxen offen lds
    s_mov_b32 m0, s45
    v_mov_b32 v4, v25
    buffer_load_dwordx4 v[4:5], s[4:7], 0 idxen offen lds
    s_sub_u32 s84, s84, s32
    s_lshr_b32 s84, s84, 2
    s_sub_u32 s85, s85, s32
    s_lshr_b32 s85, s85, 2
    s_sub_u32 s86, s86, s32
    s_lshr_b32 s86, s86, 2
    s_sub_u32 s87, s87, s32
    s_lshr_b32 s87, s87, 2
    s_sub_u32 s88, s57, s87
    s_sub_u32 s87, s87, s86
    s_sub_u32 s86, s86, s85
    s_sub_u32 s85, s85, s84
    s_cmp_lg_u32 s21, 0
    s_cselect_b32 s19, s57, s84
    s_mov_b32 s58, 0
    s_mov_b32 s35, 0
    s_sub_i32 s34, s57, 4
    s_max_i32 s34, s34, 0
    v_min_u32 v0, 1, v51
    v_lshlrev_b32 v0, 18, v0
    v_lshl_add_u32 v0, s17, 2, v0
    s_lshl_b32 s52, s18, 1
    s_sub_i32 s52, 1, s52
    s_mul_i32 s53, s52, s57
    s_add_i32 s53, s53, 0
    v_mov_b32 v19, s53
    ds_add_u32 v0, v19 offset:288
    s_mul_i32 s30, s52, -4
    s_lshl_b32 s26, s18, 31
    s_setprio 2
    v_and_b32 v11, 0x7c, v11
    v_or_b32 v11, 0xc000, v11
    v_lshlrev_b32 v10, 16, v11
    s_nop 1
    v_or_b32_dpp v19, v10, v11 row_shl:4 row_mask:0xf bank_mask:0xf bound_ctrl:0
    s_barrier
    ds_read_b64 v[8:9], v8 offset:352
    ds_read_b128 v[60:63], v84 offset:320
    ds_read_b128 v[64:67], v85 offset:320
    v_mov_b32 v4, v26
    v_mov_b32 v6, v27
    s_waitcnt lgkmcnt(2)
    v_mfma_f32_4x4x4_16b_bf16 v[28:31], v[8:9], v[76:77], 0
    v_mfma_f32_4x4x4_16b_bf16 v[32:35], v[8:9], v[78:79], 0
    v_mfma_f32_4x4x4_16b_bf16 v[36:39], v[8:9], v[80:81], 0
    v_mfma_f32_4x4x4_16b_bf16 v[40:43], v[8:9], v[82:83], 0
    s_waitcnt lgkmcnt(0)
    v_mfma_f32_32x32x16_bf16 v[44:59], v[60:63], v[68:71], 0
    v_mfma_f32_32x32x16_bf16 v[44:59], v[64:67], v[72:75], v[44:59]
    s_waitcnt vmcnt(4)
    ds_read_b64_tr_b16 v[20:21], v1 offset:0
    ds_read_b64_tr_b16 v[22:23], v1 offset:512
    ds_read_b64_tr_b16 v[24:25], v1 offset:1024
    ds_read_b64_tr_b16 v[26:27], v1 offset:1536
    v_cvt_pk_bf16_f32 v12, v28, v32
    v_cvt_pk_bf16_f32 v14, v29, v33
    v_cvt_pk_bf16_f32 v16, v30, v34
    v_cvt_pk_bf16_f32 v13, v36, v40
    v_cvt_pk_bf16_f32 v15, v37, v41
    v_cvt_pk_bf16_f32 v17, v38, v42
    s_set_gpr_idx_on s40, gpr_idx(SRC2,DST)
    s_mov_b32 m0, s40
    s_waitcnt lgkmcnt(2)
    buffer_load_dwordx4 v[4:5], s[4:7], 0 idxen offen lds
    s_mov_b32 m0, s41
    s_waitcnt lgkmcnt(0)
    buffer_load_dwordx4 v[6:7], s[4:7], 0 idxen offen lds
    s_sub_u32 s19, s19, 1
    s_cbranch_scc1 mn_st12
mn_st12_back:
mn_loop:
    v_mfma_f32_4x4x4_16b_bf16 v[28:31], v[12:13], v[20:21], 0 cbsz:4 abid:0
    v_mfma_f32_4x4x4_16b_bf16 v[32:35], v[12:13], v[22:23], 0 cbsz:4 abid:1
    v_mfma_f32_4x4x4_16b_bf16 v[36:39], v[12:13], v[24:25], 0 cbsz:4 abid:2
    v_mfma_f32_4x4x4_16b_bf16 v[40:43], v[12:13], v[26:27], 0 cbsz:4 abid:3
    ds_read_u16 v4, v2 offset:576
    ds_read_u16 v6, v2 offset:584
    v_readlane_b32 s28, v19, 0
    v_readlane_b32 s29, v19, 8
    s_waitcnt vmcnt(4)
    ds_read_b64_tr_b16 v[20:21], v1 offset:2048
    ds_read_b64_tr_b16 v[22:23], v1 offset:2560
    ds_read_b64_tr_b16 v[24:25], v1 offset:3072
    ds_read_b64_tr_b16 v[26:27], v1 offset:3584
    s_sub_u32 s34, s34, 1
    s_cmov_b32 s35, 0x30000
    s_mov_b32 m0, s28
    v_fmac_f32 v88, v28, v44
    v_fmac_f32 v89, v29, v44
    v_fmac_f32 v90, v30, v44
    v_fmac_f32 v91, v31, v44
    s_lshr_b32 m0, s28, 16
    v_fmac_f32 v88, v32, v45
    v_fmac_f32 v89, v33, v45
    v_fmac_f32 v90, v34, v45
    v_fmac_f32 v91, v35, v45
    s_mov_b32 m0, s29
    v_fmac_f32 v88, v36, v46
    v_fmac_f32 v89, v37, v46
    v_fmac_f32 v90, v38, v46
    v_fmac_f32 v91, v39, v46
    s_lshr_b32 m0, s29, 16
    v_fmac_f32 v88, v40, v47
    v_fmac_f32 v89, v41, v47
    v_fmac_f32 v90, v42, v47
    v_fmac_f32 v91, v43, v47
    s_or_b32 m0, s42, s35
    s_waitcnt lgkmcnt(0)
    buffer_load_dwordx4 v[4:5], s[4:7], 0 idxen offen lds
    buffer_load_dwordx4 v[6:7], s[12:15], 0 idxen offen offset:1024 lds
    s_sub_u32 s19, s19, 1
    s_cbranch_scc1 mn_st0
mn_st0_back:
    v_mfma_f32_4x4x4_16b_bf16 v[28:31], v[12:13], v[20:21], 0 cbsz:4 abid:4
    v_mfma_f32_4x4x4_16b_bf16 v[32:35], v[12:13], v[22:23], 0 cbsz:4 abid:5
    v_mfma_f32_4x4x4_16b_bf16 v[36:39], v[12:13], v[24:25], 0 cbsz:4 abid:6
    v_mfma_f32_4x4x4_16b_bf16 v[40:43], v[12:13], v[26:27], 0 cbsz:4 abid:7
    ds_read_u16 v4, v2 offset:592
    ds_read_u16 v6, v2 offset:600
    v_readlane_b32 s28, v19, 16
    v_readlane_b32 s29, v19, 24
    ds_read_u16 v84, v3 offset:578
    s_waitcnt vmcnt(4)
    ds_read_b64_tr_b16 v[20:21], v1 offset:4096
    ds_read_b64_tr_b16 v[22:23], v1 offset:4608
    ds_read_b64_tr_b16 v[24:25], v1 offset:5120
    ds_read_b64_tr_b16 v[26:27], v1 offset:5632
    s_sub_u32 s34, s34, 1
    s_cmov_b32 s35, 0x30000
    s_mov_b32 m0, s28
    v_fmac_f32 v88, v28, v48
    v_fmac_f32 v89, v29, v48
    v_fmac_f32 v90, v30, v48
    v_fmac_f32 v91, v31, v48
    s_lshr_b32 m0, s28, 16
    v_fmac_f32 v88, v32, v49
    v_fmac_f32 v89, v33, v49
    v_fmac_f32 v90, v34, v49
    v_fmac_f32 v91, v35, v49
    s_mov_b32 m0, s29
    v_fmac_f32 v88, v36, v50
    v_fmac_f32 v89, v37, v50
    v_fmac_f32 v90, v38, v50
    v_fmac_f32 v91, v39, v50
    s_lshr_b32 m0, s29, 16
    v_fmac_f32 v88, v40, v51
    v_fmac_f32 v89, v41, v51
    v_fmac_f32 v90, v42, v51
    v_fmac_f32 v91, v43, v51
    s_or_b32 m0, s44, s35
    s_waitcnt lgkmcnt(0)
    buffer_load_dwordx4 v[4:5], s[4:7], 0 idxen offen lds
    buffer_load_dwordx4 v[6:7], s[12:15], 0 idxen offen offset:1024 lds
    s_sub_u32 s19, s19, 1
    s_cbranch_scc1 mn_st1
mn_st1_back:
    v_mfma_f32_4x4x4_16b_bf16 v[28:31], v[12:13], v[20:21], 0 cbsz:4 abid:8
    v_mfma_f32_4x4x4_16b_bf16 v[32:35], v[12:13], v[22:23], 0 cbsz:4 abid:9
    v_mfma_f32_4x4x4_16b_bf16 v[36:39], v[12:13], v[24:25], 0 cbsz:4 abid:10
    v_mfma_f32_4x4x4_16b_bf16 v[40:43], v[12:13], v[26:27], 0 cbsz:4 abid:11
    ds_read_u16 v4, v2 offset:608
    ds_read_u16 v6, v2 offset:616
    v_readlane_b32 s28, v19, 32
    v_readlane_b32 s29, v19, 40
    v_and_b32 v84, 0x3ff, v84
    v_mad_u32_u24 v84, v84, 48, v86
    v_xor_b32 v85, 0x40000, v84
    ds_read_b128 v[60:63], v84 offset:320
    ds_read_b128 v[64:67], v85 offset:320
    s_waitcnt vmcnt(4)
    ds_read_b64_tr_b16 v[20:21], v1 offset:0
    ds_read_b64_tr_b16 v[22:23], v1 offset:512
    ds_read_b64_tr_b16 v[24:25], v1 offset:1024
    ds_read_b64_tr_b16 v[26:27], v1 offset:1536
    s_sub_u32 s34, s34, 1
    s_cmov_b32 s35, 0x30000
    s_mov_b32 m0, s28
    v_fmac_f32 v88, v28, v52
    v_fmac_f32 v89, v29, v52
    v_fmac_f32 v90, v30, v52
    v_fmac_f32 v91, v31, v52
    s_lshr_b32 m0, s28, 16
    v_fmac_f32 v88, v32, v53
    v_fmac_f32 v89, v33, v53
    v_fmac_f32 v90, v34, v53
    v_fmac_f32 v91, v35, v53
    s_mov_b32 m0, s29
    v_fmac_f32 v88, v36, v54
    v_fmac_f32 v89, v37, v54
    v_fmac_f32 v90, v38, v54
    v_fmac_f32 v91, v39, v54
    s_lshr_b32 m0, s29, 16
    v_fmac_f32 v88, v40, v55
    v_fmac_f32 v89, v41, v55
    v_fmac_f32 v90, v42, v55
    v_fmac_f32 v91, v43, v55
    s_or_b32 m0, s40, s35
    s_waitcnt lgkmcnt(0)
    buffer_load_dwordx4 v[4:5], s[4:7], 0 idxen offen lds
    buffer_load_dwordx4 v[6:7], s[12:15], 0 idxen offen offset:1024 lds
    s_sub_u32 s19, s19, 1
    s_cbranch_scc1 mn_st2
mn_st2_back:
    v_mfma_f32_4x4x4_16b_bf16 v[28:31], v[12:13], v[20:21], 0 cbsz:4 abid:12
    v_mfma_f32_4x4x4_16b_bf16 v[32:35], v[12:13], v[22:23], 0 cbsz:4 abid:13
    v_mfma_f32_4x4x4_16b_bf16 v[36:39], v[12:13], v[24:25], 0 cbsz:4 abid:14
    v_mfma_f32_4x4x4_16b_bf16 v[40:43], v[12:13], v[26:27], 0 cbsz:4 abid:15
    ds_read_u16 v4, v2 offset:624
    ds_read_u16 v6, v2 offset:632
    v_readlane_b32 s28, v19, 48
    v_readlane_b32 s29, v19, 56
    v_mov_b32 v85, s30
    ds_add_rtn_u32 v85, v0, v85 offset:288
    s_waitcnt vmcnt(4)
    ds_read_b64_tr_b16 v[20:21], v1 offset:2048
    ds_read_b64_tr_b16 v[22:23], v1 offset:2560
    ds_read_b64_tr_b16 v[24:25], v1 offset:3072
    ds_read_b64_tr_b16 v[26:27], v1 offset:3584
    s_sub_u32 s34, s34, 1
    s_cmov_b32 s35, 0x30000
    s_mov_b32 m0, s28
    v_fmac_f32 v88, v28, v56
    v_fmac_f32 v89, v29, v56
    v_fmac_f32 v90, v30, v56
    v_fmac_f32 v91, v31, v56
    s_lshr_b32 m0, s28, 16
    v_fmac_f32 v88, v32, v57
    v_fmac_f32 v89, v33, v57
    v_fmac_f32 v90, v34, v57
    v_fmac_f32 v91, v35, v57
    s_mov_b32 m0, s29
    v_fmac_f32 v88, v36, v58
    v_fmac_f32 v89, v37, v58
    v_fmac_f32 v90, v38, v58
    v_fmac_f32 v91, v39, v58
    s_lshr_b32 m0, s29, 16
    v_fmac_f32 v88, v40, v59
    v_fmac_f32 v89, v41, v59
    v_fmac_f32 v90, v42, v59
    v_fmac_f32 v91, v43, v59
    s_or_b32 m0, s42, s35
    v_mfma_f32_32x32x16_bf16 v[44:59], v[60:63], v[68:71], 0
    v_mfma_f32_32x32x16_bf16 v[44:59], v[64:67], v[72:75], v[44:59]
    s_waitcnt lgkmcnt(0)
    buffer_load_dwordx4 v[4:5], s[4:7], 0 idxen offen lds
    buffer_load_dwordx4 v[6:7], s[12:15], 0 idxen offen offset:1024 lds
    v_readfirstlane_b32 s27, v85
    s_setprio 2
    s_xor_b32 s27, s27, s26
    s_cmp_ge_i32 s27, 0
    s_cbranch_scc1 mn_pr3
    s_setprio 1
mn_pr3:
    s_sub_u32 s19, s19, 1
    s_cbranch_scc1 mn_st3
mn_st3_back:
    v_mfma_f32_4x4x4_16b_bf16 v[28:31], v[14:15], v[20:21], 0 cbsz:4 abid:0
    v_mfma_f32_4x4x4_16b_bf16 v[32:35], v[14:15], v[22:23], 0 cbsz:4 abid:1
    v_mfma_f32_4x4x4_16b_bf16 v[36:39], v[14:15], v[24:25], 0 cbsz:4 abid:2
    v_mfma_f32_4x4x4_16b_bf16 v[40:43], v[14:15], v[26:27], 0 cbsz:4 abid:3
    ds_read_u16 v4, v2 offset:640
    ds_read_u16 v6, v2 offset:648
    v_readlane_b32 s28, v19, 1
    v_readlane_b32 s29, v19, 9
    s_waitcnt vmcnt(4)
    ds_read_b64_tr_b16 v[20:21], v1 offset:4096
    ds_read_b64_tr_b16 v[22:23], v1 offset:4608
    ds_read_b64_tr_b16 v[24:25], v1 offset:5120
    ds_read_b64_tr_b16 v[26:27], v1 offset:5632
    s_sub_u32 s34, s34, 1
    s_cmov_b32 s35, 0x30000
    s_mov_b32 m0, s28
    v_fmac_f32 v88, v28, v44
    v_fmac_f32 v89, v29, v44
    v_fmac_f32 v90, v30, v44
    v_fmac_f32 v91, v31, v44
    s_lshr_b32 m0, s28, 16
    v_fmac_f32 v88, v32, v45
    v_fmac_f32 v89, v33, v45
    v_fmac_f32 v90, v34, v45
    v_fmac_f32 v91, v35, v45
    s_mov_b32 m0, s29
    v_fmac_f32 v88, v36, v46
    v_fmac_f32 v89, v37, v46
    v_fmac_f32 v90, v38, v46
    v_fmac_f32 v91, v39, v46
    s_lshr_b32 m0, s29, 16
    v_fmac_f32 v88, v40, v47
    v_fmac_f32 v89, v41, v47
    v_fmac_f32 v90, v42, v47
    v_fmac_f32 v91, v43, v47
    s_or_b32 m0, s44, s35
    s_waitcnt lgkmcnt(0)
    buffer_load_dwordx4 v[4:5], s[4:7], 0 idxen offen lds
    buffer_load_dwordx4 v[6:7], s[12:15], 0 idxen offen offset:1024 lds
    s_sub_u32 s19, s19, 1
    s_cbranch_scc1 mn_st4
mn_st4_back:
    v_mfma_f32_4x4x4_16b_bf16 v[28:31], v[14:15], v[20:21], 0 cbsz:4 abid:4
    v_mfma_f32_4x4x4_16b_bf16 v[32:35], v[14:15], v[22:23], 0 cbsz:4 abid:5
    v_mfma_f32_4x4x4_16b_bf16 v[36:39], v[14:15], v[24:25], 0 cbsz:4 abid:6
    v_mfma_f32_4x4x4_16b_bf16 v[40:43], v[14:15], v[26:27], 0 cbsz:4 abid:7
    ds_read_u16 v4, v2 offset:656
    ds_read_u16 v6, v2 offset:664
    v_readlane_b32 s28, v19, 17
    v_readlane_b32 s29, v19, 25
    ds_read_u16 v84, v3 offset:642
    s_waitcnt vmcnt(4)
    ds_read_b64_tr_b16 v[20:21], v1 offset:0
    ds_read_b64_tr_b16 v[22:23], v1 offset:512
    ds_read_b64_tr_b16 v[24:25], v1 offset:1024
    ds_read_b64_tr_b16 v[26:27], v1 offset:1536
    s_sub_u32 s34, s34, 1
    s_cmov_b32 s35, 0x30000
    s_mov_b32 m0, s28
    v_fmac_f32 v88, v28, v48
    v_fmac_f32 v89, v29, v48
    v_fmac_f32 v90, v30, v48
    v_fmac_f32 v91, v31, v48
    s_lshr_b32 m0, s28, 16
    v_fmac_f32 v88, v32, v49
    v_fmac_f32 v89, v33, v49
    v_fmac_f32 v90, v34, v49
    v_fmac_f32 v91, v35, v49
    s_mov_b32 m0, s29
    v_fmac_f32 v88, v36, v50
    v_fmac_f32 v89, v37, v50
    v_fmac_f32 v90, v38, v50
    v_fmac_f32 v91, v39, v50
    s_lshr_b32 m0, s29, 16
    v_fmac_f32 v88, v40, v51
    v_fmac_f32 v89, v41, v51
    v_fmac_f32 v90, v42, v51
    v_fmac_f32 v91, v43, v51
    s_or_b32 m0, s40, s35
    s_waitcnt lgkmcnt(0)
    buffer_load_dwordx4 v[4:5], s[4:7], 0 idxen offen lds
    buffer_load_dwordx4 v[6:7], s[12:15], 0 idxen offen offset:1024 lds
    s_sub_u32 s19, s19, 1
    s_cbranch_scc1 mn_st5
mn_st5_back:
    v_mfma_f32_4x4x4_16b_bf16 v[28:31], v[14:15], v[20:21], 0 cbsz:4 abid:8
    v_mfma_f32_4x4x4_16b_bf16 v[32:35], v[14:15], v[22:23], 0 cbsz:4 abid:9
    v_mfma_f32_4x4x4_16b_bf16 v[36:39], v[14:15], v[24:25], 0 cbsz:4 abid:10
    v_mfma_f32_4x4x4_16b_bf16 v[40:43], v[14:15], v[26:27], 0 cbsz:4 abid:11
    ds_read_u16 v4, v2 offset:672
    ds_read_u16 v6, v2 offset:680
    v_readlane_b32 s28, v19, 33
    v_readlane_b32 s29, v19, 41
    v_and_b32 v84, 0x3ff, v84
    v_mad_u32_u24 v84, v84, 48, v86
    v_xor_b32 v85, 0x40000, v84
    ds_read_b128 v[60:63], v84 offset:320
    ds_read_b128 v[64:67], v85 offset:320
    s_waitcnt vmcnt(4)
    ds_read_b64_tr_b16 v[20:21], v1 offset:2048
    ds_read_b64_tr_b16 v[22:23], v1 offset:2560
    ds_read_b64_tr_b16 v[24:25], v1 offset:3072
    ds_read_b64_tr_b16 v[26:27], v1 offset:3584
    s_sub_u32 s34, s34, 1
    s_cmov_b32 s35, 0x30000
    s_mov_b32 m0, s28
    v_fmac_f32 v88, v28, v52
    v_fmac_f32 v89, v29, v52
    v_fmac_f32 v90, v30, v52
    v_fmac_f32 v91, v31, v52
    s_lshr_b32 m0, s28, 16
    v_fmac_f32 v88, v32, v53
    v_fmac_f32 v89, v33, v53
    v_fmac_f32 v90, v34, v53
    v_fmac_f32 v91, v35, v53
    s_mov_b32 m0, s29
    v_fmac_f32 v88, v36, v54
    v_fmac_f32 v89, v37, v54
    v_fmac_f32 v90, v38, v54
    v_fmac_f32 v91, v39, v54
    s_lshr_b32 m0, s29, 16
    v_fmac_f32 v88, v40, v55
    v_fmac_f32 v89, v41, v55
    v_fmac_f32 v90, v42, v55
    v_fmac_f32 v91, v43, v55
    s_or_b32 m0, s42, s35
    s_waitcnt lgkmcnt(0)
    buffer_load_dwordx4 v[4:5], s[4:7], 0 idxen offen lds
    buffer_load_dwordx4 v[6:7], s[12:15], 0 idxen offen offset:1024 lds
    s_sub_u32 s19, s19, 1
    s_cbranch_scc1 mn_st6
mn_st6_back:
    v_mfma_f32_4x4x4_16b_bf16 v[28:31], v[14:15], v[20:21], 0 cbsz:4 abid:12
    v_mfma_f32_4x4x4_16b_bf16 v[32:35], v[14:15], v[22:23], 0 cbsz:4 abid:13
    v_mfma_f32_4x4x4_16b_bf16 v[36:39], v[14:15], v[24:25], 0 cbsz:4 abid:14
    v_mfma_f32_4x4x4_16b_bf16 v[40:43], v[14:15], v[26:27], 0 cbsz:4 abid:15
    ds_read_u16 v4, v2 offset:688
    ds_read_u16 v6, v2 offset:696
    v_readlane_b32 s28, v19, 49
    v_readlane_b32 s29, v19, 57
    v_mov_b32 v85, s30
    ds_add_rtn_u32 v85, v0, v85 offset:288
    s_waitcnt vmcnt(4)
    ds_read_b64_tr_b16 v[20:21], v1 offset:4096
    ds_read_b64_tr_b16 v[22:23], v1 offset:4608
    ds_read_b64_tr_b16 v[24:25], v1 offset:5120
    ds_read_b64_tr_b16 v[26:27], v1 offset:5632
    s_sub_u32 s34, s34, 1
    s_cmov_b32 s35, 0x30000
    s_mov_b32 m0, s28
    v_fmac_f32 v88, v28, v56
    v_fmac_f32 v89, v29, v56
    v_fmac_f32 v90, v30, v56
    v_fmac_f32 v91, v31, v56
    s_lshr_b32 m0, s28, 16
    v_fmac_f32 v88, v32, v57
    v_fmac_f32 v89, v33, v57
    v_fmac_f32 v90, v34, v57
    v_fmac_f32 v91, v35, v57
    s_mov_b32 m0, s29
    v_fmac_f32 v88, v36, v58
    v_fmac_f32 v89, v37, v58
    v_fmac_f32 v90, v38, v58
    v_fmac_f32 v91, v39, v58
    s_lshr_b32 m0, s29, 16
    v_fmac_f32 v88, v40, v59
    v_fmac_f32 v89, v41, v59
    v_fmac_f32 v90, v42, v59
    v_fmac_f32 v91, v43, v59
    s_or_b32 m0, s44, s35
    v_mfma_f32_32x32x16_bf16 v[44:59], v[60:63], v[68:71], 0
    v_mfma_f32_32x32x16_bf16 v[44:59], v[64:67], v[72:75], v[44:59]
    s_waitcnt lgkmcnt(0)
    buffer_load_dwordx4 v[4:5], s[4:7], 0 idxen offen lds
    buffer_load_dwordx4 v[6:7], s[12:15], 0 idxen offen offset:1024 lds
    v_readfirstlane_b32 s27, v85
    s_setprio 2
    s_xor_b32 s27, s27, s26
    s_cmp_ge_i32 s27, 0
    s_cbranch_scc1 mn_pr7
    s_setprio 1
mn_pr7:
    s_sub_u32 s19, s19, 1
    s_cbranch_scc1 mn_st7
mn_st7_back:
    v_mfma_f32_4x4x4_16b_bf16 v[28:31], v[16:17], v[20:21], 0 cbsz:4 abid:0
    v_mfma_f32_4x4x4_16b_bf16 v[32:35], v[16:17], v[22:23], 0 cbsz:4 abid:1
    v_mfma_f32_4x4x4_16b_bf16 v[36:39], v[16:17], v[24:25], 0 cbsz:4 abid:2
    v_mfma_f32_4x4x4_16b_bf16 v[40:43], v[16:17], v[26:27], 0 cbsz:4 abid:3
    ds_read_u16 v4, v2 offset:704
    ds_read_u16 v6, v2 offset:712
    v_readlane_b32 s28, v19, 2
    v_readlane_b32 s29, v19, 10
    ds_read_u16 v8, v18 offset:706
    s_waitcnt vmcnt(4)
    ds_read_b64_tr_b16 v[20:21], v1 offset:0
    ds_read_b64_tr_b16 v[22:23], v1 offset:512
    ds_read_b64_tr_b16 v[24:25], v1 offset:1024
    ds_read_b64_tr_b16 v[26:27], v1 offset:1536
    s_sub_u32 s34, s34, 1
    s_cmov_b32 s35, 0x30000
    s_mov_b32 m0, s28
    v_fmac_f32 v88, v28, v44
    v_fmac_f32 v89, v29, v44
    v_fmac_f32 v90, v30, v44
    v_fmac_f32 v91, v31, v44
    s_lshr_b32 m0, s28, 16
    v_fmac_f32 v88, v32, v45
    v_fmac_f32 v89, v33, v45
    v_fmac_f32 v90, v34, v45
    v_fmac_f32 v91, v35, v45
    s_mov_b32 m0, s29
    v_fmac_f32 v88, v36, v46
    v_fmac_f32 v89, v37, v46
    v_fmac_f32 v90, v38, v46
    v_fmac_f32 v91, v39, v46
    s_lshr_b32 m0, s29, 16
    v_fmac_f32 v88, v40, v47
    v_fmac_f32 v89, v41, v47
    v_fmac_f32 v90, v42, v47
    v_fmac_f32 v91, v43, v47
    s_or_b32 m0, s40, s35
    s_waitcnt lgkmcnt(0)
    buffer_load_dwordx4 v[4:5], s[4:7], 0 idxen offen lds
    buffer_load_dwordx4 v[6:7], s[12:15], 0 idxen offen offset:1024 lds
    s_sub_u32 s19, s19, 1
    s_cbranch_scc1 mn_st8
mn_st8_back:
    v_mfma_f32_4x4x4_16b_bf16 v[28:31], v[16:17], v[20:21], 0 cbsz:4 abid:4
    v_mfma_f32_4x4x4_16b_bf16 v[32:35], v[16:17], v[22:23], 0 cbsz:4 abid:5
    v_mfma_f32_4x4x4_16b_bf16 v[36:39], v[16:17], v[24:25], 0 cbsz:4 abid:6
    v_mfma_f32_4x4x4_16b_bf16 v[40:43], v[16:17], v[26:27], 0 cbsz:4 abid:7
    ds_read_u16 v4, v2 offset:720
    ds_read_u16 v6, v2 offset:728
    v_readlane_b32 s28, v19, 18
    v_readlane_b32 s29, v19, 26
    ds_read_u16 v84, v3 offset:706
    v_lshrrev_b32 v11, 8, v8
    v_and_b32 v8, 0x3ff, v8
    v_mul_u32_u24 v8, 48, v8
    ds_read_b64 v[8:9], v8 offset:352
    s_waitcnt vmcnt(4)
    ds_read_b64_tr_b16 v[20:21], v1 offset:2048
    ds_read_b64_tr_b16 v[22:23], v1 offset:2560
    ds_read_b64_tr_b16 v[24:25], v1 offset:3072
    ds_read_b64_tr_b16 v[26:27], v1 offset:3584
    s_sub_u32 s34, s34, 1
    s_cmov_b32 s35, 0x30000
    s_mov_b32 m0, s28
    v_fmac_f32 v88, v28, v48
    v_fmac_f32 v89, v29, v48
    v_fmac_f32 v90, v30, v48
    v_fmac_f32 v91, v31, v48
    s_lshr_b32 m0, s28, 16
    v_fmac_f32 v88, v32, v49
    v_fmac_f32 v89, v33, v49
    v_fmac_f32 v90, v34, v49
    v_fmac_f32 v91, v35, v49
    s_mov_b32 m0, s29
    v_fmac_f32 v88, v36, v50
    v_fmac_f32 v89, v37, v50
    v_fmac_f32 v90, v38, v50
    v_fmac_f32 v91, v39, v50
    s_lshr_b32 m0, s29, 16
    v_fmac_f32 v88, v40, v51
    v_fmac_f32 v89, v41, v51
    v_fmac_f32 v90, v42, v51
    v_fmac_f32 v91, v43, v51
    s_or_b32 m0, s42, s35
    s_waitcnt lgkmcnt(0)
    buffer_load_dwordx4 v[4:5], s[4:7], 0 idxen offen lds
    buffer_load_dwordx4 v[6:7], s[12:15], 0 idxen offen offset:1024 lds
    s_sub_u32 s19, s19, 1
    s_cbranch_scc1 mn_st9
mn_st9_back:
    v_mfma_f32_4x4x4_16b_bf16 v[28:31], v[16:17], v[20:21], 0 cbsz:4 abid:8
    v_mfma_f32_4x4x4_16b_bf16 v[32:35], v[16:17], v[22:23], 0 cbsz:4 abid:9
    v_mfma_f32_4x4x4_16b_bf16 v[36:39], v[16:17], v[24:25], 0 cbsz:4 abid:10
    v_mfma_f32_4x4x4_16b_bf16 v[40:43], v[16:17], v[26:27], 0 cbsz:4 abid:11
    ds_read_u16 v4, v2 offset:736
    ds_read_u16 v6, v2 offset:744
    v_readlane_b32 s28, v19, 34
    v_readlane_b32 s29, v19, 42
    v_and_b32 v84, 0x3ff, v84
    v_mad_u32_u24 v84, v84, 48, v86
    v_xor_b32 v85, 0x40000, v84
    ds_read_b128 v[60:63], v84 offset:320
    ds_read_b128 v[64:67], v85 offset:320
    s_waitcnt vmcnt(4)
    ds_read_b64_tr_b16 v[20:21], v1 offset:4096
    ds_read_b64_tr_b16 v[22:23], v1 offset:4608
    ds_read_b64_tr_b16 v[24:25], v1 offset:5120
    ds_read_b64_tr_b16 v[26:27], v1 offset:5632
    s_sub_u32 s34, s34, 1
    s_cmov_b32 s35, 0x30000
    s_mov_b32 m0, s28
    v_fmac_f32 v88, v28, v52
    v_fmac_f32 v89, v29, v52
    v_fmac_f32 v90, v30, v52
    v_fmac_f32 v91, v31, v52
    s_lshr_b32 m0, s28, 16
    v_fmac_f32 v88, v32, v53
    v_fmac_f32 v89, v33, v53
    v_fmac_f32 v90, v34, v53
    v_fmac_f32 v91, v35, v53
    s_mov_b32 m0, s29
    v_fmac_f32 v88, v36, v54
    v_fmac_f32 v89, v37, v54
    v_fmac_f32 v90, v38, v54
    v_fmac_f32 v91, v39, v54
    s_lshr_b32 m0, s29, 16
    v_fmac_f32 v88, v40, v55
    v_fmac_f32 v89, v41, v55
    v_fmac_f32 v90, v42, v55
    v_fmac_f32 v91, v43, v55
    s_or_b32 m0, s44, s35
    s_waitcnt lgkmcnt(0)
    buffer_load_dwordx4 v[4:5], s[4:7], 0 idxen offen lds
    buffer_load_dwordx4 v[6:7], s[12:15], 0 idxen offen offset:1024 lds
    v_and_b32 v11, 0x7c, v11
    v_or_b32 v11, 0xc000, v11
    v_lshlrev_b32 v10, 16, v11
    s_sub_u32 s19, s19, 1
    s_cbranch_scc1 mn_st10
mn_st10_back:
    v_mfma_f32_4x4x4_16b_bf16 v[28:31], v[16:17], v[20:21], 0 cbsz:4 abid:12
    v_mfma_f32_4x4x4_16b_bf16 v[32:35], v[16:17], v[22:23], 0 cbsz:4 abid:13
    v_mfma_f32_4x4x4_16b_bf16 v[36:39], v[16:17], v[24:25], 0 cbsz:4 abid:14
    v_mfma_f32_4x4x4_16b_bf16 v[40:43], v[16:17], v[26:27], 0 cbsz:4 abid:15
    ds_read_u16 v4, v2 offset:752
    ds_read_u16 v6, v2 offset:760
    v_readlane_b32 s28, v19, 50
    v_readlane_b32 s29, v19, 58
    v_mov_b32 v85, s30
    ds_add_rtn_u32 v85, v0, v85 offset:288
    s_waitcnt vmcnt(4)
    ds_read_b64_tr_b16 v[20:21], v1 offset:0
    ds_read_b64_tr_b16 v[22:23], v1 offset:512
    ds_read_b64_tr_b16 v[24:25], v1 offset:1024
    ds_read_b64_tr_b16 v[26:27], v1 offset:1536
    s_sub_u32 s34, s34, 1
    s_cmov_b32 s35, 0x30000
    s_mov_b32 m0, s28
    v_fmac_f32 v88, v28, v56
    v_fmac_f32 v89, v29, v56
    v_fmac_f32 v90, v30, v56
    v_fmac_f32 v91, v31, v56
    s_lshr_b32 m0, s28, 16
    v_fmac_f32 v88, v32, v57
    v_fmac_f32 v89, v33, v57
    v_fmac_f32 v90, v34, v57
    v_fmac_f32 v91, v35, v57
    s_mov_b32 m0, s29
    v_fmac_f32 v88, v36, v58
    v_fmac_f32 v89, v37, v58
    v_fmac_f32 v90, v38, v58
    v_fmac_f32 v91, v39, v58
    s_lshr_b32 m0, s29, 16
    v_fmac_f32 v88, v40, v59
    v_fmac_f32 v89, v41, v59
    v_fmac_f32 v90, v42, v59
    v_fmac_f32 v91, v43, v59
    s_or_b32 m0, s40, s35
    v_mfma_f32_4x4x4_16b_bf16 v[28:31], v[8:9], v[76:77], 0
    v_mfma_f32_4x4x4_16b_bf16 v[32:35], v[8:9], v[78:79], 0
    v_mfma_f32_4x4x4_16b_bf16 v[36:39], v[8:9], v[80:81], 0
    v_mfma_f32_4x4x4_16b_bf16 v[40:43], v[8:9], v[82:83], 0
    v_mfma_f32_32x32x16_bf16 v[44:59], v[60:63], v[68:71], 0
    v_mfma_f32_32x32x16_bf16 v[44:59], v[64:67], v[72:75], v[44:59]
    s_waitcnt lgkmcnt(0)
    buffer_load_dwordx4 v[4:5], s[4:7], 0 idxen offen lds
    buffer_load_dwordx4 v[6:7], s[12:15], 0 idxen offen offset:1024 lds
    v_cvt_pk_bf16_f32 v12, v28, v32
    v_cvt_pk_bf16_f32 v14, v29, v33
    v_cvt_pk_bf16_f32 v16, v30, v34
    v_cvt_pk_bf16_f32 v13, v36, v40
    v_cvt_pk_bf16_f32 v15, v37, v41
    v_cvt_pk_bf16_f32 v17, v38, v42
    v_or_b32_dpp v19, v10, v11 row_shl:4 row_mask:0xf bank_mask:0xf bound_ctrl:0
    v_add_u32 v2, 192, v2
    v_add_u32 v3, 192, v3
    v_add_u32 v18, 192, v18
    v_readfirstlane_b32 s27, v85
    s_setprio 2
    s_xor_b32 s27, s27, s26
    s_cmp_ge_i32 s27, 0
    s_cbranch_scc1 mn_pr11
    s_setprio 1
mn_pr11:
    s_sub_u32 s19, s19, 1
    s_cbranch_scc1 mn_st11
mn_st11_back:
    s_branch mn_loop
mn_st0:
    s_cmp_lg_u32 s21, 0
    s_cbranch_scc1 mn_next
    s_call_b64 s[48:49], mn_flush
    s_branch mn_st0_back
mn_st1:
    s_cmp_lg_u32 s21, 0
    s_cbranch_scc1 mn_next
    s_call_b64 s[48:49], mn_flush
    s_branch mn_st1_back
mn_st2:
    s_cmp_lg_u32 s21, 0
    s_cbranch_scc1 mn_next
    s_call_b64 s[48:49], mn_flush
    s_branch mn_st2_back
mn_st3:
    s_cmp_lg_u32 s21, 0
    s_cbranch_scc1 mn_next
    s_call_b64 s[48:49], mn_flush
    s_branch mn_st3_back
mn_st4:
    s_cmp_lg_u32 s21, 0
    s_cbranch_scc1 mn_next
    s_call_b64 s[48:49], mn_flush
    s_branch mn_st4_back
mn_st5:
    s_cmp_lg_u32 s21, 0
    s_cbranch_scc1 mn_next
    s_call_b64 s[48:49], mn_flush
    s_branch mn_st5_back
mn_st6:
    s_cmp_lg_u32 s21, 0
    s_cbranch_scc1 mn_next
    s_call_b64 s[48:49], mn_flush
    s_branch mn_st6_back
mn_st7:
    s_cmp_lg_u32 s21, 0
    s_cbranch_scc1 mn_next
    s_call_b64 s[48:49], mn_flush
    s_branch mn_st7_back
mn_st8:
    s_cmp_lg_u32 s21, 0
    s_cbranch_scc1 mn_next
    s_call_b64 s[48:49], mn_flush
    s_branch mn_st8_back
mn_st9:
    s_cmp_lg_u32 s21, 0
    s_cbranch_scc1 mn_next
    s_call_b64 s[48:49], mn_flush
    s_branch mn_st9_back
mn_st10:
    s_cmp_lg_u32 s21, 0
    s_cbranch_scc1 mn_next
    s_call_b64 s[48:49], mn_flush
    s_branch mn_st10_back
mn_st11:
    s_cmp_lg_u32 s21, 0
    s_cbranch_scc1 mn_next
    s_call_b64 s[48:49], mn_flush
    s_branch mn_st11_back
mn_st12:
    s_cmp_lg_u32 s21, 0
    s_cbranch_scc1 mn_next
    s_call_b64 s[48:49], mn_flush
    s_branch mn_st12_back
mn_flush:
    s_cmp_eq_u32 s58, 4
    s_cbranch_scc1 mn_fl4
    s_cmp_eq_u32 s58, 3
    s_cbranch_scc1 mn_fl3
    s_cmp_eq_u32 s58, 2
    s_cbranch_scc1 mn_fl2
    s_cmp_eq_u32 s58, 1
    s_cbranch_scc1 mn_fl1
mn_fl0:
    v_cvt_pk_bf16_f32 v88, v88, v89
    v_cvt_pk_bf16_f32 v89, v90, v91
    ds_write_b64 v87, v[88:89] offset:0
    v_cvt_pk_bf16_f32 v92, v92, v93
    v_cvt_pk_bf16_f32 v93, v94, v95
    ds_write_b64 v87, v[92:93] offset:576
    v_cvt_pk_bf16_f32 v96, v96, v97
    v_cvt_pk_bf16_f32 v97, v98, v99
    ds_write_b64 v87, v[96:97] offset:1152
    v_cvt_pk_bf16_f32 v100, v100, v101
    v_cvt_pk_bf16_f32 v101, v102, v103
    ds_write_b64 v87, v[100:101] offset:1728
    s_mul_i32 s52, s18, 3
    s_lshl_b32 s52, 1, s52
    v_mov_b32 v90, s52
    v_mov_b32 v91, 0
    s_mov_b64 exec, 1
    ds_add_u32 v91, v90 offset:276
    s_mov_b64 exec, -1
    s_add_u32 s58, s58, 1
    s_sub_u32 s19, s85, 1
    s_cbranch_scc1 mn_fl1
    s_setpc_b64 s[48:49]
mn_fl1:
    v_cvt_pk_bf16_f32 v104, v104, v105
    v_cvt_pk_bf16_f32 v105, v106, v107
    ds_write_b64 v87, v[104:105] offset:2304
    v_cvt_pk_bf16_f32 v108, v108, v109
    v_cvt_pk_bf16_f32 v109, v110, v111
    ds_write_b64 v87, v[108:109] offset:2880
    v_cvt_pk_bf16_f32 v112, v112, v113
    v_cvt_pk_bf16_f32 v113, v114, v115
    ds_write_b64 v87, v[112:113] offset:3456
    v_cvt_pk_bf16_f32 v116, v116, v117
    v_cvt_pk_bf16_f32 v117, v118, v119
    ds_write_b64 v87, v[116:117] offset:4032
    s_mul_i32 s52, s18, 3
    s_lshl_b32 s52, 64, s52
    v_mov_b32 v106, s52
    v_mov_b32 v107, 0
    s_mov_b64 exec, 1
    ds_add_u32 v107, v106 offset:276
    s_mov_b64 exec, -1
    s_add_u32 s58, s58, 1
    s_sub_u32 s19, s86, 1
    s_cbranch_scc1 mn_fl2
    s_setpc_b64 s[48:49]
mn_fl2:
    v_cvt_pk_bf16_f32 v120, v120, v121
    v_cvt_pk_bf16_f32 v121, v122, v123
    ds_write_b64 v87, v[120:121] offset:4608
    v_cvt_pk_bf16_f32 v124, v124, v125
    v_cvt_pk_bf16_f32 v125, v126, v127
    ds_write_b64 v87, v[124:125] offset:5184
    v_cvt_pk_bf16_f32 v128, v128, v129
    v_cvt_pk_bf16_f32 v129, v130, v131
    ds_write_b64 v87, v[128:129] offset:5760
    v_cvt_pk_bf16_f32 v132, v132, v133
    v_cvt_pk_bf16_f32 v133, v134, v135
    ds_write_b64 v87, v[132:133] offset:6336
    s_mul_i32 s52, s18, 3
    s_lshl_b32 s52, 4096, s52
    v_mov_b32 v122, s52
    v_mov_b32 v123, 0
    s_mov_b64 exec, 1
    ds_add_u32 v123, v122 offset:276
    s_mov_b64 exec, -1
    s_add_u32 s58, s58, 1
    s_sub_u32 s19, s87, 1
    s_cbranch_scc1 mn_fl3
    s_setpc_b64 s[48:49]
mn_fl3:
    v_cvt_pk_bf16_f32 v136, v136, v137
    v_cvt_pk_bf16_f32 v137, v138, v139
    ds_write_b64 v87, v[136:137] offset:6912
    v_cvt_pk_bf16_f32 v140, v140, v141
    v_cvt_pk_bf16_f32 v141, v142, v143
    ds_write_b64 v87, v[140:141] offset:7488
    v_cvt_pk_bf16_f32 v144, v144, v145
    v_cvt_pk_bf16_f32 v145, v146, v147
    ds_write_b64 v87, v[144:145] offset:8064
    v_cvt_pk_bf16_f32 v148, v148, v149
    v_cvt_pk_bf16_f32 v149, v150, v151
    ds_write_b64 v87, v[148:149] offset:8640
    s_mul_i32 s52, s18, 3
    s_lshl_b32 s52, 262144, s52
    v_mov_b32 v138, s52
    v_mov_b32 v139, 0
    s_mov_b64 exec, 1
    ds_add_u32 v139, v138 offset:276
    s_mov_b64 exec, -1
    s_add_u32 s58, s58, 1
    s_sub_u32 s19, s88, 1
    s_cbranch_scc1 mn_fl4
    s_setpc_b64 s[48:49]
mn_fl4:
    s_cmp_ge_u32 s57, 4
    s_cbranch_scc1 mn_fl4b
    s_waitcnt vmcnt(0)
mn_fl4b:
    v_cvt_pk_bf16_f32 v152, v152, v153
    v_cvt_pk_bf16_f32 v153, v154, v155
    ds_write_b64 v87, v[152:153] offset:9216
    v_cvt_pk_bf16_f32 v156, v156, v157
    v_cvt_pk_bf16_f32 v157, v158, v159
    ds_write_b64 v87, v[156:157] offset:9792
    v_cvt_pk_bf16_f32 v160, v160, v161
    v_cvt_pk_bf16_f32 v161, v162, v163
    ds_write_b64 v87, v[160:161] offset:10368
    v_cvt_pk_bf16_f32 v164, v164, v165
    v_cvt_pk_bf16_f32 v165, v166, v167
    ds_write_b64 v87, v[164:165] offset:10944
    s_mul_i32 s52, s18, 3
    s_lshl_b32 s52, 16777216, s52
    v_mov_b32 v154, s52
    v_mov_b32 v155, 0
    s_mov_b64 exec, 1
    ds_add_u32 v155, v154 offset:276
    s_mov_b64 exec, -1
    s_waitcnt vmcnt(0) lgkmcnt(0)
mn_end:
    s_endpgm
gm_main:
    s_load_dwordx2 s[56:57], s[0:1], 64
    s_load_dwordx2 s[26:27], s[0:1], 56
    v_and_b32 v3, 63, v0
    v_bfe_u32 v12, v0, 1, 7
    v_and_b32 v11, 15, v12
    v_lshrrev_b32 v10, 4, v12
    v_lshl_or_b32 v11, v11, 3, v10
    v_cmp_gt_u32 vcc, 125, v11
    v_mul_u32_u24 v13, 51200, v11
    v_bfrev_b32 v10, 2
    v_lshlrev_b32 v12, 6, v12
    v_cndmask_b32 v12, v10, v12, vcc
    v_lshlrev_b32 v2, 4, v3
    s_lshl_b32 s40, s17, 15
    s_add_u32 s40, s40, 11534336
    s_waitcnt lgkmcnt(0)
    s_mov_b32 s8, s54
    s_and_b32 s9, s55, 0xffff
    v_lshrrev_b32 v11, 4, v3
    v_lshlrev_b32 v11, 11, v11
    v_and_b32 v10, 7, v3
    v_lshl_add_u32 v11, v10, 4, v11
    v_and_b32 v10, 8, v3
    v_lshlrev_b32 v10, 10, v10
    s_lshl_b32 s52, s17, 7
    s_add_u32 s52, s52, 114688
    v_add3_u32 v11, v11, v10, s52
    s_mov_b32 s44, 0x05040100
    s_mov_b32 s45, 0x07060302
    v_mov_b32 v5, v11
    s_cmp_ge_u32 s2, 125
    s_cbranch_scc1 gm_wgo
    s_cmp_ge_u32 s16, 10
    s_cbranch_scc1 gm_wsp
    s_cmp_ge_u32 s2, 125
    s_waitcnt vmcnt(0)
    s_cbranch_scc1 gm_wsp
    v_mov_b32 v11, 0
    v_mov_b32 v10, 1
    s_mov_b64 exec, 1
    ds_add_u32 v11, v10 offset:448
    s_mov_b64 exec, -1
gm_dummy:
gm_wsp:
    v_mov_b32 v11, 0
    ds_read_b32 v11, v11 offset:448
    s_waitcnt lgkmcnt(0)
    v_readfirstlane_b32 s62, v11
    s_cmp_ge_u32 s62, 10
    s_cbranch_scc1 gm_wspx
    s_sleep 1
    s_branch gm_wsp
gm_wspx:
    s_cmp_lg_u32 s16, 10
    s_cbranch_scc1 gm_wgo
    s_and_b32 s52, s2, 1
    s_lshl_b32 s53, s52, 7
    s_add_u32 s53, s53, 64
    s_mov_b32 s62, 1
    s_atomic_add s62, s[60:61], s53 glc
    s_sub_u32 s52, 62, s52
    s_add_u32 s28, s54, 11730944
    s_addc_u32 s29, s55, 0
    s_mov_b32 s53, 0x10000
    s_waitcnt lgkmcnt(0)
    s_cmp_lg_u32 s62, s52
    s_cbranch_scc1 gm_wgo
    s_atomic_add s53, s[28:29], 0
    s_atomic_add s53, s[28:29], 128
    s_atomic_add s53, s[28:29], 256
    s_atomic_add s53, s[28:29], 384
    s_atomic_add s53, s[28:29], 512
    s_atomic_add s53, s[28:29], 640
    s_atomic_add s53, s[28:29], 768
    s_atomic_add s53, s[28:29], 896
    s_atomic_add s53, s[28:29], 1024
    s_atomic_add s53, s[28:29], 1152
    s_atomic_add s53, s[28:29], 1280
    s_atomic_add s53, s[28:29], 1408
    s_atomic_add s53, s[28:29], 1536
    s_atomic_add s53, s[28:29], 1664
    s_atomic_add s53, s[28:29], 1792
    s_atomic_add s53, s[28:29], 1920
gm_wgo:
    global_load_dwordx4 v[136:139], v5, s[26:27] offset:0
    global_load_dwordx4 v[140:143], v5, s[26:27] offset:512
    global_load_dwordx4 v[144:147], v5, s[26:27] offset:1024
    global_load_dwordx4 v[148:151], v5, s[26:27] offset:1536
    v_subrev_u32 v5, 0x4000, v5
    global_load_dwordx4 v[120:123], v5, s[26:27] offset:0
    global_load_dwordx4 v[124:127], v5, s[26:27] offset:512
    global_load_dwordx4 v[128:131], v5, s[26:27] offset:1024
    global_load_dwordx4 v[132:135], v5, s[26:27] offset:1536
    v_subrev_u32 v5, 0x4000, v5
    global_load_dwordx4 v[104:107], v5, s[26:27] offset:0
    global_load_dwordx4 v[108:111], v5, s[26:27] offset:512
    global_load_dwordx4 v[112:115], v5, s[26:27] offset:1024
    global_load_dwordx4 v[116:119], v5, s[26:27] offset:1536
    v_subrev_u32 v5, 0x4000, v5
    global_load_dwordx4 v[88:91], v5, s[26:27] offset:0
    global_load_dwordx4 v[92:95], v5, s[26:27] offset:512
    global_load_dwordx4 v[96:99], v5, s[26:27] offset:1024
    global_load_dwordx4 v[100:103], v5, s[26:27] offset:1536
    v_subrev_u32 v5, 0x4000, v5
    global_load_dwordx4 v[72:75], v5, s[26:27] offset:0
    global_load_dwordx4 v[76:79], v5, s[26:27] offset:512
    global_load_dwordx4 v[80:83], v5, s[26:27] offset:1024
    global_load_dwordx4 v[84:87], v5, s[26:27] offset:1536
    v_subrev_u32 v5, 0x4000, v5
    s_cmp_lt_u32 s2, 125
    s_cbranch_scc1 gm_wskip
    global_load_dwordx4 v[56:59], v5, s[26:27] offset:0
    global_load_dwordx4 v[60:63], v5, s[26:27] offset:512
    global_load_dwordx4 v[64:67], v5, s[26:27] offset:1024
    global_load_dwordx4 v[68:71], v5, s[26:27] offset:1536
    v_subrev_u32 v5, 0x4000, v5
    global_load_dwordx4 v[40:43], v5, s[26:27] offset:0
    global_load_dwordx4 v[44:47], v5, s[26:27] offset:512
    global_load_dwordx4 v[48:51], v5, s[26:27] offset:1024
    global_load_dwordx4 v[52:55], v5, s[26:27] offset:1536
    v_subrev_u32 v5, 0x4000, v5
gm_wskip:
    s_mul_i32 s41, s2, 625
    s_add_u32 s52, s41, 640
    s_add_u32 s41, s41, 15
    s_lshr_b32 s41, s41, 4
    s_lshr_b32 s52, s52, 4
    s_mov_b32 s12, s56
    s_and_b32 s13, s57, 0xffff
    s_lshl_b32 s14, s52, 11
    s_mov_b32 s15, 0x20000
    s_mul_i32 s42, s17, 15360
    s_add_u32 s42, s42, 40960
    s_lshl_b32 s43, s17, 1
    s_sub_u32 s43, s43, 1
    v_lshlrev_b32 v6, 2, v3
    v_add_u32 v11, 0, v3
    v_mul_u32_u24 v10, 21846, v11
    v_lshrrev_b32 v10, 16, v10
    v_lshl_add_u32 v34, v10, 2, s42
    v_mad_i32_i24 v10, v10, -3, v11
    v_lshlrev_b32 v30, 4, v10
    v_add_u32 v11, 64, v3
    v_mul_u32_u24 v10, 21846, v11
    v_lshrrev_b32 v10, 16, v10
    v_lshl_add_u32 v35, v10, 2, s42
    v_mad_i32_i24 v10, v10, -3, v11
    v_lshlrev_b32 v31, 4, v10
    v_add_u32 v11, 128, v3
    v_mul_u32_u24 v10, 21846, v11
    v_lshrrev_b32 v10, 16, v10
    v_lshl_add_u32 v36, v10, 2, s42
    v_mad_i32_i24 v10, v10, -3, v11
    v_lshlrev_b32 v32, 4, v10
gm_sp1:
    v_mov_b32 v11, 0
    ds_read_b32 v11, v11 offset:308
    s_waitcnt lgkmcnt(0)
    v_readfirstlane_b32 s62, v11
    s_cmp_ge_u32 s62, 1
    s_cbranch_scc1 gm_sp1x
    s_sleep 1
    s_branch gm_sp1
gm_sp1x:
    buffer_load_dword v4, v12, s[8:11], s22 offen offset:60 sc1
    s_waitcnt vmcnt(0)
gm_pass:
    v_lshrrev_b32 v8, 16, v4
    v_subrev_u32 v8, s24, v8
    v_med3_i32 v8, v8, 0, s20
    v_mov_b32 v9, v8
    v_and_b32 v12, 1, v0
    v_and_b32 v14, 0xffff, v4
    v_add_u32_dpp v9, v9, v9 row_shr:2 row_mask:0xf bank_mask:0xf
    v_add3_u32 v14, v14, v12, s24
    s_nop 0
    v_add_u32_dpp v9, v9, v9 row_shr:4 row_mask:0xf bank_mask:0xf
    v_mad_u32_u24 v14, v14, 40, v13
    s_nop 0
    v_add_u32_dpp v9, v9, v9 row_shr:8 row_mask:0xf bank_mask:0xf
    v_sub_u32 v15, v8, v12
    s_nop 0
    v_add_u32_dpp v9, v9, v9 row_bcast:15 row_mask:0xa bank_mask:0xf
    s_nop 0
    s_nop 0
    v_add_u32_dpp v9, v9, v9 row_bcast:31 row_mask:0xc bank_mask:0xf
    s_nop 0
    s_nop 0
    v_readlane_b32 s47, v9, 63
    v_sub_u32 v16, v9, v15
    v_lshl_add_u32 v16, v16, 2, s42
    v_cmpx_lt_i32 vcc, 0, v15
    s_cbranch_execz gm_tb_done
    ds_write_b32 v16, v14 offset:0
    v_add_u32 v14, 80, v14
    v_cmpx_lt_i32 vcc, 2, v15
    s_cbranch_execz gm_tb_done
    ds_write_b32 v16, v14 offset:8
    v_add_u32 v14, 80, v14
    v_cmpx_lt_i32 vcc, 4, v15
    s_cbranch_execz gm_tb_done
    ds_write_b32 v16, v14 offset:16
    v_add_u32 v14, 80, v14
    v_cmpx_lt_i32 vcc, 6, v15
    s_cbranch_execz gm_tb_done
    ds_write_b32 v16, v14 offset:24
    v_add_u32 v14, 80, v14
    v_cmpx_lt_i32 vcc, 8, v15
    s_cbranch_execz gm_tb_done
    ds_write_b32 v16, v14 offset:32
    v_add_u32 v14, 80, v14
    v_cmpx_lt_i32 vcc, 10, v15
    s_cbranch_execz gm_tb_done
    ds_write_b32 v16, v14 offset:40
    v_add_u32 v14, 80, v14
    v_cmpx_lt_i32 vcc, 12, v15
    s_cbranch_execz gm_tb_done
    ds_write_b32 v16, v14 offset:48
    v_add_u32 v14, 80, v14
    v_cmpx_lt_i32 vcc, 14, v15
    s_cbranch_execz gm_tb_done
    ds_write_b32 v16, v14 offset:56
    v_add_u32 v14, 80, v14
    v_cmpx_lt_i32 vcc, 16, v15
    s_cbranch_execz gm_tb_done
    ds_write_b32 v16, v14 offset:64
    v_add_u32 v14, 80, v14
    v_cmpx_lt_i32 vcc, 18, v15
    s_cbranch_execz gm_tb_done
    ds_write_b32 v16, v14 offset:72
gm_tb_done:
    s_mov_b64 exec, -1
    s_mul_i32 s47, s47, 3
    v_mov_b32 v17, 0
    ds_read_b32 v18, v34 offset:0
    ds_read_b32 v19, v35 offset:0
    ds_read_b32 v20, v36 offset:0
    ds_read_b32 v21, v34 offset:256
    ds_read_b32 v22, v35 offset:256
    ds_read_b32 v23, v36 offset:256
    ds_read_b32 v24, v34 offset:512
    ds_read_b32 v25, v35 offset:512
    ds_read_b32 v26, v36 offset:512
    ds_read_b32 v29, v17 offset:456
    s_and_b32 s62, s2, 15
    s_lshl_b32 s62, s62, 7
    s_add_u32 s62, s62, 11730944
    v_mov_b32 v28, s62
    global_load_dword v27, v28, s[54:55] sc1
    s_barrier
    ds_read_b32 v15, v6 offset:384
    ds_read_b32 v17, v17 offset:272
    v_mov_b32 v11, v34
    v_mov_b32 v10, v35
    v_mov_b32 v14, v36
    s_waitcnt lgkmcnt(1)
    v_add_u32_dpp v15, v15, v15 row_shr:1 row_mask:0xf bank_mask:0xf
    s_nop 1
    v_add_u32_dpp v15, v15, v15 row_shr:2 row_mask:0xf bank_mask:0xf
    s_nop 1
    v_add_u32_dpp v15, v15, v15 row_shr:4 row_mask:0xf bank_mask:0xf
    s_waitcnt lgkmcnt(0)
    v_readfirstlane_b32 s21, v17
    v_readlane_b32 s23, v15, 7
    v_readlane_b32 s46, v15, s43
    s_cmp_gt_u32 s23, 773
    s_cbranch_scc1 gm_ovf
    s_cmp_eq_u32 s17, 0
    s_cmov_b32 s46, 0
    s_mul_i32 s46, s46, 48
    s_add_u32 m0, s46, 3776
    v_add_u32 v18, v18, v30
    v_add_u32 v19, v19, v31
    v_add_u32 v20, v20, v32
    v_add_u32 v21, v21, v30
    v_add_u32 v22, v22, v31
    v_add_u32 v23, v23, v32
    v_add_u32 v24, v24, v30
    v_add_u32 v25, v25, v31
    v_add_u32 v26, v26, v32
    s_mov_b32 s63, 0x100000
gm_ep:
    s_waitcnt vmcnt(0)
    v_sub_u32 v27, v27, v29
    v_lshrrev_b32 v27, 16, v27
    v_cmp_eq_u32 vcc, 2, v27
    s_cbranch_vccnz gm_go2
    s_and_b32 s62, s63, 31
    s_sub_u32 s63, s63, 1
    s_cmp_eq_u32 s62, 1
    s_cbranch_scc1 gm_epd
    s_sleep 6
    global_load_dword v27, v28, s[54:55] sc1
    s_branch gm_ep
gm_epd:
    s_and_b32 s62, s2, 15
    s_lshl_b32 s62, s62, 7
    s_add_u32 s62, s62, 11730944
    v_mov_b32 v27, s62
    v_lshlrev_b32 v28, 6, v0
    v_and_b32 v28, 0xc0, v28
    s_mov_b32 s63, 0x100000
mn_poll2dem:
    s_sub_u32 s63, s63, 1
    s_cbranch_scc1 mn_poll2dex
    global_load_dword v29, v28, s[60:61] sc1
    s_waitcnt vmcnt(0)
    v_add_u32_dpp v29, v29, v29 quad_perm:[2,3,0,1] row_mask:0xf bank_mask:0xf
    s_sleep 8
    v_readlane_b32 s62, v29, 1
    s_cmp_lt_u32 s62, 125
    s_cbranch_scc1 mn_poll2dem
mn_poll2dex:
gm_go2:
    v_cmpx_gt_i32 vcc, s47, v3
    s_cbranch_execz gm_raw_done
    buffer_load_dwordx4 v18, s[8:11], 0 offen sc1 lds
    s_add_u32 m0, m0, 1024
    s_sub_i32 s47, s47, 64
    v_cmpx_gt_i32 vcc, s47, v3
    s_cbranch_execz gm_raw_done
    buffer_load_dwordx4 v19, s[8:11], 0 offen sc1 lds
    s_add_u32 m0, m0, 1024
    s_sub_i32 s47, s47, 64
    v_cmpx_gt_i32 vcc, s47, v3
    s_cbranch_execz gm_raw_done
    buffer_load_dwordx4 v20, s[8:11], 0 offen sc1 lds
    s_add_u32 m0, m0, 1024
    s_sub_i32 s47, s47, 64
    v_cmpx_gt_i32 vcc, s47, v3
    s_cbranch_execz gm_raw_done
    buffer_load_dwordx4 v21, s[8:11], 0 offen sc1 lds
    s_add_u32 m0, m0, 1024
    s_sub_i32 s47, s47, 64
    v_cmpx_gt_i32 vcc, s47, v3
    s_cbranch_execz gm_raw_done
    buffer_load_dwordx4 v22, s[8:11], 0 offen sc1 lds
    s_add_u32 m0, m0, 1024
    s_sub_i32 s47, s47, 64
    v_cmpx_gt_i32 vcc, s47, v3
    s_cbranch_execz gm_raw_done
    buffer_load_dwordx4 v23, s[8:11], 0 offen sc1 lds
    s_add_u32 m0, m0, 1024
    s_sub_i32 s47, s47, 64
    v_cmpx_gt_i32 vcc, s47, v3
    s_cbranch_execz gm_raw_done
    buffer_load_dwordx4 v24, s[8:11], 0 offen sc1 lds
    s_add_u32 m0, m0, 1024
    s_sub_i32 s47, s47, 64
    v_cmpx_gt_i32 vcc, s47, v3
    s_cbranch_execz gm_raw_done
    buffer_load_dwordx4 v25, s[8:11], 0 offen sc1 lds
    s_add_u32 m0, m0, 1024
    s_sub_i32 s47, s47, 64
    v_cmpx_gt_i32 vcc, s47, v3
    s_cbranch_execz gm_raw_done
    buffer_load_dwordx4 v26, s[8:11], 0 offen sc1 lds
    s_add_u32 m0, m0, 1024
    s_sub_i32 s47, s47, 64
    v_add_u32 v11, 768, v11
    v_add_u32 v10, 768, v10
    v_add_u32 v14, 768, v14
gm_raw:
    ds_read_b32 v18, v11 offset:0
    ds_read_b32 v19, v10 offset:0
    ds_read_b32 v20, v14 offset:0
    ds_read_b32 v21, v11 offset:256
    ds_read_b32 v22, v10 offset:256
    ds_read_b32 v23, v14 offset:256
    ds_read_b32 v24, v11 offset:512
    ds_read_b32 v25, v10 offset:512
    ds_read_b32 v26, v14 offset:512
    v_cmpx_gt_i32 vcc, s47, v3
    s_cbranch_execz gm_raw_done
    s_waitcnt lgkmcnt(8)
    v_add_u32 v18, v18, v30
    buffer_load_dwordx4 v18, s[8:11], 0 offen sc1 lds
    s_add_u32 m0, m0, 1024
    s_sub_i32 s47, s47, 64
    v_cmpx_gt_i32 vcc, s47, v3
    s_cbranch_execz gm_raw_done
    s_waitcnt lgkmcnt(7)
    v_add_u32 v19, v19, v31
    buffer_load_dwordx4 v19, s[8:11], 0 offen sc1 lds
    s_add_u32 m0, m0, 1024
    s_sub_i32 s47, s47, 64
    v_cmpx_gt_i32 vcc, s47, v3
    s_cbranch_execz gm_raw_done
    s_waitcnt lgkmcnt(6)
    v_add_u32 v20, v20, v32
    buffer_load_dwordx4 v20, s[8:11], 0 offen sc1 lds
    s_add_u32 m0, m0, 1024
    s_sub_i32 s47, s47, 64
    v_cmpx_gt_i32 vcc, s47, v3
    s_cbranch_execz gm_raw_done
    s_waitcnt lgkmcnt(5)
    v_add_u32 v21, v21, v30
    buffer_load_dwordx4 v21, s[8:11], 0 offen sc1 lds
    s_add_u32 m0, m0, 1024
    s_sub_i32 s47, s47, 64
    v_cmpx_gt_i32 vcc, s47, v3
    s_cbranch_execz gm_raw_done
    s_waitcnt lgkmcnt(4)
    v_add_u32 v22, v22, v31
    buffer_load_dwordx4 v22, s[8:11], 0 offen sc1 lds
    s_add_u32 m0, m0, 1024
    s_sub_i32 s47, s47, 64
    v_cmpx_gt_i32 vcc, s47, v3
    s_cbranch_execz gm_raw_done
    s_waitcnt lgkmcnt(3)
    v_add_u32 v23, v23, v32
    buffer_load_dwordx4 v23, s[8:11], 0 offen sc1 lds
    s_add_u32 m0, m0, 1024
    s_sub_i32 s47, s47, 64
    v_cmpx_gt_i32 vcc, s47, v3
    s_cbranch_execz gm_raw_done
    s_waitcnt lgkmcnt(2)
    v_add_u32 v24, v24, v30
    buffer_load_dwordx4 v24, s[8:11], 0 offen sc1 lds
    s_add_u32 m0, m0, 1024
    s_sub_i32 s47, s47, 64
    v_cmpx_gt_i32 vcc, s47, v3
    s_cbranch_execz gm_raw_done
    s_waitcnt lgkmcnt(1)
    v_add_u32 v25, v25, v31
    buffer_load_dwordx4 v25, s[8:11], 0 offen sc1 lds
    s_add_u32 m0, m0, 1024
    s_sub_i32 s47, s47, 64
    v_cmpx_gt_i32 vcc, s47, v3
    s_cbranch_execz gm_raw_done
    s_waitcnt lgkmcnt(0)
    v_add_u32 v26, v26, v32
    buffer_load_dwordx4 v26, s[8:11], 0 offen sc1 lds
    s_add_u32 m0, m0, 1024
    s_sub_i32 s47, s47, 64
    v_add_u32 v11, 768, v11
    v_add_u32 v10, 768, v10
    v_add_u32 v14, 768, v14
    s_branch gm_raw
gm_raw_done:
    s_mov_b64 exec, -1
    s_barrier
    s_waitcnt vmcnt(0) lgkmcnt(0)
    s_barrier
    s_cmp_lg_u32 s21, 0
    s_cbranch_scc1 gm_next
    s_cmp_ge_u32 s2, 125
    s_cbranch_scc1 gm_wdone
    global_load_dwordx4 v[56:59], v5, s[26:27] offset:0
    global_load_dwordx4 v[60:63], v5, s[26:27] offset:512
    global_load_dwordx4 v[64:67], v5, s[26:27] offset:1024
    global_load_dwordx4 v[68:71], v5, s[26:27] offset:1536
    v_subrev_u32 v5, 0x4000, v5
    s_waitcnt vmcnt(0)
    global_load_dwordx4 v[40:43], v5, s[26:27] offset:0
    global_load_dwordx4 v[44:47], v5, s[26:27] offset:512
    global_load_dwordx4 v[48:51], v5, s[26:27] offset:1024
    global_load_dwordx4 v[52:55], v5, s[26:27] offset:1536
    v_subrev_u32 v5, 0x4000, v5
    s_waitcnt vmcnt(0)
gm_wdone:
    global_load_dwordx4 v[24:27], v5, s[26:27] offset:0
    global_load_dwordx4 v[28:31], v5, s[26:27] offset:512
    global_load_dwordx4 v[32:35], v5, s[26:27] offset:1024
    global_load_dwordx4 v[36:39], v5, s[26:27] offset:1536
    v_mov_b32_dpp v152, v138 row_ror:8 row_mask:0xf bank_mask:0xf
    v_mov_b32_dpp v153, v139 row_ror:8 row_mask:0xf bank_mask:0xf
    v_mov_b32_dpp v154, v142 row_ror:8 row_mask:0xf bank_mask:0xf
    v_mov_b32_dpp v155, v143 row_ror:8 row_mask:0xf bank_mask:0xf
    v_mov_b32_dpp v156, v146 row_ror:8 row_mask:0xf bank_mask:0xf
    v_mov_b32_dpp v157, v147 row_ror:8 row_mask:0xf bank_mask:0xf
    v_mov_b32_dpp v158, v150 row_ror:8 row_mask:0xf bank_mask:0xf
    v_mov_b32_dpp v159, v151 row_ror:8 row_mask:0xf bank_mask:0xf
    v_mov_b32_dpp v138, v136 row_ror:8 row_mask:0xf bank_mask:0x3
    v_mov_b32_dpp v139, v137 row_ror:8 row_mask:0xf bank_mask:0x3
    v_mov_b32_dpp v142, v140 row_ror:8 row_mask:0xf bank_mask:0x3
    v_mov_b32_dpp v143, v141 row_ror:8 row_mask:0xf bank_mask:0x3
    v_mov_b32_dpp v146, v144 row_ror:8 row_mask:0xf bank_mask:0x3
    v_mov_b32_dpp v147, v145 row_ror:8 row_mask:0xf bank_mask:0x3
    v_mov_b32_dpp v150, v148 row_ror:8 row_mask:0xf bank_mask:0x3
    v_mov_b32_dpp v151, v149 row_ror:8 row_mask:0xf bank_mask:0x3
    v_mov_b32_dpp v136, v152 quad_perm:[0,1,2,3] row_mask:0xf bank_mask:0xc
    v_mov_b32_dpp v137, v153 quad_perm:[0,1,2,3] row_mask:0xf bank_mask:0xc
    v_mov_b32_dpp v140, v154 quad_perm:[0,1,2,3] row_mask:0xf bank_mask:0xc
    v_mov_b32_dpp v141, v155 quad_perm:[0,1,2,3] row_mask:0xf bank_mask:0xc
    v_mov_b32_dpp v144, v156 quad_perm:[0,1,2,3] row_mask:0xf bank_mask:0xc
    v_mov_b32_dpp v145, v157 quad_perm:[0,1,2,3] row_mask:0xf bank_mask:0xc
    v_mov_b32_dpp v148, v158 quad_perm:[0,1,2,3] row_mask:0xf bank_mask:0xc
    v_mov_b32_dpp v149, v159 quad_perm:[0,1,2,3] row_mask:0xf bank_mask:0xc
    v_perm_b32 v152, v140, v136, s44
    v_perm_b32 v153, v148, v144, s44
    v_perm_b32 v154, v142, v138, s44
    v_perm_b32 v155, v150, v146, s44
    v_perm_b32 v156, v140, v136, s45
    v_perm_b32 v157, v148, v144, s45
    v_perm_b32 v158, v142, v138, s45
    v_perm_b32 v159, v150, v146, s45
    v_perm_b32 v160, v141, v137, s44
    v_perm_b32 v161, v149, v145, s44
    v_perm_b32 v162, v143, v139, s44
    v_perm_b32 v163, v151, v147, s44
    v_perm_b32 v164, v141, v137, s45
    v_perm_b32 v165, v149, v145, s45
    v_perm_b32 v166, v143, v139, s45
    v_perm_b32 v167, v151, v147, s45
    v_mov_b32_dpp v136, v122 row_ror:8 row_mask:0xf bank_mask:0xf
    v_mov_b32_dpp v137, v123 row_ror:8 row_mask:0xf bank_mask:0xf
    v_mov_b32_dpp v138, v126 row_ror:8 row_mask:0xf bank_mask:0xf
    v_mov_b32_dpp v139, v127 row_ror:8 row_mask:0xf bank_mask:0xf
    v_mov_b32_dpp v140, v130 row_ror:8 row_mask:0xf bank_mask:0xf
    v_mov_b32_dpp v141, v131 row_ror:8 row_mask:0xf bank_mask:0xf
    v_mov_b32_dpp v142, v134 row_ror:8 row_mask:0xf bank_mask:0xf
    v_mov_b32_dpp v143, v135 row_ror:8 row_mask:0xf bank_mask:0xf
    v_mov_b32_dpp v122, v120 row_ror:8 row_mask:0xf bank_mask:0x3
    v_mov_b32_dpp v123, v121 row_ror:8 row_mask:0xf bank_mask:0x3
    v_mov_b32_dpp v126, v124 row_ror:8 row_mask:0xf bank_mask:0x3
    v_mov_b32_dpp v127, v125 row_ror:8 row_mask:0xf bank_mask:0x3
    v_mov_b32_dpp v130, v128 row_ror:8 row_mask:0xf bank_mask:0x3
    v_mov_b32_dpp v131, v129 row_ror:8 row_mask:0xf bank_mask:0x3
    v_mov_b32_dpp v134, v132 row_ror:8 row_mask:0xf bank_mask:0x3
    v_mov_b32_dpp v135, v133 row_ror:8 row_mask:0xf bank_mask:0x3
    v_mov_b32_dpp v120, v136 quad_perm:[0,1,2,3] row_mask:0xf bank_mask:0xc
    v_mov_b32_dpp v121, v137 quad_perm:[0,1,2,3] row_mask:0xf bank_mask:0xc
    v_mov_b32_dpp v124, v138 quad_perm:[0,1,2,3] row_mask:0xf bank_mask:0xc
    v_mov_b32_dpp v125, v139 quad_perm:[0,1,2,3] row_mask:0xf bank_mask:0xc
    v_mov_b32_dpp v128, v140 quad_perm:[0,1,2,3] row_mask:0xf bank_mask:0xc
    v_mov_b32_dpp v129, v141 quad_perm:[0,1,2,3] row_mask:0xf bank_mask:0xc
    v_mov_b32_dpp v132, v142 quad_perm:[0,1,2,3] row_mask:0xf bank_mask:0xc
    v_mov_b32_dpp v133, v143 quad_perm:[0,1,2,3] row_mask:0xf bank_mask:0xc
    v_perm_b32 v136, v124, v120, s44
    v_perm_b32 v137, v132, v128, s44
    v_perm_b32 v138, v126, v122, s44
    v_perm_b32 v139, v134, v130, s44
    v_perm_b32 v140, v124, v120, s45
    v_perm_b32 v141, v132, v128, s45
    v_perm_b32 v142, v126, v122, s45
    v_perm_b32 v143, v134, v130, s45
    v_perm_b32 v144, v125, v121, s44
    v_perm_b32 v145, v133, v129, s44
    v_perm_b32 v146, v127, v123, s44
    v_perm_b32 v147, v135, v131, s44
    v_perm_b32 v148, v125, v121, s45
    v_perm_b32 v149, v133, v129, s45
    v_perm_b32 v150, v127, v123, s45
    v_perm_b32 v151, v135, v131, s45
    v_mov_b32_dpp v120, v106 row_ror:8 row_mask:0xf bank_mask:0xf
    v_mov_b32_dpp v121, v107 row_ror:8 row_mask:0xf bank_mask:0xf
    v_mov_b32_dpp v122, v110 row_ror:8 row_mask:0xf bank_mask:0xf
    v_mov_b32_dpp v123, v111 row_ror:8 row_mask:0xf bank_mask:0xf
    v_mov_b32_dpp v124, v114 row_ror:8 row_mask:0xf bank_mask:0xf
    v_mov_b32_dpp v125, v115 row_ror:8 row_mask:0xf bank_mask:0xf
    v_mov_b32_dpp v126, v118 row_ror:8 row_mask:0xf bank_mask:0xf
    v_mov_b32_dpp v127, v119 row_ror:8 row_mask:0xf bank_mask:0xf
    v_mov_b32_dpp v106, v104 row_ror:8 row_mask:0xf bank_mask:0x3
    v_mov_b32_dpp v107, v105 row_ror:8 row_mask:0xf bank_mask:0x3
    v_mov_b32_dpp v110, v108 row_ror:8 row_mask:0xf bank_mask:0x3
    v_mov_b32_dpp v111, v109 row_ror:8 row_mask:0xf bank_mask:0x3
    v_mov_b32_dpp v114, v112 row_ror:8 row_mask:0xf bank_mask:0x3
    v_mov_b32_dpp v115, v113 row_ror:8 row_mask:0xf bank_mask:0x3
    v_mov_b32_dpp v118, v116 row_ror:8 row_mask:0xf bank_mask:0x3
    v_mov_b32_dpp v119, v117 row_ror:8 row_mask:0xf bank_mask:0x3
    v_mov_b32_dpp v104, v120 quad_perm:[0,1,2,3] row_mask:0xf bank_mask:0xc
    v_mov_b32_dpp v105, v121 quad_perm:[0,1,2,3] row_mask:0xf bank_mask:0xc
    v_mov_b32_dpp v108, v122 quad_perm:[0,1,2,3] row_mask:0xf bank_mask:0xc
    v_mov_b32_dpp v109, v123 quad_perm:[0,1,2,3] row_mask:0xf bank_mask:0xc
    v_mov_b32_dpp v112, v124 quad_perm:[0,1,2,3] row_mask:0xf bank_mask:0xc
    v_mov_b32_dpp v113, v125 quad_perm:[0,1,2,3] row_mask:0xf bank_mask:0xc
    v_mov_b32_dpp v116, v126 quad_perm:[0,1,2,3] row_mask:0xf bank_mask:0xc
    v_mov_b32_dpp v117, v127 quad_perm:[0,1,2,3] row_mask:0xf bank_mask:0xc
    v_perm_b32 v120, v108, v104, s44
    v_perm_b32 v121, v116, v112, s44
    v_perm_b32 v122, v110, v106, s44
    v_perm_b32 v123, v118, v114, s44
    v_perm_b32 v124, v108, v104, s45
    v_perm_b32 v125, v116, v112, s45
    v_perm_b32 v126, v110, v106, s45
    v_perm_b32 v127, v118, v114, s45
    v_perm_b32 v128, v109, v105, s44
    v_perm_b32 v129, v117, v113, s44
    v_perm_b32 v130, v111, v107, s44
    v_perm_b32 v131, v119, v115, s44
    v_perm_b32 v132, v109, v105, s45
    v_perm_b32 v133, v117, v113, s45
    v_perm_b32 v134, v111, v107, s45
    v_perm_b32 v135, v119, v115, s45
    v_mov_b32_dpp v104, v90 row_ror:8 row_mask:0xf bank_mask:0xf
    v_mov_b32_dpp v105, v91 row_ror:8 row_mask:0xf bank_mask:0xf
    v_mov_b32_dpp v106, v94 row_ror:8 row_mask:0xf bank_mask:0xf
    v_mov_b32_dpp v107, v95 row_ror:8 row_mask:0xf bank_mask:0xf
    v_mov_b32_dpp v108, v98 row_ror:8 row_mask:0xf bank_mask:0xf
    v_mov_b32_dpp v109, v99 row_ror:8 row_mask:0xf bank_mask:0xf
    v_mov_b32_dpp v110, v102 row_ror:8 row_mask:0xf bank_mask:0xf
    v_mov_b32_dpp v111, v103 row_ror:8 row_mask:0xf bank_mask:0xf
    v_mov_b32_dpp v90, v88 row_ror:8 row_mask:0xf bank_mask:0x3
    v_mov_b32_dpp v91, v89 row_ror:8 row_mask:0xf bank_mask:0x3
    v_mov_b32_dpp v94, v92 row_ror:8 row_mask:0xf bank_mask:0x3
    v_mov_b32_dpp v95, v93 row_ror:8 row_mask:0xf bank_mask:0x3
    v_mov_b32_dpp v98, v96 row_ror:8 row_mask:0xf bank_mask:0x3
    v_mov_b32_dpp v99, v97 row_ror:8 row_mask:0xf bank_mask:0x3
    v_mov_b32_dpp v102, v100 row_ror:8 row_mask:0xf bank_mask:0x3
    v_mov_b32_dpp v103, v101 row_ror:8 row_mask:0xf bank_mask:0x3
    v_mov_b32_dpp v88, v104 quad_perm:[0,1,2,3] row_mask:0xf bank_mask:0xc
    v_mov_b32_dpp v89, v105 quad_perm:[0,1,2,3] row_mask:0xf bank_mask:0xc
    v_mov_b32_dpp v92, v106 quad_perm:[0,1,2,3] row_mask:0xf bank_mask:0xc
    v_mov_b32_dpp v93, v107 quad_perm:[0,1,2,3] row_mask:0xf bank_mask:0xc
    v_mov_b32_dpp v96, v108 quad_perm:[0,1,2,3] row_mask:0xf bank_mask:0xc
    v_mov_b32_dpp v97, v109 quad_perm:[0,1,2,3] row_mask:0xf bank_mask:0xc
    v_mov_b32_dpp v100, v110 quad_perm:[0,1,2,3] row_mask:0xf bank_mask:0xc
    v_mov_b32_dpp v101, v111 quad_perm:[0,1,2,3] row_mask:0xf bank_mask:0xc
    v_perm_b32 v104, v92, v88, s44
    v_perm_b32 v105, v100, v96, s44
    v_perm_b32 v106, v94, v90, s44
    v_perm_b32 v107, v102, v98, s44
    v_perm_b32 v108, v92, v88, s45
    v_perm_b32 v109, v100, v96, s45
    v_perm_b32 v110, v94, v90, s45
    v_perm_b32 v111, v102, v98, s45
    v_perm_b32 v112, v93, v89, s44
    v_perm_b32 v113, v101, v97, s44
    v_perm_b32 v114, v95, v91, s44
    v_perm_b32 v115, v103, v99, s44
    v_perm_b32 v116, v93, v89, s45
    v_perm_b32 v117, v101, v97, s45
    v_perm_b32 v118, v95, v91, s45
    v_perm_b32 v119, v103, v99, s45
    v_mov_b32_dpp v88, v74 row_ror:8 row_mask:0xf bank_mask:0xf
    v_mov_b32_dpp v89, v75 row_ror:8 row_mask:0xf bank_mask:0xf
    v_mov_b32_dpp v90, v78 row_ror:8 row_mask:0xf bank_mask:0xf
    v_mov_b32_dpp v91, v79 row_ror:8 row_mask:0xf bank_mask:0xf
    v_mov_b32_dpp v92, v82 row_ror:8 row_mask:0xf bank_mask:0xf
    v_mov_b32_dpp v93, v83 row_ror:8 row_mask:0xf bank_mask:0xf
    v_mov_b32_dpp v94, v86 row_ror:8 row_mask:0xf bank_mask:0xf
    v_mov_b32_dpp v95, v87 row_ror:8 row_mask:0xf bank_mask:0xf
    v_mov_b32_dpp v74, v72 row_ror:8 row_mask:0xf bank_mask:0x3
    v_mov_b32_dpp v75, v73 row_ror:8 row_mask:0xf bank_mask:0x3
    v_mov_b32_dpp v78, v76 row_ror:8 row_mask:0xf bank_mask:0x3
    v_mov_b32_dpp v79, v77 row_ror:8 row_mask:0xf bank_mask:0x3
    v_mov_b32_dpp v82, v80 row_ror:8 row_mask:0xf bank_mask:0x3
    v_mov_b32_dpp v83, v81 row_ror:8 row_mask:0xf bank_mask:0x3
    v_mov_b32_dpp v86, v84 row_ror:8 row_mask:0xf bank_mask:0x3
    v_mov_b32_dpp v87, v85 row_ror:8 row_mask:0xf bank_mask:0x3
    v_mov_b32_dpp v72, v88 quad_perm:[0,1,2,3] row_mask:0xf bank_mask:0xc
    v_mov_b32_dpp v73, v89 quad_perm:[0,1,2,3] row_mask:0xf bank_mask:0xc
    v_mov_b32_dpp v76, v90 quad_perm:[0,1,2,3] row_mask:0xf bank_mask:0xc
    v_mov_b32_dpp v77, v91 quad_perm:[0,1,2,3] row_mask:0xf bank_mask:0xc
    v_mov_b32_dpp v80, v92 quad_perm:[0,1,2,3] row_mask:0xf bank_mask:0xc
    v_mov_b32_dpp v81, v93 quad_perm:[0,1,2,3] row_mask:0xf bank_mask:0xc
    v_mov_b32_dpp v84, v94 quad_perm:[0,1,2,3] row_mask:0xf bank_mask:0xc
    v_mov_b32_dpp v85, v95 quad_perm:[0,1,2,3] row_mask:0xf bank_mask:0xc
    v_perm_b32 v88, v76, v72, s44
    v_perm_b32 v89, v84, v80, s44
    v_perm_b32 v90, v78, v74, s44
    v_perm_b32 v91, v86, v82, s44
    v_perm_b32 v92, v76, v72, s45
    v_perm_b32 v93, v84, v80, s45
    v_perm_b32 v94, v78, v74, s45
    v_perm_b32 v95, v86, v82, s45
    v_perm_b32 v96, v77, v73, s44
    v_perm_b32 v97, v85, v81, s44
    v_perm_b32 v98, v79, v75, s44
    v_perm_b32 v99, v87, v83, s44
    v_perm_b32 v100, v77, v73, s45
    v_perm_b32 v101, v85, v81, s45
    v_perm_b32 v102, v79, v75, s45
    v_perm_b32 v103, v87, v83, s45
    v_mov_b32_dpp v72, v58 row_ror:8 row_mask:0xf bank_mask:0xf
    v_mov_b32_dpp v73, v59 row_ror:8 row_mask:0xf bank_mask:0xf
    v_mov_b32_dpp v74, v62 row_ror:8 row_mask:0xf bank_mask:0xf
    v_mov_b32_dpp v75, v63 row_ror:8 row_mask:0xf bank_mask:0xf
    v_mov_b32_dpp v76, v66 row_ror:8 row_mask:0xf bank_mask:0xf
    v_mov_b32_dpp v77, v67 row_ror:8 row_mask:0xf bank_mask:0xf
    v_mov_b32_dpp v78, v70 row_ror:8 row_mask:0xf bank_mask:0xf
    v_mov_b32_dpp v79, v71 row_ror:8 row_mask:0xf bank_mask:0xf
    v_mov_b32_dpp v58, v56 row_ror:8 row_mask:0xf bank_mask:0x3
    v_mov_b32_dpp v59, v57 row_ror:8 row_mask:0xf bank_mask:0x3
    v_mov_b32_dpp v62, v60 row_ror:8 row_mask:0xf bank_mask:0x3
    v_mov_b32_dpp v63, v61 row_ror:8 row_mask:0xf bank_mask:0x3
    v_mov_b32_dpp v66, v64 row_ror:8 row_mask:0xf bank_mask:0x3
    v_mov_b32_dpp v67, v65 row_ror:8 row_mask:0xf bank_mask:0x3
    v_mov_b32_dpp v70, v68 row_ror:8 row_mask:0xf bank_mask:0x3
    v_mov_b32_dpp v71, v69 row_ror:8 row_mask:0xf bank_mask:0x3
    v_mov_b32_dpp v56, v72 quad_perm:[0,1,2,3] row_mask:0xf bank_mask:0xc
    v_mov_b32_dpp v57, v73 quad_perm:[0,1,2,3] row_mask:0xf bank_mask:0xc
    v_mov_b32_dpp v60, v74 quad_perm:[0,1,2,3] row_mask:0xf bank_mask:0xc
    v_mov_b32_dpp v61, v75 quad_perm:[0,1,2,3] row_mask:0xf bank_mask:0xc
    v_mov_b32_dpp v64, v76 quad_perm:[0,1,2,3] row_mask:0xf bank_mask:0xc
    v_mov_b32_dpp v65, v77 quad_perm:[0,1,2,3] row_mask:0xf bank_mask:0xc
    v_mov_b32_dpp v68, v78 quad_perm:[0,1,2,3] row_mask:0xf bank_mask:0xc
    v_mov_b32_dpp v69, v79 quad_perm:[0,1,2,3] row_mask:0xf bank_mask:0xc
    v_perm_b32 v72, v60, v56, s44
    v_perm_b32 v73, v68, v64, s44
    v_perm_b32 v74, v62, v58, s44
    v_perm_b32 v75, v70, v66, s44
    v_perm_b32 v76, v60, v56, s45
    v_perm_b32 v77, v68, v64, s45
    v_perm_b32 v78, v62, v58, s45
    v_perm_b32 v79, v70, v66, s45
    v_perm_b32 v80, v61, v57, s44
    v_perm_b32 v81, v69, v65, s44
    v_perm_b32 v82, v63, v59, s44
    v_perm_b32 v83, v71, v67, s44
    v_perm_b32 v84, v61, v57, s45
    v_perm_b32 v85, v69, v65, s45
    v_perm_b32 v86, v63, v59, s45
    v_perm_b32 v87, v71, v67, s45
    v_mov_b32_dpp v56, v42 row_ror:8 row_mask:0xf bank_mask:0xf
    v_mov_b32_dpp v57, v43 row_ror:8 row_mask:0xf bank_mask:0xf
    v_mov_b32_dpp v58, v46 row_ror:8 row_mask:0xf bank_mask:0xf
    v_mov_b32_dpp v59, v47 row_ror:8 row_mask:0xf bank_mask:0xf
    v_mov_b32_dpp v60, v50 row_ror:8 row_mask:0xf bank_mask:0xf
    v_mov_b32_dpp v61, v51 row_ror:8 row_mask:0xf bank_mask:0xf
    v_mov_b32_dpp v62, v54 row_ror:8 row_mask:0xf bank_mask:0xf
    v_mov_b32_dpp v63, v55 row_ror:8 row_mask:0xf bank_mask:0xf
    v_mov_b32_dpp v42, v40 row_ror:8 row_mask:0xf bank_mask:0x3
    v_mov_b32_dpp v43, v41 row_ror:8 row_mask:0xf bank_mask:0x3
    v_mov_b32_dpp v46, v44 row_ror:8 row_mask:0xf bank_mask:0x3
    v_mov_b32_dpp v47, v45 row_ror:8 row_mask:0xf bank_mask:0x3
    v_mov_b32_dpp v50, v48 row_ror:8 row_mask:0xf bank_mask:0x3
    v_mov_b32_dpp v51, v49 row_ror:8 row_mask:0xf bank_mask:0x3
    v_mov_b32_dpp v54, v52 row_ror:8 row_mask:0xf bank_mask:0x3
    v_mov_b32_dpp v55, v53 row_ror:8 row_mask:0xf bank_mask:0x3
    v_mov_b32_dpp v40, v56 quad_perm:[0,1,2,3] row_mask:0xf bank_mask:0xc
    v_mov_b32_dpp v41, v57 quad_perm:[0,1,2,3] row_mask:0xf bank_mask:0xc
    v_mov_b32_dpp v44, v58 quad_perm:[0,1,2,3] row_mask:0xf bank_mask:0xc
    v_mov_b32_dpp v45, v59 quad_perm:[0,1,2,3] row_mask:0xf bank_mask:0xc
    v_mov_b32_dpp v48, v60 quad_perm:[0,1,2,3] row_mask:0xf bank_mask:0xc
    v_mov_b32_dpp v49, v61 quad_perm:[0,1,2,3] row_mask:0xf bank_mask:0xc
    v_mov_b32_dpp v52, v62 quad_perm:[0,1,2,3] row_mask:0xf bank_mask:0xc
    v_mov_b32_dpp v53, v63 quad_perm:[0,1,2,3] row_mask:0xf bank_mask:0xc
    v_perm_b32 v56, v44, v40, s44
    v_perm_b32 v57, v52, v48, s44
    v_perm_b32 v58, v46, v42, s44
    v_perm_b32 v59, v54, v50, s44
    v_perm_b32 v60, v44, v40, s45
    v_perm_b32 v61, v52, v48, s45
    v_perm_b32 v62, v46, v42, s45
    v_perm_b32 v63, v54, v50, s45
    v_perm_b32 v64, v45, v41, s44
    v_perm_b32 v65, v53, v49, s44
    v_perm_b32 v66, v47, v43, s44
    v_perm_b32 v67, v55, v51, s44
    v_perm_b32 v68, v45, v41, s45
    v_perm_b32 v69, v53, v49, s45
    v_perm_b32 v70, v47, v43, s45
    v_perm_b32 v71, v55, v51, s45
    s_waitcnt vmcnt(0)
    v_mov_b32_dpp v40, v26 row_ror:8 row_mask:0xf bank_mask:0xf
    v_mov_b32_dpp v41, v27 row_ror:8 row_mask:0xf bank_mask:0xf
    v_mov_b32_dpp v42, v30 row_ror:8 row_mask:0xf bank_mask:0xf
    v_mov_b32_dpp v43, v31 row_ror:8 row_mask:0xf bank_mask:0xf
    v_mov_b32_dpp v44, v34 row_ror:8 row_mask:0xf bank_mask:0xf
    v_mov_b32_dpp v45, v35 row_ror:8 row_mask:0xf bank_mask:0xf
    v_mov_b32_dpp v46, v38 row_ror:8 row_mask:0xf bank_mask:0xf
    v_mov_b32_dpp v47, v39 row_ror:8 row_mask:0xf bank_mask:0xf
    v_mov_b32_dpp v26, v24 row_ror:8 row_mask:0xf bank_mask:0x3
    v_mov_b32_dpp v27, v25 row_ror:8 row_mask:0xf bank_mask:0x3
    v_mov_b32_dpp v30, v28 row_ror:8 row_mask:0xf bank_mask:0x3
    v_mov_b32_dpp v31, v29 row_ror:8 row_mask:0xf bank_mask:0x3
    v_mov_b32_dpp v34, v32 row_ror:8 row_mask:0xf bank_mask:0x3
    v_mov_b32_dpp v35, v33 row_ror:8 row_mask:0xf bank_mask:0x3
    v_mov_b32_dpp v38, v36 row_ror:8 row_mask:0xf bank_mask:0x3
    v_mov_b32_dpp v39, v37 row_ror:8 row_mask:0xf bank_mask:0x3
    v_mov_b32_dpp v24, v40 quad_perm:[0,1,2,3] row_mask:0xf bank_mask:0xc
    v_mov_b32_dpp v25, v41 quad_perm:[0,1,2,3] row_mask:0xf bank_mask:0xc
    v_mov_b32_dpp v28, v42 quad_perm:[0,1,2,3] row_mask:0xf bank_mask:0xc
    v_mov_b32_dpp v29, v43 quad_perm:[0,1,2,3] row_mask:0xf bank_mask:0xc
    v_mov_b32_dpp v32, v44 quad_perm:[0,1,2,3] row_mask:0xf bank_mask:0xc
    v_mov_b32_dpp v33, v45 quad_perm:[0,1,2,3] row_mask:0xf bank_mask:0xc
    v_mov_b32_dpp v36, v46 quad_perm:[0,1,2,3] row_mask:0xf bank_mask:0xc
    v_mov_b32_dpp v37, v47 quad_perm:[0,1,2,3] row_mask:0xf bank_mask:0xc
    v_perm_b32 v40, v28, v24, s44
    v_perm_b32 v41, v36, v32, s44
    v_perm_b32 v42, v30, v26, s44
    v_perm_b32 v43, v38, v34, s44
    v_perm_b32 v44, v28, v24, s45
    v_perm_b32 v45, v36, v32, s45
    v_perm_b32 v46, v30, v26, s45
    v_perm_b32 v47, v38, v34, s45
    v_perm_b32 v48, v29, v25, s44
    v_perm_b32 v49, v37, v33, s44
    v_perm_b32 v50, v31, v27, s44
    v_perm_b32 v51, v39, v35, s44
    v_perm_b32 v52, v29, v25, s45
    v_perm_b32 v53, v37, v33, s45
    v_perm_b32 v54, v31, v27, s45
    v_perm_b32 v55, v39, v35, s45
    v_lshrrev_b32 v1, 4, v3
    v_lshlrev_b32 v1, 11, v1
    v_and_b32 v4, 7, v3
    v_lshl_add_u32 v1, v4, 4, v1
    v_bfe_u32 v4, v3, 3, 1
    v_lshl_add_u32 v1, v4, 9, v1
    v_and_b32 v4, 3, v3
    v_lshrrev_b32 v5, 2, v3
    v_mul_u32_u24 v0, 576, v4
    v_lshl_add_u32 v0, v5, 3, v0
    v_add_u32 v0, 40960, v0
    s_lshl_b32 s38, s41, 11
    s_lshl_b32 s53, s17, 7
    s_add_u32 s38, s38, s53
    s_mov_b32 s36, 0x24924924
    s_mov_b32 s39, 0
    s_waitcnt vmcnt(0)
gm_poll:
    v_mov_b32 v2, 0
    ds_read_b32 v2, v2 offset:276
    s_waitcnt lgkmcnt(0)
    v_readfirstlane_b32 s52, v2
    s_and_b32 s52, s52, s36
    s_cbranch_scc1 gm_go
    s_sleep 2
    s_branch gm_poll
gm_go:
    s_ff1_i32_b32 s52, s52
    s_bitset0_b32 s36, s52
    s_mul_i32 s52, s52, 11
    s_bfe_u32 s53, s52, 0x10005
    s_bfe_u32 s52, s52, 0x30006
    s_mul_i32 s35, s53, 61440
    s_mul_i32 s31, s52, 2304
    s_add_u32 s31, s31, s35
    s_sub_u32 s35, s31, s39
    v_add_u32 v0, s35, v0
    ds_read_b64_tr_b16 v[12:13], v0 offset:0
    ds_read_b64_tr_b16 v[14:15], v0 offset:128
    ds_read_b64_tr_b16 v[16:17], v0 offset:256
    ds_read_b64_tr_b16 v[18:19], v0 offset:384
    s_mov_b32 s39, s31
    s_mul_i32 s33, s53, 5
    s_add_u32 s33, s33, s52
    s_lshl_b32 s33, s33, 13
    s_add_u32 s33, s33, s38
    s_mov_b32 s37, s33
    s_mov_b32 s32, 0x7ffffff0
gm_loop:
    s_waitcnt lgkmcnt(2)
    v_mfma_f32_16x16x32_bf16 v[24:27], v[12:15], v[40:43], 0
    s_setprio 3
    v_cvt_pk_bf16_f32 v7, v33, v37
    v_cvt_pk_bf16_f32 v5, v32, v36
    ds_read_b64_tr_b16 v[20:21], v0 offset:15360
    s_setprio 0
    v_mfma_f32_16x16x32_bf16 v[28:31], v[12:15], v[44:47], 0
    s_setprio 3
    v_cvt_pk_bf16_f32 v11, v35, v39
    v_cvt_pk_bf16_f32 v9, v34, v38
    ds_read_b64_tr_b16 v[22:23], v0 offset:15488
    s_setprio 0
    v_mfma_f32_16x16x32_bf16 v[32:35], v[12:15], v[48:51], 0
    s_setprio 3
    v_mov_b32_dpp v2, v6 row_ror:8 row_mask:0xf bank_mask:0xf
    v_mov_b32_dpp v3, v7 row_ror:8 row_mask:0xf bank_mask:0xf
    s_setprio 0
    v_mfma_f32_16x16x32_bf16 v[36:39], v[12:15], v[52:55], 0
    s_setprio 3
    v_mov_b32_dpp v6, v4 row_ror:8 row_mask:0xf bank_mask:0x3
    v_mov_b32_dpp v7, v5 row_ror:8 row_mask:0xf bank_mask:0x3
    s_setprio 0
    s_waitcnt lgkmcnt(2)
    v_mfma_f32_16x16x32_bf16 v[24:27], v[16:19], v[56:59], v[24:27]
    s_setprio 3
    ds_read_b64_tr_b16 v[12:13], v0 offset:15616
    v_mov_b32_dpp v4, v2 quad_perm:[0,1,2,3] row_mask:0xf bank_mask:0xc
    s_setprio 0
    v_mfma_f32_16x16x32_bf16 v[28:31], v[16:19], v[60:63], v[28:31]
    s_setprio 3
    ds_read_b64_tr_b16 v[14:15], v0 offset:15744
    v_mov_b32_dpp v5, v3 quad_perm:[0,1,2,3] row_mask:0xf bank_mask:0xc
    s_setprio 0
    v_mfma_f32_16x16x32_bf16 v[32:35], v[16:19], v[64:67], v[32:35]
    s_setprio 3
    buffer_store_dwordx4 v[4:7], v1, s[12:15], s32 offen offset:0 sc0 sc1
    v_mov_b32_dpp v2, v10 row_ror:8 row_mask:0xf bank_mask:0xf
    s_setprio 0
    v_mfma_f32_16x16x32_bf16 v[36:39], v[16:19], v[68:71], v[36:39]
    s_setprio 3
    v_mov_b32_dpp v3, v11 row_ror:8 row_mask:0xf bank_mask:0xf
    v_mov_b32_dpp v10, v8 row_ror:8 row_mask:0xf bank_mask:0x3
    s_setprio 0
    s_waitcnt lgkmcnt(2)
    v_mfma_f32_16x16x32_bf16 v[24:27], v[20:23], v[72:75], v[24:27]
    s_setprio 3
    ds_read_b64_tr_b16 v[16:17], v0 offset:30720
    v_mov_b32_dpp v11, v9 row_ror:8 row_mask:0xf bank_mask:0x3
    s_setprio 0
    v_mfma_f32_16x16x32_bf16 v[28:31], v[20:23], v[76:79], v[28:31]
    s_setprio 3
    ds_read_b64_tr_b16 v[18:19], v0 offset:30848
    v_mov_b32_dpp v8, v2 quad_perm:[0,1,2,3] row_mask:0xf bank_mask:0xc
    s_setprio 0
    v_mfma_f32_16x16x32_bf16 v[32:35], v[20:23], v[80:83], v[32:35]
    s_setprio 3
    v_mov_b32_dpp v9, v3 quad_perm:[0,1,2,3] row_mask:0xf bank_mask:0xc
    buffer_store_dwordx4 v[8:11], v1, s[12:15], s32 offen offset:1024 sc0 sc1
    s_setprio 0
    v_mfma_f32_16x16x32_bf16 v[36:39], v[20:23], v[84:87], v[36:39]
    s_waitcnt lgkmcnt(2)
    v_mfma_f32_16x16x32_bf16 v[24:27], v[12:15], v[88:91], v[24:27]
    ds_read_b64_tr_b16 v[20:21], v0 offset:30976
    v_mfma_f32_16x16x32_bf16 v[28:31], v[12:15], v[92:95], v[28:31]
    ds_read_b64_tr_b16 v[22:23], v0 offset:31104
    v_mfma_f32_16x16x32_bf16 v[32:35], v[12:15], v[96:99], v[32:35]
    s_setprio 3
    v_mov_b32 v2, 0
    s_setprio 0
    v_mfma_f32_16x16x32_bf16 v[36:39], v[12:15], v[100:103], v[36:39]
    ds_read_b32 v2, v2 offset:276
    s_waitcnt lgkmcnt(3)
    v_mfma_f32_16x16x32_bf16 v[24:27], v[16:19], v[104:107], v[24:27]
    ds_read_b64_tr_b16 v[12:13], v0 offset:46080
    v_mfma_f32_16x16x32_bf16 v[28:31], v[16:19], v[108:111], v[28:31]
    ds_read_b64_tr_b16 v[14:15], v0 offset:46208
    v_mfma_f32_16x16x32_bf16 v[32:35], v[16:19], v[112:115], v[32:35]
    s_setprio 3
    s_waitcnt lgkmcnt(2)
    v_readfirstlane_b32 s52, v2
    s_and_b32 s52, s52, s36
    s_setprio 0
    v_mfma_f32_16x16x32_bf16 v[36:39], v[16:19], v[116:119], v[36:39]
    s_cselect_b32 s34, 1, 0
    s_ff1_i32_b32 s52, s52
    s_waitcnt lgkmcnt(2)
    v_mfma_f32_16x16x32_bf16 v[24:27], v[20:23], v[120:123], v[24:27]
    ds_read_b64_tr_b16 v[16:17], v0 offset:46336
    s_bitset0_b32 s36, s52
    s_mul_i32 s52, s52, 11
    v_mfma_f32_16x16x32_bf16 v[28:31], v[20:23], v[124:127], v[28:31]
    ds_read_b64_tr_b16 v[18:19], v0 offset:46464
    s_bfe_u32 s53, s52, 0x10005
    s_bfe_u32 s52, s52, 0x30006
    v_mfma_f32_16x16x32_bf16 v[32:35], v[20:23], v[128:131], v[32:35]
    s_mul_i32 s35, s53, 61440
    s_mul_i32 s31, s52, 2304
    s_add_u32 s31, s31, s35
    v_mfma_f32_16x16x32_bf16 v[36:39], v[20:23], v[132:135], v[36:39]
    s_setprio 3
    s_sub_u32 s35, s31, s39
    v_add_u32 v0, s35, v0
    s_setprio 0
    s_waitcnt lgkmcnt(2)
    v_mfma_f32_16x16x32_bf16 v[24:27], v[12:15], v[136:139], v[24:27]
    ds_read_b64_tr_b16 v[20:21], v0 offset:0
    v_mfma_f32_16x16x32_bf16 v[28:31], v[12:15], v[140:143], v[28:31]
    ds_read_b64_tr_b16 v[22:23], v0 offset:128
    v_mfma_f32_16x16x32_bf16 v[32:35], v[12:15], v[144:147], v[32:35]
    s_mov_b32 s39, s31
    s_mul_i32 s33, s53, 5
    s_add_u32 s33, s33, s52
    v_mfma_f32_16x16x32_bf16 v[36:39], v[12:15], v[148:151], v[36:39]
    s_lshl_b32 s33, s33, 13
    s_add_u32 s33, s33, s38
    s_waitcnt lgkmcnt(2)
    v_mfma_f32_16x16x32_bf16 v[24:27], v[16:19], v[152:155], v[24:27]
    ds_read_b64_tr_b16 v[12:13], v0 offset:256
    v_mfma_f32_16x16x32_bf16 v[28:31], v[16:19], v[156:159], v[28:31]
    ds_read_b64_tr_b16 v[14:15], v0 offset:384
    s_mov_b32 s32, s37
    s_mov_b32 s37, s33
    v_mfma_f32_16x16x32_bf16 v[32:35], v[16:19], v[160:163], v[32:35]
    s_cmp_eq_u32 s34, 0
    s_nop 1
    v_mfma_f32_16x16x32_bf16 v[36:39], v[16:19], v[164:167], v[36:39]
    s_setprio 3
    v_cvt_pk_bf16_f32 v4, v24, v28
    v_cvt_pk_bf16_f32 v6, v25, v29
    v_cvt_pk_bf16_f32 v8, v26, v30
    v_cvt_pk_bf16_f32 v10, v27, v31
    s_setprio 0
    s_cbranch_scc1 gm_drain
    s_waitcnt lgkmcnt(2)
    v_mfma_f32_16x16x32_bf16 v[24:27], v[20:23], v[40:43], 0
    s_setprio 3
    v_cvt_pk_bf16_f32 v7, v33, v37
    v_cvt_pk_bf16_f32 v5, v32, v36
    ds_read_b64_tr_b16 v[16:17], v0 offset:15360
    s_setprio 0
    v_mfma_f32_16x16x32_bf16 v[28:31], v[20:23], v[44:47], 0
    s_setprio 3
    v_cvt_pk_bf16_f32 v11, v35, v39
    v_cvt_pk_bf16_f32 v9, v34, v38
    ds_read_b64_tr_b16 v[18:19], v0 offset:15488
    s_setprio 0
    v_mfma_f32_16x16x32_bf16 v[32:35], v[20:23], v[48:51], 0
    s_setprio 3
    v_mov_b32_dpp v2, v6 row_ror:8 row_mask:0xf bank_mask:0xf
    v_mov_b32_dpp v3, v7 row_ror:8 row_mask:0xf bank_mask:0xf
    s_setprio 0
    v_mfma_f32_16x16x32_bf16 v[36:39], v[20:23], v[52:55], 0
    s_setprio 3
    v_mov_b32_dpp v6, v4 row_ror:8 row_mask:0xf bank_mask:0x3
    v_mov_b32_dpp v7, v5 row_ror:8 row_mask:0xf bank_mask:0x3
    s_setprio 0
    s_waitcnt lgkmcnt(2)
    v_mfma_f32_16x16x32_bf16 v[24:27], v[12:15], v[56:59], v[24:27]
    s_setprio 3
    ds_read_b64_tr_b16 v[20:21], v0 offset:15616
    v_mov_b32_dpp v4, v2 quad_perm:[0,1,2,3] row_mask:0xf bank_mask:0xc
    s_setprio 0
    v_mfma_f32_16x16x32_bf16 v[28:31], v[12:15], v[60:63], v[28:31]
    s_setprio 3
    ds_read_b64_tr_b16 v[22:23], v0 offset:15744
    v_mov_b32_dpp v5, v3 quad_perm:[0,1,2,3] row_mask:0xf bank_mask:0xc
    s_setprio 0
    v_mfma_f32_16x16x32_bf16 v[32:35], v[12:15], v[64:67], v[32:35]
    s_setprio 3
    buffer_store_dwordx4 v[4:7], v1, s[12:15], s32 offen offset:0 sc0 sc1
    v_mov_b32_dpp v2, v10 row_ror:8 row_mask:0xf bank_mask:0xf
    s_setprio 0
    v_mfma_f32_16x16x32_bf16 v[36:39], v[12:15], v[68:71], v[36:39]
    s_setprio 3
    v_mov_b32_dpp v3, v11 row_ror:8 row_mask:0xf bank_mask:0xf
    v_mov_b32_dpp v10, v8 row_ror:8 row_mask:0xf bank_mask:0x3
    s_setprio 0
    s_waitcnt lgkmcnt(2)
    v_mfma_f32_16x16x32_bf16 v[24:27], v[16:19], v[72:75], v[24:27]
    s_setprio 3
    ds_read_b64_tr_b16 v[12:13], v0 offset:30720
    v_mov_b32_dpp v11, v9 row_ror:8 row_mask:0xf bank_mask:0x3
    s_setprio 0
    v_mfma_f32_16x16x32_bf16 v[28:31], v[16:19], v[76:79], v[28:31]
    s_setprio 3
    ds_read_b64_tr_b16 v[14:15], v0 offset:30848
    v_mov_b32_dpp v8, v2 quad_perm:[0,1,2,3] row_mask:0xf bank_mask:0xc
    s_setprio 0
    v_mfma_f32_16x16x32_bf16 v[32:35], v[16:19], v[80:83], v[32:35]
    s_setprio 3
    v_mov_b32_dpp v9, v3 quad_perm:[0,1,2,3] row_mask:0xf bank_mask:0xc
    buffer_store_dwordx4 v[8:11], v1, s[12:15], s32 offen offset:1024 sc0 sc1
    s_setprio 0
    v_mfma_f32_16x16x32_bf16 v[36:39], v[16:19], v[84:87], v[36:39]
    s_waitcnt lgkmcnt(2)
    v_mfma_f32_16x16x32_bf16 v[24:27], v[20:23], v[88:91], v[24:27]
    ds_read_b64_tr_b16 v[16:17], v0 offset:30976
    v_mfma_f32_16x16x32_bf16 v[28:31], v[20:23], v[92:95], v[28:31]
    ds_read_b64_tr_b16 v[18:19], v0 offset:31104
    v_mfma_f32_16x16x32_bf16 v[32:35], v[20:23], v[96:99], v[32:35]
    s_setprio 3
    v_mov_b32 v2, 0
    s_setprio 0
    v_mfma_f32_16x16x32_bf16 v[36:39], v[20:23], v[100:103], v[36:39]
    ds_read_b32 v2, v2 offset:276
    s_waitcnt lgkmcnt(3)
    v_mfma_f32_16x16x32_bf16 v[24:27], v[12:15], v[104:107], v[24:27]
    ds_read_b64_tr_b16 v[20:21], v0 offset:46080
    v_mfma_f32_16x16x32_bf16 v[28:31], v[12:15], v[108:111], v[28:31]
    ds_read_b64_tr_b16 v[22:23], v0 offset:46208
    v_mfma_f32_16x16x32_bf16 v[32:35], v[12:15], v[112:115], v[32:35]
    s_setprio 3
    s_waitcnt lgkmcnt(2)
    v_readfirstlane_b32 s52, v2
    s_and_b32 s52, s52, s36
    s_setprio 0
    v_mfma_f32_16x16x32_bf16 v[36:39], v[12:15], v[116:119], v[36:39]
    s_cselect_b32 s34, 1, 0
    s_ff1_i32_b32 s52, s52
    s_waitcnt lgkmcnt(2)
    v_mfma_f32_16x16x32_bf16 v[24:27], v[16:19], v[120:123], v[24:27]
    ds_read_b64_tr_b16 v[12:13], v0 offset:46336
    s_bitset0_b32 s36, s52
    s_mul_i32 s52, s52, 11
    v_mfma_f32_16x16x32_bf16 v[28:31], v[16:19], v[124:127], v[28:31]
    ds_read_b64_tr_b16 v[14:15], v0 offset:46464
    s_bfe_u32 s53, s52, 0x10005
    s_bfe_u32 s52, s52, 0x30006
    v_mfma_f32_16x16x32_bf16 v[32:35], v[16:19], v[128:131], v[32:35]
    s_mul_i32 s35, s53, 61440
    s_mul_i32 s31, s52, 2304
    s_add_u32 s31, s31, s35
    v_mfma_f32_16x16x32_bf16 v[36:39], v[16:19], v[132:135], v[36:39]
    s_setprio 3
    s_sub_u32 s35, s31, s39
    v_add_u32 v0, s35, v0
    s_setprio 0
    s_waitcnt lgkmcnt(2)
    v_mfma_f32_16x16x32_bf16 v[24:27], v[20:23], v[136:139], v[24:27]
    ds_read_b64_tr_b16 v[16:17], v0 offset:0
    v_mfma_f32_16x16x32_bf16 v[28:31], v[20:23], v[140:143], v[28:31]
    ds_read_b64_tr_b16 v[18:19], v0 offset:128
    v_mfma_f32_16x16x32_bf16 v[32:35], v[20:23], v[144:147], v[32:35]
    s_mov_b32 s39, s31
    s_mul_i32 s33, s53, 5
    s_add_u32 s33, s33, s52
    v_mfma_f32_16x16x32_bf16 v[36:39], v[20:23], v[148:151], v[36:39]
    s_lshl_b32 s33, s33, 13
    s_add_u32 s33, s33, s38
    s_waitcnt lgkmcnt(2)
    v_mfma_f32_16x16x32_bf16 v[24:27], v[12:15], v[152:155], v[24:27]
    ds_read_b64_tr_b16 v[20:21], v0 offset:256
    v_mfma_f32_16x16x32_bf16 v[28:31], v[12:15], v[156:159], v[28:31]
    ds_read_b64_tr_b16 v[22:23], v0 offset:384
    s_mov_b32 s32, s37
    s_mov_b32 s37, s33
    v_mfma_f32_16x16x32_bf16 v[32:35], v[12:15], v[160:163], v[32:35]
    s_cmp_eq_u32 s34, 0
    s_nop 1
    v_mfma_f32_16x16x32_bf16 v[36:39], v[12:15], v[164:167], v[36:39]
    s_setprio 3
    v_cvt_pk_bf16_f32 v4, v24, v28
    v_cvt_pk_bf16_f32 v6, v25, v29
    v_cvt_pk_bf16_f32 v8, v26, v30
    v_cvt_pk_bf16_f32 v10, v27, v31
    s_setprio 0
    s_cbranch_scc1 gm_drain
    s_waitcnt lgkmcnt(2)
    v_mfma_f32_16x16x32_bf16 v[24:27], v[16:19], v[40:43], 0
    s_setprio 3
    v_cvt_pk_bf16_f32 v7, v33, v37
    v_cvt_pk_bf16_f32 v5, v32, v36
    ds_read_b64_tr_b16 v[12:13], v0 offset:15360
    s_setprio 0
    v_mfma_f32_16x16x32_bf16 v[28:31], v[16:19], v[44:47], 0
    s_setprio 3
    v_cvt_pk_bf16_f32 v11, v35, v39
    v_cvt_pk_bf16_f32 v9, v34, v38
    ds_read_b64_tr_b16 v[14:15], v0 offset:15488
    s_setprio 0
    v_mfma_f32_16x16x32_bf16 v[32:35], v[16:19], v[48:51], 0
    s_setprio 3
    v_mov_b32_dpp v2, v6 row_ror:8 row_mask:0xf bank_mask:0xf
    v_mov_b32_dpp v3, v7 row_ror:8 row_mask:0xf bank_mask:0xf
    s_setprio 0
    v_mfma_f32_16x16x32_bf16 v[36:39], v[16:19], v[52:55], 0
    s_setprio 3
    v_mov_b32_dpp v6, v4 row_ror:8 row_mask:0xf bank_mask:0x3
    v_mov_b32_dpp v7, v5 row_ror:8 row_mask:0xf bank_mask:0x3
    s_setprio 0
    s_waitcnt lgkmcnt(2)
    v_mfma_f32_16x16x32_bf16 v[24:27], v[20:23], v[56:59], v[24:27]
    s_setprio 3
    ds_read_b64_tr_b16 v[16:17], v0 offset:15616
    v_mov_b32_dpp v4, v2 quad_perm:[0,1,2,3] row_mask:0xf bank_mask:0xc
    s_setprio 0
    v_mfma_f32_16x16x32_bf16 v[28:31], v[20:23], v[60:63], v[28:31]
    s_setprio 3
    ds_read_b64_tr_b16 v[18:19], v0 offset:15744
    v_mov_b32_dpp v5, v3 quad_perm:[0,1,2,3] row_mask:0xf bank_mask:0xc
    s_setprio 0
    v_mfma_f32_16x16x32_bf16 v[32:35], v[20:23], v[64:67], v[32:35]
    s_setprio 3
    buffer_store_dwordx4 v[4:7], v1, s[12:15], s32 offen offset:0 sc0 sc1
    v_mov_b32_dpp v2, v10 row_ror:8 row_mask:0xf bank_mask:0xf
    s_setprio 0
    v_mfma_f32_16x16x32_bf16 v[36:39], v[20:23], v[68:71], v[36:39]
    s_setprio 3
    v_mov_b32_dpp v3, v11 row_ror:8 row_mask:0xf bank_mask:0xf
    v_mov_b32_dpp v10, v8 row_ror:8 row_mask:0xf bank_mask:0x3
    s_setprio 0
    s_waitcnt lgkmcnt(2)
    v_mfma_f32_16x16x32_bf16 v[24:27], v[12:15], v[72:75], v[24:27]
    s_setprio 3
    ds_read_b64_tr_b16 v[20:21], v0 offset:30720
    v_mov_b32_dpp v11, v9 row_ror:8 row_mask:0xf bank_mask:0x3
    s_setprio 0
    v_mfma_f32_16x16x32_bf16 v[28:31], v[12:15], v[76:79], v[28:31]
    s_setprio 3
    ds_read_b64_tr_b16 v[22:23], v0 offset:30848
    v_mov_b32_dpp v8, v2 quad_perm:[0,1,2,3] row_mask:0xf bank_mask:0xc
    s_setprio 0
    v_mfma_f32_16x16x32_bf16 v[32:35], v[12:15], v[80:83], v[32:35]
    s_setprio 3
    v_mov_b32_dpp v9, v3 quad_perm:[0,1,2,3] row_mask:0xf bank_mask:0xc
    buffer_store_dwordx4 v[8:11], v1, s[12:15], s32 offen offset:1024 sc0 sc1
    s_setprio 0
    v_mfma_f32_16x16x32_bf16 v[36:39], v[12:15], v[84:87], v[36:39]
    s_waitcnt lgkmcnt(2)
    v_mfma_f32_16x16x32_bf16 v[24:27], v[16:19], v[88:91], v[24:27]
    ds_read_b64_tr_b16 v[12:13], v0 offset:30976
    v_mfma_f32_16x16x32_bf16 v[28:31], v[16:19], v[92:95], v[28:31]
    ds_read_b64_tr_b16 v[14:15], v0 offset:31104
    v_mfma_f32_16x16x32_bf16 v[32:35], v[16:19], v[96:99], v[32:35]
    s_setprio 3
    v_mov_b32 v2, 0
    s_setprio 0
    v_mfma_f32_16x16x32_bf16 v[36:39], v[16:19], v[100:103], v[36:39]
    ds_read_b32 v2, v2 offset:276
    s_waitcnt lgkmcnt(3)
    v_mfma_f32_16x16x32_bf16 v[24:27], v[20:23], v[104:107], v[24:27]
    ds_read_b64_tr_b16 v[16:17], v0 offset:46080
    v_mfma_f32_16x16x32_bf16 v[28:31], v[20:23], v[108:111], v[28:31]
    ds_read_b64_tr_b16 v[18:19], v0 offset:46208
    v_mfma_f32_16x16x32_bf16 v[32:35], v[20:23], v[112:115], v[32:35]
    s_setprio 3
    s_waitcnt lgkmcnt(2)
    v_readfirstlane_b32 s52, v2
    s_and_b32 s52, s52, s36
    s_setprio 0
    v_mfma_f32_16x16x32_bf16 v[36:39], v[20:23], v[116:119], v[36:39]
    s_cselect_b32 s34, 1, 0
    s_ff1_i32_b32 s52, s52
    s_waitcnt lgkmcnt(2)
    v_mfma_f32_16x16x32_bf16 v[24:27], v[12:15], v[120:123], v[24:27]
    ds_read_b64_tr_b16 v[20:21], v0 offset:46336
    s_bitset0_b32 s36, s52
    s_mul_i32 s52, s52, 11
    v_mfma_f32_16x16x32_bf16 v[28:31], v[12:15], v[124:127], v[28:31]
    ds_read_b64_tr_b16 v[22:23], v0 offset:46464
    s_bfe_u32 s53, s52, 0x10005
    s_bfe_u32 s52, s52, 0x30006
    v_mfma_f32_16x16x32_bf16 v[32:35], v[12:15], v[128:131], v[32:35]
    s_mul_i32 s35, s53, 61440
    s_mul_i32 s31, s52, 2304
    s_add_u32 s31, s31, s35
    v_mfma_f32_16x16x32_bf16 v[36:39], v[12:15], v[132:135], v[36:39]
    s_setprio 3
    s_sub_u32 s35, s31, s39
    v_add_u32 v0, s35, v0
    s_setprio 0
    s_waitcnt lgkmcnt(2)
    v_mfma_f32_16x16x32_bf16 v[24:27], v[16:19], v[136:139], v[24:27]
    ds_read_b64_tr_b16 v[12:13], v0 offset:0
    v_mfma_f32_16x16x32_bf16 v[28:31], v[16:19], v[140:143], v[28:31]
    ds_read_b64_tr_b16 v[14:15], v0 offset:128
    v_mfma_f32_16x16x32_bf16 v[32:35], v[16:19], v[144:147], v[32:35]
    s_mov_b32 s39, s31
    s_mul_i32 s33, s53, 5
    s_add_u32 s33, s33, s52
    v_mfma_f32_16x16x32_bf16 v[36:39], v[16:19], v[148:151], v[36:39]
    s_lshl_b32 s33, s33, 13
    s_add_u32 s33, s33, s38
    s_waitcnt lgkmcnt(2)
    v_mfma_f32_16x16x32_bf16 v[24:27], v[20:23], v[152:155], v[24:27]
    ds_read_b64_tr_b16 v[16:17], v0 offset:256
    v_mfma_f32_16x16x32_bf16 v[28:31], v[20:23], v[156:159], v[28:31]
    ds_read_b64_tr_b16 v[18:19], v0 offset:384
    s_mov_b32 s32, s37
    s_mov_b32 s37, s33
    v_mfma_f32_16x16x32_bf16 v[32:35], v[20:23], v[160:163], v[32:35]
    s_cmp_eq_u32 s34, 0
    s_nop 1
    v_mfma_f32_16x16x32_bf16 v[36:39], v[20:23], v[164:167], v[36:39]
    s_setprio 3
    v_cvt_pk_bf16_f32 v4, v24, v28
    v_cvt_pk_bf16_f32 v6, v25, v29
    v_cvt_pk_bf16_f32 v8, v26, v30
    v_cvt_pk_bf16_f32 v10, v27, v31
    s_setprio 0
    s_cbranch_scc0 gm_loop
gm_drain:
    s_nop 2
    s_setprio 3
    v_cvt_pk_bf16_f32 v7, v33, v37
    v_cvt_pk_bf16_f32 v5, v32, v36
    v_cvt_pk_bf16_f32 v11, v35, v39
    v_cvt_pk_bf16_f32 v9, v34, v38
    v_mov_b32_dpp v2, v6 row_ror:8 row_mask:0xf bank_mask:0xf
    v_mov_b32_dpp v3, v7 row_ror:8 row_mask:0xf bank_mask:0xf
    v_mov_b32_dpp v6, v4 row_ror:8 row_mask:0xf bank_mask:0x3
    v_mov_b32_dpp v7, v5 row_ror:8 row_mask:0xf bank_mask:0x3
    v_mov_b32_dpp v4, v2 quad_perm:[0,1,2,3] row_mask:0xf bank_mask:0xc
    v_mov_b32_dpp v5, v3 quad_perm:[0,1,2,3] row_mask:0xf bank_mask:0xc
    buffer_store_dwordx4 v[4:7], v1, s[12:15], s32 offen offset:0 sc0 sc1
    v_mov_b32_dpp v2, v10 row_ror:8 row_mask:0xf bank_mask:0xf
    v_mov_b32_dpp v3, v11 row_ror:8 row_mask:0xf bank_mask:0xf
    v_mov_b32_dpp v10, v8 row_ror:8 row_mask:0xf bank_mask:0x3
    v_mov_b32_dpp v11, v9 row_ror:8 row_mask:0xf bank_mask:0x3
    v_mov_b32_dpp v8, v2 quad_perm:[0,1,2,3] row_mask:0xf bank_mask:0xc
    v_mov_b32_dpp v9, v3 quad_perm:[0,1,2,3] row_mask:0xf bank_mask:0xc
    buffer_store_dwordx4 v[8:11], v1, s[12:15], s32 offen offset:1024 sc0 sc1
    s_setprio 0
    s_cmp_lg_u32 s36, 0
    s_cbranch_scc1 gm_poll
    s_endpgm
mn_sp1:
    v_mov_b32 v55, 0
    ds_read_b32 v55, v55 offset:308
    s_waitcnt lgkmcnt(0)
    v_readfirstlane_b32 s62, v55
    s_cmp_ge_u32 s62, 1
    s_cbranch_scc1 mn_sp1x
    s_sleep 1
    s_branch mn_sp1
gm_wait2:
    v_mov_b32 v15, 0
    ds_read_b32 v17, v15 offset:304
    s_waitcnt lgkmcnt(0)
    v_readfirstlane_b32 s62, v17
    s_cmp_lg_u32 s62, 0
    s_cbranch_scc1 gm_go2
    s_sleep 1
    s_branch gm_wait2
gm_ovf:
    s_movk_i32 s20, 4
    s_barrier
    s_barrier
    s_branch gm_pass
gm_next:
    s_add_u32 s24, s24, s20
    s_barrier
    s_branch gm_pass
mn_w5:
    s_and_b32 s62, s2, 15
    s_lshl_b32 s62, s62, 7
    s_add_u32 s62, s62, 11730944
    v_mov_b32 v55, s62
    v_lshlrev_b32 v56, 6, v0
    v_and_b32 v56, 0xc0, v56
    s_mov_b32 s63, 0x100000
mn_poll2dm:
    s_sub_u32 s63, s63, 1
    s_cbranch_scc1 mn_poll2dx
    global_load_dword v57, v56, s[60:61] sc1
    s_waitcnt vmcnt(0)
    v_add_u32_dpp v57, v57, v57 quad_perm:[2,3,0,1] row_mask:0xf bank_mask:0xf
    s_sleep 8
    v_readlane_b32 s62, v57, 1
    s_cmp_lt_u32 s62, 125
    s_cbranch_scc1 mn_poll2dm
mn_poll2dx:
    v_add_u32 v55, 12, v35
    v_add_u32 v55, s24, v55
    v_lshrrev_b32 v56, 16, v58
    v_mov_b32 v23, 0
    v_cmpx_lt_u32 vcc, v55, v56
    s_cbranch_execz mn_g0
    v_cmp_gt_u32 vcc, 15, v55
    v_and_b32 v56, 0xffff, v58
    v_add_lshl_u32 v56, v55, v56, 2
    v_add_u32 v56, v56, v46
    v_lshl_add_u32 v57, v0, 4, s22
    v_and_or_b32 v57, v55, 12, v57
    v_cndmask_b32 v56, v56, v57, vcc
    buffer_load_dword v23, v56, s[8:11], 0 offen sc1
    s_waitcnt vmcnt(0)
mn_g0:
    s_mov_b64 exec, -1
    v_add_u32 v55, 16, v35
    v_add_u32 v55, s24, v55
    v_lshrrev_b32 v56, 16, v58
    v_mov_b32 v24, 0
    v_cmpx_lt_u32 vcc, v55, v56
    s_cbranch_execz mn_g1
    v_cmp_gt_u32 vcc, 15, v55
    v_and_b32 v56, 0xffff, v58
    v_add_lshl_u32 v56, v55, v56, 2
    v_add_u32 v56, v56, v46
    v_lshl_add_u32 v57, v0, 4, s22
    v_and_or_b32 v57, v55, 12, v57
    v_cndmask_b32 v56, v56, v57, vcc
    buffer_load_dword v24, v56, s[8:11], 0 offen sc1
    s_waitcnt vmcnt(0)
mn_g1:
    s_mov_b64 exec, -1
mn_more:
    s_add_u32 s52, s24, s20
    v_lshrrev_b32 v56, 16, v58
    v_cmp_lt_u32 vcc, s52, v56
    s_cbranch_vccz mn_count
    v_mov_b32 v55, 272
    ds_write_b32 v55, v48
    s_branch mn_count
mn_ovf:
    s_movk_i32 s20, 4
    s_waitcnt vmcnt(0) lgkmcnt(0)
    s_barrier
    s_branch mn_again
mn_next:
    s_set_gpr_idx_off
    s_waitcnt vmcnt(0) lgkmcnt(0)
    s_nop 7
    s_add_u32 s24, s24, s20
    v_mbcnt_lo_u32_b32 v0, -1, 0
    v_mbcnt_hi_u32_b32 v0, -1, v0
    v_lshl_add_u32 v0, s16, 6, v0
    v_lshrrev_b32 v56, 6, v0
    v_lshlrev_b32 v55, 1, v0
    v_and_b32 v55, 0x78, v55
    v_or_b32 v55, v55, v56
    v_cmp_gt_u32 vcc, 125, v55
    v_mul_u32_u24 v46, 5120, v55
    v_add_u32 v46, 7340032, v46
    v_bfrev_b32 v56, 2
    v_lshlrev_b32 v44, 4, v0
    v_cndmask_b32 v44, v56, v44, vcc
    v_and_b32 v51, 63, v0
    buffer_load_dwordx4 v[20:23], v44, s[8:11], s22 offen sc1
    v_mov_b32 v48, 1
    v_lshlrev_b32 v47, 2, v51
    v_bfe_u32 v2, v0, 5, 1
    v_bfe_u32 v3, v0, 3, 2
    v_and_b32 v35, 3, v0
    v_lshl_add_u32 v3, v3, 2, v35
    v_mul_u32_u24 v49, 20, v2
    v_lshrrev_b32 v18, 2, v51
    v_lshl_add_u32 v18, v35, 4, v18
    v_mov_b32 v50, 0x3fff
    s_lshl_b32 s37, s16, 2
    v_mov_b32 v59, s37
    s_sub_u32 s36, s16, 1
    s_waitcnt vmcnt(0)
    v_mov_b32_dpp v58, v23 quad_perm:[3,3,3,3] row_mask:0xf bank_mask:0xf
mn_again:
    v_mov_b32 v55, 0
    ds_write_b32 v47, v55 offset:0
    ds_write_b32 v47, v55 offset:128
    s_waitcnt vmcnt(0) lgkmcnt(0)
    s_barrier
    v_add_u32 v55, 0, v35
    v_add_u32 v55, s24, v55
    v_lshrrev_b32 v56, 16, v58
    v_mov_b32 v20, 0
    v_cmpx_lt_u32 vcc, v55, v56
    s_cbranch_execz mn_g2
    v_cmp_gt_u32 vcc, 15, v55
    v_and_b32 v56, 0xffff, v58
    v_add_lshl_u32 v56, v55, v56, 2
    v_add_u32 v56, v56, v46
    v_lshl_add_u32 v57, v0, 4, s22
    v_and_or_b32 v57, v55, 12, v57
    v_cndmask_b32 v56, v56, v57, vcc
    buffer_load_dword v20, v56, s[8:11], 0 offen sc1
    s_waitcnt vmcnt(0)
mn_g2:
    s_mov_b64 exec, -1
    v_mov_b32 v21, 0
    v_mov_b32 v22, 0
    v_mov_b32 v23, 0
    v_mov_b32 v24, 0
    s_cmp_le_u32 s20, 4
    s_cbranch_scc1 mn_more
    v_add_u32 v55, 4, v35
    v_add_u32 v55, s24, v55
    v_lshrrev_b32 v56, 16, v58
    v_mov_b32 v21, 0
    v_cmpx_lt_u32 vcc, v55, v56
    s_cbranch_execz mn_g3
    v_cmp_gt_u32 vcc, 15, v55
    v_and_b32 v56, 0xffff, v58
    v_add_lshl_u32 v56, v55, v56, 2
    v_add_u32 v56, v56, v46
    v_lshl_add_u32 v57, v0, 4, s22
    v_and_or_b32 v57, v55, 12, v57
    v_cndmask_b32 v56, v56, v57, vcc
    buffer_load_dword v21, v56, s[8:11], 0 offen sc1
    s_waitcnt vmcnt(0)
mn_g3:
    s_mov_b64 exec, -1
    v_add_u32 v55, 8, v35
    v_add_u32 v55, s24, v55
    v_lshrrev_b32 v56, 16, v58
    v_mov_b32 v22, 0
    v_cmpx_lt_u32 vcc, v55, v56
    s_cbranch_execz mn_g4
    v_cmp_gt_u32 vcc, 15, v55
    v_and_b32 v56, 0xffff, v58
    v_add_lshl_u32 v56, v55, v56, 2
    v_add_u32 v56, v56, v46
    v_lshl_add_u32 v57, v0, 4, s22
    v_and_or_b32 v57, v55, 12, v57
    v_cndmask_b32 v56, v56, v57, vcc
    buffer_load_dword v22, v56, s[8:11], 0 offen sc1
    s_waitcnt vmcnt(0)
mn_g4:
    s_mov_b64 exec, -1
    v_add_u32 v55, 12, v35
    v_add_u32 v55, s24, v55
    v_lshrrev_b32 v56, 16, v58
    v_mov_b32 v23, 0
    v_cmpx_lt_u32 vcc, v55, v56
    s_cbranch_execz mn_g5
    v_cmp_gt_u32 vcc, 15, v55
    v_and_b32 v56, 0xffff, v58
    v_add_lshl_u32 v56, v55, v56, 2
    v_add_u32 v56, v56, v46
    v_lshl_add_u32 v57, v0, 4, s22
    v_and_or_b32 v57, v55, 12, v57
    v_cndmask_b32 v56, v56, v57, vcc
    buffer_load_dword v23, v56, s[8:11], 0 offen sc1
    s_waitcnt vmcnt(0)
mn_g5:
    s_mov_b64 exec, -1
    v_add_u32 v55, 16, v35
    v_add_u32 v55, s24, v55
    v_lshrrev_b32 v56, 16, v58
    v_mov_b32 v24, 0
    v_cmpx_lt_u32 vcc, v55, v56
    s_cbranch_execz mn_g6
    v_cmp_gt_u32 vcc, 15, v55
    v_and_b32 v56, 0xffff, v58
    v_add_lshl_u32 v56, v55, v56, 2
    v_add_u32 v56, v56, v46
    v_lshl_add_u32 v57, v0, 4, s22
    v_and_or_b32 v57, v55, 12, v57
    v_cndmask_b32 v56, v56, v57, vcc
    buffer_load_dword v24, v56, s[8:11], 0 offen sc1
    s_waitcnt vmcnt(0)
mn_g6:
    s_mov_b64 exec, -1
    s_branch mn_more
mn_last:
    s_endpgm
.section .rodata,"a"
.p2align 6
.amdhsa_kernel standalone__tensor_product_equiv_mace__graph_kernel
  .amdhsa_next_free_vgpr 168
  .amdhsa_next_free_sgpr 96
  .amdhsa_accum_offset 168
  .amdhsa_group_segment_fixed_size 0
  .amdhsa_kernarg_size 88
  .amdhsa_user_sgpr_count 2
  .amdhsa_user_sgpr_kernarg_segment_ptr 1
  .amdhsa_system_sgpr_workgroup_id_x 1
.end_amdhsa_kernel
```

```asm
; @launch grid=(256,1,1) block=(768,1,1) lds=163840
.amdgcn_target "amdgcn-amd-amdhsa--gfx950"
.text
.globl standalone__tensor_product_equiv_mace__graph_kernel
.p2align 8
.type standalone__tensor_product_equiv_mace__graph_kernel,@function
standalone__tensor_product_equiv_mace__graph_kernel:
    s_load_dwordx8 s[4:11], s[0:1], 8
    s_load_dwordx4 s[12:15], s[0:1], 72
    v_lshrrev_b32 v9, 6, v0
    s_and_b32 s3, s2, 127
    v_readfirstlane_b32 s18, v9
    v_and_b32 v1, 63, v0
    s_cmp_lt_u32 s2, 125
    s_cbranch_scc1 ka_bin
    s_cmp_ge_u32 s2, 256
    s_cbranch_scc1 ka_end
    s_getpc_b64 s[36:37]
ka_pc0:
    v_lshlrev_b32 v41, 7, v0
    s_mul_i32 s34, s3, 40960
    v_add_u32 v44, s34, v41
    v_min_u32 v41, mn_last-ka_pc0, v41
    global_load_dword v41, v41, s[36:37]
    s_cmp_ge_u32 s3, 125
    s_cbranch_scc1 ka_idle
    s_cmp_ge_u32 s18, 5
    s_cbranch_scc1 ka_pf
    s_waitcnt vmcnt(0) lgkmcnt(0)
    global_load_dword v45, v44, s[10:11]
    s_branch ka_pf
ka_bin:
    s_cmp_ge_u32 s18, 10
    s_cbranch_scc1 ka_dma
    s_mul_i32 s3, s2, 5120
    v_lshl_add_u32 v5, v0, 2, s3
    s_waitcnt lgkmcnt(0)
    global_load_dword v10, v5, s[6:7]
    global_load_dword v60, v5, s[6:7] offset:2560
    global_load_dword v11, v5, s[4:5]
    global_load_dword v61, v5, s[4:5] offset:2560
    v_lshlrev_b32 v2, 2, v0
    v_and_b32 v2, 0x3fc, v2
    v_lshlrev_b32 v5, 4, v0
    v_mov_b32 v44, 0
    v_mov_b32 v45, 0
    v_mov_b32 v46, 0
    v_mov_b32 v47, 0
    ds_write_b32 v2, v44 offset:1024
    ds_write_b128 v5, v[44:47] offset:12288
    ds_write_b128 v5, v[44:47] offset:18432
    s_and_b32 s21, s15, 0xffff
    s_mov_b32 s22, 12582912
    s_mov_b32 s23, 0x20000
    s_mov_b32 s20, s14
    v_mov_b32 v3, 1
    v_lshlrev_b32 v26, 4, v1
    s_lshl_b32 s19, s18, 10
    v_add_u32 v27, s19, v26
    v_mov_b32 v4, 0x40000
    s_movk_i32 s29, 625
    s_movk_i32 s38, 0x3fff
    s_movk_i32 s39, 4096
    s_waitcnt lgkmcnt(0)
    s_barrier
    v_mov_b32 v19, 74752
    v_lshl_add_u32 v18, v0, 1, 0
    v_mul_u32_u24 v16, 13108, v18
    v_lshrrev_b32 v16, 16, v16
    v_mad_i32_i24 v18, v16, -5, v18
    v_lshlrev_b32 v16, 2, v16
    v_cmp_eq_u32 vcc, 4, v18
    v_lshlrev_b32 v18, 3, v18
    v_add_u32 v18, 33792, v18
    v_cndmask_b32 v17, 5, 3, vcc
    v_cndmask_b32 v18, v18, v19, vcc
    v_lshl_add_u32 v14, v0, 1, 1
    v_mul_u32_u24 v12, 13108, v14
    v_lshrrev_b32 v12, 16, v12
    v_mad_i32_i24 v14, v12, -5, v14
    v_lshlrev_b32 v12, 2, v12
    v_cmp_eq_u32 vcc, 4, v14
    v_lshlrev_b32 v14, 3, v14
    v_add_u32 v14, 33792, v14
    v_cndmask_b32 v13, 5, 3, vcc
    v_cndmask_b32 v14, v14, v19, vcc
    s_mul_i32 s31, s2, 51200
    s_waitcnt vmcnt(3)
    v_mul_u32_u24 v32, 214749, v10
    v_lshrrev_b32 v32, 23, v32
    v_min_u32 v32, 255, v32
    v_and_b32 v35, 7, v32
    v_lshrrev_b32 v33, 3, v32
    v_lshl_add_u32 v35, v35, 5, v33
    v_lshlrev_b32 v35, 2, v35
    ds_add_rtn_u32 v36, v35, v3 offset:1024
    s_waitcnt vmcnt(2)
    v_mul_u32_u24 v62, 214749, v60
    v_lshrrev_b32 v62, 23, v62
    v_min_u32 v62, 255, v62
    v_and_b32 v66, 7, v62
    v_lshrrev_b32 v63, 3, v62
    v_lshl_add_u32 v66, v66, 5, v63
    v_lshlrev_b32 v66, 2, v66
    ds_add_rtn_u32 v67, v66, v3 offset:1024
    v_mad_u32_u24 v33, v32, s29, 15
    v_lshrrev_b32 v33, 4, v33
    v_sub_u32 v33, v10, v33
    v_subrev_u32 v32, 20, v33
    v_min_u32 v32, v32, v33
    v_min_u32 v32, 19, v32
    v_lshlrev_b32 v40, 4, v35
    v_add_u32 v35, s19, v35
    v_mad_u32_u24 v63, v62, s29, 15
    v_lshrrev_b32 v63, 4, v63
    v_sub_u32 v63, v60, v63
    v_subrev_u32 v62, 20, v63
    v_min_u32 v62, v62, v63
    v_min_u32 v62, 19, v62
    v_lshlrev_b32 v70, 4, v66
    v_add_u32 v66, s19, v66
    s_waitcnt vmcnt(0) lgkmcnt(0)
    v_lshrrev_b32 v34, 11, v40
    v_mul_u32_u24 v34, 512, v34
    v_sub_u32 v34, v11, v34
    v_cmp_gt_u32 vcc, s39, v11
    v_add_u32 v39, s39, v34
    v_min_u32 v34, v34, v39
    v_cndmask_b32 v34, v11, v34, vcc
    v_mul_u32_u24 v39, 3330, v34
    v_lshrrev_b32 v39, 20, v39
    v_lshrrev_b32 v34, 2, v32
    v_cmp_gt_u32 vcc, 27, v39
    v_add_u32 v34, 27, v34
    v_lshlrev_b32 v23, 14, v32
    v_cndmask_b32 v39, v34, v39, vcc
    v_cmp_le_u32 vcc, 20, v33
    v_and_or_b32 v22, v11, s38, v23
    v_or_b32 v39, 64, v39
    v_add_u32 v34, 32, v39
    v_cndmask_b32 v39, v39, v34, vcc
    v_lshl_or_b32 v22, v39, 25, v22
    v_cmp_lt_u32 vcc, 14, v36
    v_and_b32 v34, 3, v36
    v_lshl_add_u32 v40, v34, 4, v40
    v_and_or_b32 v40, v36, 12, v40
    v_cndmask_b32 v40, v40, v4, vcc
    ds_write_b32 v40, v22 offset:12288
    v_lshrrev_b32 v71, 11, v70
    v_mul_u32_u24 v71, 512, v71
    v_sub_u32 v71, v61, v71
    v_cmp_gt_u32 vcc, s39, v61
    v_add_u32 v68, s39, v71
    v_min_u32 v71, v71, v68
    v_cndmask_b32 v71, v61, v71, vcc
    v_mul_u32_u24 v68, 3330, v71
    v_lshrrev_b32 v68, 20, v68
    v_lshrrev_b32 v71, 2, v62
    v_cmp_gt_u32 vcc, 27, v68
    v_add_u32 v71, 27, v71
    v_lshlrev_b32 v75, 14, v62
    v_cndmask_b32 v68, v71, v68, vcc
    v_cmp_le_u32 vcc, 20, v63
    v_and_or_b32 v74, v61, s38, v75
    v_or_b32 v68, 64, v68
    v_add_u32 v71, 32, v68
    v_cndmask_b32 v68, v68, v71, vcc
    v_lshl_or_b32 v74, v68, 25, v74
    v_cmp_lt_u32 vcc, 14, v67
    v_and_b32 v71, 3, v67
    v_lshl_add_u32 v70, v71, 4, v70
    v_and_or_b32 v70, v67, 12, v70
    v_cndmask_b32 v70, v70, v4, vcc
    ds_write_b32 v70, v74 offset:12288
    s_waitcnt lgkmcnt(0)
    s_barrier
    ds_read_b128 v[44:47], v26 offset:1024
    v_add_u32 v9, 640, v0
    v_max_u32 v8, v36, v67
    v_cmp_lt_u32 vcc, 14, v8
    s_waitcnt lgkmcnt(0)
    v_add_u32 v53, v44, v45
    v_add_u32 v54, v53, v46
    v_add_u32 v38, v54, v47
    v_mov_b32 v55, v38
    s_nop 0
    v_add_u32_dpp v38, v38, v38 row_shr:1 row_mask:0xf bank_mask:0xf
    s_nop 0
    s_nop 0
    v_add_u32_dpp v38, v38, v38 row_shr:2 row_mask:0xf bank_mask:0xf
    s_nop 0
    s_nop 0
    v_add_u32_dpp v38, v38, v38 row_shr:4 row_mask:0xf bank_mask:0xf
    s_nop 0
    s_nop 0
    v_add_u32_dpp v38, v38, v38 row_shr:8 row_mask:0xf bank_mask:0xf
    s_nop 0
    s_nop 0
    v_add_u32_dpp v38, v38, v38 row_bcast:15 row_mask:0xa bank_mask:0xf
    s_nop 0
    s_nop 0
    v_add_u32_dpp v38, v38, v38 row_bcast:31 row_mask:0xc bank_mask:0xf
    v_sub_u32 v56, v38, v55
    v_add_u32 v57, v56, v44
    v_add_u32 v58, v56, v53
    v_add_u32 v59, v56, v54
    ds_write_b128 v27, v[56:59] offset:2048
    ds_read_b32 v43, v35 offset:2048
    ds_read_b32 v69, v66 offset:2048
    s_waitcnt lgkmcnt(0)
    v_add_lshl_u32 v43, v43, v36, 2
    v_add_lshl_u32 v69, v69, v67, 2
    ds_write_b32 v43, v0 offset:28672
    ds_write_b32 v69, v9 offset:28672
    s_cbranch_vccnz ka_ov
ka_ov_back:
    s_waitcnt lgkmcnt(0)
ka_copy:
    s_barrier
    ds_read_b32 v20, v16 offset:28672
    ds_read_b32 v21, v12 offset:28672
    ds_read_b32 v22, v16 offset:29696
    ds_read_b32 v23, v12 offset:29696
    ds_read_b32 v24, v16 offset:30720
    ds_read_b32 v25, v12 offset:30720
    ds_read_b32 v26, v16 offset:31744
    ds_read_b32 v27, v12 offset:31744
    ds_read_b32 v28, v16 offset:32768
    ds_read_b32 v29, v12 offset:32768
    s_waitcnt lgkmcnt(8)
    v_lshl_add_u32 v20, v20, v17, v18
    v_lshl_add_u32 v21, v21, v13, v14
    ds_read_b64 v[44:45], v20
    ds_read_b64 v[46:47], v21
    s_waitcnt lgkmcnt(8)
    v_lshl_add_u32 v22, v22, v17, v18
    v_lshl_add_u32 v23, v23, v13, v14
    ds_read_b64 v[48:49], v22
    ds_read_b64 v[50:51], v23
    s_waitcnt lgkmcnt(8)
    v_lshl_add_u32 v24, v24, v17, v18
    v_lshl_add_u32 v25, v25, v13, v14
    ds_read_b64 v[52:53], v24
    ds_read_b64 v[54:55], v25
    s_waitcnt lgkmcnt(8)
    v_lshl_add_u32 v26, v26, v17, v18
    v_lshl_add_u32 v27, v27, v13, v14
    ds_read_b64 v[56:57], v26
    ds_read_b64 v[58:59], v27
    s_waitcnt lgkmcnt(8)
    v_lshl_add_u32 v28, v28, v17, v18
    v_lshl_add_u32 v29, v29, v13, v14
    ds_read_b64 v[60:61], v28
    ds_read_b64 v[62:63], v29
    s_waitcnt lgkmcnt(8)
    buffer_store_dwordx4 v[44:47], v5, s[20:23], s31 offen sc1
    s_addk_i32 s31, 10240
    s_waitcnt lgkmcnt(6)
    buffer_store_dwordx4 v[48:51], v5, s[20:23], s31 offen sc1
    s_addk_i32 s31, 10240
    s_waitcnt lgkmcnt(4)
    buffer_store_dwordx4 v[52:55], v5, s[20:23], s31 offen sc1
    s_addk_i32 s31, 10240
    s_waitcnt lgkmcnt(2)
    buffer_store_dwordx4 v[56:59], v5, s[20:23], s31 offen sc1
    s_addk_i32 s31, 10240
    s_waitcnt lgkmcnt(0)
    buffer_store_dwordx4 v[60:63], v5, s[20:23], s31 offen sc1
    s_branch mn_start2
ka_ov:
    s_mul_i32 s33, s2, 5120
    s_add_u32 s33, s33, 7340032
    buffer_store_dword v22, v43, s[20:23], s33 offen sc1
    buffer_store_dword v74, v69, s[20:23], s33 offen sc1
    s_branch ka_ov_back
ka_dma:
    s_cmp_eq_u32 s18, 11
    s_cbranch_scc1 ka_cell
    s_mul_i32 s35, s2, 40960
    v_lshl_add_u32 v7, v1, 4, s35
    s_mul_i32 s35, s2, 10240
    v_lshl_add_u32 v8, v1, 4, s35
    s_mov_b32 m0, 74752
    s_waitcnt lgkmcnt(0)
    s_load_dwordx4 s[36:39], s[0:1], 40
    s_barrier
    global_load_lds_dwordx4 v8, s[8:9] offset:0
    global_load_lds_dwordx4 v8, s[8:9] offset:1024
    s_add_u32 m0, m0, 2048
    v_add_u32 v8, 2048, v8
    global_load_lds_dwordx4 v8, s[8:9] offset:0
    global_load_lds_dwordx4 v8, s[8:9] offset:1024
    s_add_u32 m0, m0, 2048
    v_add_u32 v8, 2048, v8
    global_load_lds_dwordx4 v8, s[8:9] offset:0
    global_load_lds_dwordx4 v8, s[8:9] offset:1024
    s_add_u32 m0, m0, 2048
    v_add_u32 v8, 2048, v8
    global_load_lds_dwordx4 v8, s[8:9] offset:0
    global_load_lds_dwordx4 v8, s[8:9] offset:1024
    s_add_u32 m0, m0, 2048
    v_add_u32 v8, 2048, v8
    global_load_lds_dwordx4 v8, s[8:9] offset:0
    global_load_lds_dwordx4 v8, s[8:9] offset:1024
    s_add_u32 m0, m0, 2048
    v_add_u32 v8, 2048, v8
    s_mov_b32 m0, 33792
    s_nop 0
    global_load_lds_dwordx4 v7, s[10:11] offset:0
    global_load_lds_dwordx4 v7, s[10:11] offset:1024
    s_add_u32 m0, m0, 2048
    v_add_u32 v7, 2048, v7
    global_load_lds_dwordx4 v7, s[10:11] offset:0
    global_load_lds_dwordx4 v7, s[10:11] offset:1024
    s_add_u32 m0, m0, 2048
    v_add_u32 v7, 2048, v7
    global_load_lds_dwordx4 v7, s[10:11] offset:0
    global_load_lds_dwordx4 v7, s[10:11] offset:1024
    s_add_u32 m0, m0, 2048
    v_add_u32 v7, 2048, v7
    s_barrier
    global_load_lds_dwordx4 v7, s[10:11] offset:0
    global_load_lds_dwordx4 v7, s[10:11] offset:1024
    s_add_u32 m0, m0, 2048
    v_add_u32 v7, 2048, v7
    global_load_lds_dwordx4 v7, s[10:11] offset:0
    global_load_lds_dwordx4 v7, s[10:11] offset:1024
    s_add_u32 m0, m0, 2048
    v_add_u32 v7, 2048, v7
    global_load_lds_dwordx4 v7, s[10:11] offset:0
    global_load_lds_dwordx4 v7, s[10:11] offset:1024
    s_add_u32 m0, m0, 2048
    v_add_u32 v7, 2048, v7
    global_load_lds_dwordx4 v7, s[10:11] offset:0
    global_load_lds_dwordx4 v7, s[10:11] offset:1024
    s_add_u32 m0, m0, 2048
    v_add_u32 v7, 2048, v7
    global_load_lds_dwordx4 v7, s[10:11] offset:0
    global_load_lds_dwordx4 v7, s[10:11] offset:1024
    s_add_u32 m0, m0, 2048
    v_add_u32 v7, 2048, v7
    global_load_lds_dwordx4 v7, s[10:11] offset:0
    global_load_lds_dwordx4 v7, s[10:11] offset:1024
    s_add_u32 m0, m0, 2048
    v_add_u32 v7, 2048, v7
    global_load_lds_dwordx4 v7, s[10:11] offset:0
    global_load_lds_dwordx4 v7, s[10:11] offset:1024
    s_add_u32 m0, m0, 2048
    v_add_u32 v7, 2048, v7
    global_load_lds_dwordx4 v7, s[10:11] offset:0
    global_load_lds_dwordx4 v7, s[10:11] offset:1024
    s_add_u32 m0, m0, 2048
    v_add_u32 v7, 2048, v7
    global_load_lds_dwordx4 v7, s[10:11] offset:0
    global_load_lds_dwordx4 v7, s[10:11] offset:1024
    s_add_u32 m0, m0, 2048
    v_add_u32 v7, 2048, v7
    global_load_lds_dwordx4 v7, s[10:11] offset:0
    global_load_lds_dwordx4 v7, s[10:11] offset:1024
    s_add_u32 m0, m0, 2048
    v_add_u32 v7, 2048, v7
    global_load_lds_dwordx4 v7, s[10:11] offset:0
    global_load_lds_dwordx4 v7, s[10:11] offset:1024
    s_add_u32 m0, m0, 2048
    v_add_u32 v7, 2048, v7
    global_load_lds_dwordx4 v7, s[10:11] offset:0
    global_load_lds_dwordx4 v7, s[10:11] offset:1024
    s_add_u32 m0, m0, 2048
    v_add_u32 v7, 2048, v7
    global_load_lds_dwordx4 v7, s[10:11] offset:0
    global_load_lds_dwordx4 v7, s[10:11] offset:1024
    s_add_u32 m0, m0, 2048
    v_add_u32 v7, 2048, v7
    global_load_lds_dwordx4 v7, s[10:11] offset:0
    global_load_lds_dwordx4 v7, s[10:11] offset:1024
    s_add_u32 m0, m0, 2048
    v_add_u32 v7, 2048, v7
    global_load_lds_dwordx4 v7, s[10:11] offset:0
    global_load_lds_dwordx4 v7, s[10:11] offset:1024
    s_add_u32 m0, m0, 2048
    v_add_u32 v7, 2048, v7
    global_load_lds_dwordx4 v7, s[10:11] offset:0
    global_load_lds_dwordx4 v7, s[10:11] offset:1024
    s_add_u32 m0, m0, 2048
    v_add_u32 v7, 2048, v7
    global_load_lds_dwordx4 v7, s[10:11] offset:0
    global_load_lds_dwordx4 v7, s[10:11] offset:1024
    s_add_u32 m0, m0, 2048
    v_add_u32 v7, 2048, v7
    s_mov_b32 s35, m0
    s_mov_b32 m0, 148480
    v_lshlrev_b32 v9, 4, v1
    v_add_u32 v10, 4096, v9
    s_waitcnt lgkmcnt(0)
    global_load_lds_dwordx4 v9, s[38:39]
    global_load_lds_dwordx4 v9, s[38:39] offset:1024
    global_load_lds_dwordx4 v9, s[38:39] offset:2048
    global_load_lds_dwordx4 v9, s[38:39] offset:3072
    s_mov_b32 m0, 152576
    s_nop 0
    global_load_lds_dwordx4 v10, s[38:39]
    global_load_lds_dwordx4 v10, s[38:39] offset:1024
    global_load_lds_dwordx4 v10, s[38:39] offset:2048
    global_load_lds_dwordx4 v10, s[38:39] offset:3072
    s_mov_b32 m0, 156672
    s_mov_b64 exec, 0xff
    global_load_lds_dwordx4 v9, s[36:37]
    s_mov_b64 exec, -1
    s_mov_b32 m0, s35
    s_waitcnt vmcnt(0)
    s_barrier
    s_branch mn_start
ka_cell:
    s_and_b32 s28, s2, 7
    s_lshl_b32 s28, s28, 4
    s_lshr_b32 s29, s2, 3
    s_add_u32 s28, s28, s29
    s_waitcnt lgkmcnt(0)
    s_and_b32 s21, s15, 0xffff
    s_mov_b32 s22, 12582912
    s_mov_b32 s23, 0x20000
    s_mov_b32 s20, s14
    s_lshl_b32 s30, s28, 10
    s_add_u32 s30, s30, 8388608
    v_lshlrev_b32 v3, 3, v1
    v_mov_b32 v4, 0
    v_mov_b32 v5, 0
    ds_write_b64 v3, v[4:5]
    v_lshlrev_b32 v26, 4, v1
    v_lshrrev_b32 v6, 6, v1
    v_lshlrev_b32 v6, 17, v6
    v_and_b32 v7, 1008, v26
    v_or_b32 v6, v7, v6
    v_lshlrev_b32 v27, 8, v1
    s_waitcnt lgkmcnt(0)
    s_barrier
    s_and_b32 s58, s2, 15
    s_lshl_b32 s58, s58, 7
    s_add_u32 s58, s58, 11730944
    v_mov_b32 v86, s58
    global_load_dword v87, v86, s[14:15] sc1
    s_barrier
    ds_read_b128 v[12:15], v26 offset:1024
    s_waitcnt lgkmcnt(0)
    v_add_u32 v17, v12, v13
    v_add_u32 v18, v17, v14
    v_add_u32 v16, v18, v15
    v_mov_b32 v19, v16
    v_lshlrev_b32 v20, 16, v12
    v_add_u32_dpp v16, v16, v16 row_shr:1 row_mask:0xf bank_mask:0xf
    v_lshl_add_u32 v21, v13, 16, v12
    s_nop 0
    v_add_u32_dpp v16, v16, v16 row_shr:2 row_mask:0xf bank_mask:0xf
    v_lshl_add_u32 v22, v14, 16, v17
    s_nop 0
    v_add_u32_dpp v16, v16, v16 row_shr:4 row_mask:0xf bank_mask:0xf
    v_lshl_add_u32 v23, v15, 16, v18
    s_nop 0
    v_add_u32_dpp v16, v16, v16 row_shr:8 row_mask:0xf bank_mask:0xf
    s_nop 1
    v_add_u32_dpp v16, v16, v16 row_bcast:15 row_mask:0xa bank_mask:0xf
    s_nop 1
    v_add_u32_dpp v16, v16, v16 row_bcast:31 row_mask:0xc bank_mask:0xf
    v_sub_u32 v16, v16, v19
    v_mov_b32 v86, 0
    s_waitcnt vmcnt(0)
    ds_write_b32 v86, v87 offset:456
    v_add_u32 v20, v20, v16
    ds_write_b32 v27, v20 offset:12348
    v_add_u32 v21, v21, v16
    ds_write_b32 v27, v21 offset:12412
    v_add_u32 v22, v22, v16
    ds_write_b32 v27, v22 offset:12476
    v_add_u32 v23, v23, v16
    ds_write_b32 v27, v23 offset:12540
    ds_read_b128 v[28:31], v26 offset:12288
    ds_read_b128 v[32:35], v26 offset:13312
    ds_read_b128 v[36:39], v26 offset:14336
    ds_read_b128 v[40:43], v26 offset:15360
    ds_read_b128 v[44:47], v26 offset:16384
    ds_read_b128 v[48:51], v26 offset:17408
    ds_read_b128 v[52:55], v26 offset:18432
    ds_read_b128 v[56:59], v26 offset:19456
    s_waitcnt lgkmcnt(7)
    buffer_store_dwordx4 v[28:31], v6, s[20:23], s30 offen sc1
    ds_read_b128 v[60:63], v26 offset:20480
    s_add_u32 s30, s30, 131072
    s_waitcnt lgkmcnt(7)
    buffer_store_dwordx4 v[32:35], v6, s[20:23], s30 offen sc1
    ds_read_b128 v[64:67], v26 offset:21504
    s_add_u32 s30, s30, 131072
    s_waitcnt lgkmcnt(7)
    buffer_store_dwordx4 v[36:39], v6, s[20:23], s30 offen sc1
    ds_read_b128 v[68:71], v26 offset:22528
    s_add_u32 s30, s30, 131072
    s_waitcnt lgkmcnt(7)
    buffer_store_dwordx4 v[40:43], v6, s[20:23], s30 offen sc1
    ds_read_b128 v[72:75], v26 offset:23552
    s_add_u32 s30, s30, 131072
    s_waitcnt lgkmcnt(7)
    buffer_store_dwordx4 v[44:47], v6, s[20:23], s30 offen sc1
    ds_read_b128 v[76:79], v26 offset:24576
    s_add_u32 s30, s30, 131072
    s_waitcnt lgkmcnt(7)
    buffer_store_dwordx4 v[48:51], v6, s[20:23], s30 offen sc1
    ds_read_b128 v[80:83], v26 offset:25600
    s_add_u32 s30, s30, 131072
    s_waitcnt lgkmcnt(7)
    buffer_store_dwordx4 v[52:55], v6, s[20:23], s30 offen sc1
    ds_read_b128 v[28:31], v26 offset:26624
    s_add_u32 s30, s30, 131072
    s_waitcnt lgkmcnt(7)
    buffer_store_dwordx4 v[56:59], v6, s[20:23], s30 offen sc1
    ds_read_b128 v[32:35], v26 offset:27648
    s_add_u32 s30, s30, 131072
    s_waitcnt lgkmcnt(7)
    buffer_store_dwordx4 v[60:63], v6, s[20:23], s30 offen sc1
    s_add_u32 s30, s30, 131072
    s_waitcnt lgkmcnt(6)
    buffer_store_dwordx4 v[64:67], v6, s[20:23], s30 offen sc1
    s_add_u32 s30, s30, 131072
    s_waitcnt lgkmcnt(5)
    buffer_store_dwordx4 v[68:71], v6, s[20:23], s30 offen sc1
    s_add_u32 s30, s30, 131072
    s_waitcnt lgkmcnt(4)
    buffer_store_dwordx4 v[72:75], v6, s[20:23], s30 offen sc1
    s_add_u32 s30, s30, 131072
    s_waitcnt lgkmcnt(3)
    buffer_store_dwordx4 v[76:79], v6, s[20:23], s30 offen sc1
    s_add_u32 s30, s30, 131072
    s_waitcnt lgkmcnt(2)
    buffer_store_dwordx4 v[80:83], v6, s[20:23], s30 offen sc1
    s_add_u32 s30, s30, 131072
    s_waitcnt lgkmcnt(1)
    buffer_store_dwordx4 v[28:31], v6, s[20:23], s30 offen sc1
    s_add_u32 s30, s30, 131072
    s_waitcnt lgkmcnt(0)
    buffer_store_dwordx4 v[32:35], v6, s[20:23], s30 offen sc1
    s_barrier
    s_waitcnt vmcnt(0)
    s_mov_b64 exec, 1
    v_mov_b32 v2, 0
    v_mov_b32 v3, 1
    s_and_b32 s34, s2, 1
    s_lshl_b32 s35, s34, 7
    s_add_u32 s35, s35, 0
    s_mov_b32 s33, 1
    s_atomic_add s33, s[12:13], s35 glc
    s_mov_b32 s36, 1
    s_lshl_b32 s34, s34, 3
    s_lshr_b32 s34, 15678, s34
    s_and_b32 s34, s34, 0xff
    s_waitcnt lgkmcnt(0)
    s_cmp_eq_u32 s33, s34
    s_cbranch_scc1 ka_bcast
ka_arc:
    s_mov_b64 exec, -1
    s_branch mn_start
ka_pf:
    s_load_dwordx2 s[16:17], s[0:1], 0
    s_load_dwordx2 s[32:33], s[0:1], 56
    s_waitcnt lgkmcnt(0)
    s_and_b32 s34, s2, 7
    s_mul_i32 s34, s34, 1048576
    s_add_u32 s24, s16, s34
    s_addc_u32 s25, s17, 0
    s_and_b32 s25, s25, 0xffff
    s_mov_b32 s26, 1048576
    s_mov_b32 s27, 0x20000
    s_bfe_u32 s30, s2, 0x40003
    v_lshlrev_b32 v40, 7, v0
    s_mul_i32 s30, s30, 65536
    s_cmp_lg_u32 s18, 9
    s_cbranch_scc1 ka_nowt
    s_bfe_u32 s35, s2, 0x40003
    s_lshl_b32 s35, s35, 13
    v_lshl_add_u32 v46, v1, 7, s35
    global_load_dword v46, v46, s[32:33]
ka_nowt:
ka_pf1:
    s_cmp_ge_u32 s18, 8
    s_cbranch_scc1 ka_pfe
    s_waitcnt vmcnt(0)
    buffer_load_dword v42, v40, s[24:27], s30 offen
    s_cmp_ge_u32 s18, 0
    s_cbranch_scc1 ka_pfe
    s_add_u32 s30, s30, 81920
    buffer_load_dword v43, v40, s[24:27], s30 offen
    s_branch ka_pfe
ka_idle:
    s_waitcnt lgkmcnt(0)
ka_pfe:
    s_cmp_lt_u32 s18, 10
    s_cbranch_scc1 ka_pfb
    s_cmp_eq_u32 s18, 11
    s_cbranch_scc1 ka_pfz
    s_load_dwordx4 s[36:39], s[0:1], 40
    s_mov_b32 m0, 148480
    v_lshlrev_b32 v9, 4, v1
    v_add_u32 v10, 4096, v9
    s_waitcnt lgkmcnt(0)
    global_load_lds_dwordx4 v9, s[38:39]
    global_load_lds_dwordx4 v9, s[38:39] offset:1024
    global_load_lds_dwordx4 v9, s[38:39] offset:2048
    global_load_lds_dwordx4 v9, s[38:39] offset:3072
    s_mov_b32 m0, 152576
    s_nop 0
    global_load_lds_dwordx4 v10, s[38:39]
    global_load_lds_dwordx4 v10, s[38:39] offset:1024
    global_load_lds_dwordx4 v10, s[38:39] offset:2048
    global_load_lds_dwordx4 v10, s[38:39] offset:3072
    s_mov_b32 m0, 156672
    s_mov_b64 exec, 0xff
    global_load_lds_dwordx4 v9, s[36:37]
    s_mov_b64 exec, -1
    s_waitcnt vmcnt(0)
    s_branch ka_pfb
ka_pfz:
    s_and_b32 s58, s2, 15
    s_lshl_b32 s58, s58, 7
    s_add_u32 s58, s58, 11730944
    v_mov_b32 v86, s58
    global_load_dword v87, v86, s[14:15] sc1
    v_lshlrev_b32 v3, 3, v1
    v_mov_b32 v4, 0
    v_mov_b32 v5, 0
    ds_write_b64 v3, v[4:5]
    v_mov_b32 v86, 0
    s_waitcnt vmcnt(0)
    ds_write_b32 v86, v87 offset:456
    s_waitcnt lgkmcnt(0)
ka_pfb:
    s_barrier
    s_branch mn_start
ka_bcast:
    s_mov_b64 exec, -1
    s_add_u32 s34, s14, 11730944
    s_addc_u32 s35, s15, 0
    s_atomic_add s36, s[34:35], 0
    s_atomic_add s36, s[34:35], 128
    s_atomic_add s36, s[34:35], 256
    s_atomic_add s36, s[34:35], 384
    s_atomic_add s36, s[34:35], 512
    s_atomic_add s36, s[34:35], 640
    s_atomic_add s36, s[34:35], 768
    s_atomic_add s36, s[34:35], 896
    s_atomic_add s36, s[34:35], 1024
    s_atomic_add s36, s[34:35], 1152
    s_atomic_add s36, s[34:35], 1280
    s_atomic_add s36, s[34:35], 1408
    s_atomic_add s36, s[34:35], 1536
    s_atomic_add s36, s[34:35], 1664
    s_atomic_add s36, s[34:35], 1792
    s_atomic_add s36, s[34:35], 1920
    s_branch mn_start
ka_end:
    s_endpgm
mn_start:
    s_waitcnt vmcnt(0) lgkmcnt(0)
mn_start2:
    s_cmp_ge_u32 s2, 256
    s_cbranch_scc1 mn_end
    s_load_dwordx2 s[54:55], s[0:1], 80
    s_load_dwordx2 s[50:51], s[0:1], 0
    s_load_dwordx2 s[60:61], s[0:1], 72
    v_lshrrev_b32 v56, 6, v0
    s_and_b32 s48, s2, 7
    v_readfirstlane_b32 s16, v56
    s_lshr_b32 s47, s2, 3
    s_lshl_b32 s22, s48, 5
    s_add_u32 s22, s22, s47
    s_and_b32 s49, s22, 15
    s_lshr_b32 s22, s22, 4
    s_lshl_b32 s22, s22, 17
    s_lshl_b32 s49, s49, 6
    s_add_u32 s22, s22, s49
    s_add_u32 s22, s22, 8388608
    s_mov_b32 s10, 12582912
    s_mov_b32 s11, 0x20000
    s_and_b32 s17, s16, 3
    s_movk_i32 s20, 20
    s_mov_b32 s24, 0
    s_cmp_ge_u32 s16, 8
    s_cbranch_scc1 gm_main
    v_lshrrev_b32 v56, 6, v0
    v_lshlrev_b32 v55, 1, v0
    v_and_b32 v55, 0x78, v55
    v_or_b32 v55, v55, v56
    v_cmp_gt_u32 vcc, 125, v55
    v_mul_u32_u24 v46, 5120, v55
    v_add_u32 v46, 7340032, v46
    v_bfrev_b32 v56, 2
    v_lshrrev_b32 v44, 2, v0
    v_lshlrev_b32 v44, 10, v44
    v_and_b32 v57, 3, v0
    v_lshl_or_b32 v44, v57, 4, v44
    v_cndmask_b32 v44, v56, v44, vcc
    v_and_b32 v51, 63, v0
    s_waitcnt lgkmcnt(0)
    s_mov_b32 s8, s54
    s_and_b32 s9, s55, 0xffff
    v_mov_b32 v24, 0
    s_lshr_b32 s18, s16, 2
    s_lshl_b32 s53, s17, 7
    s_add_u32 s4, s50, s53
    s_addc_u32 s5, s51, 0
    s_and_b32 s5, s5, 0xffff
    s_or_b32 s5, s5, 0x08000000
    s_movk_i32 s6, 10000
    s_mov_b32 s7, 0x20000
    s_sub_u32 s12, s4, 1024
    s_subb_u32 s13, s5, 0
    s_movk_i32 s14, 10000
    s_mov_b32 s15, 0x20000
    s_mul_i32 s40, s16, 15360
    s_add_u32 s40, s40, 40960
    v_lshl_add_u32 v87, v51, 3, s40
    s_add_u32 s40, s40, 9216
    s_add_u32 s41, s40, 1024
    s_add_u32 s42, s40, 2048
    s_add_u32 s43, s40, 3072
    s_add_u32 s44, s40, 4096
    s_add_u32 s45, s40, 5120
    v_and_b32 v55, 3, v0
    v_bfe_u32 v56, v0, 2, 2
    v_bfe_u32 v57, v0, 4, 1
    v_bfe_u32 v53, v0, 5, 1
    v_lshlrev_b32 v1, 3, v55
    v_lshl_add_u32 v1, v57, 5, v1
    v_lshl_add_u32 v1, v56, 6, v1
    v_lshl_add_u32 v1, v53, 8, v1
    v_add_u32 v1, s40, v1
    v_lshlrev_b32 v5, 4, v55
    v_lshl_add_u32 v5, v57, 6, v5
    v_lshl_add_u32 v5, v56, 9, v5
    v_mov_b32 v7, v5
    v_bfe_u32 v55, v0, 2, 1
    v_lshlrev_b32 v86, 4, v53
    v_lshl_or_b32 v86, v55, 18, v86
    v_mov_b32 v48, 1
    v_lshlrev_b32 v47, 2, v51
    v_bfe_u32 v2, v0, 5, 1
    v_bfe_u32 v3, v0, 3, 2
    v_and_b32 v35, 3, v0
    v_lshl_add_u32 v3, v3, 2, v35
    v_mul_u32_u24 v49, 20, v2
    v_lshrrev_b32 v18, 2, v51
    v_lshl_add_u32 v18, v35, 4, v18
    v_mov_b32 v50, 0x3fff
    s_lshl_b32 s37, s16, 2
    v_mov_b32 v59, s37
    s_sub_u32 s36, s16, 1
    v_mov_b64 v[88:89], 0
    v_mov_b64 v[90:91], 0
    v_mov_b64 v[92:93], 0
    v_mov_b64 v[94:95], 0
    v_mov_b64 v[96:97], 0
    v_mov_b64 v[98:99], 0
    v_mov_b64 v[100:101], 0
    v_mov_b64 v[102:103], 0
    v_mov_b64 v[104:105], 0
    v_mov_b64 v[106:107], 0
    v_mov_b64 v[108:109], 0
    v_mov_b64 v[110:111], 0
    v_mov_b64 v[112:113], 0
    v_mov_b64 v[114:115], 0
    v_mov_b64 v[116:117], 0
    v_mov_b64 v[118:119], 0
    v_mov_b64 v[120:121], 0
    v_mov_b64 v[122:123], 0
    v_mov_b64 v[124:125], 0
    v_mov_b64 v[126:127], 0
    v_mov_b64 v[128:129], 0
    v_mov_b64 v[130:131], 0
    v_mov_b64 v[132:133], 0
    v_mov_b64 v[134:135], 0
    v_mov_b64 v[136:137], 0
    v_mov_b64 v[138:139], 0
    v_mov_b64 v[140:141], 0
    v_mov_b64 v[142:143], 0
    v_mov_b64 v[144:145], 0
    v_mov_b64 v[146:147], 0
    v_mov_b64 v[148:149], 0
    v_mov_b64 v[150:151], 0
    v_mov_b64 v[152:153], 0
    v_mov_b64 v[154:155], 0
    v_mov_b64 v[156:157], 0
    v_mov_b64 v[158:159], 0
    v_mov_b64 v[160:161], 0
    v_mov_b64 v[162:163], 0
    v_mov_b64 v[164:165], 0
    v_mov_b64 v[166:167], 0
    v_bfe_u32 v8, v0, 2, 2
    v_bfe_u32 v10, v0, 5, 1
    v_lshlrev_b32 v9, 3, v8
    v_add_u32 v9, 156672, v9
    v_lshl_add_u32 v8, v10, 3, v8
    v_lshlrev_b32 v8, 9, v8
    v_bfe_u32 v10, v0, 4, 1
    v_lshl_add_u32 v8, v10, 5, v8
    v_lshl_add_u32 v8, v35, 3, v8
    v_lshl_add_u32 v8, s17, 7, v8
    v_add_u32 v8, 148480, v8
    ds_read_b64_tr_b16 v[76:77], v9
    ds_read_b64_tr_b16 v[78:79], v9 offset:32
    ds_read_b64_tr_b16 v[80:81], v9 offset:64
    ds_read_b64_tr_b16 v[82:83], v9 offset:96
    ds_read_b64_tr_b16 v[68:69], v8
    ds_read_b64_tr_b16 v[70:71], v8 offset:2048
    ds_read_b64_tr_b16 v[72:73], v8 offset:64
    ds_read_b64_tr_b16 v[74:75], v8 offset:2112
    s_cmp_ge_u32 s2, 125
    s_waitcnt vmcnt(0)
    s_cbranch_scc1 mn_noarr
    v_mov_b32 v55, 0
    v_mov_b32 v56, 1
    s_mov_b64 exec, 1
    ds_add_u32 v55, v56 offset:448
    s_mov_b64 exec, -1
mn_noarr:
    s_cmp_lg_u32 s16, 7
    s_cbranch_scc1 mn_sp1
    v_mov_b32 v57, 0
    ds_read_b32 v57, v57 offset:456
    s_waitcnt lgkmcnt(0)
    v_readfirstlane_b32 s59, v57
    s_and_b32 s62, s2, 15
    s_lshl_b32 s62, s62, 7
    s_add_u32 s62, s62, 11730944
    v_mov_b32 v55, s62
    v_lshlrev_b32 v56, 6, v0
    v_and_b32 v56, 0xc0, v56
    s_mov_b32 s63, 0x100000
mn_poll1m:
    s_sub_u32 s63, s63, 1
    s_cbranch_scc1 mn_poll1x
    global_load_dword v57, v55, s[54:55] sc1
    s_waitcnt vmcnt(0)
    v_readfirstlane_b32 s62, v57
    s_sub_u32 s62, s62, s59
    s_bfe_u32 s62, s62, 1048576
    s_cmp_eq_u32 s62, 2
    s_cbranch_scc1 mn_poll1x
    s_sleep 6
    s_and_b32 s62, s63, 63
    s_cbranch_scc1 mn_poll1m
    global_load_dword v57, v56, s[60:61] sc1
    s_waitcnt vmcnt(0)
    v_add_u32_dpp v57, v57, v57 quad_perm:[2,3,0,1] row_mask:0xf bank_mask:0xf
    s_nop 0
    v_readlane_b32 s62, v57, 0
    s_cmp_lt_u32 s62, 125
    s_cbranch_scc1 mn_poll1m
mn_poll1x:
    v_mov_b32 v55, 0
    ds_write_b32 v55, v48 offset:308
mn_sp1x:
    buffer_load_dwordx4 v[20:23], v44, s[8:11], s22 offen sc1
    s_mov_b32 s52, 0x100000
    s_waitcnt vmcnt(0)
    v_mov_b32_dpp v58, v23 quad_perm:[3,3,3,3] row_mask:0xf bank_mask:0xf
    v_cmp_le_u32 vcc, s52, v58
    s_cbranch_vccnz mn_w5
mn_count:
    v_cmpx_gt_i32 vcc, 0, v20
    s_cbranch_execz mn_cn_done
    v_lshrrev_b32 v25, 23, v20
    v_and_b32 v25, 0xfc, v25
    ds_add_rtn_u32 v30, v25, v48
    v_cmpx_gt_i32 vcc, 0, v21
    s_cbranch_execz mn_cn_done
    v_lshrrev_b32 v26, 23, v21
    v_and_b32 v26, 0xfc, v26
    ds_add_rtn_u32 v31, v26, v48
    v_cmpx_gt_i32 vcc, 0, v22
    s_cbranch_execz mn_cn_done
    v_lshrrev_b32 v27, 23, v22
    v_and_b32 v27, 0xfc, v27
    ds_add_rtn_u32 v32, v27, v48
    v_cmpx_gt_i32 vcc, 0, v23
    s_cbranch_execz mn_cn_done
    v_lshrrev_b32 v28, 23, v23
    v_and_b32 v28, 0xfc, v28
    ds_add_rtn_u32 v33, v28, v48
    v_cmpx_gt_i32 vcc, 0, v24
    s_cbranch_execz mn_cn_done
    v_lshrrev_b32 v29, 23, v24
    v_and_b32 v29, 0xfc, v29
    ds_add_rtn_u32 v34, v29, v48
mn_cn_done:
    s_mov_b64 exec, -1
    v_lshrrev_b32 v42, 16, v58
    v_subrev_u32 v42, s24, v42
    v_med3_i32 v42, v42, 0, s20
    v_mov_b32 v43, v42
    v_mov_b32 v52, 0
    s_lshl_b32 s52, s18, 5
    v_add_u32_dpp v43, v43, v43 row_shr:4 row_mask:0xf bank_mask:0xf
    s_add_u32 s53, s52, 31
    s_movk_i32 s48, 0x3fff
    v_add_u32_dpp v43, v43, v43 row_shr:8 row_mask:0xf bank_mask:0xf
    s_nop 0
    s_nop 0
    v_add_u32_dpp v43, v43, v43 row_bcast:15 row_mask:0xa bank_mask:0xf
    s_nop 0
    s_nop 0
    v_add_u32_dpp v43, v43, v43 row_bcast:31 row_mask:0xc bank_mask:0xf
    s_brev_b64 exec, 1
    ds_write_b32 v59, v43 offset:384
    s_mov_b64 exec, -1
    v_sub_u32 v41, v43, v42
    s_waitcnt lgkmcnt(0)
    s_barrier
    ds_read_b32 v55, v47 offset:384
    ds_read_b32 v53, v47 offset:0
    ds_read_b32 v52, v52 offset:272
    s_waitcnt lgkmcnt(2)
    v_add_u32_dpp v55, v55, v55 row_shr:1 row_mask:0xf bank_mask:0xf
    s_waitcnt lgkmcnt(1)
    v_mov_b32 v54, v53
    v_add_u32_dpp v55, v55, v55 row_shr:2 row_mask:0xf bank_mask:0xf
    v_sub_u32 v53, v49, v53
    v_add_u32 v41, v41, v35
    v_add_u32_dpp v55, v55, v55 row_shr:4 row_mask:0xf bank_mask:0xf
    s_cmp_eq_u32 s16, 0
    v_readlane_b32 s49, v55, s36
    v_readlane_b32 s23, v55, 7
    s_cmov_b32 s49, 0
    s_add_u32 s49, s49, 72
    v_add_u32_dpp v54, v54, v54 row_shr:1 row_mask:0xf bank_mask:0xf
    v_add_u32 v41, s49, v41
    v_lshlrev_b32 v41, 16, v41
    v_add_u32_dpp v54, v54, v54 row_shr:2 row_mask:0xf bank_mask:0xf
    v_and_or_b32 v36, v20, s48, v41
    v_add_u32 v41, 262144, v41
    v_add_u32_dpp v54, v54, v54 row_shr:4 row_mask:0xf bank_mask:0xf
    v_and_or_b32 v37, v21, s48, v41
    v_add_u32 v41, 262144, v41
    v_add_u32_dpp v54, v54, v54 row_shr:8 row_mask:0xf bank_mask:0xf
    v_and_or_b32 v38, v22, s48, v41
    v_add_u32 v41, 262144, v41
    v_add_u32_dpp v54, v54, v54 row_bcast:15 row_mask:0xa bank_mask:0xf
    v_and_or_b32 v39, v23, s48, v41
    v_add_u32 v41, 262144, v41
    v_add_u32_dpp v54, v54, v54 row_bcast:31 row_mask:0xc bank_mask:0xf
    v_add_u32 v53, v53, v54
    v_add_u32 v54, v54, v49
    ds_bpermute_b32 v25, v25, v53
    ds_bpermute_b32 v26, v26, v53
    ds_bpermute_b32 v27, v27, v53
    ds_bpermute_b32 v28, v28, v53
    ds_bpermute_b32 v29, v29, v53
    v_and_or_b32 v40, v24, s48, v41
    v_bfe_u32 v56, v20, 14, 5
    v_lshl_or_b32 v36, v56, 26, v36
    v_bfe_u32 v56, v21, 14, 5
    v_lshl_or_b32 v37, v56, 26, v37
    v_bfe_u32 v56, v22, 14, 5
    v_lshl_or_b32 v38, v56, 26, v38
    v_bfe_u32 v56, v23, 14, 5
    v_lshl_or_b32 v39, v56, 26, v39
    v_bfe_u32 v56, v24, 14, 5
    v_lshl_or_b32 v40, v56, 26, v40
    v_readlane_b32 s33, v54, s53
    v_readlane_b32 s32, v53, s52
    s_cmp_gt_u32 s23, 773
    s_cbranch_scc1 mn_ovf
    v_add_lshl_u32 v55, s33, v51, 2
    s_mov_b32 exec_lo, 1048575
    s_mov_b32 exec_hi, 0
    ds_write_b32 v55, v50 offset:512
    s_mov_b64 exec, -1
    v_add_lshl_u32 v2, s32, v2, 2
    v_add_lshl_u32 v3, s32, v3, 2
    v_add_lshl_u32 v18, s32, v18, 2
    s_waitcnt lgkmcnt(1)
    v_readfirstlane_b32 s21, v52
    v_cmpx_gt_i32 vcc, 0, v20
    s_cbranch_execz mn_w2_done
    v_add_lshl_u32 v25, v25, v30, 2
    ds_write_b32 v25, v36 offset:512
    v_cmpx_gt_i32 vcc, 0, v21
    s_cbranch_execz mn_w2_done
    v_add_lshl_u32 v26, v26, v31, 2
    ds_write_b32 v26, v37 offset:512
    v_cmpx_gt_i32 vcc, 0, v22
    s_cbranch_execz mn_w2_done
    v_add_lshl_u32 v27, v27, v32, 2
    ds_write_b32 v27, v38 offset:512
    v_cmpx_gt_i32 vcc, 0, v23
    s_cbranch_execz mn_w2_done
    v_add_lshl_u32 v28, v28, v33, 2
    ds_write_b32 v28, v39 offset:512
    v_cmpx_gt_i32 vcc, 0, v24
    s_cbranch_execz mn_w2_done
    v_add_lshl_u32 v29, v29, v34, 2
    ds_write_b32 v29, v40 offset:512
mn_w2_done:
    s_mov_b64 exec, -1
    s_mov_b32 m0, s40
    s_sub_u32 s32, s32, 3
    s_sub_u32 s57, s33, s32
    s_lshr_b32 s57, s57, 2
    s_waitcnt lgkmcnt(0)
    s_barrier
    ds_read_u16 v4, v2 offset:512
    ds_read_u16 v6, v2 offset:520
    ds_read_u16 v8, v18 offset:514
    ds_read_u16 v84, v3 offset:514
    ds_read_u16 v22, v2 offset:528
    ds_read_u16 v23, v2 offset:536
    ds_read_u16 v24, v2 offset:544
    ds_read_u16 v25, v2 offset:552
    ds_read_u16 v26, v2 offset:560
    ds_read_u16 v27, v2 offset:568
    s_sub_u32 s53, s53, 4
    v_readlane_b32 s84, v54, s53
    s_add_u32 s53, s53, 1
    v_readlane_b32 s85, v54, s53
    s_add_u32 s53, s53, 1
    v_readlane_b32 s86, v54, s53
    s_add_u32 s53, s53, 1
    v_readlane_b32 s87, v54, s53
    s_waitcnt lgkmcnt(8)
    buffer_load_dwordx4 v[4:5], s[4:7], 0 idxen offen lds
    s_mov_b32 m0, s41
    s_waitcnt lgkmcnt(6)
    buffer_load_dwordx4 v[6:7], s[4:7], 0 idxen offen lds
    v_lshrrev_b32 v11, 8, v8
    v_and_b32 v8, 0x3ff, v8
    v_mul_u32_u24 v8, 48, v8
    v_and_b32 v84, 0x3ff, v84
    v_mad_u32_u24 v84, v84, 48, v86
    v_xor_b32 v85, 0x40000, v84
    s_waitcnt lgkmcnt(0)
    s_mov_b32 m0, s42
    v_mov_b32 v4, v22
    buffer_load_dwordx4 v[4:5], s[4:7], 0 idxen offen lds
    s_mov_b32 m0, s43
    v_mov_b32 v4, v23
    buffer_load_dwordx4 v[4:5], s[4:7], 0 idxen offen lds
    s_mov_b32 m0, s44
    v_mov_b32 v4, v24
    buffer_load_dwordx4 v[4:5], s[4:7], 0 idxen offen lds
    s_mov_b32 m0, s45
    v_mov_b32 v4, v25
    buffer_load_dwordx4 v[4:5], s[4:7], 0 idxen offen lds
    s_sub_u32 s84, s84, s32
    s_lshr_b32 s84, s84, 2
    s_sub_u32 s85, s85, s32
    s_lshr_b32 s85, s85, 2
    s_sub_u32 s86, s86, s32
    s_lshr_b32 s86, s86, 2
    s_sub_u32 s87, s87, s32
    s_lshr_b32 s87, s87, 2
    s_sub_u32 s88, s57, s87
    s_sub_u32 s87, s87, s86
    s_sub_u32 s86, s86, s85
    s_sub_u32 s85, s85, s84
    s_cmp_lg_u32 s21, 0
    s_cselect_b32 s19, s57, s84
    s_mov_b32 s58, 0
    s_mov_b32 s35, 0
    s_sub_i32 s34, s57, 4
    s_max_i32 s34, s34, 0
    v_min_u32 v0, 1, v51
    v_lshlrev_b32 v0, 18, v0
    v_lshl_add_u32 v0, s17, 2, v0
    s_lshl_b32 s52, s18, 1
    s_sub_i32 s52, 1, s52
    s_mul_i32 s53, s52, s57
    s_add_i32 s53, s53, 0
    v_mov_b32 v19, s53
    ds_add_u32 v0, v19 offset:288
    s_mul_i32 s30, s52, -4
    s_lshl_b32 s26, s18, 31
    s_setprio 2
    v_and_b32 v11, 0x7c, v11
    v_or_b32 v11, 0xc000, v11
    v_lshlrev_b32 v10, 16, v11
    s_nop 1
    v_or_b32_dpp v19, v10, v11 row_shl:4 row_mask:0xf bank_mask:0xf bound_ctrl:0
    s_barrier
    ds_read_b64 v[8:9], v8 offset:352
    ds_read_b128 v[60:63], v84 offset:320
    ds_read_b128 v[64:67], v85 offset:320
    v_mov_b32 v4, v26
    v_mov_b32 v6, v27
    s_waitcnt lgkmcnt(2)
    v_mfma_f32_4x4x4_16b_bf16 v[28:31], v[8:9], v[76:77], 0
    v_mfma_f32_4x4x4_16b_bf16 v[32:35], v[8:9], v[78:79], 0
    v_mfma_f32_4x4x4_16b_bf16 v[36:39], v[8:9], v[80:81], 0
    v_mfma_f32_4x4x4_16b_bf16 v[40:43], v[8:9], v[82:83], 0
    s_waitcnt lgkmcnt(0)
    v_mfma_f32_32x32x16_bf16 v[44:59], v[60:63], v[68:71], 0
    v_mfma_f32_32x32x16_bf16 v[44:59], v[64:67], v[72:75], v[44:59]
    s_waitcnt vmcnt(4)
    ds_read_b64_tr_b16 v[20:21], v1 offset:0
    ds_read_b64_tr_b16 v[22:23], v1 offset:512
    ds_read_b64_tr_b16 v[24:25], v1 offset:1024
    ds_read_b64_tr_b16 v[26:27], v1 offset:1536
    v_cvt_pk_bf16_f32 v12, v28, v32
    v_cvt_pk_bf16_f32 v14, v29, v33
    v_cvt_pk_bf16_f32 v16, v30, v34
    v_cvt_pk_bf16_f32 v13, v36, v40
    v_cvt_pk_bf16_f32 v15, v37, v41
    v_cvt_pk_bf16_f32 v17, v38, v42
    s_set_gpr_idx_on s40, gpr_idx(SRC2,DST)
    s_mov_b32 m0, s40
    s_waitcnt lgkmcnt(2)
    buffer_load_dwordx4 v[4:5], s[4:7], 0 idxen offen lds
    s_mov_b32 m0, s41
    s_waitcnt lgkmcnt(0)
    buffer_load_dwordx4 v[6:7], s[4:7], 0 idxen offen lds
    s_sub_u32 s19, s19, 1
    s_cbranch_scc1 mn_st12
mn_st12_back:
mn_loop:
    v_mfma_f32_4x4x4_16b_bf16 v[28:31], v[12:13], v[20:21], 0 cbsz:4 abid:0
    v_mfma_f32_4x4x4_16b_bf16 v[32:35], v[12:13], v[22:23], 0 cbsz:4 abid:1
    v_mfma_f32_4x4x4_16b_bf16 v[36:39], v[12:13], v[24:25], 0 cbsz:4 abid:2
    v_mfma_f32_4x4x4_16b_bf16 v[40:43], v[12:13], v[26:27], 0 cbsz:4 abid:3
    ds_read_u16 v4, v2 offset:576
    ds_read_u16 v6, v2 offset:584
    v_readlane_b32 s28, v19, 0
    v_readlane_b32 s29, v19, 8
    s_waitcnt vmcnt(4)
    ds_read_b64_tr_b16 v[20:21], v1 offset:2048
    ds_read_b64_tr_b16 v[22:23], v1 offset:2560
    ds_read_b64_tr_b16 v[24:25], v1 offset:3072
    ds_read_b64_tr_b16 v[26:27], v1 offset:3584
    s_sub_u32 s34, s34, 1
    s_cmov_b32 s35, 0x30000
    s_mov_b32 m0, s28
    v_fmac_f32 v88, v28, v44
    v_fmac_f32 v89, v29, v44
    v_fmac_f32 v90, v30, v44
    v_fmac_f32 v91, v31, v44
    s_lshr_b32 m0, s28, 16
    v_fmac_f32 v88, v32, v45
    v_fmac_f32 v89, v33, v45
    v_fmac_f32 v90, v34, v45
    v_fmac_f32 v91, v35, v45
    s_mov_b32 m0, s29
    v_fmac_f32 v88, v36, v46
    v_fmac_f32 v89, v37, v46
    v_fmac_f32 v90, v38, v46
    v_fmac_f32 v91, v39, v46
    s_lshr_b32 m0, s29, 16
    v_fmac_f32 v88, v40, v47
    v_fmac_f32 v89, v41, v47
    v_fmac_f32 v90, v42, v47
    v_fmac_f32 v91, v43, v47
    s_or_b32 m0, s42, s35
    s_waitcnt lgkmcnt(0)
    buffer_load_dwordx4 v[4:5], s[4:7], 0 idxen offen lds
    buffer_load_dwordx4 v[6:7], s[12:15], 0 idxen offen offset:1024 lds
    s_sub_u32 s19, s19, 1
    s_cbranch_scc1 mn_st0
mn_st0_back:
    v_mfma_f32_4x4x4_16b_bf16 v[28:31], v[12:13], v[20:21], 0 cbsz:4 abid:4
    v_mfma_f32_4x4x4_16b_bf16 v[32:35], v[12:13], v[22:23], 0 cbsz:4 abid:5
    v_mfma_f32_4x4x4_16b_bf16 v[36:39], v[12:13], v[24:25], 0 cbsz:4 abid:6
    v_mfma_f32_4x4x4_16b_bf16 v[40:43], v[12:13], v[26:27], 0 cbsz:4 abid:7
    ds_read_u16 v4, v2 offset:592
    ds_read_u16 v6, v2 offset:600
    v_readlane_b32 s28, v19, 16
    v_readlane_b32 s29, v19, 24
    ds_read_u16 v84, v3 offset:578
    s_waitcnt vmcnt(4)
    ds_read_b64_tr_b16 v[20:21], v1 offset:4096
    ds_read_b64_tr_b16 v[22:23], v1 offset:4608
    ds_read_b64_tr_b16 v[24:25], v1 offset:5120
    ds_read_b64_tr_b16 v[26:27], v1 offset:5632
    s_sub_u32 s34, s34, 1
    s_cmov_b32 s35, 0x30000
    s_mov_b32 m0, s28
    v_fmac_f32 v88, v28, v48
    v_fmac_f32 v89, v29, v48
    v_fmac_f32 v90, v30, v48
    v_fmac_f32 v91, v31, v48
    s_lshr_b32 m0, s28, 16
    v_fmac_f32 v88, v32, v49
    v_fmac_f32 v89, v33, v49
    v_fmac_f32 v90, v34, v49
    v_fmac_f32 v91, v35, v49
    s_mov_b32 m0, s29
    v_fmac_f32 v88, v36, v50
    v_fmac_f32 v89, v37, v50
    v_fmac_f32 v90, v38, v50
    v_fmac_f32 v91, v39, v50
    s_lshr_b32 m0, s29, 16
    v_fmac_f32 v88, v40, v51
    v_fmac_f32 v89, v41, v51
    v_fmac_f32 v90, v42, v51
    v_fmac_f32 v91, v43, v51
    s_or_b32 m0, s44, s35
    s_waitcnt lgkmcnt(0)
    buffer_load_dwordx4 v[4:5], s[4:7], 0 idxen offen lds
    buffer_load_dwordx4 v[6:7], s[12:15], 0 idxen offen offset:1024 lds
    s_sub_u32 s19, s19, 1
    s_cbranch_scc1 mn_st1
mn_st1_back:
    v_mfma_f32_4x4x4_16b_bf16 v[28:31], v[12:13], v[20:21], 0 cbsz:4 abid:8
    v_mfma_f32_4x4x4_16b_bf16 v[32:35], v[12:13], v[22:23], 0 cbsz:4 abid:9
    v_mfma_f32_4x4x4_16b_bf16 v[36:39], v[12:13], v[24:25], 0 cbsz:4 abid:10
    v_mfma_f32_4x4x4_16b_bf16 v[40:43], v[12:13], v[26:27], 0 cbsz:4 abid:11
    ds_read_u16 v4, v2 offset:608
    ds_read_u16 v6, v2 offset:616
    v_readlane_b32 s28, v19, 32
    v_readlane_b32 s29, v19, 40
    v_and_b32 v84, 0x3ff, v84
    v_mad_u32_u24 v84, v84, 48, v86
    v_xor_b32 v85, 0x40000, v84
    ds_read_b128 v[60:63], v84 offset:320
    ds_read_b128 v[64:67], v85 offset:320
    s_waitcnt vmcnt(4)
    ds_read_b64_tr_b16 v[20:21], v1 offset:0
    ds_read_b64_tr_b16 v[22:23], v1 offset:512
    ds_read_b64_tr_b16 v[24:25], v1 offset:1024
    ds_read_b64_tr_b16 v[26:27], v1 offset:1536
    s_sub_u32 s34, s34, 1
    s_cmov_b32 s35, 0x30000
    s_mov_b32 m0, s28
    v_fmac_f32 v88, v28, v52
    v_fmac_f32 v89, v29, v52
    v_fmac_f32 v90, v30, v52
    v_fmac_f32 v91, v31, v52
    s_lshr_b32 m0, s28, 16
    v_fmac_f32 v88, v32, v53
    v_fmac_f32 v89, v33, v53
    v_fmac_f32 v90, v34, v53
    v_fmac_f32 v91, v35, v53
    s_mov_b32 m0, s29
    v_fmac_f32 v88, v36, v54
    v_fmac_f32 v89, v37, v54
    v_fmac_f32 v90, v38, v54
    v_fmac_f32 v91, v39, v54
    s_lshr_b32 m0, s29, 16
    v_fmac_f32 v88, v40, v55
    v_fmac_f32 v89, v41, v55
    v_fmac_f32 v90, v42, v55
    v_fmac_f32 v91, v43, v55
    s_or_b32 m0, s40, s35
    s_waitcnt lgkmcnt(0)
    buffer_load_dwordx4 v[4:5], s[4:7], 0 idxen offen lds
    buffer_load_dwordx4 v[6:7], s[12:15], 0 idxen offen offset:1024 lds
    s_sub_u32 s19, s19, 1
    s_cbranch_scc1 mn_st2
mn_st2_back:
    v_mfma_f32_4x4x4_16b_bf16 v[28:31], v[12:13], v[20:21], 0 cbsz:4 abid:12
    v_mfma_f32_4x4x4_16b_bf16 v[32:35], v[12:13], v[22:23], 0 cbsz:4 abid:13
    v_mfma_f32_4x4x4_16b_bf16 v[36:39], v[12:13], v[24:25], 0 cbsz:4 abid:14
    v_mfma_f32_4x4x4_16b_bf16 v[40:43], v[12:13], v[26:27], 0 cbsz:4 abid:15
    ds_read_u16 v4, v2 offset:624
    ds_read_u16 v6, v2 offset:632
    v_readlane_b32 s28, v19, 48
    v_readlane_b32 s29, v19, 56
    v_mov_b32 v85, s30
    ds_add_rtn_u32 v85, v0, v85 offset:288
    s_waitcnt vmcnt(4)
    ds_read_b64_tr_b16 v[20:21], v1 offset:2048
    ds_read_b64_tr_b16 v[22:23], v1 offset:2560
    ds_read_b64_tr_b16 v[24:25], v1 offset:3072
    ds_read_b64_tr_b16 v[26:27], v1 offset:3584
    s_sub_u32 s34, s34, 1
    s_cmov_b32 s35, 0x30000
    s_mov_b32 m0, s28
    v_fmac_f32 v88, v28, v56
    v_fmac_f32 v89, v29, v56
    v_fmac_f32 v90, v30, v56
    v_fmac_f32 v91, v31, v56
    s_lshr_b32 m0, s28, 16
    v_fmac_f32 v88, v32, v57
    v_fmac_f32 v89, v33, v57
    v_fmac_f32 v90, v34, v57
    v_fmac_f32 v91, v35, v57
    s_mov_b32 m0, s29
    v_fmac_f32 v88, v36, v58
    v_fmac_f32 v89, v37, v58
    v_fmac_f32 v90, v38, v58
    v_fmac_f32 v91, v39, v58
    s_lshr_b32 m0, s29, 16
    v_fmac_f32 v88, v40, v59
    v_fmac_f32 v89, v41, v59
    v_fmac_f32 v90, v42, v59
    v_fmac_f32 v91, v43, v59
    s_or_b32 m0, s42, s35
    v_mfma_f32_32x32x16_bf16 v[44:59], v[60:63], v[68:71], 0
    v_mfma_f32_32x32x16_bf16 v[44:59], v[64:67], v[72:75], v[44:59]
    s_waitcnt lgkmcnt(0)
    buffer_load_dwordx4 v[4:5], s[4:7], 0 idxen offen lds
    buffer_load_dwordx4 v[6:7], s[12:15], 0 idxen offen offset:1024 lds
    v_readfirstlane_b32 s27, v85
    s_setprio 2
    s_xor_b32 s27, s27, s26
    s_cmp_ge_i32 s27, 0
    s_cbranch_scc1 mn_pr3
    s_setprio 1
mn_pr3:
    s_sub_u32 s19, s19, 1
    s_cbranch_scc1 mn_st3
mn_st3_back:
    v_mfma_f32_4x4x4_16b_bf16 v[28:31], v[14:15], v[20:21], 0 cbsz:4 abid:0
    v_mfma_f32_4x4x4_16b_bf16 v[32:35], v[14:15], v[22:23], 0 cbsz:4 abid:1
    v_mfma_f32_4x4x4_16b_bf16 v[36:39], v[14:15], v[24:25], 0 cbsz:4 abid:2
    v_mfma_f32_4x4x4_16b_bf16 v[40:43], v[14:15], v[26:27], 0 cbsz:4 abid:3
    ds_read_u16 v4, v2 offset:640
    ds_read_u16 v6, v2 offset:648
    v_readlane_b32 s28, v19, 1
    v_readlane_b32 s29, v19, 9
    s_waitcnt vmcnt(4)
    ds_read_b64_tr_b16 v[20:21], v1 offset:4096
    ds_read_b64_tr_b16 v[22:23], v1 offset:4608
    ds_read_b64_tr_b16 v[24:25], v1 offset:5120
    ds_read_b64_tr_b16 v[26:27], v1 offset:5632
    s_sub_u32 s34, s34, 1
    s_cmov_b32 s35, 0x30000
    s_mov_b32 m0, s28
    v_fmac_f32 v88, v28, v44
    v_fmac_f32 v89, v29, v44
    v_fmac_f32 v90, v30, v44
    v_fmac_f32 v91, v31, v44
    s_lshr_b32 m0, s28, 16
    v_fmac_f32 v88, v32, v45
    v_fmac_f32 v89, v33, v45
    v_fmac_f32 v90, v34, v45
    v_fmac_f32 v91, v35, v45
    s_mov_b32 m0, s29
    v_fmac_f32 v88, v36, v46
    v_fmac_f32 v89, v37, v46
    v_fmac_f32 v90, v38, v46
    v_fmac_f32 v91, v39, v46
    s_lshr_b32 m0, s29, 16
    v_fmac_f32 v88, v40, v47
    v_fmac_f32 v89, v41, v47
    v_fmac_f32 v90, v42, v47
    v_fmac_f32 v91, v43, v47
    s_or_b32 m0, s44, s35
    s_waitcnt lgkmcnt(0)
    buffer_load_dwordx4 v[4:5], s[4:7], 0 idxen offen lds
    buffer_load_dwordx4 v[6:7], s[12:15], 0 idxen offen offset:1024 lds
    s_sub_u32 s19, s19, 1
    s_cbranch_scc1 mn_st4
mn_st4_back:
    v_mfma_f32_4x4x4_16b_bf16 v[28:31], v[14:15], v[20:21], 0 cbsz:4 abid:4
    v_mfma_f32_4x4x4_16b_bf16 v[32:35], v[14:15], v[22:23], 0 cbsz:4 abid:5
    v_mfma_f32_4x4x4_16b_bf16 v[36:39], v[14:15], v[24:25], 0 cbsz:4 abid:6
    v_mfma_f32_4x4x4_16b_bf16 v[40:43], v[14:15], v[26:27], 0 cbsz:4 abid:7
    ds_read_u16 v4, v2 offset:656
    ds_read_u16 v6, v2 offset:664
    v_readlane_b32 s28, v19, 17
    v_readlane_b32 s29, v19, 25
    ds_read_u16 v84, v3 offset:642
    s_waitcnt vmcnt(4)
    ds_read_b64_tr_b16 v[20:21], v1 offset:0
    ds_read_b64_tr_b16 v[22:23], v1 offset:512
    ds_read_b64_tr_b16 v[24:25], v1 offset:1024
    ds_read_b64_tr_b16 v[26:27], v1 offset:1536
    s_sub_u32 s34, s34, 1
    s_cmov_b32 s35, 0x30000
    s_mov_b32 m0, s28
    v_fmac_f32 v88, v28, v48
    v_fmac_f32 v89, v29, v48
    v_fmac_f32 v90, v30, v48
    v_fmac_f32 v91, v31, v48
    s_lshr_b32 m0, s28, 16
    v_fmac_f32 v88, v32, v49
    v_fmac_f32 v89, v33, v49
    v_fmac_f32 v90, v34, v49
    v_fmac_f32 v91, v35, v49
    s_mov_b32 m0, s29
    v_fmac_f32 v88, v36, v50
    v_fmac_f32 v89, v37, v50
    v_fmac_f32 v90, v38, v50
    v_fmac_f32 v91, v39, v50
    s_lshr_b32 m0, s29, 16
    v_fmac_f32 v88, v40, v51
    v_fmac_f32 v89, v41, v51
    v_fmac_f32 v90, v42, v51
    v_fmac_f32 v91, v43, v51
    s_or_b32 m0, s40, s35
    s_waitcnt lgkmcnt(0)
    buffer_load_dwordx4 v[4:5], s[4:7], 0 idxen offen lds
    buffer_load_dwordx4 v[6:7], s[12:15], 0 idxen offen offset:1024 lds
    s_sub_u32 s19, s19, 1
    s_cbranch_scc1 mn_st5
mn_st5_back:
    v_mfma_f32_4x4x4_16b_bf16 v[28:31], v[14:15], v[20:21], 0 cbsz:4 abid:8
    v_mfma_f32_4x4x4_16b_bf16 v[32:35], v[14:15], v[22:23], 0 cbsz:4 abid:9
    v_mfma_f32_4x4x4_16b_bf16 v[36:39], v[14:15], v[24:25], 0 cbsz:4 abid:10
    v_mfma_f32_4x4x4_16b_bf16 v[40:43], v[14:15], v[26:27], 0 cbsz:4 abid:11
    ds_read_u16 v4, v2 offset:672
    ds_read_u16 v6, v2 offset:680
    v_readlane_b32 s28, v19, 33
    v_readlane_b32 s29, v19, 41
    v_and_b32 v84, 0x3ff, v84
    v_mad_u32_u24 v84, v84, 48, v86
    v_xor_b32 v85, 0x40000, v84
    ds_read_b128 v[60:63], v84 offset:320
    ds_read_b128 v[64:67], v85 offset:320
    s_waitcnt vmcnt(4)
    ds_read_b64_tr_b16 v[20:21], v1 offset:2048
    ds_read_b64_tr_b16 v[22:23], v1 offset:2560
    ds_read_b64_tr_b16 v[24:25], v1 offset:3072
    ds_read_b64_tr_b16 v[26:27], v1 offset:3584
    s_sub_u32 s34, s34, 1
    s_cmov_b32 s35, 0x30000
    s_mov_b32 m0, s28
    v_fmac_f32 v88, v28, v52
    v_fmac_f32 v89, v29, v52
    v_fmac_f32 v90, v30, v52
    v_fmac_f32 v91, v31, v52
    s_lshr_b32 m0, s28, 16
    v_fmac_f32 v88, v32, v53
    v_fmac_f32 v89, v33, v53
    v_fmac_f32 v90, v34, v53
    v_fmac_f32 v91, v35, v53
    s_mov_b32 m0, s29
    v_fmac_f32 v88, v36, v54
    v_fmac_f32 v89, v37, v54
    v_fmac_f32 v90, v38, v54
    v_fmac_f32 v91, v39, v54
    s_lshr_b32 m0, s29, 16
    v_fmac_f32 v88, v40, v55
    v_fmac_f32 v89, v41, v55
    v_fmac_f32 v90, v42, v55
    v_fmac_f32 v91, v43, v55
    s_or_b32 m0, s42, s35
    s_waitcnt lgkmcnt(0)
    buffer_load_dwordx4 v[4:5], s[4:7], 0 idxen offen lds
    buffer_load_dwordx4 v[6:7], s[12:15], 0 idxen offen offset:1024 lds
    s_sub_u32 s19, s19, 1
    s_cbranch_scc1 mn_st6
mn_st6_back:
    v_mfma_f32_4x4x4_16b_bf16 v[28:31], v[14:15], v[20:21], 0 cbsz:4 abid:12
    v_mfma_f32_4x4x4_16b_bf16 v[32:35], v[14:15], v[22:23], 0 cbsz:4 abid:13
    v_mfma_f32_4x4x4_16b_bf16 v[36:39], v[14:15], v[24:25], 0 cbsz:4 abid:14
    v_mfma_f32_4x4x4_16b_bf16 v[40:43], v[14:15], v[26:27], 0 cbsz:4 abid:15
    ds_read_u16 v4, v2 offset:688
    ds_read_u16 v6, v2 offset:696
    v_readlane_b32 s28, v19, 49
    v_readlane_b32 s29, v19, 57
    v_mov_b32 v85, s30
    ds_add_rtn_u32 v85, v0, v85 offset:288
    s_waitcnt vmcnt(4)
    ds_read_b64_tr_b16 v[20:21], v1 offset:4096
    ds_read_b64_tr_b16 v[22:23], v1 offset:4608
    ds_read_b64_tr_b16 v[24:25], v1 offset:5120
    ds_read_b64_tr_b16 v[26:27], v1 offset:5632
    s_sub_u32 s34, s34, 1
    s_cmov_b32 s35, 0x30000
    s_mov_b32 m0, s28
    v_fmac_f32 v88, v28, v56
    v_fmac_f32 v89, v29, v56
    v_fmac_f32 v90, v30, v56
    v_fmac_f32 v91, v31, v56
    s_lshr_b32 m0, s28, 16
    v_fmac_f32 v88, v32, v57
    v_fmac_f32 v89, v33, v57
    v_fmac_f32 v90, v34, v57
    v_fmac_f32 v91, v35, v57
    s_mov_b32 m0, s29
    v_fmac_f32 v88, v36, v58
    v_fmac_f32 v89, v37, v58
    v_fmac_f32 v90, v38, v58
    v_fmac_f32 v91, v39, v58
    s_lshr_b32 m0, s29, 16
    v_fmac_f32 v88, v40, v59
    v_fmac_f32 v89, v41, v59
    v_fmac_f32 v90, v42, v59
    v_fmac_f32 v91, v43, v59
    s_or_b32 m0, s44, s35
    v_mfma_f32_32x32x16_bf16 v[44:59], v[60:63], v[68:71], 0
    v_mfma_f32_32x32x16_bf16 v[44:59], v[64:67], v[72:75], v[44:59]
    s_waitcnt lgkmcnt(0)
    buffer_load_dwordx4 v[4:5], s[4:7], 0 idxen offen lds
    buffer_load_dwordx4 v[6:7], s[12:15], 0 idxen offen offset:1024 lds
    v_readfirstlane_b32 s27, v85
    s_setprio 2
    s_xor_b32 s27, s27, s26
    s_cmp_ge_i32 s27, 0
    s_cbranch_scc1 mn_pr7
    s_setprio 1
mn_pr7:
    s_sub_u32 s19, s19, 1
    s_cbranch_scc1 mn_st7
mn_st7_back:
    v_mfma_f32_4x4x4_16b_bf16 v[28:31], v[16:17], v[20:21], 0 cbsz:4 abid:0
    v_mfma_f32_4x4x4_16b_bf16 v[32:35], v[16:17], v[22:23], 0 cbsz:4 abid:1
    v_mfma_f32_4x4x4_16b_bf16 v[36:39], v[16:17], v[24:25], 0 cbsz:4 abid:2
    v_mfma_f32_4x4x4_16b_bf16 v[40:43], v[16:17], v[26:27], 0 cbsz:4 abid:3
    ds_read_u16 v4, v2 offset:704
    ds_read_u16 v6, v2 offset:712
    v_readlane_b32 s28, v19, 2
    v_readlane_b32 s29, v19, 10
    ds_read_u16 v8, v18 offset:706
    s_waitcnt vmcnt(4)
    ds_read_b64_tr_b16 v[20:21], v1 offset:0
    ds_read_b64_tr_b16 v[22:23], v1 offset:512
    ds_read_b64_tr_b16 v[24:25], v1 offset:1024
    ds_read_b64_tr_b16 v[26:27], v1 offset:1536
    s_sub_u32 s34, s34, 1
    s_cmov_b32 s35, 0x30000
    s_mov_b32 m0, s28
    v_fmac_f32 v88, v28, v44
    v_fmac_f32 v89, v29, v44
    v_fmac_f32 v90, v30, v44
    v_fmac_f32 v91, v31, v44
    s_lshr_b32 m0, s28, 16
    v_fmac_f32 v88, v32, v45
    v_fmac_f32 v89, v33, v45
    v_fmac_f32 v90, v34, v45
    v_fmac_f32 v91, v35, v45
    s_mov_b32 m0, s29
    v_fmac_f32 v88, v36, v46
    v_fmac_f32 v89, v37, v46
    v_fmac_f32 v90, v38, v46
    v_fmac_f32 v91, v39, v46
    s_lshr_b32 m0, s29, 16
    v_fmac_f32 v88, v40, v47
    v_fmac_f32 v89, v41, v47
    v_fmac_f32 v90, v42, v47
    v_fmac_f32 v91, v43, v47
    s_or_b32 m0, s40, s35
    s_waitcnt lgkmcnt(0)
    buffer_load_dwordx4 v[4:5], s[4:7], 0 idxen offen lds
    buffer_load_dwordx4 v[6:7], s[12:15], 0 idxen offen offset:1024 lds
    s_sub_u32 s19, s19, 1
    s_cbranch_scc1 mn_st8
mn_st8_back:
    v_mfma_f32_4x4x4_16b_bf16 v[28:31], v[16:17], v[20:21], 0 cbsz:4 abid:4
    v_mfma_f32_4x4x4_16b_bf16 v[32:35], v[16:17], v[22:23], 0 cbsz:4 abid:5
    v_mfma_f32_4x4x4_16b_bf16 v[36:39], v[16:17], v[24:25], 0 cbsz:4 abid:6
    v_mfma_f32_4x4x4_16b_bf16 v[40:43], v[16:17], v[26:27], 0 cbsz:4 abid:7
    ds_read_u16 v4, v2 offset:720
    ds_read_u16 v6, v2 offset:728
    v_readlane_b32 s28, v19, 18
    v_readlane_b32 s29, v19, 26
    ds_read_u16 v84, v3 offset:706
    v_lshrrev_b32 v11, 8, v8
    v_and_b32 v8, 0x3ff, v8
    v_mul_u32_u24 v8, 48, v8
    ds_read_b64 v[8:9], v8 offset:352
    s_waitcnt vmcnt(4)
    ds_read_b64_tr_b16 v[20:21], v1 offset:2048
    ds_read_b64_tr_b16 v[22:23], v1 offset:2560
    ds_read_b64_tr_b16 v[24:25], v1 offset:3072
    ds_read_b64_tr_b16 v[26:27], v1 offset:3584
    s_sub_u32 s34, s34, 1
    s_cmov_b32 s35, 0x30000
    s_mov_b32 m0, s28
    v_fmac_f32 v88, v28, v48
    v_fmac_f32 v89, v29, v48
    v_fmac_f32 v90, v30, v48
    v_fmac_f32 v91, v31, v48
    s_lshr_b32 m0, s28, 16
    v_fmac_f32 v88, v32, v49
    v_fmac_f32 v89, v33, v49
    v_fmac_f32 v90, v34, v49
    v_fmac_f32 v91, v35, v49
    s_mov_b32 m0, s29
    v_fmac_f32 v88, v36, v50
    v_fmac_f32 v89, v37, v50
    v_fmac_f32 v90, v38, v50
    v_fmac_f32 v91, v39, v50
    s_lshr_b32 m0, s29, 16
    v_fmac_f32 v88, v40, v51
    v_fmac_f32 v89, v41, v51
    v_fmac_f32 v90, v42, v51
    v_fmac_f32 v91, v43, v51
    s_or_b32 m0, s42, s35
    s_waitcnt lgkmcnt(0)
    buffer_load_dwordx4 v[4:5], s[4:7], 0 idxen offen lds
    buffer_load_dwordx4 v[6:7], s[12:15], 0 idxen offen offset:1024 lds
    s_sub_u32 s19, s19, 1
    s_cbranch_scc1 mn_st9
mn_st9_back:
    v_mfma_f32_4x4x4_16b_bf16 v[28:31], v[16:17], v[20:21], 0 cbsz:4 abid:8
    v_mfma_f32_4x4x4_16b_bf16 v[32:35], v[16:17], v[22:23], 0 cbsz:4 abid:9
    v_mfma_f32_4x4x4_16b_bf16 v[36:39], v[16:17], v[24:25], 0 cbsz:4 abid:10
    v_mfma_f32_4x4x4_16b_bf16 v[40:43], v[16:17], v[26:27], 0 cbsz:4 abid:11
    ds_read_u16 v4, v2 offset:736
    ds_read_u16 v6, v2 offset:744
    v_readlane_b32 s28, v19, 34
    v_readlane_b32 s29, v19, 42
    v_and_b32 v84, 0x3ff, v84
    v_mad_u32_u24 v84, v84, 48, v86
    v_xor_b32 v85, 0x40000, v84
    ds_read_b128 v[60:63], v84 offset:320
    ds_read_b128 v[64:67], v85 offset:320
    s_waitcnt vmcnt(4)
    ds_read_b64_tr_b16 v[20:21], v1 offset:4096
    ds_read_b64_tr_b16 v[22:23], v1 offset:4608
    ds_read_b64_tr_b16 v[24:25], v1 offset:5120
    ds_read_b64_tr_b16 v[26:27], v1 offset:5632
    s_sub_u32 s34, s34, 1
    s_cmov_b32 s35, 0x30000
    s_mov_b32 m0, s28
    v_fmac_f32 v88, v28, v52
    v_fmac_f32 v89, v29, v52
    v_fmac_f32 v90, v30, v52
    v_fmac_f32 v91, v31, v52
    s_lshr_b32 m0, s28, 16
    v_fmac_f32 v88, v32, v53
    v_fmac_f32 v89, v33, v53
    v_fmac_f32 v90, v34, v53
    v_fmac_f32 v91, v35, v53
    s_mov_b32 m0, s29
    v_fmac_f32 v88, v36, v54
    v_fmac_f32 v89, v37, v54
    v_fmac_f32 v90, v38, v54
    v_fmac_f32 v91, v39, v54
    s_lshr_b32 m0, s29, 16
    v_fmac_f32 v88, v40, v55
    v_fmac_f32 v89, v41, v55
    v_fmac_f32 v90, v42, v55
    v_fmac_f32 v91, v43, v55
    s_or_b32 m0, s44, s35
    s_waitcnt lgkmcnt(0)
    buffer_load_dwordx4 v[4:5], s[4:7], 0 idxen offen lds
    buffer_load_dwordx4 v[6:7], s[12:15], 0 idxen offen offset:1024 lds
    v_and_b32 v11, 0x7c, v11
    v_or_b32 v11, 0xc000, v11
    v_lshlrev_b32 v10, 16, v11
    s_sub_u32 s19, s19, 1
    s_cbranch_scc1 mn_st10
mn_st10_back:
    v_mfma_f32_4x4x4_16b_bf16 v[28:31], v[16:17], v[20:21], 0 cbsz:4 abid:12
    v_mfma_f32_4x4x4_16b_bf16 v[32:35], v[16:17], v[22:23], 0 cbsz:4 abid:13
    v_mfma_f32_4x4x4_16b_bf16 v[36:39], v[16:17], v[24:25], 0 cbsz:4 abid:14
    v_mfma_f32_4x4x4_16b_bf16 v[40:43], v[16:17], v[26:27], 0 cbsz:4 abid:15
    ds_read_u16 v4, v2 offset:752
    ds_read_u16 v6, v2 offset:760
    v_readlane_b32 s28, v19, 50
    v_readlane_b32 s29, v19, 58
    v_mov_b32 v85, s30
    ds_add_rtn_u32 v85, v0, v85 offset:288
    s_waitcnt vmcnt(4)
    ds_read_b64_tr_b16 v[20:21], v1 offset:0
    ds_read_b64_tr_b16 v[22:23], v1 offset:512
    ds_read_b64_tr_b16 v[24:25], v1 offset:1024
    ds_read_b64_tr_b16 v[26:27], v1 offset:1536
    s_sub_u32 s34, s34, 1
    s_cmov_b32 s35, 0x30000
    s_mov_b32 m0, s28
    v_fmac_f32 v88, v28, v56
    v_fmac_f32 v89, v29, v56
    v_fmac_f32 v90, v30, v56
    v_fmac_f32 v91, v31, v56
    s_lshr_b32 m0, s28, 16
    v_fmac_f32 v88, v32, v57
    v_fmac_f32 v89, v33, v57
    v_fmac_f32 v90, v34, v57
    v_fmac_f32 v91, v35, v57
    s_mov_b32 m0, s29
    v_fmac_f32 v88, v36, v58
    v_fmac_f32 v89, v37, v58
    v_fmac_f32 v90, v38, v58
    v_fmac_f32 v91, v39, v58
    s_lshr_b32 m0, s29, 16
    v_fmac_f32 v88, v40, v59
    v_fmac_f32 v89, v41, v59
    v_fmac_f32 v90, v42, v59
    v_fmac_f32 v91, v43, v59
    s_or_b32 m0, s40, s35
    v_mfma_f32_4x4x4_16b_bf16 v[28:31], v[8:9], v[76:77], 0
    v_mfma_f32_4x4x4_16b_bf16 v[32:35], v[8:9], v[78:79], 0
    v_mfma_f32_4x4x4_16b_bf16 v[36:39], v[8:9], v[80:81], 0
    v_mfma_f32_4x4x4_16b_bf16 v[40:43], v[8:9], v[82:83], 0
    v_mfma_f32_32x32x16_bf16 v[44:59], v[60:63], v[68:71], 0
    v_mfma_f32_32x32x16_bf16 v[44:59], v[64:67], v[72:75], v[44:59]
    s_waitcnt lgkmcnt(0)
    buffer_load_dwordx4 v[4:5], s[4:7], 0 idxen offen lds
    buffer_load_dwordx4 v[6:7], s[12:15], 0 idxen offen offset:1024 lds
    v_cvt_pk_bf16_f32 v12, v28, v32
    v_cvt_pk_bf16_f32 v14, v29, v33
    v_cvt_pk_bf16_f32 v16, v30, v34
    v_cvt_pk_bf16_f32 v13, v36, v40
    v_cvt_pk_bf16_f32 v15, v37, v41
    v_cvt_pk_bf16_f32 v17, v38, v42
    v_or_b32_dpp v19, v10, v11 row_shl:4 row_mask:0xf bank_mask:0xf bound_ctrl:0
    v_add_u32 v2, 192, v2
    v_add_u32 v3, 192, v3
    v_add_u32 v18, 192, v18
    v_readfirstlane_b32 s27, v85
    s_setprio 2
    s_xor_b32 s27, s27, s26
    s_cmp_ge_i32 s27, 0
    s_cbranch_scc1 mn_pr11
    s_setprio 1
mn_pr11:
    s_sub_u32 s19, s19, 1
    s_cbranch_scc1 mn_st11
mn_st11_back:
    s_branch mn_loop
mn_st0:
    s_cmp_lg_u32 s21, 0
    s_cbranch_scc1 mn_next
    s_call_b64 s[48:49], mn_flush
    s_branch mn_st0_back
mn_st1:
    s_cmp_lg_u32 s21, 0
    s_cbranch_scc1 mn_next
    s_call_b64 s[48:49], mn_flush
    s_branch mn_st1_back
mn_st2:
    s_cmp_lg_u32 s21, 0
    s_cbranch_scc1 mn_next
    s_call_b64 s[48:49], mn_flush
    s_branch mn_st2_back
mn_st3:
    s_cmp_lg_u32 s21, 0
    s_cbranch_scc1 mn_next
    s_call_b64 s[48:49], mn_flush
    s_branch mn_st3_back
mn_st4:
    s_cmp_lg_u32 s21, 0
    s_cbranch_scc1 mn_next
    s_call_b64 s[48:49], mn_flush
    s_branch mn_st4_back
mn_st5:
    s_cmp_lg_u32 s21, 0
    s_cbranch_scc1 mn_next
    s_call_b64 s[48:49], mn_flush
    s_branch mn_st5_back
mn_st6:
    s_cmp_lg_u32 s21, 0
    s_cbranch_scc1 mn_next
    s_call_b64 s[48:49], mn_flush
    s_branch mn_st6_back
mn_st7:
    s_cmp_lg_u32 s21, 0
    s_cbranch_scc1 mn_next
    s_call_b64 s[48:49], mn_flush
    s_branch mn_st7_back
mn_st8:
    s_cmp_lg_u32 s21, 0
    s_cbranch_scc1 mn_next
    s_call_b64 s[48:49], mn_flush
    s_branch mn_st8_back
mn_st9:
    s_cmp_lg_u32 s21, 0
    s_cbranch_scc1 mn_next
    s_call_b64 s[48:49], mn_flush
    s_branch mn_st9_back
mn_st10:
    s_cmp_lg_u32 s21, 0
    s_cbranch_scc1 mn_next
    s_call_b64 s[48:49], mn_flush
    s_branch mn_st10_back
mn_st11:
    s_cmp_lg_u32 s21, 0
    s_cbranch_scc1 mn_next
    s_call_b64 s[48:49], mn_flush
    s_branch mn_st11_back
mn_st12:
    s_cmp_lg_u32 s21, 0
    s_cbranch_scc1 mn_next
    s_call_b64 s[48:49], mn_flush
    s_branch mn_st12_back
mn_flush:
    s_cmp_eq_u32 s58, 4
    s_cbranch_scc1 mn_fl4
    s_cmp_eq_u32 s58, 3
    s_cbranch_scc1 mn_fl3
    s_cmp_eq_u32 s58, 2
    s_cbranch_scc1 mn_fl2
    s_cmp_eq_u32 s58, 1
    s_cbranch_scc1 mn_fl1
mn_fl0:
    v_cvt_pk_bf16_f32 v88, v88, v89
    v_cvt_pk_bf16_f32 v89, v90, v91
    ds_write_b64 v87, v[88:89] offset:0
    v_cvt_pk_bf16_f32 v92, v92, v93
    v_cvt_pk_bf16_f32 v93, v94, v95
    ds_write_b64 v87, v[92:93] offset:576
    v_cvt_pk_bf16_f32 v96, v96, v97
    v_cvt_pk_bf16_f32 v97, v98, v99
    ds_write_b64 v87, v[96:97] offset:1152
    v_cvt_pk_bf16_f32 v100, v100, v101
    v_cvt_pk_bf16_f32 v101, v102, v103
    ds_write_b64 v87, v[100:101] offset:1728
    s_mul_i32 s52, s18, 3
    s_lshl_b32 s52, 1, s52
    v_mov_b32 v90, s52
    v_mov_b32 v91, 0
    s_mov_b64 exec, 1
    ds_add_u32 v91, v90 offset:276
    s_mov_b64 exec, -1
    s_add_u32 s58, s58, 1
    s_sub_u32 s19, s85, 1
    s_cbranch_scc1 mn_fl1
    s_setpc_b64 s[48:49]
mn_fl1:
    v_cvt_pk_bf16_f32 v104, v104, v105
    v_cvt_pk_bf16_f32 v105, v106, v107
    ds_write_b64 v87, v[104:105] offset:2304
    v_cvt_pk_bf16_f32 v108, v108, v109
    v_cvt_pk_bf16_f32 v109, v110, v111
    ds_write_b64 v87, v[108:109] offset:2880
    v_cvt_pk_bf16_f32 v112, v112, v113
    v_cvt_pk_bf16_f32 v113, v114, v115
    ds_write_b64 v87, v[112:113] offset:3456
    v_cvt_pk_bf16_f32 v116, v116, v117
    v_cvt_pk_bf16_f32 v117, v118, v119
    ds_write_b64 v87, v[116:117] offset:4032
    s_mul_i32 s52, s18, 3
    s_lshl_b32 s52, 64, s52
    v_mov_b32 v106, s52
    v_mov_b32 v107, 0
    s_mov_b64 exec, 1
    ds_add_u32 v107, v106 offset:276
    s_mov_b64 exec, -1
    s_add_u32 s58, s58, 1
    s_sub_u32 s19, s86, 1
    s_cbranch_scc1 mn_fl2
    s_setpc_b64 s[48:49]
mn_fl2:
    v_cvt_pk_bf16_f32 v120, v120, v121
    v_cvt_pk_bf16_f32 v121, v122, v123
    ds_write_b64 v87, v[120:121] offset:4608
    v_cvt_pk_bf16_f32 v124, v124, v125
    v_cvt_pk_bf16_f32 v125, v126, v127
    ds_write_b64 v87, v[124:125] offset:5184
    v_cvt_pk_bf16_f32 v128, v128, v129
    v_cvt_pk_bf16_f32 v129, v130, v131
    ds_write_b64 v87, v[128:129] offset:5760
    v_cvt_pk_bf16_f32 v132, v132, v133
    v_cvt_pk_bf16_f32 v133, v134, v135
    ds_write_b64 v87, v[132:133] offset:6336
    s_mul_i32 s52, s18, 3
    s_lshl_b32 s52, 4096, s52
    v_mov_b32 v122, s52
    v_mov_b32 v123, 0
    s_mov_b64 exec, 1
    ds_add_u32 v123, v122 offset:276
    s_mov_b64 exec, -1
    s_add_u32 s58, s58, 1
    s_sub_u32 s19, s87, 1
    s_cbranch_scc1 mn_fl3
    s_setpc_b64 s[48:49]
mn_fl3:
    v_cvt_pk_bf16_f32 v136, v136, v137
    v_cvt_pk_bf16_f32 v137, v138, v139
    ds_write_b64 v87, v[136:137] offset:6912
    v_cvt_pk_bf16_f32 v140, v140, v141
    v_cvt_pk_bf16_f32 v141, v142, v143
    ds_write_b64 v87, v[140:141] offset:7488
    v_cvt_pk_bf16_f32 v144, v144, v145
    v_cvt_pk_bf16_f32 v145, v146, v147
    ds_write_b64 v87, v[144:145] offset:8064
    v_cvt_pk_bf16_f32 v148, v148, v149
    v_cvt_pk_bf16_f32 v149, v150, v151
    ds_write_b64 v87, v[148:149] offset:8640
    s_mul_i32 s52, s18, 3
    s_lshl_b32 s52, 262144, s52
    v_mov_b32 v138, s52
    v_mov_b32 v139, 0
    s_mov_b64 exec, 1
    ds_add_u32 v139, v138 offset:276
    s_mov_b64 exec, -1
    s_add_u32 s58, s58, 1
    s_sub_u32 s19, s88, 1
    s_cbranch_scc1 mn_fl4
    s_setpc_b64 s[48:49]
mn_fl4:
    s_cmp_ge_u32 s57, 4
    s_cbranch_scc1 mn_fl4b
    s_waitcnt vmcnt(0)
mn_fl4b:
    v_cvt_pk_bf16_f32 v152, v152, v153
    v_cvt_pk_bf16_f32 v153, v154, v155
    ds_write_b64 v87, v[152:153] offset:9216
    v_cvt_pk_bf16_f32 v156, v156, v157
    v_cvt_pk_bf16_f32 v157, v158, v159
    ds_write_b64 v87, v[156:157] offset:9792
    v_cvt_pk_bf16_f32 v160, v160, v161
    v_cvt_pk_bf16_f32 v161, v162, v163
    ds_write_b64 v87, v[160:161] offset:10368
    v_cvt_pk_bf16_f32 v164, v164, v165
    v_cvt_pk_bf16_f32 v165, v166, v167
    ds_write_b64 v87, v[164:165] offset:10944
    s_mul_i32 s52, s18, 3
    s_lshl_b32 s52, 16777216, s52
    v_mov_b32 v154, s52
    v_mov_b32 v155, 0
    s_mov_b64 exec, 1
    ds_add_u32 v155, v154 offset:276
    s_mov_b64 exec, -1
    s_waitcnt vmcnt(0) lgkmcnt(0)
mn_end:
    s_endpgm
gm_main:
    s_load_dwordx2 s[56:57], s[0:1], 64
    s_load_dwordx2 s[26:27], s[0:1], 56
    v_and_b32 v3, 63, v0
    v_bfe_u32 v12, v0, 1, 7
    v_and_b32 v11, 15, v12
    v_lshrrev_b32 v10, 4, v12
    v_lshl_or_b32 v11, v11, 3, v10
    v_cmp_gt_u32 vcc, 125, v11
    v_mul_u32_u24 v13, 51200, v11
    v_bfrev_b32 v10, 2
    v_lshlrev_b32 v12, 10, v12
    v_cndmask_b32 v12, v10, v12, vcc
    v_lshlrev_b32 v2, 4, v3
    s_lshl_b32 s40, s17, 15
    s_add_u32 s40, s40, 11534336
    s_waitcnt lgkmcnt(0)
    s_mov_b32 s8, s54
    s_and_b32 s9, s55, 0xffff
    v_lshrrev_b32 v11, 4, v3
    v_lshlrev_b32 v11, 11, v11
    v_and_b32 v10, 7, v3
    v_lshl_add_u32 v11, v10, 4, v11
    v_and_b32 v10, 8, v3
    v_lshlrev_b32 v10, 10, v10
    s_lshl_b32 s52, s17, 7
    s_add_u32 s52, s52, 114688
    v_add3_u32 v11, v11, v10, s52
    s_mov_b32 s44, 0x05040100
    s_mov_b32 s45, 0x07060302
    v_mov_b32 v5, v11
    s_cmp_ge_u32 s2, 125
    s_cbranch_scc1 gm_wgo
    s_cmp_ge_u32 s16, 10
    s_cbranch_scc1 gm_wsp
    s_cmp_ge_u32 s2, 125
    s_waitcnt vmcnt(0)
    s_cbranch_scc1 gm_wsp
    v_mov_b32 v11, 0
    v_mov_b32 v10, 1
    s_mov_b64 exec, 1
    ds_add_u32 v11, v10 offset:448
    s_mov_b64 exec, -1
gm_dummy:
gm_wsp:
    v_mov_b32 v11, 0
    ds_read_b32 v11, v11 offset:448
    s_waitcnt lgkmcnt(0)
    v_readfirstlane_b32 s62, v11
    s_cmp_ge_u32 s62, 10
    s_cbranch_scc1 gm_wspx
    s_sleep 1
    s_branch gm_wsp
gm_wspx:
    s_cmp_lg_u32 s16, 10
    s_cbranch_scc1 gm_wgo
    s_and_b32 s52, s2, 1
    s_lshl_b32 s53, s52, 7
    s_add_u32 s53, s53, 64
    s_mov_b32 s62, 1
    s_atomic_add s62, s[60:61], s53 glc
    s_sub_u32 s52, 62, s52
    s_add_u32 s28, s54, 11730944
    s_addc_u32 s29, s55, 0
    s_mov_b32 s53, 0x10000
    s_waitcnt lgkmcnt(0)
    s_cmp_lg_u32 s62, s52
    s_cbranch_scc1 gm_wgo
    s_atomic_add s53, s[28:29], 0
    s_atomic_add s53, s[28:29], 128
    s_atomic_add s53, s[28:29], 256
    s_atomic_add s53, s[28:29], 384
    s_atomic_add s53, s[28:29], 512
    s_atomic_add s53, s[28:29], 640
    s_atomic_add s53, s[28:29], 768
    s_atomic_add s53, s[28:29], 896
    s_atomic_add s53, s[28:29], 1024
    s_atomic_add s53, s[28:29], 1152
    s_atomic_add s53, s[28:29], 1280
    s_atomic_add s53, s[28:29], 1408
    s_atomic_add s53, s[28:29], 1536
    s_atomic_add s53, s[28:29], 1664
    s_atomic_add s53, s[28:29], 1792
    s_atomic_add s53, s[28:29], 1920
gm_wgo:
    global_load_dwordx4 v[136:139], v5, s[26:27] offset:0
    global_load_dwordx4 v[140:143], v5, s[26:27] offset:512
    global_load_dwordx4 v[144:147], v5, s[26:27] offset:1024
    global_load_dwordx4 v[148:151], v5, s[26:27] offset:1536
    v_subrev_u32 v5, 0x4000, v5
    global_load_dwordx4 v[120:123], v5, s[26:27] offset:0
    global_load_dwordx4 v[124:127], v5, s[26:27] offset:512
    global_load_dwordx4 v[128:131], v5, s[26:27] offset:1024
    global_load_dwordx4 v[132:135], v5, s[26:27] offset:1536
    v_subrev_u32 v5, 0x4000, v5
    global_load_dwordx4 v[104:107], v5, s[26:27] offset:0
    global_load_dwordx4 v[108:111], v5, s[26:27] offset:512
    global_load_dwordx4 v[112:115], v5, s[26:27] offset:1024
    global_load_dwordx4 v[116:119], v5, s[26:27] offset:1536
    v_subrev_u32 v5, 0x4000, v5
    global_load_dwordx4 v[88:91], v5, s[26:27] offset:0
    global_load_dwordx4 v[92:95], v5, s[26:27] offset:512
    global_load_dwordx4 v[96:99], v5, s[26:27] offset:1024
    global_load_dwordx4 v[100:103], v5, s[26:27] offset:1536
    v_subrev_u32 v5, 0x4000, v5
    global_load_dwordx4 v[72:75], v5, s[26:27] offset:0
    global_load_dwordx4 v[76:79], v5, s[26:27] offset:512
    global_load_dwordx4 v[80:83], v5, s[26:27] offset:1024
    global_load_dwordx4 v[84:87], v5, s[26:27] offset:1536
    v_subrev_u32 v5, 0x4000, v5
    s_cmp_lt_u32 s2, 125
    s_cbranch_scc1 gm_wskip
    global_load_dwordx4 v[56:59], v5, s[26:27] offset:0
    global_load_dwordx4 v[60:63], v5, s[26:27] offset:512
    global_load_dwordx4 v[64:67], v5, s[26:27] offset:1024
    global_load_dwordx4 v[68:71], v5, s[26:27] offset:1536
    v_subrev_u32 v5, 0x4000, v5
    global_load_dwordx4 v[40:43], v5, s[26:27] offset:0
    global_load_dwordx4 v[44:47], v5, s[26:27] offset:512
    global_load_dwordx4 v[48:51], v5, s[26:27] offset:1024
    global_load_dwordx4 v[52:55], v5, s[26:27] offset:1536
    v_subrev_u32 v5, 0x4000, v5
gm_wskip:
    s_mul_i32 s41, s2, 625
    s_add_u32 s52, s41, 640
    s_add_u32 s41, s41, 15
    s_lshr_b32 s41, s41, 4
    s_lshr_b32 s52, s52, 4
    s_mov_b32 s12, s56
    s_and_b32 s13, s57, 0xffff
    s_lshl_b32 s14, s52, 11
    s_mov_b32 s15, 0x20000
    s_mul_i32 s42, s17, 15360
    s_add_u32 s42, s42, 40960
    s_lshl_b32 s43, s17, 1
    s_sub_u32 s43, s43, 1
    v_lshlrev_b32 v6, 2, v3
    v_add_u32 v11, 0, v3
    v_mul_u32_u24 v10, 21846, v11
    v_lshrrev_b32 v10, 16, v10
    v_lshl_add_u32 v34, v10, 2, s42
    v_mad_i32_i24 v10, v10, -3, v11
    v_lshlrev_b32 v30, 4, v10
    v_add_u32 v11, 64, v3
    v_mul_u32_u24 v10, 21846, v11
    v_lshrrev_b32 v10, 16, v10
    v_lshl_add_u32 v35, v10, 2, s42
    v_mad_i32_i24 v10, v10, -3, v11
    v_lshlrev_b32 v31, 4, v10
    v_add_u32 v11, 128, v3
    v_mul_u32_u24 v10, 21846, v11
    v_lshrrev_b32 v10, 16, v10
    v_lshl_add_u32 v36, v10, 2, s42
    v_mad_i32_i24 v10, v10, -3, v11
    v_lshlrev_b32 v32, 4, v10
gm_sp1:
    v_mov_b32 v11, 0
    ds_read_b32 v11, v11 offset:308
    s_waitcnt lgkmcnt(0)
    v_readfirstlane_b32 s62, v11
    s_cmp_ge_u32 s62, 1
    s_cbranch_scc1 gm_sp1x
    s_sleep 1
    s_branch gm_sp1
gm_sp1x:
    buffer_load_dword v4, v12, s[8:11], s22 offen offset:60 sc1
    s_waitcnt vmcnt(0)
gm_pass:
    v_lshrrev_b32 v8, 16, v4
    v_subrev_u32 v8, s24, v8
    v_med3_i32 v8, v8, 0, s20
    v_mov_b32 v9, v8
    v_and_b32 v12, 1, v0
    v_and_b32 v14, 0xffff, v4
    v_add_u32_dpp v9, v9, v9 row_shr:2 row_mask:0xf bank_mask:0xf
    v_add3_u32 v14, v14, v12, s24
    s_nop 0
    v_add_u32_dpp v9, v9, v9 row_shr:4 row_mask:0xf bank_mask:0xf
    v_mad_u32_u24 v14, v14, 40, v13
    s_nop 0
    v_add_u32_dpp v9, v9, v9 row_shr:8 row_mask:0xf bank_mask:0xf
    v_sub_u32 v15, v8, v12
    s_nop 0
    v_add_u32_dpp v9, v9, v9 row_bcast:15 row_mask:0xa bank_mask:0xf
    s_nop 0
    s_nop 0
    v_add_u32_dpp v9, v9, v9 row_bcast:31 row_mask:0xc bank_mask:0xf
    s_nop 0
    s_nop 0
    v_readlane_b32 s47, v9, 63
    v_sub_u32 v16, v9, v15
    v_lshl_add_u32 v16, v16, 2, s42
    v_cmpx_lt_i32 vcc, 0, v15
    s_cbranch_execz gm_tb_done
    ds_write_b32 v16, v14 offset:0
    v_add_u32 v14, 80, v14
    v_cmpx_lt_i32 vcc, 2, v15
    s_cbranch_execz gm_tb_done
    ds_write_b32 v16, v14 offset:8
    v_add_u32 v14, 80, v14
    v_cmpx_lt_i32 vcc, 4, v15
    s_cbranch_execz gm_tb_done
    ds_write_b32 v16, v14 offset:16
    v_add_u32 v14, 80, v14
    v_cmpx_lt_i32 vcc, 6, v15
    s_cbranch_execz gm_tb_done
    ds_write_b32 v16, v14 offset:24
    v_add_u32 v14, 80, v14
    v_cmpx_lt_i32 vcc, 8, v15
    s_cbranch_execz gm_tb_done
    ds_write_b32 v16, v14 offset:32
    v_add_u32 v14, 80, v14
    v_cmpx_lt_i32 vcc, 10, v15
    s_cbranch_execz gm_tb_done
    ds_write_b32 v16, v14 offset:40
    v_add_u32 v14, 80, v14
    v_cmpx_lt_i32 vcc, 12, v15
    s_cbranch_execz gm_tb_done
    ds_write_b32 v16, v14 offset:48
    v_add_u32 v14, 80, v14
    v_cmpx_lt_i32 vcc, 14, v15
    s_cbranch_execz gm_tb_done
    ds_write_b32 v16, v14 offset:56
    v_add_u32 v14, 80, v14
    v_cmpx_lt_i32 vcc, 16, v15
    s_cbranch_execz gm_tb_done
    ds_write_b32 v16, v14 offset:64
    v_add_u32 v14, 80, v14
    v_cmpx_lt_i32 vcc, 18, v15
    s_cbranch_execz gm_tb_done
    ds_write_b32 v16, v14 offset:72
gm_tb_done:
    s_mov_b64 exec, -1
    s_mul_i32 s47, s47, 3
    v_mov_b32 v17, 0
    ds_read_b32 v18, v34 offset:0
    ds_read_b32 v19, v35 offset:0
    ds_read_b32 v20, v36 offset:0
    ds_read_b32 v21, v34 offset:256
    ds_read_b32 v22, v35 offset:256
    ds_read_b32 v23, v36 offset:256
    ds_read_b32 v24, v34 offset:512
    ds_read_b32 v25, v35 offset:512
    ds_read_b32 v26, v36 offset:512
    ds_read_b32 v29, v17 offset:456
    s_and_b32 s62, s2, 15
    s_lshl_b32 s62, s62, 7
    s_add_u32 s62, s62, 11730944
    v_mov_b32 v28, s62
    global_load_dword v27, v28, s[54:55] sc1
    s_barrier
    ds_read_b32 v15, v6 offset:384
    ds_read_b32 v17, v17 offset:272
    v_mov_b32 v11, v34
    v_mov_b32 v10, v35
    v_mov_b32 v14, v36
    s_waitcnt lgkmcnt(1)
    v_add_u32_dpp v15, v15, v15 row_shr:1 row_mask:0xf bank_mask:0xf
    s_nop 1
    v_add_u32_dpp v15, v15, v15 row_shr:2 row_mask:0xf bank_mask:0xf
    s_nop 1
    v_add_u32_dpp v15, v15, v15 row_shr:4 row_mask:0xf bank_mask:0xf
    s_waitcnt lgkmcnt(0)
    v_readfirstlane_b32 s21, v17
    v_readlane_b32 s23, v15, 7
    v_readlane_b32 s46, v15, s43
    s_cmp_gt_u32 s23, 773
    s_cbranch_scc1 gm_ovf
    s_cmp_eq_u32 s17, 0
    s_cmov_b32 s46, 0
    s_mul_i32 s46, s46, 48
    s_add_u32 m0, s46, 3776
    v_add_u32 v18, v18, v30
    v_add_u32 v19, v19, v31
    v_add_u32 v20, v20, v32
    v_add_u32 v21, v21, v30
    v_add_u32 v22, v22, v31
    v_add_u32 v23, v23, v32
    v_add_u32 v24, v24, v30
    v_add_u32 v25, v25, v31
    v_add_u32 v26, v26, v32
    s_mov_b32 s63, 0x100000
gm_ep:
    s_waitcnt vmcnt(0)
    v_sub_u32 v27, v27, v29
    v_lshrrev_b32 v27, 16, v27
    v_cmp_eq_u32 vcc, 2, v27
    s_cbranch_vccnz gm_go2
    s_and_b32 s62, s63, 31
    s_sub_u32 s63, s63, 1
    s_cmp_eq_u32 s62, 1
    s_cbranch_scc1 gm_epd
    s_sleep 6
    global_load_dword v27, v28, s[54:55] sc1
    s_branch gm_ep
gm_epd:
    s_and_b32 s62, s2, 15
    s_lshl_b32 s62, s62, 7
    s_add_u32 s62, s62, 11730944
    v_mov_b32 v27, s62
    v_lshlrev_b32 v28, 6, v0
    v_and_b32 v28, 0xc0, v28
    s_mov_b32 s63, 0x100000
mn_poll2dem:
    s_sub_u32 s63, s63, 1
    s_cbranch_scc1 mn_poll2dex
    global_load_dword v29, v28, s[60:61] sc1
    s_waitcnt vmcnt(0)
    v_add_u32_dpp v29, v29, v29 quad_perm:[2,3,0,1] row_mask:0xf bank_mask:0xf
    s_sleep 8
    v_readlane_b32 s62, v29, 1
    s_cmp_lt_u32 s62, 125
    s_cbranch_scc1 mn_poll2dem
mn_poll2dex:
gm_go2:
    v_cmpx_gt_i32 vcc, s47, v3
    s_cbranch_execz gm_raw_done
    buffer_load_dwordx4 v18, s[8:11], 0 offen sc1 lds
    s_add_u32 m0, m0, 1024
    s_sub_i32 s47, s47, 64
    v_cmpx_gt_i32 vcc, s47, v3
    s_cbranch_execz gm_raw_done
    buffer_load_dwordx4 v19, s[8:11], 0 offen sc1 lds
    s_add_u32 m0, m0, 1024
    s_sub_i32 s47, s47, 64
    v_cmpx_gt_i32 vcc, s47, v3
    s_cbranch_execz gm_raw_done
    buffer_load_dwordx4 v20, s[8:11], 0 offen sc1 lds
    s_add_u32 m0, m0, 1024
    s_sub_i32 s47, s47, 64
    v_cmpx_gt_i32 vcc, s47, v3
    s_cbranch_execz gm_raw_done
    buffer_load_dwordx4 v21, s[8:11], 0 offen sc1 lds
    s_add_u32 m0, m0, 1024
    s_sub_i32 s47, s47, 64
    v_cmpx_gt_i32 vcc, s47, v3
    s_cbranch_execz gm_raw_done
    buffer_load_dwordx4 v22, s[8:11], 0 offen sc1 lds
    s_add_u32 m0, m0, 1024
    s_sub_i32 s47, s47, 64
    v_cmpx_gt_i32 vcc, s47, v3
    s_cbranch_execz gm_raw_done
    buffer_load_dwordx4 v23, s[8:11], 0 offen sc1 lds
    s_add_u32 m0, m0, 1024
    s_sub_i32 s47, s47, 64
    v_cmpx_gt_i32 vcc, s47, v3
    s_cbranch_execz gm_raw_done
    buffer_load_dwordx4 v24, s[8:11], 0 offen sc1 lds
    s_add_u32 m0, m0, 1024
    s_sub_i32 s47, s47, 64
    v_cmpx_gt_i32 vcc, s47, v3
    s_cbranch_execz gm_raw_done
    buffer_load_dwordx4 v25, s[8:11], 0 offen sc1 lds
    s_add_u32 m0, m0, 1024
    s_sub_i32 s47, s47, 64
    v_cmpx_gt_i32 vcc, s47, v3
    s_cbranch_execz gm_raw_done
    buffer_load_dwordx4 v26, s[8:11], 0 offen sc1 lds
    s_add_u32 m0, m0, 1024
    s_sub_i32 s47, s47, 64
    v_add_u32 v11, 768, v11
    v_add_u32 v10, 768, v10
    v_add_u32 v14, 768, v14
gm_raw:
    ds_read_b32 v18, v11 offset:0
    ds_read_b32 v19, v10 offset:0
    ds_read_b32 v20, v14 offset:0
    ds_read_b32 v21, v11 offset:256
    ds_read_b32 v22, v10 offset:256
    ds_read_b32 v23, v14 offset:256
    ds_read_b32 v24, v11 offset:512
    ds_read_b32 v25, v10 offset:512
    ds_read_b32 v26, v14 offset:512
    v_cmpx_gt_i32 vcc, s47, v3
    s_cbranch_execz gm_raw_done
    s_waitcnt lgkmcnt(8)
    v_add_u32 v18, v18, v30
    buffer_load_dwordx4 v18, s[8:11], 0 offen sc1 lds
    s_add_u32 m0, m0, 1024
    s_sub_i32 s47, s47, 64
    v_cmpx_gt_i32 vcc, s47, v3
    s_cbranch_execz gm_raw_done
    s_waitcnt lgkmcnt(7)
    v_add_u32 v19, v19, v31
    buffer_load_dwordx4 v19, s[8:11], 0 offen sc1 lds
    s_add_u32 m0, m0, 1024
    s_sub_i32 s47, s47, 64
    v_cmpx_gt_i32 vcc, s47, v3
    s_cbranch_execz gm_raw_done
    s_waitcnt lgkmcnt(6)
    v_add_u32 v20, v20, v32
    buffer_load_dwordx4 v20, s[8:11], 0 offen sc1 lds
    s_add_u32 m0, m0, 1024
    s_sub_i32 s47, s47, 64
    v_cmpx_gt_i32 vcc, s47, v3
    s_cbranch_execz gm_raw_done
    s_waitcnt lgkmcnt(5)
    v_add_u32 v21, v21, v30
    buffer_load_dwordx4 v21, s[8:11], 0 offen sc1 lds
    s_add_u32 m0, m0, 1024
    s_sub_i32 s47, s47, 64
    v_cmpx_gt_i32 vcc, s47, v3
    s_cbranch_execz gm_raw_done
    s_waitcnt lgkmcnt(4)
    v_add_u32 v22, v22, v31
    buffer_load_dwordx4 v22, s[8:11], 0 offen sc1 lds
    s_add_u32 m0, m0, 1024
    s_sub_i32 s47, s47, 64
    v_cmpx_gt_i32 vcc, s47, v3
    s_cbranch_execz gm_raw_done
    s_waitcnt lgkmcnt(3)
    v_add_u32 v23, v23, v32
    buffer_load_dwordx4 v23, s[8:11], 0 offen sc1 lds
    s_add_u32 m0, m0, 1024
    s_sub_i32 s47, s47, 64
    v_cmpx_gt_i32 vcc, s47, v3
    s_cbranch_execz gm_raw_done
    s_waitcnt lgkmcnt(2)
    v_add_u32 v24, v24, v30
    buffer_load_dwordx4 v24, s[8:11], 0 offen sc1 lds
    s_add_u32 m0, m0, 1024
    s_sub_i32 s47, s47, 64
    v_cmpx_gt_i32 vcc, s47, v3
    s_cbranch_execz gm_raw_done
    s_waitcnt lgkmcnt(1)
    v_add_u32 v25, v25, v31
    buffer_load_dwordx4 v25, s[8:11], 0 offen sc1 lds
    s_add_u32 m0, m0, 1024
    s_sub_i32 s47, s47, 64
    v_cmpx_gt_i32 vcc, s47, v3
    s_cbranch_execz gm_raw_done
    s_waitcnt lgkmcnt(0)
    v_add_u32 v26, v26, v32
    buffer_load_dwordx4 v26, s[8:11], 0 offen sc1 lds
    s_add_u32 m0, m0, 1024
    s_sub_i32 s47, s47, 64
    v_add_u32 v11, 768, v11
    v_add_u32 v10, 768, v10
    v_add_u32 v14, 768, v14
    s_branch gm_raw
gm_raw_done:
    s_mov_b64 exec, -1
    s_barrier
    s_waitcnt vmcnt(0) lgkmcnt(0)
    s_barrier
    s_cmp_lg_u32 s21, 0
    s_cbranch_scc1 gm_next
    s_cmp_ge_u32 s2, 125
    s_cbranch_scc1 gm_wdone
    global_load_dwordx4 v[56:59], v5, s[26:27] offset:0
    global_load_dwordx4 v[60:63], v5, s[26:27] offset:512
    global_load_dwordx4 v[64:67], v5, s[26:27] offset:1024
    global_load_dwordx4 v[68:71], v5, s[26:27] offset:1536
    v_subrev_u32 v5, 0x4000, v5
    s_waitcnt vmcnt(0)
    global_load_dwordx4 v[40:43], v5, s[26:27] offset:0
    global_load_dwordx4 v[44:47], v5, s[26:27] offset:512
    global_load_dwordx4 v[48:51], v5, s[26:27] offset:1024
    global_load_dwordx4 v[52:55], v5, s[26:27] offset:1536
    v_subrev_u32 v5, 0x4000, v5
    s_waitcnt vmcnt(0)
gm_wdone:
    global_load_dwordx4 v[24:27], v5, s[26:27] offset:0
    global_load_dwordx4 v[28:31], v5, s[26:27] offset:512
    global_load_dwordx4 v[32:35], v5, s[26:27] offset:1024
    global_load_dwordx4 v[36:39], v5, s[26:27] offset:1536
    v_mov_b32_dpp v152, v138 row_ror:8 row_mask:0xf bank_mask:0xf
    v_mov_b32_dpp v153, v139 row_ror:8 row_mask:0xf bank_mask:0xf
    v_mov_b32_dpp v154, v142 row_ror:8 row_mask:0xf bank_mask:0xf
    v_mov_b32_dpp v155, v143 row_ror:8 row_mask:0xf bank_mask:0xf
    v_mov_b32_dpp v156, v146 row_ror:8 row_mask:0xf bank_mask:0xf
    v_mov_b32_dpp v157, v147 row_ror:8 row_mask:0xf bank_mask:0xf
    v_mov_b32_dpp v158, v150 row_ror:8 row_mask:0xf bank_mask:0xf
    v_mov_b32_dpp v159, v151 row_ror:8 row_mask:0xf bank_mask:0xf
    v_mov_b32_dpp v138, v136 row_ror:8 row_mask:0xf bank_mask:0x3
    v_mov_b32_dpp v139, v137 row_ror:8 row_mask:0xf bank_mask:0x3
    v_mov_b32_dpp v142, v140 row_ror:8 row_mask:0xf bank_mask:0x3
    v_mov_b32_dpp v143, v141 row_ror:8 row_mask:0xf bank_mask:0x3
    v_mov_b32_dpp v146, v144 row_ror:8 row_mask:0xf bank_mask:0x3
    v_mov_b32_dpp v147, v145 row_ror:8 row_mask:0xf bank_mask:0x3
    v_mov_b32_dpp v150, v148 row_ror:8 row_mask:0xf bank_mask:0x3
    v_mov_b32_dpp v151, v149 row_ror:8 row_mask:0xf bank_mask:0x3
    v_mov_b32_dpp v136, v152 quad_perm:[0,1,2,3] row_mask:0xf bank_mask:0xc
    v_mov_b32_dpp v137, v153 quad_perm:[0,1,2,3] row_mask:0xf bank_mask:0xc
    v_mov_b32_dpp v140, v154 quad_perm:[0,1,2,3] row_mask:0xf bank_mask:0xc
    v_mov_b32_dpp v141, v155 quad_perm:[0,1,2,3] row_mask:0xf bank_mask:0xc
    v_mov_b32_dpp v144, v156 quad_perm:[0,1,2,3] row_mask:0xf bank_mask:0xc
    v_mov_b32_dpp v145, v157 quad_perm:[0,1,2,3] row_mask:0xf bank_mask:0xc
    v_mov_b32_dpp v148, v158 quad_perm:[0,1,2,3] row_mask:0xf bank_mask:0xc
    v_mov_b32_dpp v149, v159 quad_perm:[0,1,2,3] row_mask:0xf bank_mask:0xc
    v_perm_b32 v152, v140, v136, s44
    v_perm_b32 v153, v148, v144, s44
    v_perm_b32 v154, v142, v138, s44
    v_perm_b32 v155, v150, v146, s44
    v_perm_b32 v156, v140, v136, s45
    v_perm_b32 v157, v148, v144, s45
    v_perm_b32 v158, v142, v138, s45
    v_perm_b32 v159, v150, v146, s45
    v_perm_b32 v160, v141, v137, s44
    v_perm_b32 v161, v149, v145, s44
    v_perm_b32 v162, v143, v139, s44
    v_perm_b32 v163, v151, v147, s44
    v_perm_b32 v164, v141, v137, s45
    v_perm_b32 v165, v149, v145, s45
    v_perm_b32 v166, v143, v139, s45
    v_perm_b32 v167, v151, v147, s45
    v_mov_b32_dpp v136, v122 row_ror:8 row_mask:0xf bank_mask:0xf
    v_mov_b32_dpp v137, v123 row_ror:8 row_mask:0xf bank_mask:0xf
    v_mov_b32_dpp v138, v126 row_ror:8 row_mask:0xf bank_mask:0xf
    v_mov_b32_dpp v139, v127 row_ror:8 row_mask:0xf bank_mask:0xf
    v_mov_b32_dpp v140, v130 row_ror:8 row_mask:0xf bank_mask:0xf
    v_mov_b32_dpp v141, v131 row_ror:8 row_mask:0xf bank_mask:0xf
    v_mov_b32_dpp v142, v134 row_ror:8 row_mask:0xf bank_mask:0xf
    v_mov_b32_dpp v143, v135 row_ror:8 row_mask:0xf bank_mask:0xf
    v_mov_b32_dpp v122, v120 row_ror:8 row_mask:0xf bank_mask:0x3
    v_mov_b32_dpp v123, v121 row_ror:8 row_mask:0xf bank_mask:0x3
    v_mov_b32_dpp v126, v124 row_ror:8 row_mask:0xf bank_mask:0x3
    v_mov_b32_dpp v127, v125 row_ror:8 row_mask:0xf bank_mask:0x3
    v_mov_b32_dpp v130, v128 row_ror:8 row_mask:0xf bank_mask:0x3
    v_mov_b32_dpp v131, v129 row_ror:8 row_mask:0xf bank_mask:0x3
    v_mov_b32_dpp v134, v132 row_ror:8 row_mask:0xf bank_mask:0x3
    v_mov_b32_dpp v135, v133 row_ror:8 row_mask:0xf bank_mask:0x3
    v_mov_b32_dpp v120, v136 quad_perm:[0,1,2,3] row_mask:0xf bank_mask:0xc
    v_mov_b32_dpp v121, v137 quad_perm:[0,1,2,3] row_mask:0xf bank_mask:0xc
    v_mov_b32_dpp v124, v138 quad_perm:[0,1,2,3] row_mask:0xf bank_mask:0xc
    v_mov_b32_dpp v125, v139 quad_perm:[0,1,2,3] row_mask:0xf bank_mask:0xc
    v_mov_b32_dpp v128, v140 quad_perm:[0,1,2,3] row_mask:0xf bank_mask:0xc
    v_mov_b32_dpp v129, v141 quad_perm:[0,1,2,3] row_mask:0xf bank_mask:0xc
    v_mov_b32_dpp v132, v142 quad_perm:[0,1,2,3] row_mask:0xf bank_mask:0xc
    v_mov_b32_dpp v133, v143 quad_perm:[0,1,2,3] row_mask:0xf bank_mask:0xc
    v_perm_b32 v136, v124, v120, s44
    v_perm_b32 v137, v132, v128, s44
    v_perm_b32 v138, v126, v122, s44
    v_perm_b32 v139, v134, v130, s44
    v_perm_b32 v140, v124, v120, s45
    v_perm_b32 v141, v132, v128, s45
    v_perm_b32 v142, v126, v122, s45
    v_perm_b32 v143, v134, v130, s45
    v_perm_b32 v144, v125, v121, s44
    v_perm_b32 v145, v133, v129, s44
    v_perm_b32 v146, v127, v123, s44
    v_perm_b32 v147, v135, v131, s44
    v_perm_b32 v148, v125, v121, s45
    v_perm_b32 v149, v133, v129, s45
    v_perm_b32 v150, v127, v123, s45
    v_perm_b32 v151, v135, v131, s45
    v_mov_b32_dpp v120, v106 row_ror:8 row_mask:0xf bank_mask:0xf
    v_mov_b32_dpp v121, v107 row_ror:8 row_mask:0xf bank_mask:0xf
    v_mov_b32_dpp v122, v110 row_ror:8 row_mask:0xf bank_mask:0xf
    v_mov_b32_dpp v123, v111 row_ror:8 row_mask:0xf bank_mask:0xf
    v_mov_b32_dpp v124, v114 row_ror:8 row_mask:0xf bank_mask:0xf
    v_mov_b32_dpp v125, v115 row_ror:8 row_mask:0xf bank_mask:0xf
    v_mov_b32_dpp v126, v118 row_ror:8 row_mask:0xf bank_mask:0xf
    v_mov_b32_dpp v127, v119 row_ror:8 row_mask:0xf bank_mask:0xf
    v_mov_b32_dpp v106, v104 row_ror:8 row_mask:0xf bank_mask:0x3
    v_mov_b32_dpp v107, v105 row_ror:8 row_mask:0xf bank_mask:0x3
    v_mov_b32_dpp v110, v108 row_ror:8 row_mask:0xf bank_mask:0x3
    v_mov_b32_dpp v111, v109 row_ror:8 row_mask:0xf bank_mask:0x3
    v_mov_b32_dpp v114, v112 row_ror:8 row_mask:0xf bank_mask:0x3
    v_mov_b32_dpp v115, v113 row_ror:8 row_mask:0xf bank_mask:0x3
    v_mov_b32_dpp v118, v116 row_ror:8 row_mask:0xf bank_mask:0x3
    v_mov_b32_dpp v119, v117 row_ror:8 row_mask:0xf bank_mask:0x3
    v_mov_b32_dpp v104, v120 quad_perm:[0,1,2,3] row_mask:0xf bank_mask:0xc
    v_mov_b32_dpp v105, v121 quad_perm:[0,1,2,3] row_mask:0xf bank_mask:0xc
    v_mov_b32_dpp v108, v122 quad_perm:[0,1,2,3] row_mask:0xf bank_mask:0xc
    v_mov_b32_dpp v109, v123 quad_perm:[0,1,2,3] row_mask:0xf bank_mask:0xc
    v_mov_b32_dpp v112, v124 quad_perm:[0,1,2,3] row_mask:0xf bank_mask:0xc
    v_mov_b32_dpp v113, v125 quad_perm:[0,1,2,3] row_mask:0xf bank_mask:0xc
    v_mov_b32_dpp v116, v126 quad_perm:[0,1,2,3] row_mask:0xf bank_mask:0xc
    v_mov_b32_dpp v117, v127 quad_perm:[0,1,2,3] row_mask:0xf bank_mask:0xc
    v_perm_b32 v120, v108, v104, s44
    v_perm_b32 v121, v116, v112, s44
    v_perm_b32 v122, v110, v106, s44
    v_perm_b32 v123, v118, v114, s44
    v_perm_b32 v124, v108, v104, s45
    v_perm_b32 v125, v116, v112, s45
    v_perm_b32 v126, v110, v106, s45
    v_perm_b32 v127, v118, v114, s45
    v_perm_b32 v128, v109, v105, s44
    v_perm_b32 v129, v117, v113, s44
    v_perm_b32 v130, v111, v107, s44
    v_perm_b32 v131, v119, v115, s44
    v_perm_b32 v132, v109, v105, s45
    v_perm_b32 v133, v117, v113, s45
    v_perm_b32 v134, v111, v107, s45
    v_perm_b32 v135, v119, v115, s45
    v_mov_b32_dpp v104, v90 row_ror:8 row_mask:0xf bank_mask:0xf
    v_mov_b32_dpp v105, v91 row_ror:8 row_mask:0xf bank_mask:0xf
    v_mov_b32_dpp v106, v94 row_ror:8 row_mask:0xf bank_mask:0xf
    v_mov_b32_dpp v107, v95 row_ror:8 row_mask:0xf bank_mask:0xf
    v_mov_b32_dpp v108, v98 row_ror:8 row_mask:0xf bank_mask:0xf
    v_mov_b32_dpp v109, v99 row_ror:8 row_mask:0xf bank_mask:0xf
    v_mov_b32_dpp v110, v102 row_ror:8 row_mask:0xf bank_mask:0xf
    v_mov_b32_dpp v111, v103 row_ror:8 row_mask:0xf bank_mask:0xf
    v_mov_b32_dpp v90, v88 row_ror:8 row_mask:0xf bank_mask:0x3
    v_mov_b32_dpp v91, v89 row_ror:8 row_mask:0xf bank_mask:0x3
    v_mov_b32_dpp v94, v92 row_ror:8 row_mask:0xf bank_mask:0x3
    v_mov_b32_dpp v95, v93 row_ror:8 row_mask:0xf bank_mask:0x3
    v_mov_b32_dpp v98, v96 row_ror:8 row_mask:0xf bank_mask:0x3
    v_mov_b32_dpp v99, v97 row_ror:8 row_mask:0xf bank_mask:0x3
    v_mov_b32_dpp v102, v100 row_ror:8 row_mask:0xf bank_mask:0x3
    v_mov_b32_dpp v103, v101 row_ror:8 row_mask:0xf bank_mask:0x3
    v_mov_b32_dpp v88, v104 quad_perm:[0,1,2,3] row_mask:0xf bank_mask:0xc
    v_mov_b32_dpp v89, v105 quad_perm:[0,1,2,3] row_mask:0xf bank_mask:0xc
    v_mov_b32_dpp v92, v106 quad_perm:[0,1,2,3] row_mask:0xf bank_mask:0xc
    v_mov_b32_dpp v93, v107 quad_perm:[0,1,2,3] row_mask:0xf bank_mask:0xc
    v_mov_b32_dpp v96, v108 quad_perm:[0,1,2,3] row_mask:0xf bank_mask:0xc
    v_mov_b32_dpp v97, v109 quad_perm:[0,1,2,3] row_mask:0xf bank_mask:0xc
    v_mov_b32_dpp v100, v110 quad_perm:[0,1,2,3] row_mask:0xf bank_mask:0xc
    v_mov_b32_dpp v101, v111 quad_perm:[0,1,2,3] row_mask:0xf bank_mask:0xc
    v_perm_b32 v104, v92, v88, s44
    v_perm_b32 v105, v100, v96, s44
    v_perm_b32 v106, v94, v90, s44
    v_perm_b32 v107, v102, v98, s44
    v_perm_b32 v108, v92, v88, s45
    v_perm_b32 v109, v100, v96, s45
    v_perm_b32 v110, v94, v90, s45
    v_perm_b32 v111, v102, v98, s45
    v_perm_b32 v112, v93, v89, s44
    v_perm_b32 v113, v101, v97, s44
    v_perm_b32 v114, v95, v91, s44
    v_perm_b32 v115, v103, v99, s44
    v_perm_b32 v116, v93, v89, s45
    v_perm_b32 v117, v101, v97, s45
    v_perm_b32 v118, v95, v91, s45
    v_perm_b32 v119, v103, v99, s45
    v_mov_b32_dpp v88, v74 row_ror:8 row_mask:0xf bank_mask:0xf
    v_mov_b32_dpp v89, v75 row_ror:8 row_mask:0xf bank_mask:0xf
    v_mov_b32_dpp v90, v78 row_ror:8 row_mask:0xf bank_mask:0xf
    v_mov_b32_dpp v91, v79 row_ror:8 row_mask:0xf bank_mask:0xf
    v_mov_b32_dpp v92, v82 row_ror:8 row_mask:0xf bank_mask:0xf
    v_mov_b32_dpp v93, v83 row_ror:8 row_mask:0xf bank_mask:0xf
    v_mov_b32_dpp v94, v86 row_ror:8 row_mask:0xf bank_mask:0xf
    v_mov_b32_dpp v95, v87 row_ror:8 row_mask:0xf bank_mask:0xf
    v_mov_b32_dpp v74, v72 row_ror:8 row_mask:0xf bank_mask:0x3
    v_mov_b32_dpp v75, v73 row_ror:8 row_mask:0xf bank_mask:0x3
    v_mov_b32_dpp v78, v76 row_ror:8 row_mask:0xf bank_mask:0x3
    v_mov_b32_dpp v79, v77 row_ror:8 row_mask:0xf bank_mask:0x3
    v_mov_b32_dpp v82, v80 row_ror:8 row_mask:0xf bank_mask:0x3
    v_mov_b32_dpp v83, v81 row_ror:8 row_mask:0xf bank_mask:0x3
    v_mov_b32_dpp v86, v84 row_ror:8 row_mask:0xf bank_mask:0x3
    v_mov_b32_dpp v87, v85 row_ror:8 row_mask:0xf bank_mask:0x3
    v_mov_b32_dpp v72, v88 quad_perm:[0,1,2,3] row_mask:0xf bank_mask:0xc
    v_mov_b32_dpp v73, v89 quad_perm:[0,1,2,3] row_mask:0xf bank_mask:0xc
    v_mov_b32_dpp v76, v90 quad_perm:[0,1,2,3] row_mask:0xf bank_mask:0xc
    v_mov_b32_dpp v77, v91 quad_perm:[0,1,2,3] row_mask:0xf bank_mask:0xc
    v_mov_b32_dpp v80, v92 quad_perm:[0,1,2,3] row_mask:0xf bank_mask:0xc
    v_mov_b32_dpp v81, v93 quad_perm:[0,1,2,3] row_mask:0xf bank_mask:0xc
    v_mov_b32_dpp v84, v94 quad_perm:[0,1,2,3] row_mask:0xf bank_mask:0xc
    v_mov_b32_dpp v85, v95 quad_perm:[0,1,2,3] row_mask:0xf bank_mask:0xc
    v_perm_b32 v88, v76, v72, s44
    v_perm_b32 v89, v84, v80, s44
    v_perm_b32 v90, v78, v74, s44
    v_perm_b32 v91, v86, v82, s44
    v_perm_b32 v92, v76, v72, s45
    v_perm_b32 v93, v84, v80, s45
    v_perm_b32 v94, v78, v74, s45
    v_perm_b32 v95, v86, v82, s45
    v_perm_b32 v96, v77, v73, s44
    v_perm_b32 v97, v85, v81, s44
    v_perm_b32 v98, v79, v75, s44
    v_perm_b32 v99, v87, v83, s44
    v_perm_b32 v100, v77, v73, s45
    v_perm_b32 v101, v85, v81, s45
    v_perm_b32 v102, v79, v75, s45
    v_perm_b32 v103, v87, v83, s45
    v_mov_b32_dpp v72, v58 row_ror:8 row_mask:0xf bank_mask:0xf
    v_mov_b32_dpp v73, v59 row_ror:8 row_mask:0xf bank_mask:0xf
    v_mov_b32_dpp v74, v62 row_ror:8 row_mask:0xf bank_mask:0xf
    v_mov_b32_dpp v75, v63 row_ror:8 row_mask:0xf bank_mask:0xf
    v_mov_b32_dpp v76, v66 row_ror:8 row_mask:0xf bank_mask:0xf
    v_mov_b32_dpp v77, v67 row_ror:8 row_mask:0xf bank_mask:0xf
    v_mov_b32_dpp v78, v70 row_ror:8 row_mask:0xf bank_mask:0xf
    v_mov_b32_dpp v79, v71 row_ror:8 row_mask:0xf bank_mask:0xf
    v_mov_b32_dpp v58, v56 row_ror:8 row_mask:0xf bank_mask:0x3
    v_mov_b32_dpp v59, v57 row_ror:8 row_mask:0xf bank_mask:0x3
    v_mov_b32_dpp v62, v60 row_ror:8 row_mask:0xf bank_mask:0x3
    v_mov_b32_dpp v63, v61 row_ror:8 row_mask:0xf bank_mask:0x3
    v_mov_b32_dpp v66, v64 row_ror:8 row_mask:0xf bank_mask:0x3
    v_mov_b32_dpp v67, v65 row_ror:8 row_mask:0xf bank_mask:0x3
    v_mov_b32_dpp v70, v68 row_ror:8 row_mask:0xf bank_mask:0x3
    v_mov_b32_dpp v71, v69 row_ror:8 row_mask:0xf bank_mask:0x3
    v_mov_b32_dpp v56, v72 quad_perm:[0,1,2,3] row_mask:0xf bank_mask:0xc
    v_mov_b32_dpp v57, v73 quad_perm:[0,1,2,3] row_mask:0xf bank_mask:0xc
    v_mov_b32_dpp v60, v74 quad_perm:[0,1,2,3] row_mask:0xf bank_mask:0xc
    v_mov_b32_dpp v61, v75 quad_perm:[0,1,2,3] row_mask:0xf bank_mask:0xc
    v_mov_b32_dpp v64, v76 quad_perm:[0,1,2,3] row_mask:0xf bank_mask:0xc
    v_mov_b32_dpp v65, v77 quad_perm:[0,1,2,3] row_mask:0xf bank_mask:0xc
    v_mov_b32_dpp v68, v78 quad_perm:[0,1,2,3] row_mask:0xf bank_mask:0xc
    v_mov_b32_dpp v69, v79 quad_perm:[0,1,2,3] row_mask:0xf bank_mask:0xc
    v_perm_b32 v72, v60, v56, s44
    v_perm_b32 v73, v68, v64, s44
    v_perm_b32 v74, v62, v58, s44
    v_perm_b32 v75, v70, v66, s44
    v_perm_b32 v76, v60, v56, s45
    v_perm_b32 v77, v68, v64, s45
    v_perm_b32 v78, v62, v58, s45
    v_perm_b32 v79, v70, v66, s45
    v_perm_b32 v80, v61, v57, s44
    v_perm_b32 v81, v69, v65, s44
    v_perm_b32 v82, v63, v59, s44
    v_perm_b32 v83, v71, v67, s44
    v_perm_b32 v84, v61, v57, s45
    v_perm_b32 v85, v69, v65, s45
    v_perm_b32 v86, v63, v59, s45
    v_perm_b32 v87, v71, v67, s45
    v_mov_b32_dpp v56, v42 row_ror:8 row_mask:0xf bank_mask:0xf
    v_mov_b32_dpp v57, v43 row_ror:8 row_mask:0xf bank_mask:0xf
    v_mov_b32_dpp v58, v46 row_ror:8 row_mask:0xf bank_mask:0xf
    v_mov_b32_dpp v59, v47 row_ror:8 row_mask:0xf bank_mask:0xf
    v_mov_b32_dpp v60, v50 row_ror:8 row_mask:0xf bank_mask:0xf
    v_mov_b32_dpp v61, v51 row_ror:8 row_mask:0xf bank_mask:0xf
    v_mov_b32_dpp v62, v54 row_ror:8 row_mask:0xf bank_mask:0xf
    v_mov_b32_dpp v63, v55 row_ror:8 row_mask:0xf bank_mask:0xf
    v_mov_b32_dpp v42, v40 row_ror:8 row_mask:0xf bank_mask:0x3
    v_mov_b32_dpp v43, v41 row_ror:8 row_mask:0xf bank_mask:0x3
    v_mov_b32_dpp v46, v44 row_ror:8 row_mask:0xf bank_mask:0x3
    v_mov_b32_dpp v47, v45 row_ror:8 row_mask:0xf bank_mask:0x3
    v_mov_b32_dpp v50, v48 row_ror:8 row_mask:0xf bank_mask:0x3
    v_mov_b32_dpp v51, v49 row_ror:8 row_mask:0xf bank_mask:0x3
    v_mov_b32_dpp v54, v52 row_ror:8 row_mask:0xf bank_mask:0x3
    v_mov_b32_dpp v55, v53 row_ror:8 row_mask:0xf bank_mask:0x3
    v_mov_b32_dpp v40, v56 quad_perm:[0,1,2,3] row_mask:0xf bank_mask:0xc
    v_mov_b32_dpp v41, v57 quad_perm:[0,1,2,3] row_mask:0xf bank_mask:0xc
    v_mov_b32_dpp v44, v58 quad_perm:[0,1,2,3] row_mask:0xf bank_mask:0xc
    v_mov_b32_dpp v45, v59 quad_perm:[0,1,2,3] row_mask:0xf bank_mask:0xc
    v_mov_b32_dpp v48, v60 quad_perm:[0,1,2,3] row_mask:0xf bank_mask:0xc
    v_mov_b32_dpp v49, v61 quad_perm:[0,1,2,3] row_mask:0xf bank_mask:0xc
    v_mov_b32_dpp v52, v62 quad_perm:[0,1,2,3] row_mask:0xf bank_mask:0xc
    v_mov_b32_dpp v53, v63 quad_perm:[0,1,2,3] row_mask:0xf bank_mask:0xc
    v_perm_b32 v56, v44, v40, s44
    v_perm_b32 v57, v52, v48, s44
    v_perm_b32 v58, v46, v42, s44
    v_perm_b32 v59, v54, v50, s44
    v_perm_b32 v60, v44, v40, s45
    v_perm_b32 v61, v52, v48, s45
    v_perm_b32 v62, v46, v42, s45
    v_perm_b32 v63, v54, v50, s45
    v_perm_b32 v64, v45, v41, s44
    v_perm_b32 v65, v53, v49, s44
    v_perm_b32 v66, v47, v43, s44
    v_perm_b32 v67, v55, v51, s44
    v_perm_b32 v68, v45, v41, s45
    v_perm_b32 v69, v53, v49, s45
    v_perm_b32 v70, v47, v43, s45
    v_perm_b32 v71, v55, v51, s45
    s_waitcnt vmcnt(0)
    v_mov_b32_dpp v40, v26 row_ror:8 row_mask:0xf bank_mask:0xf
    v_mov_b32_dpp v41, v27 row_ror:8 row_mask:0xf bank_mask:0xf
    v_mov_b32_dpp v42, v30 row_ror:8 row_mask:0xf bank_mask:0xf
    v_mov_b32_dpp v43, v31 row_ror:8 row_mask:0xf bank_mask:0xf
    v_mov_b32_dpp v44, v34 row_ror:8 row_mask:0xf bank_mask:0xf
    v_mov_b32_dpp v45, v35 row_ror:8 row_mask:0xf bank_mask:0xf
    v_mov_b32_dpp v46, v38 row_ror:8 row_mask:0xf bank_mask:0xf
    v_mov_b32_dpp v47, v39 row_ror:8 row_mask:0xf bank_mask:0xf
    v_mov_b32_dpp v26, v24 row_ror:8 row_mask:0xf bank_mask:0x3
    v_mov_b32_dpp v27, v25 row_ror:8 row_mask:0xf bank_mask:0x3
    v_mov_b32_dpp v30, v28 row_ror:8 row_mask:0xf bank_mask:0x3
    v_mov_b32_dpp v31, v29 row_ror:8 row_mask:0xf bank_mask:0x3
    v_mov_b32_dpp v34, v32 row_ror:8 row_mask:0xf bank_mask:0x3
    v_mov_b32_dpp v35, v33 row_ror:8 row_mask:0xf bank_mask:0x3
    v_mov_b32_dpp v38, v36 row_ror:8 row_mask:0xf bank_mask:0x3
    v_mov_b32_dpp v39, v37 row_ror:8 row_mask:0xf bank_mask:0x3
    v_mov_b32_dpp v24, v40 quad_perm:[0,1,2,3] row_mask:0xf bank_mask:0xc
    v_mov_b32_dpp v25, v41 quad_perm:[0,1,2,3] row_mask:0xf bank_mask:0xc
    v_mov_b32_dpp v28, v42 quad_perm:[0,1,2,3] row_mask:0xf bank_mask:0xc
    v_mov_b32_dpp v29, v43 quad_perm:[0,1,2,3] row_mask:0xf bank_mask:0xc
    v_mov_b32_dpp v32, v44 quad_perm:[0,1,2,3] row_mask:0xf bank_mask:0xc
    v_mov_b32_dpp v33, v45 quad_perm:[0,1,2,3] row_mask:0xf bank_mask:0xc
    v_mov_b32_dpp v36, v46 quad_perm:[0,1,2,3] row_mask:0xf bank_mask:0xc
    v_mov_b32_dpp v37, v47 quad_perm:[0,1,2,3] row_mask:0xf bank_mask:0xc
    v_perm_b32 v40, v28, v24, s44
    v_perm_b32 v41, v36, v32, s44
    v_perm_b32 v42, v30, v26, s44
    v_perm_b32 v43, v38, v34, s44
    v_perm_b32 v44, v28, v24, s45
    v_perm_b32 v45, v36, v32, s45
    v_perm_b32 v46, v30, v26, s45
    v_perm_b32 v47, v38, v34, s45
    v_perm_b32 v48, v29, v25, s44
    v_perm_b32 v49, v37, v33, s44
    v_perm_b32 v50, v31, v27, s44
    v_perm_b32 v51, v39, v35, s44
    v_perm_b32 v52, v29, v25, s45
    v_perm_b32 v53, v37, v33, s45
    v_perm_b32 v54, v31, v27, s45
    v_perm_b32 v55, v39, v35, s45
    v_lshrrev_b32 v1, 4, v3
    v_lshlrev_b32 v1, 11, v1
    v_and_b32 v4, 7, v3
    v_lshl_add_u32 v1, v4, 4, v1
    v_bfe_u32 v4, v3, 3, 1
    v_lshl_add_u32 v1, v4, 9, v1
    v_and_b32 v4, 3, v3
    v_lshrrev_b32 v5, 2, v3
    v_mul_u32_u24 v0, 576, v4
    v_lshl_add_u32 v0, v5, 3, v0
    v_add_u32 v0, 40960, v0
    s_lshl_b32 s38, s41, 11
    s_lshl_b32 s53, s17, 7
    s_add_u32 s38, s38, s53
    s_mov_b32 s36, 0x24924924
    s_mov_b32 s39, 0
    s_mov_b32 s46, 0
    s_mov_b64 vcc, -1
    s_waitcnt vmcnt(0)
gm_poll:
    v_mov_b32 v2, 0
    ds_read_b32 v2, v2 offset:276
    s_waitcnt lgkmcnt(0)
    v_readfirstlane_b32 s52, v2
    s_and_b32 s52, s52, s36
    s_cbranch_scc1 gm_go
    s_sleep 2
    s_branch gm_poll
gm_go:
    s_ff1_i32_b32 s52, s52
    s_bitset0_b32 s36, s52
    s_mul_i32 s52, s52, 11
    s_bfe_u32 s53, s52, 0x10005
    s_bfe_u32 s52, s52, 0x30006
    s_mul_i32 s35, s53, 61440
    s_mul_i32 s31, s52, 2304
    s_add_u32 s31, s31, s35
    s_sub_u32 s35, s31, s39
    v_add_u32 v0, s35, v0
    ds_read_b64_tr_b16 v[12:13], v0 offset:0
    ds_read_b64_tr_b16 v[14:15], v0 offset:128
    ds_read_b64_tr_b16 v[16:17], v0 offset:256
    ds_read_b64_tr_b16 v[18:19], v0 offset:384
    s_mov_b32 s39, s31
    s_mul_i32 s33, s53, 5
    s_add_u32 s33, s33, s52
    s_lshl_b32 s33, s33, 13
    s_add_u32 s33, s33, s38
    s_mov_b32 s37, s33
    s_mov_b32 s32, 0x7ffffff0
gm_loop:
    s_waitcnt lgkmcnt(2)
    v_mfma_f32_16x16x32_bf16 v[24:27], v[12:15], v[40:43], 0
    s_setprio 3
    v_cvt_pk_bf16_f32 v7, v33, v37
    v_cvt_pk_bf16_f32 v5, v32, v36
    ds_read_b64_tr_b16 v[20:21], v0 offset:15360
    s_setprio 0
    v_mfma_f32_16x16x32_bf16 v[28:31], v[12:15], v[44:47], 0
    s_setprio 3
    v_cvt_pk_bf16_f32 v11, v35, v39
    v_cvt_pk_bf16_f32 v9, v34, v38
    ds_read_b64_tr_b16 v[22:23], v0 offset:15488
    s_setprio 0
    v_mfma_f32_16x16x32_bf16 v[32:35], v[12:15], v[48:51], 0
    s_setprio 3
    v_mov_b32_dpp v2, v6 row_ror:8 row_mask:0xf bank_mask:0xf
    v_mov_b32_dpp v3, v7 row_ror:8 row_mask:0xf bank_mask:0xf
    s_setprio 0
    v_mfma_f32_16x16x32_bf16 v[36:39], v[12:15], v[52:55], 0
    s_setprio 3
    v_mov_b32_dpp v6, v4 row_ror:8 row_mask:0xf bank_mask:0x3
    v_mov_b32_dpp v7, v5 row_ror:8 row_mask:0xf bank_mask:0x3
    s_setprio 0
    s_waitcnt lgkmcnt(2)
    v_mfma_f32_16x16x32_bf16 v[24:27], v[16:19], v[56:59], v[24:27]
    s_setprio 3
    ds_read_b64_tr_b16 v[12:13], v0 offset:15616
    v_mov_b32_dpp v4, v2 quad_perm:[0,1,2,3] row_mask:0xf bank_mask:0xc
    s_setprio 0
    v_mfma_f32_16x16x32_bf16 v[28:31], v[16:19], v[60:63], v[28:31]
    s_setprio 3
    ds_read_b64_tr_b16 v[14:15], v0 offset:15744
    v_mov_b32_dpp v5, v3 quad_perm:[0,1,2,3] row_mask:0xf bank_mask:0xc
    s_setprio 0
    v_mfma_f32_16x16x32_bf16 v[32:35], v[16:19], v[64:67], v[32:35]
    s_setprio 3
    buffer_store_dwordx4 v[4:7], v1, s[12:15], s32 offen offset:0 sc0 sc1
    v_mov_b32_dpp v2, v10 row_ror:8 row_mask:0xf bank_mask:0xf
    s_setprio 0
    v_mfma_f32_16x16x32_bf16 v[36:39], v[16:19], v[68:71], v[36:39]
    s_setprio 3
    v_mov_b32_dpp v3, v11 row_ror:8 row_mask:0xf bank_mask:0xf
    v_mov_b32_dpp v10, v8 row_ror:8 row_mask:0xf bank_mask:0x3
    s_setprio 0
    s_waitcnt lgkmcnt(2)
    v_mfma_f32_16x16x32_bf16 v[24:27], v[20:23], v[72:75], v[24:27]
    s_setprio 3
    ds_read_b64_tr_b16 v[16:17], v0 offset:30720
    v_mov_b32_dpp v11, v9 row_ror:8 row_mask:0xf bank_mask:0x3
    s_setprio 0
    v_mfma_f32_16x16x32_bf16 v[28:31], v[20:23], v[76:79], v[28:31]
    s_setprio 3
    ds_read_b64_tr_b16 v[18:19], v0 offset:30848
    v_mov_b32_dpp v8, v2 quad_perm:[0,1,2,3] row_mask:0xf bank_mask:0xc
    s_setprio 0
    v_mfma_f32_16x16x32_bf16 v[32:35], v[20:23], v[80:83], v[32:35]
    s_setprio 3
    v_mov_b32_dpp v9, v3 quad_perm:[0,1,2,3] row_mask:0xf bank_mask:0xc
    buffer_store_dwordx4 v[8:11], v1, s[12:15], s32 offen offset:1024 sc0 sc1
    s_setprio 0
    v_mfma_f32_16x16x32_bf16 v[36:39], v[20:23], v[84:87], v[36:39]
    s_waitcnt lgkmcnt(2)
    v_mfma_f32_16x16x32_bf16 v[24:27], v[12:15], v[88:91], v[24:27]
    ds_read_b64_tr_b16 v[20:21], v0 offset:30976
    v_mfma_f32_16x16x32_bf16 v[28:31], v[12:15], v[92:95], v[28:31]
    ds_read_b64_tr_b16 v[22:23], v0 offset:31104
    v_mfma_f32_16x16x32_bf16 v[32:35], v[12:15], v[96:99], v[32:35]
    s_setprio 3
    v_mov_b32 v2, 0
    s_setprio 0
    v_mfma_f32_16x16x32_bf16 v[36:39], v[12:15], v[100:103], v[36:39]
    ds_read_b32 v2, v2 offset:276
    s_waitcnt lgkmcnt(3)
    v_mfma_f32_16x16x32_bf16 v[24:27], v[16:19], v[104:107], v[24:27]
    ds_read_b64_tr_b16 v[12:13], v0 offset:46080
    v_mfma_f32_16x16x32_bf16 v[28:31], v[16:19], v[108:111], v[28:31]
    ds_read_b64_tr_b16 v[14:15], v0 offset:46208
    v_mfma_f32_16x16x32_bf16 v[32:35], v[16:19], v[112:115], v[32:35]
    s_setprio 3
    s_waitcnt lgkmcnt(2)
    v_readfirstlane_b32 s52, v2
    s_and_b32 s52, s52, s36
    s_setprio 0
    v_mfma_f32_16x16x32_bf16 v[36:39], v[16:19], v[116:119], v[36:39]
    s_cselect_b32 s34, 1, 0
    s_ff1_i32_b32 s52, s52
    s_waitcnt lgkmcnt(2)
    v_mfma_f32_16x16x32_bf16 v[24:27], v[20:23], v[120:123], v[24:27]
    ds_read_b64_tr_b16 v[16:17], v0 offset:46336
    s_bitset0_b32 s36, s52
    s_mul_i32 s52, s52, 11
    v_mfma_f32_16x16x32_bf16 v[28:31], v[20:23], v[124:127], v[28:31]
    ds_read_b64_tr_b16 v[18:19], v0 offset:46464
    s_bfe_u32 s53, s52, 0x10005
    s_bfe_u32 s52, s52, 0x30006
    v_mfma_f32_16x16x32_bf16 v[32:35], v[20:23], v[128:131], v[32:35]
    s_mul_i32 s35, s53, 61440
    s_mul_i32 s31, s52, 2304
    s_add_u32 s31, s31, s35
    v_mfma_f32_16x16x32_bf16 v[36:39], v[20:23], v[132:135], v[36:39]
    s_setprio 3
    s_sub_u32 s35, s31, s39
    v_add_u32 v0, s35, v0
    s_setprio 0
    s_waitcnt lgkmcnt(2)
    v_mfma_f32_16x16x32_bf16 v[24:27], v[12:15], v[136:139], v[24:27]
    ds_read_b64_tr_b16 v[20:21], v0 offset:0
    v_mfma_f32_16x16x32_bf16 v[28:31], v[12:15], v[140:143], v[28:31]
    ds_read_b64_tr_b16 v[22:23], v0 offset:128
    v_mfma_f32_16x16x32_bf16 v[32:35], v[12:15], v[144:147], v[32:35]
    s_mov_b32 s39, s31
    s_mul_i32 s33, s53, 5
    s_add_u32 s33, s33, s52
    v_mfma_f32_16x16x32_bf16 v[36:39], v[12:15], v[148:151], v[36:39]
    s_lshl_b32 s33, s33, 13
    s_add_u32 s33, s33, s38
    s_waitcnt lgkmcnt(2)
    v_mfma_f32_16x16x32_bf16 v[24:27], v[16:19], v[152:155], v[24:27]
    ds_read_b64_tr_b16 v[12:13], v0 offset:256
    v_mfma_f32_16x16x32_bf16 v[28:31], v[16:19], v[156:159], v[28:31]
    ds_read_b64_tr_b16 v[14:15], v0 offset:384
    s_mov_b32 s32, s37
    s_mov_b32 s37, s33
    v_mfma_f32_16x16x32_bf16 v[32:35], v[16:19], v[160:163], v[32:35]
    s_cmp_eq_u32 s34, 0
    s_nop 1
    v_mfma_f32_16x16x32_bf16 v[36:39], v[16:19], v[164:167], v[36:39]
    s_setprio 3
    v_cvt_pk_bf16_f32 v4, v24, v28
    v_cvt_pk_bf16_f32 v6, v25, v29
    v_cvt_pk_bf16_f32 v8, v26, v30
    v_cvt_pk_bf16_f32 v10, v27, v31
    s_setprio 0
    s_cbranch_scc1 gm_drain
    s_waitcnt lgkmcnt(2)
    v_mfma_f32_16x16x32_bf16 v[24:27], v[20:23], v[40:43], 0
    s_setprio 3
    v_cvt_pk_bf16_f32 v7, v33, v37
    v_cvt_pk_bf16_f32 v5, v32, v36
    ds_read_b64_tr_b16 v[16:17], v0 offset:15360
    s_setprio 0
    v_mfma_f32_16x16x32_bf16 v[28:31], v[20:23], v[44:47], 0
    s_setprio 3
    v_cvt_pk_bf16_f32 v11, v35, v39
    v_cvt_pk_bf16_f32 v9, v34, v38
    ds_read_b64_tr_b16 v[18:19], v0 offset:15488
    s_setprio 0
    v_mfma_f32_16x16x32_bf16 v[32:35], v[20:23], v[48:51], 0
    s_setprio 3
    v_mov_b32_dpp v2, v6 row_ror:8 row_mask:0xf bank_mask:0xf
    v_mov_b32_dpp v3, v7 row_ror:8 row_mask:0xf bank_mask:0xf
    s_setprio 0
    v_mfma_f32_16x16x32_bf16 v[36:39], v[20:23], v[52:55], 0
    s_setprio 3
    v_mov_b32_dpp v6, v4 row_ror:8 row_mask:0xf bank_mask:0x3
    v_mov_b32_dpp v7, v5 row_ror:8 row_mask:0xf bank_mask:0x3
    s_setprio 0
    s_waitcnt lgkmcnt(2)
    v_mfma_f32_16x16x32_bf16 v[24:27], v[12:15], v[56:59], v[24:27]
    s_setprio 3
    ds_read_b64_tr_b16 v[20:21], v0 offset:15616
    v_mov_b32_dpp v4, v2 quad_perm:[0,1,2,3] row_mask:0xf bank_mask:0xc
    s_setprio 0
    v_mfma_f32_16x16x32_bf16 v[28:31], v[12:15], v[60:63], v[28:31]
    s_setprio 3
    ds_read_b64_tr_b16 v[22:23], v0 offset:15744
    v_mov_b32_dpp v5, v3 quad_perm:[0,1,2,3] row_mask:0xf bank_mask:0xc
    s_setprio 0
    v_mfma_f32_16x16x32_bf16 v[32:35], v[12:15], v[64:67], v[32:35]
    s_setprio 3
    buffer_store_dwordx4 v[4:7], v1, s[12:15], s32 offen offset:0 sc0 sc1
    v_mov_b32_dpp v2, v10 row_ror:8 row_mask:0xf bank_mask:0xf
    s_setprio 0
    v_mfma_f32_16x16x32_bf16 v[36:39], v[12:15], v[68:71], v[36:39]
    s_setprio 3
    v_mov_b32_dpp v3, v11 row_ror:8 row_mask:0xf bank_mask:0xf
    v_mov_b32_dpp v10, v8 row_ror:8 row_mask:0xf bank_mask:0x3
    s_setprio 0
    s_waitcnt lgkmcnt(2)
    v_mfma_f32_16x16x32_bf16 v[24:27], v[16:19], v[72:75], v[24:27]
    s_setprio 3
    ds_read_b64_tr_b16 v[12:13], v0 offset:30720
    v_mov_b32_dpp v11, v9 row_ror:8 row_mask:0xf bank_mask:0x3
    s_setprio 0
    v_mfma_f32_16x16x32_bf16 v[28:31], v[16:19], v[76:79], v[28:31]
    s_setprio 3
    ds_read_b64_tr_b16 v[14:15], v0 offset:30848
    v_mov_b32_dpp v8, v2 quad_perm:[0,1,2,3] row_mask:0xf bank_mask:0xc
    s_setprio 0
    v_mfma_f32_16x16x32_bf16 v[32:35], v[16:19], v[80:83], v[32:35]
    s_setprio 3
    v_mov_b32_dpp v9, v3 quad_perm:[0,1,2,3] row_mask:0xf bank_mask:0xc
    buffer_store_dwordx4 v[8:11], v1, s[12:15], s32 offen offset:1024 sc0 sc1
    s_setprio 0
    v_mfma_f32_16x16x32_bf16 v[36:39], v[16:19], v[84:87], v[36:39]
    s_waitcnt lgkmcnt(2)
    v_mfma_f32_16x16x32_bf16 v[24:27], v[20:23], v[88:91], v[24:27]
    ds_read_b64_tr_b16 v[16:17], v0 offset:30976
    v_mfma_f32_16x16x32_bf16 v[28:31], v[20:23], v[92:95], v[28:31]
    ds_read_b64_tr_b16 v[18:19], v0 offset:31104
    v_mfma_f32_16x16x32_bf16 v[32:35], v[20:23], v[96:99], v[32:35]
    s_setprio 3
    v_mov_b32 v2, 0
    s_setprio 0
    v_mfma_f32_16x16x32_bf16 v[36:39], v[20:23], v[100:103], v[36:39]
    ds_read_b32 v2, v2 offset:276
    s_waitcnt lgkmcnt(3)
    v_mfma_f32_16x16x32_bf16 v[24:27], v[12:15], v[104:107], v[24:27]
    ds_read_b64_tr_b16 v[20:21], v0 offset:46080
    v_mfma_f32_16x16x32_bf16 v[28:31], v[12:15], v[108:111], v[28:31]
    ds_read_b64_tr_b16 v[22:23], v0 offset:46208
    v_mfma_f32_16x16x32_bf16 v[32:35], v[12:15], v[112:115], v[32:35]
    s_setprio 3
    s_waitcnt lgkmcnt(2)
    v_readfirstlane_b32 s52, v2
    s_and_b32 s52, s52, s36
    s_setprio 0
    v_mfma_f32_16x16x32_bf16 v[36:39], v[12:15], v[116:119], v[36:39]
    s_cselect_b32 s34, 1, 0
    s_ff1_i32_b32 s52, s52
    s_waitcnt lgkmcnt(2)
    v_mfma_f32_16x16x32_bf16 v[24:27], v[16:19], v[120:123], v[24:27]
    ds_read_b64_tr_b16 v[12:13], v0 offset:46336
    s_bitset0_b32 s36, s52
    s_mul_i32 s52, s52, 11
    v_mfma_f32_16x16x32_bf16 v[28:31], v[16:19], v[124:127], v[28:31]
    ds_read_b64_tr_b16 v[14:15], v0 offset:46464
    s_bfe_u32 s53, s52, 0x10005
    s_bfe_u32 s52, s52, 0x30006
    v_mfma_f32_16x16x32_bf16 v[32:35], v[16:19], v[128:131], v[32:35]
    s_mul_i32 s35, s53, 61440
    s_mul_i32 s31, s52, 2304
    s_add_u32 s31, s31, s35
    v_mfma_f32_16x16x32_bf16 v[36:39], v[16:19], v[132:135], v[36:39]
    s_setprio 3
    s_sub_u32 s35, s31, s39
    v_add_u32 v0, s35, v0
    s_setprio 0
    s_waitcnt lgkmcnt(2)
    v_mfma_f32_16x16x32_bf16 v[24:27], v[20:23], v[136:139], v[24:27]
    ds_read_b64_tr_b16 v[16:17], v0 offset:0
    v_mfma_f32_16x16x32_bf16 v[28:31], v[20:23], v[140:143], v[28:31]
    ds_read_b64_tr_b16 v[18:19], v0 offset:128
    v_mfma_f32_16x16x32_bf16 v[32:35], v[20:23], v[144:147], v[32:35]
    s_mov_b32 s39, s31
    s_mul_i32 s33, s53, 5
    s_add_u32 s33, s33, s52
    v_mfma_f32_16x16x32_bf16 v[36:39], v[20:23], v[148:151], v[36:39]
    s_lshl_b32 s33, s33, 13
    s_add_u32 s33, s33, s38
    s_waitcnt lgkmcnt(2)
    v_mfma_f32_16x16x32_bf16 v[24:27], v[12:15], v[152:155], v[24:27]
    ds_read_b64_tr_b16 v[20:21], v0 offset:256
    v_mfma_f32_16x16x32_bf16 v[28:31], v[12:15], v[156:159], v[28:31]
    ds_read_b64_tr_b16 v[22:23], v0 offset:384
    s_mov_b32 s32, s37
    s_mov_b32 s37, s33
    v_mfma_f32_16x16x32_bf16 v[32:35], v[12:15], v[160:163], v[32:35]
    s_cmp_eq_u32 s34, 0
    s_nop 1
    v_mfma_f32_16x16x32_bf16 v[36:39], v[12:15], v[164:167], v[36:39]
    s_setprio 3
    v_cvt_pk_bf16_f32 v4, v24, v28
    v_cvt_pk_bf16_f32 v6, v25, v29
    v_cvt_pk_bf16_f32 v8, v26, v30
    v_cvt_pk_bf16_f32 v10, v27, v31
    s_setprio 0
    s_cbranch_scc1 gm_drain
    s_waitcnt lgkmcnt(2)
    v_mfma_f32_16x16x32_bf16 v[24:27], v[16:19], v[40:43], 0
    s_setprio 3
    v_cvt_pk_bf16_f32 v7, v33, v37
    v_cvt_pk_bf16_f32 v5, v32, v36
    ds_read_b64_tr_b16 v[12:13], v0 offset:15360
    s_setprio 0
    v_mfma_f32_16x16x32_bf16 v[28:31], v[16:19], v[44:47], 0
    s_setprio 3
    v_cvt_pk_bf16_f32 v11, v35, v39
    v_cvt_pk_bf16_f32 v9, v34, v38
    ds_read_b64_tr_b16 v[14:15], v0 offset:15488
    s_setprio 0
    v_mfma_f32_16x16x32_bf16 v[32:35], v[16:19], v[48:51], 0
    s_setprio 3
    v_mov_b32_dpp v2, v6 row_ror:8 row_mask:0xf bank_mask:0xf
    v_mov_b32_dpp v3, v7 row_ror:8 row_mask:0xf bank_mask:0xf
    s_setprio 0
    v_mfma_f32_16x16x32_bf16 v[36:39], v[16:19], v[52:55], 0
    s_setprio 3
    v_mov_b32_dpp v6, v4 row_ror:8 row_mask:0xf bank_mask:0x3
    v_mov_b32_dpp v7, v5 row_ror:8 row_mask:0xf bank_mask:0x3
    s_setprio 0
    s_waitcnt lgkmcnt(2)
    v_mfma_f32_16x16x32_bf16 v[24:27], v[20:23], v[56:59], v[24:27]
    s_setprio 3
    ds_read_b64_tr_b16 v[16:17], v0 offset:15616
    v_mov_b32_dpp v4, v2 quad_perm:[0,1,2,3] row_mask:0xf bank_mask:0xc
    s_setprio 0
    v_mfma_f32_16x16x32_bf16 v[28:31], v[20:23], v[60:63], v[28:31]
    s_setprio 3
    ds_read_b64_tr_b16 v[18:19], v0 offset:15744
    v_mov_b32_dpp v5, v3 quad_perm:[0,1,2,3] row_mask:0xf bank_mask:0xc
    s_setprio 0
    v_mfma_f32_16x16x32_bf16 v[32:35], v[20:23], v[64:67], v[32:35]
    s_setprio 3
    buffer_store_dwordx4 v[4:7], v1, s[12:15], s32 offen offset:0 sc0 sc1
    v_mov_b32_dpp v2, v10 row_ror:8 row_mask:0xf bank_mask:0xf
    s_setprio 0
    v_mfma_f32_16x16x32_bf16 v[36:39], v[20:23], v[68:71], v[36:39]
    s_setprio 3
    v_mov_b32_dpp v3, v11 row_ror:8 row_mask:0xf bank_mask:0xf
    v_mov_b32_dpp v10, v8 row_ror:8 row_mask:0xf bank_mask:0x3
    s_setprio 0
    s_waitcnt lgkmcnt(2)
    v_mfma_f32_16x16x32_bf16 v[24:27], v[12:15], v[72:75], v[24:27]
    s_setprio 3
    ds_read_b64_tr_b16 v[20:21], v0 offset:30720
    v_mov_b32_dpp v11, v9 row_ror:8 row_mask:0xf bank_mask:0x3
    s_setprio 0
    v_mfma_f32_16x16x32_bf16 v[28:31], v[12:15], v[76:79], v[28:31]
    s_setprio 3
    ds_read_b64_tr_b16 v[22:23], v0 offset:30848
    v_mov_b32_dpp v8, v2 quad_perm:[0,1,2,3] row_mask:0xf bank_mask:0xc
    s_setprio 0
    v_mfma_f32_16x16x32_bf16 v[32:35], v[12:15], v[80:83], v[32:35]
    s_setprio 3
    v_mov_b32_dpp v9, v3 quad_perm:[0,1,2,3] row_mask:0xf bank_mask:0xc
    buffer_store_dwordx4 v[8:11], v1, s[12:15], s32 offen offset:1024 sc0 sc1
    s_setprio 0
    v_mfma_f32_16x16x32_bf16 v[36:39], v[12:15], v[84:87], v[36:39]
    s_waitcnt lgkmcnt(2)
    v_mfma_f32_16x16x32_bf16 v[24:27], v[16:19], v[88:91], v[24:27]
    ds_read_b64_tr_b16 v[12:13], v0 offset:30976
    v_mfma_f32_16x16x32_bf16 v[28:31], v[16:19], v[92:95], v[28:31]
    ds_read_b64_tr_b16 v[14:15], v0 offset:31104
    v_mfma_f32_16x16x32_bf16 v[32:35], v[16:19], v[96:99], v[32:35]
    s_setprio 3
    v_mov_b32 v2, 0
    s_setprio 0
    v_mfma_f32_16x16x32_bf16 v[36:39], v[16:19], v[100:103], v[36:39]
    ds_read_b32 v2, v2 offset:276
    s_waitcnt lgkmcnt(3)
    v_mfma_f32_16x16x32_bf16 v[24:27], v[20:23], v[104:107], v[24:27]
    ds_read_b64_tr_b16 v[16:17], v0 offset:46080
    v_mfma_f32_16x16x32_bf16 v[28:31], v[20:23], v[108:111], v[28:31]
    ds_read_b64_tr_b16 v[18:19], v0 offset:46208
    v_mfma_f32_16x16x32_bf16 v[32:35], v[20:23], v[112:115], v[32:35]
    s_setprio 3
    s_waitcnt lgkmcnt(2)
    v_readfirstlane_b32 s52, v2
    s_and_b32 s52, s52, s36
    s_setprio 0
    v_mfma_f32_16x16x32_bf16 v[36:39], v[20:23], v[116:119], v[36:39]
    s_cselect_b32 s34, 1, 0
    s_ff1_i32_b32 s52, s52
    s_waitcnt lgkmcnt(2)
    v_mfma_f32_16x16x32_bf16 v[24:27], v[12:15], v[120:123], v[24:27]
    ds_read_b64_tr_b16 v[20:21], v0 offset:46336
    s_bitset0_b32 s36, s52
    s_mul_i32 s52, s52, 11
    v_mfma_f32_16x16x32_bf16 v[28:31], v[12:15], v[124:127], v[28:31]
    ds_read_b64_tr_b16 v[22:23], v0 offset:46464
    s_bfe_u32 s53, s52, 0x10005
    s_bfe_u32 s52, s52, 0x30006
    v_mfma_f32_16x16x32_bf16 v[32:35], v[12:15], v[128:131], v[32:35]
    s_mul_i32 s35, s53, 61440
    s_mul_i32 s31, s52, 2304
    s_add_u32 s31, s31, s35
    v_mfma_f32_16x16x32_bf16 v[36:39], v[12:15], v[132:135], v[36:39]
    s_setprio 3
    s_sub_u32 s35, s31, s39
    v_add_u32 v0, s35, v0
    s_setprio 0
    s_waitcnt lgkmcnt(2)
    v_mfma_f32_16x16x32_bf16 v[24:27], v[16:19], v[136:139], v[24:27]
    ds_read_b64_tr_b16 v[12:13], v0 offset:0
    v_mfma_f32_16x16x32_bf16 v[28:31], v[16:19], v[140:143], v[28:31]
    ds_read_b64_tr_b16 v[14:15], v0 offset:128
    v_mfma_f32_16x16x32_bf16 v[32:35], v[16:19], v[144:147], v[32:35]
    s_mov_b32 s39, s31
    s_mul_i32 s33, s53, 5
    s_add_u32 s33, s33, s52
    v_mfma_f32_16x16x32_bf16 v[36:39], v[16:19], v[148:151], v[36:39]
    s_lshl_b32 s33, s33, 13
    s_add_u32 s33, s33, s38
    s_waitcnt lgkmcnt(2)
    v_mfma_f32_16x16x32_bf16 v[24:27], v[20:23], v[152:155], v[24:27]
    ds_read_b64_tr_b16 v[16:17], v0 offset:256
    v_mfma_f32_16x16x32_bf16 v[28:31], v[20:23], v[156:159], v[28:31]
    ds_read_b64_tr_b16 v[18:19], v0 offset:384
    s_mov_b32 s32, s37
    s_mov_b32 s37, s33
    v_mfma_f32_16x16x32_bf16 v[32:35], v[20:23], v[160:163], v[32:35]
    s_cmp_eq_u32 s34, 0
    s_nop 1
    v_mfma_f32_16x16x32_bf16 v[36:39], v[20:23], v[164:167], v[36:39]
    s_setprio 3
    v_cvt_pk_bf16_f32 v4, v24, v28
    v_cvt_pk_bf16_f32 v6, v25, v29
    v_cvt_pk_bf16_f32 v8, v26, v30
    v_cvt_pk_bf16_f32 v10, v27, v31
    s_setprio 0
    s_cbranch_scc0 gm_loop
gm_drain:
    s_nop 2
    s_setprio 3
    v_cvt_pk_bf16_f32 v7, v33, v37
    v_cvt_pk_bf16_f32 v5, v32, v36
    v_cvt_pk_bf16_f32 v11, v35, v39
    v_cvt_pk_bf16_f32 v9, v34, v38
    v_mov_b32_dpp v2, v6 row_ror:8 row_mask:0xf bank_mask:0xf
    v_mov_b32_dpp v3, v7 row_ror:8 row_mask:0xf bank_mask:0xf
    v_mov_b32_dpp v6, v4 row_ror:8 row_mask:0xf bank_mask:0x3
    v_mov_b32_dpp v7, v5 row_ror:8 row_mask:0xf bank_mask:0x3
    v_mov_b32_dpp v4, v2 quad_perm:[0,1,2,3] row_mask:0xf bank_mask:0xc
    v_mov_b32_dpp v5, v3 quad_perm:[0,1,2,3] row_mask:0xf bank_mask:0xc
    buffer_store_dwordx4 v[4:7], v1, s[12:15], s32 offen offset:0 sc0 sc1
    v_mov_b32_dpp v2, v10 row_ror:8 row_mask:0xf bank_mask:0xf
    v_mov_b32_dpp v3, v11 row_ror:8 row_mask:0xf bank_mask:0xf
    v_mov_b32_dpp v10, v8 row_ror:8 row_mask:0xf bank_mask:0x3
    v_mov_b32_dpp v11, v9 row_ror:8 row_mask:0xf bank_mask:0x3
    v_mov_b32_dpp v8, v2 quad_perm:[0,1,2,3] row_mask:0xf bank_mask:0xc
    v_mov_b32_dpp v9, v3 quad_perm:[0,1,2,3] row_mask:0xf bank_mask:0xc
    buffer_store_dwordx4 v[8:11], v1, s[12:15], s32 offen offset:1024 sc0 sc1
    s_setprio 0
    s_cmp_lg_u32 s36, 0
    s_cbranch_scc1 gm_poll
    s_endpgm
mn_sp1:
    v_mov_b32 v55, 0
    ds_read_b32 v55, v55 offset:308
    s_waitcnt lgkmcnt(0)
    v_readfirstlane_b32 s62, v55
    s_cmp_ge_u32 s62, 1
    s_cbranch_scc1 mn_sp1x
    s_sleep 1
    s_branch mn_sp1
gm_wait2:
    v_mov_b32 v15, 0
    ds_read_b32 v17, v15 offset:304
    s_waitcnt lgkmcnt(0)
    v_readfirstlane_b32 s62, v17
    s_cmp_lg_u32 s62, 0
    s_cbranch_scc1 gm_go2
    s_sleep 1
    s_branch gm_wait2
gm_ovf:
    s_movk_i32 s20, 4
    s_barrier
    s_barrier
    s_branch gm_pass
gm_next:
    s_add_u32 s24, s24, s20
    s_barrier
    s_branch gm_pass
mn_w5:
    s_and_b32 s62, s2, 15
    s_lshl_b32 s62, s62, 7
    s_add_u32 s62, s62, 11730944
    v_mov_b32 v55, s62
    v_lshlrev_b32 v56, 6, v0
    v_and_b32 v56, 0xc0, v56
    s_mov_b32 s63, 0x100000
mn_poll2dm:
    s_sub_u32 s63, s63, 1
    s_cbranch_scc1 mn_poll2dx
    global_load_dword v57, v56, s[60:61] sc1
    s_waitcnt vmcnt(0)
    v_add_u32_dpp v57, v57, v57 quad_perm:[2,3,0,1] row_mask:0xf bank_mask:0xf
    s_sleep 8
    v_readlane_b32 s62, v57, 1
    s_cmp_lt_u32 s62, 125
    s_cbranch_scc1 mn_poll2dm
mn_poll2dx:
    v_add_u32 v55, 12, v35
    v_add_u32 v55, s24, v55
    v_lshrrev_b32 v56, 16, v58
    v_mov_b32 v23, 0
    v_cmpx_lt_u32 vcc, v55, v56
    s_cbranch_execz mn_g0
    v_cmp_gt_u32 vcc, 15, v55
    v_and_b32 v56, 0xffff, v58
    v_add_lshl_u32 v56, v55, v56, 2
    v_add_u32 v56, v56, v46
    v_add_u32 v57, s22, v44
    v_and_or_b32 v57, v55, 12, v57
    v_cndmask_b32 v56, v56, v57, vcc
    buffer_load_dword v23, v56, s[8:11], 0 offen sc1
    s_waitcnt vmcnt(0)
mn_g0:
    s_mov_b64 exec, -1
    v_add_u32 v55, 16, v35
    v_add_u32 v55, s24, v55
    v_lshrrev_b32 v56, 16, v58
    v_mov_b32 v24, 0
    v_cmpx_lt_u32 vcc, v55, v56
    s_cbranch_execz mn_g1
    v_cmp_gt_u32 vcc, 15, v55
    v_and_b32 v56, 0xffff, v58
    v_add_lshl_u32 v56, v55, v56, 2
    v_add_u32 v56, v56, v46
    v_add_u32 v57, s22, v44
    v_and_or_b32 v57, v55, 12, v57
    v_cndmask_b32 v56, v56, v57, vcc
    buffer_load_dword v24, v56, s[8:11], 0 offen sc1
    s_waitcnt vmcnt(0)
mn_g1:
    s_mov_b64 exec, -1
mn_more:
    s_add_u32 s52, s24, s20
    v_lshrrev_b32 v56, 16, v58
    v_cmp_lt_u32 vcc, s52, v56
    s_cbranch_vccz mn_count
    v_mov_b32 v55, 272
    ds_write_b32 v55, v48
    s_branch mn_count
mn_ovf:
    s_movk_i32 s20, 4
    s_waitcnt vmcnt(0) lgkmcnt(0)
    s_barrier
    s_branch mn_again
mn_next:
    s_set_gpr_idx_off
    s_waitcnt vmcnt(0) lgkmcnt(0)
    s_nop 7
    s_add_u32 s24, s24, s20
    v_mbcnt_lo_u32_b32 v0, -1, 0
    v_mbcnt_hi_u32_b32 v0, -1, v0
    v_lshl_add_u32 v0, s16, 6, v0
    v_lshrrev_b32 v56, 6, v0
    v_lshlrev_b32 v55, 1, v0
    v_and_b32 v55, 0x78, v55
    v_or_b32 v55, v55, v56
    v_cmp_gt_u32 vcc, 125, v55
    v_mul_u32_u24 v46, 5120, v55
    v_add_u32 v46, 7340032, v46
    v_bfrev_b32 v56, 2
    v_lshrrev_b32 v44, 2, v0
    v_lshlrev_b32 v44, 10, v44
    v_and_b32 v57, 3, v0
    v_lshl_or_b32 v44, v57, 4, v44
    v_cndmask_b32 v44, v56, v44, vcc
    v_and_b32 v51, 63, v0
    buffer_load_dwordx4 v[20:23], v44, s[8:11], s22 offen sc1
    v_mov_b32 v48, 1
    v_lshlrev_b32 v47, 2, v51
    v_bfe_u32 v2, v0, 5, 1
    v_bfe_u32 v3, v0, 3, 2
    v_and_b32 v35, 3, v0
    v_lshl_add_u32 v3, v3, 2, v35
    v_mul_u32_u24 v49, 20, v2
    v_lshrrev_b32 v18, 2, v51
    v_lshl_add_u32 v18, v35, 4, v18
    v_mov_b32 v50, 0x3fff
    s_lshl_b32 s37, s16, 2
    v_mov_b32 v59, s37
    s_sub_u32 s36, s16, 1
    s_waitcnt vmcnt(0)
    v_mov_b32_dpp v58, v23 quad_perm:[3,3,3,3] row_mask:0xf bank_mask:0xf
mn_again:
    v_mov_b32 v55, 0
    ds_write_b32 v47, v55 offset:0
    ds_write_b32 v47, v55 offset:128
    s_waitcnt vmcnt(0) lgkmcnt(0)
    s_barrier
    v_add_u32 v55, 0, v35
    v_add_u32 v55, s24, v55
    v_lshrrev_b32 v56, 16, v58
    v_mov_b32 v20, 0
    v_cmpx_lt_u32 vcc, v55, v56
    s_cbranch_execz mn_g2
    v_cmp_gt_u32 vcc, 15, v55
    v_and_b32 v56, 0xffff, v58
    v_add_lshl_u32 v56, v55, v56, 2
    v_add_u32 v56, v56, v46
    v_add_u32 v57, s22, v44
    v_and_or_b32 v57, v55, 12, v57
    v_cndmask_b32 v56, v56, v57, vcc
    buffer_load_dword v20, v56, s[8:11], 0 offen sc1
    s_waitcnt vmcnt(0)
mn_g2:
    s_mov_b64 exec, -1
    v_mov_b32 v21, 0
    v_mov_b32 v22, 0
    v_mov_b32 v23, 0
    v_mov_b32 v24, 0
    s_cmp_le_u32 s20, 4
    s_cbranch_scc1 mn_more
    v_add_u32 v55, 4, v35
    v_add_u32 v55, s24, v55
    v_lshrrev_b32 v56, 16, v58
    v_mov_b32 v21, 0
    v_cmpx_lt_u32 vcc, v55, v56
    s_cbranch_execz mn_g3
    v_cmp_gt_u32 vcc, 15, v55
    v_and_b32 v56, 0xffff, v58
    v_add_lshl_u32 v56, v55, v56, 2
    v_add_u32 v56, v56, v46
    v_add_u32 v57, s22, v44
    v_and_or_b32 v57, v55, 12, v57
    v_cndmask_b32 v56, v56, v57, vcc
    buffer_load_dword v21, v56, s[8:11], 0 offen sc1
    s_waitcnt vmcnt(0)
mn_g3:
    s_mov_b64 exec, -1
    v_add_u32 v55, 8, v35
    v_add_u32 v55, s24, v55
    v_lshrrev_b32 v56, 16, v58
    v_mov_b32 v22, 0
    v_cmpx_lt_u32 vcc, v55, v56
    s_cbranch_execz mn_g4
    v_cmp_gt_u32 vcc, 15, v55
    v_and_b32 v56, 0xffff, v58
    v_add_lshl_u32 v56, v55, v56, 2
    v_add_u32 v56, v56, v46
    v_add_u32 v57, s22, v44
    v_and_or_b32 v57, v55, 12, v57
    v_cndmask_b32 v56, v56, v57, vcc
    buffer_load_dword v22, v56, s[8:11], 0 offen sc1
    s_waitcnt vmcnt(0)
mn_g4:
    s_mov_b64 exec, -1
    v_add_u32 v55, 12, v35
    v_add_u32 v55, s24, v55
    v_lshrrev_b32 v56, 16, v58
    v_mov_b32 v23, 0
    v_cmpx_lt_u32 vcc, v55, v56
    s_cbranch_execz mn_g5
    v_cmp_gt_u32 vcc, 15, v55
    v_and_b32 v56, 0xffff, v58
    v_add_lshl_u32 v56, v55, v56, 2
    v_add_u32 v56, v56, v46
    v_add_u32 v57, s22, v44
    v_and_or_b32 v57, v55, 12, v57
    v_cndmask_b32 v56, v56, v57, vcc
    buffer_load_dword v23, v56, s[8:11], 0 offen sc1
    s_waitcnt vmcnt(0)
mn_g5:
    s_mov_b64 exec, -1
    v_add_u32 v55, 16, v35
    v_add_u32 v55, s24, v55
    v_lshrrev_b32 v56, 16, v58
    v_mov_b32 v24, 0
    v_cmpx_lt_u32 vcc, v55, v56
    s_cbranch_execz mn_g6
    v_cmp_gt_u32 vcc, 15, v55
    v_and_b32 v56, 0xffff, v58
    v_add_lshl_u32 v56, v55, v56, 2
    v_add_u32 v56, v56, v46
    v_add_u32 v57, s22, v44
    v_and_or_b32 v57, v55, 12, v57
    v_cndmask_b32 v56, v56, v57, vcc
    buffer_load_dword v24, v56, s[8:11], 0 offen sc1
    s_waitcnt vmcnt(0)
mn_g6:
    s_mov_b64 exec, -1
    s_branch mn_more
mn_last:
    s_endpgm
.section .rodata,"a"
.p2align 6
.amdhsa_kernel standalone__tensor_product_equiv_mace__graph_kernel
  .amdhsa_next_free_vgpr 168
  .amdhsa_next_free_sgpr 96
  .amdhsa_accum_offset 168
  .amdhsa_group_segment_fixed_size 0
  .amdhsa_kernarg_size 88
  .amdhsa_user_sgpr_count 2
  .amdhsa_user_sgpr_kernarg_segment_ptr 1
  .amdhsa_system_sgpr_workgroup_id_x 1
.end_amdhsa_kernel
```
